```python
import torch

def _softmax(x, axis=-1):
    return torch.softmax(x, dim=axis)
def _gelu(x):
    return torch.nn.functional.gelu(x, approximate="tanh")
def _silu(x):
    return torch.nn.functional.silu(x)
def _sigmoid(x):
    return torch.sigmoid(x)
def _layernorm(x, axis=-1, eps=1e-5):
    m = x.mean(dim=axis, keepdim=True)
    v = x.var(dim=axis, keepdim=True, unbiased=False)
    return (x - m) / torch.sqrt(v + eps)
def _scatter_add(tgt, idx, src, axis=0):
    return tgt.clone().index_add_(axis, idx, src)
def _segment_sum(src, seg, n):
    out = torch.zeros((n,) + src.shape[1:], dtype=src.dtype)
    return out.index_add_(0, seg, src)
def _pad(x, pw):
    flat = tuple(v for pair in reversed(pw) for v in pair)
    return torch.nn.functional.pad(x, flat)

kernel_name = 'concat_heads__spectral_gfnet__ssm_conv_s5__prompt'

def setup_inputs():

    _w = (lambda a: (lambda t: t.to(torch.bfloat16) if t.is_floating_point() else t)(torch.as_tensor(a)))
    def _A_setup():
        B, S, D = 1, 2048, 1024
        Df = D // 2 + 1
        return {
            "x": _w((lambda *s: torch.randn(*s, dtype=torch.bfloat16) * 0.05)(B, S, D)),
            "w_r": _w((lambda *s: torch.randn(*s, dtype=torch.bfloat16) * 0.8)(S, Df) * 0.02),
            "w_i": _w((lambda *s: torch.randn(*s, dtype=torch.bfloat16) * 0.8)(S, Df) * 0.02),
        }
    _A_in = _A_setup()

    def _B_setup():
        B, S, D = 1, 2048, 1024
        P = D
        Lambda_re = -0.5 * (lambda _x: torch.exp(torch.as_tensor(_x)))((lambda *s: torch.randn(*s, dtype=torch.bfloat16) * 0.2)(P))
        Lambda_im = (lambda *s: torch.randn(*s, dtype=torch.bfloat16) * 0.4)(P) * 1.0
        B_re = (lambda *s: torch.randn(*s, dtype=torch.bfloat16) * 0.2)(P, D) * (D ** -0.5)
        B_im = (lambda *s: torch.randn(*s, dtype=torch.bfloat16) * 0.2)(P, D) * (D ** -0.5)
        C_re = (lambda *s: torch.randn(*s, dtype=torch.bfloat16) * 0.2)(D, P) * (P ** -0.5)
        C_im = (lambda *s: torch.randn(*s, dtype=torch.bfloat16) * 0.2)(D, P) * (P ** -0.5)
        log_dt = (lambda *s: torch.randn(*s, dtype=torch.bfloat16) * 0.2)(P) * 0.3 - 2.0
        Dskip = (lambda *s: torch.randn(*s, dtype=torch.bfloat16) * 0.05)(D)
        return {
            "x": _w((lambda *s: torch.randn(*s, dtype=torch.bfloat16) * 0.05)(B, S, D)),
            "Lambda_re": _w(Lambda_re),
            "Lambda_im": _w(Lambda_im),
            "B_re": _w(B_re),
            "B_im": _w(B_im),
            "C_re": _w(C_re),
            "C_im": _w(C_im),
            "log_dt": _w(log_dt),
            "Dskip": _w(Dskip),
        }
    _B_in = _B_setup()

    return {
        "A_x": _A_in["x"],
        "A_w_r": _A_in["w_r"],
        "A_w_i": _A_in["w_i"],
        "B_x": _B_in["x"],
        "B_Lambda_re": _B_in["Lambda_re"],
        "B_Lambda_im": _B_in["Lambda_im"],
        "B_B_re": _B_in["B_re"],
        "B_B_im": _B_in["B_im"],
        "B_C_re": _B_in["C_re"],
        "B_C_im": _B_in["C_im"],
        "B_log_dt": _B_in["log_dt"],
        "B_Dskip": _B_in["Dskip"],
    }

def reference(A_x, A_w_r, A_w_i, B_x, B_Lambda_re, B_Lambda_im, B_B_re, B_B_im, B_C_re, B_C_im, B_log_dt, B_Dskip):
    def _A_ref(x, w_r, w_i):
        B, S, D = x.shape
        X = (lambda x, axes=(-2,-1): torch.fft.rfft2(x.float(), dim=axes))(x, axes=(-2, -1))
        W = w_r + 1j * w_i
        X = X * W
        y = (lambda x, s, axes=(-2,-1): torch.fft.irfft2(x, s=s, dim=axes).to(torch.bfloat16))(X, (S, D), axes=(-2, -1))
        return y

    def _B_ref(x, Lambda_re, Lambda_im, B_re, B_im, C_re, C_im, log_dt, Dskip):
        Bsz, L, H = x.shape
        Lam = Lambda_re + 1j * Lambda_im
        Bmat = B_re + 1j * B_im
        Cmat = C_re + 1j * C_im
        dt = torch.exp(log_dt)
        Lam_bar = torch.exp(dt * Lam)
        B_bar = ((Lam_bar - 1.0) / Lam)[:, None] * Bmat
        Bu = torch.einsum("bld,pd->blp", x + 0j, B_bar)
        h = torch.zeros_like(Bu[:, 0, :])
        hs = []
        for t in range(L):
            h = Lam_bar[None, :] * h + Bu[:, t, :]
            hs.append(h)
        hseq = torch.stack(hs, 1)
        y = 2.0 * torch.einsum("blp,dp->bld", hseq, Cmat).real + x * Dskip[None, None, :]
        return y

    a = _A_ref(A_x, A_w_r, A_w_i)
    b = _B_ref(B_x, B_Lambda_re, B_Lambda_im, B_B_re, B_B_im, B_C_re, B_C_im, B_log_dt, B_Dskip)
    return torch.concatenate([a, b], axis=-1)
```

```asm
; @launch kernel=g1_kernel grid=(256,1,1) block=(512,1,1) lds=131072
; @launch kernel=a1_kernel grid=(256,1,1) block=(64,1,1) lds=17408
; @launch kernel=wt_kernel grid=(272,1,1) block=(64,1,1) lds=16640
; @launch kernel=a2_kernel grid=(257,1,1) block=(128,1,1) lds=0
; @launch kernel=g2_kernel grid=(256,1,1) block=(256,1,1) lds=131072
; @launch kernel=a3_kernel grid=(256,1,1) block=(64,1,1) lds=0
.amdgcn_target "amdgcn-amd-amdhsa--gfx950"
.text
.globl g1_kernel
.p2align 8
.type g1_kernel,@function
g1_kernel:
s_cmp_ge_u32 s2, 256
s_cbranch_scc1 L_g1_kernel_end
s_load_dwordx2 s[4:5], s[0:1], 24
s_load_dwordx4 s[8:11], s[0:1], 32
s_load_dwordx4 s[12:15], s[0:1], 48
s_load_dwordx2 s[6:7], s[0:1], 80
s_load_dwordx4 s[16:19], s[0:1], 104
v_lshrrev_b32 v2, 6, v0
v_and_b32 v1, 63, v0
v_readfirstlane_b32 s20, v2
s_and_b32 s44, s2, 7
s_lshr_b32 s45, s2, 3
s_lshr_b32 s21, s44, 1
s_lshl_b32 s21, s21, 2
s_lshr_b32 s46, s45, 3
s_add_u32 s21, s21, s46
s_and_b32 s22, s44, 1
s_lshl_b32 s22, s22, 3
s_and_b32 s46, s45, 7
s_add_u32 s22, s22, s46
s_waitcnt lgkmcnt(0)
s_cmp_ge_u32 s20, 4
s_cbranch_scc0 L_g1_kernel_compute
s_sub_u32 s23, s20, 4
s_lshl_b32 s44, s21, 18
s_add_u32 s24, s4, s44
s_addc_u32 s25, s5, 0
s_mov_b32 s26, 0x40000
s_mov_b32 s27, 0x20000
s_bitcmp1_b32 s23, 0
s_cselect_b32 s28, s14, s12
s_cselect_b32 s29, s15, s13
s_lshl_b32 s44, s22, 17
s_add_u32 s28, s28, s44
s_addc_u32 s29, s29, 0
s_mov_b32 s30, 0x20000
s_mov_b32 s31, 0x20000
v_lshrrev_b32 v2, 5, v1
v_bfe_u32 v3, v1, 3, 2
v_and_b32 v4, 1, v3
v_lshrrev_b32 v5, 1, v3
v_lshlrev_b32 v6, 5, v2
v_lshl_add_u32 v6, v4, 4, v6
v_add_u32 v6, v6, v5
s_lshr_b32 s44, s23, 1
s_lshl_b32 s45, s44, 6
s_and_b32 s46, s23, 1
s_lshl_b32 s46, s46, 3
s_add_u32 s45, s45, s46
v_add_u32 v6, s45, v6
v_lshlrev_b32 v6, 11, v6
s_lshl_b32 s45, s44, 5
v_lshl_add_u32 v7, v2, 3, v3
v_add_u32 v7, s45, v7
v_lshlrev_b32 v7, 11, v7
v_and_b32 v4, 7, v1
v_lshrrev_b32 v5, 4, v1
v_xor_b32 v4, v4, v5
v_lshlrev_b32 v4, 4, v4
v_xor_b32 v5, 64, v4
v_add_u32 v8, v6, v4
v_add_u32 v12, v7, v4
v_add_u32 v9, v6, v5
v_add_u32 v9, 3072, v9
v_add_u32 v13, v7, v5
v_add_u32 v13, 7168, v13
v_add_u32 v10, v6, v4
v_add_u32 v10, 6144, v10
v_add_u32 v14, v7, v4
v_add_u32 v14, 30720, v14
v_add_u32 v11, v6, v5
v_add_u32 v11, 9216, v11
v_add_u32 v15, v7, v5
v_add_u32 v15, 37888, v15
s_lshl_b32 s47, s23, 12
s_and_b32 s49, s2, 7
s_lshl_b32 s49, s49, 8
s_or_b32 s44, s2, s23
s_cmp_lg_u32 s44, 0
s_cbranch_scc1 L_g1_kernel_nononce
s_load_dword s50, s[18:19], 0
v_mov_b32 v16, 0
s_waitcnt lgkmcnt(0)
s_add_u32 s50, s50, 1
s_cmp_eq_u32 s50, 0
s_cselect_b32 s50, 1, s50
v_mov_b32 v17, s50
global_store_dword v16, v17, s[16:17] sc0 sc1
global_store_dword v16, v17, s[18:19] offset:0
L_g1_kernel_nononce:
s_add_u32 m0, s47, 0
s_add_u32 s48, s49, 0
s_and_b32 s48, s48, 0x7ff
buffer_load_dwordx4 v8, s[24:27], s48 offen offset:0 lds
buffer_load_dwordx4 v9, s[24:27], s48 offen offset:1024 lds
buffer_load_dwordx4 v10, s[24:27], s48 offen offset:2048 lds
buffer_load_dwordx4 v11, s[24:27], s48 offen offset:3072 lds
s_add_u32 m0, s47, 16384
s_nop 0
buffer_load_dwordx4 v12, s[28:31], s48 offen offset:0 lds
buffer_load_dwordx4 v13, s[28:31], s48 offen offset:1024 lds
buffer_load_dwordx4 v14, s[28:31], s48 offen offset:2048 lds
buffer_load_dwordx4 v15, s[28:31], s48 offen offset:3072 lds
s_add_u32 m0, s47, 32768
s_add_u32 s48, s49, 128
s_and_b32 s48, s48, 0x7ff
buffer_load_dwordx4 v8, s[24:27], s48 offen offset:0 lds
buffer_load_dwordx4 v9, s[24:27], s48 offen offset:1024 lds
buffer_load_dwordx4 v10, s[24:27], s48 offen offset:2048 lds
buffer_load_dwordx4 v11, s[24:27], s48 offen offset:3072 lds
s_add_u32 m0, s47, 49152
s_nop 0
buffer_load_dwordx4 v12, s[28:31], s48 offen offset:0 lds
buffer_load_dwordx4 v13, s[28:31], s48 offen offset:1024 lds
buffer_load_dwordx4 v14, s[28:31], s48 offen offset:2048 lds
buffer_load_dwordx4 v15, s[28:31], s48 offen offset:3072 lds
s_add_u32 m0, s47, 65536
s_add_u32 s48, s49, 256
s_and_b32 s48, s48, 0x7ff
buffer_load_dwordx4 v8, s[24:27], s48 offen offset:0 lds
buffer_load_dwordx4 v9, s[24:27], s48 offen offset:1024 lds
buffer_load_dwordx4 v10, s[24:27], s48 offen offset:2048 lds
buffer_load_dwordx4 v11, s[24:27], s48 offen offset:3072 lds
s_add_u32 m0, s47, 81920
s_nop 0
buffer_load_dwordx4 v12, s[28:31], s48 offen offset:0 lds
buffer_load_dwordx4 v13, s[28:31], s48 offen offset:1024 lds
buffer_load_dwordx4 v14, s[28:31], s48 offen offset:2048 lds
buffer_load_dwordx4 v15, s[28:31], s48 offen offset:3072 lds
s_waitcnt vmcnt(16)
s_barrier
s_add_u32 m0, s47, 98304
s_add_u32 s48, s49, 384
s_and_b32 s48, s48, 0x7ff
buffer_load_dwordx4 v8, s[24:27], s48 offen offset:0 lds
buffer_load_dwordx4 v9, s[24:27], s48 offen offset:1024 lds
buffer_load_dwordx4 v10, s[24:27], s48 offen offset:2048 lds
buffer_load_dwordx4 v11, s[24:27], s48 offen offset:3072 lds
s_add_u32 m0, s47, 114688
s_nop 0
buffer_load_dwordx4 v12, s[28:31], s48 offen offset:0 lds
buffer_load_dwordx4 v13, s[28:31], s48 offen offset:1024 lds
buffer_load_dwordx4 v14, s[28:31], s48 offen offset:2048 lds
buffer_load_dwordx4 v15, s[28:31], s48 offen offset:3072 lds
s_waitcnt vmcnt(16)
s_barrier
s_add_u32 m0, s47, 0
s_add_u32 s48, s49, 512
s_and_b32 s48, s48, 0x7ff
buffer_load_dwordx4 v8, s[24:27], s48 offen offset:0 lds
buffer_load_dwordx4 v9, s[24:27], s48 offen offset:1024 lds
buffer_load_dwordx4 v10, s[24:27], s48 offen offset:2048 lds
buffer_load_dwordx4 v11, s[24:27], s48 offen offset:3072 lds
s_add_u32 m0, s47, 16384
s_nop 0
buffer_load_dwordx4 v12, s[28:31], s48 offen offset:0 lds
buffer_load_dwordx4 v13, s[28:31], s48 offen offset:1024 lds
buffer_load_dwordx4 v14, s[28:31], s48 offen offset:2048 lds
buffer_load_dwordx4 v15, s[28:31], s48 offen offset:3072 lds
s_waitcnt vmcnt(16)
s_barrier
s_add_u32 m0, s47, 32768
s_add_u32 s48, s49, 640
s_and_b32 s48, s48, 0x7ff
buffer_load_dwordx4 v8, s[24:27], s48 offen offset:0 lds
buffer_load_dwordx4 v9, s[24:27], s48 offen offset:1024 lds
buffer_load_dwordx4 v10, s[24:27], s48 offen offset:2048 lds
buffer_load_dwordx4 v11, s[24:27], s48 offen offset:3072 lds
s_add_u32 m0, s47, 49152
s_nop 0
buffer_load_dwordx4 v12, s[28:31], s48 offen offset:0 lds
buffer_load_dwordx4 v13, s[28:31], s48 offen offset:1024 lds
buffer_load_dwordx4 v14, s[28:31], s48 offen offset:2048 lds
buffer_load_dwordx4 v15, s[28:31], s48 offen offset:3072 lds
s_waitcnt vmcnt(16)
s_barrier
s_add_u32 m0, s47, 65536
s_add_u32 s48, s49, 768
s_and_b32 s48, s48, 0x7ff
buffer_load_dwordx4 v8, s[24:27], s48 offen offset:0 lds
buffer_load_dwordx4 v9, s[24:27], s48 offen offset:1024 lds
buffer_load_dwordx4 v10, s[24:27], s48 offen offset:2048 lds
buffer_load_dwordx4 v11, s[24:27], s48 offen offset:3072 lds
s_add_u32 m0, s47, 81920
s_nop 0
buffer_load_dwordx4 v12, s[28:31], s48 offen offset:0 lds
buffer_load_dwordx4 v13, s[28:31], s48 offen offset:1024 lds
buffer_load_dwordx4 v14, s[28:31], s48 offen offset:2048 lds
buffer_load_dwordx4 v15, s[28:31], s48 offen offset:3072 lds
s_waitcnt vmcnt(16)
s_barrier
s_add_u32 m0, s47, 98304
s_add_u32 s48, s49, 896
s_and_b32 s48, s48, 0x7ff
buffer_load_dwordx4 v8, s[24:27], s48 offen offset:0 lds
buffer_load_dwordx4 v9, s[24:27], s48 offen offset:1024 lds
buffer_load_dwordx4 v10, s[24:27], s48 offen offset:2048 lds
buffer_load_dwordx4 v11, s[24:27], s48 offen offset:3072 lds
s_add_u32 m0, s47, 114688
s_nop 0
buffer_load_dwordx4 v12, s[28:31], s48 offen offset:0 lds
buffer_load_dwordx4 v13, s[28:31], s48 offen offset:1024 lds
buffer_load_dwordx4 v14, s[28:31], s48 offen offset:2048 lds
buffer_load_dwordx4 v15, s[28:31], s48 offen offset:3072 lds
s_waitcnt vmcnt(16)
s_barrier
s_add_u32 m0, s47, 0
s_add_u32 s48, s49, 1024
s_and_b32 s48, s48, 0x7ff
buffer_load_dwordx4 v8, s[24:27], s48 offen offset:0 lds
buffer_load_dwordx4 v9, s[24:27], s48 offen offset:1024 lds
buffer_load_dwordx4 v10, s[24:27], s48 offen offset:2048 lds
buffer_load_dwordx4 v11, s[24:27], s48 offen offset:3072 lds
s_add_u32 m0, s47, 16384
s_nop 0
buffer_load_dwordx4 v12, s[28:31], s48 offen offset:0 lds
buffer_load_dwordx4 v13, s[28:31], s48 offen offset:1024 lds
buffer_load_dwordx4 v14, s[28:31], s48 offen offset:2048 lds
buffer_load_dwordx4 v15, s[28:31], s48 offen offset:3072 lds
s_waitcnt vmcnt(16)
s_barrier
s_add_u32 m0, s47, 32768
s_add_u32 s48, s49, 1152
s_and_b32 s48, s48, 0x7ff
buffer_load_dwordx4 v8, s[24:27], s48 offen offset:0 lds
buffer_load_dwordx4 v9, s[24:27], s48 offen offset:1024 lds
buffer_load_dwordx4 v10, s[24:27], s48 offen offset:2048 lds
buffer_load_dwordx4 v11, s[24:27], s48 offen offset:3072 lds
s_add_u32 m0, s47, 49152
s_nop 0
buffer_load_dwordx4 v12, s[28:31], s48 offen offset:0 lds
buffer_load_dwordx4 v13, s[28:31], s48 offen offset:1024 lds
buffer_load_dwordx4 v14, s[28:31], s48 offen offset:2048 lds
buffer_load_dwordx4 v15, s[28:31], s48 offen offset:3072 lds
s_waitcnt vmcnt(16)
s_barrier
s_add_u32 m0, s47, 65536
s_add_u32 s48, s49, 1280
s_and_b32 s48, s48, 0x7ff
buffer_load_dwordx4 v8, s[24:27], s48 offen offset:0 lds
buffer_load_dwordx4 v9, s[24:27], s48 offen offset:1024 lds
buffer_load_dwordx4 v10, s[24:27], s48 offen offset:2048 lds
buffer_load_dwordx4 v11, s[24:27], s48 offen offset:3072 lds
s_add_u32 m0, s47, 81920
s_nop 0
buffer_load_dwordx4 v12, s[28:31], s48 offen offset:0 lds
buffer_load_dwordx4 v13, s[28:31], s48 offen offset:1024 lds
buffer_load_dwordx4 v14, s[28:31], s48 offen offset:2048 lds
buffer_load_dwordx4 v15, s[28:31], s48 offen offset:3072 lds
s_waitcnt vmcnt(16)
s_barrier
s_add_u32 m0, s47, 98304
s_add_u32 s48, s49, 1408
s_and_b32 s48, s48, 0x7ff
buffer_load_dwordx4 v8, s[24:27], s48 offen offset:0 lds
buffer_load_dwordx4 v9, s[24:27], s48 offen offset:1024 lds
buffer_load_dwordx4 v10, s[24:27], s48 offen offset:2048 lds
buffer_load_dwordx4 v11, s[24:27], s48 offen offset:3072 lds
s_add_u32 m0, s47, 114688
s_nop 0
buffer_load_dwordx4 v12, s[28:31], s48 offen offset:0 lds
buffer_load_dwordx4 v13, s[28:31], s48 offen offset:1024 lds
buffer_load_dwordx4 v14, s[28:31], s48 offen offset:2048 lds
buffer_load_dwordx4 v15, s[28:31], s48 offen offset:3072 lds
s_waitcnt vmcnt(16)
s_barrier
s_add_u32 m0, s47, 0
s_add_u32 s48, s49, 1536
s_and_b32 s48, s48, 0x7ff
buffer_load_dwordx4 v8, s[24:27], s48 offen offset:0 lds
buffer_load_dwordx4 v9, s[24:27], s48 offen offset:1024 lds
buffer_load_dwordx4 v10, s[24:27], s48 offen offset:2048 lds
buffer_load_dwordx4 v11, s[24:27], s48 offen offset:3072 lds
s_add_u32 m0, s47, 16384
s_nop 0
buffer_load_dwordx4 v12, s[28:31], s48 offen offset:0 lds
buffer_load_dwordx4 v13, s[28:31], s48 offen offset:1024 lds
buffer_load_dwordx4 v14, s[28:31], s48 offen offset:2048 lds
buffer_load_dwordx4 v15, s[28:31], s48 offen offset:3072 lds
s_waitcnt vmcnt(16)
s_barrier
s_add_u32 m0, s47, 32768
s_add_u32 s48, s49, 1664
s_and_b32 s48, s48, 0x7ff
buffer_load_dwordx4 v8, s[24:27], s48 offen offset:0 lds
buffer_load_dwordx4 v9, s[24:27], s48 offen offset:1024 lds
buffer_load_dwordx4 v10, s[24:27], s48 offen offset:2048 lds
buffer_load_dwordx4 v11, s[24:27], s48 offen offset:3072 lds
s_add_u32 m0, s47, 49152
s_nop 0
buffer_load_dwordx4 v12, s[28:31], s48 offen offset:0 lds
buffer_load_dwordx4 v13, s[28:31], s48 offen offset:1024 lds
buffer_load_dwordx4 v14, s[28:31], s48 offen offset:2048 lds
buffer_load_dwordx4 v15, s[28:31], s48 offen offset:3072 lds
s_waitcnt vmcnt(16)
s_barrier
s_add_u32 m0, s47, 65536
s_add_u32 s48, s49, 1792
s_and_b32 s48, s48, 0x7ff
buffer_load_dwordx4 v8, s[24:27], s48 offen offset:0 lds
buffer_load_dwordx4 v9, s[24:27], s48 offen offset:1024 lds
buffer_load_dwordx4 v10, s[24:27], s48 offen offset:2048 lds
buffer_load_dwordx4 v11, s[24:27], s48 offen offset:3072 lds
s_add_u32 m0, s47, 81920
s_nop 0
buffer_load_dwordx4 v12, s[28:31], s48 offen offset:0 lds
buffer_load_dwordx4 v13, s[28:31], s48 offen offset:1024 lds
buffer_load_dwordx4 v14, s[28:31], s48 offen offset:2048 lds
buffer_load_dwordx4 v15, s[28:31], s48 offen offset:3072 lds
s_waitcnt vmcnt(16)
s_barrier
s_add_u32 m0, s47, 98304
s_add_u32 s48, s49, 1920
s_and_b32 s48, s48, 0x7ff
buffer_load_dwordx4 v8, s[24:27], s48 offen offset:0 lds
buffer_load_dwordx4 v9, s[24:27], s48 offen offset:1024 lds
buffer_load_dwordx4 v10, s[24:27], s48 offen offset:2048 lds
buffer_load_dwordx4 v11, s[24:27], s48 offen offset:3072 lds
s_add_u32 m0, s47, 114688
s_nop 0
buffer_load_dwordx4 v12, s[28:31], s48 offen offset:0 lds
buffer_load_dwordx4 v13, s[28:31], s48 offen offset:1024 lds
buffer_load_dwordx4 v14, s[28:31], s48 offen offset:2048 lds
buffer_load_dwordx4 v15, s[28:31], s48 offen offset:3072 lds
s_waitcnt vmcnt(16)
s_barrier
s_waitcnt vmcnt(8)
s_barrier
s_waitcnt vmcnt(0)
s_barrier
s_barrier
s_endpgm
L_g1_kernel_compute:
s_lshr_b32 s23, s20, 1
s_and_b32 s44, s20, 1
s_mov_b32 s51, s44
v_and_b32 v6, 31, v1
v_lshrrev_b32 v5, 5, v1
v_and_b32 v4, 0x13, v6
v_bfe_u32 v7, v6, 2, 1
v_lshl_or_b32 v4, v7, 3, v4
v_bfe_u32 v7, v6, 3, 1
v_lshl_or_b32 v4, v7, 2, v4
s_lshl_b32 s45, s22, 6
s_lshl_b32 s46, s44, 5
s_add_u32 s45, s45, s46
v_add_u32 v4, s45, v4
v_lshlrev_b32 v7, 1, v4
global_load_ushort v8, v7, s[8:9]
global_load_ushort v9, v7, s[10:11]
global_load_ushort v10, v7, s[6:7]
s_getpc_b64 s[52:53]
L_pc1:
s_add_u32 s52, s52, tables-L_pc1
s_addc_u32 s53, s53, 0
v_lshlrev_b32 v11, 4, v1
global_load_dwordx4 v[248:251], v11, s[52:53] offset:0
global_load_dwordx4 v[252:255], v11, s[52:53] offset:1024
v_bfe_u32 v7, v6, 1, 3
v_xor_b32 v7, v7, v5
v_lshlrev_b32 v7, 4, v7
v_lshl_add_u32 v7, v6, 7, v7
s_lshl_b32 s45, s23, 13
s_lshl_b32 s46, s44, 13
s_add_u32 s46, s46, 16384
v_xor_b32 v12, 0, v7
v_add_u32 v128, s45, v12
v_add_u32 v132, s46, v12
v_add_u32 v136, 65536, v128
v_add_u32 v140, 65536, v132
v_xor_b32 v12, 32, v7
v_add_u32 v129, s45, v12
v_add_u32 v133, s46, v12
v_add_u32 v137, 65536, v129
v_add_u32 v141, 65536, v133
v_xor_b32 v12, 64, v7
v_add_u32 v130, s45, v12
v_add_u32 v134, s46, v12
v_add_u32 v138, 65536, v130
v_add_u32 v142, 65536, v134
v_xor_b32 v12, 96, v7
v_add_u32 v131, s45, v12
v_add_u32 v135, s46, v12
v_add_u32 v139, 65536, v131
v_add_u32 v143, 65536, v135
v_mov_b64 v[64:65], 0
v_mov_b64 v[66:67], 0
v_mov_b64 v[68:69], 0
v_mov_b64 v[70:71], 0
v_mov_b64 v[72:73], 0
v_mov_b64 v[74:75], 0
v_mov_b64 v[76:77], 0
v_mov_b64 v[78:79], 0
v_mov_b64 v[80:81], 0
v_mov_b64 v[82:83], 0
v_mov_b64 v[84:85], 0
v_mov_b64 v[86:87], 0
v_mov_b64 v[88:89], 0
v_mov_b64 v[90:91], 0
v_mov_b64 v[92:93], 0
v_mov_b64 v[94:95], 0
v_mov_b64 v[96:97], 0
v_mov_b64 v[98:99], 0
v_mov_b64 v[100:101], 0
v_mov_b64 v[102:103], 0
v_mov_b64 v[104:105], 0
v_mov_b64 v[106:107], 0
v_mov_b64 v[108:109], 0
v_mov_b64 v[110:111], 0
v_mov_b64 v[112:113], 0
v_mov_b64 v[114:115], 0
v_mov_b64 v[116:117], 0
v_mov_b64 v[118:119], 0
v_mov_b64 v[120:121], 0
v_mov_b64 v[122:123], 0
v_mov_b64 v[124:125], 0
v_mov_b64 v[126:127], 0
s_add_u32 s32, s18, 65536
s_addc_u32 s33, s19, 0
s_mov_b32 s34, 0x40000
s_mov_b32 s35, 0x20000
s_add_u32 s36, s18, 1048576
s_addc_u32 s37, s19, 0
s_mov_b32 s38, 0x800000
s_mov_b32 s39, 0x20000
s_waitcnt vmcnt(2)
v_lshlrev_b32 v8, 16, v8
v_lshlrev_b32 v9, 16, v9
v_lshlrev_b32 v10, 16, v10
v_mul_f32 v10, 0x3fb8aa3b, v10
v_exp_f32 v10, v10
s_nop 0
v_cvt_pk_bf16_f32 v10, v10, v10
v_lshlrev_b32 v10, 16, v10
v_mul_f32 v12, v10, v8
v_mul_f32 v13, v10, v9
v_mul_f32 v12, 0x3fb8aa3b, v12
v_exp_f32 v12, v12
v_mul_f32 v13, 0.15915494, v13
v_rndne_f32 v14, v13
v_sub_f32 v13, v13, v14
v_cos_f32 v14, v13
v_sin_f32 v15, v13
v_mul_f32 v24, v12, v14
v_mul_f32 v25, v12, v15
v_add_f32 v12, -1.0, v24
v_mul_f32 v13, v8, v8
v_fma_f32 v13, v9, v9, v13
v_rcp_f32 v13, v13
s_nop 0
v_add_f32 v13, v13, v13
v_mul_f32 v14, v12, v8
v_fma_f32 v14, v25, v9, v14
v_mul_f32 v26, v14, v13
v_mul_f32 v14, v25, v8
v_fma_f32 v14, -v12, v9, v14
v_mul_f32 v27, v14, v13
v_mul_f32 v12, v25, v25
v_mul_f32 v13, v24, v25
v_fma_f32 v28, v24, v24, -v12
v_add_f32 v29, v13, v13
v_mul_f32 v12, v29, v29
v_mul_f32 v13, v28, v29
v_fma_f32 v28, v28, v28, -v12
v_add_f32 v29, v13, v13
v_mul_f32 v12, v29, v29
v_mul_f32 v13, v28, v29
v_fma_f32 v28, v28, v28, -v12
v_add_f32 v29, v13, v13
v_mul_f32 v12, v29, v29
v_mul_f32 v13, v28, v29
v_fma_f32 v28, v28, v28, -v12
v_add_f32 v29, v13, v13
v_mul_f32 v12, v29, v29
v_mul_f32 v13, v28, v29
v_fma_f32 v30, v28, v28, -v12
v_add_f32 v31, v13, v13
v_mul_f32 v12, v31, v31
v_mul_f32 v13, v30, v31
v_fma_f32 v30, v30, v30, -v12
v_add_f32 v31, v13, v13
v_mul_f32 v12, v31, v31
v_mul_f32 v13, v30, v31
v_fma_f32 v30, v30, v30, -v12
v_add_f32 v31, v13, v13
v_mul_f32 v12, v31, v31
v_mul_f32 v13, v30, v31
v_fma_f32 v2, v30, v30, -v12
v_add_f32 v3, v13, v13
s_barrier
ds_read_b128 v[32:35], v128 offset:0
ds_read_b128 v[36:39], v132 offset:0
ds_read_b128 v[40:43], v132 offset:4096
ds_read_b128 v[44:47], v128 offset:4096
s_waitcnt lgkmcnt(2)
v_mfma_f32_32x32x16_bf16 v[64:79], v[32:35], v[36:39], v[64:79]
ds_read_b128 v[48:51], v129 offset:0
ds_read_b128 v[52:55], v133 offset:0
s_waitcnt lgkmcnt(3)
v_mfma_f32_32x32x16_bf16 v[80:95], v[32:35], v[40:43], v[80:95]
ds_read_b128 v[56:59], v133 offset:4096
ds_read_b128 v[60:63], v129 offset:4096
s_waitcnt lgkmcnt(4)
v_mfma_f32_32x32x16_bf16 v[96:111], v[44:47], v[36:39], v[96:111]
v_mfma_f32_32x32x16_bf16 v[112:127], v[44:47], v[40:43], v[112:127]
s_waitcnt lgkmcnt(2)
v_mfma_f32_32x32x16_bf16 v[64:79], v[48:51], v[52:55], v[64:79]
ds_read_b128 v[32:35], v130 offset:0
ds_read_b128 v[36:39], v134 offset:0
s_waitcnt lgkmcnt(3)
v_mfma_f32_32x32x16_bf16 v[80:95], v[48:51], v[56:59], v[80:95]
ds_read_b128 v[40:43], v134 offset:4096
ds_read_b128 v[44:47], v130 offset:4096
s_waitcnt lgkmcnt(4)
v_mfma_f32_32x32x16_bf16 v[96:111], v[60:63], v[52:55], v[96:111]
v_mfma_f32_32x32x16_bf16 v[112:127], v[60:63], v[56:59], v[112:127]
s_waitcnt lgkmcnt(2)
v_mfma_f32_32x32x16_bf16 v[64:79], v[32:35], v[36:39], v[64:79]
ds_read_b128 v[48:51], v131 offset:0
ds_read_b128 v[52:55], v135 offset:0
s_waitcnt lgkmcnt(3)
v_mfma_f32_32x32x16_bf16 v[80:95], v[32:35], v[40:43], v[80:95]
ds_read_b128 v[56:59], v135 offset:4096
ds_read_b128 v[60:63], v131 offset:4096
s_waitcnt lgkmcnt(4)
v_mfma_f32_32x32x16_bf16 v[96:111], v[44:47], v[36:39], v[96:111]
v_mfma_f32_32x32x16_bf16 v[112:127], v[44:47], v[40:43], v[112:127]
s_waitcnt lgkmcnt(0)
s_barrier
v_mfma_f32_32x32x16_bf16 v[64:79], v[48:51], v[52:55], v[64:79]
ds_read_b128 v[32:35], v128 offset:32768
ds_read_b128 v[36:39], v132 offset:32768
v_mfma_f32_32x32x16_bf16 v[80:95], v[48:51], v[56:59], v[80:95]
ds_read_b128 v[40:43], v132 offset:36864
ds_read_b128 v[44:47], v128 offset:36864
v_mfma_f32_32x32x16_bf16 v[96:111], v[60:63], v[52:55], v[96:111]
v_mfma_f32_32x32x16_bf16 v[112:127], v[60:63], v[56:59], v[112:127]
s_waitcnt lgkmcnt(2)
v_mfma_f32_32x32x16_bf16 v[64:79], v[32:35], v[36:39], v[64:79]
ds_read_b128 v[48:51], v129 offset:32768
ds_read_b128 v[52:55], v133 offset:32768
s_waitcnt lgkmcnt(3)
v_mfma_f32_32x32x16_bf16 v[80:95], v[32:35], v[40:43], v[80:95]
ds_read_b128 v[56:59], v133 offset:36864
ds_read_b128 v[60:63], v129 offset:36864
s_waitcnt lgkmcnt(4)
v_mfma_f32_32x32x16_bf16 v[96:111], v[44:47], v[36:39], v[96:111]
v_mfma_f32_32x32x16_bf16 v[112:127], v[44:47], v[40:43], v[112:127]
s_waitcnt lgkmcnt(2)
v_mfma_f32_32x32x16_bf16 v[64:79], v[48:51], v[52:55], v[64:79]
ds_read_b128 v[32:35], v130 offset:32768
ds_read_b128 v[36:39], v134 offset:32768
s_waitcnt lgkmcnt(3)
v_mfma_f32_32x32x16_bf16 v[80:95], v[48:51], v[56:59], v[80:95]
ds_read_b128 v[40:43], v134 offset:36864
ds_read_b128 v[44:47], v130 offset:36864
s_waitcnt lgkmcnt(4)
v_mfma_f32_32x32x16_bf16 v[96:111], v[60:63], v[52:55], v[96:111]
v_mfma_f32_32x32x16_bf16 v[112:127], v[60:63], v[56:59], v[112:127]
s_waitcnt lgkmcnt(2)
v_mfma_f32_32x32x16_bf16 v[64:79], v[32:35], v[36:39], v[64:79]
ds_read_b128 v[48:51], v131 offset:32768
ds_read_b128 v[52:55], v135 offset:32768
s_waitcnt lgkmcnt(3)
v_mfma_f32_32x32x16_bf16 v[80:95], v[32:35], v[40:43], v[80:95]
ds_read_b128 v[56:59], v135 offset:36864
ds_read_b128 v[60:63], v131 offset:36864
s_waitcnt lgkmcnt(4)
v_mfma_f32_32x32x16_bf16 v[96:111], v[44:47], v[36:39], v[96:111]
v_mfma_f32_32x32x16_bf16 v[112:127], v[44:47], v[40:43], v[112:127]
s_waitcnt lgkmcnt(0)
s_barrier
v_mfma_f32_32x32x16_bf16 v[64:79], v[48:51], v[52:55], v[64:79]
ds_read_b128 v[32:35], v136 offset:0
ds_read_b128 v[36:39], v140 offset:0
v_mfma_f32_32x32x16_bf16 v[80:95], v[48:51], v[56:59], v[80:95]
ds_read_b128 v[40:43], v140 offset:4096
ds_read_b128 v[44:47], v136 offset:4096
v_mfma_f32_32x32x16_bf16 v[96:111], v[60:63], v[52:55], v[96:111]
v_mfma_f32_32x32x16_bf16 v[112:127], v[60:63], v[56:59], v[112:127]
s_waitcnt lgkmcnt(2)
v_mfma_f32_32x32x16_bf16 v[64:79], v[32:35], v[36:39], v[64:79]
ds_read_b128 v[48:51], v137 offset:0
ds_read_b128 v[52:55], v141 offset:0
s_waitcnt lgkmcnt(3)
v_mfma_f32_32x32x16_bf16 v[80:95], v[32:35], v[40:43], v[80:95]
ds_read_b128 v[56:59], v141 offset:4096
ds_read_b128 v[60:63], v137 offset:4096
s_waitcnt lgkmcnt(4)
v_mfma_f32_32x32x16_bf16 v[96:111], v[44:47], v[36:39], v[96:111]
v_mfma_f32_32x32x16_bf16 v[112:127], v[44:47], v[40:43], v[112:127]
s_waitcnt lgkmcnt(2)
v_mfma_f32_32x32x16_bf16 v[64:79], v[48:51], v[52:55], v[64:79]
ds_read_b128 v[32:35], v138 offset:0
ds_read_b128 v[36:39], v142 offset:0
s_waitcnt lgkmcnt(3)
v_mfma_f32_32x32x16_bf16 v[80:95], v[48:51], v[56:59], v[80:95]
ds_read_b128 v[40:43], v142 offset:4096
ds_read_b128 v[44:47], v138 offset:4096
s_waitcnt lgkmcnt(4)
v_mfma_f32_32x32x16_bf16 v[96:111], v[60:63], v[52:55], v[96:111]
v_mfma_f32_32x32x16_bf16 v[112:127], v[60:63], v[56:59], v[112:127]
s_waitcnt lgkmcnt(2)
v_mfma_f32_32x32x16_bf16 v[64:79], v[32:35], v[36:39], v[64:79]
ds_read_b128 v[48:51], v139 offset:0
ds_read_b128 v[52:55], v143 offset:0
s_waitcnt lgkmcnt(3)
v_mfma_f32_32x32x16_bf16 v[80:95], v[32:35], v[40:43], v[80:95]
ds_read_b128 v[56:59], v143 offset:4096
ds_read_b128 v[60:63], v139 offset:4096
s_waitcnt lgkmcnt(4)
v_mfma_f32_32x32x16_bf16 v[96:111], v[44:47], v[36:39], v[96:111]
v_mfma_f32_32x32x16_bf16 v[112:127], v[44:47], v[40:43], v[112:127]
s_waitcnt lgkmcnt(0)
s_barrier
v_mfma_f32_32x32x16_bf16 v[64:79], v[48:51], v[52:55], v[64:79]
ds_read_b128 v[32:35], v136 offset:32768
ds_read_b128 v[36:39], v140 offset:32768
v_mfma_f32_32x32x16_bf16 v[80:95], v[48:51], v[56:59], v[80:95]
ds_read_b128 v[40:43], v140 offset:36864
ds_read_b128 v[44:47], v136 offset:36864
v_mfma_f32_32x32x16_bf16 v[96:111], v[60:63], v[52:55], v[96:111]
v_mfma_f32_32x32x16_bf16 v[112:127], v[60:63], v[56:59], v[112:127]
s_waitcnt lgkmcnt(2)
v_mfma_f32_32x32x16_bf16 v[64:79], v[32:35], v[36:39], v[64:79]
ds_read_b128 v[48:51], v137 offset:32768
ds_read_b128 v[52:55], v141 offset:32768
s_waitcnt lgkmcnt(3)
v_mfma_f32_32x32x16_bf16 v[80:95], v[32:35], v[40:43], v[80:95]
ds_read_b128 v[56:59], v141 offset:36864
ds_read_b128 v[60:63], v137 offset:36864
s_waitcnt lgkmcnt(4)
v_mfma_f32_32x32x16_bf16 v[96:111], v[44:47], v[36:39], v[96:111]
v_mfma_f32_32x32x16_bf16 v[112:127], v[44:47], v[40:43], v[112:127]
s_waitcnt lgkmcnt(2)
v_mfma_f32_32x32x16_bf16 v[64:79], v[48:51], v[52:55], v[64:79]
ds_read_b128 v[32:35], v138 offset:32768
ds_read_b128 v[36:39], v142 offset:32768
s_waitcnt lgkmcnt(3)
v_mfma_f32_32x32x16_bf16 v[80:95], v[48:51], v[56:59], v[80:95]
ds_read_b128 v[40:43], v142 offset:36864
ds_read_b128 v[44:47], v138 offset:36864
s_waitcnt lgkmcnt(4)
v_mfma_f32_32x32x16_bf16 v[96:111], v[60:63], v[52:55], v[96:111]
v_mfma_f32_32x32x16_bf16 v[112:127], v[60:63], v[56:59], v[112:127]
s_waitcnt lgkmcnt(2)
v_mfma_f32_32x32x16_bf16 v[64:79], v[32:35], v[36:39], v[64:79]
ds_read_b128 v[48:51], v139 offset:32768
ds_read_b128 v[52:55], v143 offset:32768
s_waitcnt lgkmcnt(3)
v_mfma_f32_32x32x16_bf16 v[80:95], v[32:35], v[40:43], v[80:95]
ds_read_b128 v[56:59], v143 offset:36864
ds_read_b128 v[60:63], v139 offset:36864
s_waitcnt lgkmcnt(4)
v_mfma_f32_32x32x16_bf16 v[96:111], v[44:47], v[36:39], v[96:111]
v_mfma_f32_32x32x16_bf16 v[112:127], v[44:47], v[40:43], v[112:127]
s_waitcnt lgkmcnt(0)
s_barrier
v_mfma_f32_32x32x16_bf16 v[64:79], v[48:51], v[52:55], v[64:79]
ds_read_b128 v[32:35], v128 offset:0
ds_read_b128 v[36:39], v132 offset:0
v_mfma_f32_32x32x16_bf16 v[80:95], v[48:51], v[56:59], v[80:95]
ds_read_b128 v[40:43], v132 offset:4096
ds_read_b128 v[44:47], v128 offset:4096
v_mfma_f32_32x32x16_bf16 v[96:111], v[60:63], v[52:55], v[96:111]
v_mfma_f32_32x32x16_bf16 v[112:127], v[60:63], v[56:59], v[112:127]
s_waitcnt lgkmcnt(2)
v_mfma_f32_32x32x16_bf16 v[64:79], v[32:35], v[36:39], v[64:79]
ds_read_b128 v[48:51], v129 offset:0
ds_read_b128 v[52:55], v133 offset:0
s_waitcnt lgkmcnt(3)
v_mfma_f32_32x32x16_bf16 v[80:95], v[32:35], v[40:43], v[80:95]
ds_read_b128 v[56:59], v133 offset:4096
ds_read_b128 v[60:63], v129 offset:4096
s_waitcnt lgkmcnt(4)
v_mfma_f32_32x32x16_bf16 v[96:111], v[44:47], v[36:39], v[96:111]
v_mfma_f32_32x32x16_bf16 v[112:127], v[44:47], v[40:43], v[112:127]
s_waitcnt lgkmcnt(2)
v_mfma_f32_32x32x16_bf16 v[64:79], v[48:51], v[52:55], v[64:79]
ds_read_b128 v[32:35], v130 offset:0
ds_read_b128 v[36:39], v134 offset:0
s_waitcnt lgkmcnt(3)
v_mfma_f32_32x32x16_bf16 v[80:95], v[48:51], v[56:59], v[80:95]
ds_read_b128 v[40:43], v134 offset:4096
ds_read_b128 v[44:47], v130 offset:4096
s_waitcnt lgkmcnt(4)
v_mfma_f32_32x32x16_bf16 v[96:111], v[60:63], v[52:55], v[96:111]
v_mfma_f32_32x32x16_bf16 v[112:127], v[60:63], v[56:59], v[112:127]
s_waitcnt lgkmcnt(2)
v_mfma_f32_32x32x16_bf16 v[64:79], v[32:35], v[36:39], v[64:79]
ds_read_b128 v[48:51], v131 offset:0
ds_read_b128 v[52:55], v135 offset:0
s_waitcnt lgkmcnt(3)
v_mfma_f32_32x32x16_bf16 v[80:95], v[32:35], v[40:43], v[80:95]
ds_read_b128 v[56:59], v135 offset:4096
ds_read_b128 v[60:63], v131 offset:4096
s_waitcnt lgkmcnt(4)
v_mfma_f32_32x32x16_bf16 v[96:111], v[44:47], v[36:39], v[96:111]
v_mfma_f32_32x32x16_bf16 v[112:127], v[44:47], v[40:43], v[112:127]
s_waitcnt lgkmcnt(0)
s_barrier
v_mfma_f32_32x32x16_bf16 v[64:79], v[48:51], v[52:55], v[64:79]
ds_read_b128 v[32:35], v128 offset:32768
ds_read_b128 v[36:39], v132 offset:32768
v_mfma_f32_32x32x16_bf16 v[80:95], v[48:51], v[56:59], v[80:95]
ds_read_b128 v[40:43], v132 offset:36864
ds_read_b128 v[44:47], v128 offset:36864
v_mfma_f32_32x32x16_bf16 v[96:111], v[60:63], v[52:55], v[96:111]
v_mfma_f32_32x32x16_bf16 v[112:127], v[60:63], v[56:59], v[112:127]
s_waitcnt lgkmcnt(2)
v_mfma_f32_32x32x16_bf16 v[64:79], v[32:35], v[36:39], v[64:79]
ds_read_b128 v[48:51], v129 offset:32768
ds_read_b128 v[52:55], v133 offset:32768
s_waitcnt lgkmcnt(3)
v_mfma_f32_32x32x16_bf16 v[80:95], v[32:35], v[40:43], v[80:95]
ds_read_b128 v[56:59], v133 offset:36864
ds_read_b128 v[60:63], v129 offset:36864
s_waitcnt lgkmcnt(4)
v_mfma_f32_32x32x16_bf16 v[96:111], v[44:47], v[36:39], v[96:111]
v_mfma_f32_32x32x16_bf16 v[112:127], v[44:47], v[40:43], v[112:127]
s_waitcnt lgkmcnt(2)
v_mfma_f32_32x32x16_bf16 v[64:79], v[48:51], v[52:55], v[64:79]
ds_read_b128 v[32:35], v130 offset:32768
ds_read_b128 v[36:39], v134 offset:32768
s_waitcnt lgkmcnt(3)
v_mfma_f32_32x32x16_bf16 v[80:95], v[48:51], v[56:59], v[80:95]
ds_read_b128 v[40:43], v134 offset:36864
ds_read_b128 v[44:47], v130 offset:36864
s_waitcnt lgkmcnt(4)
v_mfma_f32_32x32x16_bf16 v[96:111], v[60:63], v[52:55], v[96:111]
v_mfma_f32_32x32x16_bf16 v[112:127], v[60:63], v[56:59], v[112:127]
s_waitcnt lgkmcnt(2)
v_mfma_f32_32x32x16_bf16 v[64:79], v[32:35], v[36:39], v[64:79]
ds_read_b128 v[48:51], v131 offset:32768
ds_read_b128 v[52:55], v135 offset:32768
s_waitcnt lgkmcnt(3)
v_mfma_f32_32x32x16_bf16 v[80:95], v[32:35], v[40:43], v[80:95]
ds_read_b128 v[56:59], v135 offset:36864
ds_read_b128 v[60:63], v131 offset:36864
s_waitcnt lgkmcnt(4)
v_mfma_f32_32x32x16_bf16 v[96:111], v[44:47], v[36:39], v[96:111]
v_mfma_f32_32x32x16_bf16 v[112:127], v[44:47], v[40:43], v[112:127]
s_waitcnt lgkmcnt(0)
s_barrier
v_mfma_f32_32x32x16_bf16 v[64:79], v[48:51], v[52:55], v[64:79]
ds_read_b128 v[32:35], v136 offset:0
ds_read_b128 v[36:39], v140 offset:0
v_mfma_f32_32x32x16_bf16 v[80:95], v[48:51], v[56:59], v[80:95]
ds_read_b128 v[40:43], v140 offset:4096
ds_read_b128 v[44:47], v136 offset:4096
v_mfma_f32_32x32x16_bf16 v[96:111], v[60:63], v[52:55], v[96:111]
v_mfma_f32_32x32x16_bf16 v[112:127], v[60:63], v[56:59], v[112:127]
s_waitcnt lgkmcnt(2)
v_mfma_f32_32x32x16_bf16 v[64:79], v[32:35], v[36:39], v[64:79]
ds_read_b128 v[48:51], v137 offset:0
ds_read_b128 v[52:55], v141 offset:0
s_waitcnt lgkmcnt(3)
v_mfma_f32_32x32x16_bf16 v[80:95], v[32:35], v[40:43], v[80:95]
ds_read_b128 v[56:59], v141 offset:4096
ds_read_b128 v[60:63], v137 offset:4096
s_waitcnt lgkmcnt(4)
v_mfma_f32_32x32x16_bf16 v[96:111], v[44:47], v[36:39], v[96:111]
v_mfma_f32_32x32x16_bf16 v[112:127], v[44:47], v[40:43], v[112:127]
s_waitcnt lgkmcnt(2)
v_mfma_f32_32x32x16_bf16 v[64:79], v[48:51], v[52:55], v[64:79]
ds_read_b128 v[32:35], v138 offset:0
ds_read_b128 v[36:39], v142 offset:0
s_waitcnt lgkmcnt(3)
v_mfma_f32_32x32x16_bf16 v[80:95], v[48:51], v[56:59], v[80:95]
ds_read_b128 v[40:43], v142 offset:4096
ds_read_b128 v[44:47], v138 offset:4096
s_waitcnt lgkmcnt(4)
v_mfma_f32_32x32x16_bf16 v[96:111], v[60:63], v[52:55], v[96:111]
v_mfma_f32_32x32x16_bf16 v[112:127], v[60:63], v[56:59], v[112:127]
s_waitcnt lgkmcnt(2)
v_mfma_f32_32x32x16_bf16 v[64:79], v[32:35], v[36:39], v[64:79]
ds_read_b128 v[48:51], v139 offset:0
ds_read_b128 v[52:55], v143 offset:0
s_waitcnt lgkmcnt(3)
v_mfma_f32_32x32x16_bf16 v[80:95], v[32:35], v[40:43], v[80:95]
ds_read_b128 v[56:59], v143 offset:4096
ds_read_b128 v[60:63], v139 offset:4096
s_waitcnt lgkmcnt(4)
v_mfma_f32_32x32x16_bf16 v[96:111], v[44:47], v[36:39], v[96:111]
v_mfma_f32_32x32x16_bf16 v[112:127], v[44:47], v[40:43], v[112:127]
s_waitcnt lgkmcnt(0)
s_barrier
v_mfma_f32_32x32x16_bf16 v[64:79], v[48:51], v[52:55], v[64:79]
ds_read_b128 v[32:35], v136 offset:32768
ds_read_b128 v[36:39], v140 offset:32768
v_mfma_f32_32x32x16_bf16 v[80:95], v[48:51], v[56:59], v[80:95]
ds_read_b128 v[40:43], v140 offset:36864
ds_read_b128 v[44:47], v136 offset:36864
v_mfma_f32_32x32x16_bf16 v[96:111], v[60:63], v[52:55], v[96:111]
v_mfma_f32_32x32x16_bf16 v[112:127], v[60:63], v[56:59], v[112:127]
s_waitcnt lgkmcnt(2)
v_mfma_f32_32x32x16_bf16 v[64:79], v[32:35], v[36:39], v[64:79]
ds_read_b128 v[48:51], v137 offset:32768
ds_read_b128 v[52:55], v141 offset:32768
s_waitcnt lgkmcnt(3)
v_mfma_f32_32x32x16_bf16 v[80:95], v[32:35], v[40:43], v[80:95]
ds_read_b128 v[56:59], v141 offset:36864
ds_read_b128 v[60:63], v137 offset:36864
s_waitcnt lgkmcnt(4)
v_mfma_f32_32x32x16_bf16 v[96:111], v[44:47], v[36:39], v[96:111]
v_mfma_f32_32x32x16_bf16 v[112:127], v[44:47], v[40:43], v[112:127]
s_waitcnt lgkmcnt(2)
v_mfma_f32_32x32x16_bf16 v[64:79], v[48:51], v[52:55], v[64:79]
ds_read_b128 v[32:35], v138 offset:32768
ds_read_b128 v[36:39], v142 offset:32768
s_waitcnt lgkmcnt(3)
v_mfma_f32_32x32x16_bf16 v[80:95], v[48:51], v[56:59], v[80:95]
ds_read_b128 v[40:43], v142 offset:36864
ds_read_b128 v[44:47], v138 offset:36864
s_waitcnt lgkmcnt(4)
v_mfma_f32_32x32x16_bf16 v[96:111], v[60:63], v[52:55], v[96:111]
v_mfma_f32_32x32x16_bf16 v[112:127], v[60:63], v[56:59], v[112:127]
s_waitcnt lgkmcnt(2)
v_mfma_f32_32x32x16_bf16 v[64:79], v[32:35], v[36:39], v[64:79]
ds_read_b128 v[48:51], v139 offset:32768
ds_read_b128 v[52:55], v143 offset:32768
s_waitcnt lgkmcnt(3)
v_mfma_f32_32x32x16_bf16 v[80:95], v[32:35], v[40:43], v[80:95]
ds_read_b128 v[56:59], v143 offset:36864
ds_read_b128 v[60:63], v139 offset:36864
s_waitcnt lgkmcnt(4)
v_mfma_f32_32x32x16_bf16 v[96:111], v[44:47], v[36:39], v[96:111]
v_mfma_f32_32x32x16_bf16 v[112:127], v[44:47], v[40:43], v[112:127]
s_waitcnt lgkmcnt(0)
s_barrier
v_mfma_f32_32x32x16_bf16 v[64:79], v[48:51], v[52:55], v[64:79]
ds_read_b128 v[32:35], v128 offset:0
ds_read_b128 v[36:39], v132 offset:0
v_mfma_f32_32x32x16_bf16 v[80:95], v[48:51], v[56:59], v[80:95]
ds_read_b128 v[40:43], v132 offset:4096
ds_read_b128 v[44:47], v128 offset:4096
v_mfma_f32_32x32x16_bf16 v[96:111], v[60:63], v[52:55], v[96:111]
v_mfma_f32_32x32x16_bf16 v[112:127], v[60:63], v[56:59], v[112:127]
s_waitcnt lgkmcnt(2)
v_mfma_f32_32x32x16_bf16 v[64:79], v[32:35], v[36:39], v[64:79]
ds_read_b128 v[48:51], v129 offset:0
ds_read_b128 v[52:55], v133 offset:0
s_waitcnt lgkmcnt(3)
v_mfma_f32_32x32x16_bf16 v[80:95], v[32:35], v[40:43], v[80:95]
ds_read_b128 v[56:59], v133 offset:4096
ds_read_b128 v[60:63], v129 offset:4096
s_waitcnt lgkmcnt(4)
v_mfma_f32_32x32x16_bf16 v[96:111], v[44:47], v[36:39], v[96:111]
v_mfma_f32_32x32x16_bf16 v[112:127], v[44:47], v[40:43], v[112:127]
s_waitcnt lgkmcnt(2)
v_mfma_f32_32x32x16_bf16 v[64:79], v[48:51], v[52:55], v[64:79]
ds_read_b128 v[32:35], v130 offset:0
ds_read_b128 v[36:39], v134 offset:0
s_waitcnt lgkmcnt(3)
v_mfma_f32_32x32x16_bf16 v[80:95], v[48:51], v[56:59], v[80:95]
ds_read_b128 v[40:43], v134 offset:4096
ds_read_b128 v[44:47], v130 offset:4096
s_waitcnt lgkmcnt(4)
v_mfma_f32_32x32x16_bf16 v[96:111], v[60:63], v[52:55], v[96:111]
v_mfma_f32_32x32x16_bf16 v[112:127], v[60:63], v[56:59], v[112:127]
s_waitcnt lgkmcnt(2)
v_mfma_f32_32x32x16_bf16 v[64:79], v[32:35], v[36:39], v[64:79]
ds_read_b128 v[48:51], v131 offset:0
ds_read_b128 v[52:55], v135 offset:0
s_waitcnt lgkmcnt(3)
v_mfma_f32_32x32x16_bf16 v[80:95], v[32:35], v[40:43], v[80:95]
ds_read_b128 v[56:59], v135 offset:4096
ds_read_b128 v[60:63], v131 offset:4096
s_waitcnt lgkmcnt(4)
v_mfma_f32_32x32x16_bf16 v[96:111], v[44:47], v[36:39], v[96:111]
v_mfma_f32_32x32x16_bf16 v[112:127], v[44:47], v[40:43], v[112:127]
s_waitcnt lgkmcnt(0)
s_barrier
v_mfma_f32_32x32x16_bf16 v[64:79], v[48:51], v[52:55], v[64:79]
ds_read_b128 v[32:35], v128 offset:32768
ds_read_b128 v[36:39], v132 offset:32768
v_mfma_f32_32x32x16_bf16 v[80:95], v[48:51], v[56:59], v[80:95]
ds_read_b128 v[40:43], v132 offset:36864
ds_read_b128 v[44:47], v128 offset:36864
v_mfma_f32_32x32x16_bf16 v[96:111], v[60:63], v[52:55], v[96:111]
v_mfma_f32_32x32x16_bf16 v[112:127], v[60:63], v[56:59], v[112:127]
s_waitcnt lgkmcnt(2)
v_mfma_f32_32x32x16_bf16 v[64:79], v[32:35], v[36:39], v[64:79]
ds_read_b128 v[48:51], v129 offset:32768
ds_read_b128 v[52:55], v133 offset:32768
s_waitcnt lgkmcnt(3)
v_mfma_f32_32x32x16_bf16 v[80:95], v[32:35], v[40:43], v[80:95]
ds_read_b128 v[56:59], v133 offset:36864
ds_read_b128 v[60:63], v129 offset:36864
s_waitcnt lgkmcnt(4)
v_mfma_f32_32x32x16_bf16 v[96:111], v[44:47], v[36:39], v[96:111]
v_mfma_f32_32x32x16_bf16 v[112:127], v[44:47], v[40:43], v[112:127]
s_waitcnt lgkmcnt(2)
v_mfma_f32_32x32x16_bf16 v[64:79], v[48:51], v[52:55], v[64:79]
ds_read_b128 v[32:35], v130 offset:32768
ds_read_b128 v[36:39], v134 offset:32768
s_waitcnt lgkmcnt(3)
v_mfma_f32_32x32x16_bf16 v[80:95], v[48:51], v[56:59], v[80:95]
ds_read_b128 v[40:43], v134 offset:36864
ds_read_b128 v[44:47], v130 offset:36864
s_waitcnt lgkmcnt(4)
v_mfma_f32_32x32x16_bf16 v[96:111], v[60:63], v[52:55], v[96:111]
v_mfma_f32_32x32x16_bf16 v[112:127], v[60:63], v[56:59], v[112:127]
s_waitcnt lgkmcnt(2)
v_mfma_f32_32x32x16_bf16 v[64:79], v[32:35], v[36:39], v[64:79]
ds_read_b128 v[48:51], v131 offset:32768
ds_read_b128 v[52:55], v135 offset:32768
s_waitcnt lgkmcnt(3)
v_mfma_f32_32x32x16_bf16 v[80:95], v[32:35], v[40:43], v[80:95]
ds_read_b128 v[56:59], v135 offset:36864
ds_read_b128 v[60:63], v131 offset:36864
s_waitcnt lgkmcnt(4)
v_mfma_f32_32x32x16_bf16 v[96:111], v[44:47], v[36:39], v[96:111]
v_mfma_f32_32x32x16_bf16 v[112:127], v[44:47], v[40:43], v[112:127]
s_waitcnt lgkmcnt(0)
s_barrier
v_mfma_f32_32x32x16_bf16 v[64:79], v[48:51], v[52:55], v[64:79]
ds_read_b128 v[32:35], v136 offset:0
ds_read_b128 v[36:39], v140 offset:0
v_mfma_f32_32x32x16_bf16 v[80:95], v[48:51], v[56:59], v[80:95]
ds_read_b128 v[40:43], v140 offset:4096
ds_read_b128 v[44:47], v136 offset:4096
v_mfma_f32_32x32x16_bf16 v[96:111], v[60:63], v[52:55], v[96:111]
v_mfma_f32_32x32x16_bf16 v[112:127], v[60:63], v[56:59], v[112:127]
s_waitcnt lgkmcnt(2)
v_mfma_f32_32x32x16_bf16 v[64:79], v[32:35], v[36:39], v[64:79]
ds_read_b128 v[48:51], v137 offset:0
ds_read_b128 v[52:55], v141 offset:0
s_waitcnt lgkmcnt(3)
v_mfma_f32_32x32x16_bf16 v[80:95], v[32:35], v[40:43], v[80:95]
ds_read_b128 v[56:59], v141 offset:4096
ds_read_b128 v[60:63], v137 offset:4096
s_waitcnt lgkmcnt(4)
v_mfma_f32_32x32x16_bf16 v[96:111], v[44:47], v[36:39], v[96:111]
v_mfma_f32_32x32x16_bf16 v[112:127], v[44:47], v[40:43], v[112:127]
s_waitcnt lgkmcnt(2)
v_mfma_f32_32x32x16_bf16 v[64:79], v[48:51], v[52:55], v[64:79]
ds_read_b128 v[32:35], v138 offset:0
ds_read_b128 v[36:39], v142 offset:0
s_waitcnt lgkmcnt(3)
v_mfma_f32_32x32x16_bf16 v[80:95], v[48:51], v[56:59], v[80:95]
ds_read_b128 v[40:43], v142 offset:4096
ds_read_b128 v[44:47], v138 offset:4096
s_waitcnt lgkmcnt(4)
v_mfma_f32_32x32x16_bf16 v[96:111], v[60:63], v[52:55], v[96:111]
v_mfma_f32_32x32x16_bf16 v[112:127], v[60:63], v[56:59], v[112:127]
s_waitcnt lgkmcnt(2)
v_mfma_f32_32x32x16_bf16 v[64:79], v[32:35], v[36:39], v[64:79]
ds_read_b128 v[48:51], v139 offset:0
ds_read_b128 v[52:55], v143 offset:0
s_waitcnt lgkmcnt(3)
v_mfma_f32_32x32x16_bf16 v[80:95], v[32:35], v[40:43], v[80:95]
ds_read_b128 v[56:59], v143 offset:4096
ds_read_b128 v[60:63], v139 offset:4096
s_waitcnt lgkmcnt(4)
v_mfma_f32_32x32x16_bf16 v[96:111], v[44:47], v[36:39], v[96:111]
v_mfma_f32_32x32x16_bf16 v[112:127], v[44:47], v[40:43], v[112:127]
s_waitcnt lgkmcnt(0)
s_barrier
v_mfma_f32_32x32x16_bf16 v[64:79], v[48:51], v[52:55], v[64:79]
ds_read_b128 v[32:35], v136 offset:32768
ds_read_b128 v[36:39], v140 offset:32768
v_mfma_f32_32x32x16_bf16 v[80:95], v[48:51], v[56:59], v[80:95]
ds_read_b128 v[40:43], v140 offset:36864
ds_read_b128 v[44:47], v136 offset:36864
v_mfma_f32_32x32x16_bf16 v[96:111], v[60:63], v[52:55], v[96:111]
v_mfma_f32_32x32x16_bf16 v[112:127], v[60:63], v[56:59], v[112:127]
s_waitcnt lgkmcnt(2)
v_mfma_f32_32x32x16_bf16 v[64:79], v[32:35], v[36:39], v[64:79]
ds_read_b128 v[48:51], v137 offset:32768
ds_read_b128 v[52:55], v141 offset:32768
s_waitcnt lgkmcnt(3)
v_mfma_f32_32x32x16_bf16 v[80:95], v[32:35], v[40:43], v[80:95]
ds_read_b128 v[56:59], v141 offset:36864
ds_read_b128 v[60:63], v137 offset:36864
s_waitcnt lgkmcnt(4)
v_mfma_f32_32x32x16_bf16 v[96:111], v[44:47], v[36:39], v[96:111]
v_mfma_f32_32x32x16_bf16 v[112:127], v[44:47], v[40:43], v[112:127]
s_waitcnt lgkmcnt(2)
v_mfma_f32_32x32x16_bf16 v[64:79], v[48:51], v[52:55], v[64:79]
ds_read_b128 v[32:35], v138 offset:32768
ds_read_b128 v[36:39], v142 offset:32768
s_waitcnt lgkmcnt(3)
v_mfma_f32_32x32x16_bf16 v[80:95], v[48:51], v[56:59], v[80:95]
ds_read_b128 v[40:43], v142 offset:36864
ds_read_b128 v[44:47], v138 offset:36864
s_waitcnt lgkmcnt(4)
v_mfma_f32_32x32x16_bf16 v[96:111], v[60:63], v[52:55], v[96:111]
v_mfma_f32_32x32x16_bf16 v[112:127], v[60:63], v[56:59], v[112:127]
s_waitcnt lgkmcnt(2)
v_mfma_f32_32x32x16_bf16 v[64:79], v[32:35], v[36:39], v[64:79]
ds_read_b128 v[48:51], v139 offset:32768
ds_read_b128 v[52:55], v143 offset:32768
s_waitcnt lgkmcnt(3)
v_mfma_f32_32x32x16_bf16 v[80:95], v[32:35], v[40:43], v[80:95]
ds_read_b128 v[56:59], v143 offset:36864
ds_read_b128 v[60:63], v139 offset:36864
s_waitcnt lgkmcnt(4)
v_mfma_f32_32x32x16_bf16 v[96:111], v[44:47], v[36:39], v[96:111]
v_mfma_f32_32x32x16_bf16 v[112:127], v[44:47], v[40:43], v[112:127]
s_waitcnt lgkmcnt(0)
s_barrier
v_mfma_f32_32x32x16_bf16 v[64:79], v[48:51], v[52:55], v[64:79]
ds_read_b128 v[32:35], v128 offset:0
ds_read_b128 v[36:39], v132 offset:0
v_mfma_f32_32x32x16_bf16 v[80:95], v[48:51], v[56:59], v[80:95]
ds_read_b128 v[40:43], v132 offset:4096
ds_read_b128 v[44:47], v128 offset:4096
v_mfma_f32_32x32x16_bf16 v[96:111], v[60:63], v[52:55], v[96:111]
v_mfma_f32_32x32x16_bf16 v[112:127], v[60:63], v[56:59], v[112:127]
s_waitcnt lgkmcnt(2)
v_mfma_f32_32x32x16_bf16 v[64:79], v[32:35], v[36:39], v[64:79]
ds_read_b128 v[48:51], v129 offset:0
ds_read_b128 v[52:55], v133 offset:0
s_waitcnt lgkmcnt(3)
v_mfma_f32_32x32x16_bf16 v[80:95], v[32:35], v[40:43], v[80:95]
ds_read_b128 v[56:59], v133 offset:4096
ds_read_b128 v[60:63], v129 offset:4096
s_waitcnt lgkmcnt(4)
v_mfma_f32_32x32x16_bf16 v[96:111], v[44:47], v[36:39], v[96:111]
v_mfma_f32_32x32x16_bf16 v[112:127], v[44:47], v[40:43], v[112:127]
s_waitcnt lgkmcnt(2)
v_mfma_f32_32x32x16_bf16 v[64:79], v[48:51], v[52:55], v[64:79]
ds_read_b128 v[32:35], v130 offset:0
ds_read_b128 v[36:39], v134 offset:0
s_waitcnt lgkmcnt(3)
v_mfma_f32_32x32x16_bf16 v[80:95], v[48:51], v[56:59], v[80:95]
ds_read_b128 v[40:43], v134 offset:4096
ds_read_b128 v[44:47], v130 offset:4096
s_waitcnt lgkmcnt(4)
v_mfma_f32_32x32x16_bf16 v[96:111], v[60:63], v[52:55], v[96:111]
v_mfma_f32_32x32x16_bf16 v[112:127], v[60:63], v[56:59], v[112:127]
s_waitcnt lgkmcnt(2)
v_mfma_f32_32x32x16_bf16 v[64:79], v[32:35], v[36:39], v[64:79]
ds_read_b128 v[48:51], v131 offset:0
ds_read_b128 v[52:55], v135 offset:0
s_waitcnt lgkmcnt(3)
v_mfma_f32_32x32x16_bf16 v[80:95], v[32:35], v[40:43], v[80:95]
ds_read_b128 v[56:59], v135 offset:4096
ds_read_b128 v[60:63], v131 offset:4096
s_waitcnt lgkmcnt(4)
v_mfma_f32_32x32x16_bf16 v[96:111], v[44:47], v[36:39], v[96:111]
v_mfma_f32_32x32x16_bf16 v[112:127], v[44:47], v[40:43], v[112:127]
s_waitcnt lgkmcnt(0)
s_barrier
v_mfma_f32_32x32x16_bf16 v[64:79], v[48:51], v[52:55], v[64:79]
ds_read_b128 v[32:35], v128 offset:32768
ds_read_b128 v[36:39], v132 offset:32768
v_mfma_f32_32x32x16_bf16 v[80:95], v[48:51], v[56:59], v[80:95]
ds_read_b128 v[40:43], v132 offset:36864
ds_read_b128 v[44:47], v128 offset:36864
v_mfma_f32_32x32x16_bf16 v[96:111], v[60:63], v[52:55], v[96:111]
v_mfma_f32_32x32x16_bf16 v[112:127], v[60:63], v[56:59], v[112:127]
s_waitcnt lgkmcnt(2)
v_mfma_f32_32x32x16_bf16 v[64:79], v[32:35], v[36:39], v[64:79]
ds_read_b128 v[48:51], v129 offset:32768
ds_read_b128 v[52:55], v133 offset:32768
s_waitcnt lgkmcnt(3)
v_mfma_f32_32x32x16_bf16 v[80:95], v[32:35], v[40:43], v[80:95]
ds_read_b128 v[56:59], v133 offset:36864
ds_read_b128 v[60:63], v129 offset:36864
s_waitcnt lgkmcnt(4)
v_mfma_f32_32x32x16_bf16 v[96:111], v[44:47], v[36:39], v[96:111]
v_mfma_f32_32x32x16_bf16 v[112:127], v[44:47], v[40:43], v[112:127]
s_waitcnt lgkmcnt(2)
v_mfma_f32_32x32x16_bf16 v[64:79], v[48:51], v[52:55], v[64:79]
ds_read_b128 v[32:35], v130 offset:32768
ds_read_b128 v[36:39], v134 offset:32768
s_waitcnt lgkmcnt(3)
v_mfma_f32_32x32x16_bf16 v[80:95], v[48:51], v[56:59], v[80:95]
ds_read_b128 v[40:43], v134 offset:36864
ds_read_b128 v[44:47], v130 offset:36864
s_waitcnt lgkmcnt(4)
v_mfma_f32_32x32x16_bf16 v[96:111], v[60:63], v[52:55], v[96:111]
v_mfma_f32_32x32x16_bf16 v[112:127], v[60:63], v[56:59], v[112:127]
s_waitcnt lgkmcnt(2)
v_mfma_f32_32x32x16_bf16 v[64:79], v[32:35], v[36:39], v[64:79]
ds_read_b128 v[48:51], v131 offset:32768
ds_read_b128 v[52:55], v135 offset:32768
s_waitcnt lgkmcnt(3)
v_mfma_f32_32x32x16_bf16 v[80:95], v[32:35], v[40:43], v[80:95]
ds_read_b128 v[56:59], v135 offset:36864
ds_read_b128 v[60:63], v131 offset:36864
s_waitcnt lgkmcnt(4)
v_mfma_f32_32x32x16_bf16 v[96:111], v[44:47], v[36:39], v[96:111]
v_mfma_f32_32x32x16_bf16 v[112:127], v[44:47], v[40:43], v[112:127]
s_waitcnt lgkmcnt(0)
s_barrier
v_mfma_f32_32x32x16_bf16 v[64:79], v[48:51], v[52:55], v[64:79]
ds_read_b128 v[32:35], v136 offset:0
ds_read_b128 v[36:39], v140 offset:0
v_mfma_f32_32x32x16_bf16 v[80:95], v[48:51], v[56:59], v[80:95]
ds_read_b128 v[40:43], v140 offset:4096
ds_read_b128 v[44:47], v136 offset:4096
v_mfma_f32_32x32x16_bf16 v[96:111], v[60:63], v[52:55], v[96:111]
v_mfma_f32_32x32x16_bf16 v[112:127], v[60:63], v[56:59], v[112:127]
s_waitcnt lgkmcnt(2)
v_mfma_f32_32x32x16_bf16 v[64:79], v[32:35], v[36:39], v[64:79]
ds_read_b128 v[48:51], v137 offset:0
ds_read_b128 v[52:55], v141 offset:0
s_waitcnt lgkmcnt(3)
v_mfma_f32_32x32x16_bf16 v[80:95], v[32:35], v[40:43], v[80:95]
ds_read_b128 v[56:59], v141 offset:4096
ds_read_b128 v[60:63], v137 offset:4096
s_waitcnt lgkmcnt(4)
v_mfma_f32_32x32x16_bf16 v[96:111], v[44:47], v[36:39], v[96:111]
v_mfma_f32_32x32x16_bf16 v[112:127], v[44:47], v[40:43], v[112:127]
s_waitcnt lgkmcnt(2)
v_mfma_f32_32x32x16_bf16 v[64:79], v[48:51], v[52:55], v[64:79]
ds_read_b128 v[32:35], v138 offset:0
ds_read_b128 v[36:39], v142 offset:0
s_waitcnt lgkmcnt(3)
v_mfma_f32_32x32x16_bf16 v[80:95], v[48:51], v[56:59], v[80:95]
ds_read_b128 v[40:43], v142 offset:4096
ds_read_b128 v[44:47], v138 offset:4096
s_waitcnt lgkmcnt(4)
v_mfma_f32_32x32x16_bf16 v[96:111], v[60:63], v[52:55], v[96:111]
v_mfma_f32_32x32x16_bf16 v[112:127], v[60:63], v[56:59], v[112:127]
s_waitcnt lgkmcnt(2)
v_mfma_f32_32x32x16_bf16 v[64:79], v[32:35], v[36:39], v[64:79]
ds_read_b128 v[48:51], v139 offset:0
ds_read_b128 v[52:55], v143 offset:0
s_waitcnt lgkmcnt(3)
v_mfma_f32_32x32x16_bf16 v[80:95], v[32:35], v[40:43], v[80:95]
ds_read_b128 v[56:59], v143 offset:4096
ds_read_b128 v[60:63], v139 offset:4096
s_waitcnt lgkmcnt(4)
v_mfma_f32_32x32x16_bf16 v[96:111], v[44:47], v[36:39], v[96:111]
v_mfma_f32_32x32x16_bf16 v[112:127], v[44:47], v[40:43], v[112:127]
s_waitcnt lgkmcnt(0)
s_barrier
v_mfma_f32_32x32x16_bf16 v[64:79], v[48:51], v[52:55], v[64:79]
ds_read_b128 v[32:35], v136 offset:32768
ds_read_b128 v[36:39], v140 offset:32768
v_mfma_f32_32x32x16_bf16 v[80:95], v[48:51], v[56:59], v[80:95]
ds_read_b128 v[40:43], v140 offset:36864
ds_read_b128 v[44:47], v136 offset:36864
v_mfma_f32_32x32x16_bf16 v[96:111], v[60:63], v[52:55], v[96:111]
v_mfma_f32_32x32x16_bf16 v[112:127], v[60:63], v[56:59], v[112:127]
s_waitcnt lgkmcnt(2)
v_mov_b32 v12, 0
global_load_dword v13, v12, s[16:17] sc1
v_mfma_f32_32x32x16_bf16 v[64:79], v[32:35], v[36:39], v[64:79]
ds_read_b128 v[48:51], v137 offset:32768
ds_read_b128 v[52:55], v141 offset:32768
s_waitcnt lgkmcnt(3)
v_mfma_f32_32x32x16_bf16 v[80:95], v[32:35], v[40:43], v[80:95]
ds_read_b128 v[56:59], v141 offset:36864
ds_read_b128 v[60:63], v137 offset:36864
s_waitcnt lgkmcnt(4)
v_mfma_f32_32x32x16_bf16 v[96:111], v[44:47], v[36:39], v[96:111]
v_mfma_f32_32x32x16_bf16 v[112:127], v[44:47], v[40:43], v[112:127]
s_waitcnt lgkmcnt(2)
v_mfma_f32_32x32x16_bf16 v[64:79], v[48:51], v[52:55], v[64:79]
ds_read_b128 v[32:35], v138 offset:32768
ds_read_b128 v[36:39], v142 offset:32768
s_waitcnt lgkmcnt(3)
v_mfma_f32_32x32x16_bf16 v[80:95], v[48:51], v[56:59], v[80:95]
ds_read_b128 v[40:43], v142 offset:36864
ds_read_b128 v[44:47], v138 offset:36864
s_waitcnt lgkmcnt(4)
v_mfma_f32_32x32x16_bf16 v[96:111], v[60:63], v[52:55], v[96:111]
v_mfma_f32_32x32x16_bf16 v[112:127], v[60:63], v[56:59], v[112:127]
s_waitcnt lgkmcnt(2)
v_mfma_f32_32x32x16_bf16 v[64:79], v[32:35], v[36:39], v[64:79]
ds_read_b128 v[48:51], v139 offset:32768
ds_read_b128 v[52:55], v143 offset:32768
s_waitcnt lgkmcnt(3)
v_mfma_f32_32x32x16_bf16 v[80:95], v[32:35], v[40:43], v[80:95]
ds_read_b128 v[56:59], v143 offset:36864
ds_read_b128 v[60:63], v139 offset:36864
s_waitcnt lgkmcnt(4)
v_mfma_f32_32x32x16_bf16 v[96:111], v[44:47], v[36:39], v[96:111]
v_mfma_f32_32x32x16_bf16 v[112:127], v[44:47], v[40:43], v[112:127]
s_waitcnt lgkmcnt(0)
s_barrier
v_mfma_f32_32x32x16_bf16 v[64:79], v[48:51], v[52:55], v[64:79]
v_mfma_f32_32x32x16_bf16 v[80:95], v[48:51], v[56:59], v[80:95]
v_mfma_f32_32x32x16_bf16 v[96:111], v[60:63], v[52:55], v[96:111]
v_mfma_f32_32x32x16_bf16 v[112:127], v[60:63], v[56:59], v[112:127]
s_nop 8
v_pk_fma_f32 v[40:41], v[24:25], v[64:65], v[66:67] op_sel_hi:[0,1,1]
v_pk_fma_f32 v[42:43], v[24:25], v[80:81], v[82:83] op_sel_hi:[0,1,1]
v_pk_fma_f32 v[32:33], v[24:25], v[80:81], v[40:41] op_sel:[1,0,0] neg_lo:[1,0,0] neg_hi:[1,0,0]
v_pk_fma_f32 v[34:35], v[24:25], v[64:65], v[42:43] op_sel:[1,0,0]
v_pk_fma_f32 v[40:41], v[24:25], v[32:33], v[68:69] op_sel_hi:[0,1,1]
v_pk_fma_f32 v[42:43], v[24:25], v[34:35], v[84:85] op_sel_hi:[0,1,1]
v_pk_fma_f32 v[36:37], v[24:25], v[34:35], v[40:41] op_sel:[1,0,0] neg_lo:[1,0,0] neg_hi:[1,0,0]
v_pk_fma_f32 v[38:39], v[24:25], v[32:33], v[42:43] op_sel:[1,0,0]
v_pk_fma_f32 v[40:41], v[24:25], v[36:37], v[70:71] op_sel_hi:[0,1,1]
v_pk_fma_f32 v[42:43], v[24:25], v[38:39], v[86:87] op_sel_hi:[0,1,1]
v_pk_fma_f32 v[32:33], v[24:25], v[38:39], v[40:41] op_sel:[1,0,0] neg_lo:[1,0,0] neg_hi:[1,0,0]
v_pk_fma_f32 v[34:35], v[24:25], v[36:37], v[42:43] op_sel:[1,0,0]
v_pk_fma_f32 v[40:41], v[24:25], v[32:33], v[72:73] op_sel_hi:[0,1,1]
v_pk_fma_f32 v[42:43], v[24:25], v[34:35], v[88:89] op_sel_hi:[0,1,1]
v_pk_fma_f32 v[36:37], v[24:25], v[34:35], v[40:41] op_sel:[1,0,0] neg_lo:[1,0,0] neg_hi:[1,0,0]
v_pk_fma_f32 v[38:39], v[24:25], v[32:33], v[42:43] op_sel:[1,0,0]
v_pk_fma_f32 v[40:41], v[24:25], v[36:37], v[74:75] op_sel_hi:[0,1,1]
v_pk_fma_f32 v[42:43], v[24:25], v[38:39], v[90:91] op_sel_hi:[0,1,1]
v_pk_fma_f32 v[32:33], v[24:25], v[38:39], v[40:41] op_sel:[1,0,0] neg_lo:[1,0,0] neg_hi:[1,0,0]
v_pk_fma_f32 v[34:35], v[24:25], v[36:37], v[42:43] op_sel:[1,0,0]
v_pk_fma_f32 v[40:41], v[24:25], v[32:33], v[76:77] op_sel_hi:[0,1,1]
v_pk_fma_f32 v[42:43], v[24:25], v[34:35], v[92:93] op_sel_hi:[0,1,1]
v_pk_fma_f32 v[36:37], v[24:25], v[34:35], v[40:41] op_sel:[1,0,0] neg_lo:[1,0,0] neg_hi:[1,0,0]
v_pk_fma_f32 v[38:39], v[24:25], v[32:33], v[42:43] op_sel:[1,0,0]
v_pk_fma_f32 v[40:41], v[24:25], v[36:37], v[78:79] op_sel_hi:[0,1,1]
v_pk_fma_f32 v[42:43], v[24:25], v[38:39], v[94:95] op_sel_hi:[0,1,1]
v_pk_fma_f32 v[32:33], v[24:25], v[38:39], v[40:41] op_sel:[1,0,0] neg_lo:[1,0,0] neg_hi:[1,0,0]
v_pk_fma_f32 v[34:35], v[24:25], v[36:37], v[42:43] op_sel:[1,0,0]
v_pk_fma_f32 v[40:41], v[24:25], v[32:33], v[96:97] op_sel_hi:[0,1,1]
v_pk_fma_f32 v[42:43], v[24:25], v[34:35], v[112:113] op_sel_hi:[0,1,1]
v_pk_fma_f32 v[36:37], v[24:25], v[34:35], v[40:41] op_sel:[1,0,0] neg_lo:[1,0,0] neg_hi:[1,0,0]
v_pk_fma_f32 v[38:39], v[24:25], v[32:33], v[42:43] op_sel:[1,0,0]
v_pk_fma_f32 v[40:41], v[24:25], v[36:37], v[98:99] op_sel_hi:[0,1,1]
v_pk_fma_f32 v[42:43], v[24:25], v[38:39], v[114:115] op_sel_hi:[0,1,1]
v_pk_fma_f32 v[32:33], v[24:25], v[38:39], v[40:41] op_sel:[1,0,0] neg_lo:[1,0,0] neg_hi:[1,0,0]
v_pk_fma_f32 v[34:35], v[24:25], v[36:37], v[42:43] op_sel:[1,0,0]
v_pk_fma_f32 v[40:41], v[24:25], v[32:33], v[100:101] op_sel_hi:[0,1,1]
v_pk_fma_f32 v[42:43], v[24:25], v[34:35], v[116:117] op_sel_hi:[0,1,1]
v_pk_fma_f32 v[36:37], v[24:25], v[34:35], v[40:41] op_sel:[1,0,0] neg_lo:[1,0,0] neg_hi:[1,0,0]
v_pk_fma_f32 v[38:39], v[24:25], v[32:33], v[42:43] op_sel:[1,0,0]
v_pk_fma_f32 v[40:41], v[24:25], v[36:37], v[102:103] op_sel_hi:[0,1,1]
v_pk_fma_f32 v[42:43], v[24:25], v[38:39], v[118:119] op_sel_hi:[0,1,1]
v_pk_fma_f32 v[32:33], v[24:25], v[38:39], v[40:41] op_sel:[1,0,0] neg_lo:[1,0,0] neg_hi:[1,0,0]
v_pk_fma_f32 v[34:35], v[24:25], v[36:37], v[42:43] op_sel:[1,0,0]
v_pk_fma_f32 v[40:41], v[24:25], v[32:33], v[104:105] op_sel_hi:[0,1,1]
v_pk_fma_f32 v[42:43], v[24:25], v[34:35], v[120:121] op_sel_hi:[0,1,1]
v_pk_fma_f32 v[36:37], v[24:25], v[34:35], v[40:41] op_sel:[1,0,0] neg_lo:[1,0,0] neg_hi:[1,0,0]
v_pk_fma_f32 v[38:39], v[24:25], v[32:33], v[42:43] op_sel:[1,0,0]
v_pk_fma_f32 v[40:41], v[24:25], v[36:37], v[106:107] op_sel_hi:[0,1,1]
v_pk_fma_f32 v[42:43], v[24:25], v[38:39], v[122:123] op_sel_hi:[0,1,1]
v_pk_fma_f32 v[32:33], v[24:25], v[38:39], v[40:41] op_sel:[1,0,0] neg_lo:[1,0,0] neg_hi:[1,0,0]
v_pk_fma_f32 v[34:35], v[24:25], v[36:37], v[42:43] op_sel:[1,0,0]
v_pk_fma_f32 v[40:41], v[24:25], v[32:33], v[108:109] op_sel_hi:[0,1,1]
v_pk_fma_f32 v[42:43], v[24:25], v[34:35], v[124:125] op_sel_hi:[0,1,1]
v_pk_fma_f32 v[36:37], v[24:25], v[34:35], v[40:41] op_sel:[1,0,0] neg_lo:[1,0,0] neg_hi:[1,0,0]
v_pk_fma_f32 v[38:39], v[24:25], v[32:33], v[42:43] op_sel:[1,0,0]
v_pk_fma_f32 v[40:41], v[24:25], v[36:37], v[110:111] op_sel_hi:[0,1,1]
v_pk_fma_f32 v[42:43], v[24:25], v[38:39], v[126:127] op_sel_hi:[0,1,1]
v_pk_fma_f32 v[32:33], v[24:25], v[38:39], v[40:41] op_sel:[1,0,0] neg_lo:[1,0,0] neg_hi:[1,0,0]
v_pk_fma_f32 v[34:35], v[24:25], v[36:37], v[42:43] op_sel:[1,0,0]
s_lshl_b32 s45, s51, 11
s_lshl_b32 s46, s23, 5
v_lshl_add_u32 v14, v6, 6, s45
v_lshl_add_u32 v15, v5, 4, v14
v_add_u32 v15, s46, v15
ds_write_b128 v15, v[32:35]
s_sub_u32 s45, s21, 1
s_lshl_b32 s45, s45, 14
v_lshlrev_b32 v16, 4, v4
v_lshlrev_b32 v17, 14, v5
v_sub_u32 v17, v16, v17
v_add_u32 v128, s45, v17
v_subrev_u32 v129, 32768, v128
v_subrev_u32 v130, 65536, v128
v_subrev_u32 v131, 98304, v128
v_subrev_u32 v132, 131072, v128
v_subrev_u32 v133, 163840, v128
v_subrev_u32 v134, 196608, v128
v_subrev_u32 v135, 229376, v128
s_lshl_b32 s45, s21, 14
v_add_u32 v16, s45, v16
v_lshlrev_b32 v17, 30, v5
v_or_b32 v16, v16, v17
s_waitcnt lgkmcnt(0)
s_barrier
ds_read_b128 v[144:147], v14 offset:0
ds_read_b128 v[148:151], v14 offset:16
ds_read_b128 v[152:155], v14 offset:32
ds_read_b128 v[156:159], v14 offset:48
L_g1_kernel_nonce:
s_waitcnt vmcnt(0)
v_readfirstlane_b32 s50, v13
s_nop 0
s_cmp_lg_u32 s50, 0
s_cbranch_scc1 L_g1_kernel_gotnonce
global_load_dword v13, v12, s[16:17] sc1
s_branch L_g1_kernel_nonce
L_g1_kernel_gotnonce:
s_waitcnt lgkmcnt(0)
v_mov_b32 v44, v144
v_mov_b32 v45, v146
v_fma_f32 v40, v28, v44, v145
v_fma_f32 v41, v28, v45, v147
v_fma_f32 v40, -v29, v45, v40
v_fma_f32 v45, v29, v44, v41
v_mov_b32 v44, v40
v_fma_f32 v40, v28, v44, v148
v_fma_f32 v41, v28, v45, v150
v_fma_f32 v40, -v29, v45, v40
v_fma_f32 v45, v29, v44, v41
v_mov_b32 v44, v40
v_fma_f32 v40, v28, v44, v149
v_fma_f32 v41, v28, v45, v151
v_fma_f32 v40, -v29, v45, v40
v_fma_f32 v45, v29, v44, v41
v_mov_b32 v44, v40
v_fma_f32 v40, v28, v44, v152
v_fma_f32 v41, v28, v45, v154
v_fma_f32 v40, -v29, v45, v40
v_fma_f32 v45, v29, v44, v41
v_mov_b32 v44, v40
v_fma_f32 v40, v28, v44, v153
v_fma_f32 v41, v28, v45, v155
v_fma_f32 v40, -v29, v45, v40
v_fma_f32 v45, v29, v44, v41
v_mov_b32 v44, v40
v_fma_f32 v40, v28, v44, v156
v_fma_f32 v41, v28, v45, v158
v_fma_f32 v40, -v29, v45, v40
v_fma_f32 v45, v29, v44, v41
v_mov_b32 v44, v40
v_fma_f32 v40, v28, v44, v157
v_fma_f32 v41, v28, v45, v159
v_fma_f32 v40, -v29, v45, v40
v_fma_f32 v45, v29, v44, v41
v_mov_b32 v44, v40
v_mov_b32 v46, s50
v_mov_b32 v47, s50
s_cmp_lg_u32 s23, 0
s_cbranch_scc1 L_g1_kernel_nopub
buffer_store_dwordx4 v[44:47], v16, s[32:35], 0 offen sc0 sc1
L_g1_kernel_nopub:
v_mov_b32 v17, 0x40000000
v_cmp_le_i32 vcc, 0, v128
s_nop 1
v_cndmask_b32 v136, 0, v46, vcc
v_cndmask_b32 v128, v17, v128, vcc
v_cmp_le_i32 vcc, 0, v129
s_nop 1
v_cndmask_b32 v137, 0, v46, vcc
v_cndmask_b32 v129, v17, v129, vcc
v_cmp_le_i32 vcc, 0, v130
s_nop 1
v_cndmask_b32 v138, 0, v46, vcc
v_cndmask_b32 v130, v17, v130, vcc
v_cmp_le_i32 vcc, 0, v131
s_nop 1
v_cndmask_b32 v139, 0, v46, vcc
v_cndmask_b32 v131, v17, v131, vcc
v_cmp_le_i32 vcc, 0, v132
s_nop 1
v_cndmask_b32 v140, 0, v46, vcc
v_cndmask_b32 v132, v17, v132, vcc
v_cmp_le_i32 vcc, 0, v133
s_nop 1
v_cndmask_b32 v141, 0, v46, vcc
v_cndmask_b32 v133, v17, v133, vcc
v_cmp_le_i32 vcc, 0, v134
s_nop 1
v_cndmask_b32 v142, 0, v46, vcc
v_cndmask_b32 v134, v17, v134, vcc
v_cmp_le_i32 vcc, 0, v135
s_nop 1
v_cndmask_b32 v143, 0, v46, vcc
v_cndmask_b32 v135, v17, v135, vcc
s_mov_b32 s46, 0
L_g1_kernel_poll:
buffer_load_dwordx4 v[160:163], v128, s[32:35], 0 offen sc1
buffer_load_dwordx4 v[164:167], v129, s[32:35], 0 offen sc1
buffer_load_dwordx4 v[168:171], v130, s[32:35], 0 offen sc1
buffer_load_dwordx4 v[172:175], v131, s[32:35], 0 offen sc1
buffer_load_dwordx4 v[176:179], v132, s[32:35], 0 offen sc1
buffer_load_dwordx4 v[180:183], v133, s[32:35], 0 offen sc1
buffer_load_dwordx4 v[184:187], v134, s[32:35], 0 offen sc1
buffer_load_dwordx4 v[188:191], v135, s[32:35], 0 offen sc1
s_mov_b64 s[54:55], 0
s_waitcnt vmcnt(7)
v_cmp_ne_u32 vcc, v162, v136
s_nop 0
s_or_b64 s[54:55], s[54:55], vcc
v_cmp_ne_u32 vcc, v163, v136
s_nop 0
s_or_b64 s[54:55], s[54:55], vcc
s_waitcnt vmcnt(6)
v_cmp_ne_u32 vcc, v166, v137
s_nop 0
s_or_b64 s[54:55], s[54:55], vcc
v_cmp_ne_u32 vcc, v167, v137
s_nop 0
s_or_b64 s[54:55], s[54:55], vcc
s_waitcnt vmcnt(5)
v_cmp_ne_u32 vcc, v170, v138
s_nop 0
s_or_b64 s[54:55], s[54:55], vcc
v_cmp_ne_u32 vcc, v171, v138
s_nop 0
s_or_b64 s[54:55], s[54:55], vcc
s_waitcnt vmcnt(4)
v_cmp_ne_u32 vcc, v174, v139
s_nop 0
s_or_b64 s[54:55], s[54:55], vcc
v_cmp_ne_u32 vcc, v175, v139
s_nop 0
s_or_b64 s[54:55], s[54:55], vcc
s_waitcnt vmcnt(3)
v_cmp_ne_u32 vcc, v178, v140
s_nop 0
s_or_b64 s[54:55], s[54:55], vcc
v_cmp_ne_u32 vcc, v179, v140
s_nop 0
s_or_b64 s[54:55], s[54:55], vcc
s_waitcnt vmcnt(2)
v_cmp_ne_u32 vcc, v182, v141
s_nop 0
s_or_b64 s[54:55], s[54:55], vcc
v_cmp_ne_u32 vcc, v183, v141
s_nop 0
s_or_b64 s[54:55], s[54:55], vcc
s_waitcnt vmcnt(1)
v_cmp_ne_u32 vcc, v186, v142
s_nop 0
s_or_b64 s[54:55], s[54:55], vcc
v_cmp_ne_u32 vcc, v187, v142
s_nop 0
s_or_b64 s[54:55], s[54:55], vcc
s_waitcnt vmcnt(0)
v_cmp_ne_u32 vcc, v190, v143
s_nop 0
s_or_b64 s[54:55], s[54:55], vcc
v_cmp_ne_u32 vcc, v191, v143
s_nop 0
s_or_b64 s[54:55], s[54:55], vcc
s_add_u32 s46, s46, 1
s_cmp_eq_u64 s[54:55], 0
s_cbranch_scc1 L_g1_kernel_polled
s_cmp_lt_u32 s46, 200000
s_cbranch_scc1 L_g1_kernel_poll
L_g1_kernel_polled:
v_fma_f32 v40, v2, v188, v184
v_fma_f32 v41, v2, v189, v185
v_fma_f32 v40, -v3, v189, v40
v_fma_f32 v189, v3, v188, v41
v_mov_b32 v188, v40
v_fma_f32 v40, v2, v188, v180
v_fma_f32 v41, v2, v189, v181
v_fma_f32 v40, -v3, v189, v40
v_fma_f32 v189, v3, v188, v41
v_mov_b32 v188, v40
v_fma_f32 v40, v2, v188, v176
v_fma_f32 v41, v2, v189, v177
v_fma_f32 v40, -v3, v189, v40
v_fma_f32 v189, v3, v188, v41
v_mov_b32 v188, v40
v_fma_f32 v40, v2, v188, v172
v_fma_f32 v41, v2, v189, v173
v_fma_f32 v40, -v3, v189, v40
v_fma_f32 v189, v3, v188, v41
v_mov_b32 v188, v40
v_fma_f32 v40, v2, v188, v168
v_fma_f32 v41, v2, v189, v169
v_fma_f32 v40, -v3, v189, v40
v_fma_f32 v189, v3, v188, v41
v_mov_b32 v188, v40
v_fma_f32 v40, v2, v188, v164
v_fma_f32 v41, v2, v189, v165
v_fma_f32 v40, -v3, v189, v40
v_fma_f32 v189, v3, v188, v41
v_mov_b32 v188, v40
v_fma_f32 v40, v2, v188, v160
v_fma_f32 v41, v2, v189, v161
v_fma_f32 v40, -v3, v189, v40
v_fma_f32 v189, v3, v188, v41
v_mov_b32 v188, v40
v_mov_b32 v48, v188
v_mov_b32 v49, v189
s_nop 0
v_permlane32_swap_b32 v188, v48
v_permlane32_swap_b32 v189, v49
v_fma_f32 v40, v30, v48, v188
v_fma_f32 v41, v30, v49, v189
v_fma_f32 v40, -v31, v49, v40
v_fma_f32 v193, v31, v48, v41
v_mov_b32 v192, v40
v_fma_f32 v40, v28, v192, v144
v_fma_f32 v41, v28, v193, v146
v_fma_f32 v40, -v29, v193, v40
v_fma_f32 v195, v29, v192, v41
v_mov_b32 v194, v40
v_fma_f32 v40, v28, v194, v145
v_fma_f32 v41, v28, v195, v147
v_fma_f32 v40, -v29, v195, v40
v_fma_f32 v197, v29, v194, v41
v_mov_b32 v196, v40
v_fma_f32 v40, v28, v196, v148
v_fma_f32 v41, v28, v197, v150
v_fma_f32 v40, -v29, v197, v40
v_fma_f32 v199, v29, v196, v41
v_mov_b32 v198, v40
v_fma_f32 v40, v28, v198, v149
v_fma_f32 v41, v28, v199, v151
v_fma_f32 v40, -v29, v199, v40
v_fma_f32 v201, v29, v198, v41
v_mov_b32 v200, v40
v_fma_f32 v40, v28, v200, v152
v_fma_f32 v41, v28, v201, v154
v_fma_f32 v40, -v29, v201, v40
v_fma_f32 v203, v29, v200, v41
v_mov_b32 v202, v40
v_fma_f32 v40, v28, v202, v153
v_fma_f32 v41, v28, v203, v155
v_fma_f32 v40, -v29, v203, v40
v_fma_f32 v205, v29, v202, v41
v_mov_b32 v204, v40
v_fma_f32 v40, v28, v204, v156
v_fma_f32 v41, v28, v205, v158
v_fma_f32 v40, -v29, v205, v40
v_fma_f32 v207, v29, v204, v41
v_mov_b32 v206, v40
s_cmp_eq_u32 s23, 0
s_cbranch_scc1 L_g1_kernel_wt0
v_mov_b32 v192, v200
v_mov_b32 v193, v201
v_mov_b32 v194, v202
v_mov_b32 v195, v203
v_mov_b32 v196, v204
v_mov_b32 v197, v205
v_mov_b32 v198, v206
v_mov_b32 v199, v207
L_g1_kernel_wt0:
v_cmp_eq_u32 vcc, 1, v5
s_nop 1
v_cndmask_b32 v48, v192, v196, vcc
v_cndmask_b32 v49, v194, v198, vcc
v_cndmask_b32 v50, v193, v197, vcc
v_cndmask_b32 v51, v195, v199, vcc
v_pk_fma_f32 v[40:41], v[24:25], v[48:49], v[64:65] op_sel_hi:[0,1,1]
v_pk_fma_f32 v[42:43], v[24:25], v[50:51], v[80:81] op_sel_hi:[0,1,1]
v_pk_fma_f32 v[64:65], v[24:25], v[50:51], v[40:41] op_sel:[1,0,0] neg_lo:[1,0,0] neg_hi:[1,0,0]
v_pk_fma_f32 v[80:81], v[24:25], v[48:49], v[42:43] op_sel:[1,0,0]
v_pk_mul_f32 v[52:53], v[26:27], v[64:65] op_sel_hi:[0,1]
v_pk_mul_f32 v[54:55], v[26:27], v[80:81] op_sel_hi:[0,1] neg_lo:[1,0] neg_hi:[1,0]
v_pk_fma_f32 v[52:53], v[26:27], v[80:81], v[52:53] op_sel:[1,0,0] neg_lo:[1,0,0] neg_hi:[1,0,0]
v_pk_fma_f32 v[54:55], v[26:27], v[64:65], v[54:55] op_sel:[1,0,0] neg_lo:[1,0,0] neg_hi:[1,0,0]
v_cvt_pk_bf16_f32 v128, v52, v53
v_cvt_pk_bf16_f32 v144, v54, v55
v_pk_fma_f32 v[40:41], v[24:25], v[64:65], v[66:67] op_sel_hi:[0,1,1]
v_pk_fma_f32 v[42:43], v[24:25], v[80:81], v[82:83] op_sel_hi:[0,1,1]
v_pk_fma_f32 v[66:67], v[24:25], v[80:81], v[40:41] op_sel:[1,0,0] neg_lo:[1,0,0] neg_hi:[1,0,0]
v_pk_fma_f32 v[82:83], v[24:25], v[64:65], v[42:43] op_sel:[1,0,0]
v_pk_mul_f32 v[52:53], v[26:27], v[66:67] op_sel_hi:[0,1]
v_pk_mul_f32 v[54:55], v[26:27], v[82:83] op_sel_hi:[0,1] neg_lo:[1,0] neg_hi:[1,0]
v_pk_fma_f32 v[52:53], v[26:27], v[82:83], v[52:53] op_sel:[1,0,0] neg_lo:[1,0,0] neg_hi:[1,0,0]
v_pk_fma_f32 v[54:55], v[26:27], v[66:67], v[54:55] op_sel:[1,0,0] neg_lo:[1,0,0] neg_hi:[1,0,0]
v_cvt_pk_bf16_f32 v129, v52, v53
v_cvt_pk_bf16_f32 v145, v54, v55
v_pk_fma_f32 v[40:41], v[24:25], v[66:67], v[68:69] op_sel_hi:[0,1,1]
v_pk_fma_f32 v[42:43], v[24:25], v[82:83], v[84:85] op_sel_hi:[0,1,1]
v_pk_fma_f32 v[68:69], v[24:25], v[82:83], v[40:41] op_sel:[1,0,0] neg_lo:[1,0,0] neg_hi:[1,0,0]
v_pk_fma_f32 v[84:85], v[24:25], v[66:67], v[42:43] op_sel:[1,0,0]
v_pk_mul_f32 v[52:53], v[26:27], v[68:69] op_sel_hi:[0,1]
v_pk_mul_f32 v[54:55], v[26:27], v[84:85] op_sel_hi:[0,1] neg_lo:[1,0] neg_hi:[1,0]
v_pk_fma_f32 v[52:53], v[26:27], v[84:85], v[52:53] op_sel:[1,0,0] neg_lo:[1,0,0] neg_hi:[1,0,0]
v_pk_fma_f32 v[54:55], v[26:27], v[68:69], v[54:55] op_sel:[1,0,0] neg_lo:[1,0,0] neg_hi:[1,0,0]
v_cvt_pk_bf16_f32 v130, v52, v53
v_cvt_pk_bf16_f32 v146, v54, v55
v_pk_fma_f32 v[40:41], v[24:25], v[68:69], v[70:71] op_sel_hi:[0,1,1]
v_pk_fma_f32 v[42:43], v[24:25], v[84:85], v[86:87] op_sel_hi:[0,1,1]
v_pk_fma_f32 v[70:71], v[24:25], v[84:85], v[40:41] op_sel:[1,0,0] neg_lo:[1,0,0] neg_hi:[1,0,0]
v_pk_fma_f32 v[86:87], v[24:25], v[68:69], v[42:43] op_sel:[1,0,0]
v_pk_mul_f32 v[52:53], v[26:27], v[70:71] op_sel_hi:[0,1]
v_pk_mul_f32 v[54:55], v[26:27], v[86:87] op_sel_hi:[0,1] neg_lo:[1,0] neg_hi:[1,0]
v_pk_fma_f32 v[52:53], v[26:27], v[86:87], v[52:53] op_sel:[1,0,0] neg_lo:[1,0,0] neg_hi:[1,0,0]
v_pk_fma_f32 v[54:55], v[26:27], v[70:71], v[54:55] op_sel:[1,0,0] neg_lo:[1,0,0] neg_hi:[1,0,0]
v_cvt_pk_bf16_f32 v131, v52, v53
v_cvt_pk_bf16_f32 v147, v54, v55
v_pk_fma_f32 v[40:41], v[24:25], v[70:71], v[72:73] op_sel_hi:[0,1,1]
v_pk_fma_f32 v[42:43], v[24:25], v[86:87], v[88:89] op_sel_hi:[0,1,1]
v_pk_fma_f32 v[72:73], v[24:25], v[86:87], v[40:41] op_sel:[1,0,0] neg_lo:[1,0,0] neg_hi:[1,0,0]
v_pk_fma_f32 v[88:89], v[24:25], v[70:71], v[42:43] op_sel:[1,0,0]
v_pk_mul_f32 v[52:53], v[26:27], v[72:73] op_sel_hi:[0,1]
v_pk_mul_f32 v[54:55], v[26:27], v[88:89] op_sel_hi:[0,1] neg_lo:[1,0] neg_hi:[1,0]
v_pk_fma_f32 v[52:53], v[26:27], v[88:89], v[52:53] op_sel:[1,0,0] neg_lo:[1,0,0] neg_hi:[1,0,0]
v_pk_fma_f32 v[54:55], v[26:27], v[72:73], v[54:55] op_sel:[1,0,0] neg_lo:[1,0,0] neg_hi:[1,0,0]
v_cvt_pk_bf16_f32 v132, v52, v53
v_cvt_pk_bf16_f32 v148, v54, v55
v_pk_fma_f32 v[40:41], v[24:25], v[72:73], v[74:75] op_sel_hi:[0,1,1]
v_pk_fma_f32 v[42:43], v[24:25], v[88:89], v[90:91] op_sel_hi:[0,1,1]
v_pk_fma_f32 v[74:75], v[24:25], v[88:89], v[40:41] op_sel:[1,0,0] neg_lo:[1,0,0] neg_hi:[1,0,0]
v_pk_fma_f32 v[90:91], v[24:25], v[72:73], v[42:43] op_sel:[1,0,0]
v_pk_mul_f32 v[52:53], v[26:27], v[74:75] op_sel_hi:[0,1]
v_pk_mul_f32 v[54:55], v[26:27], v[90:91] op_sel_hi:[0,1] neg_lo:[1,0] neg_hi:[1,0]
v_pk_fma_f32 v[52:53], v[26:27], v[90:91], v[52:53] op_sel:[1,0,0] neg_lo:[1,0,0] neg_hi:[1,0,0]
v_pk_fma_f32 v[54:55], v[26:27], v[74:75], v[54:55] op_sel:[1,0,0] neg_lo:[1,0,0] neg_hi:[1,0,0]
v_cvt_pk_bf16_f32 v133, v52, v53
v_cvt_pk_bf16_f32 v149, v54, v55
v_pk_fma_f32 v[40:41], v[24:25], v[74:75], v[76:77] op_sel_hi:[0,1,1]
v_pk_fma_f32 v[42:43], v[24:25], v[90:91], v[92:93] op_sel_hi:[0,1,1]
v_pk_fma_f32 v[76:77], v[24:25], v[90:91], v[40:41] op_sel:[1,0,0] neg_lo:[1,0,0] neg_hi:[1,0,0]
v_pk_fma_f32 v[92:93], v[24:25], v[74:75], v[42:43] op_sel:[1,0,0]
v_pk_mul_f32 v[52:53], v[26:27], v[76:77] op_sel_hi:[0,1]
v_pk_mul_f32 v[54:55], v[26:27], v[92:93] op_sel_hi:[0,1] neg_lo:[1,0] neg_hi:[1,0]
v_pk_fma_f32 v[52:53], v[26:27], v[92:93], v[52:53] op_sel:[1,0,0] neg_lo:[1,0,0] neg_hi:[1,0,0]
v_pk_fma_f32 v[54:55], v[26:27], v[76:77], v[54:55] op_sel:[1,0,0] neg_lo:[1,0,0] neg_hi:[1,0,0]
v_cvt_pk_bf16_f32 v134, v52, v53
v_cvt_pk_bf16_f32 v150, v54, v55
v_pk_fma_f32 v[40:41], v[24:25], v[76:77], v[78:79] op_sel_hi:[0,1,1]
v_pk_fma_f32 v[42:43], v[24:25], v[92:93], v[94:95] op_sel_hi:[0,1,1]
v_pk_fma_f32 v[78:79], v[24:25], v[92:93], v[40:41] op_sel:[1,0,0] neg_lo:[1,0,0] neg_hi:[1,0,0]
v_pk_fma_f32 v[94:95], v[24:25], v[76:77], v[42:43] op_sel:[1,0,0]
v_pk_mul_f32 v[52:53], v[26:27], v[78:79] op_sel_hi:[0,1]
v_pk_mul_f32 v[54:55], v[26:27], v[94:95] op_sel_hi:[0,1] neg_lo:[1,0] neg_hi:[1,0]
v_pk_fma_f32 v[52:53], v[26:27], v[94:95], v[52:53] op_sel:[1,0,0] neg_lo:[1,0,0] neg_hi:[1,0,0]
v_pk_fma_f32 v[54:55], v[26:27], v[78:79], v[54:55] op_sel:[1,0,0] neg_lo:[1,0,0] neg_hi:[1,0,0]
v_cvt_pk_bf16_f32 v135, v52, v53
v_cvt_pk_bf16_f32 v151, v54, v55
v_pk_fma_f32 v[40:41], v[24:25], v[78:79], v[96:97] op_sel_hi:[0,1,1]
v_pk_fma_f32 v[42:43], v[24:25], v[94:95], v[112:113] op_sel_hi:[0,1,1]
v_pk_fma_f32 v[96:97], v[24:25], v[94:95], v[40:41] op_sel:[1,0,0] neg_lo:[1,0,0] neg_hi:[1,0,0]
v_pk_fma_f32 v[112:113], v[24:25], v[78:79], v[42:43] op_sel:[1,0,0]
v_pk_mul_f32 v[52:53], v[26:27], v[96:97] op_sel_hi:[0,1]
v_pk_mul_f32 v[54:55], v[26:27], v[112:113] op_sel_hi:[0,1] neg_lo:[1,0] neg_hi:[1,0]
v_pk_fma_f32 v[52:53], v[26:27], v[112:113], v[52:53] op_sel:[1,0,0] neg_lo:[1,0,0] neg_hi:[1,0,0]
v_pk_fma_f32 v[54:55], v[26:27], v[96:97], v[54:55] op_sel:[1,0,0] neg_lo:[1,0,0] neg_hi:[1,0,0]
v_cvt_pk_bf16_f32 v136, v52, v53
v_cvt_pk_bf16_f32 v152, v54, v55
v_pk_fma_f32 v[40:41], v[24:25], v[96:97], v[98:99] op_sel_hi:[0,1,1]
v_pk_fma_f32 v[42:43], v[24:25], v[112:113], v[114:115] op_sel_hi:[0,1,1]
v_pk_fma_f32 v[98:99], v[24:25], v[112:113], v[40:41] op_sel:[1,0,0] neg_lo:[1,0,0] neg_hi:[1,0,0]
v_pk_fma_f32 v[114:115], v[24:25], v[96:97], v[42:43] op_sel:[1,0,0]
v_pk_mul_f32 v[52:53], v[26:27], v[98:99] op_sel_hi:[0,1]
v_pk_mul_f32 v[54:55], v[26:27], v[114:115] op_sel_hi:[0,1] neg_lo:[1,0] neg_hi:[1,0]
v_pk_fma_f32 v[52:53], v[26:27], v[114:115], v[52:53] op_sel:[1,0,0] neg_lo:[1,0,0] neg_hi:[1,0,0]
v_pk_fma_f32 v[54:55], v[26:27], v[98:99], v[54:55] op_sel:[1,0,0] neg_lo:[1,0,0] neg_hi:[1,0,0]
v_cvt_pk_bf16_f32 v137, v52, v53
v_cvt_pk_bf16_f32 v153, v54, v55
v_pk_fma_f32 v[40:41], v[24:25], v[98:99], v[100:101] op_sel_hi:[0,1,1]
v_pk_fma_f32 v[42:43], v[24:25], v[114:115], v[116:117] op_sel_hi:[0,1,1]
v_pk_fma_f32 v[100:101], v[24:25], v[114:115], v[40:41] op_sel:[1,0,0] neg_lo:[1,0,0] neg_hi:[1,0,0]
v_pk_fma_f32 v[116:117], v[24:25], v[98:99], v[42:43] op_sel:[1,0,0]
v_pk_mul_f32 v[52:53], v[26:27], v[100:101] op_sel_hi:[0,1]
v_pk_mul_f32 v[54:55], v[26:27], v[116:117] op_sel_hi:[0,1] neg_lo:[1,0] neg_hi:[1,0]
v_pk_fma_f32 v[52:53], v[26:27], v[116:117], v[52:53] op_sel:[1,0,0] neg_lo:[1,0,0] neg_hi:[1,0,0]
v_pk_fma_f32 v[54:55], v[26:27], v[100:101], v[54:55] op_sel:[1,0,0] neg_lo:[1,0,0] neg_hi:[1,0,0]
v_cvt_pk_bf16_f32 v138, v52, v53
v_cvt_pk_bf16_f32 v154, v54, v55
v_pk_fma_f32 v[40:41], v[24:25], v[100:101], v[102:103] op_sel_hi:[0,1,1]
v_pk_fma_f32 v[42:43], v[24:25], v[116:117], v[118:119] op_sel_hi:[0,1,1]
v_pk_fma_f32 v[102:103], v[24:25], v[116:117], v[40:41] op_sel:[1,0,0] neg_lo:[1,0,0] neg_hi:[1,0,0]
v_pk_fma_f32 v[118:119], v[24:25], v[100:101], v[42:43] op_sel:[1,0,0]
v_pk_mul_f32 v[52:53], v[26:27], v[102:103] op_sel_hi:[0,1]
v_pk_mul_f32 v[54:55], v[26:27], v[118:119] op_sel_hi:[0,1] neg_lo:[1,0] neg_hi:[1,0]
v_pk_fma_f32 v[52:53], v[26:27], v[118:119], v[52:53] op_sel:[1,0,0] neg_lo:[1,0,0] neg_hi:[1,0,0]
v_pk_fma_f32 v[54:55], v[26:27], v[102:103], v[54:55] op_sel:[1,0,0] neg_lo:[1,0,0] neg_hi:[1,0,0]
v_cvt_pk_bf16_f32 v139, v52, v53
v_cvt_pk_bf16_f32 v155, v54, v55
v_pk_fma_f32 v[40:41], v[24:25], v[102:103], v[104:105] op_sel_hi:[0,1,1]
v_pk_fma_f32 v[42:43], v[24:25], v[118:119], v[120:121] op_sel_hi:[0,1,1]
v_pk_fma_f32 v[104:105], v[24:25], v[118:119], v[40:41] op_sel:[1,0,0] neg_lo:[1,0,0] neg_hi:[1,0,0]
v_pk_fma_f32 v[120:121], v[24:25], v[102:103], v[42:43] op_sel:[1,0,0]
v_pk_mul_f32 v[52:53], v[26:27], v[104:105] op_sel_hi:[0,1]
v_pk_mul_f32 v[54:55], v[26:27], v[120:121] op_sel_hi:[0,1] neg_lo:[1,0] neg_hi:[1,0]
v_pk_fma_f32 v[52:53], v[26:27], v[120:121], v[52:53] op_sel:[1,0,0] neg_lo:[1,0,0] neg_hi:[1,0,0]
v_pk_fma_f32 v[54:55], v[26:27], v[104:105], v[54:55] op_sel:[1,0,0] neg_lo:[1,0,0] neg_hi:[1,0,0]
v_cvt_pk_bf16_f32 v140, v52, v53
v_cvt_pk_bf16_f32 v156, v54, v55
v_pk_fma_f32 v[40:41], v[24:25], v[104:105], v[106:107] op_sel_hi:[0,1,1]
v_pk_fma_f32 v[42:43], v[24:25], v[120:121], v[122:123] op_sel_hi:[0,1,1]
v_pk_fma_f32 v[106:107], v[24:25], v[120:121], v[40:41] op_sel:[1,0,0] neg_lo:[1,0,0] neg_hi:[1,0,0]
v_pk_fma_f32 v[122:123], v[24:25], v[104:105], v[42:43] op_sel:[1,0,0]
v_pk_mul_f32 v[52:53], v[26:27], v[106:107] op_sel_hi:[0,1]
v_pk_mul_f32 v[54:55], v[26:27], v[122:123] op_sel_hi:[0,1] neg_lo:[1,0] neg_hi:[1,0]
v_pk_fma_f32 v[52:53], v[26:27], v[122:123], v[52:53] op_sel:[1,0,0] neg_lo:[1,0,0] neg_hi:[1,0,0]
v_pk_fma_f32 v[54:55], v[26:27], v[106:107], v[54:55] op_sel:[1,0,0] neg_lo:[1,0,0] neg_hi:[1,0,0]
v_cvt_pk_bf16_f32 v141, v52, v53
v_cvt_pk_bf16_f32 v157, v54, v55
v_pk_fma_f32 v[40:41], v[24:25], v[106:107], v[108:109] op_sel_hi:[0,1,1]
v_pk_fma_f32 v[42:43], v[24:25], v[122:123], v[124:125] op_sel_hi:[0,1,1]
v_pk_fma_f32 v[108:109], v[24:25], v[122:123], v[40:41] op_sel:[1,0,0] neg_lo:[1,0,0] neg_hi:[1,0,0]
v_pk_fma_f32 v[124:125], v[24:25], v[106:107], v[42:43] op_sel:[1,0,0]
v_pk_mul_f32 v[52:53], v[26:27], v[108:109] op_sel_hi:[0,1]
v_pk_mul_f32 v[54:55], v[26:27], v[124:125] op_sel_hi:[0,1] neg_lo:[1,0] neg_hi:[1,0]
v_pk_fma_f32 v[52:53], v[26:27], v[124:125], v[52:53] op_sel:[1,0,0] neg_lo:[1,0,0] neg_hi:[1,0,0]
v_pk_fma_f32 v[54:55], v[26:27], v[108:109], v[54:55] op_sel:[1,0,0] neg_lo:[1,0,0] neg_hi:[1,0,0]
v_cvt_pk_bf16_f32 v142, v52, v53
v_cvt_pk_bf16_f32 v158, v54, v55
v_pk_fma_f32 v[40:41], v[24:25], v[108:109], v[110:111] op_sel_hi:[0,1,1]
v_pk_fma_f32 v[42:43], v[24:25], v[124:125], v[126:127] op_sel_hi:[0,1,1]
v_pk_fma_f32 v[110:111], v[24:25], v[124:125], v[40:41] op_sel:[1,0,0] neg_lo:[1,0,0] neg_hi:[1,0,0]
v_pk_fma_f32 v[126:127], v[24:25], v[108:109], v[42:43] op_sel:[1,0,0]
v_pk_mul_f32 v[52:53], v[26:27], v[110:111] op_sel_hi:[0,1]
v_pk_mul_f32 v[54:55], v[26:27], v[126:127] op_sel_hi:[0,1] neg_lo:[1,0] neg_hi:[1,0]
v_pk_fma_f32 v[52:53], v[26:27], v[126:127], v[52:53] op_sel:[1,0,0] neg_lo:[1,0,0] neg_hi:[1,0,0]
v_pk_fma_f32 v[54:55], v[26:27], v[110:111], v[54:55] op_sel:[1,0,0] neg_lo:[1,0,0] neg_hi:[1,0,0]
v_cvt_pk_bf16_f32 v143, v52, v53
v_cvt_pk_bf16_f32 v159, v54, v55
v_mfma_f32_32x32x16_bf16 v[160:175], v[128:131], v[248:251], 0
v_mfma_f32_32x32x16_bf16 v[160:175], v[132:135], v[252:255], v[160:175]
v_mfma_f32_32x32x16_bf16 v[176:191], v[136:139], v[248:251], 0
v_mfma_f32_32x32x16_bf16 v[176:191], v[140:143], v[252:255], v[176:191]
v_mfma_f32_32x32x16_bf16 v[192:207], v[144:147], v[248:251], 0
v_mfma_f32_32x32x16_bf16 v[192:207], v[148:151], v[252:255], v[192:207]
v_mfma_f32_32x32x16_bf16 v[208:223], v[152:155], v[248:251], 0
v_mfma_f32_32x32x16_bf16 v[208:223], v[156:159], v[252:255], v[208:223]
s_lshl_b32 s45, s21, 1
s_add_u32 s45, s45, s23
s_lshl_b32 s45, s45, 18
s_lshl_b32 s46, s22, 13
s_add_u32 s45, s45, s46
s_lshl_b32 s46, s51, 11
s_add_u32 s45, s45, s46
s_add_u32 s46, s45, 0
v_cvt_pk_bf16_f32 v64, v160, v161
v_cvt_pk_bf16_f32 v65, v162, v163
v_cvt_pk_bf16_f32 v66, v164, v165
v_cvt_pk_bf16_f32 v67, v166, v167
v_cvt_pk_bf16_f32 v68, v168, v169
v_cvt_pk_bf16_f32 v69, v170, v171
v_cvt_pk_bf16_f32 v70, v172, v173
v_cvt_pk_bf16_f32 v71, v174, v175
buffer_store_dwordx4 v[64:67], v11, s[36:39], s46 offen
buffer_store_dwordx4 v[68:71], v11, s[36:39], s46 offen offset:1024
s_add_u32 s46, s45, 131072
v_cvt_pk_bf16_f32 v72, v176, v177
v_cvt_pk_bf16_f32 v73, v178, v179
v_cvt_pk_bf16_f32 v74, v180, v181
v_cvt_pk_bf16_f32 v75, v182, v183
v_cvt_pk_bf16_f32 v76, v184, v185
v_cvt_pk_bf16_f32 v77, v186, v187
v_cvt_pk_bf16_f32 v78, v188, v189
v_cvt_pk_bf16_f32 v79, v190, v191
buffer_store_dwordx4 v[72:75], v11, s[36:39], s46 offen
buffer_store_dwordx4 v[76:79], v11, s[36:39], s46 offen offset:1024
s_add_u32 s46, s45, 4096
v_cvt_pk_bf16_f32 v80, v192, v193
v_cvt_pk_bf16_f32 v81, v194, v195
v_cvt_pk_bf16_f32 v82, v196, v197
v_cvt_pk_bf16_f32 v83, v198, v199
v_cvt_pk_bf16_f32 v84, v200, v201
v_cvt_pk_bf16_f32 v85, v202, v203
v_cvt_pk_bf16_f32 v86, v204, v205
v_cvt_pk_bf16_f32 v87, v206, v207
buffer_store_dwordx4 v[80:83], v11, s[36:39], s46 offen
buffer_store_dwordx4 v[84:87], v11, s[36:39], s46 offen offset:1024
s_add_u32 s46, s45, 135168
v_cvt_pk_bf16_f32 v88, v208, v209
v_cvt_pk_bf16_f32 v89, v210, v211
v_cvt_pk_bf16_f32 v90, v212, v213
v_cvt_pk_bf16_f32 v91, v214, v215
v_cvt_pk_bf16_f32 v92, v216, v217
v_cvt_pk_bf16_f32 v93, v218, v219
v_cvt_pk_bf16_f32 v94, v220, v221
v_cvt_pk_bf16_f32 v95, v222, v223
buffer_store_dwordx4 v[88:91], v11, s[36:39], s46 offen
buffer_store_dwordx4 v[92:95], v11, s[36:39], s46 offen offset:1024
L_g1_kernel_end:
s_endpgm
.globl a1_kernel
.p2align 8
.type a1_kernel,@function
a1_kernel:
s_cmp_ge_u32 s2, 256
s_cbranch_scc1 L_a1_kernel_end
v_lshrrev_b32 v2, 6, v0
v_and_b32 v1, 63, v0
v_readfirstlane_b32 s20, v2
s_load_dwordx2 s[4:5], s[0:1], 0
s_load_dwordx2 s[18:19], s[0:1], 112
s_getpc_b64 s[52:53]
L_pc2:
s_add_u32 s52, s52, tables-L_pc2
s_addc_u32 s53, s53, 0
s_mov_b32 s21, 0
s_waitcnt lgkmcnt(0)
s_and_b32 s44, s2, 31
s_lshr_b32 s45, s2, 5
s_lshl_b32 s45, s45, 7
s_add_u32 s44, s44, s45
s_lshl_b32 s44, s44, 12
s_add_u32 s24, s4, s44
s_addc_u32 s25, s5, 0
s_sub_u32 s26, 0x400000, s44
s_mov_b32 s27, 0x20000
v_lshlrev_b32 v2, 4, v1
s_add_u32 m0, s21, 0
s_mov_b32 s48, 0
buffer_load_dwordx4 v2, s[24:27], s48 offen offset:0 lds
buffer_load_dwordx4 v2, s[24:27], s48 offen offset:1024 lds
s_add_u32 m0, s21, 2176
s_mov_b32 s48, 2048
buffer_load_dwordx4 v2, s[24:27], s48 offen offset:0 lds
buffer_load_dwordx4 v2, s[24:27], s48 offen offset:1024 lds
s_add_u32 m0, s21, 4352
s_mov_b32 s48, 131072
buffer_load_dwordx4 v2, s[24:27], s48 offen offset:0 lds
buffer_load_dwordx4 v2, s[24:27], s48 offen offset:1024 lds
s_add_u32 m0, s21, 6528
s_mov_b32 s48, 133120
buffer_load_dwordx4 v2, s[24:27], s48 offen offset:0 lds
buffer_load_dwordx4 v2, s[24:27], s48 offen offset:1024 lds
s_add_u32 m0, s21, 8704
s_mov_b32 s48, 262144
buffer_load_dwordx4 v2, s[24:27], s48 offen offset:0 lds
buffer_load_dwordx4 v2, s[24:27], s48 offen offset:1024 lds
s_add_u32 m0, s21, 10880
s_mov_b32 s48, 264192
buffer_load_dwordx4 v2, s[24:27], s48 offen offset:0 lds
buffer_load_dwordx4 v2, s[24:27], s48 offen offset:1024 lds
s_add_u32 m0, s21, 13056
s_mov_b32 s48, 393216
buffer_load_dwordx4 v2, s[24:27], s48 offen offset:0 lds
buffer_load_dwordx4 v2, s[24:27], s48 offen offset:1024 lds
s_add_u32 m0, s21, 15232
s_mov_b32 s48, 395264
buffer_load_dwordx4 v2, s[24:27], s48 offen offset:0 lds
buffer_load_dwordx4 v2, s[24:27], s48 offen offset:1024 lds
v_add_u32 v3, 2048, v2
global_load_dwordx4 v[192:195], v3, s[52:53] offset:0
global_load_dwordx4 v[196:199], v3, s[52:53] offset:1024
global_load_dwordx4 v[200:203], v3, s[52:53] offset:2048
global_load_dwordx4 v[204:207], v3, s[52:53] offset:3072
v_add_u32 v3, 6144, v2
global_load_dwordx4 v[208:211], v3, s[52:53] offset:0
global_load_dwordx4 v[212:215], v3, s[52:53] offset:1024
global_load_dwordx4 v[216:219], v3, s[52:53] offset:2048
global_load_dwordx4 v[220:223], v3, s[52:53] offset:3072
v_add_u32 v3, 10240, v2
global_load_dwordx4 v[224:227], v3, s[52:53] offset:0
global_load_dwordx4 v[228:231], v3, s[52:53] offset:1024
global_load_dwordx4 v[232:235], v3, s[52:53] offset:2048
global_load_dwordx4 v[236:239], v3, s[52:53] offset:3072
v_add_u32 v3, 14336, v2
global_load_dwordx4 v[240:243], v3, s[52:53] offset:0
global_load_dwordx4 v[244:247], v3, s[52:53] offset:1024
global_load_dwordx4 v[248:251], v3, s[52:53] offset:2048
global_load_dwordx4 v[252:255], v3, s[52:53] offset:3072
v_bfe_u32 v4, v1, 2, 1
v_mul_u32_u24 v4, 2176, v4
v_bfe_u32 v5, v1, 3, 1
v_lshl_add_u32 v4, v5, 6, v4
v_lshrrev_b32 v5, 5, v1
v_lshl_add_u32 v4, v5, 8, v4
v_bfe_u32 v5, v1, 4, 1
v_lshl_add_u32 v4, v5, 5, v4
v_and_b32 v5, 3, v1
v_lshl_add_u32 v4, v5, 3, v4
v_add_u32 v4, s21, v4
v_and_b32 v5, 31, v1
v_lshlrev_b32 v5, 4, v5
v_lshrrev_b32 v6, 5, v1
v_lshl_add_u32 v5, v6, 11, v5
s_lshl_b32 s44, s2, 14
s_add_u32 s44, s44, 16777216
s_add_u32 s28, s18, s44
s_addc_u32 s29, s19, 0
s_mov_b32 s30, 0x4000
s_mov_b32 s31, 0x20000
s_waitcnt vmcnt(0)
ds_read_b64_tr_b16 v[8:9], v4 offset:0
ds_read_b64_tr_b16 v[10:11], v4 offset:128
ds_read_b64_tr_b16 v[12:13], v4 offset:512
ds_read_b64_tr_b16 v[14:15], v4 offset:640
ds_read_b64_tr_b16 v[16:17], v4 offset:1024
ds_read_b64_tr_b16 v[18:19], v4 offset:1152
ds_read_b64_tr_b16 v[20:21], v4 offset:1536
ds_read_b64_tr_b16 v[22:23], v4 offset:1664
ds_read_b64_tr_b16 v[24:25], v4 offset:4352
ds_read_b64_tr_b16 v[26:27], v4 offset:4480
ds_read_b64_tr_b16 v[28:29], v4 offset:4864
ds_read_b64_tr_b16 v[30:31], v4 offset:4992
ds_read_b64_tr_b16 v[32:33], v4 offset:5376
ds_read_b64_tr_b16 v[34:35], v4 offset:5504
ds_read_b64_tr_b16 v[36:37], v4 offset:5888
ds_read_b64_tr_b16 v[38:39], v4 offset:6016
s_waitcnt lgkmcnt(8)
v_mfma_f32_32x32x16_bf16 v[40:55], v[8:11], v[192:195], 0
v_mfma_f32_32x32x16_bf16 v[40:55], v[12:15], v[196:199], v[40:55]
v_mfma_f32_32x32x16_bf16 v[40:55], v[16:19], v[200:203], v[40:55]
v_mfma_f32_32x32x16_bf16 v[40:55], v[20:23], v[204:207], v[40:55]
v_mfma_f32_32x32x16_bf16 v[56:71], v[8:11], v[208:211], 0
v_mfma_f32_32x32x16_bf16 v[56:71], v[12:15], v[212:215], v[56:71]
v_mfma_f32_32x32x16_bf16 v[56:71], v[16:19], v[216:219], v[56:71]
v_mfma_f32_32x32x16_bf16 v[56:71], v[20:23], v[220:223], v[56:71]
s_waitcnt lgkmcnt(0)
v_mfma_f32_32x32x16_bf16 v[72:87], v[24:27], v[192:195], 0
v_mfma_f32_32x32x16_bf16 v[72:87], v[28:31], v[196:199], v[72:87]
v_mfma_f32_32x32x16_bf16 v[72:87], v[32:35], v[200:203], v[72:87]
v_mfma_f32_32x32x16_bf16 v[72:87], v[36:39], v[204:207], v[72:87]
v_mfma_f32_32x32x16_bf16 v[88:103], v[24:27], v[208:211], 0
v_mfma_f32_32x32x16_bf16 v[88:103], v[28:31], v[212:215], v[88:103]
v_mfma_f32_32x32x16_bf16 v[88:103], v[32:35], v[216:219], v[88:103]
v_mfma_f32_32x32x16_bf16 v[88:103], v[36:39], v[220:223], v[88:103]
ds_read_b64_tr_b16 v[8:9], v4 offset:8704
ds_read_b64_tr_b16 v[10:11], v4 offset:8832
ds_read_b64_tr_b16 v[12:13], v4 offset:9216
ds_read_b64_tr_b16 v[14:15], v4 offset:9344
ds_read_b64_tr_b16 v[16:17], v4 offset:9728
ds_read_b64_tr_b16 v[18:19], v4 offset:9856
ds_read_b64_tr_b16 v[20:21], v4 offset:10240
ds_read_b64_tr_b16 v[22:23], v4 offset:10368
v_pk_mul_f32 v[120:121], v[40:41], v[224:225]
v_pk_mul_f32 v[122:123], v[40:41], v[240:241]
v_pk_fma_f32 v[120:121], v[56:57], v[240:241], v[120:121] neg_lo:[1,0,0] neg_hi:[1,0,0]
v_pk_fma_f32 v[122:123], v[56:57], v[224:225], v[122:123]
v_cvt_pk_bf16_f32 v104, v120, v122
v_cvt_pk_bf16_f32 v105, v121, v123
v_pk_mul_f32 v[124:125], v[42:43], v[226:227]
v_pk_mul_f32 v[126:127], v[42:43], v[242:243]
v_pk_fma_f32 v[124:125], v[58:59], v[242:243], v[124:125] neg_lo:[1,0,0] neg_hi:[1,0,0]
v_pk_fma_f32 v[126:127], v[58:59], v[226:227], v[126:127]
v_cvt_pk_bf16_f32 v106, v124, v126
v_cvt_pk_bf16_f32 v107, v125, v127
v_pk_mul_f32 v[120:121], v[44:45], v[228:229]
v_pk_mul_f32 v[122:123], v[44:45], v[244:245]
v_pk_fma_f32 v[120:121], v[60:61], v[244:245], v[120:121] neg_lo:[1,0,0] neg_hi:[1,0,0]
v_pk_fma_f32 v[122:123], v[60:61], v[228:229], v[122:123]
v_cvt_pk_bf16_f32 v108, v120, v122
v_cvt_pk_bf16_f32 v109, v121, v123
v_pk_mul_f32 v[124:125], v[46:47], v[230:231]
v_pk_mul_f32 v[126:127], v[46:47], v[246:247]
v_pk_fma_f32 v[124:125], v[62:63], v[246:247], v[124:125] neg_lo:[1,0,0] neg_hi:[1,0,0]
v_pk_fma_f32 v[126:127], v[62:63], v[230:231], v[126:127]
v_cvt_pk_bf16_f32 v110, v124, v126
v_cvt_pk_bf16_f32 v111, v125, v127
v_pk_mul_f32 v[120:121], v[48:49], v[232:233]
v_pk_mul_f32 v[122:123], v[48:49], v[248:249]
v_pk_fma_f32 v[120:121], v[64:65], v[248:249], v[120:121] neg_lo:[1,0,0] neg_hi:[1,0,0]
v_pk_fma_f32 v[122:123], v[64:65], v[232:233], v[122:123]
v_cvt_pk_bf16_f32 v112, v120, v122
v_cvt_pk_bf16_f32 v113, v121, v123
v_pk_mul_f32 v[124:125], v[50:51], v[234:235]
v_pk_mul_f32 v[126:127], v[50:51], v[250:251]
v_pk_fma_f32 v[124:125], v[66:67], v[250:251], v[124:125] neg_lo:[1,0,0] neg_hi:[1,0,0]
v_pk_fma_f32 v[126:127], v[66:67], v[234:235], v[126:127]
v_cvt_pk_bf16_f32 v114, v124, v126
v_cvt_pk_bf16_f32 v115, v125, v127
v_pk_mul_f32 v[120:121], v[52:53], v[236:237]
v_pk_mul_f32 v[122:123], v[52:53], v[252:253]
v_pk_fma_f32 v[120:121], v[68:69], v[252:253], v[120:121] neg_lo:[1,0,0] neg_hi:[1,0,0]
v_pk_fma_f32 v[122:123], v[68:69], v[236:237], v[122:123]
v_cvt_pk_bf16_f32 v116, v120, v122
v_cvt_pk_bf16_f32 v117, v121, v123
v_pk_mul_f32 v[124:125], v[54:55], v[238:239]
v_pk_mul_f32 v[126:127], v[54:55], v[254:255]
v_pk_fma_f32 v[124:125], v[70:71], v[254:255], v[124:125] neg_lo:[1,0,0] neg_hi:[1,0,0]
v_pk_fma_f32 v[126:127], v[70:71], v[238:239], v[126:127]
v_cvt_pk_bf16_f32 v118, v124, v126
v_cvt_pk_bf16_f32 v119, v125, v127
v_mfma_f32_32x32x16_bf16 v[40:55], v[192:195], v[104:107], 0
v_mfma_f32_32x32x16_bf16 v[40:55], v[196:199], v[108:111], v[40:55]
v_mfma_f32_32x32x16_bf16 v[40:55], v[200:203], v[112:115], v[40:55]
v_mfma_f32_32x32x16_bf16 v[40:55], v[204:207], v[116:119], v[40:55]
v_mfma_f32_32x32x16_bf16 v[56:71], v[208:211], v[104:107], 0
v_mfma_f32_32x32x16_bf16 v[56:71], v[212:215], v[108:111], v[56:71]
v_mfma_f32_32x32x16_bf16 v[56:71], v[216:219], v[112:115], v[56:71]
v_mfma_f32_32x32x16_bf16 v[56:71], v[220:223], v[116:119], v[56:71]
s_nop 11
v_cvt_pk_bf16_f32 v128, v40, v56
v_cvt_pk_bf16_f32 v132, v41, v57
v_cvt_pk_bf16_f32 v136, v42, v58
v_cvt_pk_bf16_f32 v140, v43, v59
v_cvt_pk_bf16_f32 v144, v44, v60
v_cvt_pk_bf16_f32 v148, v45, v61
v_cvt_pk_bf16_f32 v152, v46, v62
v_cvt_pk_bf16_f32 v156, v47, v63
v_cvt_pk_bf16_f32 v160, v48, v64
v_cvt_pk_bf16_f32 v164, v49, v65
v_cvt_pk_bf16_f32 v168, v50, v66
v_cvt_pk_bf16_f32 v172, v51, v67
v_cvt_pk_bf16_f32 v176, v52, v68
v_cvt_pk_bf16_f32 v180, v53, v69
v_cvt_pk_bf16_f32 v184, v54, v70
v_cvt_pk_bf16_f32 v188, v55, v71
s_waitcnt lgkmcnt(0)
v_mfma_f32_32x32x16_bf16 v[40:55], v[8:11], v[192:195], 0
v_mfma_f32_32x32x16_bf16 v[40:55], v[12:15], v[196:199], v[40:55]
v_mfma_f32_32x32x16_bf16 v[40:55], v[16:19], v[200:203], v[40:55]
v_mfma_f32_32x32x16_bf16 v[40:55], v[20:23], v[204:207], v[40:55]
v_mfma_f32_32x32x16_bf16 v[56:71], v[8:11], v[208:211], 0
v_mfma_f32_32x32x16_bf16 v[56:71], v[12:15], v[212:215], v[56:71]
v_mfma_f32_32x32x16_bf16 v[56:71], v[16:19], v[216:219], v[56:71]
v_mfma_f32_32x32x16_bf16 v[56:71], v[20:23], v[220:223], v[56:71]
ds_read_b64_tr_b16 v[24:25], v4 offset:13056
ds_read_b64_tr_b16 v[26:27], v4 offset:13184
ds_read_b64_tr_b16 v[28:29], v4 offset:13568
ds_read_b64_tr_b16 v[30:31], v4 offset:13696
ds_read_b64_tr_b16 v[32:33], v4 offset:14080
ds_read_b64_tr_b16 v[34:35], v4 offset:14208
ds_read_b64_tr_b16 v[36:37], v4 offset:14592
ds_read_b64_tr_b16 v[38:39], v4 offset:14720
v_pk_mul_f32 v[120:121], v[72:73], v[224:225]
v_pk_mul_f32 v[122:123], v[72:73], v[240:241]
v_pk_fma_f32 v[120:121], v[88:89], v[240:241], v[120:121] neg_lo:[1,0,0] neg_hi:[1,0,0]
v_pk_fma_f32 v[122:123], v[88:89], v[224:225], v[122:123]
v_cvt_pk_bf16_f32 v104, v120, v122
v_cvt_pk_bf16_f32 v105, v121, v123
v_pk_mul_f32 v[124:125], v[74:75], v[226:227]
v_pk_mul_f32 v[126:127], v[74:75], v[242:243]
v_pk_fma_f32 v[124:125], v[90:91], v[242:243], v[124:125] neg_lo:[1,0,0] neg_hi:[1,0,0]
v_pk_fma_f32 v[126:127], v[90:91], v[226:227], v[126:127]
v_cvt_pk_bf16_f32 v106, v124, v126
v_cvt_pk_bf16_f32 v107, v125, v127
v_pk_mul_f32 v[120:121], v[76:77], v[228:229]
v_pk_mul_f32 v[122:123], v[76:77], v[244:245]
v_pk_fma_f32 v[120:121], v[92:93], v[244:245], v[120:121] neg_lo:[1,0,0] neg_hi:[1,0,0]
v_pk_fma_f32 v[122:123], v[92:93], v[228:229], v[122:123]
v_cvt_pk_bf16_f32 v108, v120, v122
v_cvt_pk_bf16_f32 v109, v121, v123
v_pk_mul_f32 v[124:125], v[78:79], v[230:231]
v_pk_mul_f32 v[126:127], v[78:79], v[246:247]
v_pk_fma_f32 v[124:125], v[94:95], v[246:247], v[124:125] neg_lo:[1,0,0] neg_hi:[1,0,0]
v_pk_fma_f32 v[126:127], v[94:95], v[230:231], v[126:127]
v_cvt_pk_bf16_f32 v110, v124, v126
v_cvt_pk_bf16_f32 v111, v125, v127
v_pk_mul_f32 v[120:121], v[80:81], v[232:233]
v_pk_mul_f32 v[122:123], v[80:81], v[248:249]
v_pk_fma_f32 v[120:121], v[96:97], v[248:249], v[120:121] neg_lo:[1,0,0] neg_hi:[1,0,0]
v_pk_fma_f32 v[122:123], v[96:97], v[232:233], v[122:123]
v_cvt_pk_bf16_f32 v112, v120, v122
v_cvt_pk_bf16_f32 v113, v121, v123
v_pk_mul_f32 v[124:125], v[82:83], v[234:235]
v_pk_mul_f32 v[126:127], v[82:83], v[250:251]
v_pk_fma_f32 v[124:125], v[98:99], v[250:251], v[124:125] neg_lo:[1,0,0] neg_hi:[1,0,0]
v_pk_fma_f32 v[126:127], v[98:99], v[234:235], v[126:127]
v_cvt_pk_bf16_f32 v114, v124, v126
v_cvt_pk_bf16_f32 v115, v125, v127
v_pk_mul_f32 v[120:121], v[84:85], v[236:237]
v_pk_mul_f32 v[122:123], v[84:85], v[252:253]
v_pk_fma_f32 v[120:121], v[100:101], v[252:253], v[120:121] neg_lo:[1,0,0] neg_hi:[1,0,0]
v_pk_fma_f32 v[122:123], v[100:101], v[236:237], v[122:123]
v_cvt_pk_bf16_f32 v116, v120, v122
v_cvt_pk_bf16_f32 v117, v121, v123
v_pk_mul_f32 v[124:125], v[86:87], v[238:239]
v_pk_mul_f32 v[126:127], v[86:87], v[254:255]
v_pk_fma_f32 v[124:125], v[102:103], v[254:255], v[124:125] neg_lo:[1,0,0] neg_hi:[1,0,0]
v_pk_fma_f32 v[126:127], v[102:103], v[238:239], v[126:127]
v_cvt_pk_bf16_f32 v118, v124, v126
v_cvt_pk_bf16_f32 v119, v125, v127
v_mfma_f32_32x32x16_bf16 v[72:87], v[192:195], v[104:107], 0
v_mfma_f32_32x32x16_bf16 v[72:87], v[196:199], v[108:111], v[72:87]
v_mfma_f32_32x32x16_bf16 v[72:87], v[200:203], v[112:115], v[72:87]
v_mfma_f32_32x32x16_bf16 v[72:87], v[204:207], v[116:119], v[72:87]
v_mfma_f32_32x32x16_bf16 v[88:103], v[208:211], v[104:107], 0
v_mfma_f32_32x32x16_bf16 v[88:103], v[212:215], v[108:111], v[88:103]
v_mfma_f32_32x32x16_bf16 v[88:103], v[216:219], v[112:115], v[88:103]
v_mfma_f32_32x32x16_bf16 v[88:103], v[220:223], v[116:119], v[88:103]
s_nop 11
v_cvt_pk_bf16_f32 v129, v72, v88
v_cvt_pk_bf16_f32 v133, v73, v89
v_cvt_pk_bf16_f32 v137, v74, v90
v_cvt_pk_bf16_f32 v141, v75, v91
v_cvt_pk_bf16_f32 v145, v76, v92
v_cvt_pk_bf16_f32 v149, v77, v93
v_cvt_pk_bf16_f32 v153, v78, v94
v_cvt_pk_bf16_f32 v157, v79, v95
v_cvt_pk_bf16_f32 v161, v80, v96
v_cvt_pk_bf16_f32 v165, v81, v97
v_cvt_pk_bf16_f32 v169, v82, v98
v_cvt_pk_bf16_f32 v173, v83, v99
v_cvt_pk_bf16_f32 v177, v84, v100
v_cvt_pk_bf16_f32 v181, v85, v101
v_cvt_pk_bf16_f32 v185, v86, v102
v_cvt_pk_bf16_f32 v189, v87, v103
s_waitcnt lgkmcnt(0)
v_mfma_f32_32x32x16_bf16 v[72:87], v[24:27], v[192:195], 0
v_mfma_f32_32x32x16_bf16 v[72:87], v[28:31], v[196:199], v[72:87]
v_mfma_f32_32x32x16_bf16 v[72:87], v[32:35], v[200:203], v[72:87]
v_mfma_f32_32x32x16_bf16 v[72:87], v[36:39], v[204:207], v[72:87]
v_mfma_f32_32x32x16_bf16 v[88:103], v[24:27], v[208:211], 0
v_mfma_f32_32x32x16_bf16 v[88:103], v[28:31], v[212:215], v[88:103]
v_mfma_f32_32x32x16_bf16 v[88:103], v[32:35], v[216:219], v[88:103]
v_mfma_f32_32x32x16_bf16 v[88:103], v[36:39], v[220:223], v[88:103]
v_pk_mul_f32 v[120:121], v[40:41], v[224:225]
v_pk_mul_f32 v[122:123], v[40:41], v[240:241]
v_pk_fma_f32 v[120:121], v[56:57], v[240:241], v[120:121] neg_lo:[1,0,0] neg_hi:[1,0,0]
v_pk_fma_f32 v[122:123], v[56:57], v[224:225], v[122:123]
v_cvt_pk_bf16_f32 v104, v120, v122
v_cvt_pk_bf16_f32 v105, v121, v123
v_pk_mul_f32 v[124:125], v[42:43], v[226:227]
v_pk_mul_f32 v[126:127], v[42:43], v[242:243]
v_pk_fma_f32 v[124:125], v[58:59], v[242:243], v[124:125] neg_lo:[1,0,0] neg_hi:[1,0,0]
v_pk_fma_f32 v[126:127], v[58:59], v[226:227], v[126:127]
v_cvt_pk_bf16_f32 v106, v124, v126
v_cvt_pk_bf16_f32 v107, v125, v127
v_pk_mul_f32 v[120:121], v[44:45], v[228:229]
v_pk_mul_f32 v[122:123], v[44:45], v[244:245]
v_pk_fma_f32 v[120:121], v[60:61], v[244:245], v[120:121] neg_lo:[1,0,0] neg_hi:[1,0,0]
v_pk_fma_f32 v[122:123], v[60:61], v[228:229], v[122:123]
v_cvt_pk_bf16_f32 v108, v120, v122
v_cvt_pk_bf16_f32 v109, v121, v123
v_pk_mul_f32 v[124:125], v[46:47], v[230:231]
v_pk_mul_f32 v[126:127], v[46:47], v[246:247]
v_pk_fma_f32 v[124:125], v[62:63], v[246:247], v[124:125] neg_lo:[1,0,0] neg_hi:[1,0,0]
v_pk_fma_f32 v[126:127], v[62:63], v[230:231], v[126:127]
v_cvt_pk_bf16_f32 v110, v124, v126
v_cvt_pk_bf16_f32 v111, v125, v127
v_pk_mul_f32 v[120:121], v[48:49], v[232:233]
v_pk_mul_f32 v[122:123], v[48:49], v[248:249]
v_pk_fma_f32 v[120:121], v[64:65], v[248:249], v[120:121] neg_lo:[1,0,0] neg_hi:[1,0,0]
v_pk_fma_f32 v[122:123], v[64:65], v[232:233], v[122:123]
v_cvt_pk_bf16_f32 v112, v120, v122
v_cvt_pk_bf16_f32 v113, v121, v123
v_pk_mul_f32 v[124:125], v[50:51], v[234:235]
v_pk_mul_f32 v[126:127], v[50:51], v[250:251]
v_pk_fma_f32 v[124:125], v[66:67], v[250:251], v[124:125] neg_lo:[1,0,0] neg_hi:[1,0,0]
v_pk_fma_f32 v[126:127], v[66:67], v[234:235], v[126:127]
v_cvt_pk_bf16_f32 v114, v124, v126
v_cvt_pk_bf16_f32 v115, v125, v127
v_pk_mul_f32 v[120:121], v[52:53], v[236:237]
v_pk_mul_f32 v[122:123], v[52:53], v[252:253]
v_pk_fma_f32 v[120:121], v[68:69], v[252:253], v[120:121] neg_lo:[1,0,0] neg_hi:[1,0,0]
v_pk_fma_f32 v[122:123], v[68:69], v[236:237], v[122:123]
v_cvt_pk_bf16_f32 v116, v120, v122
v_cvt_pk_bf16_f32 v117, v121, v123
v_pk_mul_f32 v[124:125], v[54:55], v[238:239]
v_pk_mul_f32 v[126:127], v[54:55], v[254:255]
v_pk_fma_f32 v[124:125], v[70:71], v[254:255], v[124:125] neg_lo:[1,0,0] neg_hi:[1,0,0]
v_pk_fma_f32 v[126:127], v[70:71], v[238:239], v[126:127]
v_cvt_pk_bf16_f32 v118, v124, v126
v_cvt_pk_bf16_f32 v119, v125, v127
v_mfma_f32_32x32x16_bf16 v[40:55], v[192:195], v[104:107], 0
v_mfma_f32_32x32x16_bf16 v[40:55], v[196:199], v[108:111], v[40:55]
v_mfma_f32_32x32x16_bf16 v[40:55], v[200:203], v[112:115], v[40:55]
v_mfma_f32_32x32x16_bf16 v[40:55], v[204:207], v[116:119], v[40:55]
v_mfma_f32_32x32x16_bf16 v[56:71], v[208:211], v[104:107], 0
v_mfma_f32_32x32x16_bf16 v[56:71], v[212:215], v[108:111], v[56:71]
v_mfma_f32_32x32x16_bf16 v[56:71], v[216:219], v[112:115], v[56:71]
v_mfma_f32_32x32x16_bf16 v[56:71], v[220:223], v[116:119], v[56:71]
s_nop 11
v_cvt_pk_bf16_f32 v130, v40, v56
v_cvt_pk_bf16_f32 v134, v41, v57
v_cvt_pk_bf16_f32 v138, v42, v58
v_cvt_pk_bf16_f32 v142, v43, v59
v_cvt_pk_bf16_f32 v146, v44, v60
v_cvt_pk_bf16_f32 v150, v45, v61
v_cvt_pk_bf16_f32 v154, v46, v62
v_cvt_pk_bf16_f32 v158, v47, v63
v_cvt_pk_bf16_f32 v162, v48, v64
v_cvt_pk_bf16_f32 v166, v49, v65
v_cvt_pk_bf16_f32 v170, v50, v66
v_cvt_pk_bf16_f32 v174, v51, v67
v_cvt_pk_bf16_f32 v178, v52, v68
v_cvt_pk_bf16_f32 v182, v53, v69
v_cvt_pk_bf16_f32 v186, v54, v70
v_cvt_pk_bf16_f32 v190, v55, v71
v_pk_mul_f32 v[120:121], v[72:73], v[224:225]
v_pk_mul_f32 v[122:123], v[72:73], v[240:241]
v_pk_fma_f32 v[120:121], v[88:89], v[240:241], v[120:121] neg_lo:[1,0,0] neg_hi:[1,0,0]
v_pk_fma_f32 v[122:123], v[88:89], v[224:225], v[122:123]
v_cvt_pk_bf16_f32 v104, v120, v122
v_cvt_pk_bf16_f32 v105, v121, v123
v_pk_mul_f32 v[124:125], v[74:75], v[226:227]
v_pk_mul_f32 v[126:127], v[74:75], v[242:243]
v_pk_fma_f32 v[124:125], v[90:91], v[242:243], v[124:125] neg_lo:[1,0,0] neg_hi:[1,0,0]
v_pk_fma_f32 v[126:127], v[90:91], v[226:227], v[126:127]
v_cvt_pk_bf16_f32 v106, v124, v126
v_cvt_pk_bf16_f32 v107, v125, v127
v_pk_mul_f32 v[120:121], v[76:77], v[228:229]
v_pk_mul_f32 v[122:123], v[76:77], v[244:245]
v_pk_fma_f32 v[120:121], v[92:93], v[244:245], v[120:121] neg_lo:[1,0,0] neg_hi:[1,0,0]
v_pk_fma_f32 v[122:123], v[92:93], v[228:229], v[122:123]
v_cvt_pk_bf16_f32 v108, v120, v122
v_cvt_pk_bf16_f32 v109, v121, v123
v_pk_mul_f32 v[124:125], v[78:79], v[230:231]
v_pk_mul_f32 v[126:127], v[78:79], v[246:247]
v_pk_fma_f32 v[124:125], v[94:95], v[246:247], v[124:125] neg_lo:[1,0,0] neg_hi:[1,0,0]
v_pk_fma_f32 v[126:127], v[94:95], v[230:231], v[126:127]
v_cvt_pk_bf16_f32 v110, v124, v126
v_cvt_pk_bf16_f32 v111, v125, v127
v_pk_mul_f32 v[120:121], v[80:81], v[232:233]
v_pk_mul_f32 v[122:123], v[80:81], v[248:249]
v_pk_fma_f32 v[120:121], v[96:97], v[248:249], v[120:121] neg_lo:[1,0,0] neg_hi:[1,0,0]
v_pk_fma_f32 v[122:123], v[96:97], v[232:233], v[122:123]
v_cvt_pk_bf16_f32 v112, v120, v122
v_cvt_pk_bf16_f32 v113, v121, v123
v_pk_mul_f32 v[124:125], v[82:83], v[234:235]
v_pk_mul_f32 v[126:127], v[82:83], v[250:251]
v_pk_fma_f32 v[124:125], v[98:99], v[250:251], v[124:125] neg_lo:[1,0,0] neg_hi:[1,0,0]
v_pk_fma_f32 v[126:127], v[98:99], v[234:235], v[126:127]
v_cvt_pk_bf16_f32 v114, v124, v126
v_cvt_pk_bf16_f32 v115, v125, v127
v_pk_mul_f32 v[120:121], v[84:85], v[236:237]
v_pk_mul_f32 v[122:123], v[84:85], v[252:253]
v_pk_fma_f32 v[120:121], v[100:101], v[252:253], v[120:121] neg_lo:[1,0,0] neg_hi:[1,0,0]
v_pk_fma_f32 v[122:123], v[100:101], v[236:237], v[122:123]
v_cvt_pk_bf16_f32 v116, v120, v122
v_cvt_pk_bf16_f32 v117, v121, v123
v_pk_mul_f32 v[124:125], v[86:87], v[238:239]
v_pk_mul_f32 v[126:127], v[86:87], v[254:255]
v_pk_fma_f32 v[124:125], v[102:103], v[254:255], v[124:125] neg_lo:[1,0,0] neg_hi:[1,0,0]
v_pk_fma_f32 v[126:127], v[102:103], v[238:239], v[126:127]
v_cvt_pk_bf16_f32 v118, v124, v126
v_cvt_pk_bf16_f32 v119, v125, v127
v_mfma_f32_32x32x16_bf16 v[72:87], v[192:195], v[104:107], 0
v_mfma_f32_32x32x16_bf16 v[72:87], v[196:199], v[108:111], v[72:87]
v_mfma_f32_32x32x16_bf16 v[72:87], v[200:203], v[112:115], v[72:87]
v_mfma_f32_32x32x16_bf16 v[72:87], v[204:207], v[116:119], v[72:87]
v_mfma_f32_32x32x16_bf16 v[88:103], v[208:211], v[104:107], 0
v_mfma_f32_32x32x16_bf16 v[88:103], v[212:215], v[108:111], v[88:103]
v_mfma_f32_32x32x16_bf16 v[88:103], v[216:219], v[112:115], v[88:103]
v_mfma_f32_32x32x16_bf16 v[88:103], v[220:223], v[116:119], v[88:103]
s_nop 11
v_cvt_pk_bf16_f32 v131, v72, v88
v_cvt_pk_bf16_f32 v135, v73, v89
v_cvt_pk_bf16_f32 v139, v74, v90
v_cvt_pk_bf16_f32 v143, v75, v91
v_cvt_pk_bf16_f32 v147, v76, v92
v_cvt_pk_bf16_f32 v151, v77, v93
v_cvt_pk_bf16_f32 v155, v78, v94
v_cvt_pk_bf16_f32 v159, v79, v95
v_cvt_pk_bf16_f32 v163, v80, v96
v_cvt_pk_bf16_f32 v167, v81, v97
v_cvt_pk_bf16_f32 v171, v82, v98
v_cvt_pk_bf16_f32 v175, v83, v99
v_cvt_pk_bf16_f32 v179, v84, v100
v_cvt_pk_bf16_f32 v183, v85, v101
v_cvt_pk_bf16_f32 v187, v86, v102
v_cvt_pk_bf16_f32 v191, v87, v103
s_mov_b32 s48, 0
buffer_store_dwordx4 v[128:131], v5, s[28:31], s48 offen offset:0
buffer_store_dwordx4 v[132:135], v5, s[28:31], s48 offen offset:512
buffer_store_dwordx4 v[136:139], v5, s[28:31], s48 offen offset:1024
buffer_store_dwordx4 v[140:143], v5, s[28:31], s48 offen offset:1536
s_mov_b32 s48, 4096
buffer_store_dwordx4 v[144:147], v5, s[28:31], s48 offen offset:0
buffer_store_dwordx4 v[148:151], v5, s[28:31], s48 offen offset:512
buffer_store_dwordx4 v[152:155], v5, s[28:31], s48 offen offset:1024
buffer_store_dwordx4 v[156:159], v5, s[28:31], s48 offen offset:1536
s_mov_b32 s48, 8192
buffer_store_dwordx4 v[160:163], v5, s[28:31], s48 offen offset:0
buffer_store_dwordx4 v[164:167], v5, s[28:31], s48 offen offset:512
buffer_store_dwordx4 v[168:171], v5, s[28:31], s48 offen offset:1024
buffer_store_dwordx4 v[172:175], v5, s[28:31], s48 offen offset:1536
s_mov_b32 s48, 12288
buffer_store_dwordx4 v[176:179], v5, s[28:31], s48 offen offset:0
buffer_store_dwordx4 v[180:183], v5, s[28:31], s48 offen offset:512
buffer_store_dwordx4 v[184:187], v5, s[28:31], s48 offen offset:1024
buffer_store_dwordx4 v[188:191], v5, s[28:31], s48 offen offset:1536
L_a1_kernel_end:
s_endpgm
.globl wt_kernel
.p2align 8
.type wt_kernel,@function
wt_kernel:
s_cmp_ge_u32 s2, 272
s_cbranch_scc1 L_wt_kernel_end
v_lshrrev_b32 v2, 6, v0
v_and_b32 v1, 63, v0
v_readfirstlane_b32 s20, v2
s_load_dwordx4 s[8:11], s[0:1], 8
s_load_dwordx2 s[18:19], s[0:1], 112
s_mov_b32 s21, 0
s_waitcnt lgkmcnt(0)
s_cmp_ge_u32 s2, 256
s_cbranch_scc1 L_wt_kernel_sp
s_mov_b32 s24, s8
s_mov_b32 s25, s9
s_mov_b32 s26, 2101248
s_mov_b32 s27, 0x20000
s_mov_b32 s28, s10
s_mov_b32 s29, s11
s_mov_b32 s30, 2101248
s_mov_b32 s31, 0x20000
s_and_b32 s44, s2, 7
s_bfe_u32 s45, s2, 0x10003
s_bfe_u32 s46, s2, 0x20004
s_lshr_b32 s47, s2, 6
s_lshr_b32 s48, s44, 1
s_lshl_b32 s48, s48, 3
s_lshl_b32 s49, s45, 2
s_add_u32 s48, s48, s49
s_and_b32 s49, s44, 1
s_lshl_b32 s49, s49, 1
s_add_u32 s48, s48, s49
s_lshl_b32 s48, s48, 5
s_lshl_b32 s49, s46, 3
s_add_u32 s48, s48, s49
s_mul_i32 s48, s48, 1026
s_lshl_b32 s49, s47, 8
s_add_u32 s48, s48, s49
v_bfe_u32 v2, v1, 4, 1
v_mul_u32_u24 v2, 32832, v2
v_lshrrev_b32 v3, 5, v1
s_mov_b32 s49, 1050624
v_mul_lo_u32 v3, s49, v3
v_and_b32 v4, 15, v1
v_lshl_add_u32 v2, v4, 4, v2
v_add_u32 v2, v2, v3
s_add_u32 m0, s21, 0
s_add_u32 s49, s48, 0
buffer_load_dwordx4 v2, s[24:27], s49 offen lds
s_add_u32 m0, s21, 1024
s_nop 0
buffer_load_dwordx4 v2, s[28:31], s49 offen lds
s_add_u32 m0, s21, 2064
s_add_u32 s49, s48, 1026
buffer_load_dwordx4 v2, s[24:27], s49 offen lds
s_add_u32 m0, s21, 3088
s_nop 0
buffer_load_dwordx4 v2, s[28:31], s49 offen lds
s_add_u32 m0, s21, 4128
s_add_u32 s49, s48, 2052
buffer_load_dwordx4 v2, s[24:27], s49 offen lds
s_add_u32 m0, s21, 5152
s_nop 0
buffer_load_dwordx4 v2, s[28:31], s49 offen lds
s_add_u32 m0, s21, 6192
s_add_u32 s49, s48, 3078
buffer_load_dwordx4 v2, s[24:27], s49 offen lds
s_add_u32 m0, s21, 7216
s_nop 0
buffer_load_dwordx4 v2, s[28:31], s49 offen lds
s_add_u32 m0, s21, 8256
s_add_u32 s49, s48, 4104
buffer_load_dwordx4 v2, s[24:27], s49 offen lds
s_add_u32 m0, s21, 9280
s_nop 0
buffer_load_dwordx4 v2, s[28:31], s49 offen lds
s_add_u32 m0, s21, 10320
s_add_u32 s49, s48, 5130
buffer_load_dwordx4 v2, s[24:27], s49 offen lds
s_add_u32 m0, s21, 11344
s_nop 0
buffer_load_dwordx4 v2, s[28:31], s49 offen lds
s_add_u32 m0, s21, 12384
s_add_u32 s49, s48, 6156
buffer_load_dwordx4 v2, s[24:27], s49 offen lds
s_add_u32 m0, s21, 13408
s_nop 0
buffer_load_dwordx4 v2, s[28:31], s49 offen lds
s_add_u32 m0, s21, 14448
s_add_u32 s49, s48, 7182
buffer_load_dwordx4 v2, s[24:27], s49 offen lds
s_add_u32 m0, s21, 15472
s_nop 0
buffer_load_dwordx4 v2, s[28:31], s49 offen lds
v_and_b32 v3, 7, v1
v_mul_u32_u24 v4, 2064, v3
v_lshrrev_b32 v5, 3, v1
v_lshl_add_u32 v4, v5, 4, v4
v_add_u32 v4, s21, v4
v_lshlrev_b32 v5, 16, v5
v_lshl_add_u32 v5, v3, 4, v5
s_lshl_b32 s48, s47, 20
s_lshl_b32 s49, s44, 10
s_add_u32 s48, s48, s49
s_lshl_b32 s49, s45, 9
s_add_u32 s48, s48, s49
s_lshl_b32 s49, s46, 7
s_add_u32 s48, s48, s49
s_add_u32 s49, s48, 25165824
s_add_u32 s32, s18, s49
s_addc_u32 s33, s19, 0
s_sub_u32 s34, 0x400000, s48
s_mov_b32 s35, 0x20000
s_mov_b32 s46, 0x05040100
s_mov_b32 s47, 0x07060302
s_waitcnt vmcnt(0)
ds_read_b128 v[8:11], v4 offset:0
ds_read_b128 v[12:15], v4 offset:256
ds_read_b128 v[16:19], v4 offset:512
ds_read_b128 v[20:23], v4 offset:768
ds_read_b128 v[24:27], v4 offset:1024
ds_read_b128 v[28:31], v4 offset:1280
ds_read_b128 v[32:35], v4 offset:1536
ds_read_b128 v[36:39], v4 offset:1792
ds_read_b128 v[40:43], v4 offset:128
ds_read_b128 v[44:47], v4 offset:384
ds_read_b128 v[48:51], v4 offset:640
ds_read_b128 v[52:55], v4 offset:896
ds_read_b128 v[56:59], v4 offset:1152
ds_read_b128 v[60:63], v4 offset:1408
ds_read_b128 v[64:67], v4 offset:1664
ds_read_b128 v[68:71], v4 offset:1920
s_waitcnt lgkmcnt(8)
v_perm_b32 v72, v24, v8, s46
v_perm_b32 v73, v32, v16, s46
v_perm_b32 v74, v28, v12, s46
v_perm_b32 v75, v36, v20, s46
s_mov_b32 s48, 0
buffer_store_dwordx4 v[72:75], v5, s[32:35], s48 offen
v_perm_b32 v76, v24, v8, s47
v_perm_b32 v77, v32, v16, s47
v_perm_b32 v78, v28, v12, s47
v_perm_b32 v79, v36, v20, s47
s_mov_b32 s48, 8192
buffer_store_dwordx4 v[76:79], v5, s[32:35], s48 offen
v_perm_b32 v80, v25, v9, s46
v_perm_b32 v81, v33, v17, s46
v_perm_b32 v82, v29, v13, s46
v_perm_b32 v83, v37, v21, s46
s_mov_b32 s48, 16384
buffer_store_dwordx4 v[80:83], v5, s[32:35], s48 offen
v_perm_b32 v84, v25, v9, s47
v_perm_b32 v85, v33, v17, s47
v_perm_b32 v86, v29, v13, s47
v_perm_b32 v87, v37, v21, s47
s_mov_b32 s48, 24576
buffer_store_dwordx4 v[84:87], v5, s[32:35], s48 offen
v_perm_b32 v88, v26, v10, s46
v_perm_b32 v89, v34, v18, s46
v_perm_b32 v90, v30, v14, s46
v_perm_b32 v91, v38, v22, s46
s_mov_b32 s48, 32768
buffer_store_dwordx4 v[88:91], v5, s[32:35], s48 offen
v_perm_b32 v92, v26, v10, s47
v_perm_b32 v93, v34, v18, s47
v_perm_b32 v94, v30, v14, s47
v_perm_b32 v95, v38, v22, s47
s_mov_b32 s48, 40960
buffer_store_dwordx4 v[92:95], v5, s[32:35], s48 offen
v_perm_b32 v96, v27, v11, s46
v_perm_b32 v97, v35, v19, s46
v_perm_b32 v98, v31, v15, s46
v_perm_b32 v99, v39, v23, s46
s_mov_b32 s48, 49152
buffer_store_dwordx4 v[96:99], v5, s[32:35], s48 offen
v_perm_b32 v100, v27, v11, s47
v_perm_b32 v101, v35, v19, s47
v_perm_b32 v102, v31, v15, s47
v_perm_b32 v103, v39, v23, s47
s_mov_b32 s48, 57344
buffer_store_dwordx4 v[100:103], v5, s[32:35], s48 offen
s_waitcnt lgkmcnt(0)
v_perm_b32 v104, v56, v40, s46
v_perm_b32 v105, v64, v48, s46
v_perm_b32 v106, v60, v44, s46
v_perm_b32 v107, v68, v52, s46
s_mov_b32 s48, 524288
buffer_store_dwordx4 v[104:107], v5, s[32:35], s48 offen
v_perm_b32 v108, v56, v40, s47
v_perm_b32 v109, v64, v48, s47
v_perm_b32 v110, v60, v44, s47
v_perm_b32 v111, v68, v52, s47
s_mov_b32 s48, 532480
buffer_store_dwordx4 v[108:111], v5, s[32:35], s48 offen
v_perm_b32 v112, v57, v41, s46
v_perm_b32 v113, v65, v49, s46
v_perm_b32 v114, v61, v45, s46
v_perm_b32 v115, v69, v53, s46
s_mov_b32 s48, 540672
buffer_store_dwordx4 v[112:115], v5, s[32:35], s48 offen
v_perm_b32 v116, v57, v41, s47
v_perm_b32 v117, v65, v49, s47
v_perm_b32 v118, v61, v45, s47
v_perm_b32 v119, v69, v53, s47
s_mov_b32 s48, 548864
buffer_store_dwordx4 v[116:119], v5, s[32:35], s48 offen
v_perm_b32 v120, v58, v42, s46
v_perm_b32 v121, v66, v50, s46
v_perm_b32 v122, v62, v46, s46
v_perm_b32 v123, v70, v54, s46
s_mov_b32 s48, 557056
buffer_store_dwordx4 v[120:123], v5, s[32:35], s48 offen
v_perm_b32 v124, v58, v42, s47
v_perm_b32 v125, v66, v50, s47
v_perm_b32 v126, v62, v46, s47
v_perm_b32 v127, v70, v54, s47
s_mov_b32 s48, 565248
buffer_store_dwordx4 v[124:127], v5, s[32:35], s48 offen
v_perm_b32 v128, v59, v43, s46
v_perm_b32 v129, v67, v51, s46
v_perm_b32 v130, v63, v47, s46
v_perm_b32 v131, v71, v55, s46
s_mov_b32 s48, 573440
buffer_store_dwordx4 v[128:131], v5, s[32:35], s48 offen
v_perm_b32 v132, v59, v43, s47
v_perm_b32 v133, v67, v51, s47
v_perm_b32 v134, v63, v47, s47
v_perm_b32 v135, v71, v55, s47
s_mov_b32 s48, 581632
buffer_store_dwordx4 v[132:135], v5, s[32:35], s48 offen
s_branch L_wt_kernel_fin
L_wt_kernel_sp:
s_sub_u32 s22, s2, 256
s_mov_b32 s24, s8
s_mov_b32 s25, s9
s_mov_b32 s26, 2101248
s_mov_b32 s27, 0x20000
s_mov_b32 s28, s10
s_mov_b32 s29, s11
s_mov_b32 s30, 2101248
s_mov_b32 s31, 0x20000
s_and_b32 s44, s22, 7
s_lshr_b32 s45, s22, 3
s_lshr_b32 s48, s44, 1
s_lshl_b32 s48, s48, 3
s_and_b32 s49, s44, 1
s_lshl_b32 s49, s49, 1
s_add_u32 s48, s48, s49
s_lshl_b32 s48, s48, 5
v_and_b32 v2, 31, v1
v_lshrrev_b32 v3, 5, v1
v_lshl_add_u32 v2, v3, 7, v2
v_add_u32 v2, s48, v2
s_lshl_b32 s46, s45, 10
s_movk_i32 s47, 1026
v_add_u32 v4, 0, v2
v_sub_u32 v5, 2048, v4
v_and_b32 v5, 2047, v5
v_mul_lo_u32 v4, s47, v4
v_mul_lo_u32 v5, s47, v5
buffer_load_ushort v8, v4, s[24:27], s46 offen
buffer_load_ushort v9, v4, s[28:31], s46 offen
buffer_load_ushort v10, v5, s[24:27], s46 offen
buffer_load_ushort v11, v5, s[28:31], s46 offen
v_add_u32 v4, 1024, v2
v_sub_u32 v5, 2048, v4
v_and_b32 v5, 2047, v5
v_mul_lo_u32 v4, s47, v4
v_mul_lo_u32 v5, s47, v5
buffer_load_ushort v12, v4, s[24:27], s46 offen
buffer_load_ushort v13, v4, s[28:31], s46 offen
buffer_load_ushort v14, v5, s[24:27], s46 offen
buffer_load_ushort v15, v5, s[28:31], s46 offen
v_add_u32 v4, 32, v2
v_sub_u32 v5, 2048, v4
v_and_b32 v5, 2047, v5
v_mul_lo_u32 v4, s47, v4
v_mul_lo_u32 v5, s47, v5
buffer_load_ushort v16, v4, s[24:27], s46 offen
buffer_load_ushort v17, v4, s[28:31], s46 offen
buffer_load_ushort v18, v5, s[24:27], s46 offen
buffer_load_ushort v19, v5, s[28:31], s46 offen
v_add_u32 v4, 1056, v2
v_sub_u32 v5, 2048, v4
v_and_b32 v5, 2047, v5
v_mul_lo_u32 v4, s47, v4
v_mul_lo_u32 v5, s47, v5
buffer_load_ushort v20, v4, s[24:27], s46 offen
buffer_load_ushort v21, v4, s[28:31], s46 offen
buffer_load_ushort v22, v5, s[24:27], s46 offen
buffer_load_ushort v23, v5, s[28:31], s46 offen
s_sub_u32 s45, 513, s45
s_lshl_b32 s45, s45, 13
s_lshl_b32 s44, s44, 10
s_add_u32 s45, s45, s44
s_add_u32 s45, s45, 25165824
s_add_u32 s32, s18, s45
s_addc_u32 s33, s19, 0
s_mov_b32 s34, 0x400
s_mov_b32 s35, 0x20000
v_lshlrev_b32 v6, 4, v1
s_waitcnt vmcnt(0)
v_lshlrev_b32 v8, 16, v8
v_lshlrev_b32 v9, 16, v9
v_lshlrev_b32 v10, 16, v10
v_lshlrev_b32 v11, 16, v11
v_add_f32 v8, v8, v10
v_sub_f32 v9, v9, v11
v_mul_f32 v8, 0.5, v8
v_mul_f32 v9, 0.5, v9
v_cvt_pk_bf16_f32 v24, v8, v9
v_lshlrev_b32 v12, 16, v12
v_lshlrev_b32 v13, 16, v13
v_lshlrev_b32 v14, 16, v14
v_lshlrev_b32 v15, 16, v15
v_add_f32 v12, v12, v14
v_sub_f32 v13, v13, v15
v_mul_f32 v12, 0.5, v12
v_mul_f32 v13, 0.5, v13
v_cvt_pk_bf16_f32 v25, v12, v13
v_lshlrev_b32 v16, 16, v16
v_lshlrev_b32 v17, 16, v17
v_lshlrev_b32 v18, 16, v18
v_lshlrev_b32 v19, 16, v19
v_add_f32 v16, v16, v18
v_sub_f32 v17, v17, v19
v_mul_f32 v16, 0.5, v16
v_mul_f32 v17, 0.5, v17
v_cvt_pk_bf16_f32 v26, v16, v17
v_lshlrev_b32 v20, 16, v20
v_lshlrev_b32 v21, 16, v21
v_lshlrev_b32 v22, 16, v22
v_lshlrev_b32 v23, 16, v23
v_add_f32 v20, v20, v22
v_sub_f32 v21, v21, v23
v_mul_f32 v20, 0.5, v20
v_mul_f32 v21, 0.5, v21
v_cvt_pk_bf16_f32 v27, v20, v21
buffer_store_dwordx4 v[24:27], v6, s[32:35], 0 offen
L_wt_kernel_fin:
L_wt_kernel_end:
s_endpgm
.globl a2_kernel
.p2align 8
.type a2_kernel,@function
a2_kernel:
s_cmp_ge_u32 s2, 257
s_cbranch_scc1 L_a2_kernel_end
v_lshrrev_b32 v2, 6, v0
v_and_b32 v1, 63, v0
v_readfirstlane_b32 s20, v2
s_load_dwordx2 s[18:19], s[0:1], 112
s_getpc_b64 s[52:53]
L_pc3:
s_add_u32 s52, s52, tables-L_pc3
s_addc_u32 s53, s53, 0
s_and_b32 s44, s2, 7
s_lshr_b32 s45, s2, 3
s_lshl_b32 s44, s44, 5
s_add_u32 s44, s44, s45
s_cmp_eq_u32 s2, 256
s_cselect_b32 s44, 256, s44
s_lshl_b32 s22, s44, 1
s_add_u32 s22, s22, s20
s_waitcnt lgkmcnt(0)
s_cmp_gt_u32 s22, 512
s_cbranch_scc1 L_a2_kernel_fin
s_add_u32 s24, s18, 16777216
s_addc_u32 s25, s19, 0
s_mov_b32 s26, 0x400000
s_mov_b32 s27, 0x20000
s_add_u32 s28, s18, 20971520
s_addc_u32 s29, s19, 0
s_mov_b32 s30, 0x400000
s_mov_b32 s31, 0x20000
s_cmp_eq_u32 s22, 0
s_cselect_b32 s44, 513, s22
s_lshl_b32 s44, s44, 13
s_add_u32 s44, s44, 25165824
s_add_u32 s32, s18, s44
s_addc_u32 s33, s19, 0
s_mov_b32 s34, 0x2000
s_mov_b32 s35, 0x20000
v_and_b32 v2, 31, v1
v_lshlrev_b32 v2, 14, v2
v_lshrrev_b32 v3, 5, v1
v_lshl_add_u32 v2, v3, 19, v2
s_lshl_b32 s44, s22, 4
s_sub_u32 s45, 1024, s22
s_and_b32 s45, s45, 1023
s_lshl_b32 s45, s45, 4
v_add_u32 v3, s45, v2
v_add_u32 v2, s44, v2
s_mov_b32 s48, 0
buffer_load_dwordx4 v[8:11], v2, s[24:27], s48 offen
buffer_load_dwordx4 v[24:27], v3, s[24:27], s48 offen
s_mov_b32 s48, 1048576
buffer_load_dwordx4 v[12:15], v2, s[24:27], s48 offen
buffer_load_dwordx4 v[28:31], v3, s[24:27], s48 offen
s_mov_b32 s48, 2097152
buffer_load_dwordx4 v[16:19], v2, s[24:27], s48 offen
buffer_load_dwordx4 v[32:35], v3, s[24:27], s48 offen
s_mov_b32 s48, 3145728
buffer_load_dwordx4 v[20:23], v2, s[24:27], s48 offen
buffer_load_dwordx4 v[36:39], v3, s[24:27], s48 offen
v_lshlrev_b32 v4, 4, v1
v_add_u32 v5, 2048, v4
global_load_dwordx4 v[192:195], v5, s[52:53] offset:0
global_load_dwordx4 v[196:199], v5, s[52:53] offset:1024
global_load_dwordx4 v[200:203], v5, s[52:53] offset:2048
global_load_dwordx4 v[204:207], v5, s[52:53] offset:3072
v_add_u32 v5, 6144, v4
global_load_dwordx4 v[208:211], v5, s[52:53] offset:0
global_load_dwordx4 v[212:215], v5, s[52:53] offset:1024
global_load_dwordx4 v[216:219], v5, s[52:53] offset:2048
global_load_dwordx4 v[220:223], v5, s[52:53] offset:3072
v_add_u32 v5, 10240, v4
global_load_dwordx4 v[224:227], v5, s[52:53] offset:0
global_load_dwordx4 v[228:231], v5, s[52:53] offset:1024
global_load_dwordx4 v[232:235], v5, s[52:53] offset:2048
global_load_dwordx4 v[236:239], v5, s[52:53] offset:3072
v_add_u32 v5, 14336, v4
global_load_dwordx4 v[240:243], v5, s[52:53] offset:0
global_load_dwordx4 v[244:247], v5, s[52:53] offset:1024
global_load_dwordx4 v[248:251], v5, s[52:53] offset:2048
global_load_dwordx4 v[252:255], v5, s[52:53] offset:3072
v_add_u32 v5, 18432, v4
global_load_dwordx4 v[136:139], v5, s[52:53] offset:0
global_load_dwordx4 v[140:143], v5, s[52:53] offset:1024
global_load_dwordx4 v[144:147], v5, s[52:53] offset:2048
global_load_dwordx4 v[148:151], v5, s[52:53] offset:3072
v_add_u32 v5, 22528, v4
global_load_dwordx4 v[152:155], v5, s[52:53] offset:0
global_load_dwordx4 v[156:159], v5, s[52:53] offset:1024
global_load_dwordx4 v[160:163], v5, s[52:53] offset:2048
global_load_dwordx4 v[164:167], v5, s[52:53] offset:3072
s_mov_b32 s48, 0
buffer_load_dwordx4 v[104:107], v4, s[32:35], s48 offen offset:0
buffer_load_dwordx4 v[108:111], v4, s[32:35], s48 offen offset:1024
buffer_load_dwordx4 v[112:115], v4, s[32:35], s48 offen offset:2048
buffer_load_dwordx4 v[116:119], v4, s[32:35], s48 offen offset:3072
s_mov_b32 s48, 4096
buffer_load_dwordx4 v[120:123], v4, s[32:35], s48 offen offset:0
buffer_load_dwordx4 v[124:127], v4, s[32:35], s48 offen offset:1024
buffer_load_dwordx4 v[128:131], v4, s[32:35], s48 offen offset:2048
buffer_load_dwordx4 v[132:135], v4, s[32:35], s48 offen offset:3072
s_waitcnt vmcnt(24)
v_xor_b32 v24, 0x80000000, v24
v_xor_b32 v25, 0x80000000, v25
v_xor_b32 v26, 0x80000000, v26
v_xor_b32 v27, 0x80000000, v27
v_xor_b32 v28, 0x80000000, v28
v_xor_b32 v29, 0x80000000, v29
v_xor_b32 v30, 0x80000000, v30
v_xor_b32 v31, 0x80000000, v31
v_xor_b32 v32, 0x80000000, v32
v_xor_b32 v33, 0x80000000, v33
v_xor_b32 v34, 0x80000000, v34
v_xor_b32 v35, 0x80000000, v35
v_xor_b32 v36, 0x80000000, v36
v_xor_b32 v37, 0x80000000, v37
v_xor_b32 v38, 0x80000000, v38
v_xor_b32 v39, 0x80000000, v39
v_mfma_f32_32x32x16_bf16 v[40:55], v[8:11], v[192:195], 0
v_mfma_f32_32x32x16_bf16 v[40:55], v[12:15], v[196:199], v[40:55]
v_mfma_f32_32x32x16_bf16 v[40:55], v[16:19], v[200:203], v[40:55]
v_mfma_f32_32x32x16_bf16 v[40:55], v[20:23], v[204:207], v[40:55]
v_mfma_f32_32x32x16_bf16 v[56:71], v[8:11], v[208:211], 0
v_mfma_f32_32x32x16_bf16 v[56:71], v[12:15], v[212:215], v[56:71]
v_mfma_f32_32x32x16_bf16 v[56:71], v[16:19], v[216:219], v[56:71]
v_mfma_f32_32x32x16_bf16 v[56:71], v[20:23], v[220:223], v[56:71]
v_mfma_f32_32x32x16_bf16 v[72:87], v[24:27], v[192:195], 0
v_mfma_f32_32x32x16_bf16 v[72:87], v[28:31], v[196:199], v[72:87]
v_mfma_f32_32x32x16_bf16 v[72:87], v[32:35], v[200:203], v[72:87]
v_mfma_f32_32x32x16_bf16 v[72:87], v[36:39], v[204:207], v[72:87]
v_mfma_f32_32x32x16_bf16 v[88:103], v[24:27], v[208:211], 0
v_mfma_f32_32x32x16_bf16 v[88:103], v[28:31], v[212:215], v[88:103]
v_mfma_f32_32x32x16_bf16 v[88:103], v[32:35], v[216:219], v[88:103]
v_mfma_f32_32x32x16_bf16 v[88:103], v[36:39], v[220:223], v[88:103]
s_waitcnt vmcnt(16)
v_pk_mul_f32 v[168:169], v[40:41], v[224:225]
v_pk_mul_f32 v[170:171], v[40:41], v[240:241]
s_nop 0
v_pk_fma_f32 v[168:169], v[56:57], v[240:241], v[168:169] neg_lo:[1,0,0] neg_hi:[1,0,0]
v_pk_fma_f32 v[170:171], v[56:57], v[224:225], v[170:171]
v_cvt_pk_bf16_f32 v8, v168, v170
v_cvt_pk_bf16_f32 v9, v169, v171
v_pk_mul_f32 v[172:173], v[42:43], v[226:227]
v_pk_mul_f32 v[174:175], v[42:43], v[242:243]
v_pk_fma_f32 v[172:173], v[58:59], v[242:243], v[172:173] neg_lo:[1,0,0] neg_hi:[1,0,0]
v_pk_fma_f32 v[174:175], v[58:59], v[226:227], v[174:175]
v_cvt_pk_bf16_f32 v10, v172, v174
v_cvt_pk_bf16_f32 v11, v173, v175
v_pk_mul_f32 v[168:169], v[44:45], v[228:229]
v_pk_mul_f32 v[170:171], v[44:45], v[244:245]
v_pk_fma_f32 v[168:169], v[60:61], v[244:245], v[168:169] neg_lo:[1,0,0] neg_hi:[1,0,0]
v_pk_fma_f32 v[170:171], v[60:61], v[228:229], v[170:171]
v_cvt_pk_bf16_f32 v12, v168, v170
v_cvt_pk_bf16_f32 v13, v169, v171
v_pk_mul_f32 v[172:173], v[46:47], v[230:231]
v_pk_mul_f32 v[174:175], v[46:47], v[246:247]
v_pk_fma_f32 v[172:173], v[62:63], v[246:247], v[172:173] neg_lo:[1,0,0] neg_hi:[1,0,0]
v_pk_fma_f32 v[174:175], v[62:63], v[230:231], v[174:175]
v_cvt_pk_bf16_f32 v14, v172, v174
v_cvt_pk_bf16_f32 v15, v173, v175
v_pk_mul_f32 v[168:169], v[48:49], v[232:233]
v_pk_mul_f32 v[170:171], v[48:49], v[248:249]
v_pk_fma_f32 v[168:169], v[64:65], v[248:249], v[168:169] neg_lo:[1,0,0] neg_hi:[1,0,0]
v_pk_fma_f32 v[170:171], v[64:65], v[232:233], v[170:171]
v_cvt_pk_bf16_f32 v16, v168, v170
v_cvt_pk_bf16_f32 v17, v169, v171
v_pk_mul_f32 v[172:173], v[50:51], v[234:235]
v_pk_mul_f32 v[174:175], v[50:51], v[250:251]
v_pk_fma_f32 v[172:173], v[66:67], v[250:251], v[172:173] neg_lo:[1,0,0] neg_hi:[1,0,0]
v_pk_fma_f32 v[174:175], v[66:67], v[234:235], v[174:175]
v_cvt_pk_bf16_f32 v18, v172, v174
v_cvt_pk_bf16_f32 v19, v173, v175
v_pk_mul_f32 v[168:169], v[52:53], v[236:237]
v_pk_mul_f32 v[170:171], v[52:53], v[252:253]
v_pk_fma_f32 v[168:169], v[68:69], v[252:253], v[168:169] neg_lo:[1,0,0] neg_hi:[1,0,0]
v_pk_fma_f32 v[170:171], v[68:69], v[236:237], v[170:171]
v_cvt_pk_bf16_f32 v20, v168, v170
v_cvt_pk_bf16_f32 v21, v169, v171
v_pk_mul_f32 v[172:173], v[54:55], v[238:239]
v_pk_mul_f32 v[174:175], v[54:55], v[254:255]
v_pk_fma_f32 v[172:173], v[70:71], v[254:255], v[172:173] neg_lo:[1,0,0] neg_hi:[1,0,0]
v_pk_fma_f32 v[174:175], v[70:71], v[238:239], v[174:175]
v_cvt_pk_bf16_f32 v22, v172, v174
v_cvt_pk_bf16_f32 v23, v173, v175
v_mfma_f32_32x32x16_bf16 v[40:55], v[192:195], v[8:11], 0
v_mfma_f32_32x32x16_bf16 v[40:55], v[196:199], v[12:15], v[40:55]
v_mfma_f32_32x32x16_bf16 v[40:55], v[200:203], v[16:19], v[40:55]
v_mfma_f32_32x32x16_bf16 v[40:55], v[204:207], v[20:23], v[40:55]
v_mfma_f32_32x32x16_bf16 v[56:71], v[208:211], v[8:11], 0
v_mfma_f32_32x32x16_bf16 v[56:71], v[212:215], v[12:15], v[56:71]
v_mfma_f32_32x32x16_bf16 v[56:71], v[216:219], v[16:19], v[56:71]
v_mfma_f32_32x32x16_bf16 v[56:71], v[220:223], v[20:23], v[56:71]
v_pk_mul_f32 v[168:169], v[72:73], v[224:225]
v_pk_mul_f32 v[170:171], v[72:73], v[240:241]
v_pk_fma_f32 v[168:169], v[88:89], v[240:241], v[168:169] neg_lo:[1,0,0] neg_hi:[1,0,0]
v_pk_fma_f32 v[170:171], v[88:89], v[224:225], v[170:171]
v_cvt_pk_bf16_f32 v24, v168, v170
v_cvt_pk_bf16_f32 v25, v169, v171
v_pk_mul_f32 v[172:173], v[74:75], v[226:227]
v_pk_mul_f32 v[174:175], v[74:75], v[242:243]
v_pk_fma_f32 v[172:173], v[90:91], v[242:243], v[172:173] neg_lo:[1,0,0] neg_hi:[1,0,0]
v_pk_fma_f32 v[174:175], v[90:91], v[226:227], v[174:175]
v_cvt_pk_bf16_f32 v26, v172, v174
v_cvt_pk_bf16_f32 v27, v173, v175
v_pk_mul_f32 v[168:169], v[76:77], v[228:229]
v_pk_mul_f32 v[170:171], v[76:77], v[244:245]
v_pk_fma_f32 v[168:169], v[92:93], v[244:245], v[168:169] neg_lo:[1,0,0] neg_hi:[1,0,0]
v_pk_fma_f32 v[170:171], v[92:93], v[228:229], v[170:171]
v_cvt_pk_bf16_f32 v28, v168, v170
v_cvt_pk_bf16_f32 v29, v169, v171
v_pk_mul_f32 v[172:173], v[78:79], v[230:231]
v_pk_mul_f32 v[174:175], v[78:79], v[246:247]
v_pk_fma_f32 v[172:173], v[94:95], v[246:247], v[172:173] neg_lo:[1,0,0] neg_hi:[1,0,0]
v_pk_fma_f32 v[174:175], v[94:95], v[230:231], v[174:175]
v_cvt_pk_bf16_f32 v30, v172, v174
v_cvt_pk_bf16_f32 v31, v173, v175
v_pk_mul_f32 v[168:169], v[80:81], v[232:233]
v_pk_mul_f32 v[170:171], v[80:81], v[248:249]
v_pk_fma_f32 v[168:169], v[96:97], v[248:249], v[168:169] neg_lo:[1,0,0] neg_hi:[1,0,0]
v_pk_fma_f32 v[170:171], v[96:97], v[232:233], v[170:171]
v_cvt_pk_bf16_f32 v32, v168, v170
v_cvt_pk_bf16_f32 v33, v169, v171
v_pk_mul_f32 v[172:173], v[82:83], v[234:235]
v_pk_mul_f32 v[174:175], v[82:83], v[250:251]
v_pk_fma_f32 v[172:173], v[98:99], v[250:251], v[172:173] neg_lo:[1,0,0] neg_hi:[1,0,0]
v_pk_fma_f32 v[174:175], v[98:99], v[234:235], v[174:175]
v_cvt_pk_bf16_f32 v34, v172, v174
v_cvt_pk_bf16_f32 v35, v173, v175
v_pk_mul_f32 v[168:169], v[84:85], v[236:237]
v_pk_mul_f32 v[170:171], v[84:85], v[252:253]
v_pk_fma_f32 v[168:169], v[100:101], v[252:253], v[168:169] neg_lo:[1,0,0] neg_hi:[1,0,0]
v_pk_fma_f32 v[170:171], v[100:101], v[236:237], v[170:171]
v_cvt_pk_bf16_f32 v36, v168, v170
v_cvt_pk_bf16_f32 v37, v169, v171
v_pk_mul_f32 v[172:173], v[86:87], v[238:239]
v_pk_mul_f32 v[174:175], v[86:87], v[254:255]
v_pk_fma_f32 v[172:173], v[102:103], v[254:255], v[172:173] neg_lo:[1,0,0] neg_hi:[1,0,0]
v_pk_fma_f32 v[174:175], v[102:103], v[238:239], v[174:175]
v_cvt_pk_bf16_f32 v38, v172, v174
v_cvt_pk_bf16_f32 v39, v173, v175
v_mfma_f32_32x32x16_bf16 v[72:87], v[192:195], v[24:27], 0
v_mfma_f32_32x32x16_bf16 v[72:87], v[196:199], v[28:31], v[72:87]
v_mfma_f32_32x32x16_bf16 v[72:87], v[200:203], v[32:35], v[72:87]
v_mfma_f32_32x32x16_bf16 v[72:87], v[204:207], v[36:39], v[72:87]
v_mfma_f32_32x32x16_bf16 v[88:103], v[208:211], v[24:27], 0
v_mfma_f32_32x32x16_bf16 v[88:103], v[212:215], v[28:31], v[88:103]
v_mfma_f32_32x32x16_bf16 v[88:103], v[216:219], v[32:35], v[88:103]
v_mfma_f32_32x32x16_bf16 v[88:103], v[220:223], v[36:39], v[88:103]
s_waitcnt vmcnt(0)
v_lshlrev_b32 v168, 16, v104
v_and_b32 v170, 0xffff0000, v104
v_lshlrev_b32 v172, 16, v105
v_and_b32 v174, 0xffff0000, v105
v_lshlrev_b32 v169, 16, v106
v_and_b32 v171, 0xffff0000, v106
v_lshlrev_b32 v173, 16, v107
v_and_b32 v175, 0xffff0000, v107
v_pk_add_f32 v[176:177], v[168:169], v[172:173]
v_pk_add_f32 v[178:179], v[170:171], v[174:175]
v_pk_add_f32 v[168:169], v[168:169], v[172:173] neg_lo:[0,1] neg_hi:[0,1]
v_pk_add_f32 v[170:171], v[170:171], v[174:175] neg_lo:[0,1] neg_hi:[0,1]
v_pk_mul_f32 v[172:173], v[152:153], v[40:41]
v_pk_mul_f32 v[174:175], v[152:153], v[56:57]
v_pk_mul_f32 v[180:181], v[152:153], v[72:73]
v_pk_mul_f32 v[182:183], v[152:153], v[88:89]
v_pk_fma_f32 v[172:173], v[136:137], v[88:89], v[172:173] neg_lo:[1,0,0] neg_hi:[1,0,0]
v_pk_fma_f32 v[174:175], v[136:137], v[72:73], v[174:175]
v_pk_fma_f32 v[180:181], v[136:137], v[56:57], v[180:181] neg_lo:[1,0,0] neg_hi:[1,0,0]
v_pk_fma_f32 v[182:183], v[136:137], v[40:41], v[182:183]
v_pk_mul_f32 v[184:185], v[176:177], v[40:41]
v_pk_mul_f32 v[186:187], v[176:177], v[56:57]
v_pk_mul_f32 v[188:189], v[176:177], v[72:73]
v_pk_mul_f32 v[190:191], v[176:177], v[88:89]
v_pk_fma_f32 v[184:185], v[178:179], v[56:57], v[184:185] neg_lo:[1,0,0] neg_hi:[1,0,0]
v_pk_fma_f32 v[186:187], v[178:179], v[40:41], v[186:187]
v_pk_fma_f32 v[188:189], v[178:179], v[88:89], v[188:189] neg_lo:[1,0,0] neg_hi:[1,0,0]
v_pk_fma_f32 v[190:191], v[178:179], v[72:73], v[190:191]
v_pk_fma_f32 v[184:185], v[168:169], v[172:173], v[184:185]
v_pk_fma_f32 v[186:187], v[168:169], v[174:175], v[186:187]
v_pk_fma_f32 v[188:189], v[168:169], v[180:181], v[188:189] neg_lo:[1,0,0] neg_hi:[1,0,0]
v_pk_fma_f32 v[190:191], v[168:169], v[182:183], v[190:191] neg_lo:[1,0,0] neg_hi:[1,0,0]
v_pk_fma_f32 v[184:185], v[170:171], v[174:175], v[184:185] neg_lo:[1,0,0] neg_hi:[1,0,0]
v_pk_fma_f32 v[186:187], v[170:171], v[172:173], v[186:187]
v_pk_fma_f32 v[188:189], v[170:171], v[182:183], v[188:189]
v_pk_fma_f32 v[190:191], v[170:171], v[180:181], v[190:191] neg_lo:[1,0,0] neg_hi:[1,0,0]
v_cvt_pk_bf16_f32 v8, v186, v184
v_cvt_pk_bf16_f32 v24, v190, v188
v_cvt_pk_bf16_f32 v9, v187, v185
v_cvt_pk_bf16_f32 v25, v191, v189
v_lshlrev_b32 v168, 16, v108
v_and_b32 v170, 0xffff0000, v108
v_lshlrev_b32 v172, 16, v109
v_and_b32 v174, 0xffff0000, v109
v_lshlrev_b32 v169, 16, v110
v_and_b32 v171, 0xffff0000, v110
v_lshlrev_b32 v173, 16, v111
v_and_b32 v175, 0xffff0000, v111
v_pk_add_f32 v[176:177], v[168:169], v[172:173]
v_pk_add_f32 v[178:179], v[170:171], v[174:175]
v_pk_add_f32 v[168:169], v[168:169], v[172:173] neg_lo:[0,1] neg_hi:[0,1]
v_pk_add_f32 v[170:171], v[170:171], v[174:175] neg_lo:[0,1] neg_hi:[0,1]
v_pk_mul_f32 v[172:173], v[154:155], v[42:43]
v_pk_mul_f32 v[174:175], v[154:155], v[58:59]
v_pk_mul_f32 v[180:181], v[154:155], v[74:75]
v_pk_mul_f32 v[182:183], v[154:155], v[90:91]
v_pk_fma_f32 v[172:173], v[138:139], v[90:91], v[172:173] neg_lo:[1,0,0] neg_hi:[1,0,0]
v_pk_fma_f32 v[174:175], v[138:139], v[74:75], v[174:175]
v_pk_fma_f32 v[180:181], v[138:139], v[58:59], v[180:181] neg_lo:[1,0,0] neg_hi:[1,0,0]
v_pk_fma_f32 v[182:183], v[138:139], v[42:43], v[182:183]
v_pk_mul_f32 v[184:185], v[176:177], v[42:43]
v_pk_mul_f32 v[186:187], v[176:177], v[58:59]
v_pk_mul_f32 v[188:189], v[176:177], v[74:75]
v_pk_mul_f32 v[190:191], v[176:177], v[90:91]
v_pk_fma_f32 v[184:185], v[178:179], v[58:59], v[184:185] neg_lo:[1,0,0] neg_hi:[1,0,0]
v_pk_fma_f32 v[186:187], v[178:179], v[42:43], v[186:187]
v_pk_fma_f32 v[188:189], v[178:179], v[90:91], v[188:189] neg_lo:[1,0,0] neg_hi:[1,0,0]
v_pk_fma_f32 v[190:191], v[178:179], v[74:75], v[190:191]
v_pk_fma_f32 v[184:185], v[168:169], v[172:173], v[184:185]
v_pk_fma_f32 v[186:187], v[168:169], v[174:175], v[186:187]
v_pk_fma_f32 v[188:189], v[168:169], v[180:181], v[188:189] neg_lo:[1,0,0] neg_hi:[1,0,0]
v_pk_fma_f32 v[190:191], v[168:169], v[182:183], v[190:191] neg_lo:[1,0,0] neg_hi:[1,0,0]
v_pk_fma_f32 v[184:185], v[170:171], v[174:175], v[184:185] neg_lo:[1,0,0] neg_hi:[1,0,0]
v_pk_fma_f32 v[186:187], v[170:171], v[172:173], v[186:187]
v_pk_fma_f32 v[188:189], v[170:171], v[182:183], v[188:189]
v_pk_fma_f32 v[190:191], v[170:171], v[180:181], v[190:191] neg_lo:[1,0,0] neg_hi:[1,0,0]
v_cvt_pk_bf16_f32 v10, v186, v184
v_cvt_pk_bf16_f32 v26, v190, v188
v_cvt_pk_bf16_f32 v11, v187, v185
v_cvt_pk_bf16_f32 v27, v191, v189
v_lshlrev_b32 v168, 16, v112
v_and_b32 v170, 0xffff0000, v112
v_lshlrev_b32 v172, 16, v113
v_and_b32 v174, 0xffff0000, v113
v_lshlrev_b32 v169, 16, v114
v_and_b32 v171, 0xffff0000, v114
v_lshlrev_b32 v173, 16, v115
v_and_b32 v175, 0xffff0000, v115
v_pk_add_f32 v[176:177], v[168:169], v[172:173]
v_pk_add_f32 v[178:179], v[170:171], v[174:175]
v_pk_add_f32 v[168:169], v[168:169], v[172:173] neg_lo:[0,1] neg_hi:[0,1]
v_pk_add_f32 v[170:171], v[170:171], v[174:175] neg_lo:[0,1] neg_hi:[0,1]
v_pk_mul_f32 v[172:173], v[156:157], v[44:45]
v_pk_mul_f32 v[174:175], v[156:157], v[60:61]
v_pk_mul_f32 v[180:181], v[156:157], v[76:77]
v_pk_mul_f32 v[182:183], v[156:157], v[92:93]
v_pk_fma_f32 v[172:173], v[140:141], v[92:93], v[172:173] neg_lo:[1,0,0] neg_hi:[1,0,0]
v_pk_fma_f32 v[174:175], v[140:141], v[76:77], v[174:175]
v_pk_fma_f32 v[180:181], v[140:141], v[60:61], v[180:181] neg_lo:[1,0,0] neg_hi:[1,0,0]
v_pk_fma_f32 v[182:183], v[140:141], v[44:45], v[182:183]
v_pk_mul_f32 v[184:185], v[176:177], v[44:45]
v_pk_mul_f32 v[186:187], v[176:177], v[60:61]
v_pk_mul_f32 v[188:189], v[176:177], v[76:77]
v_pk_mul_f32 v[190:191], v[176:177], v[92:93]
v_pk_fma_f32 v[184:185], v[178:179], v[60:61], v[184:185] neg_lo:[1,0,0] neg_hi:[1,0,0]
v_pk_fma_f32 v[186:187], v[178:179], v[44:45], v[186:187]
v_pk_fma_f32 v[188:189], v[178:179], v[92:93], v[188:189] neg_lo:[1,0,0] neg_hi:[1,0,0]
v_pk_fma_f32 v[190:191], v[178:179], v[76:77], v[190:191]
v_pk_fma_f32 v[184:185], v[168:169], v[172:173], v[184:185]
v_pk_fma_f32 v[186:187], v[168:169], v[174:175], v[186:187]
v_pk_fma_f32 v[188:189], v[168:169], v[180:181], v[188:189] neg_lo:[1,0,0] neg_hi:[1,0,0]
v_pk_fma_f32 v[190:191], v[168:169], v[182:183], v[190:191] neg_lo:[1,0,0] neg_hi:[1,0,0]
v_pk_fma_f32 v[184:185], v[170:171], v[174:175], v[184:185] neg_lo:[1,0,0] neg_hi:[1,0,0]
v_pk_fma_f32 v[186:187], v[170:171], v[172:173], v[186:187]
v_pk_fma_f32 v[188:189], v[170:171], v[182:183], v[188:189]
v_pk_fma_f32 v[190:191], v[170:171], v[180:181], v[190:191] neg_lo:[1,0,0] neg_hi:[1,0,0]
v_cvt_pk_bf16_f32 v12, v186, v184
v_cvt_pk_bf16_f32 v28, v190, v188
v_cvt_pk_bf16_f32 v13, v187, v185
v_cvt_pk_bf16_f32 v29, v191, v189
v_lshlrev_b32 v168, 16, v116
v_and_b32 v170, 0xffff0000, v116
v_lshlrev_b32 v172, 16, v117
v_and_b32 v174, 0xffff0000, v117
v_lshlrev_b32 v169, 16, v118
v_and_b32 v171, 0xffff0000, v118
v_lshlrev_b32 v173, 16, v119
v_and_b32 v175, 0xffff0000, v119
v_pk_add_f32 v[176:177], v[168:169], v[172:173]
v_pk_add_f32 v[178:179], v[170:171], v[174:175]
v_pk_add_f32 v[168:169], v[168:169], v[172:173] neg_lo:[0,1] neg_hi:[0,1]
v_pk_add_f32 v[170:171], v[170:171], v[174:175] neg_lo:[0,1] neg_hi:[0,1]
v_pk_mul_f32 v[172:173], v[158:159], v[46:47]
v_pk_mul_f32 v[174:175], v[158:159], v[62:63]
v_pk_mul_f32 v[180:181], v[158:159], v[78:79]
v_pk_mul_f32 v[182:183], v[158:159], v[94:95]
v_pk_fma_f32 v[172:173], v[142:143], v[94:95], v[172:173] neg_lo:[1,0,0] neg_hi:[1,0,0]
v_pk_fma_f32 v[174:175], v[142:143], v[78:79], v[174:175]
v_pk_fma_f32 v[180:181], v[142:143], v[62:63], v[180:181] neg_lo:[1,0,0] neg_hi:[1,0,0]
v_pk_fma_f32 v[182:183], v[142:143], v[46:47], v[182:183]
v_pk_mul_f32 v[184:185], v[176:177], v[46:47]
v_pk_mul_f32 v[186:187], v[176:177], v[62:63]
v_pk_mul_f32 v[188:189], v[176:177], v[78:79]
v_pk_mul_f32 v[190:191], v[176:177], v[94:95]
v_pk_fma_f32 v[184:185], v[178:179], v[62:63], v[184:185] neg_lo:[1,0,0] neg_hi:[1,0,0]
v_pk_fma_f32 v[186:187], v[178:179], v[46:47], v[186:187]
v_pk_fma_f32 v[188:189], v[178:179], v[94:95], v[188:189] neg_lo:[1,0,0] neg_hi:[1,0,0]
v_pk_fma_f32 v[190:191], v[178:179], v[78:79], v[190:191]
v_pk_fma_f32 v[184:185], v[168:169], v[172:173], v[184:185]
v_pk_fma_f32 v[186:187], v[168:169], v[174:175], v[186:187]
v_pk_fma_f32 v[188:189], v[168:169], v[180:181], v[188:189] neg_lo:[1,0,0] neg_hi:[1,0,0]
v_pk_fma_f32 v[190:191], v[168:169], v[182:183], v[190:191] neg_lo:[1,0,0] neg_hi:[1,0,0]
v_pk_fma_f32 v[184:185], v[170:171], v[174:175], v[184:185] neg_lo:[1,0,0] neg_hi:[1,0,0]
v_pk_fma_f32 v[186:187], v[170:171], v[172:173], v[186:187]
v_pk_fma_f32 v[188:189], v[170:171], v[182:183], v[188:189]
v_pk_fma_f32 v[190:191], v[170:171], v[180:181], v[190:191] neg_lo:[1,0,0] neg_hi:[1,0,0]
v_cvt_pk_bf16_f32 v14, v186, v184
v_cvt_pk_bf16_f32 v30, v190, v188
v_cvt_pk_bf16_f32 v15, v187, v185
v_cvt_pk_bf16_f32 v31, v191, v189
v_lshlrev_b32 v168, 16, v120
v_and_b32 v170, 0xffff0000, v120
v_lshlrev_b32 v172, 16, v121
v_and_b32 v174, 0xffff0000, v121
v_lshlrev_b32 v169, 16, v122
v_and_b32 v171, 0xffff0000, v122
v_lshlrev_b32 v173, 16, v123
v_and_b32 v175, 0xffff0000, v123
v_pk_add_f32 v[176:177], v[168:169], v[172:173]
v_pk_add_f32 v[178:179], v[170:171], v[174:175]
v_pk_add_f32 v[168:169], v[168:169], v[172:173] neg_lo:[0,1] neg_hi:[0,1]
v_pk_add_f32 v[170:171], v[170:171], v[174:175] neg_lo:[0,1] neg_hi:[0,1]
v_pk_mul_f32 v[172:173], v[160:161], v[48:49]
v_pk_mul_f32 v[174:175], v[160:161], v[64:65]
v_pk_mul_f32 v[180:181], v[160:161], v[80:81]
v_pk_mul_f32 v[182:183], v[160:161], v[96:97]
v_pk_fma_f32 v[172:173], v[144:145], v[96:97], v[172:173] neg_lo:[1,0,0] neg_hi:[1,0,0]
v_pk_fma_f32 v[174:175], v[144:145], v[80:81], v[174:175]
v_pk_fma_f32 v[180:181], v[144:145], v[64:65], v[180:181] neg_lo:[1,0,0] neg_hi:[1,0,0]
v_pk_fma_f32 v[182:183], v[144:145], v[48:49], v[182:183]
v_pk_mul_f32 v[184:185], v[176:177], v[48:49]
v_pk_mul_f32 v[186:187], v[176:177], v[64:65]
v_pk_mul_f32 v[188:189], v[176:177], v[80:81]
v_pk_mul_f32 v[190:191], v[176:177], v[96:97]
v_pk_fma_f32 v[184:185], v[178:179], v[64:65], v[184:185] neg_lo:[1,0,0] neg_hi:[1,0,0]
v_pk_fma_f32 v[186:187], v[178:179], v[48:49], v[186:187]
v_pk_fma_f32 v[188:189], v[178:179], v[96:97], v[188:189] neg_lo:[1,0,0] neg_hi:[1,0,0]
v_pk_fma_f32 v[190:191], v[178:179], v[80:81], v[190:191]
v_pk_fma_f32 v[184:185], v[168:169], v[172:173], v[184:185]
v_pk_fma_f32 v[186:187], v[168:169], v[174:175], v[186:187]
v_pk_fma_f32 v[188:189], v[168:169], v[180:181], v[188:189] neg_lo:[1,0,0] neg_hi:[1,0,0]
v_pk_fma_f32 v[190:191], v[168:169], v[182:183], v[190:191] neg_lo:[1,0,0] neg_hi:[1,0,0]
v_pk_fma_f32 v[184:185], v[170:171], v[174:175], v[184:185] neg_lo:[1,0,0] neg_hi:[1,0,0]
v_pk_fma_f32 v[186:187], v[170:171], v[172:173], v[186:187]
v_pk_fma_f32 v[188:189], v[170:171], v[182:183], v[188:189]
v_pk_fma_f32 v[190:191], v[170:171], v[180:181], v[190:191] neg_lo:[1,0,0] neg_hi:[1,0,0]
v_cvt_pk_bf16_f32 v16, v186, v184
v_cvt_pk_bf16_f32 v32, v190, v188
v_cvt_pk_bf16_f32 v17, v187, v185
v_cvt_pk_bf16_f32 v33, v191, v189
v_lshlrev_b32 v168, 16, v124
v_and_b32 v170, 0xffff0000, v124
v_lshlrev_b32 v172, 16, v125
v_and_b32 v174, 0xffff0000, v125
v_lshlrev_b32 v169, 16, v126
v_and_b32 v171, 0xffff0000, v126
v_lshlrev_b32 v173, 16, v127
v_and_b32 v175, 0xffff0000, v127
v_pk_add_f32 v[176:177], v[168:169], v[172:173]
v_pk_add_f32 v[178:179], v[170:171], v[174:175]
v_pk_add_f32 v[168:169], v[168:169], v[172:173] neg_lo:[0,1] neg_hi:[0,1]
v_pk_add_f32 v[170:171], v[170:171], v[174:175] neg_lo:[0,1] neg_hi:[0,1]
v_pk_mul_f32 v[172:173], v[162:163], v[50:51]
v_pk_mul_f32 v[174:175], v[162:163], v[66:67]
v_pk_mul_f32 v[180:181], v[162:163], v[82:83]
v_pk_mul_f32 v[182:183], v[162:163], v[98:99]
v_pk_fma_f32 v[172:173], v[146:147], v[98:99], v[172:173] neg_lo:[1,0,0] neg_hi:[1,0,0]
v_pk_fma_f32 v[174:175], v[146:147], v[82:83], v[174:175]
v_pk_fma_f32 v[180:181], v[146:147], v[66:67], v[180:181] neg_lo:[1,0,0] neg_hi:[1,0,0]
v_pk_fma_f32 v[182:183], v[146:147], v[50:51], v[182:183]
v_pk_mul_f32 v[184:185], v[176:177], v[50:51]
v_pk_mul_f32 v[186:187], v[176:177], v[66:67]
v_pk_mul_f32 v[188:189], v[176:177], v[82:83]
v_pk_mul_f32 v[190:191], v[176:177], v[98:99]
v_pk_fma_f32 v[184:185], v[178:179], v[66:67], v[184:185] neg_lo:[1,0,0] neg_hi:[1,0,0]
v_pk_fma_f32 v[186:187], v[178:179], v[50:51], v[186:187]
v_pk_fma_f32 v[188:189], v[178:179], v[98:99], v[188:189] neg_lo:[1,0,0] neg_hi:[1,0,0]
v_pk_fma_f32 v[190:191], v[178:179], v[82:83], v[190:191]
v_pk_fma_f32 v[184:185], v[168:169], v[172:173], v[184:185]
v_pk_fma_f32 v[186:187], v[168:169], v[174:175], v[186:187]
v_pk_fma_f32 v[188:189], v[168:169], v[180:181], v[188:189] neg_lo:[1,0,0] neg_hi:[1,0,0]
v_pk_fma_f32 v[190:191], v[168:169], v[182:183], v[190:191] neg_lo:[1,0,0] neg_hi:[1,0,0]
v_pk_fma_f32 v[184:185], v[170:171], v[174:175], v[184:185] neg_lo:[1,0,0] neg_hi:[1,0,0]
v_pk_fma_f32 v[186:187], v[170:171], v[172:173], v[186:187]
v_pk_fma_f32 v[188:189], v[170:171], v[182:183], v[188:189]
v_pk_fma_f32 v[190:191], v[170:171], v[180:181], v[190:191] neg_lo:[1,0,0] neg_hi:[1,0,0]
v_cvt_pk_bf16_f32 v18, v186, v184
v_cvt_pk_bf16_f32 v34, v190, v188
v_cvt_pk_bf16_f32 v19, v187, v185
v_cvt_pk_bf16_f32 v35, v191, v189
v_lshlrev_b32 v168, 16, v128
v_and_b32 v170, 0xffff0000, v128
v_lshlrev_b32 v172, 16, v129
v_and_b32 v174, 0xffff0000, v129
v_lshlrev_b32 v169, 16, v130
v_and_b32 v171, 0xffff0000, v130
v_lshlrev_b32 v173, 16, v131
v_and_b32 v175, 0xffff0000, v131
v_pk_add_f32 v[176:177], v[168:169], v[172:173]
v_pk_add_f32 v[178:179], v[170:171], v[174:175]
v_pk_add_f32 v[168:169], v[168:169], v[172:173] neg_lo:[0,1] neg_hi:[0,1]
v_pk_add_f32 v[170:171], v[170:171], v[174:175] neg_lo:[0,1] neg_hi:[0,1]
v_pk_mul_f32 v[172:173], v[164:165], v[52:53]
v_pk_mul_f32 v[174:175], v[164:165], v[68:69]
v_pk_mul_f32 v[180:181], v[164:165], v[84:85]
v_pk_mul_f32 v[182:183], v[164:165], v[100:101]
v_pk_fma_f32 v[172:173], v[148:149], v[100:101], v[172:173] neg_lo:[1,0,0] neg_hi:[1,0,0]
v_pk_fma_f32 v[174:175], v[148:149], v[84:85], v[174:175]
v_pk_fma_f32 v[180:181], v[148:149], v[68:69], v[180:181] neg_lo:[1,0,0] neg_hi:[1,0,0]
v_pk_fma_f32 v[182:183], v[148:149], v[52:53], v[182:183]
v_pk_mul_f32 v[184:185], v[176:177], v[52:53]
v_pk_mul_f32 v[186:187], v[176:177], v[68:69]
v_pk_mul_f32 v[188:189], v[176:177], v[84:85]
v_pk_mul_f32 v[190:191], v[176:177], v[100:101]
v_pk_fma_f32 v[184:185], v[178:179], v[68:69], v[184:185] neg_lo:[1,0,0] neg_hi:[1,0,0]
v_pk_fma_f32 v[186:187], v[178:179], v[52:53], v[186:187]
v_pk_fma_f32 v[188:189], v[178:179], v[100:101], v[188:189] neg_lo:[1,0,0] neg_hi:[1,0,0]
v_pk_fma_f32 v[190:191], v[178:179], v[84:85], v[190:191]
v_pk_fma_f32 v[184:185], v[168:169], v[172:173], v[184:185]
v_pk_fma_f32 v[186:187], v[168:169], v[174:175], v[186:187]
v_pk_fma_f32 v[188:189], v[168:169], v[180:181], v[188:189] neg_lo:[1,0,0] neg_hi:[1,0,0]
v_pk_fma_f32 v[190:191], v[168:169], v[182:183], v[190:191] neg_lo:[1,0,0] neg_hi:[1,0,0]
v_pk_fma_f32 v[184:185], v[170:171], v[174:175], v[184:185] neg_lo:[1,0,0] neg_hi:[1,0,0]
v_pk_fma_f32 v[186:187], v[170:171], v[172:173], v[186:187]
v_pk_fma_f32 v[188:189], v[170:171], v[182:183], v[188:189]
v_pk_fma_f32 v[190:191], v[170:171], v[180:181], v[190:191] neg_lo:[1,0,0] neg_hi:[1,0,0]
v_cvt_pk_bf16_f32 v20, v186, v184
v_cvt_pk_bf16_f32 v36, v190, v188
v_cvt_pk_bf16_f32 v21, v187, v185
v_cvt_pk_bf16_f32 v37, v191, v189
v_lshlrev_b32 v168, 16, v132
v_and_b32 v170, 0xffff0000, v132
v_lshlrev_b32 v172, 16, v133
v_and_b32 v174, 0xffff0000, v133
v_lshlrev_b32 v169, 16, v134
v_and_b32 v171, 0xffff0000, v134
v_lshlrev_b32 v173, 16, v135
v_and_b32 v175, 0xffff0000, v135
v_pk_add_f32 v[176:177], v[168:169], v[172:173]
v_pk_add_f32 v[178:179], v[170:171], v[174:175]
v_pk_add_f32 v[168:169], v[168:169], v[172:173] neg_lo:[0,1] neg_hi:[0,1]
v_pk_add_f32 v[170:171], v[170:171], v[174:175] neg_lo:[0,1] neg_hi:[0,1]
v_pk_mul_f32 v[172:173], v[166:167], v[54:55]
v_pk_mul_f32 v[174:175], v[166:167], v[70:71]
v_pk_mul_f32 v[180:181], v[166:167], v[86:87]
v_pk_mul_f32 v[182:183], v[166:167], v[102:103]
v_pk_fma_f32 v[172:173], v[150:151], v[102:103], v[172:173] neg_lo:[1,0,0] neg_hi:[1,0,0]
v_pk_fma_f32 v[174:175], v[150:151], v[86:87], v[174:175]
v_pk_fma_f32 v[180:181], v[150:151], v[70:71], v[180:181] neg_lo:[1,0,0] neg_hi:[1,0,0]
v_pk_fma_f32 v[182:183], v[150:151], v[54:55], v[182:183]
v_pk_mul_f32 v[184:185], v[176:177], v[54:55]
v_pk_mul_f32 v[186:187], v[176:177], v[70:71]
v_pk_mul_f32 v[188:189], v[176:177], v[86:87]
v_pk_mul_f32 v[190:191], v[176:177], v[102:103]
v_pk_fma_f32 v[184:185], v[178:179], v[70:71], v[184:185] neg_lo:[1,0,0] neg_hi:[1,0,0]
v_pk_fma_f32 v[186:187], v[178:179], v[54:55], v[186:187]
v_pk_fma_f32 v[188:189], v[178:179], v[102:103], v[188:189] neg_lo:[1,0,0] neg_hi:[1,0,0]
v_pk_fma_f32 v[190:191], v[178:179], v[86:87], v[190:191]
v_pk_fma_f32 v[184:185], v[168:169], v[172:173], v[184:185]
v_pk_fma_f32 v[186:187], v[168:169], v[174:175], v[186:187]
v_pk_fma_f32 v[188:189], v[168:169], v[180:181], v[188:189] neg_lo:[1,0,0] neg_hi:[1,0,0]
v_pk_fma_f32 v[190:191], v[168:169], v[182:183], v[190:191] neg_lo:[1,0,0] neg_hi:[1,0,0]
v_pk_fma_f32 v[184:185], v[170:171], v[174:175], v[184:185] neg_lo:[1,0,0] neg_hi:[1,0,0]
v_pk_fma_f32 v[186:187], v[170:171], v[172:173], v[186:187]
v_pk_fma_f32 v[188:189], v[170:171], v[182:183], v[188:189]
v_pk_fma_f32 v[190:191], v[170:171], v[180:181], v[190:191] neg_lo:[1,0,0] neg_hi:[1,0,0]
v_cvt_pk_bf16_f32 v22, v186, v184
v_cvt_pk_bf16_f32 v38, v190, v188
v_cvt_pk_bf16_f32 v23, v187, v185
v_cvt_pk_bf16_f32 v39, v191, v189
v_mfma_f32_32x32x16_bf16 v[40:55], v[8:11], v[192:195], 0
v_mfma_f32_32x32x16_bf16 v[40:55], v[12:15], v[196:199], v[40:55]
v_mfma_f32_32x32x16_bf16 v[40:55], v[16:19], v[200:203], v[40:55]
v_mfma_f32_32x32x16_bf16 v[40:55], v[20:23], v[204:207], v[40:55]
v_mfma_f32_32x32x16_bf16 v[56:71], v[8:11], v[208:211], 0
v_mfma_f32_32x32x16_bf16 v[56:71], v[12:15], v[212:215], v[56:71]
v_mfma_f32_32x32x16_bf16 v[56:71], v[16:19], v[216:219], v[56:71]
v_mfma_f32_32x32x16_bf16 v[56:71], v[20:23], v[220:223], v[56:71]
v_mfma_f32_32x32x16_bf16 v[72:87], v[24:27], v[192:195], 0
v_mfma_f32_32x32x16_bf16 v[72:87], v[28:31], v[196:199], v[72:87]
v_mfma_f32_32x32x16_bf16 v[72:87], v[32:35], v[200:203], v[72:87]
v_mfma_f32_32x32x16_bf16 v[72:87], v[36:39], v[204:207], v[72:87]
v_mfma_f32_32x32x16_bf16 v[88:103], v[24:27], v[208:211], 0
v_mfma_f32_32x32x16_bf16 v[88:103], v[28:31], v[212:215], v[88:103]
v_mfma_f32_32x32x16_bf16 v[88:103], v[32:35], v[216:219], v[88:103]
v_mfma_f32_32x32x16_bf16 v[88:103], v[36:39], v[220:223], v[88:103]
v_pk_mul_f32 v[168:169], v[40:41], v[224:225]
v_pk_mul_f32 v[170:171], v[40:41], v[240:241]
s_nop 1
v_pk_fma_f32 v[168:169], v[56:57], v[240:241], v[168:169] neg_lo:[1,0,0] neg_hi:[1,0,0]
v_pk_fma_f32 v[170:171], v[56:57], v[224:225], v[170:171]
v_cvt_pk_bf16_f32 v8, v168, v170
v_cvt_pk_bf16_f32 v9, v169, v171
v_pk_mul_f32 v[172:173], v[42:43], v[226:227]
v_pk_mul_f32 v[174:175], v[42:43], v[242:243]
v_pk_fma_f32 v[172:173], v[58:59], v[242:243], v[172:173] neg_lo:[1,0,0] neg_hi:[1,0,0]
v_pk_fma_f32 v[174:175], v[58:59], v[226:227], v[174:175]
v_cvt_pk_bf16_f32 v10, v172, v174
v_cvt_pk_bf16_f32 v11, v173, v175
v_pk_mul_f32 v[168:169], v[44:45], v[228:229]
v_pk_mul_f32 v[170:171], v[44:45], v[244:245]
v_pk_fma_f32 v[168:169], v[60:61], v[244:245], v[168:169] neg_lo:[1,0,0] neg_hi:[1,0,0]
v_pk_fma_f32 v[170:171], v[60:61], v[228:229], v[170:171]
v_cvt_pk_bf16_f32 v12, v168, v170
v_cvt_pk_bf16_f32 v13, v169, v171
v_pk_mul_f32 v[172:173], v[46:47], v[230:231]
v_pk_mul_f32 v[174:175], v[46:47], v[246:247]
v_pk_fma_f32 v[172:173], v[62:63], v[246:247], v[172:173] neg_lo:[1,0,0] neg_hi:[1,0,0]
v_pk_fma_f32 v[174:175], v[62:63], v[230:231], v[174:175]
v_cvt_pk_bf16_f32 v14, v172, v174
v_cvt_pk_bf16_f32 v15, v173, v175
v_pk_mul_f32 v[168:169], v[48:49], v[232:233]
v_pk_mul_f32 v[170:171], v[48:49], v[248:249]
v_pk_fma_f32 v[168:169], v[64:65], v[248:249], v[168:169] neg_lo:[1,0,0] neg_hi:[1,0,0]
v_pk_fma_f32 v[170:171], v[64:65], v[232:233], v[170:171]
v_cvt_pk_bf16_f32 v16, v168, v170
v_cvt_pk_bf16_f32 v17, v169, v171
v_pk_mul_f32 v[172:173], v[50:51], v[234:235]
v_pk_mul_f32 v[174:175], v[50:51], v[250:251]
v_pk_fma_f32 v[172:173], v[66:67], v[250:251], v[172:173] neg_lo:[1,0,0] neg_hi:[1,0,0]
v_pk_fma_f32 v[174:175], v[66:67], v[234:235], v[174:175]
v_cvt_pk_bf16_f32 v18, v172, v174
v_cvt_pk_bf16_f32 v19, v173, v175
v_pk_mul_f32 v[168:169], v[52:53], v[236:237]
v_pk_mul_f32 v[170:171], v[52:53], v[252:253]
v_pk_fma_f32 v[168:169], v[68:69], v[252:253], v[168:169] neg_lo:[1,0,0] neg_hi:[1,0,0]
v_pk_fma_f32 v[170:171], v[68:69], v[236:237], v[170:171]
v_cvt_pk_bf16_f32 v20, v168, v170
v_cvt_pk_bf16_f32 v21, v169, v171
v_pk_mul_f32 v[172:173], v[54:55], v[238:239]
v_pk_mul_f32 v[174:175], v[54:55], v[254:255]
v_pk_fma_f32 v[172:173], v[70:71], v[254:255], v[172:173] neg_lo:[1,0,0] neg_hi:[1,0,0]
v_pk_fma_f32 v[174:175], v[70:71], v[238:239], v[174:175]
v_cvt_pk_bf16_f32 v22, v172, v174
v_cvt_pk_bf16_f32 v23, v173, v175
v_mfma_f32_32x32x16_bf16 v[40:55], v[192:195], v[8:11], 0
v_mfma_f32_32x32x16_bf16 v[40:55], v[196:199], v[12:15], v[40:55]
v_mfma_f32_32x32x16_bf16 v[40:55], v[200:203], v[16:19], v[40:55]
v_mfma_f32_32x32x16_bf16 v[40:55], v[204:207], v[20:23], v[40:55]
v_mfma_f32_32x32x16_bf16 v[56:71], v[208:211], v[8:11], 0
v_mfma_f32_32x32x16_bf16 v[56:71], v[212:215], v[12:15], v[56:71]
v_mfma_f32_32x32x16_bf16 v[56:71], v[216:219], v[16:19], v[56:71]
v_mfma_f32_32x32x16_bf16 v[56:71], v[220:223], v[20:23], v[56:71]
v_pk_mul_f32 v[168:169], v[72:73], v[224:225]
v_pk_mul_f32 v[170:171], v[72:73], v[240:241]
v_pk_fma_f32 v[168:169], v[88:89], v[240:241], v[168:169] neg_lo:[1,0,0] neg_hi:[1,0,0]
v_pk_fma_f32 v[170:171], v[88:89], v[224:225], v[170:171]
v_cvt_pk_bf16_f32 v24, v168, v170
v_cvt_pk_bf16_f32 v25, v169, v171
v_pk_mul_f32 v[172:173], v[74:75], v[226:227]
v_pk_mul_f32 v[174:175], v[74:75], v[242:243]
v_pk_fma_f32 v[172:173], v[90:91], v[242:243], v[172:173] neg_lo:[1,0,0] neg_hi:[1,0,0]
v_pk_fma_f32 v[174:175], v[90:91], v[226:227], v[174:175]
v_cvt_pk_bf16_f32 v26, v172, v174
v_cvt_pk_bf16_f32 v27, v173, v175
v_pk_mul_f32 v[168:169], v[76:77], v[228:229]
v_pk_mul_f32 v[170:171], v[76:77], v[244:245]
v_pk_fma_f32 v[168:169], v[92:93], v[244:245], v[168:169] neg_lo:[1,0,0] neg_hi:[1,0,0]
v_pk_fma_f32 v[170:171], v[92:93], v[228:229], v[170:171]
v_cvt_pk_bf16_f32 v28, v168, v170
v_cvt_pk_bf16_f32 v29, v169, v171
v_pk_mul_f32 v[172:173], v[78:79], v[230:231]
v_pk_mul_f32 v[174:175], v[78:79], v[246:247]
v_pk_fma_f32 v[172:173], v[94:95], v[246:247], v[172:173] neg_lo:[1,0,0] neg_hi:[1,0,0]
v_pk_fma_f32 v[174:175], v[94:95], v[230:231], v[174:175]
v_cvt_pk_bf16_f32 v30, v172, v174
v_cvt_pk_bf16_f32 v31, v173, v175
v_pk_mul_f32 v[168:169], v[80:81], v[232:233]
v_pk_mul_f32 v[170:171], v[80:81], v[248:249]
v_pk_fma_f32 v[168:169], v[96:97], v[248:249], v[168:169] neg_lo:[1,0,0] neg_hi:[1,0,0]
v_pk_fma_f32 v[170:171], v[96:97], v[232:233], v[170:171]
v_cvt_pk_bf16_f32 v32, v168, v170
v_cvt_pk_bf16_f32 v33, v169, v171
v_pk_mul_f32 v[172:173], v[82:83], v[234:235]
v_pk_mul_f32 v[174:175], v[82:83], v[250:251]
v_pk_fma_f32 v[172:173], v[98:99], v[250:251], v[172:173] neg_lo:[1,0,0] neg_hi:[1,0,0]
v_pk_fma_f32 v[174:175], v[98:99], v[234:235], v[174:175]
v_cvt_pk_bf16_f32 v34, v172, v174
v_cvt_pk_bf16_f32 v35, v173, v175
v_pk_mul_f32 v[168:169], v[84:85], v[236:237]
v_pk_mul_f32 v[170:171], v[84:85], v[252:253]
v_pk_fma_f32 v[168:169], v[100:101], v[252:253], v[168:169] neg_lo:[1,0,0] neg_hi:[1,0,0]
v_pk_fma_f32 v[170:171], v[100:101], v[236:237], v[170:171]
v_cvt_pk_bf16_f32 v36, v168, v170
v_cvt_pk_bf16_f32 v37, v169, v171
v_pk_mul_f32 v[172:173], v[86:87], v[238:239]
v_pk_mul_f32 v[174:175], v[86:87], v[254:255]
v_pk_fma_f32 v[172:173], v[102:103], v[254:255], v[172:173] neg_lo:[1,0,0] neg_hi:[1,0,0]
v_pk_fma_f32 v[174:175], v[102:103], v[238:239], v[174:175]
v_cvt_pk_bf16_f32 v38, v172, v174
v_cvt_pk_bf16_f32 v39, v173, v175
v_mfma_f32_32x32x16_bf16 v[72:87], v[192:195], v[24:27], 0
v_mfma_f32_32x32x16_bf16 v[72:87], v[196:199], v[28:31], v[72:87]
v_mfma_f32_32x32x16_bf16 v[72:87], v[200:203], v[32:35], v[72:87]
v_mfma_f32_32x32x16_bf16 v[72:87], v[204:207], v[36:39], v[72:87]
v_mfma_f32_32x32x16_bf16 v[88:103], v[208:211], v[24:27], 0
v_mfma_f32_32x32x16_bf16 v[88:103], v[212:215], v[28:31], v[88:103]
v_mfma_f32_32x32x16_bf16 v[88:103], v[216:219], v[32:35], v[88:103]
v_mfma_f32_32x32x16_bf16 v[88:103], v[220:223], v[36:39], v[88:103]
v_cvt_pk_bf16_f32 v8, v40, v56
v_cvt_pk_bf16_f32 v9, v41, v57
v_cvt_pk_bf16_f32 v10, v42, v58
v_cvt_pk_bf16_f32 v11, v43, v59
v_cvt_pk_bf16_f32 v12, v44, v60
v_cvt_pk_bf16_f32 v13, v45, v61
v_cvt_pk_bf16_f32 v14, v46, v62
v_cvt_pk_bf16_f32 v15, v47, v63
v_cvt_pk_bf16_f32 v16, v48, v64
v_cvt_pk_bf16_f32 v17, v49, v65
v_cvt_pk_bf16_f32 v18, v50, v66
v_cvt_pk_bf16_f32 v19, v51, v67
v_cvt_pk_bf16_f32 v20, v52, v68
v_cvt_pk_bf16_f32 v21, v53, v69
v_cvt_pk_bf16_f32 v22, v54, v70
v_cvt_pk_bf16_f32 v23, v55, v71
s_mov_b32 s48, 0
buffer_store_dwordx4 v[8:11], v2, s[28:31], s48 offen
s_mov_b32 s48, 1048576
buffer_store_dwordx4 v[12:15], v2, s[28:31], s48 offen
s_mov_b32 s48, 2097152
buffer_store_dwordx4 v[16:19], v2, s[28:31], s48 offen
s_mov_b32 s48, 3145728
buffer_store_dwordx4 v[20:23], v2, s[28:31], s48 offen
v_cvt_pk_bf16_f32 v24, -v72, v88
v_cvt_pk_bf16_f32 v25, -v73, v89
v_cvt_pk_bf16_f32 v26, -v74, v90
v_cvt_pk_bf16_f32 v27, -v75, v91
v_cvt_pk_bf16_f32 v28, -v76, v92
v_cvt_pk_bf16_f32 v29, -v77, v93
v_cvt_pk_bf16_f32 v30, -v78, v94
v_cvt_pk_bf16_f32 v31, -v79, v95
v_cvt_pk_bf16_f32 v32, -v80, v96
v_cvt_pk_bf16_f32 v33, -v81, v97
v_cvt_pk_bf16_f32 v34, -v82, v98
v_cvt_pk_bf16_f32 v35, -v83, v99
v_cvt_pk_bf16_f32 v36, -v84, v100
v_cvt_pk_bf16_f32 v37, -v85, v101
v_cvt_pk_bf16_f32 v38, -v86, v102
v_cvt_pk_bf16_f32 v39, -v87, v103
s_mov_b32 s48, 0
buffer_store_dwordx4 v[24:27], v3, s[28:31], s48 offen
s_mov_b32 s48, 1048576
buffer_store_dwordx4 v[28:31], v3, s[28:31], s48 offen
s_mov_b32 s48, 2097152
buffer_store_dwordx4 v[32:35], v3, s[28:31], s48 offen
s_mov_b32 s48, 3145728
buffer_store_dwordx4 v[36:39], v3, s[28:31], s48 offen
L_a2_kernel_fin:
L_a2_kernel_end:
s_endpgm
.globl g2_kernel
.p2align 8
.type g2_kernel,@function
g2_kernel:
s_cmp_ge_u32 s2, 256
s_cbranch_scc1 L_g2_kernel_end
s_load_dwordx2 s[4:5], s[0:1], 24
s_load_dwordx4 s[8:11], s[0:1], 64
s_load_dwordx4 s[12:15], s[0:1], 88
s_load_dwordx2 s[18:19], s[0:1], 112
v_lshrrev_b32 v2, 6, v0
v_and_b32 v1, 63, v0
v_readfirstlane_b32 s20, v2
s_and_b32 s44, s2, 7
s_lshr_b32 s45, s2, 3
s_lshr_b32 s21, s44, 1
s_lshl_b32 s21, s21, 2
s_lshr_b32 s46, s45, 3
s_add_u32 s21, s21, s46
s_and_b32 s22, s44, 1
s_lshl_b32 s22, s22, 3
s_and_b32 s46, s45, 7
s_add_u32 s22, s22, s46
v_lshlrev_b32 v2, 4, v1
v_lshrrev_b32 v3, 3, v1
s_and_b32 s44, s20, 1
s_lshl_b32 s44, s44, 5
s_lshr_b32 s45, s20, 1
s_add_u32 s44, s44, s45
v_lshl_add_u32 v3, v3, 1, s44
v_lshlrev_b32 v3, 11, v3
v_and_b32 v12, 7, v1
v_lshrrev_b32 v13, 4, v1
v_xor_b32 v12, v12, v13
v_lshlrev_b32 v12, 4, v12
v_xor_b32 v13, 64, v12
v_add_u32 v14, v3, v12
v_add_u32 v15, v3, v13
v_add_u32 v15, 31744, v15
s_waitcnt lgkmcnt(0)
s_lshl_b32 s44, s21, 2
s_add_u32 s44, s44, s20
s_lshl_b32 s44, s44, 17
s_add_u32 s44, s44, 1048576
s_add_u32 s24, s18, s44
s_addc_u32 s25, s19, 0
s_mov_b32 s26, 0x20000
s_mov_b32 s27, 0x20000
s_lshl_b32 s44, s22, 17
s_add_u32 s28, s8, s44
s_addc_u32 s29, s9, 0
s_mov_b32 s30, 0x20000
s_mov_b32 s31, 0x20000
s_add_u32 s32, s10, s44
s_addc_u32 s33, s11, 0
s_mov_b32 s34, 0x20000
s_mov_b32 s35, 0x20000
s_lshl_b32 s47, s20, 11
s_and_b32 s57, s2, 7
s_lshl_b32 s56, s57, 14
s_lshl_b32 s57, s57, 8
s_add_u32 m0, s47, 0
s_add_u32 s49, s57, 0
s_and_b32 s49, s49, 0x7ff
buffer_load_dwordx4 v14, s[28:31], s49 offen offset:0 lds
buffer_load_dwordx4 v15, s[28:31], s49 offen offset:1024 lds
s_add_u32 s48, s56, 0
s_and_b32 s48, s48, 0x1ffff
buffer_load_dwordx4 v[64:67], v2, s[24:27], s48 offen offset:0
buffer_load_dwordx4 v[68:71], v2, s[24:27], s48 offen offset:1024
buffer_load_dwordx4 v[72:75], v2, s[24:27], s48 offen offset:2048
buffer_load_dwordx4 v[76:79], v2, s[24:27], s48 offen offset:3072
s_add_u32 m0, s47, 8192
s_add_u32 s49, s57, 0
s_and_b32 s49, s49, 0x7ff
buffer_load_dwordx4 v14, s[32:35], s49 offen offset:0 lds
buffer_load_dwordx4 v15, s[32:35], s49 offen offset:1024 lds
s_add_u32 s48, s56, 4096
s_and_b32 s48, s48, 0x1ffff
buffer_load_dwordx4 v[80:83], v2, s[24:27], s48 offen offset:0
buffer_load_dwordx4 v[84:87], v2, s[24:27], s48 offen offset:1024
buffer_load_dwordx4 v[88:91], v2, s[24:27], s48 offen offset:2048
buffer_load_dwordx4 v[92:95], v2, s[24:27], s48 offen offset:3072
s_add_u32 m0, s47, 16384
s_add_u32 s49, s57, 128
s_and_b32 s49, s49, 0x7ff
buffer_load_dwordx4 v14, s[28:31], s49 offen offset:0 lds
buffer_load_dwordx4 v15, s[28:31], s49 offen offset:1024 lds
s_add_u32 s48, s56, 8192
s_and_b32 s48, s48, 0x1ffff
buffer_load_dwordx4 v[96:99], v2, s[24:27], s48 offen offset:0
buffer_load_dwordx4 v[100:103], v2, s[24:27], s48 offen offset:1024
buffer_load_dwordx4 v[104:107], v2, s[24:27], s48 offen offset:2048
buffer_load_dwordx4 v[108:111], v2, s[24:27], s48 offen offset:3072
s_add_u32 m0, s47, 24576
s_add_u32 s49, s57, 128
s_and_b32 s49, s49, 0x7ff
buffer_load_dwordx4 v14, s[32:35], s49 offen offset:0 lds
buffer_load_dwordx4 v15, s[32:35], s49 offen offset:1024 lds
s_add_u32 s48, s56, 12288
s_and_b32 s48, s48, 0x1ffff
buffer_load_dwordx4 v[112:115], v2, s[24:27], s48 offen offset:0
buffer_load_dwordx4 v[116:119], v2, s[24:27], s48 offen offset:1024
buffer_load_dwordx4 v[120:123], v2, s[24:27], s48 offen offset:2048
buffer_load_dwordx4 v[124:127], v2, s[24:27], s48 offen offset:3072
s_add_u32 m0, s47, 32768
s_add_u32 s49, s57, 256
s_and_b32 s49, s49, 0x7ff
buffer_load_dwordx4 v14, s[28:31], s49 offen offset:0 lds
buffer_load_dwordx4 v15, s[28:31], s49 offen offset:1024 lds
s_add_u32 s48, s56, 16384
s_and_b32 s48, s48, 0x1ffff
buffer_load_dwordx4 v[128:131], v2, s[24:27], s48 offen offset:0
buffer_load_dwordx4 v[132:135], v2, s[24:27], s48 offen offset:1024
buffer_load_dwordx4 v[136:139], v2, s[24:27], s48 offen offset:2048
buffer_load_dwordx4 v[140:143], v2, s[24:27], s48 offen offset:3072
s_add_u32 m0, s47, 40960
s_add_u32 s49, s57, 256
s_and_b32 s49, s49, 0x7ff
buffer_load_dwordx4 v14, s[32:35], s49 offen offset:0 lds
buffer_load_dwordx4 v15, s[32:35], s49 offen offset:1024 lds
s_add_u32 s48, s56, 20480
s_and_b32 s48, s48, 0x1ffff
buffer_load_dwordx4 v[144:147], v2, s[24:27], s48 offen offset:0
buffer_load_dwordx4 v[148:151], v2, s[24:27], s48 offen offset:1024
buffer_load_dwordx4 v[152:155], v2, s[24:27], s48 offen offset:2048
buffer_load_dwordx4 v[156:159], v2, s[24:27], s48 offen offset:3072
s_add_u32 m0, s47, 49152
s_add_u32 s49, s57, 384
s_and_b32 s49, s49, 0x7ff
buffer_load_dwordx4 v14, s[28:31], s49 offen offset:0 lds
buffer_load_dwordx4 v15, s[28:31], s49 offen offset:1024 lds
s_add_u32 s48, s56, 24576
s_and_b32 s48, s48, 0x1ffff
buffer_load_dwordx4 v[160:163], v2, s[24:27], s48 offen offset:0
buffer_load_dwordx4 v[164:167], v2, s[24:27], s48 offen offset:1024
buffer_load_dwordx4 v[168:171], v2, s[24:27], s48 offen offset:2048
buffer_load_dwordx4 v[172:175], v2, s[24:27], s48 offen offset:3072
s_add_u32 m0, s47, 57344
s_add_u32 s49, s57, 384
s_and_b32 s49, s49, 0x7ff
buffer_load_dwordx4 v14, s[32:35], s49 offen offset:0 lds
buffer_load_dwordx4 v15, s[32:35], s49 offen offset:1024 lds
s_add_u32 s48, s56, 28672
s_and_b32 s48, s48, 0x1ffff
buffer_load_dwordx4 v[176:179], v2, s[24:27], s48 offen offset:0
buffer_load_dwordx4 v[180:183], v2, s[24:27], s48 offen offset:1024
buffer_load_dwordx4 v[184:187], v2, s[24:27], s48 offen offset:2048
buffer_load_dwordx4 v[188:191], v2, s[24:27], s48 offen offset:3072
s_add_u32 m0, s47, 65536
s_add_u32 s49, s57, 512
s_and_b32 s49, s49, 0x7ff
buffer_load_dwordx4 v14, s[28:31], s49 offen offset:0 lds
buffer_load_dwordx4 v15, s[28:31], s49 offen offset:1024 lds
s_add_u32 m0, s47, 73728
s_add_u32 s49, s57, 512
s_and_b32 s49, s49, 0x7ff
buffer_load_dwordx4 v14, s[32:35], s49 offen offset:0 lds
buffer_load_dwordx4 v15, s[32:35], s49 offen offset:1024 lds
v_and_b32 v16, 31, v1
v_lshrrev_b32 v17, 5, v1
v_bfe_u32 v18, v16, 1, 3
v_xor_b32 v18, v18, v17
v_lshlrev_b32 v18, 4, v18
v_lshl_add_u32 v18, v16, 7, v18
v_xor_b32 v4, 0, v18
v_add_u32 v8, 0x10000, v4
v_xor_b32 v5, 32, v18
v_add_u32 v9, 0x10000, v5
v_xor_b32 v6, 64, v18
v_add_u32 v10, 0x10000, v6
v_xor_b32 v7, 96, v18
v_add_u32 v11, 0x10000, v7
s_and_b32 s44, s20, 1
s_lshl_b32 s44, s44, 3
v_lshl_add_u32 v17, v17, 2, s44
v_lshlrev_b32 v208, 11, v17
v_lshl_add_u32 v208, v16, 2, v208
v_lshlrev_b32 v209, 13, v17
v_lshl_add_u32 v209, v16, 3, v209
v_lshlrev_b32 v210, 2, v16
s_lshl_b32 s44, s21, 1
s_lshr_b32 s45, s20, 1
s_add_u32 s44, s44, s45
s_lshl_b32 s45, s44, 17
s_lshl_b32 s46, s22, 7
s_add_u32 s45, s45, s46
s_add_u32 s36, s4, s45
s_addc_u32 s37, s5, 0
s_sub_u32 s38, 0x20000, s46
s_mov_b32 s39, 0x20000
s_add_u32 s12, s12, s46
s_addc_u32 s13, s13, 0
s_lshl_b32 s45, s44, 19
s_lshl_b32 s46, s22, 8
s_add_u32 s46, s46, 4096
s_add_u32 s45, s45, s46
s_add_u32 s40, s14, s45
s_addc_u32 s41, s15, 0
s_sub_u32 s42, 0x80000, s46
s_mov_b32 s43, 0x20000
s_waitcnt vmcnt(44)
s_barrier
ds_read_b128 v[48:51], v4 offset:0
ds_read_b128 v[52:55], v4 offset:4096
ds_read_b128 v[56:59], v5 offset:0
ds_read_b128 v[60:63], v5 offset:4096
s_waitcnt vmcnt(49) lgkmcnt(2)
v_mfma_f32_32x32x16_bf16 v[16:31], v[64:67], v[48:51], 0
v_mfma_f32_32x32x16_bf16 v[32:47], v[64:67], v[52:55], 0
s_add_u32 s48, s56, 32768
s_and_b32 s48, s48, 0x1ffff
buffer_load_dwordx4 v[64:67], v2, s[24:27], s48 offen offset:0
s_add_u32 m0, s47, 81920
s_add_u32 s49, s57, 640
s_and_b32 s49, s49, 0x7ff
buffer_load_dwordx4 v14, s[28:31], s49 offen offset:0 lds
ds_read_b128 v[48:51], v6 offset:0
ds_read_b128 v[52:55], v6 offset:4096
s_waitcnt vmcnt(50) lgkmcnt(2)
v_mfma_f32_32x32x16_bf16 v[16:31], v[68:71], v[56:59], v[16:31]
v_mfma_f32_32x32x16_bf16 v[32:47], v[68:71], v[60:63], v[32:47]
buffer_load_dwordx4 v[68:71], v2, s[24:27], s48 offen offset:1024
ds_read_b128 v[56:59], v7 offset:0
ds_read_b128 v[60:63], v7 offset:4096
s_waitcnt vmcnt(50) lgkmcnt(2)
v_mfma_f32_32x32x16_bf16 v[16:31], v[72:75], v[48:51], v[16:31]
v_mfma_f32_32x32x16_bf16 v[32:47], v[72:75], v[52:55], v[32:47]
buffer_load_dwordx4 v[72:75], v2, s[24:27], s48 offen offset:2048
buffer_load_dwordx4 v15, s[28:31], s49 offen offset:1024 lds
ds_read_b128 v[48:51], v4 offset:8192
ds_read_b128 v[52:55], v4 offset:12288
s_waitcnt vmcnt(51) lgkmcnt(2)
v_mfma_f32_32x32x16_bf16 v[16:31], v[76:79], v[56:59], v[16:31]
v_mfma_f32_32x32x16_bf16 v[32:47], v[76:79], v[60:63], v[32:47]
buffer_load_dwordx4 v[76:79], v2, s[24:27], s48 offen offset:3072
ds_read_b128 v[56:59], v5 offset:8192
ds_read_b128 v[60:63], v5 offset:12288
s_waitcnt vmcnt(49) lgkmcnt(2)
v_mfma_f32_32x32x16_bf16 v[16:31], v[80:83], v[48:51], v[16:31]
v_mfma_f32_32x32x16_bf16 v[32:47], v[80:83], v[52:55], v[32:47]
s_add_u32 s48, s56, 36864
s_and_b32 s48, s48, 0x1ffff
buffer_load_dwordx4 v[80:83], v2, s[24:27], s48 offen offset:0
s_add_u32 m0, s47, 90112
s_add_u32 s49, s57, 640
s_and_b32 s49, s49, 0x7ff
buffer_load_dwordx4 v14, s[32:35], s49 offen offset:0 lds
ds_read_b128 v[48:51], v6 offset:8192
ds_read_b128 v[52:55], v6 offset:12288
s_waitcnt vmcnt(50) lgkmcnt(2)
v_mfma_f32_32x32x16_bf16 v[16:31], v[84:87], v[56:59], v[16:31]
v_mfma_f32_32x32x16_bf16 v[32:47], v[84:87], v[60:63], v[32:47]
buffer_load_dwordx4 v[84:87], v2, s[24:27], s48 offen offset:1024
ds_read_b128 v[56:59], v7 offset:8192
ds_read_b128 v[60:63], v7 offset:12288
s_waitcnt vmcnt(50) lgkmcnt(2)
v_mfma_f32_32x32x16_bf16 v[16:31], v[88:91], v[48:51], v[16:31]
v_mfma_f32_32x32x16_bf16 v[32:47], v[88:91], v[52:55], v[32:47]
buffer_load_dwordx4 v[88:91], v2, s[24:27], s48 offen offset:2048
buffer_load_dwordx4 v15, s[32:35], s49 offen offset:1024 lds
s_waitcnt vmcnt(43) lgkmcnt(0)
s_barrier
ds_read_b128 v[48:51], v4 offset:16384
ds_read_b128 v[52:55], v4 offset:20480
v_mfma_f32_32x32x16_bf16 v[16:31], v[92:95], v[56:59], v[16:31]
v_mfma_f32_32x32x16_bf16 v[32:47], v[92:95], v[60:63], v[32:47]
buffer_load_dwordx4 v[92:95], v2, s[24:27], s48 offen offset:3072
ds_read_b128 v[56:59], v5 offset:16384
ds_read_b128 v[60:63], v5 offset:20480
s_waitcnt vmcnt(49) lgkmcnt(2)
v_mfma_f32_32x32x16_bf16 v[16:31], v[96:99], v[48:51], v[16:31]
v_mfma_f32_32x32x16_bf16 v[32:47], v[96:99], v[52:55], v[32:47]
s_add_u32 s48, s56, 40960
s_and_b32 s48, s48, 0x1ffff
buffer_load_dwordx4 v[96:99], v2, s[24:27], s48 offen offset:0
s_add_u32 m0, s47, 98304
s_add_u32 s49, s57, 768
s_and_b32 s49, s49, 0x7ff
buffer_load_dwordx4 v14, s[28:31], s49 offen offset:0 lds
ds_read_b128 v[48:51], v6 offset:16384
ds_read_b128 v[52:55], v6 offset:20480
s_waitcnt vmcnt(50) lgkmcnt(2)
v_mfma_f32_32x32x16_bf16 v[16:31], v[100:103], v[56:59], v[16:31]
v_mfma_f32_32x32x16_bf16 v[32:47], v[100:103], v[60:63], v[32:47]
buffer_load_dwordx4 v[100:103], v2, s[24:27], s48 offen offset:1024
ds_read_b128 v[56:59], v7 offset:16384
ds_read_b128 v[60:63], v7 offset:20480
s_waitcnt vmcnt(50) lgkmcnt(2)
v_mfma_f32_32x32x16_bf16 v[16:31], v[104:107], v[48:51], v[16:31]
v_mfma_f32_32x32x16_bf16 v[32:47], v[104:107], v[52:55], v[32:47]
buffer_load_dwordx4 v[104:107], v2, s[24:27], s48 offen offset:2048
buffer_load_dwordx4 v15, s[28:31], s49 offen offset:1024 lds
ds_read_b128 v[48:51], v4 offset:24576
ds_read_b128 v[52:55], v4 offset:28672
s_waitcnt vmcnt(51) lgkmcnt(2)
v_mfma_f32_32x32x16_bf16 v[16:31], v[108:111], v[56:59], v[16:31]
v_mfma_f32_32x32x16_bf16 v[32:47], v[108:111], v[60:63], v[32:47]
buffer_load_dwordx4 v[108:111], v2, s[24:27], s48 offen offset:3072
ds_read_b128 v[56:59], v5 offset:24576
ds_read_b128 v[60:63], v5 offset:28672
s_waitcnt vmcnt(49) lgkmcnt(2)
v_mfma_f32_32x32x16_bf16 v[16:31], v[112:115], v[48:51], v[16:31]
v_mfma_f32_32x32x16_bf16 v[32:47], v[112:115], v[52:55], v[32:47]
s_add_u32 s48, s56, 45056
s_and_b32 s48, s48, 0x1ffff
buffer_load_dwordx4 v[112:115], v2, s[24:27], s48 offen offset:0
s_add_u32 m0, s47, 106496
s_add_u32 s49, s57, 768
s_and_b32 s49, s49, 0x7ff
buffer_load_dwordx4 v14, s[32:35], s49 offen offset:0 lds
ds_read_b128 v[48:51], v6 offset:24576
ds_read_b128 v[52:55], v6 offset:28672
s_waitcnt vmcnt(50) lgkmcnt(2)
v_mfma_f32_32x32x16_bf16 v[16:31], v[116:119], v[56:59], v[16:31]
v_mfma_f32_32x32x16_bf16 v[32:47], v[116:119], v[60:63], v[32:47]
buffer_load_dwordx4 v[116:119], v2, s[24:27], s48 offen offset:1024
ds_read_b128 v[56:59], v7 offset:24576
ds_read_b128 v[60:63], v7 offset:28672
s_waitcnt vmcnt(50) lgkmcnt(2)
v_mfma_f32_32x32x16_bf16 v[16:31], v[120:123], v[48:51], v[16:31]
v_mfma_f32_32x32x16_bf16 v[32:47], v[120:123], v[52:55], v[32:47]
buffer_load_dwordx4 v[120:123], v2, s[24:27], s48 offen offset:2048
buffer_load_dwordx4 v15, s[32:35], s49 offen offset:1024 lds
s_waitcnt vmcnt(43) lgkmcnt(0)
s_barrier
ds_read_b128 v[48:51], v4 offset:32768
ds_read_b128 v[52:55], v4 offset:36864
v_mfma_f32_32x32x16_bf16 v[16:31], v[124:127], v[56:59], v[16:31]
v_mfma_f32_32x32x16_bf16 v[32:47], v[124:127], v[60:63], v[32:47]
buffer_load_dwordx4 v[124:127], v2, s[24:27], s48 offen offset:3072
ds_read_b128 v[56:59], v5 offset:32768
ds_read_b128 v[60:63], v5 offset:36864
s_waitcnt vmcnt(49) lgkmcnt(2)
v_mfma_f32_32x32x16_bf16 v[16:31], v[128:131], v[48:51], v[16:31]
v_mfma_f32_32x32x16_bf16 v[32:47], v[128:131], v[52:55], v[32:47]
s_add_u32 s48, s56, 49152
s_and_b32 s48, s48, 0x1ffff
buffer_load_dwordx4 v[128:131], v2, s[24:27], s48 offen offset:0
s_add_u32 m0, s47, 114688
s_add_u32 s49, s57, 896
s_and_b32 s49, s49, 0x7ff
buffer_load_dwordx4 v14, s[28:31], s49 offen offset:0 lds
ds_read_b128 v[48:51], v6 offset:32768
ds_read_b128 v[52:55], v6 offset:36864
s_waitcnt vmcnt(50) lgkmcnt(2)
v_mfma_f32_32x32x16_bf16 v[16:31], v[132:135], v[56:59], v[16:31]
v_mfma_f32_32x32x16_bf16 v[32:47], v[132:135], v[60:63], v[32:47]
buffer_load_dwordx4 v[132:135], v2, s[24:27], s48 offen offset:1024
ds_read_b128 v[56:59], v7 offset:32768
ds_read_b128 v[60:63], v7 offset:36864
s_waitcnt vmcnt(50) lgkmcnt(2)
v_mfma_f32_32x32x16_bf16 v[16:31], v[136:139], v[48:51], v[16:31]
v_mfma_f32_32x32x16_bf16 v[32:47], v[136:139], v[52:55], v[32:47]
buffer_load_dwordx4 v[136:139], v2, s[24:27], s48 offen offset:2048
buffer_load_dwordx4 v15, s[28:31], s49 offen offset:1024 lds
ds_read_b128 v[48:51], v4 offset:40960
ds_read_b128 v[52:55], v4 offset:45056
s_waitcnt vmcnt(51) lgkmcnt(2)
v_mfma_f32_32x32x16_bf16 v[16:31], v[140:143], v[56:59], v[16:31]
v_mfma_f32_32x32x16_bf16 v[32:47], v[140:143], v[60:63], v[32:47]
buffer_load_dwordx4 v[140:143], v2, s[24:27], s48 offen offset:3072
ds_read_b128 v[56:59], v5 offset:40960
ds_read_b128 v[60:63], v5 offset:45056
s_waitcnt vmcnt(49) lgkmcnt(2)
v_mfma_f32_32x32x16_bf16 v[16:31], v[144:147], v[48:51], v[16:31]
v_mfma_f32_32x32x16_bf16 v[32:47], v[144:147], v[52:55], v[32:47]
s_add_u32 s48, s56, 53248
s_and_b32 s48, s48, 0x1ffff
buffer_load_dwordx4 v[144:147], v2, s[24:27], s48 offen offset:0
s_add_u32 m0, s47, 122880
s_add_u32 s49, s57, 896
s_and_b32 s49, s49, 0x7ff
buffer_load_dwordx4 v14, s[32:35], s49 offen offset:0 lds
ds_read_b128 v[48:51], v6 offset:40960
ds_read_b128 v[52:55], v6 offset:45056
s_waitcnt vmcnt(50) lgkmcnt(2)
v_mfma_f32_32x32x16_bf16 v[16:31], v[148:151], v[56:59], v[16:31]
v_mfma_f32_32x32x16_bf16 v[32:47], v[148:151], v[60:63], v[32:47]
buffer_load_dwordx4 v[148:151], v2, s[24:27], s48 offen offset:1024
ds_read_b128 v[56:59], v7 offset:40960
ds_read_b128 v[60:63], v7 offset:45056
s_waitcnt vmcnt(50) lgkmcnt(2)
v_mfma_f32_32x32x16_bf16 v[16:31], v[152:155], v[48:51], v[16:31]
v_mfma_f32_32x32x16_bf16 v[32:47], v[152:155], v[52:55], v[32:47]
buffer_load_dwordx4 v[152:155], v2, s[24:27], s48 offen offset:2048
buffer_load_dwordx4 v15, s[32:35], s49 offen offset:1024 lds
s_waitcnt vmcnt(43) lgkmcnt(0)
s_barrier
ds_read_b128 v[48:51], v4 offset:49152
ds_read_b128 v[52:55], v4 offset:53248
v_mfma_f32_32x32x16_bf16 v[16:31], v[156:159], v[56:59], v[16:31]
v_mfma_f32_32x32x16_bf16 v[32:47], v[156:159], v[60:63], v[32:47]
buffer_load_dwordx4 v[156:159], v2, s[24:27], s48 offen offset:3072
ds_read_b128 v[56:59], v5 offset:49152
ds_read_b128 v[60:63], v5 offset:53248
s_waitcnt vmcnt(49) lgkmcnt(2)
v_mfma_f32_32x32x16_bf16 v[16:31], v[160:163], v[48:51], v[16:31]
v_mfma_f32_32x32x16_bf16 v[32:47], v[160:163], v[52:55], v[32:47]
s_add_u32 s48, s56, 57344
s_and_b32 s48, s48, 0x1ffff
buffer_load_dwordx4 v[160:163], v2, s[24:27], s48 offen offset:0
s_add_u32 m0, s47, 0
s_add_u32 s49, s57, 1024
s_and_b32 s49, s49, 0x7ff
buffer_load_dwordx4 v14, s[28:31], s49 offen offset:0 lds
ds_read_b128 v[48:51], v6 offset:49152
ds_read_b128 v[52:55], v6 offset:53248
s_waitcnt vmcnt(50) lgkmcnt(2)
v_mfma_f32_32x32x16_bf16 v[16:31], v[164:167], v[56:59], v[16:31]
v_mfma_f32_32x32x16_bf16 v[32:47], v[164:167], v[60:63], v[32:47]
buffer_load_dwordx4 v[164:167], v2, s[24:27], s48 offen offset:1024
ds_read_b128 v[56:59], v7 offset:49152
ds_read_b128 v[60:63], v7 offset:53248
s_waitcnt vmcnt(50) lgkmcnt(2)
v_mfma_f32_32x32x16_bf16 v[16:31], v[168:171], v[48:51], v[16:31]
v_mfma_f32_32x32x16_bf16 v[32:47], v[168:171], v[52:55], v[32:47]
buffer_load_dwordx4 v[168:171], v2, s[24:27], s48 offen offset:2048
buffer_load_dwordx4 v15, s[28:31], s49 offen offset:1024 lds
ds_read_b128 v[48:51], v4 offset:57344
ds_read_b128 v[52:55], v4 offset:61440
s_waitcnt vmcnt(51) lgkmcnt(2)
v_mfma_f32_32x32x16_bf16 v[16:31], v[172:175], v[56:59], v[16:31]
v_mfma_f32_32x32x16_bf16 v[32:47], v[172:175], v[60:63], v[32:47]
buffer_load_dwordx4 v[172:175], v2, s[24:27], s48 offen offset:3072
ds_read_b128 v[56:59], v5 offset:57344
ds_read_b128 v[60:63], v5 offset:61440
s_waitcnt vmcnt(49) lgkmcnt(2)
v_mfma_f32_32x32x16_bf16 v[16:31], v[176:179], v[48:51], v[16:31]
v_mfma_f32_32x32x16_bf16 v[32:47], v[176:179], v[52:55], v[32:47]
s_add_u32 s48, s56, 61440
s_and_b32 s48, s48, 0x1ffff
buffer_load_dwordx4 v[176:179], v2, s[24:27], s48 offen offset:0
s_add_u32 m0, s47, 8192
s_add_u32 s49, s57, 1024
s_and_b32 s49, s49, 0x7ff
buffer_load_dwordx4 v14, s[32:35], s49 offen offset:0 lds
ds_read_b128 v[48:51], v6 offset:57344
ds_read_b128 v[52:55], v6 offset:61440
s_waitcnt vmcnt(50) lgkmcnt(2)
v_mfma_f32_32x32x16_bf16 v[16:31], v[180:183], v[56:59], v[16:31]
v_mfma_f32_32x32x16_bf16 v[32:47], v[180:183], v[60:63], v[32:47]
buffer_load_dwordx4 v[180:183], v2, s[24:27], s48 offen offset:1024
ds_read_b128 v[56:59], v7 offset:57344
ds_read_b128 v[60:63], v7 offset:61440
s_waitcnt vmcnt(50) lgkmcnt(2)
v_mfma_f32_32x32x16_bf16 v[16:31], v[184:187], v[48:51], v[16:31]
v_mfma_f32_32x32x16_bf16 v[32:47], v[184:187], v[52:55], v[32:47]
buffer_load_dwordx4 v[184:187], v2, s[24:27], s48 offen offset:2048
buffer_load_dwordx4 v15, s[32:35], s49 offen offset:1024 lds
s_waitcnt vmcnt(47) lgkmcnt(0)
s_barrier
ds_read_b128 v[48:51], v8 offset:0
ds_read_b128 v[52:55], v8 offset:4096
v_mfma_f32_32x32x16_bf16 v[16:31], v[188:191], v[56:59], v[16:31]
v_mfma_f32_32x32x16_bf16 v[32:47], v[188:191], v[60:63], v[32:47]
buffer_load_dwordx4 v[188:191], v2, s[24:27], s48 offen offset:3072
ds_read_b128 v[56:59], v9 offset:0
ds_read_b128 v[60:63], v9 offset:4096
s_waitcnt vmcnt(47) lgkmcnt(2)
v_mfma_f32_32x32x16_bf16 v[16:31], v[64:67], v[48:51], v[16:31]
v_mfma_f32_32x32x16_bf16 v[32:47], v[64:67], v[52:55], v[32:47]
s_add_u32 s48, s56, 65536
s_and_b32 s48, s48, 0x1ffff
buffer_load_dwordx4 v[64:67], v2, s[24:27], s48 offen offset:0
s_add_u32 m0, s47, 16384
s_add_u32 s49, s57, 1152
s_and_b32 s49, s49, 0x7ff
buffer_load_dwordx4 v14, s[28:31], s49 offen offset:0 lds
ds_read_b128 v[48:51], v10 offset:0
ds_read_b128 v[52:55], v10 offset:4096
s_waitcnt vmcnt(47) lgkmcnt(2)
v_mfma_f32_32x32x16_bf16 v[16:31], v[68:71], v[56:59], v[16:31]
v_mfma_f32_32x32x16_bf16 v[32:47], v[68:71], v[60:63], v[32:47]
buffer_load_dwordx4 v[68:71], v2, s[24:27], s48 offen offset:1024
ds_read_b128 v[56:59], v11 offset:0
ds_read_b128 v[60:63], v11 offset:4096
s_waitcnt vmcnt(47) lgkmcnt(2)
v_mfma_f32_32x32x16_bf16 v[16:31], v[72:75], v[48:51], v[16:31]
v_mfma_f32_32x32x16_bf16 v[32:47], v[72:75], v[52:55], v[32:47]
buffer_load_dwordx4 v[72:75], v2, s[24:27], s48 offen offset:2048
buffer_load_dwordx4 v15, s[28:31], s49 offen offset:1024 lds
ds_read_b128 v[48:51], v8 offset:8192
ds_read_b128 v[52:55], v8 offset:12288
s_waitcnt vmcnt(47) lgkmcnt(2)
v_mfma_f32_32x32x16_bf16 v[16:31], v[76:79], v[56:59], v[16:31]
v_mfma_f32_32x32x16_bf16 v[32:47], v[76:79], v[60:63], v[32:47]
buffer_load_dwordx4 v[76:79], v2, s[24:27], s48 offen offset:3072
ds_read_b128 v[56:59], v9 offset:8192
ds_read_b128 v[60:63], v9 offset:12288
s_waitcnt vmcnt(47) lgkmcnt(2)
v_mfma_f32_32x32x16_bf16 v[16:31], v[80:83], v[48:51], v[16:31]
v_mfma_f32_32x32x16_bf16 v[32:47], v[80:83], v[52:55], v[32:47]
s_add_u32 s48, s56, 69632
s_and_b32 s48, s48, 0x1ffff
buffer_load_dwordx4 v[80:83], v2, s[24:27], s48 offen offset:0
s_add_u32 m0, s47, 24576
s_add_u32 s49, s57, 1152
s_and_b32 s49, s49, 0x7ff
buffer_load_dwordx4 v14, s[32:35], s49 offen offset:0 lds
ds_read_b128 v[48:51], v10 offset:8192
ds_read_b128 v[52:55], v10 offset:12288
s_waitcnt vmcnt(47) lgkmcnt(2)
v_mfma_f32_32x32x16_bf16 v[16:31], v[84:87], v[56:59], v[16:31]
v_mfma_f32_32x32x16_bf16 v[32:47], v[84:87], v[60:63], v[32:47]
buffer_load_dwordx4 v[84:87], v2, s[24:27], s48 offen offset:1024
ds_read_b128 v[56:59], v11 offset:8192
ds_read_b128 v[60:63], v11 offset:12288
s_waitcnt vmcnt(47) lgkmcnt(2)
v_mfma_f32_32x32x16_bf16 v[16:31], v[88:91], v[48:51], v[16:31]
v_mfma_f32_32x32x16_bf16 v[32:47], v[88:91], v[52:55], v[32:47]
buffer_load_dwordx4 v[88:91], v2, s[24:27], s48 offen offset:2048
buffer_load_dwordx4 v15, s[32:35], s49 offen offset:1024 lds
s_waitcnt vmcnt(47) lgkmcnt(0)
s_barrier
ds_read_b128 v[48:51], v8 offset:16384
ds_read_b128 v[52:55], v8 offset:20480
v_mfma_f32_32x32x16_bf16 v[16:31], v[92:95], v[56:59], v[16:31]
v_mfma_f32_32x32x16_bf16 v[32:47], v[92:95], v[60:63], v[32:47]
buffer_load_dwordx4 v[92:95], v2, s[24:27], s48 offen offset:3072
ds_read_b128 v[56:59], v9 offset:16384
ds_read_b128 v[60:63], v9 offset:20480
s_waitcnt vmcnt(47) lgkmcnt(2)
v_mfma_f32_32x32x16_bf16 v[16:31], v[96:99], v[48:51], v[16:31]
v_mfma_f32_32x32x16_bf16 v[32:47], v[96:99], v[52:55], v[32:47]
s_add_u32 s48, s56, 73728
s_and_b32 s48, s48, 0x1ffff
buffer_load_dwordx4 v[96:99], v2, s[24:27], s48 offen offset:0
s_add_u32 m0, s47, 32768
s_add_u32 s49, s57, 1280
s_and_b32 s49, s49, 0x7ff
buffer_load_dwordx4 v14, s[28:31], s49 offen offset:0 lds
ds_read_b128 v[48:51], v10 offset:16384
ds_read_b128 v[52:55], v10 offset:20480
s_waitcnt vmcnt(47) lgkmcnt(2)
v_mfma_f32_32x32x16_bf16 v[16:31], v[100:103], v[56:59], v[16:31]
v_mfma_f32_32x32x16_bf16 v[32:47], v[100:103], v[60:63], v[32:47]
buffer_load_dwordx4 v[100:103], v2, s[24:27], s48 offen offset:1024
ds_read_b128 v[56:59], v11 offset:16384
ds_read_b128 v[60:63], v11 offset:20480
s_waitcnt vmcnt(47) lgkmcnt(2)
v_mfma_f32_32x32x16_bf16 v[16:31], v[104:107], v[48:51], v[16:31]
v_mfma_f32_32x32x16_bf16 v[32:47], v[104:107], v[52:55], v[32:47]
buffer_load_dwordx4 v[104:107], v2, s[24:27], s48 offen offset:2048
buffer_load_dwordx4 v15, s[28:31], s49 offen offset:1024 lds
ds_read_b128 v[48:51], v8 offset:24576
ds_read_b128 v[52:55], v8 offset:28672
s_waitcnt vmcnt(47) lgkmcnt(2)
v_mfma_f32_32x32x16_bf16 v[16:31], v[108:111], v[56:59], v[16:31]
v_mfma_f32_32x32x16_bf16 v[32:47], v[108:111], v[60:63], v[32:47]
buffer_load_dwordx4 v[108:111], v2, s[24:27], s48 offen offset:3072
ds_read_b128 v[56:59], v9 offset:24576
ds_read_b128 v[60:63], v9 offset:28672
s_waitcnt vmcnt(47) lgkmcnt(2)
v_mfma_f32_32x32x16_bf16 v[16:31], v[112:115], v[48:51], v[16:31]
v_mfma_f32_32x32x16_bf16 v[32:47], v[112:115], v[52:55], v[32:47]
s_add_u32 s48, s56, 77824
s_and_b32 s48, s48, 0x1ffff
buffer_load_dwordx4 v[112:115], v2, s[24:27], s48 offen offset:0
s_add_u32 m0, s47, 40960
s_add_u32 s49, s57, 1280
s_and_b32 s49, s49, 0x7ff
buffer_load_dwordx4 v14, s[32:35], s49 offen offset:0 lds
ds_read_b128 v[48:51], v10 offset:24576
ds_read_b128 v[52:55], v10 offset:28672
s_waitcnt vmcnt(47) lgkmcnt(2)
v_mfma_f32_32x32x16_bf16 v[16:31], v[116:119], v[56:59], v[16:31]
v_mfma_f32_32x32x16_bf16 v[32:47], v[116:119], v[60:63], v[32:47]
buffer_load_dwordx4 v[116:119], v2, s[24:27], s48 offen offset:1024
ds_read_b128 v[56:59], v11 offset:24576
ds_read_b128 v[60:63], v11 offset:28672
s_waitcnt vmcnt(47) lgkmcnt(2)
v_mfma_f32_32x32x16_bf16 v[16:31], v[120:123], v[48:51], v[16:31]
v_mfma_f32_32x32x16_bf16 v[32:47], v[120:123], v[52:55], v[32:47]
buffer_load_dwordx4 v[120:123], v2, s[24:27], s48 offen offset:2048
buffer_load_dwordx4 v15, s[32:35], s49 offen offset:1024 lds
s_waitcnt vmcnt(47) lgkmcnt(0)
s_barrier
ds_read_b128 v[48:51], v8 offset:32768
ds_read_b128 v[52:55], v8 offset:36864
v_mfma_f32_32x32x16_bf16 v[16:31], v[124:127], v[56:59], v[16:31]
v_mfma_f32_32x32x16_bf16 v[32:47], v[124:127], v[60:63], v[32:47]
buffer_load_dwordx4 v[124:127], v2, s[24:27], s48 offen offset:3072
ds_read_b128 v[56:59], v9 offset:32768
ds_read_b128 v[60:63], v9 offset:36864
s_waitcnt vmcnt(47) lgkmcnt(2)
v_mfma_f32_32x32x16_bf16 v[16:31], v[128:131], v[48:51], v[16:31]
v_mfma_f32_32x32x16_bf16 v[32:47], v[128:131], v[52:55], v[32:47]
s_add_u32 s48, s56, 81920
s_and_b32 s48, s48, 0x1ffff
buffer_load_dwordx4 v[128:131], v2, s[24:27], s48 offen offset:0
s_add_u32 m0, s47, 49152
s_add_u32 s49, s57, 1408
s_and_b32 s49, s49, 0x7ff
buffer_load_dwordx4 v14, s[28:31], s49 offen offset:0 lds
ds_read_b128 v[48:51], v10 offset:32768
ds_read_b128 v[52:55], v10 offset:36864
s_waitcnt vmcnt(47) lgkmcnt(2)
v_mfma_f32_32x32x16_bf16 v[16:31], v[132:135], v[56:59], v[16:31]
v_mfma_f32_32x32x16_bf16 v[32:47], v[132:135], v[60:63], v[32:47]
buffer_load_dwordx4 v[132:135], v2, s[24:27], s48 offen offset:1024
ds_read_b128 v[56:59], v11 offset:32768
ds_read_b128 v[60:63], v11 offset:36864
s_waitcnt vmcnt(47) lgkmcnt(2)
v_mfma_f32_32x32x16_bf16 v[16:31], v[136:139], v[48:51], v[16:31]
v_mfma_f32_32x32x16_bf16 v[32:47], v[136:139], v[52:55], v[32:47]
buffer_load_dwordx4 v[136:139], v2, s[24:27], s48 offen offset:2048
buffer_load_dwordx4 v15, s[28:31], s49 offen offset:1024 lds
ds_read_b128 v[48:51], v8 offset:40960
ds_read_b128 v[52:55], v8 offset:45056
s_waitcnt vmcnt(47) lgkmcnt(2)
v_mfma_f32_32x32x16_bf16 v[16:31], v[140:143], v[56:59], v[16:31]
v_mfma_f32_32x32x16_bf16 v[32:47], v[140:143], v[60:63], v[32:47]
buffer_load_dwordx4 v[140:143], v2, s[24:27], s48 offen offset:3072
ds_read_b128 v[56:59], v9 offset:40960
ds_read_b128 v[60:63], v9 offset:45056
s_waitcnt vmcnt(47) lgkmcnt(2)
v_mfma_f32_32x32x16_bf16 v[16:31], v[144:147], v[48:51], v[16:31]
v_mfma_f32_32x32x16_bf16 v[32:47], v[144:147], v[52:55], v[32:47]
s_add_u32 s48, s56, 86016
s_and_b32 s48, s48, 0x1ffff
buffer_load_dwordx4 v[144:147], v2, s[24:27], s48 offen offset:0
s_add_u32 m0, s47, 57344
s_add_u32 s49, s57, 1408
s_and_b32 s49, s49, 0x7ff
buffer_load_dwordx4 v14, s[32:35], s49 offen offset:0 lds
ds_read_b128 v[48:51], v10 offset:40960
ds_read_b128 v[52:55], v10 offset:45056
s_waitcnt vmcnt(47) lgkmcnt(2)
v_mfma_f32_32x32x16_bf16 v[16:31], v[148:151], v[56:59], v[16:31]
v_mfma_f32_32x32x16_bf16 v[32:47], v[148:151], v[60:63], v[32:47]
buffer_load_dwordx4 v[148:151], v2, s[24:27], s48 offen offset:1024
ds_read_b128 v[56:59], v11 offset:40960
ds_read_b128 v[60:63], v11 offset:45056
s_waitcnt vmcnt(47) lgkmcnt(2)
v_mfma_f32_32x32x16_bf16 v[16:31], v[152:155], v[48:51], v[16:31]
v_mfma_f32_32x32x16_bf16 v[32:47], v[152:155], v[52:55], v[32:47]
buffer_load_dwordx4 v[152:155], v2, s[24:27], s48 offen offset:2048
buffer_load_dwordx4 v15, s[32:35], s49 offen offset:1024 lds
s_waitcnt vmcnt(47) lgkmcnt(0)
s_barrier
ds_read_b128 v[48:51], v8 offset:49152
ds_read_b128 v[52:55], v8 offset:53248
v_mfma_f32_32x32x16_bf16 v[16:31], v[156:159], v[56:59], v[16:31]
v_mfma_f32_32x32x16_bf16 v[32:47], v[156:159], v[60:63], v[32:47]
buffer_load_dwordx4 v[156:159], v2, s[24:27], s48 offen offset:3072
ds_read_b128 v[56:59], v9 offset:49152
ds_read_b128 v[60:63], v9 offset:53248
s_waitcnt vmcnt(47) lgkmcnt(2)
v_mfma_f32_32x32x16_bf16 v[16:31], v[160:163], v[48:51], v[16:31]
v_mfma_f32_32x32x16_bf16 v[32:47], v[160:163], v[52:55], v[32:47]
s_add_u32 s48, s56, 90112
s_and_b32 s48, s48, 0x1ffff
buffer_load_dwordx4 v[160:163], v2, s[24:27], s48 offen offset:0
s_add_u32 m0, s47, 65536
s_add_u32 s49, s57, 1536
s_and_b32 s49, s49, 0x7ff
buffer_load_dwordx4 v14, s[28:31], s49 offen offset:0 lds
ds_read_b128 v[48:51], v10 offset:49152
ds_read_b128 v[52:55], v10 offset:53248
s_waitcnt vmcnt(47) lgkmcnt(2)
v_mfma_f32_32x32x16_bf16 v[16:31], v[164:167], v[56:59], v[16:31]
v_mfma_f32_32x32x16_bf16 v[32:47], v[164:167], v[60:63], v[32:47]
buffer_load_dwordx4 v[164:167], v2, s[24:27], s48 offen offset:1024
ds_read_b128 v[56:59], v11 offset:49152
ds_read_b128 v[60:63], v11 offset:53248
s_waitcnt vmcnt(47) lgkmcnt(2)
v_mfma_f32_32x32x16_bf16 v[16:31], v[168:171], v[48:51], v[16:31]
v_mfma_f32_32x32x16_bf16 v[32:47], v[168:171], v[52:55], v[32:47]
buffer_load_dwordx4 v[168:171], v2, s[24:27], s48 offen offset:2048
buffer_load_dwordx4 v15, s[28:31], s49 offen offset:1024 lds
ds_read_b128 v[48:51], v8 offset:57344
ds_read_b128 v[52:55], v8 offset:61440
s_waitcnt vmcnt(47) lgkmcnt(2)
v_mfma_f32_32x32x16_bf16 v[16:31], v[172:175], v[56:59], v[16:31]
v_mfma_f32_32x32x16_bf16 v[32:47], v[172:175], v[60:63], v[32:47]
buffer_load_dwordx4 v[172:175], v2, s[24:27], s48 offen offset:3072
ds_read_b128 v[56:59], v9 offset:57344
ds_read_b128 v[60:63], v9 offset:61440
s_waitcnt vmcnt(47) lgkmcnt(2)
v_mfma_f32_32x32x16_bf16 v[16:31], v[176:179], v[48:51], v[16:31]
v_mfma_f32_32x32x16_bf16 v[32:47], v[176:179], v[52:55], v[32:47]
s_add_u32 s48, s56, 94208
s_and_b32 s48, s48, 0x1ffff
buffer_load_dwordx4 v[176:179], v2, s[24:27], s48 offen offset:0
s_add_u32 m0, s47, 73728
s_add_u32 s49, s57, 1536
s_and_b32 s49, s49, 0x7ff
buffer_load_dwordx4 v14, s[32:35], s49 offen offset:0 lds
ds_read_b128 v[48:51], v10 offset:57344
ds_read_b128 v[52:55], v10 offset:61440
s_waitcnt vmcnt(47) lgkmcnt(2)
v_mfma_f32_32x32x16_bf16 v[16:31], v[180:183], v[56:59], v[16:31]
v_mfma_f32_32x32x16_bf16 v[32:47], v[180:183], v[60:63], v[32:47]
buffer_load_dwordx4 v[180:183], v2, s[24:27], s48 offen offset:1024
ds_read_b128 v[56:59], v11 offset:57344
ds_read_b128 v[60:63], v11 offset:61440
s_waitcnt vmcnt(47) lgkmcnt(2)
v_mfma_f32_32x32x16_bf16 v[16:31], v[184:187], v[48:51], v[16:31]
v_mfma_f32_32x32x16_bf16 v[32:47], v[184:187], v[52:55], v[32:47]
buffer_load_dwordx4 v[184:187], v2, s[24:27], s48 offen offset:2048
buffer_load_dwordx4 v15, s[32:35], s49 offen offset:1024 lds
s_waitcnt vmcnt(47) lgkmcnt(0)
s_barrier
ds_read_b128 v[48:51], v4 offset:0
ds_read_b128 v[52:55], v4 offset:4096
v_mfma_f32_32x32x16_bf16 v[16:31], v[188:191], v[56:59], v[16:31]
v_mfma_f32_32x32x16_bf16 v[32:47], v[188:191], v[60:63], v[32:47]
buffer_load_dwordx4 v[188:191], v2, s[24:27], s48 offen offset:3072
ds_read_b128 v[56:59], v5 offset:0
ds_read_b128 v[60:63], v5 offset:4096
s_waitcnt vmcnt(47) lgkmcnt(2)
v_mfma_f32_32x32x16_bf16 v[16:31], v[64:67], v[48:51], v[16:31]
v_mfma_f32_32x32x16_bf16 v[32:47], v[64:67], v[52:55], v[32:47]
s_add_u32 s48, s56, 98304
s_and_b32 s48, s48, 0x1ffff
buffer_load_dwordx4 v[64:67], v2, s[24:27], s48 offen offset:0
s_add_u32 m0, s47, 81920
s_add_u32 s49, s57, 1664
s_and_b32 s49, s49, 0x7ff
buffer_load_dwordx4 v14, s[28:31], s49 offen offset:0 lds
ds_read_b128 v[48:51], v6 offset:0
ds_read_b128 v[52:55], v6 offset:4096
s_waitcnt vmcnt(47) lgkmcnt(2)
v_mfma_f32_32x32x16_bf16 v[16:31], v[68:71], v[56:59], v[16:31]
v_mfma_f32_32x32x16_bf16 v[32:47], v[68:71], v[60:63], v[32:47]
buffer_load_dwordx4 v[68:71], v2, s[24:27], s48 offen offset:1024
ds_read_b128 v[56:59], v7 offset:0
ds_read_b128 v[60:63], v7 offset:4096
s_waitcnt vmcnt(47) lgkmcnt(2)
v_mfma_f32_32x32x16_bf16 v[16:31], v[72:75], v[48:51], v[16:31]
v_mfma_f32_32x32x16_bf16 v[32:47], v[72:75], v[52:55], v[32:47]
buffer_load_dwordx4 v[72:75], v2, s[24:27], s48 offen offset:2048
buffer_load_dwordx4 v15, s[28:31], s49 offen offset:1024 lds
ds_read_b128 v[48:51], v4 offset:8192
ds_read_b128 v[52:55], v4 offset:12288
s_waitcnt vmcnt(47) lgkmcnt(2)
v_mfma_f32_32x32x16_bf16 v[16:31], v[76:79], v[56:59], v[16:31]
v_mfma_f32_32x32x16_bf16 v[32:47], v[76:79], v[60:63], v[32:47]
buffer_load_dwordx4 v[76:79], v2, s[24:27], s48 offen offset:3072
ds_read_b128 v[56:59], v5 offset:8192
ds_read_b128 v[60:63], v5 offset:12288
s_waitcnt vmcnt(47) lgkmcnt(2)
v_mfma_f32_32x32x16_bf16 v[16:31], v[80:83], v[48:51], v[16:31]
v_mfma_f32_32x32x16_bf16 v[32:47], v[80:83], v[52:55], v[32:47]
s_add_u32 s48, s56, 102400
s_and_b32 s48, s48, 0x1ffff
buffer_load_dwordx4 v[80:83], v2, s[24:27], s48 offen offset:0
s_add_u32 m0, s47, 90112
s_add_u32 s49, s57, 1664
s_and_b32 s49, s49, 0x7ff
buffer_load_dwordx4 v14, s[32:35], s49 offen offset:0 lds
ds_read_b128 v[48:51], v6 offset:8192
ds_read_b128 v[52:55], v6 offset:12288
s_waitcnt vmcnt(47) lgkmcnt(2)
v_mfma_f32_32x32x16_bf16 v[16:31], v[84:87], v[56:59], v[16:31]
v_mfma_f32_32x32x16_bf16 v[32:47], v[84:87], v[60:63], v[32:47]
buffer_load_dwordx4 v[84:87], v2, s[24:27], s48 offen offset:1024
ds_read_b128 v[56:59], v7 offset:8192
ds_read_b128 v[60:63], v7 offset:12288
s_waitcnt vmcnt(47) lgkmcnt(2)
v_mfma_f32_32x32x16_bf16 v[16:31], v[88:91], v[48:51], v[16:31]
v_mfma_f32_32x32x16_bf16 v[32:47], v[88:91], v[52:55], v[32:47]
buffer_load_dwordx4 v[88:91], v2, s[24:27], s48 offen offset:2048
buffer_load_dwordx4 v15, s[32:35], s49 offen offset:1024 lds
s_waitcnt vmcnt(47) lgkmcnt(0)
s_barrier
ds_read_b128 v[48:51], v4 offset:16384
ds_read_b128 v[52:55], v4 offset:20480
v_mfma_f32_32x32x16_bf16 v[16:31], v[92:95], v[56:59], v[16:31]
v_mfma_f32_32x32x16_bf16 v[32:47], v[92:95], v[60:63], v[32:47]
buffer_load_dwordx4 v[92:95], v2, s[24:27], s48 offen offset:3072
ds_read_b128 v[56:59], v5 offset:16384
ds_read_b128 v[60:63], v5 offset:20480
s_waitcnt vmcnt(47) lgkmcnt(2)
v_mfma_f32_32x32x16_bf16 v[16:31], v[96:99], v[48:51], v[16:31]
v_mfma_f32_32x32x16_bf16 v[32:47], v[96:99], v[52:55], v[32:47]
s_add_u32 s48, s56, 106496
s_and_b32 s48, s48, 0x1ffff
buffer_load_dwordx4 v[96:99], v2, s[24:27], s48 offen offset:0
s_add_u32 m0, s47, 98304
s_add_u32 s49, s57, 1792
s_and_b32 s49, s49, 0x7ff
buffer_load_dwordx4 v14, s[28:31], s49 offen offset:0 lds
ds_read_b128 v[48:51], v6 offset:16384
ds_read_b128 v[52:55], v6 offset:20480
s_waitcnt vmcnt(47) lgkmcnt(2)
v_mfma_f32_32x32x16_bf16 v[16:31], v[100:103], v[56:59], v[16:31]
v_mfma_f32_32x32x16_bf16 v[32:47], v[100:103], v[60:63], v[32:47]
buffer_load_dwordx4 v[100:103], v2, s[24:27], s48 offen offset:1024
ds_read_b128 v[56:59], v7 offset:16384
ds_read_b128 v[60:63], v7 offset:20480
s_waitcnt vmcnt(47) lgkmcnt(2)
v_mfma_f32_32x32x16_bf16 v[16:31], v[104:107], v[48:51], v[16:31]
v_mfma_f32_32x32x16_bf16 v[32:47], v[104:107], v[52:55], v[32:47]
buffer_load_dwordx4 v[104:107], v2, s[24:27], s48 offen offset:2048
buffer_load_dwordx4 v15, s[28:31], s49 offen offset:1024 lds
ds_read_b128 v[48:51], v4 offset:24576
ds_read_b128 v[52:55], v4 offset:28672
s_waitcnt vmcnt(47) lgkmcnt(2)
v_mfma_f32_32x32x16_bf16 v[16:31], v[108:111], v[56:59], v[16:31]
v_mfma_f32_32x32x16_bf16 v[32:47], v[108:111], v[60:63], v[32:47]
buffer_load_dwordx4 v[108:111], v2, s[24:27], s48 offen offset:3072
ds_read_b128 v[56:59], v5 offset:24576
ds_read_b128 v[60:63], v5 offset:28672
s_waitcnt vmcnt(47) lgkmcnt(2)
v_mfma_f32_32x32x16_bf16 v[16:31], v[112:115], v[48:51], v[16:31]
v_mfma_f32_32x32x16_bf16 v[32:47], v[112:115], v[52:55], v[32:47]
s_add_u32 s48, s56, 110592
s_and_b32 s48, s48, 0x1ffff
buffer_load_dwordx4 v[112:115], v2, s[24:27], s48 offen offset:0
s_add_u32 m0, s47, 106496
s_add_u32 s49, s57, 1792
s_and_b32 s49, s49, 0x7ff
buffer_load_dwordx4 v14, s[32:35], s49 offen offset:0 lds
ds_read_b128 v[48:51], v6 offset:24576
ds_read_b128 v[52:55], v6 offset:28672
s_waitcnt vmcnt(47) lgkmcnt(2)
v_mfma_f32_32x32x16_bf16 v[16:31], v[116:119], v[56:59], v[16:31]
v_mfma_f32_32x32x16_bf16 v[32:47], v[116:119], v[60:63], v[32:47]
buffer_load_dwordx4 v[116:119], v2, s[24:27], s48 offen offset:1024
ds_read_b128 v[56:59], v7 offset:24576
ds_read_b128 v[60:63], v7 offset:28672
s_waitcnt vmcnt(47) lgkmcnt(2)
v_mfma_f32_32x32x16_bf16 v[16:31], v[120:123], v[48:51], v[16:31]
v_mfma_f32_32x32x16_bf16 v[32:47], v[120:123], v[52:55], v[32:47]
buffer_load_dwordx4 v[120:123], v2, s[24:27], s48 offen offset:2048
buffer_load_dwordx4 v15, s[32:35], s49 offen offset:1024 lds
s_waitcnt vmcnt(47) lgkmcnt(0)
s_barrier
ds_read_b128 v[48:51], v4 offset:32768
ds_read_b128 v[52:55], v4 offset:36864
v_mfma_f32_32x32x16_bf16 v[16:31], v[124:127], v[56:59], v[16:31]
v_mfma_f32_32x32x16_bf16 v[32:47], v[124:127], v[60:63], v[32:47]
buffer_load_dwordx4 v[124:127], v2, s[24:27], s48 offen offset:3072
ds_read_b128 v[56:59], v5 offset:32768
ds_read_b128 v[60:63], v5 offset:36864
s_waitcnt vmcnt(47) lgkmcnt(2)
v_mfma_f32_32x32x16_bf16 v[16:31], v[128:131], v[48:51], v[16:31]
v_mfma_f32_32x32x16_bf16 v[32:47], v[128:131], v[52:55], v[32:47]
s_add_u32 s48, s56, 114688
s_and_b32 s48, s48, 0x1ffff
buffer_load_dwordx4 v[128:131], v2, s[24:27], s48 offen offset:0
s_add_u32 m0, s47, 114688
s_add_u32 s49, s57, 1920
s_and_b32 s49, s49, 0x7ff
buffer_load_dwordx4 v14, s[28:31], s49 offen offset:0 lds
ds_read_b128 v[48:51], v6 offset:32768
ds_read_b128 v[52:55], v6 offset:36864
s_waitcnt vmcnt(47) lgkmcnt(2)
v_mfma_f32_32x32x16_bf16 v[16:31], v[132:135], v[56:59], v[16:31]
v_mfma_f32_32x32x16_bf16 v[32:47], v[132:135], v[60:63], v[32:47]
buffer_load_dwordx4 v[132:135], v2, s[24:27], s48 offen offset:1024
ds_read_b128 v[56:59], v7 offset:32768
ds_read_b128 v[60:63], v7 offset:36864
s_waitcnt vmcnt(47) lgkmcnt(2)
v_mfma_f32_32x32x16_bf16 v[16:31], v[136:139], v[48:51], v[16:31]
v_mfma_f32_32x32x16_bf16 v[32:47], v[136:139], v[52:55], v[32:47]
buffer_load_dwordx4 v[136:139], v2, s[24:27], s48 offen offset:2048
buffer_load_dwordx4 v15, s[28:31], s49 offen offset:1024 lds
ds_read_b128 v[48:51], v4 offset:40960
ds_read_b128 v[52:55], v4 offset:45056
s_waitcnt vmcnt(47) lgkmcnt(2)
v_mfma_f32_32x32x16_bf16 v[16:31], v[140:143], v[56:59], v[16:31]
v_mfma_f32_32x32x16_bf16 v[32:47], v[140:143], v[60:63], v[32:47]
buffer_load_dwordx4 v[140:143], v2, s[24:27], s48 offen offset:3072
ds_read_b128 v[56:59], v5 offset:40960
ds_read_b128 v[60:63], v5 offset:45056
s_waitcnt vmcnt(47) lgkmcnt(2)
v_mfma_f32_32x32x16_bf16 v[16:31], v[144:147], v[48:51], v[16:31]
v_mfma_f32_32x32x16_bf16 v[32:47], v[144:147], v[52:55], v[32:47]
s_add_u32 s48, s56, 118784
s_and_b32 s48, s48, 0x1ffff
buffer_load_dwordx4 v[144:147], v2, s[24:27], s48 offen offset:0
s_add_u32 m0, s47, 122880
s_add_u32 s49, s57, 1920
s_and_b32 s49, s49, 0x7ff
buffer_load_dwordx4 v14, s[32:35], s49 offen offset:0 lds
ds_read_b128 v[48:51], v6 offset:40960
ds_read_b128 v[52:55], v6 offset:45056
s_waitcnt vmcnt(47) lgkmcnt(2)
v_mfma_f32_32x32x16_bf16 v[16:31], v[148:151], v[56:59], v[16:31]
v_mfma_f32_32x32x16_bf16 v[32:47], v[148:151], v[60:63], v[32:47]
buffer_load_dwordx4 v[148:151], v2, s[24:27], s48 offen offset:1024
ds_read_b128 v[56:59], v7 offset:40960
ds_read_b128 v[60:63], v7 offset:45056
s_waitcnt vmcnt(47) lgkmcnt(2)
v_mfma_f32_32x32x16_bf16 v[16:31], v[152:155], v[48:51], v[16:31]
v_mfma_f32_32x32x16_bf16 v[32:47], v[152:155], v[52:55], v[32:47]
buffer_load_dwordx4 v[152:155], v2, s[24:27], s48 offen offset:2048
buffer_load_dwordx4 v15, s[32:35], s49 offen offset:1024 lds
s_waitcnt vmcnt(47) lgkmcnt(0)
s_barrier
ds_read_b128 v[48:51], v4 offset:49152
ds_read_b128 v[52:55], v4 offset:53248
v_mfma_f32_32x32x16_bf16 v[16:31], v[156:159], v[56:59], v[16:31]
v_mfma_f32_32x32x16_bf16 v[32:47], v[156:159], v[60:63], v[32:47]
buffer_load_dwordx4 v[156:159], v2, s[24:27], s48 offen offset:3072
ds_read_b128 v[56:59], v5 offset:49152
ds_read_b128 v[60:63], v5 offset:53248
s_waitcnt vmcnt(47) lgkmcnt(2)
v_mfma_f32_32x32x16_bf16 v[16:31], v[160:163], v[48:51], v[16:31]
v_mfma_f32_32x32x16_bf16 v[32:47], v[160:163], v[52:55], v[32:47]
s_add_u32 s48, s56, 122880
s_and_b32 s48, s48, 0x1ffff
buffer_load_dwordx4 v[160:163], v2, s[24:27], s48 offen offset:0
ds_read_b128 v[48:51], v6 offset:49152
ds_read_b128 v[52:55], v6 offset:53248
s_waitcnt vmcnt(46) lgkmcnt(2)
v_mfma_f32_32x32x16_bf16 v[16:31], v[164:167], v[56:59], v[16:31]
v_mfma_f32_32x32x16_bf16 v[32:47], v[164:167], v[60:63], v[32:47]
buffer_load_dwordx4 v[164:167], v2, s[24:27], s48 offen offset:1024
ds_read_b128 v[56:59], v7 offset:49152
ds_read_b128 v[60:63], v7 offset:53248
s_waitcnt vmcnt(46) lgkmcnt(2)
v_mfma_f32_32x32x16_bf16 v[16:31], v[168:171], v[48:51], v[16:31]
v_mfma_f32_32x32x16_bf16 v[32:47], v[168:171], v[52:55], v[32:47]
buffer_load_dwordx4 v[168:171], v2, s[24:27], s48 offen offset:2048
ds_read_b128 v[48:51], v4 offset:57344
ds_read_b128 v[52:55], v4 offset:61440
s_waitcnt vmcnt(45) lgkmcnt(2)
v_mfma_f32_32x32x16_bf16 v[16:31], v[172:175], v[56:59], v[16:31]
v_mfma_f32_32x32x16_bf16 v[32:47], v[172:175], v[60:63], v[32:47]
buffer_load_dwordx4 v[172:175], v2, s[24:27], s48 offen offset:3072
ds_read_b128 v[56:59], v5 offset:57344
ds_read_b128 v[60:63], v5 offset:61440
s_waitcnt vmcnt(45) lgkmcnt(2)
v_mfma_f32_32x32x16_bf16 v[16:31], v[176:179], v[48:51], v[16:31]
v_mfma_f32_32x32x16_bf16 v[32:47], v[176:179], v[52:55], v[32:47]
s_add_u32 s48, s56, 126976
s_and_b32 s48, s48, 0x1ffff
buffer_load_dwordx4 v[176:179], v2, s[24:27], s48 offen offset:0
ds_read_b128 v[48:51], v6 offset:57344
ds_read_b128 v[52:55], v6 offset:61440
s_waitcnt vmcnt(44) lgkmcnt(2)
v_mfma_f32_32x32x16_bf16 v[16:31], v[180:183], v[56:59], v[16:31]
v_mfma_f32_32x32x16_bf16 v[32:47], v[180:183], v[60:63], v[32:47]
buffer_load_dwordx4 v[180:183], v2, s[24:27], s48 offen offset:1024
ds_read_b128 v[56:59], v7 offset:57344
ds_read_b128 v[60:63], v7 offset:61440
s_waitcnt vmcnt(44) lgkmcnt(2)
v_mfma_f32_32x32x16_bf16 v[16:31], v[184:187], v[48:51], v[16:31]
v_mfma_f32_32x32x16_bf16 v[32:47], v[184:187], v[52:55], v[32:47]
buffer_load_dwordx4 v[184:187], v2, s[24:27], s48 offen offset:2048
s_waitcnt vmcnt(43) lgkmcnt(0)
s_barrier
ds_read_b128 v[48:51], v8 offset:0
ds_read_b128 v[52:55], v8 offset:4096
v_mfma_f32_32x32x16_bf16 v[16:31], v[188:191], v[56:59], v[16:31]
v_mfma_f32_32x32x16_bf16 v[32:47], v[188:191], v[60:63], v[32:47]
buffer_load_dwordx4 v[188:191], v2, s[24:27], s48 offen offset:3072
ds_read_b128 v[56:59], v9 offset:0
ds_read_b128 v[60:63], v9 offset:4096
s_waitcnt vmcnt(43) lgkmcnt(2)
v_mfma_f32_32x32x16_bf16 v[16:31], v[64:67], v[48:51], v[16:31]
v_mfma_f32_32x32x16_bf16 v[32:47], v[64:67], v[52:55], v[32:47]
global_load_dword v211, v210, s[12:13]
s_mov_b32 s50, 0
buffer_load_dword v192, v208, s[36:39], s50 offen offset:0
ds_read_b128 v[48:51], v10 offset:0
ds_read_b128 v[52:55], v10 offset:4096
s_waitcnt vmcnt(43) lgkmcnt(2)
v_mfma_f32_32x32x16_bf16 v[16:31], v[68:71], v[56:59], v[16:31]
v_mfma_f32_32x32x16_bf16 v[32:47], v[68:71], v[60:63], v[32:47]
s_mov_b32 s50, 0
buffer_load_dword v193, v208, s[36:39], s50 offen offset:2048
ds_read_b128 v[56:59], v11 offset:0
ds_read_b128 v[60:63], v11 offset:4096
s_waitcnt vmcnt(43) lgkmcnt(2)
v_mfma_f32_32x32x16_bf16 v[16:31], v[72:75], v[48:51], v[16:31]
v_mfma_f32_32x32x16_bf16 v[32:47], v[72:75], v[52:55], v[32:47]
s_mov_b32 s50, 4096
buffer_load_dword v194, v208, s[36:39], s50 offen offset:0
ds_read_b128 v[48:51], v8 offset:8192
ds_read_b128 v[52:55], v8 offset:12288
s_waitcnt vmcnt(42) lgkmcnt(2)
v_mfma_f32_32x32x16_bf16 v[16:31], v[76:79], v[56:59], v[16:31]
v_mfma_f32_32x32x16_bf16 v[32:47], v[76:79], v[60:63], v[32:47]
s_mov_b32 s50, 4096
buffer_load_dword v195, v208, s[36:39], s50 offen offset:2048
ds_read_b128 v[56:59], v9 offset:8192
ds_read_b128 v[60:63], v9 offset:12288
s_waitcnt vmcnt(42) lgkmcnt(2)
v_mfma_f32_32x32x16_bf16 v[16:31], v[80:83], v[48:51], v[16:31]
v_mfma_f32_32x32x16_bf16 v[32:47], v[80:83], v[52:55], v[32:47]
s_mov_b32 s50, 32768
buffer_load_dword v196, v208, s[36:39], s50 offen offset:0
ds_read_b128 v[48:51], v10 offset:8192
ds_read_b128 v[52:55], v10 offset:12288
s_waitcnt vmcnt(41) lgkmcnt(2)
v_mfma_f32_32x32x16_bf16 v[16:31], v[84:87], v[56:59], v[16:31]
v_mfma_f32_32x32x16_bf16 v[32:47], v[84:87], v[60:63], v[32:47]
s_mov_b32 s50, 32768
buffer_load_dword v197, v208, s[36:39], s50 offen offset:2048
ds_read_b128 v[56:59], v11 offset:8192
ds_read_b128 v[60:63], v11 offset:12288
s_waitcnt vmcnt(41) lgkmcnt(2)
v_mfma_f32_32x32x16_bf16 v[16:31], v[88:91], v[48:51], v[16:31]
v_mfma_f32_32x32x16_bf16 v[32:47], v[88:91], v[52:55], v[32:47]
s_mov_b32 s50, 36864
buffer_load_dword v198, v208, s[36:39], s50 offen offset:0
s_waitcnt vmcnt(40) lgkmcnt(0)
s_barrier
ds_read_b128 v[48:51], v8 offset:16384
ds_read_b128 v[52:55], v8 offset:20480
v_mfma_f32_32x32x16_bf16 v[16:31], v[92:95], v[56:59], v[16:31]
v_mfma_f32_32x32x16_bf16 v[32:47], v[92:95], v[60:63], v[32:47]
s_mov_b32 s50, 36864
buffer_load_dword v199, v208, s[36:39], s50 offen offset:2048
ds_read_b128 v[56:59], v9 offset:16384
ds_read_b128 v[60:63], v9 offset:20480
s_waitcnt vmcnt(40) lgkmcnt(2)
v_mfma_f32_32x32x16_bf16 v[16:31], v[96:99], v[48:51], v[16:31]
v_mfma_f32_32x32x16_bf16 v[32:47], v[96:99], v[52:55], v[32:47]
s_mov_b32 s50, 65536
buffer_load_dword v200, v208, s[36:39], s50 offen offset:0
ds_read_b128 v[48:51], v10 offset:16384
ds_read_b128 v[52:55], v10 offset:20480
s_waitcnt vmcnt(39) lgkmcnt(2)
v_mfma_f32_32x32x16_bf16 v[16:31], v[100:103], v[56:59], v[16:31]
v_mfma_f32_32x32x16_bf16 v[32:47], v[100:103], v[60:63], v[32:47]
s_mov_b32 s50, 65536
buffer_load_dword v201, v208, s[36:39], s50 offen offset:2048
ds_read_b128 v[56:59], v11 offset:16384
ds_read_b128 v[60:63], v11 offset:20480
s_waitcnt vmcnt(39) lgkmcnt(2)
v_mfma_f32_32x32x16_bf16 v[16:31], v[104:107], v[48:51], v[16:31]
v_mfma_f32_32x32x16_bf16 v[32:47], v[104:107], v[52:55], v[32:47]
s_mov_b32 s50, 69632
buffer_load_dword v202, v208, s[36:39], s50 offen offset:0
ds_read_b128 v[48:51], v8 offset:24576
ds_read_b128 v[52:55], v8 offset:28672
s_waitcnt vmcnt(38) lgkmcnt(2)
v_mfma_f32_32x32x16_bf16 v[16:31], v[108:111], v[56:59], v[16:31]
v_mfma_f32_32x32x16_bf16 v[32:47], v[108:111], v[60:63], v[32:47]
s_mov_b32 s50, 69632
buffer_load_dword v203, v208, s[36:39], s50 offen offset:2048
ds_read_b128 v[56:59], v9 offset:24576
ds_read_b128 v[60:63], v9 offset:28672
s_waitcnt vmcnt(38) lgkmcnt(2)
v_mfma_f32_32x32x16_bf16 v[16:31], v[112:115], v[48:51], v[16:31]
v_mfma_f32_32x32x16_bf16 v[32:47], v[112:115], v[52:55], v[32:47]
s_mov_b32 s50, 98304
buffer_load_dword v204, v208, s[36:39], s50 offen offset:0
ds_read_b128 v[48:51], v10 offset:24576
ds_read_b128 v[52:55], v10 offset:28672
s_waitcnt vmcnt(37) lgkmcnt(2)
v_mfma_f32_32x32x16_bf16 v[16:31], v[116:119], v[56:59], v[16:31]
v_mfma_f32_32x32x16_bf16 v[32:47], v[116:119], v[60:63], v[32:47]
s_mov_b32 s50, 98304
buffer_load_dword v205, v208, s[36:39], s50 offen offset:2048
ds_read_b128 v[56:59], v11 offset:24576
ds_read_b128 v[60:63], v11 offset:28672
s_waitcnt vmcnt(37) lgkmcnt(2)
v_mfma_f32_32x32x16_bf16 v[16:31], v[120:123], v[48:51], v[16:31]
v_mfma_f32_32x32x16_bf16 v[32:47], v[120:123], v[52:55], v[32:47]
s_mov_b32 s50, 102400
buffer_load_dword v206, v208, s[36:39], s50 offen offset:0
s_waitcnt vmcnt(36) lgkmcnt(0)
s_barrier
ds_read_b128 v[48:51], v8 offset:32768
ds_read_b128 v[52:55], v8 offset:36864
v_mfma_f32_32x32x16_bf16 v[16:31], v[124:127], v[56:59], v[16:31]
v_mfma_f32_32x32x16_bf16 v[32:47], v[124:127], v[60:63], v[32:47]
s_mov_b32 s50, 102400
buffer_load_dword v207, v208, s[36:39], s50 offen offset:2048
ds_read_b128 v[56:59], v9 offset:32768
ds_read_b128 v[60:63], v9 offset:36864
s_waitcnt vmcnt(36) lgkmcnt(2)
v_mfma_f32_32x32x16_bf16 v[16:31], v[128:131], v[48:51], v[16:31]
v_mfma_f32_32x32x16_bf16 v[32:47], v[128:131], v[52:55], v[32:47]
ds_read_b128 v[48:51], v10 offset:32768
ds_read_b128 v[52:55], v10 offset:36864
s_waitcnt vmcnt(34) lgkmcnt(2)
v_mfma_f32_32x32x16_bf16 v[16:31], v[132:135], v[56:59], v[16:31]
v_mfma_f32_32x32x16_bf16 v[32:47], v[132:135], v[60:63], v[32:47]
ds_read_b128 v[56:59], v11 offset:32768
ds_read_b128 v[60:63], v11 offset:36864
s_waitcnt vmcnt(33) lgkmcnt(2)
v_mfma_f32_32x32x16_bf16 v[16:31], v[136:139], v[48:51], v[16:31]
v_mfma_f32_32x32x16_bf16 v[32:47], v[136:139], v[52:55], v[32:47]
ds_read_b128 v[48:51], v8 offset:40960
ds_read_b128 v[52:55], v8 offset:45056
s_waitcnt vmcnt(31) lgkmcnt(2)
v_mfma_f32_32x32x16_bf16 v[16:31], v[140:143], v[56:59], v[16:31]
v_mfma_f32_32x32x16_bf16 v[32:47], v[140:143], v[60:63], v[32:47]
ds_read_b128 v[56:59], v9 offset:40960
ds_read_b128 v[60:63], v9 offset:45056
s_waitcnt vmcnt(30) lgkmcnt(2)
v_mfma_f32_32x32x16_bf16 v[16:31], v[144:147], v[48:51], v[16:31]
v_mfma_f32_32x32x16_bf16 v[32:47], v[144:147], v[52:55], v[32:47]
ds_read_b128 v[48:51], v10 offset:40960
ds_read_b128 v[52:55], v10 offset:45056
s_waitcnt vmcnt(28) lgkmcnt(2)
v_mfma_f32_32x32x16_bf16 v[16:31], v[148:151], v[56:59], v[16:31]
v_mfma_f32_32x32x16_bf16 v[32:47], v[148:151], v[60:63], v[32:47]
ds_read_b128 v[56:59], v11 offset:40960
ds_read_b128 v[60:63], v11 offset:45056
s_waitcnt vmcnt(27) lgkmcnt(2)
v_mfma_f32_32x32x16_bf16 v[16:31], v[152:155], v[48:51], v[16:31]
v_mfma_f32_32x32x16_bf16 v[32:47], v[152:155], v[52:55], v[32:47]
s_waitcnt vmcnt(25) lgkmcnt(0)
s_barrier
ds_read_b128 v[48:51], v8 offset:49152
ds_read_b128 v[52:55], v8 offset:53248
v_mfma_f32_32x32x16_bf16 v[16:31], v[156:159], v[56:59], v[16:31]
v_mfma_f32_32x32x16_bf16 v[32:47], v[156:159], v[60:63], v[32:47]
ds_read_b128 v[56:59], v9 offset:49152
ds_read_b128 v[60:63], v9 offset:53248
s_waitcnt vmcnt(24) lgkmcnt(2)
v_mfma_f32_32x32x16_bf16 v[16:31], v[160:163], v[48:51], v[16:31]
v_mfma_f32_32x32x16_bf16 v[32:47], v[160:163], v[52:55], v[32:47]
ds_read_b128 v[48:51], v10 offset:49152
ds_read_b128 v[52:55], v10 offset:53248
s_waitcnt vmcnt(23) lgkmcnt(2)
v_mfma_f32_32x32x16_bf16 v[16:31], v[164:167], v[56:59], v[16:31]
v_mfma_f32_32x32x16_bf16 v[32:47], v[164:167], v[60:63], v[32:47]
ds_read_b128 v[56:59], v11 offset:49152
ds_read_b128 v[60:63], v11 offset:53248
s_waitcnt vmcnt(22) lgkmcnt(2)
v_mfma_f32_32x32x16_bf16 v[16:31], v[168:171], v[48:51], v[16:31]
v_mfma_f32_32x32x16_bf16 v[32:47], v[168:171], v[52:55], v[32:47]
ds_read_b128 v[48:51], v8 offset:57344
ds_read_b128 v[52:55], v8 offset:61440
s_waitcnt vmcnt(21) lgkmcnt(2)
v_mfma_f32_32x32x16_bf16 v[16:31], v[172:175], v[56:59], v[16:31]
v_mfma_f32_32x32x16_bf16 v[32:47], v[172:175], v[60:63], v[32:47]
ds_read_b128 v[56:59], v9 offset:57344
ds_read_b128 v[60:63], v9 offset:61440
s_waitcnt vmcnt(20) lgkmcnt(2)
v_mfma_f32_32x32x16_bf16 v[16:31], v[176:179], v[48:51], v[16:31]
v_mfma_f32_32x32x16_bf16 v[32:47], v[176:179], v[52:55], v[32:47]
ds_read_b128 v[48:51], v10 offset:57344
ds_read_b128 v[52:55], v10 offset:61440
s_waitcnt vmcnt(19) lgkmcnt(2)
v_mfma_f32_32x32x16_bf16 v[16:31], v[180:183], v[56:59], v[16:31]
v_mfma_f32_32x32x16_bf16 v[32:47], v[180:183], v[60:63], v[32:47]
ds_read_b128 v[56:59], v11 offset:57344
ds_read_b128 v[60:63], v11 offset:61440
s_waitcnt vmcnt(18) lgkmcnt(2)
v_mfma_f32_32x32x16_bf16 v[16:31], v[184:187], v[48:51], v[16:31]
v_mfma_f32_32x32x16_bf16 v[32:47], v[184:187], v[52:55], v[32:47]
s_waitcnt vmcnt(17) lgkmcnt(0)
v_mfma_f32_32x32x16_bf16 v[16:31], v[188:191], v[56:59], v[16:31]
v_mfma_f32_32x32x16_bf16 v[32:47], v[188:191], v[60:63], v[32:47]
s_waitcnt vmcnt(0)
v_lshlrev_b32 v212, 16, v211
v_and_b32 v213, 0xffff0000, v211
v_lshlrev_b32 v64, 16, v192
v_and_b32 v65, 0xffff0000, v192
v_pk_mul_f32 v[64:65], v[64:65], v[212:213]
v_cvt_pk_bf16_f32 v66, v64, v65
v_lshlrev_b32 v64, 16, v66
v_and_b32 v65, 0xffff0000, v66
s_nop 1
v_add_f32 v64, v64, v16
v_add_f32 v65, v65, v32
s_mov_b32 s50, 0
buffer_store_dwordx2 v[64:65], v209, s[40:43], s50 offen
v_lshlrev_b32 v68, 16, v193
v_and_b32 v69, 0xffff0000, v193
v_pk_mul_f32 v[68:69], v[68:69], v[212:213]
v_cvt_pk_bf16_f32 v70, v68, v69
v_lshlrev_b32 v68, 16, v70
v_and_b32 v69, 0xffff0000, v70
v_add_f32 v68, v68, v17
v_add_f32 v69, v69, v33
s_mov_b32 s50, 8192
buffer_store_dwordx2 v[68:69], v209, s[40:43], s50 offen
v_lshlrev_b32 v72, 16, v194
v_and_b32 v73, 0xffff0000, v194
v_pk_mul_f32 v[72:73], v[72:73], v[212:213]
v_cvt_pk_bf16_f32 v74, v72, v73
v_lshlrev_b32 v72, 16, v74
v_and_b32 v73, 0xffff0000, v74
v_add_f32 v72, v72, v18
v_add_f32 v73, v73, v34
s_mov_b32 s50, 16384
buffer_store_dwordx2 v[72:73], v209, s[40:43], s50 offen
v_lshlrev_b32 v76, 16, v195
v_and_b32 v77, 0xffff0000, v195
v_pk_mul_f32 v[76:77], v[76:77], v[212:213]
v_cvt_pk_bf16_f32 v78, v76, v77
v_lshlrev_b32 v76, 16, v78
v_and_b32 v77, 0xffff0000, v78
v_add_f32 v76, v76, v19
v_add_f32 v77, v77, v35
s_mov_b32 s50, 24576
buffer_store_dwordx2 v[76:77], v209, s[40:43], s50 offen
v_lshlrev_b32 v80, 16, v196
v_and_b32 v81, 0xffff0000, v196
v_pk_mul_f32 v[80:81], v[80:81], v[212:213]
v_cvt_pk_bf16_f32 v82, v80, v81
v_lshlrev_b32 v80, 16, v82
v_and_b32 v81, 0xffff0000, v82
v_add_f32 v80, v80, v20
v_add_f32 v81, v81, v36
s_mov_b32 s50, 131072
buffer_store_dwordx2 v[80:81], v209, s[40:43], s50 offen
v_lshlrev_b32 v84, 16, v197
v_and_b32 v85, 0xffff0000, v197
v_pk_mul_f32 v[84:85], v[84:85], v[212:213]
v_cvt_pk_bf16_f32 v86, v84, v85
v_lshlrev_b32 v84, 16, v86
v_and_b32 v85, 0xffff0000, v86
v_add_f32 v84, v84, v21
v_add_f32 v85, v85, v37
s_mov_b32 s50, 139264
buffer_store_dwordx2 v[84:85], v209, s[40:43], s50 offen
v_lshlrev_b32 v88, 16, v198
v_and_b32 v89, 0xffff0000, v198
v_pk_mul_f32 v[88:89], v[88:89], v[212:213]
v_cvt_pk_bf16_f32 v90, v88, v89
v_lshlrev_b32 v88, 16, v90
v_and_b32 v89, 0xffff0000, v90
v_add_f32 v88, v88, v22
v_add_f32 v89, v89, v38
s_mov_b32 s50, 147456
buffer_store_dwordx2 v[88:89], v209, s[40:43], s50 offen
v_lshlrev_b32 v92, 16, v199
v_and_b32 v93, 0xffff0000, v199
v_pk_mul_f32 v[92:93], v[92:93], v[212:213]
v_cvt_pk_bf16_f32 v94, v92, v93
v_lshlrev_b32 v92, 16, v94
v_and_b32 v93, 0xffff0000, v94
v_add_f32 v92, v92, v23
v_add_f32 v93, v93, v39
s_mov_b32 s50, 155648
buffer_store_dwordx2 v[92:93], v209, s[40:43], s50 offen
v_lshlrev_b32 v96, 16, v200
v_and_b32 v97, 0xffff0000, v200
v_pk_mul_f32 v[96:97], v[96:97], v[212:213]
v_cvt_pk_bf16_f32 v98, v96, v97
v_lshlrev_b32 v96, 16, v98
v_and_b32 v97, 0xffff0000, v98
v_add_f32 v96, v96, v24
v_add_f32 v97, v97, v40
s_mov_b32 s50, 262144
buffer_store_dwordx2 v[96:97], v209, s[40:43], s50 offen
v_lshlrev_b32 v100, 16, v201
v_and_b32 v101, 0xffff0000, v201
v_pk_mul_f32 v[100:101], v[100:101], v[212:213]
v_cvt_pk_bf16_f32 v102, v100, v101
v_lshlrev_b32 v100, 16, v102
v_and_b32 v101, 0xffff0000, v102
v_add_f32 v100, v100, v25
v_add_f32 v101, v101, v41
s_mov_b32 s50, 270336
buffer_store_dwordx2 v[100:101], v209, s[40:43], s50 offen
v_lshlrev_b32 v104, 16, v202
v_and_b32 v105, 0xffff0000, v202
v_pk_mul_f32 v[104:105], v[104:105], v[212:213]
v_cvt_pk_bf16_f32 v106, v104, v105
v_lshlrev_b32 v104, 16, v106
v_and_b32 v105, 0xffff0000, v106
v_add_f32 v104, v104, v26
v_add_f32 v105, v105, v42
s_mov_b32 s50, 278528
buffer_store_dwordx2 v[104:105], v209, s[40:43], s50 offen
v_lshlrev_b32 v108, 16, v203
v_and_b32 v109, 0xffff0000, v203
v_pk_mul_f32 v[108:109], v[108:109], v[212:213]
v_cvt_pk_bf16_f32 v110, v108, v109
v_lshlrev_b32 v108, 16, v110
v_and_b32 v109, 0xffff0000, v110
v_add_f32 v108, v108, v27
v_add_f32 v109, v109, v43
s_mov_b32 s50, 286720
buffer_store_dwordx2 v[108:109], v209, s[40:43], s50 offen
v_lshlrev_b32 v112, 16, v204
v_and_b32 v113, 0xffff0000, v204
v_pk_mul_f32 v[112:113], v[112:113], v[212:213]
v_cvt_pk_bf16_f32 v114, v112, v113
v_lshlrev_b32 v112, 16, v114
v_and_b32 v113, 0xffff0000, v114
v_add_f32 v112, v112, v28
v_add_f32 v113, v113, v44
s_mov_b32 s50, 393216
buffer_store_dwordx2 v[112:113], v209, s[40:43], s50 offen
v_lshlrev_b32 v116, 16, v205
v_and_b32 v117, 0xffff0000, v205
v_pk_mul_f32 v[116:117], v[116:117], v[212:213]
v_cvt_pk_bf16_f32 v118, v116, v117
v_lshlrev_b32 v116, 16, v118
v_and_b32 v117, 0xffff0000, v118
v_add_f32 v116, v116, v29
v_add_f32 v117, v117, v45
s_mov_b32 s50, 401408
buffer_store_dwordx2 v[116:117], v209, s[40:43], s50 offen
v_lshlrev_b32 v120, 16, v206
v_and_b32 v121, 0xffff0000, v206
v_pk_mul_f32 v[120:121], v[120:121], v[212:213]
v_cvt_pk_bf16_f32 v122, v120, v121
v_lshlrev_b32 v120, 16, v122
v_and_b32 v121, 0xffff0000, v122
v_add_f32 v120, v120, v30
v_add_f32 v121, v121, v46
s_mov_b32 s50, 409600
buffer_store_dwordx2 v[120:121], v209, s[40:43], s50 offen
v_lshlrev_b32 v124, 16, v207
v_and_b32 v125, 0xffff0000, v207
v_pk_mul_f32 v[124:125], v[124:125], v[212:213]
v_cvt_pk_bf16_f32 v126, v124, v125
v_lshlrev_b32 v124, 16, v126
v_and_b32 v125, 0xffff0000, v126
v_add_f32 v124, v124, v31
v_add_f32 v125, v125, v47
s_mov_b32 s50, 417792
buffer_store_dwordx2 v[124:125], v209, s[40:43], s50 offen
L_g2_kernel_end:
s_endpgm
.globl a3_kernel
.p2align 8
.type a3_kernel,@function
a3_kernel:
s_cmp_ge_u32 s2, 256
s_cbranch_scc1 L_a3_kernel_end
v_lshrrev_b32 v2, 6, v0
v_and_b32 v1, 63, v0
v_readfirstlane_b32 s20, v2
s_load_dwordx2 s[14:15], s[0:1], 96
s_load_dwordx2 s[18:19], s[0:1], 112
s_getpc_b64 s[52:53]
L_pc4:
s_add_u32 s52, s52, tables-L_pc4
s_addc_u32 s53, s53, 0
s_waitcnt lgkmcnt(0)
s_lshl_b32 s44, s2, 14
s_add_u32 s44, s44, 20971520
s_add_u32 s24, s18, s44
s_addc_u32 s25, s19, 0
s_mov_b32 s26, 0x4000
s_mov_b32 s27, 0x20000
v_and_b32 v2, 31, v1
v_lshrrev_b32 v3, 5, v1
v_lshlrev_b32 v5, 4, v2
v_lshl_add_u32 v5, v3, 11, v5
s_mov_b32 s48, 0
buffer_load_dwordx4 v[8:11], v5, s[24:27], s48 offen offset:0
buffer_load_dwordx4 v[12:15], v5, s[24:27], s48 offen offset:512
buffer_load_dwordx4 v[16:19], v5, s[24:27], s48 offen offset:1024
buffer_load_dwordx4 v[20:23], v5, s[24:27], s48 offen offset:1536
s_mov_b32 s48, 4096
buffer_load_dwordx4 v[24:27], v5, s[24:27], s48 offen offset:0
buffer_load_dwordx4 v[28:31], v5, s[24:27], s48 offen offset:512
buffer_load_dwordx4 v[32:35], v5, s[24:27], s48 offen offset:1024
buffer_load_dwordx4 v[36:39], v5, s[24:27], s48 offen offset:1536
s_mov_b32 s48, 8192
buffer_load_dwordx4 v[40:43], v5, s[24:27], s48 offen offset:0
buffer_load_dwordx4 v[44:47], v5, s[24:27], s48 offen offset:512
buffer_load_dwordx4 v[48:51], v5, s[24:27], s48 offen offset:1024
buffer_load_dwordx4 v[52:55], v5, s[24:27], s48 offen offset:1536
s_mov_b32 s48, 12288
buffer_load_dwordx4 v[56:59], v5, s[24:27], s48 offen offset:0
buffer_load_dwordx4 v[60:63], v5, s[24:27], s48 offen offset:512
buffer_load_dwordx4 v[64:67], v5, s[24:27], s48 offen offset:1024
buffer_load_dwordx4 v[68:71], v5, s[24:27], s48 offen offset:1536
v_lshlrev_b32 v4, 4, v1
v_add_u32 v6, 2048, v4
global_load_dwordx4 v[192:195], v6, s[52:53] offset:0
global_load_dwordx4 v[196:199], v6, s[52:53] offset:1024
global_load_dwordx4 v[200:203], v6, s[52:53] offset:2048
global_load_dwordx4 v[204:207], v6, s[52:53] offset:3072
v_add_u32 v6, 6144, v4
global_load_dwordx4 v[208:211], v6, s[52:53] offset:0
global_load_dwordx4 v[212:215], v6, s[52:53] offset:1024
global_load_dwordx4 v[216:219], v6, s[52:53] offset:2048
global_load_dwordx4 v[220:223], v6, s[52:53] offset:3072
v_add_u32 v6, 10240, v4
global_load_dwordx4 v[224:227], v6, s[52:53] offset:0
global_load_dwordx4 v[228:231], v6, s[52:53] offset:1024
global_load_dwordx4 v[232:235], v6, s[52:53] offset:2048
global_load_dwordx4 v[236:239], v6, s[52:53] offset:3072
v_add_u32 v6, 14336, v4
global_load_dwordx4 v[240:243], v6, s[52:53] offset:0
global_load_dwordx4 v[244:247], v6, s[52:53] offset:1024
global_load_dwordx4 v[248:251], v6, s[52:53] offset:2048
global_load_dwordx4 v[252:255], v6, s[52:53] offset:3072
s_and_b32 s44, s2, 31
s_lshr_b32 s45, s2, 5
s_lshl_b32 s45, s45, 7
s_add_u32 s44, s44, s45
s_lshl_b32 s44, s44, 14
s_add_u32 s28, s14, s44
s_addc_u32 s29, s15, 0
s_sub_u32 s30, 0x1000000, s44
s_mov_b32 s31, 0x20000
v_lshlrev_b32 v7, 2, v2
v_lshl_add_u32 v7, v3, 9, v7
s_waitcnt vmcnt(16)
v_swap_b32 v9, v12
v_swap_b32 v10, v16
v_swap_b32 v11, v20
v_swap_b32 v14, v17
v_swap_b32 v15, v21
v_swap_b32 v19, v22
v_swap_b32 v25, v28
v_swap_b32 v26, v32
v_swap_b32 v27, v36
v_swap_b32 v30, v33
v_swap_b32 v31, v37
v_swap_b32 v35, v38
v_swap_b32 v41, v44
v_swap_b32 v42, v48
v_swap_b32 v43, v52
v_swap_b32 v46, v49
v_swap_b32 v47, v53
v_swap_b32 v51, v54
v_swap_b32 v57, v60
v_swap_b32 v58, v64
v_swap_b32 v59, v68
v_swap_b32 v62, v65
v_swap_b32 v63, v69
v_swap_b32 v67, v70
s_waitcnt vmcnt(0)
s_mov_b32 s46, 0x35000000
s_mov_b32 s47, 0x35000000
v_pk_mul_f32 v[224:225], s[46:47], v[224:225]
v_pk_mul_f32 v[226:227], s[46:47], v[226:227]
v_pk_mul_f32 v[228:229], s[46:47], v[228:229]
v_pk_mul_f32 v[230:231], s[46:47], v[230:231]
v_pk_mul_f32 v[232:233], s[46:47], v[232:233]
v_pk_mul_f32 v[234:235], s[46:47], v[234:235]
v_pk_mul_f32 v[236:237], s[46:47], v[236:237]
v_pk_mul_f32 v[238:239], s[46:47], v[238:239]
v_pk_mul_f32 v[240:241], s[46:47], v[240:241]
v_pk_mul_f32 v[242:243], s[46:47], v[242:243]
v_pk_mul_f32 v[244:245], s[46:47], v[244:245]
v_pk_mul_f32 v[246:247], s[46:47], v[246:247]
v_pk_mul_f32 v[248:249], s[46:47], v[248:249]
v_pk_mul_f32 v[250:251], s[46:47], v[250:251]
v_pk_mul_f32 v[252:253], s[46:47], v[252:253]
v_pk_mul_f32 v[254:255], s[46:47], v[254:255]
v_mfma_f32_32x32x16_bf16 v[72:87], v[8:11], v[192:195], 0
v_mfma_f32_32x32x16_bf16 v[72:87], v[24:27], v[196:199], v[72:87]
v_mfma_f32_32x32x16_bf16 v[72:87], v[40:43], v[200:203], v[72:87]
v_mfma_f32_32x32x16_bf16 v[72:87], v[56:59], v[204:207], v[72:87]
v_mfma_f32_32x32x16_bf16 v[88:103], v[8:11], v[208:211], 0
v_mfma_f32_32x32x16_bf16 v[88:103], v[24:27], v[212:215], v[88:103]
v_mfma_f32_32x32x16_bf16 v[88:103], v[40:43], v[216:219], v[88:103]
v_mfma_f32_32x32x16_bf16 v[88:103], v[56:59], v[220:223], v[88:103]
v_mfma_f32_32x32x16_bf16 v[104:119], v[12:15], v[192:195], 0
v_mfma_f32_32x32x16_bf16 v[104:119], v[28:31], v[196:199], v[104:119]
v_mfma_f32_32x32x16_bf16 v[104:119], v[44:47], v[200:203], v[104:119]
v_mfma_f32_32x32x16_bf16 v[104:119], v[60:63], v[204:207], v[104:119]
v_mfma_f32_32x32x16_bf16 v[120:135], v[12:15], v[208:211], 0
v_mfma_f32_32x32x16_bf16 v[120:135], v[28:31], v[212:215], v[120:135]
v_mfma_f32_32x32x16_bf16 v[120:135], v[44:47], v[216:219], v[120:135]
v_mfma_f32_32x32x16_bf16 v[120:135], v[60:63], v[220:223], v[120:135]
v_pk_mul_f32 v[152:153], v[72:73], v[224:225]
v_pk_mul_f32 v[154:155], v[72:73], v[240:241]
s_nop 1
v_pk_fma_f32 v[152:153], v[88:89], v[240:241], v[152:153] neg_lo:[1,0,0] neg_hi:[1,0,0]
v_pk_fma_f32 v[154:155], v[88:89], v[224:225], v[154:155]
v_cvt_pk_bf16_f32 v136, v152, v154
v_cvt_pk_bf16_f32 v137, v153, v155
v_pk_mul_f32 v[156:157], v[74:75], v[226:227]
v_pk_mul_f32 v[158:159], v[74:75], v[242:243]
v_pk_fma_f32 v[156:157], v[90:91], v[242:243], v[156:157] neg_lo:[1,0,0] neg_hi:[1,0,0]
v_pk_fma_f32 v[158:159], v[90:91], v[226:227], v[158:159]
v_cvt_pk_bf16_f32 v138, v156, v158
v_cvt_pk_bf16_f32 v139, v157, v159
v_pk_mul_f32 v[152:153], v[76:77], v[228:229]
v_pk_mul_f32 v[154:155], v[76:77], v[244:245]
v_pk_fma_f32 v[152:153], v[92:93], v[244:245], v[152:153] neg_lo:[1,0,0] neg_hi:[1,0,0]
v_pk_fma_f32 v[154:155], v[92:93], v[228:229], v[154:155]
v_cvt_pk_bf16_f32 v140, v152, v154
v_cvt_pk_bf16_f32 v141, v153, v155
v_pk_mul_f32 v[156:157], v[78:79], v[230:231]
v_pk_mul_f32 v[158:159], v[78:79], v[246:247]
v_pk_fma_f32 v[156:157], v[94:95], v[246:247], v[156:157] neg_lo:[1,0,0] neg_hi:[1,0,0]
v_pk_fma_f32 v[158:159], v[94:95], v[230:231], v[158:159]
v_cvt_pk_bf16_f32 v142, v156, v158
v_cvt_pk_bf16_f32 v143, v157, v159
v_pk_mul_f32 v[152:153], v[80:81], v[232:233]
v_pk_mul_f32 v[154:155], v[80:81], v[248:249]
v_pk_fma_f32 v[152:153], v[96:97], v[248:249], v[152:153] neg_lo:[1,0,0] neg_hi:[1,0,0]
v_pk_fma_f32 v[154:155], v[96:97], v[232:233], v[154:155]
v_cvt_pk_bf16_f32 v144, v152, v154
v_cvt_pk_bf16_f32 v145, v153, v155
v_pk_mul_f32 v[156:157], v[82:83], v[234:235]
v_pk_mul_f32 v[158:159], v[82:83], v[250:251]
v_pk_fma_f32 v[156:157], v[98:99], v[250:251], v[156:157] neg_lo:[1,0,0] neg_hi:[1,0,0]
v_pk_fma_f32 v[158:159], v[98:99], v[234:235], v[158:159]
v_cvt_pk_bf16_f32 v146, v156, v158
v_cvt_pk_bf16_f32 v147, v157, v159
v_pk_mul_f32 v[152:153], v[84:85], v[236:237]
v_pk_mul_f32 v[154:155], v[84:85], v[252:253]
v_pk_fma_f32 v[152:153], v[100:101], v[252:253], v[152:153] neg_lo:[1,0,0] neg_hi:[1,0,0]
v_pk_fma_f32 v[154:155], v[100:101], v[236:237], v[154:155]
v_cvt_pk_bf16_f32 v148, v152, v154
v_cvt_pk_bf16_f32 v149, v153, v155
v_pk_mul_f32 v[156:157], v[86:87], v[238:239]
v_pk_mul_f32 v[158:159], v[86:87], v[254:255]
v_pk_fma_f32 v[156:157], v[102:103], v[254:255], v[156:157] neg_lo:[1,0,0] neg_hi:[1,0,0]
v_pk_fma_f32 v[158:159], v[102:103], v[238:239], v[158:159]
v_cvt_pk_bf16_f32 v150, v156, v158
v_cvt_pk_bf16_f32 v151, v157, v159
v_mfma_f32_32x32x16_bf16 v[72:87], v[192:195], v[136:139], 0
v_mfma_f32_32x32x16_bf16 v[72:87], v[196:199], v[140:143], v[72:87]
v_mfma_f32_32x32x16_bf16 v[72:87], v[200:203], v[144:147], v[72:87]
v_mfma_f32_32x32x16_bf16 v[72:87], v[204:207], v[148:151], v[72:87]
v_mfma_f32_32x32x16_bf16 v[88:103], v[208:211], v[136:139], 0
v_mfma_f32_32x32x16_bf16 v[88:103], v[212:215], v[140:143], v[88:103]
v_mfma_f32_32x32x16_bf16 v[88:103], v[216:219], v[144:147], v[88:103]
v_mfma_f32_32x32x16_bf16 v[88:103], v[220:223], v[148:151], v[88:103]
s_mov_b32 s48, 0
s_mov_b32 s49, 8192
s_nop 9
v_cvt_pk_bf16_f32 v161, v88, v72
v_lshlrev_b32 v160, 16, v161
v_and_b32 v161, 0xffff0000, v161
buffer_store_dword v160, v7, s[28:31], s48 offen offset:0
buffer_store_dword v161, v7, s[28:31], s49 offen offset:0
v_cvt_pk_bf16_f32 v163, v89, v73
v_lshlrev_b32 v162, 16, v163
v_and_b32 v163, 0xffff0000, v163
buffer_store_dword v162, v7, s[28:31], s48 offen offset:128
buffer_store_dword v163, v7, s[28:31], s49 offen offset:128
v_cvt_pk_bf16_f32 v165, v90, v74
v_lshlrev_b32 v164, 16, v165
v_and_b32 v165, 0xffff0000, v165
buffer_store_dword v164, v7, s[28:31], s48 offen offset:256
buffer_store_dword v165, v7, s[28:31], s49 offen offset:256
v_cvt_pk_bf16_f32 v167, v91, v75
v_lshlrev_b32 v166, 16, v167
v_and_b32 v167, 0xffff0000, v167
buffer_store_dword v166, v7, s[28:31], s48 offen offset:384
buffer_store_dword v167, v7, s[28:31], s49 offen offset:384
v_cvt_pk_bf16_f32 v169, v92, v76
v_lshlrev_b32 v168, 16, v169
v_and_b32 v169, 0xffff0000, v169
buffer_store_dword v168, v7, s[28:31], s48 offen offset:1024
buffer_store_dword v169, v7, s[28:31], s49 offen offset:1024
v_cvt_pk_bf16_f32 v171, v93, v77
v_lshlrev_b32 v170, 16, v171
v_and_b32 v171, 0xffff0000, v171
buffer_store_dword v170, v7, s[28:31], s48 offen offset:1152
buffer_store_dword v171, v7, s[28:31], s49 offen offset:1152
v_cvt_pk_bf16_f32 v173, v94, v78
v_lshlrev_b32 v172, 16, v173
v_and_b32 v173, 0xffff0000, v173
buffer_store_dword v172, v7, s[28:31], s48 offen offset:1280
buffer_store_dword v173, v7, s[28:31], s49 offen offset:1280
v_cvt_pk_bf16_f32 v175, v95, v79
v_lshlrev_b32 v174, 16, v175
v_and_b32 v175, 0xffff0000, v175
buffer_store_dword v174, v7, s[28:31], s48 offen offset:1408
buffer_store_dword v175, v7, s[28:31], s49 offen offset:1408
v_cvt_pk_bf16_f32 v177, v96, v80
v_lshlrev_b32 v176, 16, v177
v_and_b32 v177, 0xffff0000, v177
buffer_store_dword v176, v7, s[28:31], s48 offen offset:2048
buffer_store_dword v177, v7, s[28:31], s49 offen offset:2048
v_cvt_pk_bf16_f32 v179, v97, v81
v_lshlrev_b32 v178, 16, v179
v_and_b32 v179, 0xffff0000, v179
buffer_store_dword v178, v7, s[28:31], s48 offen offset:2176
buffer_store_dword v179, v7, s[28:31], s49 offen offset:2176
v_cvt_pk_bf16_f32 v181, v98, v82
v_lshlrev_b32 v180, 16, v181
v_and_b32 v181, 0xffff0000, v181
buffer_store_dword v180, v7, s[28:31], s48 offen offset:2304
buffer_store_dword v181, v7, s[28:31], s49 offen offset:2304
v_cvt_pk_bf16_f32 v183, v99, v83
v_lshlrev_b32 v182, 16, v183
v_and_b32 v183, 0xffff0000, v183
buffer_store_dword v182, v7, s[28:31], s48 offen offset:2432
buffer_store_dword v183, v7, s[28:31], s49 offen offset:2432
v_cvt_pk_bf16_f32 v185, v100, v84
v_lshlrev_b32 v184, 16, v185
v_and_b32 v185, 0xffff0000, v185
buffer_store_dword v184, v7, s[28:31], s48 offen offset:3072
buffer_store_dword v185, v7, s[28:31], s49 offen offset:3072
v_cvt_pk_bf16_f32 v187, v101, v85
v_lshlrev_b32 v186, 16, v187
v_and_b32 v187, 0xffff0000, v187
buffer_store_dword v186, v7, s[28:31], s48 offen offset:3200
buffer_store_dword v187, v7, s[28:31], s49 offen offset:3200
v_cvt_pk_bf16_f32 v189, v102, v86
v_lshlrev_b32 v188, 16, v189
v_and_b32 v189, 0xffff0000, v189
buffer_store_dword v188, v7, s[28:31], s48 offen offset:3328
buffer_store_dword v189, v7, s[28:31], s49 offen offset:3328
v_cvt_pk_bf16_f32 v191, v103, v87
v_lshlrev_b32 v190, 16, v191
v_and_b32 v191, 0xffff0000, v191
buffer_store_dword v190, v7, s[28:31], s48 offen offset:3456
buffer_store_dword v191, v7, s[28:31], s49 offen offset:3456
v_mfma_f32_32x32x16_bf16 v[72:87], v[16:19], v[192:195], 0
v_mfma_f32_32x32x16_bf16 v[72:87], v[32:35], v[196:199], v[72:87]
v_mfma_f32_32x32x16_bf16 v[72:87], v[48:51], v[200:203], v[72:87]
v_mfma_f32_32x32x16_bf16 v[72:87], v[64:67], v[204:207], v[72:87]
v_mfma_f32_32x32x16_bf16 v[88:103], v[16:19], v[208:211], 0
v_mfma_f32_32x32x16_bf16 v[88:103], v[32:35], v[212:215], v[88:103]
v_mfma_f32_32x32x16_bf16 v[88:103], v[48:51], v[216:219], v[88:103]
v_mfma_f32_32x32x16_bf16 v[88:103], v[64:67], v[220:223], v[88:103]
v_pk_mul_f32 v[152:153], v[104:105], v[224:225]
v_pk_mul_f32 v[154:155], v[104:105], v[240:241]
v_pk_fma_f32 v[152:153], v[120:121], v[240:241], v[152:153] neg_lo:[1,0,0] neg_hi:[1,0,0]
v_pk_fma_f32 v[154:155], v[120:121], v[224:225], v[154:155]
v_cvt_pk_bf16_f32 v136, v152, v154
v_cvt_pk_bf16_f32 v137, v153, v155
v_pk_mul_f32 v[156:157], v[106:107], v[226:227]
v_pk_mul_f32 v[158:159], v[106:107], v[242:243]
v_pk_fma_f32 v[156:157], v[122:123], v[242:243], v[156:157] neg_lo:[1,0,0] neg_hi:[1,0,0]
v_pk_fma_f32 v[158:159], v[122:123], v[226:227], v[158:159]
v_cvt_pk_bf16_f32 v138, v156, v158
v_cvt_pk_bf16_f32 v139, v157, v159
v_pk_mul_f32 v[152:153], v[108:109], v[228:229]
v_pk_mul_f32 v[154:155], v[108:109], v[244:245]
v_pk_fma_f32 v[152:153], v[124:125], v[244:245], v[152:153] neg_lo:[1,0,0] neg_hi:[1,0,0]
v_pk_fma_f32 v[154:155], v[124:125], v[228:229], v[154:155]
v_cvt_pk_bf16_f32 v140, v152, v154
v_cvt_pk_bf16_f32 v141, v153, v155
v_pk_mul_f32 v[156:157], v[110:111], v[230:231]
v_pk_mul_f32 v[158:159], v[110:111], v[246:247]
v_pk_fma_f32 v[156:157], v[126:127], v[246:247], v[156:157] neg_lo:[1,0,0] neg_hi:[1,0,0]
v_pk_fma_f32 v[158:159], v[126:127], v[230:231], v[158:159]
v_cvt_pk_bf16_f32 v142, v156, v158
v_cvt_pk_bf16_f32 v143, v157, v159
v_pk_mul_f32 v[152:153], v[112:113], v[232:233]
v_pk_mul_f32 v[154:155], v[112:113], v[248:249]
v_pk_fma_f32 v[152:153], v[128:129], v[248:249], v[152:153] neg_lo:[1,0,0] neg_hi:[1,0,0]
v_pk_fma_f32 v[154:155], v[128:129], v[232:233], v[154:155]
v_cvt_pk_bf16_f32 v144, v152, v154
v_cvt_pk_bf16_f32 v145, v153, v155
v_pk_mul_f32 v[156:157], v[114:115], v[234:235]
v_pk_mul_f32 v[158:159], v[114:115], v[250:251]
v_pk_fma_f32 v[156:157], v[130:131], v[250:251], v[156:157] neg_lo:[1,0,0] neg_hi:[1,0,0]
v_pk_fma_f32 v[158:159], v[130:131], v[234:235], v[158:159]
v_cvt_pk_bf16_f32 v146, v156, v158
v_cvt_pk_bf16_f32 v147, v157, v159
v_pk_mul_f32 v[152:153], v[116:117], v[236:237]
v_pk_mul_f32 v[154:155], v[116:117], v[252:253]
v_pk_fma_f32 v[152:153], v[132:133], v[252:253], v[152:153] neg_lo:[1,0,0] neg_hi:[1,0,0]
v_pk_fma_f32 v[154:155], v[132:133], v[236:237], v[154:155]
v_cvt_pk_bf16_f32 v148, v152, v154
v_cvt_pk_bf16_f32 v149, v153, v155
v_pk_mul_f32 v[156:157], v[118:119], v[238:239]
v_pk_mul_f32 v[158:159], v[118:119], v[254:255]
v_pk_fma_f32 v[156:157], v[134:135], v[254:255], v[156:157] neg_lo:[1,0,0] neg_hi:[1,0,0]
v_pk_fma_f32 v[158:159], v[134:135], v[238:239], v[158:159]
v_cvt_pk_bf16_f32 v150, v156, v158
v_cvt_pk_bf16_f32 v151, v157, v159
v_mfma_f32_32x32x16_bf16 v[104:119], v[192:195], v[136:139], 0
v_mfma_f32_32x32x16_bf16 v[104:119], v[196:199], v[140:143], v[104:119]
v_mfma_f32_32x32x16_bf16 v[104:119], v[200:203], v[144:147], v[104:119]
v_mfma_f32_32x32x16_bf16 v[104:119], v[204:207], v[148:151], v[104:119]
v_mfma_f32_32x32x16_bf16 v[120:135], v[208:211], v[136:139], 0
v_mfma_f32_32x32x16_bf16 v[120:135], v[212:215], v[140:143], v[120:135]
v_mfma_f32_32x32x16_bf16 v[120:135], v[216:219], v[144:147], v[120:135]
v_mfma_f32_32x32x16_bf16 v[120:135], v[220:223], v[148:151], v[120:135]
s_mov_b32 s48, 524288
s_mov_b32 s49, 532480
s_nop 9
v_cvt_pk_bf16_f32 v161, v120, v104
v_lshlrev_b32 v160, 16, v161
v_and_b32 v161, 0xffff0000, v161
buffer_store_dword v160, v7, s[28:31], s48 offen offset:0
buffer_store_dword v161, v7, s[28:31], s49 offen offset:0
v_cvt_pk_bf16_f32 v163, v121, v105
v_lshlrev_b32 v162, 16, v163
v_and_b32 v163, 0xffff0000, v163
buffer_store_dword v162, v7, s[28:31], s48 offen offset:128
buffer_store_dword v163, v7, s[28:31], s49 offen offset:128
v_cvt_pk_bf16_f32 v165, v122, v106
v_lshlrev_b32 v164, 16, v165
v_and_b32 v165, 0xffff0000, v165
buffer_store_dword v164, v7, s[28:31], s48 offen offset:256
buffer_store_dword v165, v7, s[28:31], s49 offen offset:256
v_cvt_pk_bf16_f32 v167, v123, v107
v_lshlrev_b32 v166, 16, v167
v_and_b32 v167, 0xffff0000, v167
buffer_store_dword v166, v7, s[28:31], s48 offen offset:384
buffer_store_dword v167, v7, s[28:31], s49 offen offset:384
v_cvt_pk_bf16_f32 v169, v124, v108
v_lshlrev_b32 v168, 16, v169
v_and_b32 v169, 0xffff0000, v169
buffer_store_dword v168, v7, s[28:31], s48 offen offset:1024
buffer_store_dword v169, v7, s[28:31], s49 offen offset:1024
v_cvt_pk_bf16_f32 v171, v125, v109
v_lshlrev_b32 v170, 16, v171
v_and_b32 v171, 0xffff0000, v171
buffer_store_dword v170, v7, s[28:31], s48 offen offset:1152
buffer_store_dword v171, v7, s[28:31], s49 offen offset:1152
v_cvt_pk_bf16_f32 v173, v126, v110
v_lshlrev_b32 v172, 16, v173
v_and_b32 v173, 0xffff0000, v173
buffer_store_dword v172, v7, s[28:31], s48 offen offset:1280
buffer_store_dword v173, v7, s[28:31], s49 offen offset:1280
v_cvt_pk_bf16_f32 v175, v127, v111
v_lshlrev_b32 v174, 16, v175
v_and_b32 v175, 0xffff0000, v175
buffer_store_dword v174, v7, s[28:31], s48 offen offset:1408
buffer_store_dword v175, v7, s[28:31], s49 offen offset:1408
v_cvt_pk_bf16_f32 v177, v128, v112
v_lshlrev_b32 v176, 16, v177
v_and_b32 v177, 0xffff0000, v177
buffer_store_dword v176, v7, s[28:31], s48 offen offset:2048
buffer_store_dword v177, v7, s[28:31], s49 offen offset:2048
v_cvt_pk_bf16_f32 v179, v129, v113
v_lshlrev_b32 v178, 16, v179
v_and_b32 v179, 0xffff0000, v179
buffer_store_dword v178, v7, s[28:31], s48 offen offset:2176
buffer_store_dword v179, v7, s[28:31], s49 offen offset:2176
v_cvt_pk_bf16_f32 v181, v130, v114
v_lshlrev_b32 v180, 16, v181
v_and_b32 v181, 0xffff0000, v181
buffer_store_dword v180, v7, s[28:31], s48 offen offset:2304
buffer_store_dword v181, v7, s[28:31], s49 offen offset:2304
v_cvt_pk_bf16_f32 v183, v131, v115
v_lshlrev_b32 v182, 16, v183
v_and_b32 v183, 0xffff0000, v183
buffer_store_dword v182, v7, s[28:31], s48 offen offset:2432
buffer_store_dword v183, v7, s[28:31], s49 offen offset:2432
v_cvt_pk_bf16_f32 v185, v132, v116
v_lshlrev_b32 v184, 16, v185
v_and_b32 v185, 0xffff0000, v185
buffer_store_dword v184, v7, s[28:31], s48 offen offset:3072
buffer_store_dword v185, v7, s[28:31], s49 offen offset:3072
v_cvt_pk_bf16_f32 v187, v133, v117
v_lshlrev_b32 v186, 16, v187
v_and_b32 v187, 0xffff0000, v187
buffer_store_dword v186, v7, s[28:31], s48 offen offset:3200
buffer_store_dword v187, v7, s[28:31], s49 offen offset:3200
v_cvt_pk_bf16_f32 v189, v134, v118
v_lshlrev_b32 v188, 16, v189
v_and_b32 v189, 0xffff0000, v189
buffer_store_dword v188, v7, s[28:31], s48 offen offset:3328
buffer_store_dword v189, v7, s[28:31], s49 offen offset:3328
v_cvt_pk_bf16_f32 v191, v135, v119
v_lshlrev_b32 v190, 16, v191
v_and_b32 v191, 0xffff0000, v191
buffer_store_dword v190, v7, s[28:31], s48 offen offset:3456
buffer_store_dword v191, v7, s[28:31], s49 offen offset:3456
v_mfma_f32_32x32x16_bf16 v[104:119], v[20:23], v[192:195], 0
v_mfma_f32_32x32x16_bf16 v[104:119], v[36:39], v[196:199], v[104:119]
v_mfma_f32_32x32x16_bf16 v[104:119], v[52:55], v[200:203], v[104:119]
v_mfma_f32_32x32x16_bf16 v[104:119], v[68:71], v[204:207], v[104:119]
v_mfma_f32_32x32x16_bf16 v[120:135], v[20:23], v[208:211], 0
v_mfma_f32_32x32x16_bf16 v[120:135], v[36:39], v[212:215], v[120:135]
v_mfma_f32_32x32x16_bf16 v[120:135], v[52:55], v[216:219], v[120:135]
v_mfma_f32_32x32x16_bf16 v[120:135], v[68:71], v[220:223], v[120:135]
v_pk_mul_f32 v[152:153], v[72:73], v[224:225]
v_pk_mul_f32 v[154:155], v[72:73], v[240:241]
v_pk_fma_f32 v[152:153], v[88:89], v[240:241], v[152:153] neg_lo:[1,0,0] neg_hi:[1,0,0]
v_pk_fma_f32 v[154:155], v[88:89], v[224:225], v[154:155]
v_cvt_pk_bf16_f32 v136, v152, v154
v_cvt_pk_bf16_f32 v137, v153, v155
v_pk_mul_f32 v[156:157], v[74:75], v[226:227]
v_pk_mul_f32 v[158:159], v[74:75], v[242:243]
v_pk_fma_f32 v[156:157], v[90:91], v[242:243], v[156:157] neg_lo:[1,0,0] neg_hi:[1,0,0]
v_pk_fma_f32 v[158:159], v[90:91], v[226:227], v[158:159]
v_cvt_pk_bf16_f32 v138, v156, v158
v_cvt_pk_bf16_f32 v139, v157, v159
v_pk_mul_f32 v[152:153], v[76:77], v[228:229]
v_pk_mul_f32 v[154:155], v[76:77], v[244:245]
v_pk_fma_f32 v[152:153], v[92:93], v[244:245], v[152:153] neg_lo:[1,0,0] neg_hi:[1,0,0]
v_pk_fma_f32 v[154:155], v[92:93], v[228:229], v[154:155]
v_cvt_pk_bf16_f32 v140, v152, v154
v_cvt_pk_bf16_f32 v141, v153, v155
v_pk_mul_f32 v[156:157], v[78:79], v[230:231]
v_pk_mul_f32 v[158:159], v[78:79], v[246:247]
v_pk_fma_f32 v[156:157], v[94:95], v[246:247], v[156:157] neg_lo:[1,0,0] neg_hi:[1,0,0]
v_pk_fma_f32 v[158:159], v[94:95], v[230:231], v[158:159]
v_cvt_pk_bf16_f32 v142, v156, v158
v_cvt_pk_bf16_f32 v143, v157, v159
v_pk_mul_f32 v[152:153], v[80:81], v[232:233]
v_pk_mul_f32 v[154:155], v[80:81], v[248:249]
v_pk_fma_f32 v[152:153], v[96:97], v[248:249], v[152:153] neg_lo:[1,0,0] neg_hi:[1,0,0]
v_pk_fma_f32 v[154:155], v[96:97], v[232:233], v[154:155]
v_cvt_pk_bf16_f32 v144, v152, v154
v_cvt_pk_bf16_f32 v145, v153, v155
v_pk_mul_f32 v[156:157], v[82:83], v[234:235]
v_pk_mul_f32 v[158:159], v[82:83], v[250:251]
v_pk_fma_f32 v[156:157], v[98:99], v[250:251], v[156:157] neg_lo:[1,0,0] neg_hi:[1,0,0]
v_pk_fma_f32 v[158:159], v[98:99], v[234:235], v[158:159]
v_cvt_pk_bf16_f32 v146, v156, v158
v_cvt_pk_bf16_f32 v147, v157, v159
v_pk_mul_f32 v[152:153], v[84:85], v[236:237]
v_pk_mul_f32 v[154:155], v[84:85], v[252:253]
v_pk_fma_f32 v[152:153], v[100:101], v[252:253], v[152:153] neg_lo:[1,0,0] neg_hi:[1,0,0]
v_pk_fma_f32 v[154:155], v[100:101], v[236:237], v[154:155]
v_cvt_pk_bf16_f32 v148, v152, v154
v_cvt_pk_bf16_f32 v149, v153, v155
v_pk_mul_f32 v[156:157], v[86:87], v[238:239]
v_pk_mul_f32 v[158:159], v[86:87], v[254:255]
v_pk_fma_f32 v[156:157], v[102:103], v[254:255], v[156:157] neg_lo:[1,0,0] neg_hi:[1,0,0]
v_pk_fma_f32 v[158:159], v[102:103], v[238:239], v[158:159]
v_cvt_pk_bf16_f32 v150, v156, v158
v_cvt_pk_bf16_f32 v151, v157, v159
v_mfma_f32_32x32x16_bf16 v[72:87], v[192:195], v[136:139], 0
v_mfma_f32_32x32x16_bf16 v[72:87], v[196:199], v[140:143], v[72:87]
v_mfma_f32_32x32x16_bf16 v[72:87], v[200:203], v[144:147], v[72:87]
v_mfma_f32_32x32x16_bf16 v[72:87], v[204:207], v[148:151], v[72:87]
v_mfma_f32_32x32x16_bf16 v[88:103], v[208:211], v[136:139], 0
v_mfma_f32_32x32x16_bf16 v[88:103], v[212:215], v[140:143], v[88:103]
v_mfma_f32_32x32x16_bf16 v[88:103], v[216:219], v[144:147], v[88:103]
v_mfma_f32_32x32x16_bf16 v[88:103], v[220:223], v[148:151], v[88:103]
s_mov_b32 s48, 1048576
s_mov_b32 s49, 1056768
s_nop 9
v_cvt_pk_bf16_f32 v161, v88, v72
v_lshlrev_b32 v160, 16, v161
v_and_b32 v161, 0xffff0000, v161
buffer_store_dword v160, v7, s[28:31], s48 offen offset:0
buffer_store_dword v161, v7, s[28:31], s49 offen offset:0
v_cvt_pk_bf16_f32 v163, v89, v73
v_lshlrev_b32 v162, 16, v163
v_and_b32 v163, 0xffff0000, v163
buffer_store_dword v162, v7, s[28:31], s48 offen offset:128
buffer_store_dword v163, v7, s[28:31], s49 offen offset:128
v_cvt_pk_bf16_f32 v165, v90, v74
v_lshlrev_b32 v164, 16, v165
v_and_b32 v165, 0xffff0000, v165
buffer_store_dword v164, v7, s[28:31], s48 offen offset:256
buffer_store_dword v165, v7, s[28:31], s49 offen offset:256
v_cvt_pk_bf16_f32 v167, v91, v75
v_lshlrev_b32 v166, 16, v167
v_and_b32 v167, 0xffff0000, v167
buffer_store_dword v166, v7, s[28:31], s48 offen offset:384
buffer_store_dword v167, v7, s[28:31], s49 offen offset:384
v_cvt_pk_bf16_f32 v169, v92, v76
v_lshlrev_b32 v168, 16, v169
v_and_b32 v169, 0xffff0000, v169
buffer_store_dword v168, v7, s[28:31], s48 offen offset:1024
buffer_store_dword v169, v7, s[28:31], s49 offen offset:1024
v_cvt_pk_bf16_f32 v171, v93, v77
v_lshlrev_b32 v170, 16, v171
v_and_b32 v171, 0xffff0000, v171
buffer_store_dword v170, v7, s[28:31], s48 offen offset:1152
buffer_store_dword v171, v7, s[28:31], s49 offen offset:1152
v_cvt_pk_bf16_f32 v173, v94, v78
v_lshlrev_b32 v172, 16, v173
v_and_b32 v173, 0xffff0000, v173
buffer_store_dword v172, v7, s[28:31], s48 offen offset:1280
buffer_store_dword v173, v7, s[28:31], s49 offen offset:1280
v_cvt_pk_bf16_f32 v175, v95, v79
v_lshlrev_b32 v174, 16, v175
v_and_b32 v175, 0xffff0000, v175
buffer_store_dword v174, v7, s[28:31], s48 offen offset:1408
buffer_store_dword v175, v7, s[28:31], s49 offen offset:1408
v_cvt_pk_bf16_f32 v177, v96, v80
v_lshlrev_b32 v176, 16, v177
v_and_b32 v177, 0xffff0000, v177
buffer_store_dword v176, v7, s[28:31], s48 offen offset:2048
buffer_store_dword v177, v7, s[28:31], s49 offen offset:2048
v_cvt_pk_bf16_f32 v179, v97, v81
v_lshlrev_b32 v178, 16, v179
v_and_b32 v179, 0xffff0000, v179
buffer_store_dword v178, v7, s[28:31], s48 offen offset:2176
buffer_store_dword v179, v7, s[28:31], s49 offen offset:2176
v_cvt_pk_bf16_f32 v181, v98, v82
v_lshlrev_b32 v180, 16, v181
v_and_b32 v181, 0xffff0000, v181
buffer_store_dword v180, v7, s[28:31], s48 offen offset:2304
buffer_store_dword v181, v7, s[28:31], s49 offen offset:2304
v_cvt_pk_bf16_f32 v183, v99, v83
v_lshlrev_b32 v182, 16, v183
v_and_b32 v183, 0xffff0000, v183
buffer_store_dword v182, v7, s[28:31], s48 offen offset:2432
buffer_store_dword v183, v7, s[28:31], s49 offen offset:2432
v_cvt_pk_bf16_f32 v185, v100, v84
v_lshlrev_b32 v184, 16, v185
v_and_b32 v185, 0xffff0000, v185
buffer_store_dword v184, v7, s[28:31], s48 offen offset:3072
buffer_store_dword v185, v7, s[28:31], s49 offen offset:3072
v_cvt_pk_bf16_f32 v187, v101, v85
v_lshlrev_b32 v186, 16, v187
v_and_b32 v187, 0xffff0000, v187
buffer_store_dword v186, v7, s[28:31], s48 offen offset:3200
buffer_store_dword v187, v7, s[28:31], s49 offen offset:3200
v_cvt_pk_bf16_f32 v189, v102, v86
v_lshlrev_b32 v188, 16, v189
v_and_b32 v189, 0xffff0000, v189
buffer_store_dword v188, v7, s[28:31], s48 offen offset:3328
buffer_store_dword v189, v7, s[28:31], s49 offen offset:3328
v_cvt_pk_bf16_f32 v191, v103, v87
v_lshlrev_b32 v190, 16, v191
v_and_b32 v191, 0xffff0000, v191
buffer_store_dword v190, v7, s[28:31], s48 offen offset:3456
buffer_store_dword v191, v7, s[28:31], s49 offen offset:3456
v_pk_mul_f32 v[152:153], v[104:105], v[224:225]
v_pk_mul_f32 v[154:155], v[104:105], v[240:241]
v_pk_fma_f32 v[152:153], v[120:121], v[240:241], v[152:153] neg_lo:[1,0,0] neg_hi:[1,0,0]
v_pk_fma_f32 v[154:155], v[120:121], v[224:225], v[154:155]
v_cvt_pk_bf16_f32 v136, v152, v154
v_cvt_pk_bf16_f32 v137, v153, v155
v_pk_mul_f32 v[156:157], v[106:107], v[226:227]
v_pk_mul_f32 v[158:159], v[106:107], v[242:243]
v_pk_fma_f32 v[156:157], v[122:123], v[242:243], v[156:157] neg_lo:[1,0,0] neg_hi:[1,0,0]
v_pk_fma_f32 v[158:159], v[122:123], v[226:227], v[158:159]
v_cvt_pk_bf16_f32 v138, v156, v158
v_cvt_pk_bf16_f32 v139, v157, v159
v_pk_mul_f32 v[152:153], v[108:109], v[228:229]
v_pk_mul_f32 v[154:155], v[108:109], v[244:245]
v_pk_fma_f32 v[152:153], v[124:125], v[244:245], v[152:153] neg_lo:[1,0,0] neg_hi:[1,0,0]
v_pk_fma_f32 v[154:155], v[124:125], v[228:229], v[154:155]
v_cvt_pk_bf16_f32 v140, v152, v154
v_cvt_pk_bf16_f32 v141, v153, v155
v_pk_mul_f32 v[156:157], v[110:111], v[230:231]
v_pk_mul_f32 v[158:159], v[110:111], v[246:247]
v_pk_fma_f32 v[156:157], v[126:127], v[246:247], v[156:157] neg_lo:[1,0,0] neg_hi:[1,0,0]
v_pk_fma_f32 v[158:159], v[126:127], v[230:231], v[158:159]
v_cvt_pk_bf16_f32 v142, v156, v158
v_cvt_pk_bf16_f32 v143, v157, v159
v_pk_mul_f32 v[152:153], v[112:113], v[232:233]
v_pk_mul_f32 v[154:155], v[112:113], v[248:249]
v_pk_fma_f32 v[152:153], v[128:129], v[248:249], v[152:153] neg_lo:[1,0,0] neg_hi:[1,0,0]
v_pk_fma_f32 v[154:155], v[128:129], v[232:233], v[154:155]
v_cvt_pk_bf16_f32 v144, v152, v154
v_cvt_pk_bf16_f32 v145, v153, v155
v_pk_mul_f32 v[156:157], v[114:115], v[234:235]
v_pk_mul_f32 v[158:159], v[114:115], v[250:251]
v_pk_fma_f32 v[156:157], v[130:131], v[250:251], v[156:157] neg_lo:[1,0,0] neg_hi:[1,0,0]
v_pk_fma_f32 v[158:159], v[130:131], v[234:235], v[158:159]
v_cvt_pk_bf16_f32 v146, v156, v158
v_cvt_pk_bf16_f32 v147, v157, v159
v_pk_mul_f32 v[152:153], v[116:117], v[236:237]
v_pk_mul_f32 v[154:155], v[116:117], v[252:253]
v_pk_fma_f32 v[152:153], v[132:133], v[252:253], v[152:153] neg_lo:[1,0,0] neg_hi:[1,0,0]
v_pk_fma_f32 v[154:155], v[132:133], v[236:237], v[154:155]
v_cvt_pk_bf16_f32 v148, v152, v154
v_cvt_pk_bf16_f32 v149, v153, v155
v_pk_mul_f32 v[156:157], v[118:119], v[238:239]
v_pk_mul_f32 v[158:159], v[118:119], v[254:255]
v_pk_fma_f32 v[156:157], v[134:135], v[254:255], v[156:157] neg_lo:[1,0,0] neg_hi:[1,0,0]
v_pk_fma_f32 v[158:159], v[134:135], v[238:239], v[158:159]
v_cvt_pk_bf16_f32 v150, v156, v158
v_cvt_pk_bf16_f32 v151, v157, v159
v_mfma_f32_32x32x16_bf16 v[104:119], v[192:195], v[136:139], 0
v_mfma_f32_32x32x16_bf16 v[104:119], v[196:199], v[140:143], v[104:119]
v_mfma_f32_32x32x16_bf16 v[104:119], v[200:203], v[144:147], v[104:119]
v_mfma_f32_32x32x16_bf16 v[104:119], v[204:207], v[148:151], v[104:119]
v_mfma_f32_32x32x16_bf16 v[120:135], v[208:211], v[136:139], 0
v_mfma_f32_32x32x16_bf16 v[120:135], v[212:215], v[140:143], v[120:135]
v_mfma_f32_32x32x16_bf16 v[120:135], v[216:219], v[144:147], v[120:135]
v_mfma_f32_32x32x16_bf16 v[120:135], v[220:223], v[148:151], v[120:135]
s_mov_b32 s48, 1572864
s_mov_b32 s49, 1581056
s_nop 9
v_cvt_pk_bf16_f32 v161, v120, v104
v_lshlrev_b32 v160, 16, v161
v_and_b32 v161, 0xffff0000, v161
buffer_store_dword v160, v7, s[28:31], s48 offen offset:0
buffer_store_dword v161, v7, s[28:31], s49 offen offset:0
v_cvt_pk_bf16_f32 v163, v121, v105
v_lshlrev_b32 v162, 16, v163
v_and_b32 v163, 0xffff0000, v163
buffer_store_dword v162, v7, s[28:31], s48 offen offset:128
buffer_store_dword v163, v7, s[28:31], s49 offen offset:128
v_cvt_pk_bf16_f32 v165, v122, v106
v_lshlrev_b32 v164, 16, v165
v_and_b32 v165, 0xffff0000, v165
buffer_store_dword v164, v7, s[28:31], s48 offen offset:256
buffer_store_dword v165, v7, s[28:31], s49 offen offset:256
v_cvt_pk_bf16_f32 v167, v123, v107
v_lshlrev_b32 v166, 16, v167
v_and_b32 v167, 0xffff0000, v167
buffer_store_dword v166, v7, s[28:31], s48 offen offset:384
buffer_store_dword v167, v7, s[28:31], s49 offen offset:384
v_cvt_pk_bf16_f32 v169, v124, v108
v_lshlrev_b32 v168, 16, v169
v_and_b32 v169, 0xffff0000, v169
buffer_store_dword v168, v7, s[28:31], s48 offen offset:1024
buffer_store_dword v169, v7, s[28:31], s49 offen offset:1024
v_cvt_pk_bf16_f32 v171, v125, v109
v_lshlrev_b32 v170, 16, v171
v_and_b32 v171, 0xffff0000, v171
buffer_store_dword v170, v7, s[28:31], s48 offen offset:1152
buffer_store_dword v171, v7, s[28:31], s49 offen offset:1152
v_cvt_pk_bf16_f32 v173, v126, v110
v_lshlrev_b32 v172, 16, v173
v_and_b32 v173, 0xffff0000, v173
buffer_store_dword v172, v7, s[28:31], s48 offen offset:1280
buffer_store_dword v173, v7, s[28:31], s49 offen offset:1280
v_cvt_pk_bf16_f32 v175, v127, v111
v_lshlrev_b32 v174, 16, v175
v_and_b32 v175, 0xffff0000, v175
buffer_store_dword v174, v7, s[28:31], s48 offen offset:1408
buffer_store_dword v175, v7, s[28:31], s49 offen offset:1408
v_cvt_pk_bf16_f32 v177, v128, v112
v_lshlrev_b32 v176, 16, v177
v_and_b32 v177, 0xffff0000, v177
buffer_store_dword v176, v7, s[28:31], s48 offen offset:2048
buffer_store_dword v177, v7, s[28:31], s49 offen offset:2048
v_cvt_pk_bf16_f32 v179, v129, v113
v_lshlrev_b32 v178, 16, v179
v_and_b32 v179, 0xffff0000, v179
buffer_store_dword v178, v7, s[28:31], s48 offen offset:2176
buffer_store_dword v179, v7, s[28:31], s49 offen offset:2176
v_cvt_pk_bf16_f32 v181, v130, v114
v_lshlrev_b32 v180, 16, v181
v_and_b32 v181, 0xffff0000, v181
buffer_store_dword v180, v7, s[28:31], s48 offen offset:2304
buffer_store_dword v181, v7, s[28:31], s49 offen offset:2304
v_cvt_pk_bf16_f32 v183, v131, v115
v_lshlrev_b32 v182, 16, v183
v_and_b32 v183, 0xffff0000, v183
buffer_store_dword v182, v7, s[28:31], s48 offen offset:2432
buffer_store_dword v183, v7, s[28:31], s49 offen offset:2432
v_cvt_pk_bf16_f32 v185, v132, v116
v_lshlrev_b32 v184, 16, v185
v_and_b32 v185, 0xffff0000, v185
buffer_store_dword v184, v7, s[28:31], s48 offen offset:3072
buffer_store_dword v185, v7, s[28:31], s49 offen offset:3072
v_cvt_pk_bf16_f32 v187, v133, v117
v_lshlrev_b32 v186, 16, v187
v_and_b32 v187, 0xffff0000, v187
buffer_store_dword v186, v7, s[28:31], s48 offen offset:3200
buffer_store_dword v187, v7, s[28:31], s49 offen offset:3200
v_cvt_pk_bf16_f32 v189, v134, v118
v_lshlrev_b32 v188, 16, v189
v_and_b32 v189, 0xffff0000, v189
buffer_store_dword v188, v7, s[28:31], s48 offen offset:3328
buffer_store_dword v189, v7, s[28:31], s49 offen offset:3328
v_cvt_pk_bf16_f32 v191, v135, v119
v_lshlrev_b32 v190, 16, v191
v_and_b32 v191, 0xffff0000, v191
buffer_store_dword v190, v7, s[28:31], s48 offen offset:3456
buffer_store_dword v191, v7, s[28:31], s49 offen offset:3456
L_a3_kernel_end:
s_endpgm
.p2align 8
.type tables,@object
tables:
.long 0x3f80,0x0,0x0,0x0,0x0,0x3f80,0x0,0x0
.long 0x0,0x0,0x3f80,0x0,0x0,0x0,0x0,0x3f80
.long 0x0,0x0,0x0,0x0,0x0,0x0,0x0,0x0
.long 0x0,0x0,0x0,0x0,0x0,0x0,0x0,0x0
.long 0x3f800000,0x0,0x0,0x0,0x0,0x3f800000,0x0,0x0
.long 0x0,0x0,0x3f800000,0x0,0x0,0x0,0x0,0x3f800000
.long 0x0,0x0,0x0,0x0,0x0,0x0,0x0,0x0
.long 0x0,0x0,0x0,0x0,0x0,0x0,0x0,0x0
.long 0x0,0x0,0x0,0x0,0x0,0x0,0x0,0x0
.long 0x0,0x0,0x0,0x0,0x0,0x0,0x0,0x0
.long 0x0,0x0,0x0,0x0,0x0,0x0,0x0,0x0
.long 0x0,0x0,0x0,0x0,0x0,0x0,0x0,0x0
.long 0x0,0x0,0x0,0x0,0x0,0x0,0x0,0x0
.long 0x0,0x0,0x0,0x0,0x0,0x0,0x0,0x0
.long 0x0,0x0,0x0,0x0,0x0,0x0,0x0,0x0
.long 0x0,0x0,0x0,0x0,0x0,0x0,0x0,0x0
.long 0x0,0x0,0x0,0x0,0x0,0x0,0x0,0x0
.long 0x0,0x0,0x0,0x0,0x0,0x0,0x0,0x0
.long 0x0,0x0,0x0,0x0,0x0,0x0,0x0,0x0
.long 0x0,0x0,0x0,0x0,0x0,0x0,0x0,0x0
.long 0x0,0x0,0x0,0x0,0x0,0x0,0x0,0x0
.long 0x0,0x0,0x0,0x0,0x0,0x0,0x0,0x0
.long 0x0,0x0,0x0,0x0,0x0,0x0,0x0,0x0
.long 0x0,0x0,0x0,0x0,0x0,0x0,0x0,0x0
.long 0x3f80,0x0,0x0,0x0,0x0,0x3f80,0x0,0x0
.long 0x0,0x0,0x3f80,0x0,0x0,0x0,0x0,0x3f80
.long 0x0,0x0,0x0,0x0,0x0,0x0,0x0,0x0
.long 0x0,0x0,0x0,0x0,0x0,0x0,0x0,0x0
.long 0x3f800000,0x0,0x0,0x0,0x0,0x3f800000,0x0,0x0
.long 0x0,0x0,0x3f800000,0x0,0x0,0x0,0x0,0x3f800000
.long 0x0,0x0,0x0,0x0,0x0,0x0,0x0,0x0
.long 0x0,0x0,0x0,0x0,0x0,0x0,0x0,0x0
.long 0x0,0x0,0x0,0x0,0x0,0x0,0x0,0x0
.long 0x0,0x0,0x0,0x0,0x0,0x0,0x0,0x0
.long 0x3f80,0x0,0x0,0x0,0x0,0x3f80,0x0,0x0
.long 0x0,0x0,0x3f80,0x0,0x0,0x0,0x0,0x3f80
.long 0x0,0x0,0x0,0x0,0x0,0x0,0x0,0x0
.long 0x0,0x0,0x0,0x0,0x0,0x0,0x0,0x0
.long 0x3f800000,0x0,0x0,0x0,0x0,0x3f800000,0x0,0x0
.long 0x0,0x0,0x3f800000,0x0,0x0,0x0,0x0,0x3f800000
.long 0x0,0x0,0x0,0x0,0x0,0x0,0x0,0x0
.long 0x0,0x0,0x0,0x0,0x0,0x0,0x0,0x0
.long 0x0,0x0,0x0,0x0,0x0,0x0,0x0,0x0
.long 0x0,0x0,0x0,0x0,0x0,0x0,0x0,0x0
.long 0x0,0x0,0x0,0x0,0x0,0x0,0x0,0x0
.long 0x0,0x0,0x0,0x0,0x0,0x0,0x0,0x0
.long 0x0,0x0,0x0,0x0,0x0,0x0,0x0,0x0
.long 0x0,0x0,0x0,0x0,0x0,0x0,0x0,0x0
.long 0x0,0x0,0x0,0x0,0x0,0x0,0x0,0x0
.long 0x0,0x0,0x0,0x0,0x0,0x0,0x0,0x0
.long 0x0,0x0,0x0,0x0,0x0,0x0,0x0,0x0
.long 0x0,0x0,0x0,0x0,0x0,0x0,0x0,0x0
.long 0x0,0x0,0x0,0x0,0x0,0x0,0x0,0x0
.long 0x0,0x0,0x0,0x0,0x0,0x0,0x0,0x0
.long 0x0,0x0,0x0,0x0,0x0,0x0,0x0,0x0
.long 0x0,0x0,0x0,0x0,0x0,0x0,0x0,0x0
.long 0x0,0x0,0x0,0x0,0x0,0x0,0x0,0x0
.long 0x0,0x0,0x0,0x0,0x0,0x0,0x0,0x0
.long 0x3f80,0x0,0x0,0x0,0x0,0x3f80,0x0,0x0
.long 0x0,0x0,0x3f80,0x0,0x0,0x0,0x0,0x3f80
.long 0x0,0x0,0x0,0x0,0x0,0x0,0x0,0x0
.long 0x0,0x0,0x0,0x0,0x0,0x0,0x0,0x0
.long 0x3f800000,0x0,0x0,0x0,0x0,0x3f800000,0x0,0x0
.long 0x0,0x0,0x3f800000,0x0,0x0,0x0,0x0,0x3f800000
.long 0x3f80,0x3f80,0x3f80,0x3f80,0x3f80,0x3e483f7b,0x3ec43f6d,0x3f0e3f55
.long 0x3f80,0x3ec43f6d,0x3f353f35,0x3f6d3ec4,0x3f80,0x3f0e3f55,0x3f6d3ec4,0x3f7bbe48
.long 0x3f80,0x3f353f35,0x3f800000,0x3f35bf35,0x3f80,0x3f553f0e,0x3f6dbec4,0x3e48bf7b
.long 0x3f80,0x3f6d3ec4,0x3f35bf35,0xbec4bf6d,0x3f80,0x3f7b3e48,0x3ec4bf6d,0xbf55bf0e
.long 0x3f80,0x3f800000,0xbf80,0xbf800000,0x3f80,0x3f7bbe48,0xbec4bf6d,0xbf553f0e
.long 0x3f80,0x3f6dbec4,0xbf35bf35,0xbec43f6d,0x3f80,0x3f55bf0e,0xbf6dbec4,0x3e483f7b
.long 0x3f80,0x3f35bf35,0xbf800000,0x3f353f35,0x3f80,0x3f0ebf55,0xbf6d3ec4,0x3f7b3e48
.long 0x3f80,0x3ec4bf6d,0xbf353f35,0x3f6dbec4,0x3f80,0x3e48bf7b,0xbec43f6d,0x3f0ebf55
.long 0x3f80,0xbf80,0x3f80,0xbf80,0x3f80,0xbe48bf7b,0x3ec43f6d,0xbf0ebf55
.long 0x3f80,0xbec4bf6d,0x3f353f35,0xbf6dbec4,0x3f80,0xbf0ebf55,0x3f6d3ec4,0xbf7b3e48
.long 0x3f80,0xbf35bf35,0x3f800000,0xbf353f35,0x3f80,0xbf55bf0e,0x3f6dbec4,0xbe483f7b
.long 0x3f80,0xbf6dbec4,0x3f35bf35,0x3ec43f6d,0x3f80,0xbf7bbe48,0x3ec4bf6d,0x3f553f0e
.long 0x3f80,0xbf800000,0xbf80,0x3f800000,0x3f80,0xbf7b3e48,0xbec4bf6d,0x3f55bf0e
.long 0x3f80,0xbf6d3ec4,0xbf35bf35,0x3ec4bf6d,0x3f80,0xbf553f0e,0xbf6dbec4,0xbe48bf7b
.long 0x3f80,0xbf353f35,0xbf800000,0xbf35bf35,0x3f80,0xbf0e3f55,0xbf6d3ec4,0xbf7bbe48
.long 0x3f80,0xbec43f6d,0xbf353f35,0xbf6d3ec4,0x3f80,0xbe483f7b,0xbec43f6d,0xbf0e3f55
.long 0x3f80,0x3f80,0x3f80,0x3f80,0x3f353f35,0x3f553f0e,0x3f6d3ec4,0x3f7b3e48
.long 0x3f800000,0x3f6dbec4,0x3f35bf35,0x3ec4bf6d,0x3f35bf35,0x3e48bf7b,0xbec4bf6d,0xbf55bf0e
.long 0xbf80,0xbf35bf35,0xbf800000,0xbf353f35,0xbf35bf35,0xbf7b3e48,0xbec43f6d,0x3f0e3f55
.long 0xbf800000,0xbec43f6d,0x3f353f35,0x3f6dbec4,0xbf353f35,0x3f0e3f55,0x3f6dbec4,0xbe48bf7b
.long 0x3f80,0x3f800000,0xbf80,0xbf800000,0x3f353f35,0x3f0ebf55,0xbf6dbec4,0xbe483f7b
.long 0x3f800000,0xbec4bf6d,0xbf353f35,0x3f6d3ec4,0x3f35bf35,0xbf7bbe48,0x3ec43f6d,0x3f0ebf55
.long 0xbf80,0xbf353f35,0x3f800000,0xbf35bf35,0xbf35bf35,0x3e483f7b,0x3ec4bf6d,0xbf553f0e
.long 0xbf800000,0x3f6d3ec4,0xbf35bf35,0x3ec43f6d,0xbf353f35,0x3f55bf0e,0xbf6d3ec4,0x3f7bbe48
.long 0x3f80,0xbf80,0x3f80,0xbf80,0x3f353f35,0xbf55bf0e,0x3f6d3ec4,0xbf7bbe48
.long 0x3f800000,0xbf6d3ec4,0x3f35bf35,0xbec43f6d,0x3f35bf35,0xbe483f7b,0xbec4bf6d,0x3f553f0e
.long 0xbf80,0x3f353f35,0xbf800000,0x3f35bf35,0xbf35bf35,0x3f7bbe48,0xbec43f6d,0xbf0ebf55
.long 0xbf800000,0x3ec4bf6d,0x3f353f35,0xbf6d3ec4,0xbf353f35,0xbf0ebf55,0x3f6dbec4,0x3e483f7b
.long 0x3f80,0xbf800000,0xbf80,0x3f800000,0x3f353f35,0xbf0e3f55,0xbf6dbec4,0x3e48bf7b
.long 0x3f800000,0x3ec43f6d,0xbf353f35,0xbf6dbec4,0x3f35bf35,0x3f7b3e48,0x3ec43f6d,0xbf0e3f55
.long 0xbf80,0x3f35bf35,0x3f800000,0x3f353f35,0xbf35bf35,0xbe48bf7b,0x3ec4bf6d,0x3f55bf0e
.long 0xbf800000,0xbf6dbec4,0xbf35bf35,0xbec4bf6d,0xbf353f35,0xbf553f0e,0xbf6d3ec4,0xbf7b3e48
.long 0x3f80,0x3f80,0x3f80,0x3f80,0x3f800000,0x3f7bbe48,0x3f6dbec4,0x3f55bf0e
.long 0xbf80,0xbec4bf6d,0xbf35bf35,0xbf6dbec4,0xbf800000,0xbf553f0e,0xbec43f6d,0x3e483f7b
.long 0x3f80,0x3f353f35,0x3f800000,0x3f35bf35,0x3f800000,0x3f0ebf55,0xbec4bf6d,0xbf7bbe48
.long 0xbf80,0xbf6dbec4,0xbf353f35,0x3ec43f6d,0xbf800000,0xbe483f7b,0x3f6d3ec4,0x3f0ebf55
.long 0x3f80,0x3f800000,0xbf80,0xbf800000,0x3f800000,0xbe48bf7b,0xbf6d3ec4,0x3f0e3f55
.long 0xbf80,0xbf6d3ec4,0x3f353f35,0x3ec4bf6d,0xbf800000,0x3f0e3f55,0x3ec4bf6d,0xbf7b3e48
.long 0x3f80,0x3f35bf35,0xbf800000,0x3f353f35,0x3f800000,0xbf55bf0e,0x3ec43f6d,0x3e48bf7b
.long 0xbf80,0xbec43f6d,0x3f35bf35,0xbf6d3ec4,0xbf800000,0x3f7b3e48,0xbf6dbec4,0x3f553f0e
.long 0x3f80,0xbf80,0x3f80,0xbf80,0x3f800000,0xbf7b3e48,0x3f6dbec4,0xbf553f0e
.long 0xbf80,0x3ec43f6d,0xbf35bf35,0x3f6d3ec4,0xbf800000,0x3f55bf0e,0xbec43f6d,0xbe48bf7b
.long 0x3f80,0xbf35bf35,0x3f800000,0xbf353f35,0x3f800000,0xbf0e3f55,0xbec4bf6d,0x3f7b3e48
.long 0xbf80,0x3f6d3ec4,0xbf353f35,0xbec4bf6d,0xbf800000,0x3e48bf7b,0x3f6d3ec4,0xbf0e3f55
.long 0x3f80,0xbf800000,0xbf80,0x3f800000,0x3f800000,0x3e483f7b,0xbf6d3ec4,0xbf0ebf55
.long 0xbf80,0x3f6dbec4,0x3f353f35,0xbec43f6d,0xbf800000,0xbf0ebf55,0x3ec4bf6d,0x3f7bbe48
.long 0x3f80,0xbf353f35,0xbf800000,0xbf35bf35,0x3f800000,0x3f553f0e,0x3ec43f6d,0xbe483f7b
.long 0xbf80,0x3ec4bf6d,0x3f35bf35,0x3f6dbec4,0xbf800000,0xbf7bbe48,0xbf6dbec4,0xbf55bf0e
.long 0x3f80,0x3f80,0x3f80,0x3f80,0x3f35bf35,0x3f0ebf55,0x3ec4bf6d,0x3e48bf7b
.long 0xbf800000,0xbf6d3ec4,0xbf353f35,0xbec43f6d,0x3f353f35,0x3f7b3e48,0x3f6dbec4,0x3f0ebf55
.long 0xbf80,0xbf35bf35,0xbf800000,0xbf353f35,0xbf353f35,0x3e483f7b,0x3f6d3ec4,0x3f55bf0e
.long 0x3f800000,0x3ec4bf6d,0xbf35bf35,0xbf6d3ec4,0xbf35bf35,0xbf553f0e,0x3ec43f6d,0x3f7bbe48
.long 0x3f80,0x3f800000,0xbf80,0xbf800000,0x3f35bf35,0xbf55bf0e,0xbec43f6d,0x3f7b3e48
.long 0xbf800000,0x3ec43f6d,0x3f35bf35,0xbf6dbec4,0x3f353f35,0x3e48bf7b,0xbf6d3ec4,0x3f553f0e
.long 0xbf80,0xbf353f35,0x3f800000,0xbf35bf35,0xbf353f35,0x3f7bbe48,0xbf6dbec4,0x3f0e3f55
.long 0x3f800000,0xbf6dbec4,0x3f353f35,0xbec4bf6d,0xbf35bf35,0x3f0e3f55,0xbec4bf6d,0x3e483f7b
.long 0x3f80,0xbf80,0x3f80,0xbf80,0x3f35bf35,0xbf0e3f55,0x3ec4bf6d,0xbe483f7b
.long 0xbf800000,0x3f6dbec4,0xbf353f35,0x3ec4bf6d,0x3f353f35,0xbf7bbe48,0x3f6dbec4,0xbf0e3f55
.long 0xbf80,0x3f353f35,0xbf800000,0x3f35bf35,0xbf353f35,0xbe48bf7b,0x3f6d3ec4,0xbf553f0e
.long 0x3f800000,0xbec43f6d,0xbf35bf35,0x3f6dbec4,0xbf35bf35,0x3f55bf0e,0x3ec43f6d,0xbf7b3e48
.long 0x3f80,0xbf800000,0xbf80,0x3f800000,0x3f35bf35,0x3f553f0e,0xbec43f6d,0xbf7bbe48
.long 0xbf800000,0xbec4bf6d,0x3f35bf35,0x3f6d3ec4,0x3f353f35,0xbe483f7b,0xbf6d3ec4,0xbf55bf0e
.long 0xbf80,0x3f35bf35,0x3f800000,0x3f353f35,0xbf353f35,0xbf7b3e48,0xbf6dbec4,0xbf0ebf55
.long 0x3f800000,0x3f6d3ec4,0x3f353f35,0x3ec43f6d,0xbf35bf35,0xbf0ebf55,0xbec4bf6d,0xbe48bf7b
.long 0x3f80,0x3f80,0x3f80,0x3f80,0xbf80,0xbe48bf7b,0xbec4bf6d,0xbf0ebf55
.long 0x3f80,0x3ec43f6d,0x3f353f35,0x3f6d3ec4,0xbf80,0xbf0ebf55,0xbf6dbec4,0xbf7b3e48
.long 0x3f80,0x3f353f35,0x3f800000,0x3f35bf35,0xbf80,0xbf55bf0e,0xbf6d3ec4,0xbe483f7b
.long 0x3f80,0x3f6d3ec4,0x3f35bf35,0xbec4bf6d,0xbf80,0xbf7bbe48,0xbec43f6d,0x3f553f0e
.long 0x3f80,0x3f800000,0xbf80,0xbf800000,0xbf80,0xbf7b3e48,0x3ec43f6d,0x3f55bf0e
.long 0x3f80,0x3f6dbec4,0xbf35bf35,0xbec43f6d,0xbf80,0xbf553f0e,0x3f6d3ec4,0xbe48bf7b
.long 0x3f80,0x3f35bf35,0xbf800000,0x3f353f35,0xbf80,0xbf0e3f55,0x3f6dbec4,0xbf7bbe48
.long 0x3f80,0x3ec4bf6d,0xbf353f35,0x3f6dbec4,0xbf80,0xbe483f7b,0x3ec4bf6d,0xbf0e3f55
.long 0x3f80,0xbf80,0x3f80,0xbf80,0xbf80,0x3e483f7b,0xbec4bf6d,0x3f0e3f55
.long 0x3f80,0xbec4bf6d,0x3f353f35,0xbf6dbec4,0xbf80,0x3f0e3f55,0xbf6dbec4,0x3f7bbe48
.long 0x3f80,0xbf35bf35,0x3f800000,0xbf353f35,0xbf80,0x3f553f0e,0xbf6d3ec4,0x3e48bf7b
.long 0x3f80,0xbf6dbec4,0x3f35bf35,0x3ec43f6d,0xbf80,0x3f7b3e48,0xbec43f6d,0xbf55bf0e
.long 0x3f80,0xbf800000,0xbf80,0x3f800000,0xbf80,0x3f7bbe48,0x3ec43f6d,0xbf553f0e
.long 0x3f80,0xbf6d3ec4,0xbf35bf35,0x3ec4bf6d,0xbf80,0x3f55bf0e,0x3f6d3ec4,0x3e483f7b
.long 0x3f80,0xbf353f35,0xbf800000,0xbf35bf35,0xbf80,0x3f0ebf55,0x3f6dbec4,0x3f7b3e48
.long 0x3f80,0xbec43f6d,0xbf353f35,0xbf6d3ec4,0xbf80,0x3e48bf7b,0x3ec4bf6d,0x3f0ebf55
.long 0x3f80,0x3f80,0x3f80,0x3f80,0xbf35bf35,0xbf55bf0e,0xbf6dbec4,0xbf7bbe48
.long 0x3f800000,0x3f6dbec4,0x3f35bf35,0x3ec4bf6d,0xbf353f35,0xbe483f7b,0x3ec43f6d,0x3f553f0e
.long 0xbf80,0xbf35bf35,0xbf800000,0xbf353f35,0x3f353f35,0x3f7bbe48,0x3ec4bf6d,0xbf0ebf55
.long 0xbf800000,0xbec43f6d,0x3f353f35,0x3f6dbec4,0x3f35bf35,0xbf0ebf55,0xbf6d3ec4,0x3e483f7b
.long 0x3f80,0x3f800000,0xbf80,0xbf800000,0xbf35bf35,0xbf0e3f55,0x3f6d3ec4,0x3e48bf7b
.long 0x3f800000,0xbec4bf6d,0xbf353f35,0x3f6d3ec4,0xbf353f35,0x3f7b3e48,0xbec4bf6d,0xbf0e3f55
.long 0xbf80,0xbf353f35,0x3f800000,0xbf35bf35,0x3f353f35,0xbe48bf7b,0xbec43f6d,0x3f55bf0e
.long 0xbf800000,0x3f6d3ec4,0xbf35bf35,0x3ec43f6d,0x3f35bf35,0xbf553f0e,0x3f6dbec4,0xbf7b3e48
.long 0x3f80,0xbf80,0x3f80,0xbf80,0xbf35bf35,0x3f553f0e,0xbf6dbec4,0x3f7b3e48
.long 0x3f800000,0xbf6d3ec4,0x3f35bf35,0xbec43f6d,0xbf353f35,0x3e48bf7b,0x3ec43f6d,0xbf55bf0e
.long 0xbf80,0x3f353f35,0xbf800000,0x3f35bf35,0x3f353f35,0xbf7b3e48,0x3ec4bf6d,0x3f0e3f55
.long 0xbf800000,0x3ec4bf6d,0x3f353f35,0xbf6d3ec4,0x3f35bf35,0x3f0e3f55,0xbf6d3ec4,0xbe48bf7b
.long 0x3f80,0xbf800000,0xbf80,0x3f800000,0xbf35bf35,0x3f0ebf55,0x3f6d3ec4,0xbe483f7b
.long 0x3f800000,0x3ec43f6d,0xbf353f35,0xbf6dbec4,0xbf353f35,0xbf7bbe48,0xbec4bf6d,0x3f0ebf55
.long 0xbf80,0x3f35bf35,0x3f800000,0x3f353f35,0x3f353f35,0x3e483f7b,0xbec43f6d,0xbf553f0e
.long 0xbf800000,0xbf6dbec4,0xbf35bf35,0xbec4bf6d,0x3f35bf35,0x3f55bf0e,0x3f6dbec4,0x3f7bbe48
.long 0x3f80,0x3f80,0x3f80,0x3f80,0xbf800000,0xbf7b3e48,0xbf6d3ec4,0xbf553f0e
.long 0xbf80,0xbec4bf6d,0xbf35bf35,0xbf6dbec4,0x3f800000,0x3f55bf0e,0x3ec4bf6d,0xbe48bf7b
.long 0x3f80,0x3f353f35,0x3f800000,0x3f35bf35,0xbf800000,0xbf0e3f55,0x3ec43f6d,0x3f7b3e48
.long 0xbf80,0xbf6dbec4,0xbf353f35,0x3ec43f6d,0x3f800000,0x3e48bf7b,0xbf6dbec4,0xbf0e3f55
.long 0x3f80,0x3f800000,0xbf80,0xbf800000,0xbf800000,0x3e483f7b,0x3f6dbec4,0xbf0ebf55
.long 0xbf80,0xbf6d3ec4,0x3f353f35,0x3ec4bf6d,0x3f800000,0xbf0ebf55,0xbec43f6d,0x3f7bbe48
.long 0x3f80,0x3f35bf35,0xbf800000,0x3f353f35,0xbf800000,0x3f553f0e,0xbec4bf6d,0xbe483f7b
.long 0xbf80,0xbec43f6d,0x3f35bf35,0xbf6d3ec4,0x3f800000,0xbf7bbe48,0x3f6d3ec4,0xbf55bf0e
.long 0x3f80,0xbf80,0x3f80,0xbf80,0xbf800000,0x3f7bbe48,0xbf6d3ec4,0x3f55bf0e
.long 0xbf80,0x3ec43f6d,0xbf35bf35,0x3f6d3ec4,0x3f800000,0xbf553f0e,0x3ec4bf6d,0x3e483f7b
.long 0x3f80,0xbf35bf35,0x3f800000,0xbf353f35,0xbf800000,0x3f0ebf55,0x3ec43f6d,0xbf7bbe48
.long 0xbf80,0x3f6d3ec4,0xbf353f35,0xbec4bf6d,0x3f800000,0xbe483f7b,0xbf6dbec4,0x3f0ebf55
.long 0x3f80,0xbf800000,0xbf80,0x3f800000,0xbf800000,0xbe48bf7b,0x3f6dbec4,0x3f0e3f55
.long 0xbf80,0x3f6dbec4,0x3f353f35,0xbec43f6d,0x3f800000,0x3f0e3f55,0xbec43f6d,0xbf7b3e48
.long 0x3f80,0xbf353f35,0xbf800000,0xbf35bf35,0xbf800000,0xbf55bf0e,0xbec4bf6d,0x3e48bf7b
.long 0xbf80,0x3ec4bf6d,0x3f35bf35,0x3f6dbec4,0x3f800000,0x3f7b3e48,0x3f6d3ec4,0x3f553f0e
.long 0x3f80,0x3f80,0x3f80,0x3f80,0xbf353f35,0xbf0e3f55,0xbec43f6d,0xbe483f7b
.long 0xbf800000,0xbf6d3ec4,0xbf353f35,0xbec43f6d,0xbf35bf35,0xbf7bbe48,0xbf6d3ec4,0xbf0e3f55
.long 0xbf80,0xbf35bf35,0xbf800000,0xbf353f35,0x3f35bf35,0xbe48bf7b,0xbf6dbec4,0xbf553f0e
.long 0x3f800000,0x3ec4bf6d,0xbf35bf35,0xbf6d3ec4,0x3f353f35,0x3f55bf0e,0xbec4bf6d,0xbf7b3e48
.long 0x3f80,0x3f800000,0xbf80,0xbf800000,0xbf353f35,0x3f553f0e,0x3ec4bf6d,0xbf7bbe48
.long 0xbf800000,0x3ec43f6d,0x3f35bf35,0xbf6dbec4,0xbf35bf35,0xbe483f7b,0x3f6dbec4,0xbf55bf0e
.long 0xbf80,0xbf353f35,0x3f800000,0xbf35bf35,0x3f35bf35,0xbf7b3e48,0x3f6d3ec4,0xbf0ebf55
.long 0x3f800000,0xbf6dbec4,0x3f353f35,0xbec4bf6d,0x3f353f35,0xbf0ebf55,0x3ec43f6d,0xbe48bf7b
.long 0x3f80,0xbf80,0x3f80,0xbf80,0xbf353f35,0x3f0ebf55,0xbec43f6d,0x3e48bf7b
.long 0xbf800000,0x3f6dbec4,0xbf353f35,0x3ec4bf6d,0xbf35bf35,0x3f7b3e48,0xbf6d3ec4,0x3f0ebf55
.long 0xbf80,0x3f353f35,0xbf800000,0x3f35bf35,0x3f35bf35,0x3e483f7b,0xbf6dbec4,0x3f55bf0e
.long 0x3f800000,0xbec43f6d,0xbf35bf35,0x3f6dbec4,0x3f353f35,0xbf553f0e,0xbec4bf6d,0x3f7bbe48
.long 0x3f80,0xbf800000,0xbf80,0x3f800000,0xbf353f35,0xbf55bf0e,0x3ec4bf6d,0x3f7b3e48
.long 0xbf800000,0xbec4bf6d,0x3f35bf35,0x3f6d3ec4,0xbf35bf35,0x3e48bf7b,0x3f6dbec4,0x3f553f0e
.long 0xbf80,0x3f35bf35,0x3f800000,0x3f353f35,0x3f35bf35,0x3f7bbe48,0x3f6d3ec4,0x3f0e3f55
.long 0x3f800000,0x3f6d3ec4,0x3f353f35,0x3ec43f6d,0x3f353f35,0x3f0e3f55,0x3ec43f6d,0x3e483f7b
.long 0x3f808000,0x3f808000,0x3f808000,0x3f808000,0x3f808000,0x3f7bbe48,0x3f6dbec4,0x3f55bf0e
.long 0x3f808000,0x3f6dbec4,0x3f35bf35,0x3ec4bf6d,0x3f808000,0x3f55bf0e,0x3ec4bf6d,0xbe48bf7b
.long 0x3f808000,0x3f35bf35,0xbf80,0xbf35bf35,0x3f808000,0x3f0ebf55,0xbec4bf6d,0xbf7bbe48
.long 0x3f808000,0x3ec4bf6d,0xbf35bf35,0xbf6d3ec4,0x3f808000,0x3e48bf7b,0xbf6dbec4,0xbf0e3f55
.long 0x3f808000,0xbf80,0xbf808000,0x3f80,0x3f808000,0xbe48bf7b,0xbf6d3ec4,0x3f0e3f55
.long 0x3f808000,0xbec4bf6d,0xbf353f35,0x3f6d3ec4,0x3f808000,0xbf0ebf55,0xbec43f6d,0x3f7bbe48
.long 0x3f808000,0xbf35bf35,0x3f80,0x3f35bf35,0x3f808000,0xbf55bf0e,0x3ec43f6d,0x3e48bf7b
.long 0x3f808000,0xbf6dbec4,0x3f353f35,0xbec4bf6d,0x3f808000,0xbf7bbe48,0x3f6d3ec4,0xbf55bf0e
.long 0x3f808000,0xbf808000,0x3f808000,0xbf808000,0x3f808000,0xbf7b3e48,0x3f6dbec4,0xbf553f0e
.long 0x3f808000,0xbf6d3ec4,0x3f35bf35,0xbec43f6d,0x3f808000,0xbf553f0e,0x3ec4bf6d,0x3e483f7b
.long 0x3f808000,0xbf353f35,0xbf80,0x3f353f35,0x3f808000,0xbf0e3f55,0xbec4bf6d,0x3f7b3e48
.long 0x3f808000,0xbec43f6d,0xbf35bf35,0x3f6dbec4,0x3f808000,0xbe483f7b,0xbf6dbec4,0x3f0ebf55
.long 0x3f808000,0x3f80,0xbf808000,0xbf80,0x3f808000,0x3e483f7b,0xbf6d3ec4,0xbf0ebf55
.long 0x3f808000,0x3ec43f6d,0xbf353f35,0xbf6dbec4,0x3f808000,0x3f0e3f55,0xbec43f6d,0xbf7b3e48
.long 0x3f808000,0x3f353f35,0x3f80,0xbf353f35,0x3f808000,0x3f553f0e,0x3ec43f6d,0xbe483f7b
.long 0x3f808000,0x3f6d3ec4,0x3f353f35,0x3ec43f6d,0x3f808000,0x3f7b3e48,0x3f6d3ec4,0x3f553f0e
.long 0x3f808000,0x3f808000,0x3f808000,0x3f808000,0x3f35bf35,0x3f0ebf55,0x3ec4bf6d,0x3e48bf7b
.long 0xbf80,0xbec4bf6d,0xbf35bf35,0xbf6dbec4,0xbf35bf35,0xbf7bbe48,0xbf6d3ec4,0xbf0e3f55
.long 0xbf808000,0xbf353f35,0x3f80,0x3f353f35,0xbf353f35,0x3e483f7b,0x3f6d3ec4,0x3f55bf0e
.long 0x3f80,0x3f6d3ec4,0x3f35bf35,0xbec4bf6d,0x3f353f35,0x3f55bf0e,0xbec4bf6d,0xbf7b3e48
.long 0x3f808000,0xbf80,0xbf808000,0x3f80,0x3f35bf35,0xbf55bf0e,0xbec43f6d,0x3f7b3e48
.long 0xbf80,0xbf6d3ec4,0x3f353f35,0x3ec4bf6d,0xbf35bf35,0xbe483f7b,0x3f6dbec4,0xbf55bf0e
.long 0xbf808000,0x3f353f35,0xbf80,0xbf353f35,0xbf353f35,0x3f7bbe48,0xbf6dbec4,0x3f0e3f55
.long 0x3f80,0x3ec4bf6d,0xbf353f35,0x3f6dbec4,0x3f353f35,0xbf0ebf55,0x3ec43f6d,0xbe48bf7b
.long 0x3f808000,0xbf808000,0x3f808000,0xbf808000,0x3f35bf35,0xbf0e3f55,0x3ec4bf6d,0xbe483f7b
.long 0xbf80,0x3ec43f6d,0xbf35bf35,0x3f6d3ec4,0xbf35bf35,0x3f7b3e48,0xbf6d3ec4,0x3f0ebf55
.long 0xbf808000,0x3f35bf35,0x3f80,0xbf35bf35,0xbf353f35,0xbe48bf7b,0x3f6d3ec4,0xbf553f0e
.long 0x3f80,0xbf6dbec4,0x3f35bf35,0x3ec43f6d,0x3f353f35,0xbf553f0e,0xbec4bf6d,0x3f7bbe48
.long 0x3f808000,0x3f80,0xbf808000,0xbf80,0x3f35bf35,0x3f553f0e,0xbec43f6d,0xbf7bbe48
.long 0xbf80,0x3f6dbec4,0x3f353f35,0xbec43f6d,0xbf35bf35,0x3e48bf7b,0x3f6dbec4,0x3f553f0e
.long 0xbf808000,0xbf35bf35,0xbf80,0x3f35bf35,0xbf353f35,0xbf7b3e48,0xbf6dbec4,0xbf0ebf55
.long 0x3f80,0xbec43f6d,0xbf353f35,0xbf6d3ec4,0x3f353f35,0x3f0e3f55,0x3ec43f6d,0x3e483f7b
.long 0x3f808000,0x3f808000,0x3f808000,0x3f808000,0xbf80,0xbe48bf7b,0xbec4bf6d,0xbf0ebf55
.long 0xbf808000,0xbf6d3ec4,0xbf353f35,0xbec43f6d,0x3f80,0x3f0e3f55,0x3f6d3ec4,0x3f7bbe48
.long 0x3f808000,0x3f35bf35,0xbf80,0xbf35bf35,0xbf80,0xbf55bf0e,0xbf6d3ec4,0xbe483f7b
.long 0xbf808000,0xbec43f6d,0x3f353f35,0x3f6dbec4,0x3f80,0x3f7b3e48,0x3ec4bf6d,0xbf55bf0e
.long 0x3f808000,0xbf80,0xbf808000,0x3f80,0xbf80,0xbf7b3e48,0x3ec43f6d,0x3f55bf0e
.long 0xbf808000,0x3ec43f6d,0x3f35bf35,0xbf6dbec4,0x3f80,0x3f55bf0e,0xbf6dbec4,0x3e483f7b
.long 0x3f808000,0xbf35bf35,0x3f80,0x3f35bf35,0xbf80,0xbf0e3f55,0x3f6dbec4,0xbf7bbe48
.long 0xbf808000,0x3f6d3ec4,0xbf35bf35,0x3ec43f6d,0x3f80,0x3e48bf7b,0xbec43f6d,0x3f0ebf55
.long 0x3f808000,0xbf808000,0x3f808000,0xbf808000,0xbf80,0x3e483f7b,0xbec4bf6d,0x3f0e3f55
.long 0xbf808000,0x3f6dbec4,0xbf353f35,0x3ec4bf6d,0x3f80,0xbf0ebf55,0x3f6d3ec4,0xbf7b3e48
.long 0x3f808000,0xbf353f35,0xbf80,0x3f353f35,0xbf80,0x3f553f0e,0xbf6d3ec4,0x3e48bf7b
.long 0xbf808000,0x3ec4bf6d,0x3f353f35,0xbf6d3ec4,0x3f80,0xbf7bbe48,0x3ec4bf6d,0x3f553f0e
.long 0x3f808000,0x3f80,0xbf808000,0xbf80,0xbf80,0x3f7bbe48,0x3ec43f6d,0xbf553f0e
.long 0xbf808000,0xbec4bf6d,0x3f35bf35,0x3f6d3ec4,0x3f80,0xbf553f0e,0xbf6dbec4,0xbe48bf7b
.long 0x3f808000,0x3f353f35,0x3f80,0xbf353f35,0xbf80,0x3f0ebf55,0x3f6dbec4,0x3f7b3e48
.long 0xbf808000,0xbf6dbec4,0xbf35bf35,0xbec4bf6d,0x3f80,0xbe483f7b,0xbec43f6d,0xbf0e3f55
.long 0x3f808000,0x3f808000,0x3f808000,0x3f808000,0xbf35bf35,0xbf55bf0e,0xbf6dbec4,0xbf7bbe48
.long 0x3f80,0x3ec43f6d,0x3f353f35,0x3f6d3ec4,0x3f35bf35,0x3e48bf7b,0xbec4bf6d,0xbf55bf0e
.long 0xbf808000,0xbf353f35,0x3f80,0x3f353f35,0x3f353f35,0x3f7bbe48,0x3ec4bf6d,0xbf0ebf55
.long 0xbf80,0xbf6dbec4,0xbf353f35,0x3ec43f6d,0xbf353f35,0x3f0e3f55,0x3f6dbec4,0xbe48bf7b
.long 0x3f808000,0xbf80,0xbf808000,0x3f80,0xbf35bf35,0xbf0e3f55,0x3f6d3ec4,0x3e48bf7b
.long 0x3f80,0x3f6dbec4,0xbf35bf35,0xbec43f6d,0x3f35bf35,0xbf7bbe48,0x3ec43f6d,0x3f0ebf55
.long 0xbf808000,0x3f353f35,0xbf80,0xbf353f35,0x3f353f35,0xbe48bf7b,0xbec43f6d,0x3f55bf0e
.long 0xbf80,0xbec43f6d,0x3f35bf35,0xbf6d3ec4,0xbf353f35,0x3f55bf0e,0xbf6d3ec4,0x3f7bbe48
.long 0x3f808000,0xbf808000,0x3f808000,0xbf808000,0xbf35bf35,0x3f553f0e,0xbf6dbec4,0x3f7b3e48
.long 0x3f80,0xbec4bf6d,0x3f353f35,0xbf6dbec4,0x3f35bf35,0xbe483f7b,0xbec4bf6d,0x3f553f0e
.long 0xbf808000,0x3f35bf35,0x3f80,0xbf35bf35,0x3f353f35,0xbf7b3e48,0x3ec4bf6d,0x3f0e3f55
.long 0xbf80,0x3f6d3ec4,0xbf353f35,0xbec4bf6d,0xbf353f35,0xbf0ebf55,0x3f6dbec4,0x3e483f7b
.long 0x3f808000,0x3f80,0xbf808000,0xbf80,0xbf35bf35,0x3f0ebf55,0x3f6d3ec4,0xbe483f7b
.long 0x3f80,0xbf6d3ec4,0xbf35bf35,0x3ec4bf6d,0x3f35bf35,0x3f7b3e48,0x3ec43f6d,0xbf0e3f55
.long 0xbf808000,0xbf35bf35,0xbf80,0x3f35bf35,0x3f353f35,0x3e483f7b,0xbec43f6d,0xbf553f0e
.long 0xbf80,0x3ec4bf6d,0x3f35bf35,0x3f6dbec4,0xbf353f35,0xbf553f0e,0xbf6d3ec4,0xbf7b3e48
.long 0x3f808000,0x3f808000,0x3f808000,0x3f808000,0xbf808000,0xbf7b3e48,0xbf6d3ec4,0xbf553f0e
.long 0x3f808000,0x3f6dbec4,0x3f35bf35,0x3ec4bf6d,0xbf808000,0xbf553f0e,0xbec43f6d,0x3e483f7b
.long 0x3f808000,0x3f35bf35,0xbf80,0xbf35bf35,0xbf808000,0xbf0e3f55,0x3ec43f6d,0x3f7b3e48
.long 0x3f808000,0x3ec4bf6d,0xbf35bf35,0xbf6d3ec4,0xbf808000,0xbe483f7b,0x3f6d3ec4,0x3f0ebf55
.long 0x3f808000,0xbf80,0xbf808000,0x3f80,0xbf808000,0x3e483f7b,0x3f6dbec4,0xbf0ebf55
.long 0x3f808000,0xbec4bf6d,0xbf353f35,0x3f6d3ec4,0xbf808000,0x3f0e3f55,0x3ec4bf6d,0xbf7b3e48
.long 0x3f808000,0xbf35bf35,0x3f80,0x3f35bf35,0xbf808000,0x3f553f0e,0xbec4bf6d,0xbe483f7b
.long 0x3f808000,0xbf6dbec4,0x3f353f35,0xbec4bf6d,0xbf808000,0x3f7b3e48,0xbf6dbec4,0x3f553f0e
.long 0x3f808000,0xbf808000,0x3f808000,0xbf808000,0xbf808000,0x3f7bbe48,0xbf6d3ec4,0x3f55bf0e
.long 0x3f808000,0xbf6d3ec4,0x3f35bf35,0xbec43f6d,0xbf808000,0x3f55bf0e,0xbec43f6d,0xbe48bf7b
.long 0x3f808000,0xbf353f35,0xbf80,0x3f353f35,0xbf808000,0x3f0ebf55,0x3ec43f6d,0xbf7bbe48
.long 0x3f808000,0xbec43f6d,0xbf35bf35,0x3f6dbec4,0xbf808000,0x3e48bf7b,0x3f6d3ec4,0xbf0e3f55
.long 0x3f808000,0x3f80,0xbf808000,0xbf80,0xbf808000,0xbe48bf7b,0x3f6dbec4,0x3f0e3f55
.long 0x3f808000,0x3ec43f6d,0xbf353f35,0xbf6dbec4,0xbf808000,0xbf0ebf55,0x3ec4bf6d,0x3f7bbe48
.long 0x3f808000,0x3f353f35,0x3f80,0xbf353f35,0xbf808000,0xbf55bf0e,0xbec4bf6d,0x3e48bf7b
.long 0x3f808000,0x3f6d3ec4,0x3f353f35,0x3ec43f6d,0xbf808000,0xbf7bbe48,0xbf6dbec4,0xbf55bf0e
.long 0x3f808000,0x3f808000,0x3f808000,0x3f808000,0xbf353f35,0xbf0e3f55,0xbec43f6d,0xbe483f7b
.long 0xbf80,0xbec4bf6d,0xbf35bf35,0xbf6dbec4,0x3f353f35,0x3f7b3e48,0x3f6dbec4,0x3f0ebf55
.long 0xbf808000,0xbf353f35,0x3f80,0x3f353f35,0x3f35bf35,0xbe48bf7b,0xbf6dbec4,0xbf553f0e
.long 0x3f80,0x3f6d3ec4,0x3f35bf35,0xbec4bf6d,0xbf35bf35,0xbf553f0e,0x3ec43f6d,0x3f7bbe48
.long 0x3f808000,0xbf80,0xbf808000,0x3f80,0xbf353f35,0x3f553f0e,0x3ec4bf6d,0xbf7bbe48
.long 0xbf80,0xbf6d3ec4,0x3f353f35,0x3ec4bf6d,0x3f353f35,0x3e48bf7b,0xbf6d3ec4,0x3f553f0e
.long 0xbf808000,0x3f353f35,0xbf80,0xbf353f35,0x3f35bf35,0xbf7b3e48,0x3f6d3ec4,0xbf0ebf55
.long 0x3f80,0x3ec4bf6d,0xbf353f35,0x3f6dbec4,0xbf35bf35,0x3f0e3f55,0xbec4bf6d,0x3e483f7b
.long 0x3f808000,0xbf808000,0x3f808000,0xbf808000,0xbf353f35,0x3f0ebf55,0xbec43f6d,0x3e48bf7b
.long 0xbf80,0x3ec43f6d,0xbf35bf35,0x3f6d3ec4,0x3f353f35,0xbf7bbe48,0x3f6dbec4,0xbf0e3f55
.long 0xbf808000,0x3f35bf35,0x3f80,0xbf35bf35,0x3f35bf35,0x3e483f7b,0xbf6dbec4,0x3f55bf0e
.long 0x3f80,0xbf6dbec4,0x3f35bf35,0x3ec43f6d,0xbf35bf35,0x3f55bf0e,0x3ec43f6d,0xbf7b3e48
.long 0x3f808000,0x3f80,0xbf808000,0xbf80,0xbf353f35,0xbf55bf0e,0x3ec4bf6d,0x3f7b3e48
.long 0xbf80,0x3f6dbec4,0x3f353f35,0xbec43f6d,0x3f353f35,0xbe483f7b,0xbf6d3ec4,0xbf55bf0e
.long 0xbf808000,0xbf35bf35,0xbf80,0x3f35bf35,0x3f35bf35,0x3f7bbe48,0x3f6d3ec4,0x3f0e3f55
.long 0x3f80,0xbec43f6d,0xbf353f35,0xbf6d3ec4,0xbf35bf35,0xbf0ebf55,0xbec4bf6d,0xbe48bf7b
.long 0x3f808000,0x3f808000,0x3f808000,0x3f808000,0x3f80,0x3e483f7b,0x3ec43f6d,0x3f0e3f55
.long 0xbf808000,0xbf6d3ec4,0xbf353f35,0xbec43f6d,0xbf80,0xbf0ebf55,0xbf6dbec4,0xbf7b3e48
.long 0x3f808000,0x3f35bf35,0xbf80,0xbf35bf35,0x3f80,0x3f553f0e,0x3f6dbec4,0x3e48bf7b
.long 0xbf808000,0xbec43f6d,0x3f353f35,0x3f6dbec4,0xbf80,0xbf7bbe48,0xbec43f6d,0x3f553f0e
.long 0x3f808000,0xbf80,0xbf808000,0x3f80,0x3f80,0x3f7bbe48,0xbec4bf6d,0xbf553f0e
.long 0xbf808000,0x3ec43f6d,0x3f35bf35,0xbf6dbec4,0xbf80,0xbf553f0e,0x3f6d3ec4,0xbe48bf7b
.long 0x3f808000,0xbf35bf35,0x3f80,0x3f35bf35,0x3f80,0x3f0ebf55,0xbf6d3ec4,0x3f7b3e48
.long 0xbf808000,0x3f6d3ec4,0xbf35bf35,0x3ec43f6d,0xbf80,0xbe483f7b,0x3ec4bf6d,0xbf0e3f55
.long 0x3f808000,0xbf808000,0x3f808000,0xbf808000,0x3f80,0xbe48bf7b,0x3ec43f6d,0xbf0ebf55
.long 0xbf808000,0x3f6dbec4,0xbf353f35,0x3ec4bf6d,0xbf80,0x3f0e3f55,0xbf6dbec4,0x3f7bbe48
.long 0x3f808000,0xbf353f35,0xbf80,0x3f353f35,0x3f80,0xbf55bf0e,0x3f6dbec4,0xbe483f7b
.long 0xbf808000,0x3ec4bf6d,0x3f353f35,0xbf6d3ec4,0xbf80,0x3f7b3e48,0xbec43f6d,0xbf55bf0e
.long 0x3f808000,0x3f80,0xbf808000,0xbf80,0x3f80,0xbf7b3e48,0xbec4bf6d,0x3f55bf0e
.long 0xbf808000,0xbec4bf6d,0x3f35bf35,0x3f6d3ec4,0xbf80,0x3f55bf0e,0x3f6d3ec4,0x3e483f7b
.long 0x3f808000,0x3f353f35,0x3f80,0xbf353f35,0x3f80,0xbf0e3f55,0xbf6d3ec4,0xbf7bbe48
.long 0xbf808000,0xbf6dbec4,0xbf35bf35,0xbec4bf6d,0xbf80,0x3e48bf7b,0x3ec4bf6d,0x3f0ebf55
.long 0x3f808000,0x3f808000,0x3f808000,0x3f808000,0x3f353f35,0x3f553f0e,0x3f6d3ec4,0x3f7b3e48
.long 0x3f80,0x3ec43f6d,0x3f353f35,0x3f6d3ec4,0xbf353f35,0xbe483f7b,0x3ec43f6d,0x3f553f0e
.long 0xbf808000,0xbf353f35,0x3f80,0x3f353f35,0xbf35bf35,0xbf7b3e48,0xbec43f6d,0x3f0e3f55
.long 0xbf80,0xbf6dbec4,0xbf353f35,0x3ec43f6d,0x3f35bf35,0xbf0ebf55,0xbf6d3ec4,0x3e483f7b
.long 0x3f808000,0xbf80,0xbf808000,0x3f80,0x3f353f35,0x3f0ebf55,0xbf6dbec4,0xbe483f7b
.long 0x3f80,0x3f6dbec4,0xbf35bf35,0xbec43f6d,0xbf353f35,0x3f7b3e48,0xbec4bf6d,0xbf0e3f55
.long 0xbf808000,0x3f353f35,0xbf80,0xbf353f35,0xbf35bf35,0x3e483f7b,0x3ec4bf6d,0xbf553f0e
.long 0xbf80,0xbec43f6d,0x3f35bf35,0xbf6d3ec4,0x3f35bf35,0xbf553f0e,0x3f6dbec4,0xbf7b3e48
.long 0x3f808000,0xbf808000,0x3f808000,0xbf808000,0x3f353f35,0xbf55bf0e,0x3f6d3ec4,0xbf7bbe48
.long 0x3f80,0xbec4bf6d,0x3f353f35,0xbf6dbec4,0xbf353f35,0x3e48bf7b,0x3ec43f6d,0xbf55bf0e
.long 0xbf808000,0x3f35bf35,0x3f80,0xbf35bf35,0xbf35bf35,0x3f7bbe48,0xbec43f6d,0xbf0ebf55
.long 0xbf80,0x3f6d3ec4,0xbf353f35,0xbec4bf6d,0x3f35bf35,0x3f0e3f55,0xbf6d3ec4,0xbe48bf7b
.long 0x3f808000,0x3f80,0xbf808000,0xbf80,0x3f353f35,0xbf0e3f55,0xbf6dbec4,0x3e48bf7b
.long 0x3f80,0xbf6d3ec4,0xbf35bf35,0x3ec4bf6d,0xbf353f35,0xbf7bbe48,0xbec4bf6d,0x3f0ebf55
.long 0xbf808000,0xbf35bf35,0xbf80,0x3f35bf35,0xbf35bf35,0xbe48bf7b,0x3ec4bf6d,0x3f55bf0e
.long 0xbf80,0x3ec4bf6d,0x3f35bf35,0x3f6dbec4,0x3f35bf35,0x3f55bf0e,0x3f6dbec4,0x3f7bbe48
.long 0x3f800000,0x3f800000,0x3f800000,0x3f800000,0x3f800000,0x3f7ffec4,0x3f7ffb11,0x3f7ff4e6
.long 0x3f800000,0x3f7ffb11,0x3f7fec43,0x3f7fd397,0x3f800000,0x3f7ff4e6,0x3f7fd397,0x3f7f9c18
.long 0x3f800000,0x3f7fec43,0x3f7fb10f,0x3f7f4e6d,0x3f800000,0x3f7fe129,0x3f7f84ab,0x3f7eea9d
.long 0x3f800000,0x3f7fd397,0x3f7f4e6d,0x3f7e70b0,0x3f800000,0x3f7fc38f,0x3f7f0e58,0x3f7de0b1
.long 0x3f800000,0x3f7fb10f,0x3f7ec46d,0x3f7d3aac,0x3f800000,0x3f7f9c18,0x3f7e70b0,0x3f7c7eb0
.long 0x3f800000,0x3f7f84ab,0x3f7e1324,0x3f7baccd,0x3f800000,0x3f7f6ac7,0x3f7dabcc,0x3f7ac516
.long 0x3f800000,0x3f7f4e6d,0x3f7d3aac,0x3f79c79d,0x3f800000,0x3f7f2f9d,0x3f7cbfc9,0x3f78b47b
.long 0x3f800000,0x3f7f0e58,0x3f7c3b28,0x3f778bc5,0x3f800000,0x3f7eea9d,0x3f7baccd,0x3f764d97
.long 0x3f800000,0x3f7ec46d,0x3f7b14be,0x3f74fa0b,0x3f800000,0x3f7e9bc9,0x3f7a7302,0x3f73913f
.long 0x3f800000,0x3f7e70b0,0x3f79c79d,0x3f721352,0x3f800000,0x3f7e4323,0x3f791298,0x3f708066
.long 0x3f800000,0x3f7e1324,0x3f7853f8,0x3f6ed89e,0x3f800000,0x3f7de0b1,0x3f778bc5,0x3f6d1c1d
.long 0x3f800000,0x3f7dabcc,0x3f76ba07,0x3f6b4b0c,0x3f800000,0x3f7d7474,0x3f75dec6,0x3f696591
.long 0x3f800000,0x3f7d3aac,0x3f74fa0b,0x3f676bd8,0x3f800000,0x3f7cfe73,0x3f740bdd,0x3f655e0b
.long 0x3f800000,0x3f7cbfc9,0x3f731447,0x3f633c5a,0x3f800000,0x3f7c7eb0,0x3f721352,0x3f6106f2
.long 0x3f800000,0x3f7c3b28,0x3f710908,0x3f5ebe05,0x3f800000,0x3f7bf531,0x3f6ff573,0x3f5c61c7
.long 0x3f800000,0x3f7baccd,0x3f6ed89e,0x3f59f26a,0x3f800000,0x3f7b61fc,0x3f6db293,0x3f577026
.long 0x3f800000,0x3f800000,0x3f800000,0x3f800000,0x3f7fec43,0x3f7fe129,0x3f7fd397,0x3f7fc38f
.long 0x3f7fb10f,0x3f7f84ab,0x3f7f4e6d,0x3f7f0e58,0x3f7f4e6d,0x3f7eea9d,0x3f7e70b0,0x3f7de0b1
.long 0x3f7ec46d,0x3f7e1324,0x3f7d3aac,0x3f7c3b28,0x3f7e1324,0x3f7cfe73,0x3f7baccd,0x3f7a1e84
.long 0x3f7d3aac,0x3f7baccd,0x3f79c79d,0x3f778bc5,0x3f7c3b28,0x3f7a1e84,0x3f778bc5,0x3f748422
.long 0x3f7b14be,0x3f7853f8,0x3f74fa0b,0x3f710908,0x3f79c79d,0x3f764d97,0x3f721352,0x3f6d1c1d
.long 0x3f7853f8,0x3f740bdd,0x3f6ed89e,0x3f68bf3c,0x3f76ba07,0x3f718f57,0x3f6b4b0c,0x3f63f473
.long 0x3f74fa0b,0x3f6ed89e,0x3f676bd8,0x3f5ebe05,0x3f731447,0x3f6be858,0x3f633c5a,0x3f591e6a
.long 0x3f710908,0x3f68bf3c,0x3f5ebe05,0x3f531849,0x3f6ed89e,0x3f655e0b,0x3f59f26a,0x3f4cae79
.long 0x3f6c835e,0x3f61c598,0x3f54db31,0x3f45e403,0x3f6a09a7,0x3f5df6be,0x3f4f7a1f,0x3f3ebc1b
.long 0x3f676bd8,0x3f59f26a,0x3f49d112,0x3f373a23,0x3f64aa59,0x3f55b993,0x3f43e200,0x3f2f61a5
.long 0x3f61c598,0x3f514d3d,0x3f3daef9,0x3f273656,0x3f5ebe05,0x3f4cae79,0x3f373a23,0x3f1ebc12
.long 0x3f5b941a,0x3f47de65,0x3f3085bb,0x3f15f6d9,0x3f584853,0x3f42de29,0x3f299415,0x3f0cead0
.long 0x3f54db31,0x3f3daef9,0x3f226799,0x3f039c3d,0x3f514d3d,0x3f385216,0x3f1b02c6,0x3ef41f07
.long 0x3f4d9f02,0x3f32c8c9,0x3f13682a,0x3ee0924f,0x3f49d112,0x3f2d1469,0x3f0b9a6b,0x3ecc9b8b
.long 0x3f45e403,0x3f273656,0x3f039c3d,0x3eb8442a,0x3f41d870,0x3f212ff9,0x3ef6e0cb,0x3ea395c5
.long 0x3f3daef9,0x3f1b02c6,0x3ee63375,0x3e8e9a22,0x3f396842,0x3f14b039,0x3ed53641,0x3e72b651
.long 0x3f800000,0x3f800000,0x3f800000,0x3f800000,0x3f7fb10f,0x3f7f9c18,0x3f7f84ab,0x3f7f6ac7
.long 0x3f7ec46d,0x3f7e70b0,0x3f7e1324,0x3f7dabcc,0x3f7d3aac,0x3f7c7eb0,0x3f7baccd,0x3f7ac516
.long 0x3f7b14be,0x3f79c79d,0x3f7853f8,0x3f76ba07,0x3f7853f8,0x3f764d97,0x3f740bdd,0x3f718f57
.long 0x3f74fa0b,0x3f721352,0x3f6ed89e,0x3f6b4b0c,0x3f710908,0x3f6d1c1d,0x3f68bf3c,0x3f63f473
.long 0x3f6c835e,0x3f676bd8,0x3f61c598,0x3f5b941a,0x3f676bd8,0x3f6106f2,0x3f59f26a,0x3f5233c6
.long 0x3f61c598,0x3f59f26a,0x3f514d3d,0x3f47de65,0x3f5b941a,0x3f5233c6,0x3f47de65,0x3f3ca003
.long 0x3f54db31,0x3f49d112,0x3f3daef9,0x3f3085bb,0x3f4d9f02,0x3f40d0da,0x3f32c8c9,0x3f239da9
.long 0x3f45e403,0x3f373a23,0x3f273656,0x3f15f6d9,0x3f3daef9,0x3f2d1469,0x3f1b02c6,0x3f07a136
.long 0x3f3504f3,0x3f226799,0x3f0e39da,0x3ef15aea,0x3f2beb4a,0x3f173c07,0x3f00e7e4,0x3ed25a09
.long 0x3f226799,0x3f0b9a6b,0x3ee63375,0x3eb263ef,0x3f187fc0,0x3eff17b2,0x3ec9b953,0x3e919ddd
.long 0x3f0e39da,0x3ee63375,0x3eac7cd4,0x3e605c13,0x3f039c3d,0x3ecc9b8b,0x3e8e9a22,0x3e1c76de
.long 0x3ef15aea,0x3eb263ef,0x3e605c13,0x3dafb680,0x3edae880,0x3e97a117,0x3e22abb6,0x3c96c9b6
.long 0x3ec3ef15,0x3e78cfcc,0x3dc8bd36,0xbd48fb30,0x3eac7cd4,0x3e419b37,0x3d16c32c,0xbdee3876
.long 0x3e94a031,0x3e09cf86,0xbcc90ab0,0xbe3b6ecf,0x3e78cfcc,0x3da3308c,0xbdafb680,0xbe7ee6e1
.long 0x3e47c5c2,0x3cc90ab0,0xbe164083,0xbea09ae5,0x3e164083,0xbcfb49ba,0xbe541501,0xbec1071e
.long 0x3dc8bd36,0xbdafb680,0xbe888e93,0xbee0924f,0x3d48fb30,0xbe1008b7,0xbea68f12,0xbeff17b2
.long 0x3f800000,0x3f800000,0x3f800000,0x3f800000,0x3f7f4e6d,0x3f7f2f9d,0x3f7f0e58,0x3f7eea9d
.long 0x3f7d3aac,0x3f7cbfc9,0x3f7c3b28,0x3f7baccd,0x3f79c79d,0x3f78b47b,0x3f778bc5,0x3f764d97
.long 0x3f74fa0b,0x3f731447,0x3f710908,0x3f6ed89e,0x3f6ed89e,0x3f6be858,0x3f68bf3c,0x3f655e0b
.long 0x3f676bd8,0x3f633c5a,0x3f5ebe05,0x3f59f26a,0x3f5ebe05,0x3f591e6a,0x3f531849,0x3f4cae79
.long 0x3f54db31,0x3f4d9f02,0x3f45e403,0x3f3daef9,0x3f49d112,0x3f40d0da,0x3f373a23,0x3f2d1469
.long 0x3f3daef9,0x3f32c8c9,0x3f273656,0x3f1b02c6,0x3f3085bb,0x3f239da9,0x3f15f6d9,0x3f07a136
.long 0x3f226799,0x3f13682a,0x3f039c3d,0x3ee63375,0x3f13682a,0x3f0242b1,0x3ee0924f,0x3ebb31a0
.long 0x3f039c3d,0x3ee0924f,0x3eb8442a,0x3e8e9a22,0x3ee63375,0x3ebb31a0,0x3e8e9a22,0x3e419b37
.long 0x3ec3ef15,0x3e94a031,0x3e47c5c2,0x3dc8bd36,0x3ea09ae5,0x3e5a3997,0x3de1bc2e,0x3bc90f88
.long 0x3e78cfcc,0x3e09cf86,0x3cc90ab0,0xbdafb680,0x3e2f10a2,0x3d621469,0xbd7b2b74,0xbe354098
.long 0x3dc8bd36,0xbcc90ab0,0xbe164083,0xbe888e93,0x3cc90ab0,0xbdd53db9,0xbe6c9a7f,0xbeb554ec
.long 0xbd48fb30,0xbe3b6ecf,0xbea09ae5,0xbee0924f,0xbdfab273,0xbe8586ce,0xbec9b953,0xbf04f484
.long 0xbe47c5c2,0xbeac7cd4,0xbef15aea,0xbf187fc0,0xbe888e93,0xbed25a09,0xbf0b9a6b,0xbf2ac082
.long 0xbeac7cd4,0xbef6e0cb,0xbf1d7fd1,0xbf3b8f3b,0xbecf7bca,0xbf0cead0,0xbf2e3bde,0xbf4ac77f
.long 0xbef15aea,0xbf1d7fd1,0xbf3daef9,0xbf584853,0xbf08f59b,0xbf2d1469,0xbf4bbbf8,0xbf63f473
.long 0xbf187fc0,0xbf3b8f3b,0xbf584853,0xbf6db293,0xbf273656,0xbf48d8b3,0xbf633c5a,0xbf756d97
.long 0x3f800000,0x3f800000,0x3f800000,0x3f800000,0x3f7ec46d,0x3f7e9bc9,0x3f7e70b0,0x3f7e4323
.long 0x3f7b14be,0x3f7a7302,0x3f79c79d,0x3f791298,0x3f74fa0b,0x3f73913f,0x3f721352,0x3f708066
.long 0x3f6c835e,0x3f6a09a7,0x3f676bd8,0x3f64aa59,0x3f61c598,0x3f5df6be,0x3f59f26a,0x3f55b993
.long 0x3f54db31,0x3f4f7a1f,0x3f49d112,0x3f43e200,0x3f45e403,0x3f3ebc1b,0x3f373a23,0x3f2f61a5
.long 0x3f3504f3,0x3f2beb4a,0x3f226799,0x3f187fc0,0x3f226799,0x3f173c07,0x3f0b9a6b,0x3eff17b2
.long 0x3f0e39da,0x3f00e7e4,0x3ee63375,0x3ec9b953,0x3ef15aea,0x3ed25a09,0x3eb263ef,0x3e919ddd
.long 0x3ec3ef15,0x3ea09ae5,0x3e78cfcc,0x3e2f10a2,0x3e94a031,0x3e5a3997,0x3e09cf86,0x3d621469
.long 0x3e47c5c2,0x3de1bc2e,0x3cc90ab0,0xbd7b2b74,0x3dc8bd36,0x3bc90f88,0xbdafb680,0xbe354098
.long 0x248d3132,0xbdc8bd36,0xbe47c5c2,0xbe94a031,0xbdc8bd36,0xbe4dee60,0xbe9aa086,0xbecc9b8b
.long 0xbe47c5c2,0xbe9aa086,0xbecf7bca,0xbf00e7e4,0xbe94a031,0xbecc9b8b,0xbf00e7e4,0xbf19c200
.long 0xbec3ef15,0xbefc5d27,0xbf187fc0,0xbf3085bb,0xbef15aea,0xbf14b039,0xbf2e3bde,0xbf44e3f5
.long 0xbf0e39da,0xbf299415,0xbf41d870,0xbf5695e5,0xbf226799,0xbf3ca003,0xbf531849,0xbf655e0b
.long 0xbf3504f3,0xbf4d9f02,0xbf61c598,0xbf710908,0xbf45e403,0xbf5c61c7,0xbf6db293,0xbf796e4e
.long 0xbf54db31,0xbf68bf3c,0xbf76ba07,0xbf7e70b0,0xbf61c598,0xbf7294f8,0xbf7cbfc9,0xbf7ffec4
.long 0xbf6c835e,0xbf79c79d,0xbf7fb10f,0xbf7e1324,0xbf74fa0b,0xbf7e4323,0xbf7f84ab,0xbf78b47b
.long 0xbf7b14be,0xbf7ffb11,0xbf7c3b28,0xbf6ff573,0xbf7ec46d,0xbf7eea9d,0xbf75dec6,0xbf63f473
.long 0x3f800000,0x3f800000,0x3f800000,0x3f800000,0x3f7e1324,0x3f7de0b1,0x3f7dabcc,0x3f7d7474
.long 0x3f7853f8,0x3f778bc5,0x3f76ba07,0x3f75dec6,0x3f6ed89e,0x3f6d1c1d,0x3f6b4b0c,0x3f696591
.long 0x3f61c598,0x3f5ebe05,0x3f5b941a,0x3f584853,0x3f514d3d,0x3f4cae79,0x3f47de65,0x3f42de29
.long 0x3f3daef9,0x3f373a23,0x3f3085bb,0x3f299415,0x3f273656,0x3f1ebc12,0x3f15f6d9,0x3f0cead0
.long 0x3f0e39da,0x3f039c3d,0x3ef15aea,0x3edae880,0x3ee63375,0x3ecc9b8b,0x3eb263ef,0x3e97a117
.long 0x3eac7cd4,0x3e8e9a22,0x3e605c13,0x3e22abb6,0x3e605c13,0x3e1c76de,0x3dafb680,0x3c96c9b6
.long 0x3dc8bd36,0x3cc90ab0,0xbd48fb30,0xbdfab273,0xbcc90ab0,0xbdd53db9,0xbe3b6ecf,0xbe8586ce
.long 0xbe164083,0xbe6c9a7f,0xbea09ae5,0xbec9b953,0xbe888e93,0xbeb554ec,0xbee0924f,0xbf04f484
.long 0xbec3ef15,0xbef15aea,0xbf0e39da,0xbf226799,0xbefc5d27,0xbf14b039,0xbf299415,0xbf3ca003
.long 0xbf187fc0,0xbf2e3bde,0xbf41d870,0xbf531849,0xbf3085bb,0xbf44e3f5,0xbf5695e5,0xbf655e0b
.long 0xbf45e403,0xbf584853,0xbf676bd8,0xbf731447,0xbf584853,0xbf6816a8,0xbf740bdd,0xbf7bf531
.long 0xbf676bd8,0xbf740bdd,0xbf7c3b28,0xbf7fd397,0xbf731447,0xbf7bf531,0xbf7fd397,0xbf7e9bc9
.long 0xbf7b14be,0xbf7fb10f,0xbf7ec46d,0xbf7853f8,0xbf7f4e6d,0xbf7f2f9d,0xbf791298,0xbf6d1c1d
.long 0xbf7fb10f,0xbf7a7302,0xbf6ed89e,0xbf5d2d53,0xbf7c3b28,0xbf718f57,0xbf604621,0xbf48d8b3
.long 0xbf74fa0b,0xbf64aa59,0xbf4d9f02,0xbf3085bb,0xbf6a09a7,0xbf53fac3,0xbf373a23,0xbf14b039
.long 0xbf5b941a,0xbf3fc767,0xbf1d7fd1,0xbeebcbbb,0xbf49d112,0xbf286605,0xbf00e7e4,0xbea986c4
.long 0x3f800000,0x3f800000,0x3f800000,0x3f800000,0x3f7d3aac,0x3f7cfe73,0x3f7cbfc9,0x3f7c7eb0
.long 0x3f74fa0b,0x3f740bdd,0x3f731447,0x3f721352,0x3f676bd8,0x3f655e0b,0x3f633c5a,0x3f6106f2
.long 0x3f54db31,0x3f514d3d,0x3f4d9f02,0x3f49d112,0x3f3daef9,0x3f385216,0x3f32c8c9,0x3f2d1469
.long 0x3f226799,0x3f1b02c6,0x3f13682a,0x3f0b9a6b,0x3f039c3d,0x3ef41f07,0x3ee0924f,0x3ecc9b8b
.long 0x3ec3ef15,0x3eac7cd4,0x3e94a031,0x3e78cfcc,0x3e78cfcc,0x3e419b37,0x3e09cf86,0x3da3308c
.long 0x3dc8bd36,0x3d16c32c,0xbcc90ab0,0xbdafb680,0xbd48fb30,0xbdee3876,0xbe3b6ecf,0xbe7ee6e1
.long 0xbe47c5c2,0xbe888e93,0xbeac7cd4,0xbecf7bca,0xbeac7cd4,0xbed25a09,0xbef6e0cb,0xbf0cead0
.long 0xbef15aea,0xbf0b9a6b,0xbf1d7fd1,0xbf2e3bde,0xbf187fc0,0xbf2ac082,0xbf3b8f3b,0xbf4ac77f
.long 0xbf3504f3,0xbf45e403,0xbf54db31,0xbf61c598,0xbf4d9f02,0xbf5c61c7,0xbf68bf3c,0xbf7294f8
.long 0xbf61c598,0xbf6db293,0xbf76ba07,0xbf7cbfc9,0xbf710908,0xbf796e4e,0xbf7e70b0,0xbf7ffec4
.long 0xbf7b14be,0xbf7f4e6d,0xbf7fb10f,0xbf7c3b28,0xbf7fb10f,0xbf7f2f9d,0xbf7a7302,0xbf718f57
.long 0xbf7ec46d,0xbf791298,0xbf6ed89e,0xbf604621,0xbf7853f8,0xbf6d1c1d,0xbf5d2d53,0xbf48d8b3
.long 0xbf6c835e,0xbf5b941a,0xbf45e403,0xbf2beb4a,0xbf5b941a,0xbf44e3f5,0xbf299415,0xbf0a48ad
.long 0xbf45e403,0xbf299415,0xbf08f59b,0xbec9b953,0xbf2beb4a,0xbf0a48ad,0xbec9b953,0xbe72b651
.long 0xbf0e39da,0xbecf7bca,0xbe78cfcc,0xbd96a905,0xbedae880,0xbe8586ce,0xbdafb680,0x3dbc3ac3
.long 0xbe94a031,0xbde1bc2e,0x3d96a905,0x3e827dc0,0xbe164083,0x3d2fe007,0x3e6c9a7f,0x3ed25a09
.long 0x3f800000,0x3f800000,0x3f800000,0x3f800000,0x3f7c3b28,0x3f7bf531,0x3f7baccd,0x3f7b61fc
.long 0x3f710908,0x3f6ff573,0x3f6ed89e,0x3f6db293,0x3f5ebe05,0x3f5c61c7,0x3f59f26a,0x3f577026
.long 0x3f45e403,0x3f41d870,0x3f3daef9,0x3f396842,0x3f273656,0x3f212ff9,0x3f1b02c6,0x3f14b039
.long 0x3f039c3d,0x3ef6e0cb,0x3ee63375,0x3ed53641,0x3eb8442a,0x3ea395c5,0x3e8e9a22,0x3e72b651
.long 0x3e47c5c2,0x3e164083,0x3dc8bd36,0x3d48fb30,0x3cc90ab0,0xbcfb49ba,0xbdafb680,0xbe1008b7
.long 0xbe164083,0xbe541501,0xbe888e93,0xbea68f12,0xbea09ae5,0xbec1071e,0xbee0924f,0xbeff17b2
.long 0xbef15aea,0xbf08f59b,0xbf187fc0,0xbf273656,0xbf1d7fd1,0xbf2d1469,0xbf3b8f3b,0xbf48d8b3
.long 0xbf3daef9,0xbf4bbbf8,0xbf584853,0xbf633c5a,0xbf584853,0xbf63f473,0xbf6db293,0xbf756d97
.long 0xbf6c835e,0xbf74fa0b,0xbf7b14be,0xbf7ec46d,0xbf79c79d,0xbf7e4323,0xbf7ffb11,0xbf7eea9d
.long 0xbf7fb10f,0xbf7f84ab,0xbf7c3b28,0xbf75dec6,0xbf7e1324,0xbf78b47b,0xbf6ff573,0xbf63f473
.long 0xbf74fa0b,0xbf6a09a7,0xbf5b941a,0xbf49d112,0xbf64aa59,0xbf53fac3,0xbf3fc767,0xbf286605
.long 0xbf4d9f02,0xbf373a23,0xbf1d7fd1,0xbf00e7e4,0xbf3085bb,0xbf14b039,0xbeebcbbb,0xbea986c4
.long 0xbf0e39da,0xbedae880,0xbe94a031,0xbe164083,0xbecf7bca,0xbe8586ce,0xbde1bc2e,0x3d2fe007
.long 0xbe78cfcc,0xbdafb680,0x3d96a905,0x3e6c9a7f,0xbd96a905,0x3dbc3ac3,0x3e827dc0,0x3ed25a09
.long 0x3dc8bd36,0x3e888e93,0x3edae880,0x3f13682a,0x3e888e93,0x3eddbe79,0x3f15f6d9,0x3f385216
.long 0x3edae880,0x3f15f6d9,0x3f396842,0x3f5695e5,0x3f13682a,0x3f385216,0x3f5695e5,0x3f6d1c1d
.long 0x80000000,0x80000000,0x80000000,0x80000000,0x80000000,0xbbc90f88,0xbc490e90,0xbc96c9b6
.long 0x80000000,0xbc490e90,0xbcc90ab0,0xbd16c32c,0x80000000,0xbc96c9b6,0xbd16c32c,0xbd621469
.long 0x80000000,0xbcc90ab0,0xbd48fb30,0xbd96a905,0x80000000,0xbcfb49ba,0xbd7b2b74,0xbdbc3ac3
.long 0x80000000,0xbd16c32c,0xbd96a905,0xbde1bc2e,0x80000000,0xbd2fe007,0xbdafb680,0xbe039502
.long 0x80000000,0xbd48fb30,0xbdc8bd36,0xbe164083,0x80000000,0xbd621469,0xbde1bc2e,0xbe28defc
.long 0x80000000,0xbd7b2b74,0xbdfab273,0xbe3b6ecf,0x80000000,0xbd8a200a,0xbe09cf86,0xbe4dee60
.long 0x80000000,0xbd96a905,0xbe164083,0xbe605c13,0x80000000,0xbda3308c,0xbe22abb6,0xbe72b651
.long 0x80000000,0xbdafb680,0xbe2f10a2,0xbe827dc0,0x80000000,0xbdbc3ac3,0xbe3b6ecf,0xbe8b9507
.long 0x80000000,0xbdc8bd36,0xbe47c5c2,0xbe94a031,0x80000000,0xbdd53db9,0xbe541501,0xbe9d9e78
.long 0x80000000,0xbde1bc2e,0xbe605c13,0xbea68f12,0x80000000,0xbdee3876,0xbe6c9a7f,0xbeaf713a
.long 0x80000000,0xbdfab273,0xbe78cfcc,0xbeb8442a,0x80000000,0xbe039502,0xbe827dc0,0xbec1071e
.long 0x80000000,0xbe09cf86,0xbe888e93,0xbec9b953,0x80000000,0xbe1008b7,0xbe8e9a22,0xbed25a09
.long 0x80000000,0xbe164083,0xbe94a031,0xbedae880,0x80000000,0xbe1c76de,0xbe9aa086,0xbee363fa
.long 0x80000000,0xbe22abb6,0xbea09ae5,0xbeebcbbb,0x80000000,0xbe28defc,0xbea68f12,0xbef41f07
.long 0x80000000,0xbe2f10a2,0xbeac7cd4,0xbefc5d27,0x80000000,0xbe354098,0xbeb263ef,0xbf0242b1
.long 0x80000000,0xbe3b6ecf,0xbeb8442a,0xbf064b82,0x80000000,0xbe419b37,0xbebe1d4a,0xbf0a48ad
.long 0x80000000,0x80000000,0x80000000,0x80000000,0xbcc90ab0,0xbcfb49ba,0xbd16c32c,0xbd2fe007
.long 0xbd48fb30,0xbd7b2b74,0xbd96a905,0xbdafb680,0xbd96a905,0xbdbc3ac3,0xbde1bc2e,0xbe039502
.long 0xbdc8bd36,0xbdfab273,0xbe164083,0xbe2f10a2,0xbdfab273,0xbe1c76de,0xbe3b6ecf,0xbe5a3997
.long 0xbe164083,0xbe3b6ecf,0xbe605c13,0xbe827dc0,0xbe2f10a2,0xbe5a3997,0xbe827dc0,0xbe97a117
.long 0xbe47c5c2,0xbe78cfcc,0xbe94a031,0xbeac7cd4,0xbe605c13,0xbe8b9507,0xbea68f12,0xbec1071e
.long 0xbe78cfcc,0xbe9aa086,0xbeb8442a,0xbed53641,0xbe888e93,0xbea986c4,0xbec9b953,0xbee900b7
.long 0xbe94a031,0xbeb8442a,0xbedae880,0xbefc5d27,0xbea09ae5,0xbec6d529,0xbeebcbbb,0xbf07a136
.long 0xbeac7cd4,0xbed53641,0xbefc5d27,0xbf10d3cd,0xbeb8442a,0xbee363fa,0xbf064b82,0xbf19c200
.long 0xbec3ef15,0xbef15aea,0xbf0e39da,0xbf226799,0xbecf7bca,0xbeff17b2,0xbf15f6d9,0xbf2ac082
.long 0xbedae880,0xbf064b82,0xbf1d7fd1,0xbf32c8c9,0xbee63375,0xbf0cead0,0xbf24d225,0xbf3a7ca4
.long 0xbef15aea,0xbf13682a,0xbf2beb4a,0xbf41d870,0xbefc5d27,0xbf19c200,0xbf32c8c9,0xbf48d8b3
.long 0xbf039c3d,0xbf1ff6cb,0xbf396842,0xbf4f7a1f,0xbf08f59b,0xbf26050a,0xbf3fc767,0xbf55b993
.long 0xbf0e39da,0xbf2beb4a,0xbf45e403,0xbf5b941a,0xbf13682a,0xbf31a81d,0xbf4bbbf8,0xbf6106f2
.long 0xbf187fc0,0xbf373a23,0xbf514d3d,0xbf660f88,0xbf1d7fd1,0xbf3ca003,0xbf5695e5,0xbf6aab7b
.long 0xbf226799,0xbf41d870,0xbf5b941a,0xbf6ed89e,0xbf273656,0xbf46e22a,0xbf604621,0xbf7294f8
.long 0xbf2beb4a,0xbf4bbbf8,0xbf64aa59,0xbf75dec6,0xbf3085bb,0xbf5064af,0xbf68bf3c,0xbf78b47b
.long 0x80000000,0x80000000,0x80000000,0x80000000,0xbd48fb30,0xbd621469,0xbd7b2b74,0xbd8a200a
.long 0xbdc8bd36,0xbde1bc2e,0xbdfab273,0xbe09cf86,0xbe164083,0xbe28defc,0xbe3b6ecf,0xbe4dee60
.long 0xbe47c5c2,0xbe605c13,0xbe78cfcc,0xbe888e93,0xbe78cfcc,0xbe8b9507,0xbe9aa086,0xbea986c4
.long 0xbe94a031,0xbea68f12,0xbeb8442a,0xbec9b953,0xbeac7cd4,0xbec1071e,0xbed53641,0xbee900b7
.long 0xbec3ef15,0xbedae880,0xbef15aea,0xbf039c3d,0xbedae880,0xbef41f07,0xbf064b82,0xbf121eb0
.long 0xbef15aea,0xbf064b82,0xbf13682a,0xbf1ff6cb,0xbf039c3d,0xbf121eb0,0xbf1ff6cb,0xbf2d1469
.long 0xbf0e39da,0xbf1d7fd1,0xbf2beb4a,0xbf396842,0xbf187fc0,0xbf286605,0xbf373a23,0xbf44e3f5
.long 0xbf226799,0xbf32c8c9,0xbf41d870,0xbf4f7a1f,0xbf2beb4a,0xbf3ca003,0xbf4bbbf8,0xbf591e6a
.long 0xbf3504f3,0xbf45e403,0xbf54db31,0xbf61c598,0xbf3daef9,0xbf4e8d90,0xbf5d2d53,0xbf696591
.long 0xbf45e403,0xbf5695e5,0xbf64aa59,0xbf6ff573,0xbf4d9f02,0xbf5df6be,0xbf6b4b0c,0xbf756d97
.long 0xbf54db31,0xbf64aa59,0xbf710908,0xbf79c79d,0xbf5b941a,0xbf6aab7b,0xbf75dec6,0xbf7cfe73
.long 0xbf61c598,0xbf6ff573,0xbf79c79d,0xbf7f0e58,0xbf676bd8,0xbf748422,0xbf7cbfc9,0xbf7ff4e6
.long 0xbf6c835e,0xbf7853f8,0xbf7ec46d,0xbf7fb10f,0xbf710908,0xbf7b61fc,0xbf7fd397,0xbf7e4323
.long 0xbf74fa0b,0xbf7dabcc,0xbf7fec43,0xbf7baccd,0xbf7853f8,0xbf7f2f9d,0xbf7f0e58,0xbf77f110
.long 0xbf7b14be,0xbf7fec43,0xbf7d3aac,0xbf731447,0xbf7d3aac,0xbf7fe129,0xbf7a7302,0xbf6d1c1d
.long 0xbf7ec46d,0xbf7f0e58,0xbf76ba07,0xbf660f88,0xbf7fb10f,0xbf7d7474,0xbf721352,0xbf5df6be
.long 0x80000000,0x80000000,0x80000000,0x80000000,0xbd96a905,0xbda3308c,0xbdafb680,0xbdbc3ac3
.long 0xbe164083,0xbe22abb6,0xbe2f10a2,0xbe3b6ecf,0xbe605c13,0xbe72b651,0xbe827dc0,0xbe8b9507
.long 0xbe94a031,0xbea09ae5,0xbeac7cd4,0xbeb8442a,0xbeb8442a,0xbec6d529,0xbed53641,0xbee363fa
.long 0xbedae880,0xbeebcbbb,0xbefc5d27,0xbf064b82,0xbefc5d27,0xbf07a136,0xbf10d3cd,0xbf19c200
.long 0xbf0e39da,0xbf187fc0,0xbf226799,0xbf2beb4a,0xbf1d7fd1,0xbf286605,0xbf32c8c9,0xbf3ca003
.long 0xbf2beb4a,0xbf373a23,0xbf41d870,0xbf4bbbf8,0xbf396842,0xbf44e3f5,0xbf4f7a1f,0xbf591e6a
.long 0xbf45e403,0xbf514d3d,0xbf5b941a,0xbf64aa59,0xbf514d3d,0xbf5c61c7,0xbf660f88,0xbf6e46be
.long 0xbf5b941a,0xbf660f88,0xbf6ed89e,0xbf75dec6,0xbf64aa59,0xbf6e46be,0xbf75dec6,0xbf7b61fc
.long 0xbf6c835e,0xbf74fa0b,0xbf7b14be,0xbf7ec46d,0xbf731447,0xbf7a1e84,0xbf7e70b0,0xbf7ffec4
.long 0xbf7853f8,0xbf7dabcc,0xbf7fec43,0xbf7f0e58,0xbf7c3b28,0xbf7f9c18,0xbf7f84ab,0xbf7bf531
.long 0xbf7ec46d,0xbf7fec43,0xbf7d3aac,0xbf76ba07,0xbf7fec43,0xbf7e9bc9,0xbf791298,0xbf6f6830
.long 0xbf7fb10f,0xbf7baccd,0xbf731447,0xbf660f88,0xbf7e1324,0xbf772417,0xbf6b4b0c,0xbf5ac450
.long 0xbf7b14be,0xbf710908,0xbf61c598,0xbf4d9f02,0xbf76ba07,0xbf696591,0xbf5695e5,0xbf3ebc1b
.long 0xbf710908,0xbf604621,0xbf49d112,0xbf2e3bde,0xbf6a09a7,0xbf55b993,0xbf3b8f3b,0xbf1c420c
.long 0xbf61c598,0xbf49d112,0xbf2beb4a,0xbf08f59b,0xbf584853,0xbf3ca003,0xbf1b02c6,0xbee900b7
.long 0xbf4d9f02,0xbf2e3bde,0xbf08f59b,0xbebe1d4a,0xbf41d870,0xbf1ebc12,0xbeebcbbb,0xbe919ddd
.long 0x80000000,0x80000000,0x80000000,0x80000000,0xbdc8bd36,0xbdd53db9,0xbde1bc2e,0xbdee3876
.long 0xbe47c5c2,0xbe541501,0xbe605c13,0xbe6c9a7f,0xbe94a031,0xbe9d9e78,0xbea68f12,0xbeaf713a
.long 0xbec3ef15,0xbecf7bca,0xbedae880,0xbee63375,0xbef15aea,0xbeff17b2,0xbf064b82,0xbf0cead0
.long 0xbf0e39da,0xbf15f6d9,0xbf1d7fd1,0xbf24d225,0xbf226799,0xbf2ac082,0xbf32c8c9,0xbf3a7ca4
.long 0xbf3504f3,0xbf3daef9,0xbf45e403,0xbf4d9f02,0xbf45e403,0xbf4e8d90,0xbf5695e5,0xbf5df6be
.long 0xbf54db31,0xbf5d2d53,0xbf64aa59,0xbf6b4b0c,0xbf61c598,0xbf696591,0xbf6ff573,0xbf756d97
.long 0xbf6c835e,0xbf731447,0xbf7853f8,0xbf7c3b28,0xbf74fa0b,0xbf7a1e84,0xbf7dabcc,0xbf7f9c18
.long 0xbf7b14be,0xbf7e70b0,0xbf7fec43,0xbf7f84ab,0xbf7ec46d,0xbf7ffec4,0xbf7f0e58,0xbf7bf531
.long 0xbf800000,0xbf7ec46d,0xbf7b14be,0xbf74fa0b,0xbf7ec46d,0xbf7ac516,0xbf740bdd,0xbf6aab7b
.long 0xbf7b14be,0xbf740bdd,0xbf6a09a7,0xbf5d2d53,0xbf74fa0b,0xbf6aab7b,0xbf5d2d53,0xbf4cae79
.long 0xbf6c835e,0xbf5ebe05,0xbf4d9f02,0xbf396842,0xbf61c598,0xbf5064af,0xbf3b8f3b,0xbf239da9
.long 0xbf54db31,0xbf3fc767,0xbf273656,0xbf0b9a6b,0xbf45e403,0xbf2d1469,0xbf10d3cd,0xbee363fa
.long 0xbf3504f3,0xbf187fc0,0xbef15aea,0xbeac7cd4,0xbf226799,0xbf0242b1,0xbebe1d4a,0xbe667c66
.long 0xbf0e39da,0xbed53641,0xbe888e93,0xbde1bc2e,0xbef15aea,0xbea395c5,0xbe22abb6,0x3bc90f88
.long 0xbec3ef15,0xbe605c13,0xbd48fb30,0x3dfab273,0xbe94a031,0xbdee3876,0x3d7b2b74,0x3e72b651
.long 0xbe47c5c2,0xbc490e90,0x3e2f10a2,0x3eb263ef,0xbdc8bd36,0x3dbc3ac3,0x3e8e9a22,0x3ee900b7
.long 0x80000000,0x80000000,0x80000000,0x80000000,0xbdfab273,0xbe039502,0xbe09cf86,0xbe1008b7
.long 0xbe78cfcc,0xbe827dc0,0xbe888e93,0xbe8e9a22,0xbeb8442a,0xbec1071e,0xbec9b953,0xbed25a09
.long 0xbef15aea,0xbefc5d27,0xbf039c3d,0xbf08f59b,0xbf13682a,0xbf19c200,0xbf1ff6cb,0xbf26050a
.long 0xbf2beb4a,0xbf32c8c9,0xbf396842,0xbf3fc767,0xbf41d870,0xbf48d8b3,0xbf4f7a1f,0xbf55b993
.long 0xbf54db31,0xbf5b941a,0xbf61c598,0xbf676bd8,0xbf64aa59,0xbf6aab7b,0xbf6ff573,0xbf748422
.long 0xbf710908,0xbf75dec6,0xbf79c79d,0xbf7cbfc9,0xbf79c79d,0xbf7cfe73,0xbf7f0e58,0xbf7ff4e6
.long 0xbf7ec46d,0xbf7fec43,0xbf7fb10f,0xbf7e1324,0xbf7fec43,0xbf7e9bc9,0xbf7baccd,0xbf772417
.long 0xbf7d3aac,0xbf791298,0xbf731447,0xbf6b4b0c,0xbf76ba07,0xbf6f6830,0xbf660f88,0xbf5ac450
.long 0xbf6c835e,0xbf61c598,0xbf54db31,0xbf45e403,0xbf5ebe05,0xbf5064af,0xbf3fc767,0xbf2d1469
.long 0xbf4d9f02,0xbf3b8f3b,0xbf273656,0xbf10d3cd,0xbf396842,0xbf239da9,0xbf0b9a6b,0xbee363fa
.long 0xbf226799,0xbf08f59b,0xbedae880,0xbea09ae5,0xbf08f59b,0xbed8106b,0xbe9aa086,0xbe354098
.long 0xbedae880,0xbe9aa086,0xbe2f10a2,0xbd16c32c,0xbea09ae5,0xbe354098,0xbd16c32c,0x3dd53db9
.long 0xbe47c5c2,0xbd48fb30,0x3dc8bd36,0x3e78cfcc,0xbd96a905,0x3da3308c,0x3e6c9a7f,0x3ec1071e
.long 0x3d48fb30,0x3e541501,0x3eb8442a,0x3f00e7e4,0x3e2f10a2,0x3ea986c4,0x3ef6e0cb,0x3f1ebc12
.long 0x3e94a031,0x3ee63375,0x3f187fc0,0x3f396842,0x3ecf7bca,0x3f0f8784,0x3f32c8c9,0x3f5064af
.long 0x3f039c3d,0x3f299415,0x3f49d112,0x3f633c5a,0x3f1d7fd1,0x3f40d0da,0x3f5d2d53,0x3f718f57
.long 0x80000000,0x80000000,0x80000000,0x80000000,0xbe164083,0xbe1c76de,0xbe22abb6,0xbe28defc
.long 0xbe94a031,0xbe9aa086,0xbea09ae5,0xbea68f12,0xbedae880,0xbee363fa,0xbeebcbbb,0xbef41f07
.long 0xbf0e39da,0xbf13682a,0xbf187fc0,0xbf1d7fd1,0xbf2beb4a,0xbf31a81d,0xbf373a23,0xbf3ca003
.long 0xbf45e403,0xbf4bbbf8,0xbf514d3d,0xbf5695e5,0xbf5b941a,0xbf6106f2,0xbf660f88,0xbf6aab7b
.long 0xbf6c835e,0xbf710908,0xbf74fa0b,0xbf7853f8,0xbf7853f8,0xbf7b61fc,0xbf7dabcc,0xbf7f2f9d
.long 0xbf7ec46d,0xbf7fd397,0xbf7fec43,0xbf7f0e58,0xbf7fb10f,0xbf7e4323,0xbf7baccd,0xbf77f110
.long 0xbf7b14be,0xbf76ba07,0xbf710908,0xbf6a09a7,0xbf710908,0xbf696591,0xbf604621,0xbf55b993
.long 0xbf61c598,0xbf5695e5,0xbf49d112,0xbf3b8f3b,0xbf4d9f02,0xbf3ebc1b,0xbf2e3bde,0xbf1c420c
.long 0xbf3504f3,0xbf226799,0xbf0e39da,0xbef15aea,0xbf187fc0,0xbf0242b1,0xbed53641,0xbea395c5
.long 0xbef15aea,0xbebe1d4a,0xbe888e93,0xbe22abb6,0xbeac7cd4,0xbe667c66,0xbde1bc2e,0x3bc90f88
.long 0xbe47c5c2,0xbd96a905,0x3d48fb30,0x3e2f10a2,0xbd48fb30,0x3da3308c,0x3e541501,0x3ea986c4
.long 0x3dc8bd36,0x3e6c9a7f,0x3eb8442a,0x3ef6e0cb,0x3e78cfcc,0x3ec1071e,0x3f00e7e4,0x3f1ebc12
.long 0x3ec3ef15,0x3f039c3d,0x3f226799,0x3f3daef9,0x3f039c3d,0x3f239da9,0x3f3fc767,0x3f577026
.long 0x3f226799,0x3f3fc767,0x3f584853,0x3f6b4b0c,0x3f3daef9,0x3f577026,0x3f6b4b0c,0x3f78b47b
.long 0x3f54db31,0x3f6a09a7,0x3f7853f8,0x3f7f4e6d,0x3f676bd8,0x3f772417,0x3f7f0e58,0x3f7eea9d
.long 0x3f74fa0b,0x3f7e70b0,0x3f7f4e6d,0x3f778bc5,0x3f7d3aac,0x3f7fc38f,0x3f791298,0x3f696591
.long 0x80000000,0x80000000,0x80000000,0x80000000,0xbe2f10a2,0xbe354098,0xbe3b6ecf,0xbe419b37
.long 0xbeac7cd4,0xbeb263ef,0xbeb8442a,0xbebe1d4a,0xbefc5d27,0xbf0242b1,0xbf064b82,0xbf0a48ad
.long 0xbf226799,0xbf273656,0xbf2beb4a,0xbf3085bb,0xbf41d870,0xbf46e22a,0xbf4bbbf8,0xbf5064af
.long 0xbf5b941a,0xbf604621,0xbf64aa59,0xbf68bf3c,0xbf6ed89e,0xbf7294f8,0xbf75dec6,0xbf78b47b
.long 0xbf7b14be,0xbf7d3aac,0xbf7ec46d,0xbf7fb10f,0xbf7fec43,0xbf7fe129,0xbf7f0e58,0xbf7d7474
.long 0xbf7d3aac,0xbf7a7302,0xbf76ba07,0xbf721352,0xbf731447,0xbf6d1c1d,0xbf660f88,0xbf5df6be
.long 0xbf61c598,0xbf584853,0xbf4d9f02,0xbf41d870,0xbf49d112,0xbf3ca003,0xbf2e3bde,0xbf1ebc12
.long 0xbf2beb4a,0xbf1b02c6,0xbf08f59b,0xbeebcbbb,0xbf08f59b,0xbee900b7,0xbebe1d4a,0xbe919ddd
.long 0xbec3ef15,0xbe94a031,0xbe47c5c2,0xbdc8bd36,0xbe605c13,0xbdee3876,0xbc490e90,0x3dbc3ac3
.long 0xbd48fb30,0x3d7b2b74,0x3e2f10a2,0x3e8e9a22,0x3dfab273,0x3e72b651,0x3eb263ef,0x3ee900b7
.long 0x3e94a031,0x3ecf7bca,0x3f039c3d,0x3f1d7fd1,0x3ee63375,0x3f0f8784,0x3f299415,0x3f40d0da
.long 0x3f187fc0,0x3f32c8c9,0x3f49d112,0x3f5d2d53,0x3f396842,0x3f5064af,0x3f633c5a,0x3f718f57
.long 0x3f54db31,0x3f676bd8,0x3f74fa0b,0x3f7d3aac,0x3f6a09a7,0x3f772417,0x3f7e70b0,0x3f7fc38f
.long 0x3f7853f8,0x3f7f0e58,0x3f7f4e6d,0x3f791298,0x3f7f4e6d,0x3f7eea9d,0x3f778bc5,0x3f696591
.long 0x3f7ec46d,0x3f76ba07,0x3f676bd8,0x3f514d3d,0x3f76ba07,0x3f66becc,0x3f4f7a1f,0x3f31a81d
.long 0x3f676bd8,0x3f4f7a1f,0x3f3085bb,0x3f0b9a6b,0x3f514d3d,0x3f31a81d,0x3f0b9a6b,0x3ec1071e
.long 0x3f800000,0x3f7ec46d,0x3f7b14be,0x3f74fa0b,0x3f7fffb1,0x3f7eb069,0x3f7aed37,0x3f74bf62
.long 0x3f7ffec4,0x3f7e9bc9,0x3f7ac516,0x3f748422,0x3f7ffd39,0x3f7e868b,0x3f7a9c59,0x3f74484b
.long 0x3f7ffb11,0x3f7e70b0,0x3f7a7302,0x3f740bdd,0x3f7ff84a,0x3f7e5a38,0x3f7a4910,0x3f73ced9
.long 0x3f7ff4e6,0x3f7e4323,0x3f7a1e84,0x3f73913f,0x3f7ff0e3,0x3f7e2b72,0x3f79f35e,0x3f73530e
.long 0x3f7fec43,0x3f7e1324,0x3f79c79d,0x3f731447,0x3f7fe705,0x3f7dfa38,0x3f799b43,0x3f72d4eb
.long 0x3f7fe129,0x3f7de0b1,0x3f796e4e,0x3f7294f8,0x3f7fdaaf,0x3f7dc68c,0x3f7940c0,0x3f725470
.long 0x3f7fd397,0x3f7dabcc,0x3f791298,0x3f721352,0x3f7fcbe2,0x3f7d906e,0x3f78e3d6,0x3f71d19f
.long 0x3f7fc38f,0x3f7d7474,0x3f78b47b,0x3f718f57,0x3f7fba9e,0x3f7d57de,0x3f788486,0x3f714c7a
.long 0x3f7fb10f,0x3f7d3aac,0x3f7853f8,0x3f710908,0x3f7fa6e3,0x3f7d1cdd,0x3f7822d1,0x3f70c501
.long 0x3f7f9c18,0x3f7cfe73,0x3f77f110,0x3f708066,0x3f7f90b1,0x3f7cdf6c,0x3f77beb7,0x3f703b37
.long 0x3f7f84ab,0x3f7cbfc9,0x3f778bc5,0x3f6ff573,0x3f7f7808,0x3f7c9f8a,0x3f77583a,0x3f6faf1b
.long 0x3f7f6ac7,0x3f7c7eb0,0x3f772417,0x3f6f6830,0x3f7f5ce9,0x3f7c5d3a,0x3f76ef5b,0x3f6f20b0
.long 0x3f7f4e6d,0x3f7c3b28,0x3f76ba07,0x3f6ed89e,0x3f7f3f54,0x3f7c187a,0x3f76841b,0x3f6e8ff8
.long 0x3f7f2f9d,0x3f7bf531,0x3f764d97,0x3f6e46be,0x3f7f1f49,0x3f7bd14d,0x3f76167a,0x3f6dfcf2
.long 0x3f7f0e58,0x3f7baccd,0x3f75dec6,0x3f6db293,0x3f7efcc9,0x3f7b87b2,0x3f75a67b,0x3f6d67a1
.long 0x3f7eea9d,0x3f7b61fc,0x3f756d97,0x3f6d1c1d,0x3f7ed7d4,0x3f7b3bab,0x3f75341d,0x3f6cd007
.long 0x3f6c835e,0x3f61c598,0x3f54db31,0x3f45e403,0x3f6c3624,0x3f61668a,0x3f546b3b,0x3f456439
.long 0x3f6be858,0x3f6106f2,0x3f53fac3,0x3f44e3f5,0x3f6b99fb,0x3f60a6cf,0x3f5389c7,0x3f446337
.long 0x3f6b4b0c,0x3f604621,0x3f531849,0x3f43e200,0x3f6afb8c,0x3f5fe4e9,0x3f52a649,0x3f436051
.long 0x3f6aab7b,0x3f5f8327,0x3f5233c6,0x3f42de29,0x3f6a5ad9,0x3f5f20db,0x3f51c0c2,0x3f425b89
.long 0x3f6a09a7,0x3f5ebe05,0x3f514d3d,0x3f41d870,0x3f69b7e4,0x3f5e5aa6,0x3f50d937,0x3f4154e1
.long 0x3f696591,0x3f5df6be,0x3f5064af,0x3f40d0da,0x3f6912ae,0x3f5d924d,0x3f4fefa8,0x3f404c5c
.long 0x3f68bf3c,0x3f5d2d53,0x3f4f7a1f,0x3f3fc767,0x3f686b39,0x3f5cc7d1,0x3f4f0417,0x3f3f41fc
.long 0x3f6816a8,0x3f5c61c7,0x3f4e8d90,0x3f3ebc1b,0x3f67c187,0x3f5bfb34,0x3f4e1689,0x3f3e35c5
.long 0x3f676bd8,0x3f5b941a,0x3f4d9f02,0x3f3daef9,0x3f671599,0x3f5b2c79,0x3f4d26fd,0x3f3d27b8
.long 0x3f66becc,0x3f5ac450,0x3f4cae79,0x3f3ca003,0x3f666771,0x3f5a5ba0,0x3f4c3578,0x3f3c17d9
.long 0x3f660f88,0x3f59f26a,0x3f4bbbf8,0x3f3b8f3b,0x3f65b710,0x3f5988ad,0x3f4b41fa,0x3f3b0629
.long 0x3f655e0b,0x3f591e6a,0x3f4ac77f,0x3f3a7ca4,0x3f650479,0x3f58b3a1,0x3f4a4c87,0x3f39f2ac
.long 0x3f64aa59,0x3f584853,0x3f49d112,0x3f396842,0x3f644fac,0x3f57dc7f,0x3f495521,0x3f38dd65
.long 0x3f63f473,0x3f577026,0x3f48d8b3,0x3f385216,0x3f6398ac,0x3f570348,0x3f485bca,0x3f37c655
.long 0x3f633c5a,0x3f5695e5,0x3f47de65,0x3f373a23,0x3f62df7b,0x3f5627fe,0x3f476085,0x3f36ad7f
.long 0x3f628210,0x3f55b993,0x3f46e22a,0x3f36206c,0x3f62241a,0x3f554aa4,0x3f466354,0x3f3592e7
.long 0x3f3504f3,0x3f226799,0x3f0e39da,0x3ef15aea,0x3f34768f,0x3f21cbfb,0x3f0d9281,0x3eeff7fb
.long 0x3f33e7bc,0x3f212ff9,0x3f0cead0,0x3eee9479,0x3f33587a,0x3f209393,0x3f0c42c9,0x3eed3063
.long 0x3f32c8c9,0x3f1ff6cb,0x3f0b9a6b,0x3eebcbbb,0x3f3238aa,0x3f1f599f,0x3f0af1b7,0x3eea6681
.long 0x3f31a81d,0x3f1ebc12,0x3f0a48ad,0x3ee900b7,0x3f311722,0x3f1e1e22,0x3f099f4e,0x3ee79a5d
.long 0x3f3085bb,0x3f1d7fd1,0x3f08f59b,0x3ee63375,0x3f2ff3e6,0x3f1ce11f,0x3f084b92,0x3ee4cbfe
.long 0x3f2f61a5,0x3f1c420c,0x3f07a136,0x3ee363fa,0x3f2ecef7,0x3f1ba299,0x3f06f686,0x3ee1fb6a
.long 0x3f2e3bde,0x3f1b02c6,0x3f064b82,0x3ee0924f,0x3f2da859,0x3f1a6293,0x3f05a02c,0x3edf28a9
.long 0x3f2d1469,0x3f19c200,0x3f04f484,0x3eddbe79,0x3f2c800f,0x3f19210f,0x3f044889,0x3edc53c1
.long 0x3f2beb4a,0x3f187fc0,0x3f039c3d,0x3edae880,0x3f2b561b,0x3f17de12,0x3f02ef9f,0x3ed97cb9
.long 0x3f2ac082,0x3f173c07,0x3f0242b1,0x3ed8106b,0x3f2a2a80,0x3f16999f,0x3f019573,0x3ed6a399
.long 0x3f299415,0x3f15f6d9,0x3f00e7e4,0x3ed53641,0x3f28fd41,0x3f1553b7,0x3f003a06,0x3ed3c867
.long 0x3f286605,0x3f14b039,0x3eff17b2,0x3ed25a09,0x3f27ce61,0x3f140c5f,0x3efdbabb,0x3ed0eb2a
.long 0x3f273656,0x3f13682a,0x3efc5d27,0x3ecf7bca,0x3f269de3,0x3f12c39a,0x3efafef7,0x3ece0bea
.long 0x3f26050a,0x3f121eb0,0x3ef9a02d,0x3ecc9b8b,0x3f256bcb,0x3f11796b,0x3ef840c8,0x3ecb2aae
.long 0x3f24d225,0x3f10d3cd,0x3ef6e0cb,0x3ec9b953,0x3f24381a,0x3f102dd5,0x3ef58035,0x3ec8477c
.long 0x3f239da9,0x3f0f8784,0x3ef41f07,0x3ec6d529,0x3f2302d3,0x3f0ee0db,0x3ef2bd43,0x3ec5625c
.long 0x3ec3ef15,0x3e94a031,0x3e47c5c2,0x3dc8bd36,0x3ec27b55,0x3e931f35,0x3e44b0b9,0x3dc27c39
.long 0x3ec1071e,0x3e919ddd,0x3e419b37,0x3dbc3ac3,0x3ebf926f,0x3e901c2c,0x3e3e853e,0x3db5f8da
.long 0x3ebe1d4a,0x3e8e9a22,0x3e3b6ecf,0x3dafb680,0x3ebca7af,0x3e8d17c0,0x3e3857ec,0x3da973ba
.long 0x3ebb31a0,0x3e8b9507,0x3e354098,0x3da3308c,0x3eb9bb1e,0x3e8a11f7,0x3e3228d4,0x3d9cecf9
.long 0x3eb8442a,0x3e888e93,0x3e2f10a2,0x3d96a905,0x3eb6ccc3,0x3e870ada,0x3e2bf804,0x3d9064b4
.long 0x3eb554ec,0x3e8586ce,0x3e28defc,0x3d8a200a,0x3eb3dca5,0x3e840270,0x3e25c58c,0x3d83db0a
.long 0x3eb263ef,0x3e827dc0,0x3e22abb6,0x3d7b2b74,0x3eb0eacb,0x3e80f8c0,0x3e1f917b,0x3d6ea038
.long 0x3eaf713a,0x3e7ee6e1,0x3e1c76de,0x3d621469,0x3eadf73c,0x3e7bdba4,0x3e195be0,0x3d55880e
.long 0x3eac7cd4,0x3e78cfcc,0x3e164083,0x3d48fb30,0x3eab0201,0x3e75c35a,0x3e1324ca,0x3d3c6dd5
.long 0x3ea986c4,0x3e72b651,0x3e1008b7,0x3d2fe007,0x3ea80b1f,0x3e6fa8b2,0x3e0cec4a,0x3d2351cb
.long 0x3ea68f12,0x3e6c9a7f,0x3e09cf86,0x3d16c32c,0x3ea5129f,0x3e698bba,0x3e06b26e,0x3d0a342f
.long 0x3ea395c5,0x3e667c66,0x3e039502,0x3cfb49ba,0x3ea21887,0x3e636c83,0x3e007745,0x3ce22a7a
.long 0x3ea09ae5,0x3e605c13,0x3dfab273,0x3cc90ab0,0x3e9f1cdf,0x3e5d4b1a,0x3df475c0,0x3cafea69
.long 0x3e9d9e78,0x3e5a3997,0x3dee3876,0x3c96c9b6,0x3e9c1faf,0x3e57278f,0x3de7fa9a,0x3c7b514b
.long 0x3e9aa086,0x3e541501,0x3de1bc2e,0x3c490e90,0x3e9920fe,0x3e5101f1,0x3ddb7d37,0x3c16cb58
.long 0x3e97a117,0x3e4dee60,0x3dd53db9,0x3bc90f88,0x3e9620d2,0x3e4ada4f,0x3dcefdb7,0x3b490fc6
.long 0x248d3132,0xbdc8bd36,0xbe47c5c2,0xbe94a031,0xbb490fc6,0xbdcefdb7,0xbe4ada4f,0xbe9620d2
.long 0xbbc90f88,0xbdd53db9,0xbe4dee60,0xbe97a117,0xbc16cb58,0xbddb7d37,0xbe5101f1,0xbe9920fe
.long 0xbc490e90,0xbde1bc2e,0xbe541501,0xbe9aa086,0xbc7b514b,0xbde7fa9a,0xbe57278f,0xbe9c1faf
.long 0xbc96c9b6,0xbdee3876,0xbe5a3997,0xbe9d9e78,0xbcafea69,0xbdf475c0,0xbe5d4b1a,0xbe9f1cdf
.long 0xbcc90ab0,0xbdfab273,0xbe605c13,0xbea09ae5,0xbce22a7a,0xbe007745,0xbe636c83,0xbea21887
.long 0xbcfb49ba,0xbe039502,0xbe667c66,0xbea395c5,0xbd0a342f,0xbe06b26e,0xbe698bba,0xbea5129f
.long 0xbd16c32c,0xbe09cf86,0xbe6c9a7f,0xbea68f12,0xbd2351cb,0xbe0cec4a,0xbe6fa8b2,0xbea80b1f
.long 0xbd2fe007,0xbe1008b7,0xbe72b651,0xbea986c4,0xbd3c6dd5,0xbe1324ca,0xbe75c35a,0xbeab0201
.long 0xbd48fb30,0xbe164083,0xbe78cfcc,0xbeac7cd4,0xbd55880e,0xbe195be0,0xbe7bdba4,0xbeadf73c
.long 0xbd621469,0xbe1c76de,0xbe7ee6e1,0xbeaf713a,0xbd6ea038,0xbe1f917b,0xbe80f8c0,0xbeb0eacb
.long 0xbd7b2b74,0xbe22abb6,0xbe827dc0,0xbeb263ef,0xbd83db0a,0xbe25c58c,0xbe840270,0xbeb3dca5
.long 0xbd8a200a,0xbe28defc,0xbe8586ce,0xbeb554ec,0xbd9064b4,0xbe2bf804,0xbe870ada,0xbeb6ccc3
.long 0xbd96a905,0xbe2f10a2,0xbe888e93,0xbeb8442a,0xbd9cecf9,0xbe3228d4,0xbe8a11f7,0xbeb9bb1e
.long 0xbda3308c,0xbe354098,0xbe8b9507,0xbebb31a0,0xbda973ba,0xbe3857ec,0xbe8d17c0,0xbebca7af
.long 0xbdafb680,0xbe3b6ecf,0xbe8e9a22,0xbebe1d4a,0xbdb5f8da,0xbe3e853e,0xbe901c2c,0xbebf926f
.long 0xbdbc3ac3,0xbe419b37,0xbe919ddd,0xbec1071e,0xbdc27c39,0xbe44b0b9,0xbe931f35,0xbec27b55
.long 0xbec3ef15,0xbef15aea,0xbf0e39da,0xbf226799,0xbec5625c,0xbef2bd43,0xbf0ee0db,0xbf2302d3
.long 0xbec6d529,0xbef41f07,0xbf0f8784,0xbf239da9,0xbec8477c,0xbef58035,0xbf102dd5,0xbf24381a
.long 0xbec9b953,0xbef6e0cb,0xbf10d3cd,0xbf24d225,0xbecb2aae,0xbef840c8,0xbf11796b,0xbf256bcb
.long 0xbecc9b8b,0xbef9a02d,0xbf121eb0,0xbf26050a,0xbece0bea,0xbefafef7,0xbf12c39a,0xbf269de3
.long 0xbecf7bca,0xbefc5d27,0xbf13682a,0xbf273656,0xbed0eb2a,0xbefdbabb,0xbf140c5f,0xbf27ce61
.long 0xbed25a09,0xbeff17b2,0xbf14b039,0xbf286605,0xbed3c867,0xbf003a06,0xbf1553b7,0xbf28fd41
.long 0xbed53641,0xbf00e7e4,0xbf15f6d9,0xbf299415,0xbed6a399,0xbf019573,0xbf16999f,0xbf2a2a80
.long 0xbed8106b,0xbf0242b1,0xbf173c07,0xbf2ac082,0xbed97cb9,0xbf02ef9f,0xbf17de12,0xbf2b561b
.long 0xbedae880,0xbf039c3d,0xbf187fc0,0xbf2beb4a,0xbedc53c1,0xbf044889,0xbf19210f,0xbf2c800f
.long 0xbeddbe79,0xbf04f484,0xbf19c200,0xbf2d1469,0xbedf28a9,0xbf05a02c,0xbf1a6293,0xbf2da859
.long 0xbee0924f,0xbf064b82,0xbf1b02c6,0xbf2e3bde,0xbee1fb6a,0xbf06f686,0xbf1ba299,0xbf2ecef7
.long 0xbee363fa,0xbf07a136,0xbf1c420c,0xbf2f61a5,0xbee4cbfe,0xbf084b92,0xbf1ce11f,0xbf2ff3e6
.long 0xbee63375,0xbf08f59b,0xbf1d7fd1,0xbf3085bb,0xbee79a5d,0xbf099f4e,0xbf1e1e22,0xbf311722
.long 0xbee900b7,0xbf0a48ad,0xbf1ebc12,0xbf31a81d,0xbeea6681,0xbf0af1b7,0xbf1f599f,0xbf3238aa
.long 0xbeebcbbb,0xbf0b9a6b,0xbf1ff6cb,0xbf32c8c9,0xbeed3063,0xbf0c42c9,0xbf209393,0xbf33587a
.long 0xbeee9479,0xbf0cead0,0xbf212ff9,0xbf33e7bc,0xbeeff7fb,0xbf0d9281,0xbf21cbfb,0xbf34768f
.long 0xbf3504f3,0xbf45e403,0xbf54db31,0xbf61c598,0xbf3592e7,0xbf466354,0xbf554aa4,0xbf62241a
.long 0xbf36206c,0xbf46e22a,0xbf55b993,0xbf628210,0xbf36ad7f,0xbf476085,0xbf5627fe,0xbf62df7b
.long 0xbf373a23,0xbf47de65,0xbf5695e5,0xbf633c5a,0xbf37c655,0xbf485bca,0xbf570348,0xbf6398ac
.long 0xbf385216,0xbf48d8b3,0xbf577026,0xbf63f473,0xbf38dd65,0xbf495521,0xbf57dc7f,0xbf644fac
.long 0xbf396842,0xbf49d112,0xbf584853,0xbf64aa59,0xbf39f2ac,0xbf4a4c87,0xbf58b3a1,0xbf650479
.long 0xbf3a7ca4,0xbf4ac77f,0xbf591e6a,0xbf655e0b,0xbf3b0629,0xbf4b41fa,0xbf5988ad,0xbf65b710
.long 0xbf3b8f3b,0xbf4bbbf8,0xbf59f26a,0xbf660f88,0xbf3c17d9,0xbf4c3578,0xbf5a5ba0,0xbf666771
.long 0xbf3ca003,0xbf4cae79,0xbf5ac450,0xbf66becc,0xbf3d27b8,0xbf4d26fd,0xbf5b2c79,0xbf671599
.long 0xbf3daef9,0xbf4d9f02,0xbf5b941a,0xbf676bd8,0xbf3e35c5,0xbf4e1689,0xbf5bfb34,0xbf67c187
.long 0xbf3ebc1b,0xbf4e8d90,0xbf5c61c7,0xbf6816a8,0xbf3f41fc,0xbf4f0417,0xbf5cc7d1,0xbf686b39
.long 0xbf3fc767,0xbf4f7a1f,0xbf5d2d53,0xbf68bf3c,0xbf404c5c,0xbf4fefa8,0xbf5d924d,0xbf6912ae
.long 0xbf40d0da,0xbf5064af,0xbf5df6be,0xbf696591,0xbf4154e1,0xbf50d937,0xbf5e5aa6,0xbf69b7e4
.long 0xbf41d870,0xbf514d3d,0xbf5ebe05,0xbf6a09a7,0xbf425b89,0xbf51c0c2,0xbf5f20db,0xbf6a5ad9
.long 0xbf42de29,0xbf5233c6,0xbf5f8327,0xbf6aab7b,0xbf436051,0xbf52a649,0xbf5fe4e9,0xbf6afb8c
.long 0xbf43e200,0xbf531849,0xbf604621,0xbf6b4b0c,0xbf446337,0xbf5389c7,0xbf60a6cf,0xbf6b99fb
.long 0xbf44e3f5,0xbf53fac3,0xbf6106f2,0xbf6be858,0xbf456439,0xbf546b3b,0xbf61668a,0xbf6c3624
.long 0xbf6c835e,0xbf74fa0b,0xbf7b14be,0xbf7ec46d,0xbf6cd007,0xbf75341d,0xbf7b3bab,0xbf7ed7d4
.long 0xbf6d1c1d,0xbf756d97,0xbf7b61fc,0xbf7eea9d,0xbf6d67a1,0xbf75a67b,0xbf7b87b2,0xbf7efcc9
.long 0xbf6db293,0xbf75dec6,0xbf7baccd,0xbf7f0e58,0xbf6dfcf2,0xbf76167a,0xbf7bd14d,0xbf7f1f49
.long 0xbf6e46be,0xbf764d97,0xbf7bf531,0xbf7f2f9d,0xbf6e8ff8,0xbf76841b,0xbf7c187a,0xbf7f3f54
.long 0xbf6ed89e,0xbf76ba07,0xbf7c3b28,0xbf7f4e6d,0xbf6f20b0,0xbf76ef5b,0xbf7c5d3a,0xbf7f5ce9
.long 0xbf6f6830,0xbf772417,0xbf7c7eb0,0xbf7f6ac7,0xbf6faf1b,0xbf77583a,0xbf7c9f8a,0xbf7f7808
.long 0xbf6ff573,0xbf778bc5,0xbf7cbfc9,0xbf7f84ab,0xbf703b37,0xbf77beb7,0xbf7cdf6c,0xbf7f90b1
.long 0xbf708066,0xbf77f110,0xbf7cfe73,0xbf7f9c18,0xbf70c501,0xbf7822d1,0xbf7d1cdd,0xbf7fa6e3
.long 0xbf710908,0xbf7853f8,0xbf7d3aac,0xbf7fb10f,0xbf714c7a,0xbf788486,0xbf7d57de,0xbf7fba9e
.long 0xbf718f57,0xbf78b47b,0xbf7d7474,0xbf7fc38f,0xbf71d19f,0xbf78e3d6,0xbf7d906e,0xbf7fcbe2
.long 0xbf721352,0xbf791298,0xbf7dabcc,0xbf7fd397,0xbf725470,0xbf7940c0,0xbf7dc68c,0xbf7fdaaf
.long 0xbf7294f8,0xbf796e4e,0xbf7de0b1,0xbf7fe129,0xbf72d4eb,0xbf799b43,0xbf7dfa38,0xbf7fe705
.long 0xbf731447,0xbf79c79d,0xbf7e1324,0xbf7fec43,0xbf73530e,0xbf79f35e,0xbf7e2b72,0xbf7ff0e3
.long 0xbf73913f,0xbf7a1e84,0xbf7e4323,0xbf7ff4e6,0xbf73ced9,0xbf7a4910,0xbf7e5a38,0xbf7ff84a
.long 0xbf740bdd,0xbf7a7302,0xbf7e70b0,0xbf7ffb11,0xbf74484b,0xbf7a9c59,0xbf7e868b,0xbf7ffd39
.long 0xbf748422,0xbf7ac516,0xbf7e9bc9,0xbf7ffec4,0xbf74bf62,0xbf7aed37,0xbf7eb069,0xbf7fffb1
.long 0x80000000,0xbdc8bd36,0xbe47c5c2,0xbe94a031,0xbb490fc6,0xbdcefdb7,0xbe4ada4f,0xbe9620d2
.long 0xbbc90f88,0xbdd53db9,0xbe4dee60,0xbe97a117,0xbc16cb58,0xbddb7d37,0xbe5101f1,0xbe9920fe
.long 0xbc490e90,0xbde1bc2e,0xbe541501,0xbe9aa086,0xbc7b514b,0xbde7fa9a,0xbe57278f,0xbe9c1faf
.long 0xbc96c9b6,0xbdee3876,0xbe5a3997,0xbe9d9e78,0xbcafea69,0xbdf475c0,0xbe5d4b1a,0xbe9f1cdf
.long 0xbcc90ab0,0xbdfab273,0xbe605c13,0xbea09ae5,0xbce22a7a,0xbe007745,0xbe636c83,0xbea21887
.long 0xbcfb49ba,0xbe039502,0xbe667c66,0xbea395c5,0xbd0a342f,0xbe06b26e,0xbe698bba,0xbea5129f
.long 0xbd16c32c,0xbe09cf86,0xbe6c9a7f,0xbea68f12,0xbd2351cb,0xbe0cec4a,0xbe6fa8b2,0xbea80b1f
.long 0xbd2fe007,0xbe1008b7,0xbe72b651,0xbea986c4,0xbd3c6dd5,0xbe1324ca,0xbe75c35a,0xbeab0201
.long 0xbd48fb30,0xbe164083,0xbe78cfcc,0xbeac7cd4,0xbd55880e,0xbe195be0,0xbe7bdba4,0xbeadf73c
.long 0xbd621469,0xbe1c76de,0xbe7ee6e1,0xbeaf713a,0xbd6ea038,0xbe1f917b,0xbe80f8c0,0xbeb0eacb
.long 0xbd7b2b74,0xbe22abb6,0xbe827dc0,0xbeb263ef,0xbd83db0a,0xbe25c58c,0xbe840270,0xbeb3dca5
.long 0xbd8a200a,0xbe28defc,0xbe8586ce,0xbeb554ec,0xbd9064b4,0xbe2bf804,0xbe870ada,0xbeb6ccc3
.long 0xbd96a905,0xbe2f10a2,0xbe888e93,0xbeb8442a,0xbd9cecf9,0xbe3228d4,0xbe8a11f7,0xbeb9bb1e
.long 0xbda3308c,0xbe354098,0xbe8b9507,0xbebb31a0,0xbda973ba,0xbe3857ec,0xbe8d17c0,0xbebca7af
.long 0xbdafb680,0xbe3b6ecf,0xbe8e9a22,0xbebe1d4a,0xbdb5f8da,0xbe3e853e,0xbe901c2c,0xbebf926f
.long 0xbdbc3ac3,0xbe419b37,0xbe919ddd,0xbec1071e,0xbdc27c39,0xbe44b0b9,0xbe931f35,0xbec27b55
.long 0xbec3ef15,0xbef15aea,0xbf0e39da,0xbf226799,0xbec5625c,0xbef2bd43,0xbf0ee0db,0xbf2302d3
.long 0xbec6d529,0xbef41f07,0xbf0f8784,0xbf239da9,0xbec8477c,0xbef58035,0xbf102dd5,0xbf24381a
.long 0xbec9b953,0xbef6e0cb,0xbf10d3cd,0xbf24d225,0xbecb2aae,0xbef840c8,0xbf11796b,0xbf256bcb
.long 0xbecc9b8b,0xbef9a02d,0xbf121eb0,0xbf26050a,0xbece0bea,0xbefafef7,0xbf12c39a,0xbf269de3
.long 0xbecf7bca,0xbefc5d27,0xbf13682a,0xbf273656,0xbed0eb2a,0xbefdbabb,0xbf140c5f,0xbf27ce61
.long 0xbed25a09,0xbeff17b2,0xbf14b039,0xbf286605,0xbed3c867,0xbf003a06,0xbf1553b7,0xbf28fd41
.long 0xbed53641,0xbf00e7e4,0xbf15f6d9,0xbf299415,0xbed6a399,0xbf019573,0xbf16999f,0xbf2a2a80
.long 0xbed8106b,0xbf0242b1,0xbf173c07,0xbf2ac082,0xbed97cb9,0xbf02ef9f,0xbf17de12,0xbf2b561b
.long 0xbedae880,0xbf039c3d,0xbf187fc0,0xbf2beb4a,0xbedc53c1,0xbf044889,0xbf19210f,0xbf2c800f
.long 0xbeddbe79,0xbf04f484,0xbf19c200,0xbf2d1469,0xbedf28a9,0xbf05a02c,0xbf1a6293,0xbf2da859
.long 0xbee0924f,0xbf064b82,0xbf1b02c6,0xbf2e3bde,0xbee1fb6a,0xbf06f686,0xbf1ba299,0xbf2ecef7
.long 0xbee363fa,0xbf07a136,0xbf1c420c,0xbf2f61a5,0xbee4cbfe,0xbf084b92,0xbf1ce11f,0xbf2ff3e6
.long 0xbee63375,0xbf08f59b,0xbf1d7fd1,0xbf3085bb,0xbee79a5d,0xbf099f4e,0xbf1e1e22,0xbf311722
.long 0xbee900b7,0xbf0a48ad,0xbf1ebc12,0xbf31a81d,0xbeea6681,0xbf0af1b7,0xbf1f599f,0xbf3238aa
.long 0xbeebcbbb,0xbf0b9a6b,0xbf1ff6cb,0xbf32c8c9,0xbeed3063,0xbf0c42c9,0xbf209393,0xbf33587a
.long 0xbeee9479,0xbf0cead0,0xbf212ff9,0xbf33e7bc,0xbeeff7fb,0xbf0d9281,0xbf21cbfb,0xbf34768f
.long 0xbf3504f3,0xbf45e403,0xbf54db31,0xbf61c598,0xbf3592e7,0xbf466354,0xbf554aa4,0xbf62241a
.long 0xbf36206c,0xbf46e22a,0xbf55b993,0xbf628210,0xbf36ad7f,0xbf476085,0xbf5627fe,0xbf62df7b
.long 0xbf373a23,0xbf47de65,0xbf5695e5,0xbf633c5a,0xbf37c655,0xbf485bca,0xbf570348,0xbf6398ac
.long 0xbf385216,0xbf48d8b3,0xbf577026,0xbf63f473,0xbf38dd65,0xbf495521,0xbf57dc7f,0xbf644fac
.long 0xbf396842,0xbf49d112,0xbf584853,0xbf64aa59,0xbf39f2ac,0xbf4a4c87,0xbf58b3a1,0xbf650479
.long 0xbf3a7ca4,0xbf4ac77f,0xbf591e6a,0xbf655e0b,0xbf3b0629,0xbf4b41fa,0xbf5988ad,0xbf65b710
.long 0xbf3b8f3b,0xbf4bbbf8,0xbf59f26a,0xbf660f88,0xbf3c17d9,0xbf4c3578,0xbf5a5ba0,0xbf666771
.long 0xbf3ca003,0xbf4cae79,0xbf5ac450,0xbf66becc,0xbf3d27b8,0xbf4d26fd,0xbf5b2c79,0xbf671599
.long 0xbf3daef9,0xbf4d9f02,0xbf5b941a,0xbf676bd8,0xbf3e35c5,0xbf4e1689,0xbf5bfb34,0xbf67c187
.long 0xbf3ebc1b,0xbf4e8d90,0xbf5c61c7,0xbf6816a8,0xbf3f41fc,0xbf4f0417,0xbf5cc7d1,0xbf686b39
.long 0xbf3fc767,0xbf4f7a1f,0xbf5d2d53,0xbf68bf3c,0xbf404c5c,0xbf4fefa8,0xbf5d924d,0xbf6912ae
.long 0xbf40d0da,0xbf5064af,0xbf5df6be,0xbf696591,0xbf4154e1,0xbf50d937,0xbf5e5aa6,0xbf69b7e4
.long 0xbf41d870,0xbf514d3d,0xbf5ebe05,0xbf6a09a7,0xbf425b89,0xbf51c0c2,0xbf5f20db,0xbf6a5ad9
.long 0xbf42de29,0xbf5233c6,0xbf5f8327,0xbf6aab7b,0xbf436051,0xbf52a649,0xbf5fe4e9,0xbf6afb8c
.long 0xbf43e200,0xbf531849,0xbf604621,0xbf6b4b0c,0xbf446337,0xbf5389c7,0xbf60a6cf,0xbf6b99fb
.long 0xbf44e3f5,0xbf53fac3,0xbf6106f2,0xbf6be858,0xbf456439,0xbf546b3b,0xbf61668a,0xbf6c3624
.long 0xbf6c835e,0xbf74fa0b,0xbf7b14be,0xbf7ec46d,0xbf6cd007,0xbf75341d,0xbf7b3bab,0xbf7ed7d4
.long 0xbf6d1c1d,0xbf756d97,0xbf7b61fc,0xbf7eea9d,0xbf6d67a1,0xbf75a67b,0xbf7b87b2,0xbf7efcc9
.long 0xbf6db293,0xbf75dec6,0xbf7baccd,0xbf7f0e58,0xbf6dfcf2,0xbf76167a,0xbf7bd14d,0xbf7f1f49
.long 0xbf6e46be,0xbf764d97,0xbf7bf531,0xbf7f2f9d,0xbf6e8ff8,0xbf76841b,0xbf7c187a,0xbf7f3f54
.long 0xbf6ed89e,0xbf76ba07,0xbf7c3b28,0xbf7f4e6d,0xbf6f20b0,0xbf76ef5b,0xbf7c5d3a,0xbf7f5ce9
.long 0xbf6f6830,0xbf772417,0xbf7c7eb0,0xbf7f6ac7,0xbf6faf1b,0xbf77583a,0xbf7c9f8a,0xbf7f7808
.long 0xbf6ff573,0xbf778bc5,0xbf7cbfc9,0xbf7f84ab,0xbf703b37,0xbf77beb7,0xbf7cdf6c,0xbf7f90b1
.long 0xbf708066,0xbf77f110,0xbf7cfe73,0xbf7f9c18,0xbf70c501,0xbf7822d1,0xbf7d1cdd,0xbf7fa6e3
.long 0xbf710908,0xbf7853f8,0xbf7d3aac,0xbf7fb10f,0xbf714c7a,0xbf788486,0xbf7d57de,0xbf7fba9e
.long 0xbf718f57,0xbf78b47b,0xbf7d7474,0xbf7fc38f,0xbf71d19f,0xbf78e3d6,0xbf7d906e,0xbf7fcbe2
.long 0xbf721352,0xbf791298,0xbf7dabcc,0xbf7fd397,0xbf725470,0xbf7940c0,0xbf7dc68c,0xbf7fdaaf
.long 0xbf7294f8,0xbf796e4e,0xbf7de0b1,0xbf7fe129,0xbf72d4eb,0xbf799b43,0xbf7dfa38,0xbf7fe705
.long 0xbf731447,0xbf79c79d,0xbf7e1324,0xbf7fec43,0xbf73530e,0xbf79f35e,0xbf7e2b72,0xbf7ff0e3
.long 0xbf73913f,0xbf7a1e84,0xbf7e4323,0xbf7ff4e6,0xbf73ced9,0xbf7a4910,0xbf7e5a38,0xbf7ff84a
.long 0xbf740bdd,0xbf7a7302,0xbf7e70b0,0xbf7ffb11,0xbf74484b,0xbf7a9c59,0xbf7e868b,0xbf7ffd39
.long 0xbf748422,0xbf7ac516,0xbf7e9bc9,0xbf7ffec4,0xbf74bf62,0xbf7aed37,0xbf7eb069,0xbf7fffb1
.long 0xbf800000,0xbf7ec46d,0xbf7b14be,0xbf74fa0b,0xbf7fffb1,0xbf7eb069,0xbf7aed37,0xbf74bf62
.long 0xbf7ffec4,0xbf7e9bc9,0xbf7ac516,0xbf748422,0xbf7ffd39,0xbf7e868b,0xbf7a9c59,0xbf74484b
.long 0xbf7ffb11,0xbf7e70b0,0xbf7a7302,0xbf740bdd,0xbf7ff84a,0xbf7e5a38,0xbf7a4910,0xbf73ced9
.long 0xbf7ff4e6,0xbf7e4323,0xbf7a1e84,0xbf73913f,0xbf7ff0e3,0xbf7e2b72,0xbf79f35e,0xbf73530e
.long 0xbf7fec43,0xbf7e1324,0xbf79c79d,0xbf731447,0xbf7fe705,0xbf7dfa38,0xbf799b43,0xbf72d4eb
.long 0xbf7fe129,0xbf7de0b1,0xbf796e4e,0xbf7294f8,0xbf7fdaaf,0xbf7dc68c,0xbf7940c0,0xbf725470
.long 0xbf7fd397,0xbf7dabcc,0xbf791298,0xbf721352,0xbf7fcbe2,0xbf7d906e,0xbf78e3d6,0xbf71d19f
.long 0xbf7fc38f,0xbf7d7474,0xbf78b47b,0xbf718f57,0xbf7fba9e,0xbf7d57de,0xbf788486,0xbf714c7a
.long 0xbf7fb10f,0xbf7d3aac,0xbf7853f8,0xbf710908,0xbf7fa6e3,0xbf7d1cdd,0xbf7822d1,0xbf70c501
.long 0xbf7f9c18,0xbf7cfe73,0xbf77f110,0xbf708066,0xbf7f90b1,0xbf7cdf6c,0xbf77beb7,0xbf703b37
.long 0xbf7f84ab,0xbf7cbfc9,0xbf778bc5,0xbf6ff573,0xbf7f7808,0xbf7c9f8a,0xbf77583a,0xbf6faf1b
.long 0xbf7f6ac7,0xbf7c7eb0,0xbf772417,0xbf6f6830,0xbf7f5ce9,0xbf7c5d3a,0xbf76ef5b,0xbf6f20b0
.long 0xbf7f4e6d,0xbf7c3b28,0xbf76ba07,0xbf6ed89e,0xbf7f3f54,0xbf7c187a,0xbf76841b,0xbf6e8ff8
.long 0xbf7f2f9d,0xbf7bf531,0xbf764d97,0xbf6e46be,0xbf7f1f49,0xbf7bd14d,0xbf76167a,0xbf6dfcf2
.long 0xbf7f0e58,0xbf7baccd,0xbf75dec6,0xbf6db293,0xbf7efcc9,0xbf7b87b2,0xbf75a67b,0xbf6d67a1
.long 0xbf7eea9d,0xbf7b61fc,0xbf756d97,0xbf6d1c1d,0xbf7ed7d4,0xbf7b3bab,0xbf75341d,0xbf6cd007
.long 0xbf6c835e,0xbf61c598,0xbf54db31,0xbf45e403,0xbf6c3624,0xbf61668a,0xbf546b3b,0xbf456439
.long 0xbf6be858,0xbf6106f2,0xbf53fac3,0xbf44e3f5,0xbf6b99fb,0xbf60a6cf,0xbf5389c7,0xbf446337
.long 0xbf6b4b0c,0xbf604621,0xbf531849,0xbf43e200,0xbf6afb8c,0xbf5fe4e9,0xbf52a649,0xbf436051
.long 0xbf6aab7b,0xbf5f8327,0xbf5233c6,0xbf42de29,0xbf6a5ad9,0xbf5f20db,0xbf51c0c2,0xbf425b89
.long 0xbf6a09a7,0xbf5ebe05,0xbf514d3d,0xbf41d870,0xbf69b7e4,0xbf5e5aa6,0xbf50d937,0xbf4154e1
.long 0xbf696591,0xbf5df6be,0xbf5064af,0xbf40d0da,0xbf6912ae,0xbf5d924d,0xbf4fefa8,0xbf404c5c
.long 0xbf68bf3c,0xbf5d2d53,0xbf4f7a1f,0xbf3fc767,0xbf686b39,0xbf5cc7d1,0xbf4f0417,0xbf3f41fc
.long 0xbf6816a8,0xbf5c61c7,0xbf4e8d90,0xbf3ebc1b,0xbf67c187,0xbf5bfb34,0xbf4e1689,0xbf3e35c5
.long 0xbf676bd8,0xbf5b941a,0xbf4d9f02,0xbf3daef9,0xbf671599,0xbf5b2c79,0xbf4d26fd,0xbf3d27b8
.long 0xbf66becc,0xbf5ac450,0xbf4cae79,0xbf3ca003,0xbf666771,0xbf5a5ba0,0xbf4c3578,0xbf3c17d9
.long 0xbf660f88,0xbf59f26a,0xbf4bbbf8,0xbf3b8f3b,0xbf65b710,0xbf5988ad,0xbf4b41fa,0xbf3b0629
.long 0xbf655e0b,0xbf591e6a,0xbf4ac77f,0xbf3a7ca4,0xbf650479,0xbf58b3a1,0xbf4a4c87,0xbf39f2ac
.long 0xbf64aa59,0xbf584853,0xbf49d112,0xbf396842,0xbf644fac,0xbf57dc7f,0xbf495521,0xbf38dd65
.long 0xbf63f473,0xbf577026,0xbf48d8b3,0xbf385216,0xbf6398ac,0xbf570348,0xbf485bca,0xbf37c655
.long 0xbf633c5a,0xbf5695e5,0xbf47de65,0xbf373a23,0xbf62df7b,0xbf5627fe,0xbf476085,0xbf36ad7f
.long 0xbf628210,0xbf55b993,0xbf46e22a,0xbf36206c,0xbf62241a,0xbf554aa4,0xbf466354,0xbf3592e7
.long 0xbf3504f3,0xbf226799,0xbf0e39da,0xbef15aea,0xbf34768f,0xbf21cbfb,0xbf0d9281,0xbeeff7fb
.long 0xbf33e7bc,0xbf212ff9,0xbf0cead0,0xbeee9479,0xbf33587a,0xbf209393,0xbf0c42c9,0xbeed3063
.long 0xbf32c8c9,0xbf1ff6cb,0xbf0b9a6b,0xbeebcbbb,0xbf3238aa,0xbf1f599f,0xbf0af1b7,0xbeea6681
.long 0xbf31a81d,0xbf1ebc12,0xbf0a48ad,0xbee900b7,0xbf311722,0xbf1e1e22,0xbf099f4e,0xbee79a5d
.long 0xbf3085bb,0xbf1d7fd1,0xbf08f59b,0xbee63375,0xbf2ff3e6,0xbf1ce11f,0xbf084b92,0xbee4cbfe
.long 0xbf2f61a5,0xbf1c420c,0xbf07a136,0xbee363fa,0xbf2ecef7,0xbf1ba299,0xbf06f686,0xbee1fb6a
.long 0xbf2e3bde,0xbf1b02c6,0xbf064b82,0xbee0924f,0xbf2da859,0xbf1a6293,0xbf05a02c,0xbedf28a9
.long 0xbf2d1469,0xbf19c200,0xbf04f484,0xbeddbe79,0xbf2c800f,0xbf19210f,0xbf044889,0xbedc53c1
.long 0xbf2beb4a,0xbf187fc0,0xbf039c3d,0xbedae880,0xbf2b561b,0xbf17de12,0xbf02ef9f,0xbed97cb9
.long 0xbf2ac082,0xbf173c07,0xbf0242b1,0xbed8106b,0xbf2a2a80,0xbf16999f,0xbf019573,0xbed6a399
.long 0xbf299415,0xbf15f6d9,0xbf00e7e4,0xbed53641,0xbf28fd41,0xbf1553b7,0xbf003a06,0xbed3c867
.long 0xbf286605,0xbf14b039,0xbeff17b2,0xbed25a09,0xbf27ce61,0xbf140c5f,0xbefdbabb,0xbed0eb2a
.long 0xbf273656,0xbf13682a,0xbefc5d27,0xbecf7bca,0xbf269de3,0xbf12c39a,0xbefafef7,0xbece0bea
.long 0xbf26050a,0xbf121eb0,0xbef9a02d,0xbecc9b8b,0xbf256bcb,0xbf11796b,0xbef840c8,0xbecb2aae
.long 0xbf24d225,0xbf10d3cd,0xbef6e0cb,0xbec9b953,0xbf24381a,0xbf102dd5,0xbef58035,0xbec8477c
.long 0xbf239da9,0xbf0f8784,0xbef41f07,0xbec6d529,0xbf2302d3,0xbf0ee0db,0xbef2bd43,0xbec5625c
.long 0xbec3ef15,0xbe94a031,0xbe47c5c2,0xbdc8bd36,0xbec27b55,0xbe931f35,0xbe44b0b9,0xbdc27c39
.long 0xbec1071e,0xbe919ddd,0xbe419b37,0xbdbc3ac3,0xbebf926f,0xbe901c2c,0xbe3e853e,0xbdb5f8da
.long 0xbebe1d4a,0xbe8e9a22,0xbe3b6ecf,0xbdafb680,0xbebca7af,0xbe8d17c0,0xbe3857ec,0xbda973ba
.long 0xbebb31a0,0xbe8b9507,0xbe354098,0xbda3308c,0xbeb9bb1e,0xbe8a11f7,0xbe3228d4,0xbd9cecf9
.long 0xbeb8442a,0xbe888e93,0xbe2f10a2,0xbd96a905,0xbeb6ccc3,0xbe870ada,0xbe2bf804,0xbd9064b4
.long 0xbeb554ec,0xbe8586ce,0xbe28defc,0xbd8a200a,0xbeb3dca5,0xbe840270,0xbe25c58c,0xbd83db0a
.long 0xbeb263ef,0xbe827dc0,0xbe22abb6,0xbd7b2b74,0xbeb0eacb,0xbe80f8c0,0xbe1f917b,0xbd6ea038
.long 0xbeaf713a,0xbe7ee6e1,0xbe1c76de,0xbd621469,0xbeadf73c,0xbe7bdba4,0xbe195be0,0xbd55880e
.long 0xbeac7cd4,0xbe78cfcc,0xbe164083,0xbd48fb30,0xbeab0201,0xbe75c35a,0xbe1324ca,0xbd3c6dd5
.long 0xbea986c4,0xbe72b651,0xbe1008b7,0xbd2fe007,0xbea80b1f,0xbe6fa8b2,0xbe0cec4a,0xbd2351cb
.long 0xbea68f12,0xbe6c9a7f,0xbe09cf86,0xbd16c32c,0xbea5129f,0xbe698bba,0xbe06b26e,0xbd0a342f
.long 0xbea395c5,0xbe667c66,0xbe039502,0xbcfb49ba,0xbea21887,0xbe636c83,0xbe007745,0xbce22a7a
.long 0xbea09ae5,0xbe605c13,0xbdfab273,0xbcc90ab0,0xbe9f1cdf,0xbe5d4b1a,0xbdf475c0,0xbcafea69
.long 0xbe9d9e78,0xbe5a3997,0xbdee3876,0xbc96c9b6,0xbe9c1faf,0xbe57278f,0xbde7fa9a,0xbc7b514b
.long 0xbe9aa086,0xbe541501,0xbde1bc2e,0xbc490e90,0xbe9920fe,0xbe5101f1,0xbddb7d37,0xbc16cb58
.long 0xbe97a117,0xbe4dee60,0xbdd53db9,0xbbc90f88,0xbe9620d2,0xbe4ada4f,0xbdcefdb7,0xbb490fc6
.size tables, 26624
.section .rodata,"a"
.p2align 6
.amdhsa_kernel g1_kernel
  .amdhsa_next_free_vgpr 256
  .amdhsa_next_free_sgpr 102
  .amdhsa_accum_offset 256
  .amdhsa_group_segment_fixed_size 0
  .amdhsa_kernarg_size 120
  .amdhsa_user_sgpr_count 2
  .amdhsa_user_sgpr_kernarg_segment_ptr 1
  .amdhsa_system_sgpr_workgroup_id_x 1
.end_amdhsa_kernel
.text
.section .rodata,"a"
.p2align 6
.amdhsa_kernel a1_kernel
  .amdhsa_next_free_vgpr 256
  .amdhsa_next_free_sgpr 102
  .amdhsa_accum_offset 256
  .amdhsa_group_segment_fixed_size 0
  .amdhsa_kernarg_size 120
  .amdhsa_user_sgpr_count 2
  .amdhsa_user_sgpr_kernarg_segment_ptr 1
  .amdhsa_system_sgpr_workgroup_id_x 1
.end_amdhsa_kernel
.text
.section .rodata,"a"
.p2align 6
.amdhsa_kernel wt_kernel
  .amdhsa_next_free_vgpr 256
  .amdhsa_next_free_sgpr 102
  .amdhsa_accum_offset 256
  .amdhsa_group_segment_fixed_size 0
  .amdhsa_kernarg_size 120
  .amdhsa_user_sgpr_count 2
  .amdhsa_user_sgpr_kernarg_segment_ptr 1
  .amdhsa_system_sgpr_workgroup_id_x 1
.end_amdhsa_kernel
.text
.section .rodata,"a"
.p2align 6
.amdhsa_kernel a2_kernel
  .amdhsa_next_free_vgpr 256
  .amdhsa_next_free_sgpr 102
  .amdhsa_accum_offset 256
  .amdhsa_group_segment_fixed_size 0
  .amdhsa_kernarg_size 120
  .amdhsa_user_sgpr_count 2
  .amdhsa_user_sgpr_kernarg_segment_ptr 1
  .amdhsa_system_sgpr_workgroup_id_x 1
.end_amdhsa_kernel
.text
.section .rodata,"a"
.p2align 6
.amdhsa_kernel g2_kernel
  .amdhsa_next_free_vgpr 256
  .amdhsa_next_free_sgpr 102
  .amdhsa_accum_offset 256
  .amdhsa_group_segment_fixed_size 0
  .amdhsa_kernarg_size 120
  .amdhsa_user_sgpr_count 2
  .amdhsa_user_sgpr_kernarg_segment_ptr 1
  .amdhsa_system_sgpr_workgroup_id_x 1
.end_amdhsa_kernel
.text
.section .rodata,"a"
.p2align 6
.amdhsa_kernel a3_kernel
  .amdhsa_next_free_vgpr 256
  .amdhsa_next_free_sgpr 102
  .amdhsa_accum_offset 256
  .amdhsa_group_segment_fixed_size 0
  .amdhsa_kernarg_size 120
  .amdhsa_user_sgpr_count 2
  .amdhsa_user_sgpr_kernarg_segment_ptr 1
  .amdhsa_system_sgpr_workgroup_id_x 1
.end_amdhsa_kernel
.text
```

```asm
; @launch grid=(256,1,1) block=(512,1,1) lds=163840
.amdgcn_target "amdgcn-amd-amdhsa--gfx950"
.text
.globl concat_heads__spectral_gfnet__ssm_conv_s5__prompt_kernel
.p2align 8
.type concat_heads__spectral_gfnet__ssm_conv_s5__prompt_kernel,@function
concat_heads__spectral_gfnet__ssm_conv_s5__prompt_kernel:
s_cmp_ge_u32 s2, 256
s_cbranch_scc1 L_concat_heads__spectral_gfnet__ssm_conv_s5__prompt_kernel_end
s_load_dwordx16 s[4:19], s[0:1], 0
s_load_dwordx8 s[20:27], s[0:1], 64
s_load_dwordx4 s[28:31], s[0:1], 96
s_load_dwordx2 s[32:33], s[0:1], 112
v_lshrrev_b32 v2, 6, v0
v_and_b32 v1, 63, v0
v_readfirstlane_b32 s34, v2
s_and_b32 s60, s2, 7
s_lshr_b32 s61, s2, 3
s_lshr_b32 s35, s60, 1
s_lshl_b32 s35, s35, 2
s_lshr_b32 s62, s61, 3
s_add_u32 s35, s35, s62
s_and_b32 s36, s60, 1
s_lshl_b32 s36, s36, 3
s_and_b32 s62, s61, 7
s_add_u32 s36, s36, s62
s_cmp_ge_u32 s34, 4
s_cbranch_scc0 L_concat_heads__spectral_gfnet__ssm_conv_s5__prompt_kernel_gemm
s_sub_u32 s66, s34, 4
v_lshrrev_b32 v2, 5, v1
v_bfe_u32 v3, v1, 3, 2
v_and_b32 v4, 1, v3
v_lshrrev_b32 v5, 1, v3
v_lshlrev_b32 v6, 5, v2
v_lshl_add_u32 v6, v4, 4, v6
v_add_u32 v6, v6, v5
s_lshr_b32 s60, s66, 1
s_lshl_b32 s61, s60, 6
s_and_b32 s62, s66, 1
s_lshl_b32 s62, s62, 3
s_add_u32 s61, s61, s62
v_add_u32 v6, s61, v6
v_lshlrev_b32 v6, 11, v6
s_lshl_b32 s61, s60, 5
v_lshl_add_u32 v7, v2, 3, v3
v_add_u32 v7, s61, v7
v_lshlrev_b32 v7, 11, v7
v_and_b32 v4, 7, v1
v_lshrrev_b32 v5, 4, v1
v_xor_b32 v4, v4, v5
v_lshlrev_b32 v4, 4, v4
v_xor_b32 v5, 64, v4
v_add_u32 v176, v6, v4
v_add_u32 v180, v7, v4
v_add_u32 v177, v6, v5
v_add_u32 v177, 3072, v177
v_add_u32 v181, v7, v5
v_add_u32 v181, 7168, v181
v_add_u32 v178, v6, v4
v_add_u32 v178, 6144, v178
v_add_u32 v182, v7, v4
v_add_u32 v182, 30720, v182
v_add_u32 v179, v6, v5
v_add_u32 v179, 9216, v179
v_add_u32 v183, v7, v5
v_add_u32 v183, 37888, v183
s_and_b32 s64, s2, 7
s_mul_i32 s64, s64, 384
s_add_u32 s60, s35, s36
s_and_b32 s60, s60, 1
s_mul_i32 s60, s60, 1024
s_add_u32 s64, s64, s60
s_lshl_b32 s60, s35, 18
s_lshl_b32 s61, s36, 17
s_waitcnt lgkmcnt(0)
s_lshl_b32 s25, s66, 12
s_mov_b32 s24, s64
s_add_u32 s12, s10, s60
s_addc_u32 s13, s11, 0
s_mov_b32 s14, 262144
s_mov_b32 s15, 0x20000
s_bitcmp1_b32 s66, 0
s_cselect_b32 s62, s18, s16
s_cselect_b32 s63, s19, s17
s_add_u32 s20, s62, s61
s_addc_u32 s21, s63, 0
s_mov_b32 s22, 131072
s_mov_b32 s23, 0x20000
s_add_u32 m0, s25, 0
s_add_u32 s26, s24, 0
s_and_b32 s26, s26, 0x7ff
buffer_load_dwordx4 v176, s[12:15], s26 offen offset:0 lds
buffer_load_dwordx4 v177, s[12:15], s26 offen offset:1024 lds
buffer_load_dwordx4 v178, s[12:15], s26 offen offset:2048 lds
buffer_load_dwordx4 v179, s[12:15], s26 offen offset:3072 lds
s_add_u32 m0, s25, 16384
s_nop 0
buffer_load_dwordx4 v180, s[20:23], s26 offen offset:0 lds
buffer_load_dwordx4 v181, s[20:23], s26 offen offset:1024 lds
buffer_load_dwordx4 v182, s[20:23], s26 offen offset:2048 lds
buffer_load_dwordx4 v183, s[20:23], s26 offen offset:3072 lds
s_mov_b32 s48, s6
s_mov_b32 s49, s7
s_mov_b32 s50, 2101248
s_mov_b32 s51, 0x20000
s_mov_b32 s52, s8
s_mov_b32 s53, s9
s_mov_b32 s54, 2101248
s_mov_b32 s55, 0x20000
s_and_b32 s60, s2, 31
s_lshr_b32 s61, s2, 5
s_lshl_b32 s61, s61, 7
s_add_u32 s60, s60, s61
s_lshl_b32 s61, s66, 5
s_add_u32 s67, s60, s61
s_lshl_b32 s60, s67, 12
s_add_u32 s4, s4, s60
s_addc_u32 s5, s5, 0
s_mov_b32 s6, 4096
s_mov_b32 s7, 0x20000
v_lshlrev_b32 v2, 4, v1
v_xor_b32 v3, 128, v2
s_lshl_b32 s68, s66, 12
s_add_u32 s68, s68, 131072
s_and_b32 s60, s2, 7
s_bfe_u32 s61, s2, 0x10003
s_bfe_u32 s62, s2, 0x20004
s_lshr_b32 s63, s2, 6
s_lshr_b32 s64, s60, 1
s_lshl_b32 s64, s64, 3
s_lshl_b32 s65, s61, 2
s_add_u32 s64, s64, s65
s_and_b32 s65, s60, 1
s_lshl_b32 s65, s65, 1
s_add_u32 s64, s64, s65
s_lshl_b32 s64, s64, 5
s_lshl_b32 s65, s62, 3
s_add_u32 s64, s64, s65
s_lshl_b32 s65, s66, 1
s_add_u32 s64, s64, s65
s_mul_i32 s64, s64, 1026
s_lshl_b32 s65, s63, 8
s_add_u32 s69, s64, s65
v_bfe_u32 v8, v1, 4, 1
v_mul_u32_u24 v8, 32832, v8
v_lshrrev_b32 v9, 5, v1
s_mov_b32 s65, 1050624
v_mul_lo_u32 v9, s65, v9
v_add_u32 v8, v8, v9
v_and_b32 v9, 15, v1
s_lshl_b32 s65, s66, 1
v_xor_b32 v9, s65, v9
v_lshl_add_u32 v18, v9, 4, v8
v_xor_b32 v9, 1, v9
v_lshl_add_u32 v19, v9, 4, v8
v_add_u32 v19, 1026, v19
s_bfe_u32 s64, s2, 0x20005
s_lshl_b32 s64, s64, 8
s_bfe_u32 s65, s2, 0x10004
s_lshl_b32 s65, s65, 6
s_add_u32 s64, s64, s65
s_bfe_u32 s65, s2, 0x10003
s_lshl_b32 s65, s65, 7
s_add_u32 s64, s64, s65
s_and_b32 s65, s2, 7
s_lshl_b32 s65, s65, 2
s_add_u32 s64, s64, s65
v_bfe_u32 v8, v1, 3, 2
v_add_u32 v8, s64, v8
v_bfe_u32 v9, v1, 2, 1
v_lshl_add_u32 v8, v9, 5, v8
v_bfe_u32 v9, v1, 1, 1
v_lshl_add_u32 v8, v9, 10, v8
v_sub_u32 v9, 2048, v8
v_and_b32 v9, 2047, v9
v_and_b32 v10, 1, v1
v_cmp_eq_u32 vcc, 1, v10
s_nop 1
v_cndmask_b32 v8, v8, v9, vcc
v_mul_u32_u24 v17, 1026, v8
s_lshr_b32 s64, s2, 7
s_lshl_b32 s64, s64, 10
v_add_u32 v17, s64, v17
v_mov_b32 v184, 126992
s_lshl_b32 s64, s66, 2
v_add_u32 v185, s64, v184
v_and_b32 v8, 31, v1
v_lshrrev_b32 v9, 5, v1
v_and_b32 v10, 1, v1
v_lshrrev_b32 v11, 1, v8
v_lshlrev_b32 v4, 6, v11
v_lshl_add_u32 v4, v10, 4, v4
v_lshl_add_u32 v4, v9, 12, v4
v_add_u32 v11, v11, v10
v_lshlrev_b32 v11, 6, v11
v_lshl_add_u32 v11, v10, 4, v11
v_lshl_add_u32 v11, v9, 12, v11
v_sub_u32 v5, 5168, v11
v_bfe_u32 v11, v4, 7, 1
v_lshlrev_b32 v11, 5, v11
v_xor_b32 v4, v4, v11
v_bfe_u32 v11, v5, 7, 1
v_lshlrev_b32 v11, 5, v11
v_xor_b32 v5, v5, v11
v_add_u32 v6, 11264, v5
v_and_b32 v6, 0x3fff, v6
s_add_u32 s64, s64, 131072
v_add_u32 v4, s64, v4
v_add_u32 v5, s64, v5
v_add_u32 v6, s64, v6
v_bfe_u32 v11, v1, 3, 1
v_lshlrev_b32 v11, 5, v11
v_xor_b32 v7, v2, v11
v_bfe_u32 v12, v1, 2, 1
v_mul_u32_u24 v12, 2176, v12
v_bfe_u32 v13, v1, 3, 1
v_lshl_add_u32 v12, v13, 6, v12
v_lshl_add_u32 v12, v9, 8, v12
v_bfe_u32 v13, v1, 4, 1
v_lshl_add_u32 v12, v13, 5, v12
v_and_b32 v13, 3, v1
v_lshl_add_u32 v12, v13, 3, v12
v_add_u32 v12, s68, v12
v_xor_b32 v13, 128, v12
s_lshl_b32 s64, s2, 14
s_lshl_b32 s65, s66, 12
s_add_u32 s64, s64, s65
s_add_u32 s42, s64, 16777216
s_add_u32 s40, s32, s42
s_addc_u32 s41, s33, 0
s_mov_b32 s42, 4096
s_mov_b32 s43, 0x20000
s_add_u32 s46, s64, 20971520
s_add_u32 s44, s32, s46
s_addc_u32 s45, s33, 0
s_mov_b32 s46, 4096
s_mov_b32 s47, 0x20000
v_and_b32 v14, 7, v1
v_lshrrev_b32 v15, 3, v1
v_xor_b32 v16, v14, v15
v_lshlrev_b32 v16, 4, v16
v_lshl_add_u32 v16, v14, 11, v16
s_lshr_b32 s64, s66, 1
s_lshl_b32 s64, s64, 7
s_and_b32 s65, s66, 1
s_lshl_b32 s65, s65, 3
s_add_u32 s64, s64, s65
s_add_u32 s64, s64, 147456
v_add_u32 v16, s64, v16
v_lshlrev_b32 v15, 16, v15
v_lshl_add_u32 v15, v14, 4, v15
s_lshl_b32 s64, s63, 7
s_lshr_b32 s65, s66, 1
s_lshl_b32 s65, s65, 6
s_add_u32 s64, s64, s65
s_and_b32 s65, s66, 1
s_lshl_b32 s65, s65, 2
s_add_u32 s64, s64, s65
s_lshl_b32 s64, s64, 13
s_lshl_b32 s65, s60, 10
s_add_u32 s64, s64, s65
s_lshl_b32 s65, s61, 9
s_add_u32 s64, s64, s65
s_lshl_b32 s65, s62, 7
s_add_u32 s64, s64, s65
s_add_u32 s58, s64, 25165824
s_add_u32 s56, s32, s58
s_addc_u32 s57, s33, 0
s_sub_u32 s58, 4194304, s64
s_mov_b32 s59, 0x20000
v_and_b32 v104, 31, v1
v_cvt_f32_u32 v104, v104
v_lshrrev_b32 v105, 5, v1
v_lshlrev_b32 v105, 2, v105
v_cvt_f32_u32 v105, v105
v_mul_f32 v105, v104, v105
v_mul_f32 v105, 0x3d000000, v105
v_fmamk_f32 v106, v104, 0x0, v105
v_fract_f32 v106, v106
v_cos_f32 v107, v106
v_sin_f32 v108, v106
s_nop 0
v_cvt_pk_bf16_f32 v192, v107, v108
v_cvt_pk_bf16_f32 v208, -v108, v107
v_fmamk_f32 v109, v104, 0x3d000000, v105
v_fract_f32 v109, v109
v_cos_f32 v110, v109
v_sin_f32 v111, v109
s_nop 0
v_cvt_pk_bf16_f32 v193, v110, v111
v_cvt_pk_bf16_f32 v209, -v111, v110
v_fmamk_f32 v106, v104, 0x3d800000, v105
v_fract_f32 v106, v106
v_cos_f32 v107, v106
v_sin_f32 v108, v106
s_nop 0
v_cvt_pk_bf16_f32 v194, v107, v108
v_cvt_pk_bf16_f32 v210, -v108, v107
v_fmamk_f32 v109, v104, 0x3dc00000, v105
v_fract_f32 v109, v109
v_cos_f32 v110, v109
v_sin_f32 v111, v109
s_nop 0
v_cvt_pk_bf16_f32 v195, v110, v111
v_cvt_pk_bf16_f32 v211, -v111, v110
v_fmamk_f32 v106, v104, 0x3e800000, v105
v_fract_f32 v106, v106
v_cos_f32 v107, v106
v_sin_f32 v108, v106
s_nop 0
v_cvt_pk_bf16_f32 v196, v107, v108
v_cvt_pk_bf16_f32 v212, -v108, v107
v_fmamk_f32 v109, v104, 0x3e900000, v105
v_fract_f32 v109, v109
v_cos_f32 v110, v109
v_sin_f32 v111, v109
s_nop 0
v_cvt_pk_bf16_f32 v197, v110, v111
v_cvt_pk_bf16_f32 v213, -v111, v110
v_fmamk_f32 v106, v104, 0x3ea00000, v105
v_fract_f32 v106, v106
v_cos_f32 v107, v106
v_sin_f32 v108, v106
s_nop 0
v_cvt_pk_bf16_f32 v198, v107, v108
v_cvt_pk_bf16_f32 v214, -v108, v107
v_fmamk_f32 v109, v104, 0x3eb00000, v105
v_fract_f32 v109, v109
v_cos_f32 v110, v109
v_sin_f32 v111, v109
s_nop 0
v_cvt_pk_bf16_f32 v199, v110, v111
v_cvt_pk_bf16_f32 v215, -v111, v110
v_fmamk_f32 v106, v104, 0x3f000000, v105
v_fract_f32 v106, v106
v_cos_f32 v107, v106
v_sin_f32 v108, v106
s_nop 0
v_cvt_pk_bf16_f32 v200, v107, v108
v_cvt_pk_bf16_f32 v216, -v108, v107
v_fmamk_f32 v109, v104, 0x3f080000, v105
v_fract_f32 v109, v109
v_cos_f32 v110, v109
v_sin_f32 v111, v109
s_nop 0
v_cvt_pk_bf16_f32 v201, v110, v111
v_cvt_pk_bf16_f32 v217, -v111, v110
v_fmamk_f32 v106, v104, 0x3f100000, v105
v_fract_f32 v106, v106
v_cos_f32 v107, v106
v_sin_f32 v108, v106
s_nop 0
v_cvt_pk_bf16_f32 v202, v107, v108
v_cvt_pk_bf16_f32 v218, -v108, v107
v_fmamk_f32 v109, v104, 0x3f180000, v105
v_fract_f32 v109, v109
v_cos_f32 v110, v109
v_sin_f32 v111, v109
s_nop 0
v_cvt_pk_bf16_f32 v203, v110, v111
v_cvt_pk_bf16_f32 v219, -v111, v110
v_fmamk_f32 v106, v104, 0x3f400000, v105
v_fract_f32 v106, v106
v_cos_f32 v107, v106
v_sin_f32 v108, v106
s_nop 0
v_cvt_pk_bf16_f32 v204, v107, v108
v_cvt_pk_bf16_f32 v220, -v108, v107
v_fmamk_f32 v109, v104, 0x3f480000, v105
v_fract_f32 v109, v109
v_cos_f32 v110, v109
v_sin_f32 v111, v109
s_nop 0
v_cvt_pk_bf16_f32 v205, v110, v111
v_cvt_pk_bf16_f32 v221, -v111, v110
v_fmamk_f32 v106, v104, 0x3f500000, v105
v_fract_f32 v106, v106
v_cos_f32 v107, v106
v_sin_f32 v108, v106
s_nop 0
v_cvt_pk_bf16_f32 v206, v107, v108
v_cvt_pk_bf16_f32 v222, -v108, v107
v_fmamk_f32 v109, v104, 0x3f580000, v105
v_fract_f32 v109, v109
v_cos_f32 v110, v109
v_sin_f32 v111, v109
s_nop 0
v_cvt_pk_bf16_f32 v207, v110, v111
v_cvt_pk_bf16_f32 v223, -v111, v110
v_and_b32 v104, 31, v1
v_cvt_f32_u32 v104, v104
v_lshrrev_b32 v105, 5, v1
v_lshlrev_b32 v105, 2, v105
v_cvt_f32_u32 v105, v105
v_mul_f32 v105, v104, v105
v_mul_f32 v105, 0x3a800000, v105
v_fmamk_f32 v106, v104, 0x0, v105
v_cos_f32 v224, v106
v_sin_f32 v240, -v106
v_fmamk_f32 v107, v104, 0x3a800000, v105
v_cos_f32 v225, v107
v_sin_f32 v241, -v107
v_fmamk_f32 v106, v104, 0x3b000000, v105
v_cos_f32 v226, v106
v_sin_f32 v242, -v106
v_fmamk_f32 v107, v104, 0x3b400000, v105
v_cos_f32 v227, v107
v_sin_f32 v243, -v107
v_fmamk_f32 v106, v104, 0x3c000000, v105
v_cos_f32 v228, v106
v_sin_f32 v244, -v106
v_fmamk_f32 v107, v104, 0x3c100000, v105
v_cos_f32 v229, v107
v_sin_f32 v245, -v107
v_fmamk_f32 v106, v104, 0x3c200000, v105
v_cos_f32 v230, v106
v_sin_f32 v246, -v106
v_fmamk_f32 v107, v104, 0x3c300000, v105
v_cos_f32 v231, v107
v_sin_f32 v247, -v107
v_fmamk_f32 v106, v104, 0x3c800000, v105
v_cos_f32 v232, v106
v_sin_f32 v248, -v106
v_fmamk_f32 v107, v104, 0x3c880000, v105
v_cos_f32 v233, v107
v_sin_f32 v249, -v107
v_fmamk_f32 v106, v104, 0x3c900000, v105
v_cos_f32 v234, v106
v_sin_f32 v250, -v106
v_fmamk_f32 v107, v104, 0x3c980000, v105
v_cos_f32 v235, v107
v_sin_f32 v251, -v107
v_fmamk_f32 v106, v104, 0x3cc00000, v105
v_cos_f32 v236, v106
v_sin_f32 v252, -v106
v_fmamk_f32 v107, v104, 0x3cc80000, v105
v_cos_f32 v237, v107
v_sin_f32 v253, -v107
v_fmamk_f32 v106, v104, 0x3cd00000, v105
v_cos_f32 v238, v106
v_sin_f32 v254, -v106
v_fmamk_f32 v107, v104, 0x3cd80000, v105
v_cos_f32 v239, v107
v_sin_f32 v255, -v107
s_add_u32 m0, s25, 32768
s_add_u32 s26, s24, 128
s_and_b32 s26, s26, 0x7ff
buffer_load_dwordx4 v176, s[12:15], s26 offen offset:0 lds
buffer_load_dwordx4 v177, s[12:15], s26 offen offset:1024 lds
buffer_load_dwordx4 v178, s[12:15], s26 offen offset:2048 lds
buffer_load_dwordx4 v179, s[12:15], s26 offen offset:3072 lds
s_add_u32 m0, s25, 49152
s_nop 0
buffer_load_dwordx4 v180, s[20:23], s26 offen offset:0 lds
buffer_load_dwordx4 v181, s[20:23], s26 offen offset:1024 lds
buffer_load_dwordx4 v182, s[20:23], s26 offen offset:2048 lds
buffer_load_dwordx4 v183, s[20:23], s26 offen offset:3072 lds
s_waitcnt vmcnt(8)
s_barrier
s_add_u32 m0, s25, 65536
s_add_u32 s26, s24, 256
s_and_b32 s26, s26, 0x7ff
buffer_load_dwordx4 v176, s[12:15], s26 offen offset:0 lds
buffer_load_dwordx4 v177, s[12:15], s26 offen offset:1024 lds
buffer_load_dwordx4 v178, s[12:15], s26 offen offset:2048 lds
buffer_load_dwordx4 v179, s[12:15], s26 offen offset:3072 lds
s_add_u32 m0, s25, 81920
s_nop 0
buffer_load_dwordx4 v180, s[20:23], s26 offen offset:0 lds
buffer_load_dwordx4 v181, s[20:23], s26 offen offset:1024 lds
buffer_load_dwordx4 v182, s[20:23], s26 offen offset:2048 lds
buffer_load_dwordx4 v183, s[20:23], s26 offen offset:3072 lds
s_waitcnt vmcnt(8)
s_barrier
s_add_u32 m0, s25, 0
s_add_u32 s26, s24, 384
s_and_b32 s26, s26, 0x7ff
buffer_load_dwordx4 v176, s[12:15], s26 offen offset:0 lds
buffer_load_dwordx4 v177, s[12:15], s26 offen offset:1024 lds
buffer_load_dwordx4 v178, s[12:15], s26 offen offset:2048 lds
buffer_load_dwordx4 v179, s[12:15], s26 offen offset:3072 lds
s_add_u32 m0, s25, 16384
s_nop 0
buffer_load_dwordx4 v180, s[20:23], s26 offen offset:0 lds
buffer_load_dwordx4 v181, s[20:23], s26 offen offset:1024 lds
buffer_load_dwordx4 v182, s[20:23], s26 offen offset:2048 lds
buffer_load_dwordx4 v183, s[20:23], s26 offen offset:3072 lds
s_waitcnt vmcnt(8)
s_barrier
s_add_u32 m0, s25, 32768
s_add_u32 s26, s24, 512
s_and_b32 s26, s26, 0x7ff
buffer_load_dwordx4 v176, s[12:15], s26 offen offset:0 lds
buffer_load_dwordx4 v177, s[12:15], s26 offen offset:1024 lds
buffer_load_dwordx4 v178, s[12:15], s26 offen offset:2048 lds
buffer_load_dwordx4 v179, s[12:15], s26 offen offset:3072 lds
s_add_u32 m0, s25, 49152
s_nop 0
buffer_load_dwordx4 v180, s[20:23], s26 offen offset:0 lds
buffer_load_dwordx4 v181, s[20:23], s26 offen offset:1024 lds
buffer_load_dwordx4 v182, s[20:23], s26 offen offset:2048 lds
buffer_load_dwordx4 v183, s[20:23], s26 offen offset:3072 lds
s_waitcnt vmcnt(8)
s_barrier
s_add_u32 m0, s25, 65536
s_add_u32 s26, s24, 640
s_and_b32 s26, s26, 0x7ff
buffer_load_dwordx4 v176, s[12:15], s26 offen offset:0 lds
buffer_load_dwordx4 v177, s[12:15], s26 offen offset:1024 lds
buffer_load_dwordx4 v178, s[12:15], s26 offen offset:2048 lds
buffer_load_dwordx4 v179, s[12:15], s26 offen offset:3072 lds
s_add_u32 m0, s25, 81920
s_nop 0
buffer_load_dwordx4 v180, s[20:23], s26 offen offset:0 lds
buffer_load_dwordx4 v181, s[20:23], s26 offen offset:1024 lds
buffer_load_dwordx4 v182, s[20:23], s26 offen offset:2048 lds
buffer_load_dwordx4 v183, s[20:23], s26 offen offset:3072 lds
s_waitcnt vmcnt(8)
s_barrier
s_add_u32 m0, s25, 0
s_add_u32 s26, s24, 768
s_and_b32 s26, s26, 0x7ff
buffer_load_dwordx4 v176, s[12:15], s26 offen offset:0 lds
buffer_load_dwordx4 v177, s[12:15], s26 offen offset:1024 lds
buffer_load_dwordx4 v178, s[12:15], s26 offen offset:2048 lds
buffer_load_dwordx4 v179, s[12:15], s26 offen offset:3072 lds
s_add_u32 m0, s25, 16384
s_nop 0
buffer_load_dwordx4 v180, s[20:23], s26 offen offset:0 lds
buffer_load_dwordx4 v181, s[20:23], s26 offen offset:1024 lds
buffer_load_dwordx4 v182, s[20:23], s26 offen offset:2048 lds
buffer_load_dwordx4 v183, s[20:23], s26 offen offset:3072 lds
s_waitcnt vmcnt(8)
s_barrier
s_add_u32 m0, s25, 32768
s_add_u32 s26, s24, 896
s_and_b32 s26, s26, 0x7ff
buffer_load_dwordx4 v176, s[12:15], s26 offen offset:0 lds
buffer_load_dwordx4 v177, s[12:15], s26 offen offset:1024 lds
buffer_load_dwordx4 v178, s[12:15], s26 offen offset:2048 lds
buffer_load_dwordx4 v179, s[12:15], s26 offen offset:3072 lds
s_add_u32 m0, s25, 49152
s_nop 0
buffer_load_dwordx4 v180, s[20:23], s26 offen offset:0 lds
buffer_load_dwordx4 v181, s[20:23], s26 offen offset:1024 lds
buffer_load_dwordx4 v182, s[20:23], s26 offen offset:2048 lds
buffer_load_dwordx4 v183, s[20:23], s26 offen offset:3072 lds
v_and_b32 v104, 31, v1
v_cvt_f32_u32 v104, v104
v_lshrrev_b32 v105, 5, v1
v_lshlrev_b32 v105, 2, v105
v_cvt_f32_u32 v105, v105
v_mul_f32 v104, 0x3a000000, v104
v_fmamk_f32 v105, v105, 0x3c800000, v104
v_add_f32 v106, 0x0, v105
v_cos_f32 v136, v106
v_sin_f32 v152, -v106
v_add_f32 v107, 0x3c800000, v105
v_cos_f32 v137, v107
v_sin_f32 v153, -v107
v_add_f32 v106, 0x3d000000, v105
v_cos_f32 v138, v106
v_sin_f32 v154, -v106
v_add_f32 v107, 0x3d400000, v105
v_cos_f32 v139, v107
v_sin_f32 v155, -v107
v_add_f32 v106, 0x3e000000, v105
v_cos_f32 v140, v106
v_sin_f32 v156, -v106
v_add_f32 v107, 0x3e100000, v105
v_cos_f32 v141, v107
v_sin_f32 v157, -v107
v_add_f32 v106, 0x3e200000, v105
v_cos_f32 v142, v106
v_sin_f32 v158, -v106
v_add_f32 v107, 0x3e300000, v105
v_cos_f32 v143, v107
v_sin_f32 v159, -v107
v_add_f32 v106, 0x3e800000, v105
v_cos_f32 v144, v106
v_sin_f32 v160, -v106
v_add_f32 v107, 0x3e880000, v105
v_cos_f32 v145, v107
v_sin_f32 v161, -v107
v_add_f32 v106, 0x3e900000, v105
v_cos_f32 v146, v106
v_sin_f32 v162, -v106
v_add_f32 v107, 0x3e980000, v105
v_cos_f32 v147, v107
v_sin_f32 v163, -v107
v_add_f32 v106, 0x3ec00000, v105
v_cos_f32 v148, v106
v_sin_f32 v164, -v106
v_add_f32 v107, 0x3ec80000, v105
v_cos_f32 v149, v107
v_sin_f32 v165, -v107
v_add_f32 v106, 0x3ed00000, v105
v_cos_f32 v150, v106
v_sin_f32 v166, -v106
v_add_f32 v107, 0x3ed80000, v105
v_cos_f32 v151, v107
v_sin_f32 v167, -v107
s_waitcnt vmcnt(8)
s_barrier
s_add_u32 m0, s25, 65536
s_add_u32 s26, s24, 1024
s_and_b32 s26, s26, 0x7ff
buffer_load_dwordx4 v176, s[12:15], s26 offen offset:0 lds
buffer_load_dwordx4 v177, s[12:15], s26 offen offset:1024 lds
buffer_load_dwordx4 v178, s[12:15], s26 offen offset:2048 lds
buffer_load_dwordx4 v179, s[12:15], s26 offen offset:3072 lds
s_add_u32 m0, s25, 81920
s_nop 0
buffer_load_dwordx4 v180, s[20:23], s26 offen offset:0 lds
buffer_load_dwordx4 v181, s[20:23], s26 offen offset:1024 lds
buffer_load_dwordx4 v182, s[20:23], s26 offen offset:2048 lds
buffer_load_dwordx4 v183, s[20:23], s26 offen offset:3072 lds
s_waitcnt vmcnt(8)
s_barrier
s_add_u32 m0, s25, 0
s_add_u32 s26, s24, 1152
s_and_b32 s26, s26, 0x7ff
buffer_load_dwordx4 v176, s[12:15], s26 offen offset:0 lds
buffer_load_dwordx4 v177, s[12:15], s26 offen offset:1024 lds
buffer_load_dwordx4 v178, s[12:15], s26 offen offset:2048 lds
buffer_load_dwordx4 v179, s[12:15], s26 offen offset:3072 lds
s_add_u32 m0, s25, 16384
s_nop 0
buffer_load_dwordx4 v180, s[20:23], s26 offen offset:0 lds
buffer_load_dwordx4 v181, s[20:23], s26 offen offset:1024 lds
buffer_load_dwordx4 v182, s[20:23], s26 offen offset:2048 lds
buffer_load_dwordx4 v183, s[20:23], s26 offen offset:3072 lds
s_waitcnt vmcnt(8)
s_barrier
s_add_u32 m0, s25, 32768
s_add_u32 s26, s24, 1280
s_and_b32 s26, s26, 0x7ff
buffer_load_dwordx4 v176, s[12:15], s26 offen offset:0 lds
buffer_load_dwordx4 v177, s[12:15], s26 offen offset:1024 lds
buffer_load_dwordx4 v178, s[12:15], s26 offen offset:2048 lds
buffer_load_dwordx4 v179, s[12:15], s26 offen offset:3072 lds
s_add_u32 m0, s25, 49152
s_nop 0
buffer_load_dwordx4 v180, s[20:23], s26 offen offset:0 lds
buffer_load_dwordx4 v181, s[20:23], s26 offen offset:1024 lds
buffer_load_dwordx4 v182, s[20:23], s26 offen offset:2048 lds
buffer_load_dwordx4 v183, s[20:23], s26 offen offset:3072 lds
s_waitcnt vmcnt(8)
s_barrier
s_add_u32 m0, s25, 65536
s_add_u32 s26, s24, 1408
s_and_b32 s26, s26, 0x7ff
buffer_load_dwordx4 v176, s[12:15], s26 offen offset:0 lds
buffer_load_dwordx4 v177, s[12:15], s26 offen offset:1024 lds
buffer_load_dwordx4 v178, s[12:15], s26 offen offset:2048 lds
buffer_load_dwordx4 v179, s[12:15], s26 offen offset:3072 lds
s_add_u32 m0, s25, 81920
s_nop 0
buffer_load_dwordx4 v180, s[20:23], s26 offen offset:0 lds
buffer_load_dwordx4 v181, s[20:23], s26 offen offset:1024 lds
buffer_load_dwordx4 v182, s[20:23], s26 offen offset:2048 lds
buffer_load_dwordx4 v183, s[20:23], s26 offen offset:3072 lds
s_waitcnt vmcnt(8)
s_barrier
s_add_u32 m0, s25, 0
s_add_u32 s26, s24, 1536
s_and_b32 s26, s26, 0x7ff
buffer_load_dwordx4 v176, s[12:15], s26 offen offset:0 lds
buffer_load_dwordx4 v177, s[12:15], s26 offen offset:1024 lds
buffer_load_dwordx4 v178, s[12:15], s26 offen offset:2048 lds
buffer_load_dwordx4 v179, s[12:15], s26 offen offset:3072 lds
s_add_u32 m0, s25, 16384
s_nop 0
buffer_load_dwordx4 v180, s[20:23], s26 offen offset:0 lds
buffer_load_dwordx4 v181, s[20:23], s26 offen offset:1024 lds
buffer_load_dwordx4 v182, s[20:23], s26 offen offset:2048 lds
buffer_load_dwordx4 v183, s[20:23], s26 offen offset:3072 lds
s_waitcnt vmcnt(8)
s_barrier
s_add_u32 m0, s25, 32768
s_add_u32 s26, s24, 1664
s_and_b32 s26, s26, 0x7ff
buffer_load_dwordx4 v176, s[12:15], s26 offen offset:0 lds
buffer_load_dwordx4 v177, s[12:15], s26 offen offset:1024 lds
buffer_load_dwordx4 v178, s[12:15], s26 offen offset:2048 lds
buffer_load_dwordx4 v179, s[12:15], s26 offen offset:3072 lds
s_add_u32 m0, s25, 49152
s_nop 0
buffer_load_dwordx4 v180, s[20:23], s26 offen offset:0 lds
buffer_load_dwordx4 v181, s[20:23], s26 offen offset:1024 lds
buffer_load_dwordx4 v182, s[20:23], s26 offen offset:2048 lds
buffer_load_dwordx4 v183, s[20:23], s26 offen offset:3072 lds
s_waitcnt vmcnt(8)
s_barrier
s_add_u32 m0, s25, 65536
s_add_u32 s26, s24, 1792
s_and_b32 s26, s26, 0x7ff
buffer_load_dwordx4 v176, s[12:15], s26 offen offset:0 lds
buffer_load_dwordx4 v177, s[12:15], s26 offen offset:1024 lds
buffer_load_dwordx4 v178, s[12:15], s26 offen offset:2048 lds
buffer_load_dwordx4 v179, s[12:15], s26 offen offset:3072 lds
s_add_u32 m0, s25, 81920
s_nop 0
buffer_load_dwordx4 v180, s[20:23], s26 offen offset:0 lds
buffer_load_dwordx4 v181, s[20:23], s26 offen offset:1024 lds
buffer_load_dwordx4 v182, s[20:23], s26 offen offset:2048 lds
buffer_load_dwordx4 v183, s[20:23], s26 offen offset:3072 lds
s_waitcnt vmcnt(8)
s_barrier
s_add_u32 m0, s25, 0
s_add_u32 s26, s24, 1920
s_and_b32 s26, s26, 0x7ff
buffer_load_dwordx4 v176, s[12:15], s26 offen offset:0 lds
buffer_load_dwordx4 v177, s[12:15], s26 offen offset:1024 lds
buffer_load_dwordx4 v178, s[12:15], s26 offen offset:2048 lds
buffer_load_dwordx4 v179, s[12:15], s26 offen offset:3072 lds
s_add_u32 m0, s25, 16384
s_nop 0
buffer_load_dwordx4 v180, s[20:23], s26 offen offset:0 lds
buffer_load_dwordx4 v181, s[20:23], s26 offen offset:1024 lds
buffer_load_dwordx4 v182, s[20:23], s26 offen offset:2048 lds
buffer_load_dwordx4 v183, s[20:23], s26 offen offset:3072 lds
s_waitcnt vmcnt(8)
s_barrier
s_waitcnt vmcnt(0)
s_barrier
s_add_u32 m0, s68, 0
s_mov_b32 s92, 0
buffer_load_dwordx4 v2, s[4:7], s92 offen offset:0 nt lds
buffer_load_dwordx4 v2, s[4:7], s92 offen offset:1024 nt lds
s_add_u32 m0, s68, 2048
s_mov_b32 s92, 2048
buffer_load_dwordx4 v3, s[4:7], s92 offen offset:0 nt lds
buffer_load_dwordx4 v3, s[4:7], s92 offen offset:1024 nt lds
s_add_u32 m0, s68, 16384
s_nop 0
buffer_load_dwordx4 v18, s[48:51], s69 offen nt lds
s_add_u32 m0, s68, 17408
s_nop 0
buffer_load_dwordx4 v18, s[52:55], s69 offen nt lds
s_add_u32 m0, s68, 18432
s_nop 0
buffer_load_dwordx4 v19, s[48:51], s69 offen nt lds
s_add_u32 m0, s68, 19456
s_nop 0
buffer_load_dwordx4 v19, s[52:55], s69 offen nt lds
s_cmp_lg_u32 s66, 3
s_cbranch_scc1 L_nw1
s_mov_b32 exec_hi, 0
buffer_load_ushort v88, v17, s[48:51], 0 offen nt
buffer_load_ushort v89, v17, s[52:55], 0 offen nt
s_mov_b64 exec, -1
L_nw1:
s_barrier
s_barrier
s_setprio 3
v_mov_b32 v20, 0
L_n2:
global_load_dword v21, v20, s[30:31] sc1
s_waitcnt vmcnt(0)
v_readfirstlane_b32 s37, v21
s_nop 0
s_cmp_eq_u32 s37, 0
s_cbranch_scc1 L_n2
v_mov_b32 v190, 1
s_mov_b64 exec, 1
ds_write_b32 v185, v190
s_mov_b64 exec, -1
L_lc4:
ds_read_b128 v[186:189], v184
s_waitcnt lgkmcnt(0)
v_min3_u32 v186, v186, v187, v188
v_min_u32 v186, v186, v189
s_nop 0
v_readfirstlane_b32 s92, v186
s_nop 0
s_cmp_ge_u32 s92, 1
s_cbranch_scc1 L_lcd5
s_sleep 1
s_branch L_lc4
L_lcd5:
ds_read_b64_tr_b16 v[24:25], v12 offset:0
ds_read_b64_tr_b16 v[26:27], v13 offset:0
ds_read_b64_tr_b16 v[28:29], v12 offset:512
ds_read_b64_tr_b16 v[30:31], v13 offset:512
ds_read_b64_tr_b16 v[32:33], v12 offset:1024
ds_read_b64_tr_b16 v[34:35], v13 offset:1024
ds_read_b64_tr_b16 v[36:37], v12 offset:1536
ds_read_b64_tr_b16 v[38:39], v13 offset:1536
ds_read_b64 v[104:105], v16 offset:0
ds_read_b64 v[106:107], v16 offset:256
ds_read_b64 v[108:109], v16 offset:512
ds_read_b64 v[110:111], v16 offset:768
ds_read_b64 v[112:113], v16 offset:1024
ds_read_b64 v[114:115], v16 offset:1280
ds_read_b64 v[116:117], v16 offset:1536
ds_read_b64 v[118:119], v16 offset:1792
s_mov_b32 s64, 0x05040100
s_mov_b32 s65, 0x07060302
s_waitcnt lgkmcnt(8)
v_mfma_f32_32x32x16_bf16 v[40:55], v[24:27], v[192:195], 0
v_mfma_f32_32x32x16_bf16 v[40:55], v[28:31], v[196:199], v[40:55]
v_mfma_f32_32x32x16_bf16 v[40:55], v[32:35], v[200:203], v[40:55]
v_mfma_f32_32x32x16_bf16 v[40:55], v[36:39], v[204:207], v[40:55]
v_mfma_f32_32x32x16_bf16 v[56:71], v[24:27], v[208:211], 0
v_mfma_f32_32x32x16_bf16 v[56:71], v[28:31], v[212:215], v[56:71]
v_mfma_f32_32x32x16_bf16 v[56:71], v[32:35], v[216:219], v[56:71]
v_mfma_f32_32x32x16_bf16 v[56:71], v[36:39], v[220:223], v[56:71]
s_waitcnt lgkmcnt(0)
v_perm_b32 v120, v112, v104, s64
v_perm_b32 v121, v116, v108, s64
v_perm_b32 v122, v114, v106, s64
v_perm_b32 v123, v118, v110, s64
v_perm_b32 v124, v112, v104, s65
v_perm_b32 v125, v116, v108, s65
v_perm_b32 v126, v114, v106, s65
v_perm_b32 v127, v118, v110, s65
v_perm_b32 v128, v113, v105, s64
v_perm_b32 v129, v117, v109, s64
v_perm_b32 v130, v115, v107, s64
v_perm_b32 v131, v119, v111, s64
v_perm_b32 v132, v113, v105, s65
v_perm_b32 v133, v117, v109, s65
v_perm_b32 v134, v115, v107, s65
v_perm_b32 v135, v119, v111, s65
v_mul_f32 v168, v40, v224
v_mul_f32 v169, v40, v240
v_fma_f32 v168, -v56, v240, v168
v_fmac_f32 v169, v56, v224
v_cvt_pk_bf16_f32 v72, v168, v169
v_mul_f32 v170, v41, v225
v_mul_f32 v171, v41, v241
v_fma_f32 v170, -v57, v241, v170
v_fmac_f32 v171, v57, v225
v_cvt_pk_bf16_f32 v73, v170, v171
v_mul_f32 v172, v42, v226
v_mul_f32 v173, v42, v242
v_fma_f32 v172, -v58, v242, v172
v_fmac_f32 v173, v58, v226
v_cvt_pk_bf16_f32 v74, v172, v173
v_mul_f32 v174, v43, v227
v_mul_f32 v175, v43, v243
v_fma_f32 v174, -v59, v243, v174
v_fmac_f32 v175, v59, v227
v_cvt_pk_bf16_f32 v75, v174, v175
v_mul_f32 v168, v44, v228
v_mul_f32 v169, v44, v244
v_fma_f32 v168, -v60, v244, v168
v_fmac_f32 v169, v60, v228
v_cvt_pk_bf16_f32 v76, v168, v169
v_mul_f32 v170, v45, v229
v_mul_f32 v171, v45, v245
v_fma_f32 v170, -v61, v245, v170
v_fmac_f32 v171, v61, v229
v_cvt_pk_bf16_f32 v77, v170, v171
v_mul_f32 v172, v46, v230
v_mul_f32 v173, v46, v246
v_fma_f32 v172, -v62, v246, v172
v_fmac_f32 v173, v62, v230
v_cvt_pk_bf16_f32 v78, v172, v173
v_mul_f32 v174, v47, v231
v_mul_f32 v175, v47, v247
v_fma_f32 v174, -v63, v247, v174
v_fmac_f32 v175, v63, v231
v_cvt_pk_bf16_f32 v79, v174, v175
v_mul_f32 v168, v48, v232
v_mul_f32 v169, v48, v248
v_fma_f32 v168, -v64, v248, v168
v_fmac_f32 v169, v64, v232
v_cvt_pk_bf16_f32 v80, v168, v169
v_mul_f32 v170, v49, v233
v_mul_f32 v171, v49, v249
v_fma_f32 v170, -v65, v249, v170
v_fmac_f32 v171, v65, v233
v_cvt_pk_bf16_f32 v81, v170, v171
v_mul_f32 v172, v50, v234
v_mul_f32 v173, v50, v250
v_fma_f32 v172, -v66, v250, v172
v_fmac_f32 v173, v66, v234
v_cvt_pk_bf16_f32 v82, v172, v173
v_mul_f32 v174, v51, v235
v_mul_f32 v175, v51, v251
v_fma_f32 v174, -v67, v251, v174
v_fmac_f32 v175, v67, v235
v_cvt_pk_bf16_f32 v83, v174, v175
v_mul_f32 v168, v52, v236
v_mul_f32 v169, v52, v252
v_fma_f32 v168, -v68, v252, v168
v_fmac_f32 v169, v68, v236
v_cvt_pk_bf16_f32 v84, v168, v169
v_mul_f32 v170, v53, v237
v_mul_f32 v171, v53, v253
v_fma_f32 v170, -v69, v253, v170
v_fmac_f32 v171, v69, v237
v_cvt_pk_bf16_f32 v85, v170, v171
v_mul_f32 v172, v54, v238
v_mul_f32 v173, v54, v254
v_fma_f32 v172, -v70, v254, v172
v_fmac_f32 v173, v70, v238
v_cvt_pk_bf16_f32 v86, v172, v173
v_mul_f32 v174, v55, v239
v_mul_f32 v175, v55, v255
v_fma_f32 v174, -v71, v255, v174
v_fmac_f32 v175, v71, v239
v_cvt_pk_bf16_f32 v87, v174, v175
v_mfma_f32_32x32x16_bf16 v[40:55], v[192:195], v[72:75], 0
v_mfma_f32_32x32x16_bf16 v[40:55], v[196:199], v[76:79], v[40:55]
v_mfma_f32_32x32x16_bf16 v[40:55], v[200:203], v[80:83], v[40:55]
v_mfma_f32_32x32x16_bf16 v[40:55], v[204:207], v[84:87], v[40:55]
v_mfma_f32_32x32x16_bf16 v[56:71], v[208:211], v[72:75], 0
v_mfma_f32_32x32x16_bf16 v[56:71], v[212:215], v[76:79], v[56:71]
v_mfma_f32_32x32x16_bf16 v[56:71], v[216:219], v[80:83], v[56:71]
v_mfma_f32_32x32x16_bf16 v[56:71], v[220:223], v[84:87], v[56:71]
v_mov_b32 v190, 2
s_mov_b64 exec, 1
ds_write_b32 v185, v190
s_mov_b64 exec, -1
L_lc6:
ds_read_b128 v[186:189], v184
s_waitcnt lgkmcnt(0)
v_min3_u32 v186, v186, v187, v188
v_min_u32 v186, v186, v189
s_nop 0
v_readfirstlane_b32 s92, v186
s_nop 0
s_cmp_ge_u32 s92, 2
s_cbranch_scc1 L_lcd7
s_sleep 1
s_branch L_lc6
L_lcd7:
v_cvt_pk_bf16_f32 v72, v40, v56
ds_write_b32 v4, v72 offset:0
v_cvt_pk_bf16_f32 v73, v41, v57
ds_write_b32 v4, v73 offset:1024
v_cvt_pk_bf16_f32 v74, v42, v58
ds_write_b32 v4, v74 offset:2048
v_cvt_pk_bf16_f32 v75, v43, v59
ds_write_b32 v4, v75 offset:3072
v_cvt_pk_bf16_f32 v76, v44, v60
ds_write_b32 v4, v76 offset:8192
v_cvt_pk_bf16_f32 v77, v45, v61
ds_write_b32 v4, v77 offset:9216
v_cvt_pk_bf16_f32 v78, v46, v62
ds_write_b32 v4, v78 offset:10240
v_cvt_pk_bf16_f32 v79, v47, v63
ds_write_b32 v4, v79 offset:11264
v_cvt_pk_bf16_f32 v80, v48, v64
ds_write_b32 v6, v80 offset:0
v_cvt_pk_bf16_f32 v81, v49, v65
ds_write_b32 v5, v81 offset:10240
v_cvt_pk_bf16_f32 v82, v50, v66
ds_write_b32 v5, v82 offset:9216
v_cvt_pk_bf16_f32 v83, v51, v67
ds_write_b32 v5, v83 offset:8192
v_cvt_pk_bf16_f32 v84, v52, v68
ds_write_b32 v5, v84 offset:3072
v_cvt_pk_bf16_f32 v85, v53, v69
ds_write_b32 v5, v85 offset:2048
v_cvt_pk_bf16_f32 v86, v54, v70
ds_write_b32 v5, v86 offset:1024
v_cvt_pk_bf16_f32 v87, v55, v71
ds_write_b32 v5, v87 offset:0
s_waitcnt lgkmcnt(0)
v_mov_b32 v190, 3
s_mov_b64 exec, 1
ds_write_b32 v185, v190
s_mov_b64 exec, -1
L_lc8:
ds_read_b128 v[186:189], v184
s_waitcnt lgkmcnt(0)
v_min3_u32 v186, v186, v187, v188
v_min_u32 v186, v186, v189
s_nop 0
v_readfirstlane_b32 s92, v186
s_nop 0
s_cmp_ge_u32 s92, 3
s_cbranch_scc1 L_lcd9
s_sleep 1
s_branch L_lc8
L_lcd9:
v_add_u32 v8, s68, v7
ds_read_b128 v[72:75], v8 offset:0
ds_read_b128 v[76:79], v8 offset:1024
ds_read_b128 v[80:83], v8 offset:2048
ds_read_b128 v[84:87], v8 offset:3072
s_mov_b32 s92, 0
buffer_store_dwordx4 v[120:123], v15, s[56:59], s92 offen sc1
s_mov_b32 s92, 8192
buffer_store_dwordx4 v[124:127], v15, s[56:59], s92 offen sc1
s_mov_b32 s92, 16384
buffer_store_dwordx4 v[128:131], v15, s[56:59], s92 offen sc1
s_mov_b32 s92, 24576
buffer_store_dwordx4 v[132:135], v15, s[56:59], s92 offen sc1
s_waitcnt lgkmcnt(3)
buffer_store_dwordx4 v[72:75], v2, s[40:43], 0 offen offset:0 sc1
s_waitcnt lgkmcnt(2)
buffer_store_dwordx4 v[76:79], v2, s[40:43], 0 offen offset:1024 sc1
s_waitcnt lgkmcnt(1)
buffer_store_dwordx4 v[80:83], v2, s[40:43], 0 offen offset:2048 sc1
s_waitcnt lgkmcnt(0)
buffer_store_dwordx4 v[84:87], v2, s[40:43], 0 offen offset:3072 sc1
s_cmp_lg_u32 s66, 3
s_cbranch_scc1 L_nw10
s_lshr_b32 s64, s2, 7
s_sub_u32 s64, 513, s64
s_lshl_b32 s64, s64, 13
s_and_b32 s65, s2, 127
s_lshl_b32 s65, s65, 6
s_add_u32 s64, s64, s65
s_add_u32 s58, s64, 25165824
s_add_u32 s56, s32, s58
s_addc_u32 s57, s33, 0
s_mov_b32 s58, 64
s_mov_b32 s59, 0x20000
v_lshlrev_b32 v88, 16, v88
v_lshlrev_b32 v89, 16, v89
v_lshlrev_b32 v8, 1, v1
v_add_f32_dpp v90, v88, v88 quad_perm:[1,0,3,2] row_mask:0xf bank_mask:0xf
v_subrev_f32_dpp v91, v89, v89 quad_perm:[1,0,3,2] row_mask:0xf bank_mask:0xf
v_mul_f32 v90, 0.5, v90
v_mul_f32 v91, 0.5, v91
v_cvt_pk_bf16_f32 v88, v90, v91
s_mov_b32 exec_lo, 0x55555555
s_mov_b32 exec_hi, 0
buffer_store_dword v88, v8, s[56:59], 0 offen sc1
s_mov_b64 exec, -1
L_nw10:
s_and_b32 s60, s2, 7
s_lshl_b32 s60, s60, 5
s_lshr_b32 s64, s2, 3
s_add_u32 s60, s60, s64
s_lshr_b32 s64, s66, 1
s_xor_b32 s64, s64, s66
s_and_b32 s64, s64, 1
s_or_b32 s65, s64, s60
s_cmp_eq_u32 s65, 0
s_cselect_b32 s61, 1, 0
s_lshl_b32 s65, s60, 1
s_add_u32 s64, s64, s65
s_lshr_b32 s65, s66, 1
s_sub_u32 s69, 513, s65
s_cmp_eq_u32 s61, 1
s_cselect_b32 s64, s69, s64
s_cselect_b32 s65, 0, s65
s_lshl_b32 s62, s65, 31
s_or_b32 s63, s62, 0x3f800000
s_lshl_b32 s64, s64, 13
s_add_u32 s50, s64, 25165824
s_add_u32 s48, s32, s50
s_addc_u32 s49, s33, 0
s_mov_b32 s50, 8192
s_mov_b32 s51, 0x20000
s_lshl_b32 s64, s66, 20
s_lshl_b32 s65, s60, 6
s_add_u32 s64, s64, s65
s_add_u32 s54, s64, 16777216
s_add_u32 s52, s32, s54
s_addc_u32 s53, s33, 0
s_sub_u32 s54, 1048576, s65
s_mov_b32 s55, 0x20000
s_add_u32 s58, s64, 20971520
s_add_u32 s56, s32, s58
s_addc_u32 s57, s33, 0
s_sub_u32 s58, 1048576, s65
s_mov_b32 s59, 0x20000
v_lshrrev_b32 v8, 2, v1
v_lshlrev_b32 v8, 14, v8
v_and_b32 v9, 3, v1
v_lshrrev_b32 v10, 4, v1
v_xor_b32 v9, v9, v10
v_lshl_add_u32 v14, v9, 4, v8
v_and_b32 v8, 31, v1
v_bfe_u32 v9, v1, 2, 2
v_xor_b32 v9, s66, v9
v_lshlrev_b32 v9, 4, v9
v_lshl_add_u32 v9, v8, 6, v9
v_lshrrev_b32 v8, 5, v1
v_lshl_add_u32 v9, v8, 11, v9
v_add_u32 v15, 131072, v9
s_lshl_b32 s64, s66, 13
s_add_u32 s64, s64, 131072
v_add_u32 v16, s64, v2
s_xor_b32 s65, s64, 24576
s_cmp_eq_u32 s61, 1
s_cselect_b32 s65, s64, s65
v_add_u32 v17, s65, v2
v_add_u32 v18, s68, v2
v_pk_mul_f32 v[136:137], s[62:63], v[136:137] op_sel:[1,0]
v_pk_mul_f32 v[138:139], s[62:63], v[138:139] op_sel:[1,0]
v_pk_mul_f32 v[140:141], s[62:63], v[140:141] op_sel:[1,0]
v_pk_mul_f32 v[142:143], s[62:63], v[142:143] op_sel:[1,0]
v_pk_mul_f32 v[144:145], s[62:63], v[144:145] op_sel:[1,0]
v_pk_mul_f32 v[146:147], s[62:63], v[146:147] op_sel:[1,0]
v_pk_mul_f32 v[148:149], s[62:63], v[148:149] op_sel:[1,0]
v_pk_mul_f32 v[150:151], s[62:63], v[150:151] op_sel:[1,0]
v_pk_mul_f32 v[152:153], s[62:63], v[152:153] op_sel:[1,0]
v_pk_mul_f32 v[154:155], s[62:63], v[154:155] op_sel:[1,0]
v_pk_mul_f32 v[156:157], s[62:63], v[156:157] op_sel:[1,0]
v_pk_mul_f32 v[158:159], s[62:63], v[158:159] op_sel:[1,0]
v_pk_mul_f32 v[160:161], s[62:63], v[160:161] op_sel:[1,0]
v_pk_mul_f32 v[162:163], s[62:63], v[162:163] op_sel:[1,0]
v_pk_mul_f32 v[164:165], s[62:63], v[164:165] op_sel:[1,0]
v_pk_mul_f32 v[166:167], s[62:63], v[166:167] op_sel:[1,0]
s_waitcnt vmcnt(0)
v_mov_b32 v190, 4
s_mov_b64 exec, 1
ds_write_b32 v185, v190
s_mov_b64 exec, -1
s_cmp_lg_u32 s66, 0
s_cbranch_scc1 L_ph11
L_lc12:
ds_read_b128 v[186:189], v184
s_waitcnt lgkmcnt(0)
v_min3_u32 v186, v186, v187, v188
v_min_u32 v186, v186, v189
s_nop 0
v_readfirstlane_b32 s92, v186
s_nop 0
s_cmp_ge_u32 s92, 4
s_cbranch_scc1 L_lcd13
s_sleep 1
s_branch L_lc12
L_lcd13:
s_and_b32 s64, s2, 15
s_lshl_b32 s65, s64, 7
s_add_u32 s65, s65, 4096
s_add_u32 s90, s32, s65
s_addc_u32 s91, s33, 0
s_mov_b32 s65, 1
s_atomic_add s65, s[90:91], 0x0 glc
s_lshl_b32 s64, s64, 2
s_add_u32 s64, s64, 540672
v_lshl_add_u32 v20, v1, 7, s64
v_mov_b32 v21, s37
s_and_b32 s64, s2, 63
s_lshl_b32 s64, s64, 7
s_add_u32 s64, s64, 540672
s_waitcnt lgkmcnt(0)
s_cmp_lg_u32 s65, 15
s_cbranch_scc1 L_sg14
global_store_dword v20, v21, s[32:33] sc1
L_sg14:
s_add_u32 s90, s32, s64
s_addc_u32 s91, s33, 0
s_mov_b32 s64, s37
s_mov_b32 s65, s37
s_mov_b32 s92, 0
s_branch L_sp15
L_nok16:
s_add_u32 s92, s92, 1
s_cmp_ge_u32 s92, 200000
s_cbranch_scc1 L_ph11
s_sleep 2
L_sp15:
s_load_dwordx16 s[4:19], s[90:91], 0x0 glc
s_waitcnt lgkmcnt(0)
s_cmp_eq_u64 s[4:5], s[64:65]
s_cbranch_scc0 L_nok16
s_cmp_eq_u64 s[6:7], s[64:65]
s_cbranch_scc0 L_nok16
s_cmp_eq_u64 s[8:9], s[64:65]
s_cbranch_scc0 L_nok16
s_cmp_eq_u64 s[10:11], s[64:65]
s_cbranch_scc0 L_nok16
s_cmp_eq_u64 s[12:13], s[64:65]
s_cbranch_scc0 L_nok16
s_cmp_eq_u64 s[14:15], s[64:65]
s_cbranch_scc0 L_nok16
s_cmp_eq_u64 s[16:17], s[64:65]
s_cbranch_scc0 L_nok16
s_cmp_eq_u64 s[18:19], s[64:65]
s_cbranch_scc0 L_nok16
L_ph11:
v_mov_b32 v190, 5
s_mov_b64 exec, 1
ds_write_b32 v185, v190
s_mov_b64 exec, -1
L_lc17:
ds_read_b128 v[186:189], v184
s_waitcnt lgkmcnt(0)
v_min3_u32 v186, v186, v187, v188
v_min_u32 v186, v186, v189
s_nop 0
v_readfirstlane_b32 s92, v186
s_nop 0
s_cmp_ge_u32 s92, 5
s_cbranch_scc1 L_lcd18
s_sleep 1
s_branch L_lc17
L_lcd18:
s_add_u32 m0, s68, 0
s_mov_b32 s64, 0
buffer_load_dwordx4 v14, s[52:55], s64 offen sc1 lds
s_add_u32 m0, s68, 1024
s_mov_b32 s64, 262144
buffer_load_dwordx4 v14, s[52:55], s64 offen sc1 lds
s_add_u32 m0, s68, 2048
s_mov_b32 s64, 524288
buffer_load_dwordx4 v14, s[52:55], s64 offen sc1 lds
s_add_u32 m0, s68, 3072
s_mov_b32 s64, 786432
buffer_load_dwordx4 v14, s[52:55], s64 offen sc1 lds
s_movk_i32 s64, 0x1000
buffer_load_dwordx4 v[104:107], v2, s[48:51], 0 offen offset:0 sc1
buffer_load_dwordx4 v[108:111], v2, s[48:51], 0 offen offset:1024 sc1
buffer_load_dwordx4 v[112:115], v2, s[48:51], 0 offen offset:2048 sc1
buffer_load_dwordx4 v[116:119], v2, s[48:51], 0 offen offset:3072 sc1
buffer_load_dwordx4 v[120:123], v2, s[48:51], s64 offen offset:0 sc1
buffer_load_dwordx4 v[124:127], v2, s[48:51], s64 offen offset:1024 sc1
buffer_load_dwordx4 v[128:131], v2, s[48:51], s64 offen offset:2048 sc1
buffer_load_dwordx4 v[132:135], v2, s[48:51], s64 offen offset:3072 sc1
s_waitcnt vmcnt(8)
v_mov_b32 v190, 6
s_mov_b64 exec, 1
ds_write_b32 v185, v190
s_mov_b64 exec, -1
L_lc19:
ds_read_b128 v[186:189], v184
s_waitcnt lgkmcnt(0)
v_min3_u32 v186, v186, v187, v188
v_min_u32 v186, v186, v189
s_nop 0
v_readfirstlane_b32 s92, v186
s_nop 0
s_cmp_ge_u32 s92, 6
s_cbranch_scc1 L_lcd20
s_sleep 1
s_branch L_lc19
L_lcd20:
ds_read_b128 v[72:75], v15 offset:0
ds_read_b128 v[76:79], v15 offset:4096
ds_read_b128 v[80:83], v15 offset:8192
ds_read_b128 v[84:87], v15 offset:12288
s_waitcnt lgkmcnt(0)
v_mov_b32 v190, 7
s_mov_b64 exec, 1
ds_write_b32 v185, v190
s_mov_b64 exec, -1
s_lshl_b32 s64, s61, 31
s_or_b32 s64, s64, s62
L_fft21:
v_xor_b32 v24, s64, v72
v_xor_b32 v25, s64, v73
v_xor_b32 v26, s64, v74
v_xor_b32 v27, s64, v75
v_xor_b32 v28, s64, v76
v_xor_b32 v29, s64, v77
v_xor_b32 v30, s64, v78
v_xor_b32 v31, s64, v79
v_xor_b32 v32, s64, v80
v_xor_b32 v33, s64, v81
v_xor_b32 v34, s64, v82
v_xor_b32 v35, s64, v83
v_xor_b32 v36, s64, v84
v_xor_b32 v37, s64, v85
v_xor_b32 v38, s64, v86
v_xor_b32 v39, s64, v87
v_mfma_f32_32x32x16_bf16 v[40:55], v[24:27], v[192:195], 0
v_mfma_f32_32x32x16_bf16 v[40:55], v[28:31], v[196:199], v[40:55]
v_mfma_f32_32x32x16_bf16 v[40:55], v[32:35], v[200:203], v[40:55]
v_mfma_f32_32x32x16_bf16 v[40:55], v[36:39], v[204:207], v[40:55]
v_mfma_f32_32x32x16_bf16 v[56:71], v[24:27], v[208:211], 0
v_mfma_f32_32x32x16_bf16 v[56:71], v[28:31], v[212:215], v[56:71]
v_mfma_f32_32x32x16_bf16 v[56:71], v[32:35], v[216:219], v[56:71]
v_mfma_f32_32x32x16_bf16 v[56:71], v[36:39], v[220:223], v[56:71]
s_nop 7
v_mul_f32 v168, v40, v224
v_mul_f32 v169, v40, v240
s_nop 1
v_fma_f32 v168, -v56, v240, v168
v_fmac_f32 v169, v56, v224
v_cvt_pk_bf16_f32 v24, v168, v169
v_mul_f32 v170, v41, v225
v_mul_f32 v171, v41, v241
v_fma_f32 v170, -v57, v241, v170
v_fmac_f32 v171, v57, v225
v_cvt_pk_bf16_f32 v25, v170, v171
v_mul_f32 v172, v42, v226
v_mul_f32 v173, v42, v242
v_fma_f32 v172, -v58, v242, v172
v_fmac_f32 v173, v58, v226
v_cvt_pk_bf16_f32 v26, v172, v173
v_mul_f32 v174, v43, v227
v_mul_f32 v175, v43, v243
v_fma_f32 v174, -v59, v243, v174
v_fmac_f32 v175, v59, v227
v_cvt_pk_bf16_f32 v27, v174, v175
v_mul_f32 v168, v44, v228
v_mul_f32 v169, v44, v244
v_fma_f32 v168, -v60, v244, v168
v_fmac_f32 v169, v60, v228
v_cvt_pk_bf16_f32 v28, v168, v169
v_mul_f32 v170, v45, v229
v_mul_f32 v171, v45, v245
v_fma_f32 v170, -v61, v245, v170
v_fmac_f32 v171, v61, v229
v_cvt_pk_bf16_f32 v29, v170, v171
v_mul_f32 v172, v46, v230
v_mul_f32 v173, v46, v246
v_fma_f32 v172, -v62, v246, v172
v_fmac_f32 v173, v62, v230
v_cvt_pk_bf16_f32 v30, v172, v173
v_mul_f32 v174, v47, v231
v_mul_f32 v175, v47, v247
v_fma_f32 v174, -v63, v247, v174
v_fmac_f32 v175, v63, v231
v_cvt_pk_bf16_f32 v31, v174, v175
v_mul_f32 v168, v48, v232
v_mul_f32 v169, v48, v248
v_fma_f32 v168, -v64, v248, v168
v_fmac_f32 v169, v64, v232
v_cvt_pk_bf16_f32 v32, v168, v169
v_mul_f32 v170, v49, v233
v_mul_f32 v171, v49, v249
v_fma_f32 v170, -v65, v249, v170
v_fmac_f32 v171, v65, v233
v_cvt_pk_bf16_f32 v33, v170, v171
v_mul_f32 v172, v50, v234
v_mul_f32 v173, v50, v250
v_fma_f32 v172, -v66, v250, v172
v_fmac_f32 v173, v66, v234
v_cvt_pk_bf16_f32 v34, v172, v173
v_mul_f32 v174, v51, v235
v_mul_f32 v175, v51, v251
v_fma_f32 v174, -v67, v251, v174
v_fmac_f32 v175, v67, v235
v_cvt_pk_bf16_f32 v35, v174, v175
v_mul_f32 v168, v52, v236
v_mul_f32 v169, v52, v252
v_fma_f32 v168, -v68, v252, v168
v_fmac_f32 v169, v68, v236
v_cvt_pk_bf16_f32 v36, v168, v169
v_mul_f32 v170, v53, v237
v_mul_f32 v171, v53, v253
v_fma_f32 v170, -v69, v253, v170
v_fmac_f32 v171, v69, v237
v_cvt_pk_bf16_f32 v37, v170, v171
v_mul_f32 v172, v54, v238
v_mul_f32 v173, v54, v254
v_fma_f32 v172, -v70, v254, v172
v_fmac_f32 v173, v70, v238
v_cvt_pk_bf16_f32 v38, v172, v173
v_mul_f32 v174, v55, v239
v_mul_f32 v175, v55, v255
v_fma_f32 v174, -v71, v255, v174
v_fmac_f32 v175, v71, v239
v_cvt_pk_bf16_f32 v39, v174, v175
v_mfma_f32_32x32x16_bf16 v[40:55], v[192:195], v[24:27], 0
v_mfma_f32_32x32x16_bf16 v[40:55], v[196:199], v[28:31], v[40:55]
v_mfma_f32_32x32x16_bf16 v[40:55], v[200:203], v[32:35], v[40:55]
v_mfma_f32_32x32x16_bf16 v[40:55], v[204:207], v[36:39], v[40:55]
v_mfma_f32_32x32x16_bf16 v[56:71], v[208:211], v[24:27], 0
v_mfma_f32_32x32x16_bf16 v[56:71], v[212:215], v[28:31], v[56:71]
v_mfma_f32_32x32x16_bf16 v[56:71], v[216:219], v[32:35], v[56:71]
v_mfma_f32_32x32x16_bf16 v[56:71], v[220:223], v[36:39], v[56:71]
L_lc23:
ds_read_b128 v[186:189], v184
s_waitcnt lgkmcnt(0)
v_min3_u32 v186, v186, v187, v188
v_min_u32 v186, v186, v189
s_nop 0
v_readfirstlane_b32 s92, v186
s_nop 0
s_cmp_ge_u32 s92, 7
s_cbranch_scc1 L_lcd24
s_sleep 1
s_branch L_lc23
L_lcd24:
s_cmp_eq_u32 s61, 2
s_cbranch_scc1 L_nwr22
ds_write_b128 v16, v[40:43] offset:0
ds_write_b128 v16, v[44:47] offset:1024
ds_write_b128 v16, v[48:51] offset:2048
ds_write_b128 v16, v[52:55] offset:3072
ds_write_b128 v16, v[56:59] offset:4096
ds_write_b128 v16, v[60:63] offset:5120
ds_write_b128 v16, v[64:67] offset:6144
ds_write_b128 v16, v[68:71] offset:7168
s_cmp_eq_u32 s61, 0
s_cbranch_scc1 L_nwr22
s_mov_b32 s61, 2
s_mov_b32 s64, 0
s_branch L_fft21
L_nwr22:
s_waitcnt lgkmcnt(0)
v_mov_b32 v190, 8
s_mov_b64 exec, 1
ds_write_b32 v185, v190
s_mov_b64 exec, -1
L_lc25:
ds_read_b128 v[186:189], v184
s_waitcnt lgkmcnt(0)
v_min3_u32 v186, v186, v187, v188
v_min_u32 v186, v186, v189
s_nop 0
v_readfirstlane_b32 s92, v186
s_nop 0
s_cmp_ge_u32 s92, 8
s_cbranch_scc1 L_lcd26
s_sleep 1
s_branch L_lc25
L_lcd26:
ds_read_b128 v[72:75], v17 offset:0
ds_read_b128 v[76:79], v17 offset:1024
ds_read_b128 v[80:83], v17 offset:2048
ds_read_b128 v[84:87], v17 offset:3072
ds_read_b128 v[88:91], v17 offset:4096
ds_read_b128 v[92:95], v17 offset:5120
ds_read_b128 v[96:99], v17 offset:6144
ds_read_b128 v[100:103], v17 offset:7168
s_waitcnt vmcnt(0) lgkmcnt(0)
v_mov_b32 v190, 9
s_mov_b64 exec, 1
ds_write_b32 v185, v190
s_mov_b64 exec, -1
v_lshlrev_b32 v168, 16, v104
v_and_b32 v169, 0xffff0000, v104
v_lshlrev_b32 v170, 16, v105
v_and_b32 v171, 0xffff0000, v105
v_add_f32 v172, v168, v170
v_add_f32 v173, v169, v171
v_sub_f32 v168, v168, v170
v_sub_f32 v169, v169, v171
v_mul_f32 v170, v152, v40
v_mul_f32 v171, v152, v56
v_mul_f32 v174, v172, v40
v_mul_f32 v175, v172, v56
v_fma_f32 v170, -v136, v88, v170
v_fmac_f32 v171, v136, v72
v_fma_f32 v174, -v173, v56, v174
v_fmac_f32 v175, v173, v40
v_fmac_f32 v174, v168, v170
v_fmac_f32 v175, v168, v171
v_fma_f32 v174, -v169, v171, v174
v_fmac_f32 v175, v169, v170
v_cvt_pk_bf16_f32 v24, v175, v174
v_lshlrev_b32 v176, 16, v106
v_and_b32 v177, 0xffff0000, v106
v_lshlrev_b32 v178, 16, v107
v_and_b32 v179, 0xffff0000, v107
v_add_f32 v180, v176, v178
v_add_f32 v181, v177, v179
v_sub_f32 v176, v176, v178
v_sub_f32 v177, v177, v179
v_mul_f32 v178, v153, v41
v_mul_f32 v179, v153, v57
v_mul_f32 v182, v180, v41
v_mul_f32 v183, v180, v57
v_fma_f32 v178, -v137, v89, v178
v_fmac_f32 v179, v137, v73
v_fma_f32 v182, -v181, v57, v182
v_fmac_f32 v183, v181, v41
v_fmac_f32 v182, v176, v178
v_fmac_f32 v183, v176, v179
v_fma_f32 v182, -v177, v179, v182
v_fmac_f32 v183, v177, v178
v_cvt_pk_bf16_f32 v25, v183, v182
v_lshlrev_b32 v168, 16, v108
v_and_b32 v169, 0xffff0000, v108
v_lshlrev_b32 v170, 16, v109
v_and_b32 v171, 0xffff0000, v109
v_add_f32 v172, v168, v170
v_add_f32 v173, v169, v171
v_sub_f32 v168, v168, v170
v_sub_f32 v169, v169, v171
v_mul_f32 v170, v154, v42
v_mul_f32 v171, v154, v58
v_mul_f32 v174, v172, v42
v_mul_f32 v175, v172, v58
v_fma_f32 v170, -v138, v90, v170
v_fmac_f32 v171, v138, v74
v_fma_f32 v174, -v173, v58, v174
v_fmac_f32 v175, v173, v42
v_fmac_f32 v174, v168, v170
v_fmac_f32 v175, v168, v171
v_fma_f32 v174, -v169, v171, v174
v_fmac_f32 v175, v169, v170
v_cvt_pk_bf16_f32 v26, v175, v174
v_lshlrev_b32 v176, 16, v110
v_and_b32 v177, 0xffff0000, v110
v_lshlrev_b32 v178, 16, v111
v_and_b32 v179, 0xffff0000, v111
v_add_f32 v180, v176, v178
v_add_f32 v181, v177, v179
v_sub_f32 v176, v176, v178
v_sub_f32 v177, v177, v179
v_mul_f32 v178, v155, v43
v_mul_f32 v179, v155, v59
v_mul_f32 v182, v180, v43
v_mul_f32 v183, v180, v59
v_fma_f32 v178, -v139, v91, v178
v_fmac_f32 v179, v139, v75
v_fma_f32 v182, -v181, v59, v182
v_fmac_f32 v183, v181, v43
v_fmac_f32 v182, v176, v178
v_fmac_f32 v183, v176, v179
v_fma_f32 v182, -v177, v179, v182
v_fmac_f32 v183, v177, v178
v_cvt_pk_bf16_f32 v27, v183, v182
v_lshlrev_b32 v168, 16, v112
v_and_b32 v169, 0xffff0000, v112
v_lshlrev_b32 v170, 16, v113
v_and_b32 v171, 0xffff0000, v113
v_add_f32 v172, v168, v170
v_add_f32 v173, v169, v171
v_sub_f32 v168, v168, v170
v_sub_f32 v169, v169, v171
v_mul_f32 v170, v156, v44
v_mul_f32 v171, v156, v60
v_mul_f32 v174, v172, v44
v_mul_f32 v175, v172, v60
v_fma_f32 v170, -v140, v92, v170
v_fmac_f32 v171, v140, v76
v_fma_f32 v174, -v173, v60, v174
v_fmac_f32 v175, v173, v44
v_fmac_f32 v174, v168, v170
v_fmac_f32 v175, v168, v171
v_fma_f32 v174, -v169, v171, v174
v_fmac_f32 v175, v169, v170
v_cvt_pk_bf16_f32 v28, v175, v174
v_lshlrev_b32 v176, 16, v114
v_and_b32 v177, 0xffff0000, v114
v_lshlrev_b32 v178, 16, v115
v_and_b32 v179, 0xffff0000, v115
v_add_f32 v180, v176, v178
v_add_f32 v181, v177, v179
v_sub_f32 v176, v176, v178
v_sub_f32 v177, v177, v179
v_mul_f32 v178, v157, v45
v_mul_f32 v179, v157, v61
v_mul_f32 v182, v180, v45
v_mul_f32 v183, v180, v61
v_fma_f32 v178, -v141, v93, v178
v_fmac_f32 v179, v141, v77
v_fma_f32 v182, -v181, v61, v182
v_fmac_f32 v183, v181, v45
v_fmac_f32 v182, v176, v178
v_fmac_f32 v183, v176, v179
v_fma_f32 v182, -v177, v179, v182
v_fmac_f32 v183, v177, v178
v_cvt_pk_bf16_f32 v29, v183, v182
v_lshlrev_b32 v168, 16, v116
v_and_b32 v169, 0xffff0000, v116
v_lshlrev_b32 v170, 16, v117
v_and_b32 v171, 0xffff0000, v117
v_add_f32 v172, v168, v170
v_add_f32 v173, v169, v171
v_sub_f32 v168, v168, v170
v_sub_f32 v169, v169, v171
v_mul_f32 v170, v158, v46
v_mul_f32 v171, v158, v62
v_mul_f32 v174, v172, v46
v_mul_f32 v175, v172, v62
v_fma_f32 v170, -v142, v94, v170
v_fmac_f32 v171, v142, v78
v_fma_f32 v174, -v173, v62, v174
v_fmac_f32 v175, v173, v46
v_fmac_f32 v174, v168, v170
v_fmac_f32 v175, v168, v171
v_fma_f32 v174, -v169, v171, v174
v_fmac_f32 v175, v169, v170
v_cvt_pk_bf16_f32 v30, v175, v174
v_lshlrev_b32 v176, 16, v118
v_and_b32 v177, 0xffff0000, v118
v_lshlrev_b32 v178, 16, v119
v_and_b32 v179, 0xffff0000, v119
v_add_f32 v180, v176, v178
v_add_f32 v181, v177, v179
v_sub_f32 v176, v176, v178
v_sub_f32 v177, v177, v179
v_mul_f32 v178, v159, v47
v_mul_f32 v179, v159, v63
v_mul_f32 v182, v180, v47
v_mul_f32 v183, v180, v63
v_fma_f32 v178, -v143, v95, v178
v_fmac_f32 v179, v143, v79
v_fma_f32 v182, -v181, v63, v182
v_fmac_f32 v183, v181, v47
v_fmac_f32 v182, v176, v178
v_fmac_f32 v183, v176, v179
v_fma_f32 v182, -v177, v179, v182
v_fmac_f32 v183, v177, v178
v_cvt_pk_bf16_f32 v31, v183, v182
v_lshlrev_b32 v168, 16, v120
v_and_b32 v169, 0xffff0000, v120
v_lshlrev_b32 v170, 16, v121
v_and_b32 v171, 0xffff0000, v121
v_add_f32 v172, v168, v170
v_add_f32 v173, v169, v171
v_sub_f32 v168, v168, v170
v_sub_f32 v169, v169, v171
v_mul_f32 v170, v160, v48
v_mul_f32 v171, v160, v64
v_mul_f32 v174, v172, v48
v_mul_f32 v175, v172, v64
v_fma_f32 v170, -v144, v96, v170
v_fmac_f32 v171, v144, v80
v_fma_f32 v174, -v173, v64, v174
v_fmac_f32 v175, v173, v48
v_fmac_f32 v174, v168, v170
v_fmac_f32 v175, v168, v171
v_fma_f32 v174, -v169, v171, v174
v_fmac_f32 v175, v169, v170
v_cvt_pk_bf16_f32 v32, v175, v174
v_lshlrev_b32 v176, 16, v122
v_and_b32 v177, 0xffff0000, v122
v_lshlrev_b32 v178, 16, v123
v_and_b32 v179, 0xffff0000, v123
v_add_f32 v180, v176, v178
v_add_f32 v181, v177, v179
v_sub_f32 v176, v176, v178
v_sub_f32 v177, v177, v179
v_mul_f32 v178, v161, v49
v_mul_f32 v179, v161, v65
v_mul_f32 v182, v180, v49
v_mul_f32 v183, v180, v65
v_fma_f32 v178, -v145, v97, v178
v_fmac_f32 v179, v145, v81
v_fma_f32 v182, -v181, v65, v182
v_fmac_f32 v183, v181, v49
v_fmac_f32 v182, v176, v178
v_fmac_f32 v183, v176, v179
v_fma_f32 v182, -v177, v179, v182
v_fmac_f32 v183, v177, v178
v_cvt_pk_bf16_f32 v33, v183, v182
v_lshlrev_b32 v168, 16, v124
v_and_b32 v169, 0xffff0000, v124
v_lshlrev_b32 v170, 16, v125
v_and_b32 v171, 0xffff0000, v125
v_add_f32 v172, v168, v170
v_add_f32 v173, v169, v171
v_sub_f32 v168, v168, v170
v_sub_f32 v169, v169, v171
v_mul_f32 v170, v162, v50
v_mul_f32 v171, v162, v66
v_mul_f32 v174, v172, v50
v_mul_f32 v175, v172, v66
v_fma_f32 v170, -v146, v98, v170
v_fmac_f32 v171, v146, v82
v_fma_f32 v174, -v173, v66, v174
v_fmac_f32 v175, v173, v50
v_fmac_f32 v174, v168, v170
v_fmac_f32 v175, v168, v171
v_fma_f32 v174, -v169, v171, v174
v_fmac_f32 v175, v169, v170
v_cvt_pk_bf16_f32 v34, v175, v174
v_lshlrev_b32 v176, 16, v126
v_and_b32 v177, 0xffff0000, v126
v_lshlrev_b32 v178, 16, v127
v_and_b32 v179, 0xffff0000, v127
v_add_f32 v180, v176, v178
v_add_f32 v181, v177, v179
v_sub_f32 v176, v176, v178
v_sub_f32 v177, v177, v179
v_mul_f32 v178, v163, v51
v_mul_f32 v179, v163, v67
v_mul_f32 v182, v180, v51
v_mul_f32 v183, v180, v67
v_fma_f32 v178, -v147, v99, v178
v_fmac_f32 v179, v147, v83
v_fma_f32 v182, -v181, v67, v182
v_fmac_f32 v183, v181, v51
v_fmac_f32 v182, v176, v178
v_fmac_f32 v183, v176, v179
v_fma_f32 v182, -v177, v179, v182
v_fmac_f32 v183, v177, v178
v_cvt_pk_bf16_f32 v35, v183, v182
v_lshlrev_b32 v168, 16, v128
v_and_b32 v169, 0xffff0000, v128
v_lshlrev_b32 v170, 16, v129
v_and_b32 v171, 0xffff0000, v129
v_add_f32 v172, v168, v170
v_add_f32 v173, v169, v171
v_sub_f32 v168, v168, v170
v_sub_f32 v169, v169, v171
v_mul_f32 v170, v164, v52
v_mul_f32 v171, v164, v68
v_mul_f32 v174, v172, v52
v_mul_f32 v175, v172, v68
v_fma_f32 v170, -v148, v100, v170
v_fmac_f32 v171, v148, v84
v_fma_f32 v174, -v173, v68, v174
v_fmac_f32 v175, v173, v52
v_fmac_f32 v174, v168, v170
v_fmac_f32 v175, v168, v171
v_fma_f32 v174, -v169, v171, v174
v_fmac_f32 v175, v169, v170
v_cvt_pk_bf16_f32 v36, v175, v174
v_lshlrev_b32 v176, 16, v130
v_and_b32 v177, 0xffff0000, v130
v_lshlrev_b32 v178, 16, v131
v_and_b32 v179, 0xffff0000, v131
v_add_f32 v180, v176, v178
v_add_f32 v181, v177, v179
v_sub_f32 v176, v176, v178
v_sub_f32 v177, v177, v179
v_mul_f32 v178, v165, v53
v_mul_f32 v179, v165, v69
v_mul_f32 v182, v180, v53
v_mul_f32 v183, v180, v69
v_fma_f32 v178, -v149, v101, v178
v_fmac_f32 v179, v149, v85
v_fma_f32 v182, -v181, v69, v182
v_fmac_f32 v183, v181, v53
v_fmac_f32 v182, v176, v178
v_fmac_f32 v183, v176, v179
v_fma_f32 v182, -v177, v179, v182
v_fmac_f32 v183, v177, v178
v_cvt_pk_bf16_f32 v37, v183, v182
v_lshlrev_b32 v168, 16, v132
v_and_b32 v169, 0xffff0000, v132
v_lshlrev_b32 v170, 16, v133
v_and_b32 v171, 0xffff0000, v133
v_add_f32 v172, v168, v170
v_add_f32 v173, v169, v171
v_sub_f32 v168, v168, v170
v_sub_f32 v169, v169, v171
v_mul_f32 v170, v166, v54
v_mul_f32 v171, v166, v70
v_mul_f32 v174, v172, v54
v_mul_f32 v175, v172, v70
v_fma_f32 v170, -v150, v102, v170
v_fmac_f32 v171, v150, v86
v_fma_f32 v174, -v173, v70, v174
v_fmac_f32 v175, v173, v54
v_fmac_f32 v174, v168, v170
v_fmac_f32 v175, v168, v171
v_fma_f32 v174, -v169, v171, v174
v_fmac_f32 v175, v169, v170
v_cvt_pk_bf16_f32 v38, v175, v174
v_lshlrev_b32 v176, 16, v134
v_and_b32 v177, 0xffff0000, v134
v_lshlrev_b32 v178, 16, v135
v_and_b32 v179, 0xffff0000, v135
v_add_f32 v180, v176, v178
v_add_f32 v181, v177, v179
v_sub_f32 v176, v176, v178
v_sub_f32 v177, v177, v179
v_mul_f32 v178, v167, v55
v_mul_f32 v179, v167, v71
v_mul_f32 v182, v180, v55
v_mul_f32 v183, v180, v71
v_fma_f32 v178, -v151, v103, v178
v_fmac_f32 v179, v151, v87
v_fma_f32 v182, -v181, v71, v182
v_fmac_f32 v183, v181, v55
v_fmac_f32 v182, v176, v178
v_fmac_f32 v183, v176, v179
v_fma_f32 v182, -v177, v179, v182
v_fmac_f32 v183, v177, v178
v_cvt_pk_bf16_f32 v39, v183, v182
v_mfma_f32_32x32x16_bf16 v[40:55], v[24:27], v[192:195], 0
v_mfma_f32_32x32x16_bf16 v[40:55], v[28:31], v[196:199], v[40:55]
v_mfma_f32_32x32x16_bf16 v[40:55], v[32:35], v[200:203], v[40:55]
v_mfma_f32_32x32x16_bf16 v[40:55], v[36:39], v[204:207], v[40:55]
v_mfma_f32_32x32x16_bf16 v[56:71], v[24:27], v[208:211], 0
v_mfma_f32_32x32x16_bf16 v[56:71], v[28:31], v[212:215], v[56:71]
v_mfma_f32_32x32x16_bf16 v[56:71], v[32:35], v[216:219], v[56:71]
v_mfma_f32_32x32x16_bf16 v[56:71], v[36:39], v[220:223], v[56:71]
s_nop 7
v_mul_f32 v168, v40, v224
v_mul_f32 v169, v40, v240
s_nop 1
v_fma_f32 v168, -v56, v240, v168
v_fmac_f32 v169, v56, v224
v_cvt_pk_bf16_f32 v24, v168, v169
v_mul_f32 v170, v41, v225
v_mul_f32 v171, v41, v241
v_fma_f32 v170, -v57, v241, v170
v_fmac_f32 v171, v57, v225
v_cvt_pk_bf16_f32 v25, v170, v171
v_mul_f32 v172, v42, v226
v_mul_f32 v173, v42, v242
v_fma_f32 v172, -v58, v242, v172
v_fmac_f32 v173, v58, v226
v_cvt_pk_bf16_f32 v26, v172, v173
v_mul_f32 v174, v43, v227
v_mul_f32 v175, v43, v243
v_fma_f32 v174, -v59, v243, v174
v_fmac_f32 v175, v59, v227
v_cvt_pk_bf16_f32 v27, v174, v175
v_mul_f32 v168, v44, v228
v_mul_f32 v169, v44, v244
v_fma_f32 v168, -v60, v244, v168
v_fmac_f32 v169, v60, v228
v_cvt_pk_bf16_f32 v28, v168, v169
v_mul_f32 v170, v45, v229
v_mul_f32 v171, v45, v245
v_fma_f32 v170, -v61, v245, v170
v_fmac_f32 v171, v61, v229
v_cvt_pk_bf16_f32 v29, v170, v171
v_mul_f32 v172, v46, v230
v_mul_f32 v173, v46, v246
v_fma_f32 v172, -v62, v246, v172
v_fmac_f32 v173, v62, v230
v_cvt_pk_bf16_f32 v30, v172, v173
v_mul_f32 v174, v47, v231
v_mul_f32 v175, v47, v247
v_fma_f32 v174, -v63, v247, v174
v_fmac_f32 v175, v63, v231
v_cvt_pk_bf16_f32 v31, v174, v175
v_mul_f32 v168, v48, v232
v_mul_f32 v169, v48, v248
v_fma_f32 v168, -v64, v248, v168
v_fmac_f32 v169, v64, v232
v_cvt_pk_bf16_f32 v32, v168, v169
v_mul_f32 v170, v49, v233
v_mul_f32 v171, v49, v249
v_fma_f32 v170, -v65, v249, v170
v_fmac_f32 v171, v65, v233
v_cvt_pk_bf16_f32 v33, v170, v171
v_mul_f32 v172, v50, v234
v_mul_f32 v173, v50, v250
v_fma_f32 v172, -v66, v250, v172
v_fmac_f32 v173, v66, v234
v_cvt_pk_bf16_f32 v34, v172, v173
v_mul_f32 v174, v51, v235
v_mul_f32 v175, v51, v251
v_fma_f32 v174, -v67, v251, v174
v_fmac_f32 v175, v67, v235
v_cvt_pk_bf16_f32 v35, v174, v175
v_mul_f32 v168, v52, v236
v_mul_f32 v169, v52, v252
v_fma_f32 v168, -v68, v252, v168
v_fmac_f32 v169, v68, v236
v_cvt_pk_bf16_f32 v36, v168, v169
v_mul_f32 v170, v53, v237
v_mul_f32 v171, v53, v253
v_fma_f32 v170, -v69, v253, v170
v_fmac_f32 v171, v69, v237
v_cvt_pk_bf16_f32 v37, v170, v171
v_mul_f32 v172, v54, v238
v_mul_f32 v173, v54, v254
v_fma_f32 v172, -v70, v254, v172
v_fmac_f32 v173, v70, v238
v_cvt_pk_bf16_f32 v38, v172, v173
v_mul_f32 v174, v55, v239
v_mul_f32 v175, v55, v255
v_fma_f32 v174, -v71, v255, v174
v_fmac_f32 v175, v71, v239
v_cvt_pk_bf16_f32 v39, v174, v175
v_mfma_f32_32x32x16_bf16 v[40:55], v[192:195], v[24:27], 0
v_mfma_f32_32x32x16_bf16 v[40:55], v[196:199], v[28:31], v[40:55]
v_mfma_f32_32x32x16_bf16 v[40:55], v[200:203], v[32:35], v[40:55]
v_mfma_f32_32x32x16_bf16 v[40:55], v[204:207], v[36:39], v[40:55]
v_mfma_f32_32x32x16_bf16 v[56:71], v[208:211], v[24:27], 0
v_mfma_f32_32x32x16_bf16 v[56:71], v[212:215], v[28:31], v[56:71]
v_mfma_f32_32x32x16_bf16 v[56:71], v[216:219], v[32:35], v[56:71]
v_mfma_f32_32x32x16_bf16 v[56:71], v[220:223], v[36:39], v[56:71]
s_lshr_b32 s64, s62, 16
L_lc27:
ds_read_b128 v[186:189], v184
s_waitcnt lgkmcnt(0)
v_min3_u32 v186, v186, v187, v188
v_min_u32 v186, v186, v189
s_nop 0
v_readfirstlane_b32 s92, v186
s_nop 0
s_cmp_ge_u32 s92, 9
s_cbranch_scc1 L_lcd28
s_sleep 1
s_branch L_lc27
L_lcd28:
s_nop 1
v_cvt_pk_bf16_f32 v24, v40, v56
v_xor_b32 v24, s64, v24
v_cvt_pk_bf16_f32 v25, v41, v57
v_xor_b32 v25, s64, v25
v_cvt_pk_bf16_f32 v26, v42, v58
v_xor_b32 v26, s64, v26
v_cvt_pk_bf16_f32 v27, v43, v59
v_xor_b32 v27, s64, v27
ds_write_b128 v15, v[24:27] offset:0
v_cvt_pk_bf16_f32 v28, v44, v60
v_xor_b32 v28, s64, v28
v_cvt_pk_bf16_f32 v29, v45, v61
v_xor_b32 v29, s64, v29
v_cvt_pk_bf16_f32 v30, v46, v62
v_xor_b32 v30, s64, v30
v_cvt_pk_bf16_f32 v31, v47, v63
v_xor_b32 v31, s64, v31
ds_write_b128 v15, v[28:31] offset:4096
v_cvt_pk_bf16_f32 v32, v48, v64
v_xor_b32 v32, s64, v32
v_cvt_pk_bf16_f32 v33, v49, v65
v_xor_b32 v33, s64, v33
v_cvt_pk_bf16_f32 v34, v50, v66
v_xor_b32 v34, s64, v34
v_cvt_pk_bf16_f32 v35, v51, v67
v_xor_b32 v35, s64, v35
ds_write_b128 v15, v[32:35] offset:8192
v_cvt_pk_bf16_f32 v36, v52, v68
v_xor_b32 v36, s64, v36
v_cvt_pk_bf16_f32 v37, v53, v69
v_xor_b32 v37, s64, v37
v_cvt_pk_bf16_f32 v38, v54, v70
v_xor_b32 v38, s64, v38
v_cvt_pk_bf16_f32 v39, v55, v71
v_xor_b32 v39, s64, v39
ds_write_b128 v15, v[36:39] offset:12288
s_waitcnt lgkmcnt(0)
v_mov_b32 v190, 10
s_mov_b64 exec, 1
ds_write_b32 v185, v190
s_mov_b64 exec, -1
L_lc29:
ds_read_b128 v[186:189], v184
s_waitcnt lgkmcnt(0)
v_min3_u32 v186, v186, v187, v188
v_min_u32 v186, v186, v189
s_nop 0
v_readfirstlane_b32 s92, v186
s_nop 0
s_cmp_ge_u32 s92, 10
s_cbranch_scc1 L_lcd30
s_sleep 1
s_branch L_lc29
L_lcd30:
ds_read_b128 v[24:27], v18 offset:0
ds_read_b128 v[28:31], v18 offset:1024
ds_read_b128 v[32:35], v18 offset:2048
ds_read_b128 v[36:39], v18 offset:3072
s_mov_b32 s64, 0
s_waitcnt lgkmcnt(3)
buffer_store_dwordx4 v[24:27], v14, s[56:59], s64 offen sc1
s_mov_b32 s64, 262144
s_waitcnt lgkmcnt(2)
buffer_store_dwordx4 v[28:31], v14, s[56:59], s64 offen sc1
s_mov_b32 s64, 524288
s_waitcnt lgkmcnt(1)
buffer_store_dwordx4 v[32:35], v14, s[56:59], s64 offen sc1
s_mov_b32 s64, 786432
s_waitcnt lgkmcnt(0)
buffer_store_dwordx4 v[36:39], v14, s[56:59], s64 offen sc1
s_lshl_b32 s64, s67, 14
s_add_u32 s40, s28, s64
s_addc_u32 s41, s29, 0
s_mov_b32 s42, 16384
s_mov_b32 s43, 0x20000
v_and_b32 v8, 31, v1
v_lshrrev_b32 v9, 5, v1
v_lshlrev_b32 v14, 2, v8
v_lshl_add_u32 v14, v9, 9, v14
s_mov_b32 s64, 0x35000000
v_mul_f32 v224, s64, v224
v_mul_f32 v225, s64, v225
v_mul_f32 v226, s64, v226
v_mul_f32 v227, s64, v227
v_mul_f32 v228, s64, v228
v_mul_f32 v229, s64, v229
v_mul_f32 v230, s64, v230
v_mul_f32 v231, s64, v231
v_mul_f32 v232, s64, v232
v_mul_f32 v233, s64, v233
v_mul_f32 v234, s64, v234
v_mul_f32 v235, s64, v235
v_mul_f32 v236, s64, v236
v_mul_f32 v237, s64, v237
v_mul_f32 v238, s64, v238
v_mul_f32 v239, s64, v239
v_mul_f32 v240, s64, v240
v_mul_f32 v241, s64, v241
v_mul_f32 v242, s64, v242
v_mul_f32 v243, s64, v243
v_mul_f32 v244, s64, v244
v_mul_f32 v245, s64, v245
v_mul_f32 v246, s64, v246
v_mul_f32 v247, s64, v247
v_mul_f32 v248, s64, v248
v_mul_f32 v249, s64, v249
v_mul_f32 v250, s64, v250
v_mul_f32 v251, s64, v251
v_mul_f32 v252, s64, v252
v_mul_f32 v253, s64, v253
v_mul_f32 v254, s64, v254
v_mul_f32 v255, s64, v255
s_waitcnt vmcnt(0)
v_mov_b32 v190, 11
s_mov_b64 exec, 1
ds_write_b32 v185, v190
s_mov_b64 exec, -1
s_cmp_lg_u32 s66, 0
s_cbranch_scc1 L_ph31
L_lc32:
ds_read_b128 v[186:189], v184
s_waitcnt lgkmcnt(0)
v_min3_u32 v186, v186, v187, v188
v_min_u32 v186, v186, v189
s_nop 0
v_readfirstlane_b32 s92, v186
s_nop 0
s_cmp_ge_u32 s92, 11
s_cbranch_scc1 L_lcd33
s_sleep 1
s_branch L_lc32
L_lcd33:
s_and_b32 s64, s2, 15
s_lshl_b32 s65, s64, 7
s_add_u32 s65, s65, 6144
s_add_u32 s90, s32, s65
s_addc_u32 s91, s33, 0
s_mov_b32 s65, 1
s_atomic_add s65, s[90:91], 0x0 glc
s_lshl_b32 s64, s64, 2
s_add_u32 s64, s64, 548864
v_lshl_add_u32 v20, v1, 7, s64
v_mov_b32 v21, s37
s_and_b32 s64, s2, 63
s_lshl_b32 s64, s64, 7
s_add_u32 s64, s64, 548864
s_waitcnt lgkmcnt(0)
s_cmp_lg_u32 s65, 15
s_cbranch_scc1 L_sg34
global_store_dword v20, v21, s[32:33] sc1
L_sg34:
s_add_u32 s90, s32, s64
s_addc_u32 s91, s33, 0
s_mov_b32 s64, s37
s_mov_b32 s65, s37
s_mov_b32 s92, 0
s_branch L_sp35
L_nok36:
s_add_u32 s92, s92, 1
s_cmp_ge_u32 s92, 200000
s_cbranch_scc1 L_ph31
s_sleep 2
L_sp35:
s_load_dwordx16 s[4:19], s[90:91], 0x0 glc
s_waitcnt lgkmcnt(0)
s_cmp_eq_u64 s[4:5], s[64:65]
s_cbranch_scc0 L_nok36
s_cmp_eq_u64 s[6:7], s[64:65]
s_cbranch_scc0 L_nok36
s_cmp_eq_u64 s[8:9], s[64:65]
s_cbranch_scc0 L_nok36
s_cmp_eq_u64 s[10:11], s[64:65]
s_cbranch_scc0 L_nok36
s_cmp_eq_u64 s[12:13], s[64:65]
s_cbranch_scc0 L_nok36
s_cmp_eq_u64 s[14:15], s[64:65]
s_cbranch_scc0 L_nok36
s_cmp_eq_u64 s[16:17], s[64:65]
s_cbranch_scc0 L_nok36
s_cmp_eq_u64 s[18:19], s[64:65]
s_cbranch_scc0 L_nok36
L_ph31:
v_mov_b32 v190, 12
s_mov_b64 exec, 1
ds_write_b32 v185, v190
s_mov_b64 exec, -1
L_lc37:
ds_read_b128 v[186:189], v184
s_waitcnt lgkmcnt(0)
v_min3_u32 v186, v186, v187, v188
v_min_u32 v186, v186, v189
s_nop 0
v_readfirstlane_b32 s92, v186
s_nop 0
s_cmp_ge_u32 s92, 12
s_cbranch_scc1 L_lcd38
s_sleep 1
s_branch L_lc37
L_lcd38:
s_mov_b32 m0, s68
s_nop 0
buffer_load_dwordx4 v7, s[44:47], 0 offen offset:0 sc1 lds
buffer_load_dwordx4 v7, s[44:47], 0 offen offset:1024 sc1 lds
buffer_load_dwordx4 v7, s[44:47], 0 offen offset:2048 sc1 lds
buffer_load_dwordx4 v7, s[44:47], 0 offen offset:3072 sc1 lds
s_waitcnt vmcnt(0)
v_mov_b32 v190, 13
s_mov_b64 exec, 1
ds_write_b32 v185, v190
s_mov_b64 exec, -1
L_lc39:
ds_read_b128 v[186:189], v184
s_waitcnt lgkmcnt(0)
v_min3_u32 v186, v186, v187, v188
v_min_u32 v186, v186, v189
s_nop 0
v_readfirstlane_b32 s92, v186
s_nop 0
s_cmp_ge_u32 s92, 13
s_cbranch_scc1 L_lcd40
s_sleep 1
s_branch L_lc39
L_lcd40:
ds_read_b32 v24, v4 offset:0
ds_read_b32 v25, v4 offset:1024
ds_read_b32 v26, v4 offset:2048
ds_read_b32 v27, v4 offset:3072
ds_read_b32 v28, v4 offset:8192
ds_read_b32 v29, v4 offset:9216
ds_read_b32 v30, v4 offset:10240
ds_read_b32 v31, v4 offset:11264
ds_read_b32 v32, v6 offset:0
ds_read_b32 v33, v5 offset:10240
ds_read_b32 v34, v5 offset:9216
ds_read_b32 v35, v5 offset:8192
ds_read_b32 v36, v5 offset:3072
ds_read_b32 v37, v5 offset:2048
ds_read_b32 v38, v5 offset:1024
ds_read_b32 v39, v5 offset:0
s_waitcnt lgkmcnt(0)
v_mfma_f32_32x32x16_bf16 v[40:55], v[24:27], v[192:195], 0
v_mfma_f32_32x32x16_bf16 v[40:55], v[28:31], v[196:199], v[40:55]
v_mfma_f32_32x32x16_bf16 v[40:55], v[32:35], v[200:203], v[40:55]
v_mfma_f32_32x32x16_bf16 v[40:55], v[36:39], v[204:207], v[40:55]
v_mfma_f32_32x32x16_bf16 v[56:71], v[24:27], v[208:211], 0
v_mfma_f32_32x32x16_bf16 v[56:71], v[28:31], v[212:215], v[56:71]
v_mfma_f32_32x32x16_bf16 v[56:71], v[32:35], v[216:219], v[56:71]
v_mfma_f32_32x32x16_bf16 v[56:71], v[36:39], v[220:223], v[56:71]
s_nop 7
v_mul_f32 v168, v40, v224
v_mul_f32 v169, v40, v240
s_nop 1
v_fma_f32 v168, -v56, v240, v168
v_fmac_f32 v169, v56, v224
v_cvt_pk_bf16_f32 v24, v168, v169
v_mul_f32 v170, v41, v225
v_mul_f32 v171, v41, v241
v_fma_f32 v170, -v57, v241, v170
v_fmac_f32 v171, v57, v225
v_cvt_pk_bf16_f32 v25, v170, v171
v_mul_f32 v172, v42, v226
v_mul_f32 v173, v42, v242
v_fma_f32 v172, -v58, v242, v172
v_fmac_f32 v173, v58, v226
v_cvt_pk_bf16_f32 v26, v172, v173
v_mul_f32 v174, v43, v227
v_mul_f32 v175, v43, v243
v_fma_f32 v174, -v59, v243, v174
v_fmac_f32 v175, v59, v227
v_cvt_pk_bf16_f32 v27, v174, v175
v_mul_f32 v168, v44, v228
v_mul_f32 v169, v44, v244
v_fma_f32 v168, -v60, v244, v168
v_fmac_f32 v169, v60, v228
v_cvt_pk_bf16_f32 v28, v168, v169
v_mul_f32 v170, v45, v229
v_mul_f32 v171, v45, v245
v_fma_f32 v170, -v61, v245, v170
v_fmac_f32 v171, v61, v229
v_cvt_pk_bf16_f32 v29, v170, v171
v_mul_f32 v172, v46, v230
v_mul_f32 v173, v46, v246
v_fma_f32 v172, -v62, v246, v172
v_fmac_f32 v173, v62, v230
v_cvt_pk_bf16_f32 v30, v172, v173
v_mul_f32 v174, v47, v231
v_mul_f32 v175, v47, v247
v_fma_f32 v174, -v63, v247, v174
v_fmac_f32 v175, v63, v231
v_cvt_pk_bf16_f32 v31, v174, v175
v_mul_f32 v168, v48, v232
v_mul_f32 v169, v48, v248
v_fma_f32 v168, -v64, v248, v168
v_fmac_f32 v169, v64, v232
v_cvt_pk_bf16_f32 v32, v168, v169
v_mul_f32 v170, v49, v233
v_mul_f32 v171, v49, v249
v_fma_f32 v170, -v65, v249, v170
v_fmac_f32 v171, v65, v233
v_cvt_pk_bf16_f32 v33, v170, v171
v_mul_f32 v172, v50, v234
v_mul_f32 v173, v50, v250
v_fma_f32 v172, -v66, v250, v172
v_fmac_f32 v173, v66, v234
v_cvt_pk_bf16_f32 v34, v172, v173
v_mul_f32 v174, v51, v235
v_mul_f32 v175, v51, v251
v_fma_f32 v174, -v67, v251, v174
v_fmac_f32 v175, v67, v235
v_cvt_pk_bf16_f32 v35, v174, v175
v_mul_f32 v168, v52, v236
v_mul_f32 v169, v52, v252
v_fma_f32 v168, -v68, v252, v168
v_fmac_f32 v169, v68, v236
v_cvt_pk_bf16_f32 v36, v168, v169
v_mul_f32 v170, v53, v237
v_mul_f32 v171, v53, v253
v_fma_f32 v170, -v69, v253, v170
v_fmac_f32 v171, v69, v237
v_cvt_pk_bf16_f32 v37, v170, v171
v_mul_f32 v172, v54, v238
v_mul_f32 v173, v54, v254
v_fma_f32 v172, -v70, v254, v172
v_fmac_f32 v173, v70, v238
v_cvt_pk_bf16_f32 v38, v172, v173
v_mul_f32 v174, v55, v239
v_mul_f32 v175, v55, v255
v_fma_f32 v174, -v71, v255, v174
v_fmac_f32 v175, v71, v239
v_cvt_pk_bf16_f32 v39, v174, v175
v_mfma_f32_32x32x16_bf16 v[40:55], v[192:195], v[24:27], 0
v_mfma_f32_32x32x16_bf16 v[40:55], v[196:199], v[28:31], v[40:55]
v_mfma_f32_32x32x16_bf16 v[40:55], v[200:203], v[32:35], v[40:55]
v_mfma_f32_32x32x16_bf16 v[40:55], v[204:207], v[36:39], v[40:55]
v_mfma_f32_32x32x16_bf16 v[56:71], v[208:211], v[24:27], 0
v_mfma_f32_32x32x16_bf16 v[56:71], v[212:215], v[28:31], v[56:71]
v_mfma_f32_32x32x16_bf16 v[56:71], v[216:219], v[32:35], v[56:71]
v_mfma_f32_32x32x16_bf16 v[56:71], v[220:223], v[36:39], v[56:71]
s_movk_i32 s64, 0x2000
s_nop 10
v_cvt_pk_bf16_f32 v73, v56, v40
v_lshlrev_b32 v72, 16, v73
v_and_b32 v73, 0xffff0000, v73
buffer_store_dword v72, v14, s[40:43], 0 offen offset:0
buffer_store_dword v73, v14, s[40:43], s64 offen offset:0
v_cvt_pk_bf16_f32 v75, v57, v41
v_lshlrev_b32 v74, 16, v75
v_and_b32 v75, 0xffff0000, v75
buffer_store_dword v74, v14, s[40:43], 0 offen offset:128
buffer_store_dword v75, v14, s[40:43], s64 offen offset:128
v_cvt_pk_bf16_f32 v77, v58, v42
v_lshlrev_b32 v76, 16, v77
v_and_b32 v77, 0xffff0000, v77
buffer_store_dword v76, v14, s[40:43], 0 offen offset:256
buffer_store_dword v77, v14, s[40:43], s64 offen offset:256
v_cvt_pk_bf16_f32 v79, v59, v43
v_lshlrev_b32 v78, 16, v79
v_and_b32 v79, 0xffff0000, v79
buffer_store_dword v78, v14, s[40:43], 0 offen offset:384
buffer_store_dword v79, v14, s[40:43], s64 offen offset:384
v_cvt_pk_bf16_f32 v81, v60, v44
v_lshlrev_b32 v80, 16, v81
v_and_b32 v81, 0xffff0000, v81
buffer_store_dword v80, v14, s[40:43], 0 offen offset:1024
buffer_store_dword v81, v14, s[40:43], s64 offen offset:1024
v_cvt_pk_bf16_f32 v83, v61, v45
v_lshlrev_b32 v82, 16, v83
v_and_b32 v83, 0xffff0000, v83
buffer_store_dword v82, v14, s[40:43], 0 offen offset:1152
buffer_store_dword v83, v14, s[40:43], s64 offen offset:1152
v_cvt_pk_bf16_f32 v85, v62, v46
v_lshlrev_b32 v84, 16, v85
v_and_b32 v85, 0xffff0000, v85
buffer_store_dword v84, v14, s[40:43], 0 offen offset:1280
buffer_store_dword v85, v14, s[40:43], s64 offen offset:1280
v_cvt_pk_bf16_f32 v87, v63, v47
v_lshlrev_b32 v86, 16, v87
v_and_b32 v87, 0xffff0000, v87
buffer_store_dword v86, v14, s[40:43], 0 offen offset:1408
buffer_store_dword v87, v14, s[40:43], s64 offen offset:1408
v_cvt_pk_bf16_f32 v89, v64, v48
v_lshlrev_b32 v88, 16, v89
v_and_b32 v89, 0xffff0000, v89
buffer_store_dword v88, v14, s[40:43], 0 offen offset:2048
buffer_store_dword v89, v14, s[40:43], s64 offen offset:2048
v_cvt_pk_bf16_f32 v91, v65, v49
v_lshlrev_b32 v90, 16, v91
v_and_b32 v91, 0xffff0000, v91
buffer_store_dword v90, v14, s[40:43], 0 offen offset:2176
buffer_store_dword v91, v14, s[40:43], s64 offen offset:2176
v_cvt_pk_bf16_f32 v93, v66, v50
v_lshlrev_b32 v92, 16, v93
v_and_b32 v93, 0xffff0000, v93
buffer_store_dword v92, v14, s[40:43], 0 offen offset:2304
buffer_store_dword v93, v14, s[40:43], s64 offen offset:2304
v_cvt_pk_bf16_f32 v95, v67, v51
v_lshlrev_b32 v94, 16, v95
v_and_b32 v95, 0xffff0000, v95
buffer_store_dword v94, v14, s[40:43], 0 offen offset:2432
buffer_store_dword v95, v14, s[40:43], s64 offen offset:2432
v_cvt_pk_bf16_f32 v97, v68, v52
v_lshlrev_b32 v96, 16, v97
v_and_b32 v97, 0xffff0000, v97
buffer_store_dword v96, v14, s[40:43], 0 offen offset:3072
buffer_store_dword v97, v14, s[40:43], s64 offen offset:3072
v_cvt_pk_bf16_f32 v99, v69, v53
v_lshlrev_b32 v98, 16, v99
v_and_b32 v99, 0xffff0000, v99
buffer_store_dword v98, v14, s[40:43], 0 offen offset:3200
buffer_store_dword v99, v14, s[40:43], s64 offen offset:3200
v_cvt_pk_bf16_f32 v101, v70, v54
v_lshlrev_b32 v100, 16, v101
v_and_b32 v101, 0xffff0000, v101
buffer_store_dword v100, v14, s[40:43], 0 offen offset:3328
buffer_store_dword v101, v14, s[40:43], s64 offen offset:3328
v_cvt_pk_bf16_f32 v103, v71, v55
v_lshlrev_b32 v102, 16, v103
v_and_b32 v103, 0xffff0000, v103
buffer_store_dword v102, v14, s[40:43], 0 offen offset:3456
buffer_store_dword v103, v14, s[40:43], s64 offen offset:3456
s_endpgm
L_concat_heads__spectral_gfnet__ssm_conv_s5__prompt_kernel_gemm:
s_lshr_b32 s68, s34, 1
s_and_b32 s66, s34, 1
v_and_b32 v6, 31, v1
v_lshrrev_b32 v5, 5, v1
v_and_b32 v4, 0x13, v6
v_bfe_u32 v7, v6, 2, 1
v_lshl_or_b32 v4, v7, 3, v4
v_bfe_u32 v7, v6, 3, 1
v_lshl_or_b32 v4, v7, 2, v4
s_lshl_b32 s60, s36, 6
s_lshl_b32 s61, s66, 5
s_add_u32 s60, s60, s61
v_add_u32 v4, s60, v4
v_lshlrev_b32 v7, 1, v4
v_lshlrev_b32 v11, 4, v1
s_waitcnt lgkmcnt(0)
global_load_ushort v8, v7, s[12:13]
global_load_ushort v9, v7, s[14:15]
global_load_ushort v10, v7, s[24:25]
s_lshl_b32 s60, s2, 3
s_add_u32 s60, s60, s34
s_cmp_lg_u32 s60, 1
s_cbranch_scc1 L_nn41
s_load_dword s60, s[32:33], 0
v_mov_b32 v16, 0
v_and_b32 v17, 31, v1
v_lshlrev_b32 v17, 7, v17
v_add_u32 v17, 4096, v17
global_store_dword v17, v16, s[32:33] sc1
s_waitcnt vmcnt(0) lgkmcnt(0)
s_add_u32 s60, s60, 1
s_cmp_eq_u32 s60, 0
s_cselect_b32 s60, 1, s60
v_mov_b32 v17, s60
s_mov_b64 exec, 1
global_store_dword v16, v17, s[30:31] sc1
global_store_dword v16, v17, s[32:33] offset:0
s_mov_b64 exec, -1
L_nn41:
s_cmp_lg_u32 s34, 0
s_cbranch_scc1 L_pf42
s_lshr_b32 s60, s2, 3
s_lshl_b32 s60, s60, 11
v_and_b32 v12, 15, v1
v_lshl_add_u32 v12, v12, 7, s60
v_min_u32 v12, L_concat_heads__spectral_gfnet__ssm_conv_s5__prompt_kernel_end-concat_heads__spectral_gfnet__ssm_conv_s5__prompt_kernel, v12
s_getpc_b64 s[60:61]
L_pc43:
s_sub_u32 s60, s60, L_pc43-concat_heads__spectral_gfnet__ssm_conv_s5__prompt_kernel
s_subb_u32 s61, s61, 0
global_load_dword v247, v12, s[60:61]
L_pf42:
v_bfe_u32 v7, v6, 1, 3
v_xor_b32 v7, v7, v5
v_lshlrev_b32 v7, 4, v7
v_lshl_add_u32 v7, v6, 7, v7
s_lshl_b32 s60, s68, 13
s_lshl_b32 s61, s66, 13
s_add_u32 s61, s61, 16384
v_xor_b32 v12, 0, v7
v_add_u32 v128, s60, v12
v_add_u32 v132, s61, v12
v_add_u32 v136, 0x10000, v128
v_add_u32 v140, 0x10000, v132
v_xor_b32 v12, 32, v7
v_add_u32 v129, s60, v12
v_add_u32 v133, s61, v12
v_add_u32 v137, 0x10000, v129
v_add_u32 v141, 0x10000, v133
v_xor_b32 v12, 64, v7
v_add_u32 v130, s60, v12
v_add_u32 v134, s61, v12
v_add_u32 v138, 0x10000, v130
v_add_u32 v142, 0x10000, v134
v_xor_b32 v12, 96, v7
v_add_u32 v131, s60, v12
v_add_u32 v135, s61, v12
v_add_u32 v139, 0x10000, v131
v_add_u32 v143, 0x10000, v135
v_mov_b64 v[64:65], 0
v_mov_b64 v[66:67], 0
v_mov_b64 v[68:69], 0
v_mov_b64 v[70:71], 0
v_mov_b64 v[72:73], 0
v_mov_b64 v[74:75], 0
v_mov_b64 v[76:77], 0
v_mov_b64 v[78:79], 0
v_mov_b64 v[80:81], 0
v_mov_b64 v[82:83], 0
v_mov_b64 v[84:85], 0
v_mov_b64 v[86:87], 0
v_mov_b64 v[88:89], 0
v_mov_b64 v[90:91], 0
v_mov_b64 v[92:93], 0
v_mov_b64 v[94:95], 0
v_mov_b64 v[96:97], 0
v_mov_b64 v[98:99], 0
v_mov_b64 v[100:101], 0
v_mov_b64 v[102:103], 0
v_mov_b64 v[104:105], 0
v_mov_b64 v[106:107], 0
v_mov_b64 v[108:109], 0
v_mov_b64 v[110:111], 0
v_mov_b64 v[112:113], 0
v_mov_b64 v[114:115], 0
v_mov_b64 v[116:117], 0
v_mov_b64 v[118:119], 0
v_mov_b64 v[120:121], 0
v_mov_b64 v[122:123], 0
v_mov_b64 v[124:125], 0
v_mov_b64 v[126:127], 0
v_mov_b32 v34, 126976
v_mov_b64 v[36:37], 0
v_mov_b64 v[38:39], 0
s_mov_b64 exec, 1
ds_write_b128 v34, v[36:39]
ds_write_b128 v34, v[36:39] offset:16
s_mov_b64 exec, -1
v_lshlrev_b32 v12, 4, v5
v_sub_u32 v12, v6, v12
v_mov_b32 v13, 0x3f80
v_mov_b32 v14, 1.0
v_cmp_eq_u32 vcc, 0, v12
v_cmp_eq_u32 s[60:61], 8, v12
s_nop 0
v_cndmask_b32 v248, 0, v13, vcc
v_cndmask_b32 v248, v248, v14, s[60:61]
v_cmp_eq_u32 vcc, 1, v12
v_cmp_eq_u32 s[60:61], 9, v12
s_nop 0
v_cndmask_b32 v249, 0, v13, vcc
v_cndmask_b32 v249, v249, v14, s[60:61]
v_cmp_eq_u32 vcc, 2, v12
v_cmp_eq_u32 s[60:61], 10, v12
s_nop 0
v_cndmask_b32 v250, 0, v13, vcc
v_cndmask_b32 v250, v250, v14, s[60:61]
v_cmp_eq_u32 vcc, 3, v12
v_cmp_eq_u32 s[60:61], 11, v12
s_nop 0
v_cndmask_b32 v251, 0, v13, vcc
v_cndmask_b32 v251, v251, v14, s[60:61]
v_cmp_eq_u32 vcc, 4, v12
v_cmp_eq_u32 s[60:61], 12, v12
s_nop 0
v_cndmask_b32 v252, 0, v13, vcc
v_cndmask_b32 v252, v252, v14, s[60:61]
v_cmp_eq_u32 vcc, 5, v12
v_cmp_eq_u32 s[60:61], 13, v12
s_nop 0
v_cndmask_b32 v253, 0, v13, vcc
v_cndmask_b32 v253, v253, v14, s[60:61]
v_cmp_eq_u32 vcc, 6, v12
v_cmp_eq_u32 s[60:61], 14, v12
s_nop 0
v_cndmask_b32 v254, 0, v13, vcc
v_cndmask_b32 v254, v254, v14, s[60:61]
v_cmp_eq_u32 vcc, 7, v12
v_cmp_eq_u32 s[60:61], 15, v12
s_nop 0
v_cndmask_b32 v255, 0, v13, vcc
v_cndmask_b32 v255, v255, v14, s[60:61]
s_add_u32 s40, s32, 65536
s_addc_u32 s41, s33, 0
s_mov_b32 s42, 262144
s_mov_b32 s43, 0x20000
s_add_u32 s44, s32, 1048576
s_addc_u32 s45, s33, 0
s_mov_b32 s46, 8388608
s_mov_b32 s47, 0x20000
s_waitcnt vmcnt(0)
v_lshlrev_b32 v8, 16, v8
v_lshlrev_b32 v9, 16, v9
v_lshlrev_b32 v10, 16, v10
v_mul_f32 v10, 0x3fb8aa3b, v10
v_exp_f32 v10, v10
s_nop 0
v_cvt_pk_bf16_f32 v10, v10, v10
v_lshlrev_b32 v10, 16, v10
v_mul_f32 v12, v10, v8
v_mul_f32 v13, v10, v9
v_mul_f32 v12, 0x3fb8aa3b, v12
v_exp_f32 v12, v12
v_mul_f32 v13, 0.15915494, v13
v_rndne_f32 v14, v13
v_sub_f32 v13, v13, v14
v_cos_f32 v14, v13
v_sin_f32 v15, v13
v_mul_f32 v24, v12, v14
v_mul_f32 v25, v12, v15
v_add_f32 v12, -1.0, v24
v_mul_f32 v13, v8, v8
v_fma_f32 v13, v9, v9, v13
v_rcp_f32 v13, v13
s_nop 0
v_add_f32 v13, v13, v13
v_mul_f32 v14, v12, v8
v_fma_f32 v14, v25, v9, v14
v_mul_f32 v26, v14, v13
v_mul_f32 v14, v25, v8
v_fma_f32 v14, -v12, v9, v14
v_mul_f32 v27, v14, v13
v_mul_f32 v12, v25, v25
v_mul_f32 v13, v24, v25
v_fma_f32 v28, v24, v24, -v12
v_add_f32 v29, v13, v13
v_mul_f32 v12, v29, v29
v_mul_f32 v13, v28, v29
v_fma_f32 v28, v28, v28, -v12
v_add_f32 v29, v13, v13
v_mul_f32 v12, v29, v29
v_mul_f32 v13, v28, v29
v_fma_f32 v28, v28, v28, -v12
v_add_f32 v29, v13, v13
v_mul_f32 v12, v29, v29
v_mul_f32 v13, v28, v29
v_fma_f32 v28, v28, v28, -v12
v_add_f32 v29, v13, v13
v_mul_f32 v12, v29, v29
v_mul_f32 v13, v28, v29
v_fma_f32 v20, v28, v28, -v12
v_add_f32 v21, v13, v13
v_mul_f32 v12, v21, v21
v_mul_f32 v13, v20, v21
v_fma_f32 v30, v20, v20, -v12
v_add_f32 v31, v13, v13
v_mul_f32 v12, v31, v31
v_mul_f32 v13, v30, v31
v_fma_f32 v30, v30, v30, -v12
v_add_f32 v31, v13, v13
v_mul_f32 v12, v31, v31
v_mul_f32 v13, v30, v31
v_fma_f32 v2, v30, v30, -v12
v_add_f32 v3, v13, v13
s_waitcnt lgkmcnt(0)
s_barrier
ds_read_b128 v[32:35], v128 offset:0
ds_read_b128 v[36:39], v132 offset:0
ds_read_b128 v[40:43], v132 offset:4096
ds_read_b128 v[44:47], v128 offset:4096
s_waitcnt lgkmcnt(2)
v_mfma_f32_32x32x16_bf16 v[64:79], v[32:35], v[36:39], v[64:79]
ds_read_b128 v[48:51], v129 offset:0
ds_read_b128 v[52:55], v133 offset:0
s_waitcnt lgkmcnt(3)
v_mfma_f32_32x32x16_bf16 v[80:95], v[32:35], v[40:43], v[80:95]
ds_read_b128 v[56:59], v133 offset:4096
ds_read_b128 v[60:63], v129 offset:4096
s_waitcnt lgkmcnt(4)
v_mfma_f32_32x32x16_bf16 v[96:111], v[44:47], v[36:39], v[96:111]
v_mfma_f32_32x32x16_bf16 v[112:127], v[44:47], v[40:43], v[112:127]
s_waitcnt lgkmcnt(2)
v_mfma_f32_32x32x16_bf16 v[64:79], v[48:51], v[52:55], v[64:79]
ds_read_b128 v[32:35], v130 offset:0
ds_read_b128 v[36:39], v134 offset:0
s_waitcnt lgkmcnt(3)
v_mfma_f32_32x32x16_bf16 v[80:95], v[48:51], v[56:59], v[80:95]
ds_read_b128 v[40:43], v134 offset:4096
ds_read_b128 v[44:47], v130 offset:4096
s_waitcnt lgkmcnt(4)
v_mfma_f32_32x32x16_bf16 v[96:111], v[60:63], v[52:55], v[96:111]
v_mfma_f32_32x32x16_bf16 v[112:127], v[60:63], v[56:59], v[112:127]
s_waitcnt lgkmcnt(2)
v_mfma_f32_32x32x16_bf16 v[64:79], v[32:35], v[36:39], v[64:79]
ds_read_b128 v[48:51], v131 offset:0
ds_read_b128 v[52:55], v135 offset:0
s_waitcnt lgkmcnt(3)
v_mfma_f32_32x32x16_bf16 v[80:95], v[32:35], v[40:43], v[80:95]
ds_read_b128 v[56:59], v135 offset:4096
ds_read_b128 v[60:63], v131 offset:4096
s_waitcnt lgkmcnt(4)
v_mfma_f32_32x32x16_bf16 v[96:111], v[44:47], v[36:39], v[96:111]
v_mfma_f32_32x32x16_bf16 v[112:127], v[44:47], v[40:43], v[112:127]
s_waitcnt lgkmcnt(0)
s_barrier
v_mfma_f32_32x32x16_bf16 v[64:79], v[48:51], v[52:55], v[64:79]
ds_read_b128 v[32:35], v128 offset:32768
ds_read_b128 v[36:39], v132 offset:32768
v_mfma_f32_32x32x16_bf16 v[80:95], v[48:51], v[56:59], v[80:95]
ds_read_b128 v[40:43], v132 offset:36864
ds_read_b128 v[44:47], v128 offset:36864
v_mfma_f32_32x32x16_bf16 v[96:111], v[60:63], v[52:55], v[96:111]
v_mfma_f32_32x32x16_bf16 v[112:127], v[60:63], v[56:59], v[112:127]
s_waitcnt lgkmcnt(2)
v_mfma_f32_32x32x16_bf16 v[64:79], v[32:35], v[36:39], v[64:79]
ds_read_b128 v[48:51], v129 offset:32768
ds_read_b128 v[52:55], v133 offset:32768
s_waitcnt lgkmcnt(3)
v_mfma_f32_32x32x16_bf16 v[80:95], v[32:35], v[40:43], v[80:95]
ds_read_b128 v[56:59], v133 offset:36864
ds_read_b128 v[60:63], v129 offset:36864
s_waitcnt lgkmcnt(4)
v_mfma_f32_32x32x16_bf16 v[96:111], v[44:47], v[36:39], v[96:111]
v_mfma_f32_32x32x16_bf16 v[112:127], v[44:47], v[40:43], v[112:127]
s_waitcnt lgkmcnt(2)
v_mfma_f32_32x32x16_bf16 v[64:79], v[48:51], v[52:55], v[64:79]
ds_read_b128 v[32:35], v130 offset:32768
ds_read_b128 v[36:39], v134 offset:32768
s_waitcnt lgkmcnt(3)
v_mfma_f32_32x32x16_bf16 v[80:95], v[48:51], v[56:59], v[80:95]
ds_read_b128 v[40:43], v134 offset:36864
ds_read_b128 v[44:47], v130 offset:36864
s_waitcnt lgkmcnt(4)
v_mfma_f32_32x32x16_bf16 v[96:111], v[60:63], v[52:55], v[96:111]
v_mfma_f32_32x32x16_bf16 v[112:127], v[60:63], v[56:59], v[112:127]
s_waitcnt lgkmcnt(2)
v_mfma_f32_32x32x16_bf16 v[64:79], v[32:35], v[36:39], v[64:79]
ds_read_b128 v[48:51], v131 offset:32768
ds_read_b128 v[52:55], v135 offset:32768
s_waitcnt lgkmcnt(3)
v_mfma_f32_32x32x16_bf16 v[80:95], v[32:35], v[40:43], v[80:95]
ds_read_b128 v[56:59], v135 offset:36864
ds_read_b128 v[60:63], v131 offset:36864
s_waitcnt lgkmcnt(4)
v_mfma_f32_32x32x16_bf16 v[96:111], v[44:47], v[36:39], v[96:111]
v_mfma_f32_32x32x16_bf16 v[112:127], v[44:47], v[40:43], v[112:127]
s_waitcnt lgkmcnt(0)
s_barrier
v_mfma_f32_32x32x16_bf16 v[64:79], v[48:51], v[52:55], v[64:79]
ds_read_b128 v[32:35], v136 offset:0
ds_read_b128 v[36:39], v140 offset:0
v_mfma_f32_32x32x16_bf16 v[80:95], v[48:51], v[56:59], v[80:95]
ds_read_b128 v[40:43], v140 offset:4096
ds_read_b128 v[44:47], v136 offset:4096
v_mfma_f32_32x32x16_bf16 v[96:111], v[60:63], v[52:55], v[96:111]
v_mfma_f32_32x32x16_bf16 v[112:127], v[60:63], v[56:59], v[112:127]
s_waitcnt lgkmcnt(2)
v_mfma_f32_32x32x16_bf16 v[64:79], v[32:35], v[36:39], v[64:79]
ds_read_b128 v[48:51], v137 offset:0
ds_read_b128 v[52:55], v141 offset:0
s_waitcnt lgkmcnt(3)
v_mfma_f32_32x32x16_bf16 v[80:95], v[32:35], v[40:43], v[80:95]
ds_read_b128 v[56:59], v141 offset:4096
ds_read_b128 v[60:63], v137 offset:4096
s_waitcnt lgkmcnt(4)
v_mfma_f32_32x32x16_bf16 v[96:111], v[44:47], v[36:39], v[96:111]
v_mfma_f32_32x32x16_bf16 v[112:127], v[44:47], v[40:43], v[112:127]
s_waitcnt lgkmcnt(2)
v_mfma_f32_32x32x16_bf16 v[64:79], v[48:51], v[52:55], v[64:79]
ds_read_b128 v[32:35], v138 offset:0
ds_read_b128 v[36:39], v142 offset:0
s_waitcnt lgkmcnt(3)
v_mfma_f32_32x32x16_bf16 v[80:95], v[48:51], v[56:59], v[80:95]
ds_read_b128 v[40:43], v142 offset:4096
ds_read_b128 v[44:47], v138 offset:4096
s_waitcnt lgkmcnt(4)
v_mfma_f32_32x32x16_bf16 v[96:111], v[60:63], v[52:55], v[96:111]
v_mfma_f32_32x32x16_bf16 v[112:127], v[60:63], v[56:59], v[112:127]
s_waitcnt lgkmcnt(2)
v_mfma_f32_32x32x16_bf16 v[64:79], v[32:35], v[36:39], v[64:79]
ds_read_b128 v[48:51], v139 offset:0
ds_read_b128 v[52:55], v143 offset:0
s_waitcnt lgkmcnt(3)
v_mfma_f32_32x32x16_bf16 v[80:95], v[32:35], v[40:43], v[80:95]
ds_read_b128 v[56:59], v143 offset:4096
ds_read_b128 v[60:63], v139 offset:4096
s_waitcnt lgkmcnt(4)
v_mfma_f32_32x32x16_bf16 v[96:111], v[44:47], v[36:39], v[96:111]
v_mfma_f32_32x32x16_bf16 v[112:127], v[44:47], v[40:43], v[112:127]
s_waitcnt lgkmcnt(0)
s_barrier
v_mfma_f32_32x32x16_bf16 v[64:79], v[48:51], v[52:55], v[64:79]
ds_read_b128 v[32:35], v128 offset:0
ds_read_b128 v[36:39], v132 offset:0
v_mfma_f32_32x32x16_bf16 v[80:95], v[48:51], v[56:59], v[80:95]
ds_read_b128 v[40:43], v132 offset:4096
ds_read_b128 v[44:47], v128 offset:4096
v_mfma_f32_32x32x16_bf16 v[96:111], v[60:63], v[52:55], v[96:111]
v_mfma_f32_32x32x16_bf16 v[112:127], v[60:63], v[56:59], v[112:127]
s_waitcnt lgkmcnt(2)
v_mfma_f32_32x32x16_bf16 v[64:79], v[32:35], v[36:39], v[64:79]
ds_read_b128 v[48:51], v129 offset:0
ds_read_b128 v[52:55], v133 offset:0
s_waitcnt lgkmcnt(3)
v_mfma_f32_32x32x16_bf16 v[80:95], v[32:35], v[40:43], v[80:95]
ds_read_b128 v[56:59], v133 offset:4096
ds_read_b128 v[60:63], v129 offset:4096
s_waitcnt lgkmcnt(4)
v_mfma_f32_32x32x16_bf16 v[96:111], v[44:47], v[36:39], v[96:111]
v_mfma_f32_32x32x16_bf16 v[112:127], v[44:47], v[40:43], v[112:127]
s_waitcnt lgkmcnt(2)
v_mfma_f32_32x32x16_bf16 v[64:79], v[48:51], v[52:55], v[64:79]
ds_read_b128 v[32:35], v130 offset:0
ds_read_b128 v[36:39], v134 offset:0
s_waitcnt lgkmcnt(3)
v_mfma_f32_32x32x16_bf16 v[80:95], v[48:51], v[56:59], v[80:95]
ds_read_b128 v[40:43], v134 offset:4096
ds_read_b128 v[44:47], v130 offset:4096
s_waitcnt lgkmcnt(4)
v_mfma_f32_32x32x16_bf16 v[96:111], v[60:63], v[52:55], v[96:111]
v_mfma_f32_32x32x16_bf16 v[112:127], v[60:63], v[56:59], v[112:127]
s_waitcnt lgkmcnt(2)
v_mfma_f32_32x32x16_bf16 v[64:79], v[32:35], v[36:39], v[64:79]
ds_read_b128 v[48:51], v131 offset:0
ds_read_b128 v[52:55], v135 offset:0
s_waitcnt lgkmcnt(3)
v_mfma_f32_32x32x16_bf16 v[80:95], v[32:35], v[40:43], v[80:95]
ds_read_b128 v[56:59], v135 offset:4096
ds_read_b128 v[60:63], v131 offset:4096
s_waitcnt lgkmcnt(4)
v_mfma_f32_32x32x16_bf16 v[96:111], v[44:47], v[36:39], v[96:111]
v_mfma_f32_32x32x16_bf16 v[112:127], v[44:47], v[40:43], v[112:127]
s_waitcnt lgkmcnt(0)
s_barrier
v_mfma_f32_32x32x16_bf16 v[64:79], v[48:51], v[52:55], v[64:79]
ds_read_b128 v[32:35], v128 offset:32768
ds_read_b128 v[36:39], v132 offset:32768
v_mfma_f32_32x32x16_bf16 v[80:95], v[48:51], v[56:59], v[80:95]
ds_read_b128 v[40:43], v132 offset:36864
ds_read_b128 v[44:47], v128 offset:36864
v_mfma_f32_32x32x16_bf16 v[96:111], v[60:63], v[52:55], v[96:111]
v_mfma_f32_32x32x16_bf16 v[112:127], v[60:63], v[56:59], v[112:127]
s_waitcnt lgkmcnt(2)
v_mfma_f32_32x32x16_bf16 v[64:79], v[32:35], v[36:39], v[64:79]
ds_read_b128 v[48:51], v129 offset:32768
ds_read_b128 v[52:55], v133 offset:32768
s_waitcnt lgkmcnt(3)
v_mfma_f32_32x32x16_bf16 v[80:95], v[32:35], v[40:43], v[80:95]
ds_read_b128 v[56:59], v133 offset:36864
ds_read_b128 v[60:63], v129 offset:36864
s_waitcnt lgkmcnt(4)
v_mfma_f32_32x32x16_bf16 v[96:111], v[44:47], v[36:39], v[96:111]
v_mfma_f32_32x32x16_bf16 v[112:127], v[44:47], v[40:43], v[112:127]
s_waitcnt lgkmcnt(2)
v_mfma_f32_32x32x16_bf16 v[64:79], v[48:51], v[52:55], v[64:79]
ds_read_b128 v[32:35], v130 offset:32768
ds_read_b128 v[36:39], v134 offset:32768
s_waitcnt lgkmcnt(3)
v_mfma_f32_32x32x16_bf16 v[80:95], v[48:51], v[56:59], v[80:95]
ds_read_b128 v[40:43], v134 offset:36864
ds_read_b128 v[44:47], v130 offset:36864
s_waitcnt lgkmcnt(4)
v_mfma_f32_32x32x16_bf16 v[96:111], v[60:63], v[52:55], v[96:111]
v_mfma_f32_32x32x16_bf16 v[112:127], v[60:63], v[56:59], v[112:127]
s_waitcnt lgkmcnt(2)
v_mfma_f32_32x32x16_bf16 v[64:79], v[32:35], v[36:39], v[64:79]
ds_read_b128 v[48:51], v131 offset:32768
ds_read_b128 v[52:55], v135 offset:32768
s_waitcnt lgkmcnt(3)
v_mfma_f32_32x32x16_bf16 v[80:95], v[32:35], v[40:43], v[80:95]
ds_read_b128 v[56:59], v135 offset:36864
ds_read_b128 v[60:63], v131 offset:36864
s_waitcnt lgkmcnt(4)
v_mfma_f32_32x32x16_bf16 v[96:111], v[44:47], v[36:39], v[96:111]
v_mfma_f32_32x32x16_bf16 v[112:127], v[44:47], v[40:43], v[112:127]
s_waitcnt lgkmcnt(0)
s_barrier
v_mfma_f32_32x32x16_bf16 v[64:79], v[48:51], v[52:55], v[64:79]
ds_read_b128 v[32:35], v136 offset:0
ds_read_b128 v[36:39], v140 offset:0
v_mfma_f32_32x32x16_bf16 v[80:95], v[48:51], v[56:59], v[80:95]
ds_read_b128 v[40:43], v140 offset:4096
ds_read_b128 v[44:47], v136 offset:4096
v_mfma_f32_32x32x16_bf16 v[96:111], v[60:63], v[52:55], v[96:111]
v_mfma_f32_32x32x16_bf16 v[112:127], v[60:63], v[56:59], v[112:127]
s_waitcnt lgkmcnt(2)
v_mfma_f32_32x32x16_bf16 v[64:79], v[32:35], v[36:39], v[64:79]
ds_read_b128 v[48:51], v137 offset:0
ds_read_b128 v[52:55], v141 offset:0
s_waitcnt lgkmcnt(3)
v_mfma_f32_32x32x16_bf16 v[80:95], v[32:35], v[40:43], v[80:95]
ds_read_b128 v[56:59], v141 offset:4096
ds_read_b128 v[60:63], v137 offset:4096
s_waitcnt lgkmcnt(4)
v_mfma_f32_32x32x16_bf16 v[96:111], v[44:47], v[36:39], v[96:111]
v_mfma_f32_32x32x16_bf16 v[112:127], v[44:47], v[40:43], v[112:127]
s_waitcnt lgkmcnt(2)
v_mfma_f32_32x32x16_bf16 v[64:79], v[48:51], v[52:55], v[64:79]
ds_read_b128 v[32:35], v138 offset:0
ds_read_b128 v[36:39], v142 offset:0
s_waitcnt lgkmcnt(3)
v_mfma_f32_32x32x16_bf16 v[80:95], v[48:51], v[56:59], v[80:95]
ds_read_b128 v[40:43], v142 offset:4096
ds_read_b128 v[44:47], v138 offset:4096
s_waitcnt lgkmcnt(4)
v_mfma_f32_32x32x16_bf16 v[96:111], v[60:63], v[52:55], v[96:111]
v_mfma_f32_32x32x16_bf16 v[112:127], v[60:63], v[56:59], v[112:127]
s_waitcnt lgkmcnt(2)
v_mfma_f32_32x32x16_bf16 v[64:79], v[32:35], v[36:39], v[64:79]
ds_read_b128 v[48:51], v139 offset:0
ds_read_b128 v[52:55], v143 offset:0
s_waitcnt lgkmcnt(3)
v_mfma_f32_32x32x16_bf16 v[80:95], v[32:35], v[40:43], v[80:95]
ds_read_b128 v[56:59], v143 offset:4096
ds_read_b128 v[60:63], v139 offset:4096
s_waitcnt lgkmcnt(4)
v_mfma_f32_32x32x16_bf16 v[96:111], v[44:47], v[36:39], v[96:111]
v_mfma_f32_32x32x16_bf16 v[112:127], v[44:47], v[40:43], v[112:127]
s_waitcnt lgkmcnt(0)
s_barrier
v_mfma_f32_32x32x16_bf16 v[64:79], v[48:51], v[52:55], v[64:79]
ds_read_b128 v[32:35], v128 offset:0
ds_read_b128 v[36:39], v132 offset:0
v_mfma_f32_32x32x16_bf16 v[80:95], v[48:51], v[56:59], v[80:95]
ds_read_b128 v[40:43], v132 offset:4096
ds_read_b128 v[44:47], v128 offset:4096
v_mfma_f32_32x32x16_bf16 v[96:111], v[60:63], v[52:55], v[96:111]
v_mfma_f32_32x32x16_bf16 v[112:127], v[60:63], v[56:59], v[112:127]
s_waitcnt lgkmcnt(2)
v_mfma_f32_32x32x16_bf16 v[64:79], v[32:35], v[36:39], v[64:79]
ds_read_b128 v[48:51], v129 offset:0
ds_read_b128 v[52:55], v133 offset:0
s_waitcnt lgkmcnt(3)
v_mfma_f32_32x32x16_bf16 v[80:95], v[32:35], v[40:43], v[80:95]
ds_read_b128 v[56:59], v133 offset:4096
ds_read_b128 v[60:63], v129 offset:4096
s_waitcnt lgkmcnt(4)
v_mfma_f32_32x32x16_bf16 v[96:111], v[44:47], v[36:39], v[96:111]
v_mfma_f32_32x32x16_bf16 v[112:127], v[44:47], v[40:43], v[112:127]
s_waitcnt lgkmcnt(2)
v_mfma_f32_32x32x16_bf16 v[64:79], v[48:51], v[52:55], v[64:79]
ds_read_b128 v[32:35], v130 offset:0
ds_read_b128 v[36:39], v134 offset:0
s_waitcnt lgkmcnt(3)
v_mfma_f32_32x32x16_bf16 v[80:95], v[48:51], v[56:59], v[80:95]
ds_read_b128 v[40:43], v134 offset:4096
ds_read_b128 v[44:47], v130 offset:4096
s_waitcnt lgkmcnt(4)
v_mfma_f32_32x32x16_bf16 v[96:111], v[60:63], v[52:55], v[96:111]
v_mfma_f32_32x32x16_bf16 v[112:127], v[60:63], v[56:59], v[112:127]
s_waitcnt lgkmcnt(2)
v_mfma_f32_32x32x16_bf16 v[64:79], v[32:35], v[36:39], v[64:79]
ds_read_b128 v[48:51], v131 offset:0
ds_read_b128 v[52:55], v135 offset:0
s_waitcnt lgkmcnt(3)
v_mfma_f32_32x32x16_bf16 v[80:95], v[32:35], v[40:43], v[80:95]
ds_read_b128 v[56:59], v135 offset:4096
ds_read_b128 v[60:63], v131 offset:4096
s_waitcnt lgkmcnt(4)
v_mfma_f32_32x32x16_bf16 v[96:111], v[44:47], v[36:39], v[96:111]
v_mfma_f32_32x32x16_bf16 v[112:127], v[44:47], v[40:43], v[112:127]
s_waitcnt lgkmcnt(0)
s_barrier
v_mfma_f32_32x32x16_bf16 v[64:79], v[48:51], v[52:55], v[64:79]
ds_read_b128 v[32:35], v128 offset:32768
ds_read_b128 v[36:39], v132 offset:32768
v_mfma_f32_32x32x16_bf16 v[80:95], v[48:51], v[56:59], v[80:95]
ds_read_b128 v[40:43], v132 offset:36864
ds_read_b128 v[44:47], v128 offset:36864
v_mfma_f32_32x32x16_bf16 v[96:111], v[60:63], v[52:55], v[96:111]
v_mfma_f32_32x32x16_bf16 v[112:127], v[60:63], v[56:59], v[112:127]
s_waitcnt lgkmcnt(2)
v_mfma_f32_32x32x16_bf16 v[64:79], v[32:35], v[36:39], v[64:79]
ds_read_b128 v[48:51], v129 offset:32768
ds_read_b128 v[52:55], v133 offset:32768
s_waitcnt lgkmcnt(3)
v_mfma_f32_32x32x16_bf16 v[80:95], v[32:35], v[40:43], v[80:95]
ds_read_b128 v[56:59], v133 offset:36864
ds_read_b128 v[60:63], v129 offset:36864
s_waitcnt lgkmcnt(4)
v_mfma_f32_32x32x16_bf16 v[96:111], v[44:47], v[36:39], v[96:111]
v_mfma_f32_32x32x16_bf16 v[112:127], v[44:47], v[40:43], v[112:127]
s_waitcnt lgkmcnt(2)
v_mfma_f32_32x32x16_bf16 v[64:79], v[48:51], v[52:55], v[64:79]
ds_read_b128 v[32:35], v130 offset:32768
ds_read_b128 v[36:39], v134 offset:32768
s_waitcnt lgkmcnt(3)
v_mfma_f32_32x32x16_bf16 v[80:95], v[48:51], v[56:59], v[80:95]
ds_read_b128 v[40:43], v134 offset:36864
ds_read_b128 v[44:47], v130 offset:36864
s_waitcnt lgkmcnt(4)
v_mfma_f32_32x32x16_bf16 v[96:111], v[60:63], v[52:55], v[96:111]
v_mfma_f32_32x32x16_bf16 v[112:127], v[60:63], v[56:59], v[112:127]
s_waitcnt lgkmcnt(2)
v_mfma_f32_32x32x16_bf16 v[64:79], v[32:35], v[36:39], v[64:79]
ds_read_b128 v[48:51], v131 offset:32768
ds_read_b128 v[52:55], v135 offset:32768
s_waitcnt lgkmcnt(3)
v_mfma_f32_32x32x16_bf16 v[80:95], v[32:35], v[40:43], v[80:95]
ds_read_b128 v[56:59], v135 offset:36864
ds_read_b128 v[60:63], v131 offset:36864
s_waitcnt lgkmcnt(4)
v_mfma_f32_32x32x16_bf16 v[96:111], v[44:47], v[36:39], v[96:111]
v_mfma_f32_32x32x16_bf16 v[112:127], v[44:47], v[40:43], v[112:127]
s_waitcnt lgkmcnt(0)
s_barrier
v_mfma_f32_32x32x16_bf16 v[64:79], v[48:51], v[52:55], v[64:79]
ds_read_b128 v[32:35], v136 offset:0
ds_read_b128 v[36:39], v140 offset:0
v_mfma_f32_32x32x16_bf16 v[80:95], v[48:51], v[56:59], v[80:95]
ds_read_b128 v[40:43], v140 offset:4096
ds_read_b128 v[44:47], v136 offset:4096
v_mfma_f32_32x32x16_bf16 v[96:111], v[60:63], v[52:55], v[96:111]
v_mfma_f32_32x32x16_bf16 v[112:127], v[60:63], v[56:59], v[112:127]
s_waitcnt lgkmcnt(2)
v_mfma_f32_32x32x16_bf16 v[64:79], v[32:35], v[36:39], v[64:79]
ds_read_b128 v[48:51], v137 offset:0
ds_read_b128 v[52:55], v141 offset:0
s_waitcnt lgkmcnt(3)
v_mfma_f32_32x32x16_bf16 v[80:95], v[32:35], v[40:43], v[80:95]
ds_read_b128 v[56:59], v141 offset:4096
ds_read_b128 v[60:63], v137 offset:4096
s_waitcnt lgkmcnt(4)
v_mfma_f32_32x32x16_bf16 v[96:111], v[44:47], v[36:39], v[96:111]
v_mfma_f32_32x32x16_bf16 v[112:127], v[44:47], v[40:43], v[112:127]
s_waitcnt lgkmcnt(2)
v_mfma_f32_32x32x16_bf16 v[64:79], v[48:51], v[52:55], v[64:79]
ds_read_b128 v[32:35], v138 offset:0
ds_read_b128 v[36:39], v142 offset:0
s_waitcnt lgkmcnt(3)
v_mfma_f32_32x32x16_bf16 v[80:95], v[48:51], v[56:59], v[80:95]
ds_read_b128 v[40:43], v142 offset:4096
ds_read_b128 v[44:47], v138 offset:4096
s_waitcnt lgkmcnt(4)
v_mfma_f32_32x32x16_bf16 v[96:111], v[60:63], v[52:55], v[96:111]
v_mfma_f32_32x32x16_bf16 v[112:127], v[60:63], v[56:59], v[112:127]
s_waitcnt lgkmcnt(2)
v_mfma_f32_32x32x16_bf16 v[64:79], v[32:35], v[36:39], v[64:79]
ds_read_b128 v[48:51], v139 offset:0
ds_read_b128 v[52:55], v143 offset:0
s_waitcnt lgkmcnt(3)
v_mfma_f32_32x32x16_bf16 v[80:95], v[32:35], v[40:43], v[80:95]
ds_read_b128 v[56:59], v143 offset:4096
ds_read_b128 v[60:63], v139 offset:4096
s_waitcnt lgkmcnt(4)
v_mfma_f32_32x32x16_bf16 v[96:111], v[44:47], v[36:39], v[96:111]
v_mfma_f32_32x32x16_bf16 v[112:127], v[44:47], v[40:43], v[112:127]
s_waitcnt lgkmcnt(0)
s_barrier
v_mfma_f32_32x32x16_bf16 v[64:79], v[48:51], v[52:55], v[64:79]
ds_read_b128 v[32:35], v128 offset:0
ds_read_b128 v[36:39], v132 offset:0
v_mfma_f32_32x32x16_bf16 v[80:95], v[48:51], v[56:59], v[80:95]
ds_read_b128 v[40:43], v132 offset:4096
ds_read_b128 v[44:47], v128 offset:4096
v_mfma_f32_32x32x16_bf16 v[96:111], v[60:63], v[52:55], v[96:111]
v_mfma_f32_32x32x16_bf16 v[112:127], v[60:63], v[56:59], v[112:127]
s_waitcnt lgkmcnt(2)
v_mfma_f32_32x32x16_bf16 v[64:79], v[32:35], v[36:39], v[64:79]
ds_read_b128 v[48:51], v129 offset:0
ds_read_b128 v[52:55], v133 offset:0
s_waitcnt lgkmcnt(3)
v_mfma_f32_32x32x16_bf16 v[80:95], v[32:35], v[40:43], v[80:95]
ds_read_b128 v[56:59], v133 offset:4096
ds_read_b128 v[60:63], v129 offset:4096
s_waitcnt lgkmcnt(4)
v_mfma_f32_32x32x16_bf16 v[96:111], v[44:47], v[36:39], v[96:111]
v_mfma_f32_32x32x16_bf16 v[112:127], v[44:47], v[40:43], v[112:127]
s_waitcnt lgkmcnt(2)
v_mfma_f32_32x32x16_bf16 v[64:79], v[48:51], v[52:55], v[64:79]
ds_read_b128 v[32:35], v130 offset:0
ds_read_b128 v[36:39], v134 offset:0
s_waitcnt lgkmcnt(3)
v_mfma_f32_32x32x16_bf16 v[80:95], v[48:51], v[56:59], v[80:95]
ds_read_b128 v[40:43], v134 offset:4096
ds_read_b128 v[44:47], v130 offset:4096
s_waitcnt lgkmcnt(4)
v_mfma_f32_32x32x16_bf16 v[96:111], v[60:63], v[52:55], v[96:111]
v_mfma_f32_32x32x16_bf16 v[112:127], v[60:63], v[56:59], v[112:127]
s_waitcnt lgkmcnt(2)
v_mfma_f32_32x32x16_bf16 v[64:79], v[32:35], v[36:39], v[64:79]
ds_read_b128 v[48:51], v131 offset:0
ds_read_b128 v[52:55], v135 offset:0
s_waitcnt lgkmcnt(3)
v_mfma_f32_32x32x16_bf16 v[80:95], v[32:35], v[40:43], v[80:95]
ds_read_b128 v[56:59], v135 offset:4096
ds_read_b128 v[60:63], v131 offset:4096
s_waitcnt lgkmcnt(4)
v_mfma_f32_32x32x16_bf16 v[96:111], v[44:47], v[36:39], v[96:111]
v_mfma_f32_32x32x16_bf16 v[112:127], v[44:47], v[40:43], v[112:127]
s_waitcnt lgkmcnt(0)
s_barrier
v_mfma_f32_32x32x16_bf16 v[64:79], v[48:51], v[52:55], v[64:79]
ds_read_b128 v[32:35], v128 offset:32768
ds_read_b128 v[36:39], v132 offset:32768
v_mfma_f32_32x32x16_bf16 v[80:95], v[48:51], v[56:59], v[80:95]
ds_read_b128 v[40:43], v132 offset:36864
ds_read_b128 v[44:47], v128 offset:36864
v_mfma_f32_32x32x16_bf16 v[96:111], v[60:63], v[52:55], v[96:111]
v_mfma_f32_32x32x16_bf16 v[112:127], v[60:63], v[56:59], v[112:127]
s_waitcnt lgkmcnt(2)
v_mfma_f32_32x32x16_bf16 v[64:79], v[32:35], v[36:39], v[64:79]
ds_read_b128 v[48:51], v129 offset:32768
ds_read_b128 v[52:55], v133 offset:32768
s_waitcnt lgkmcnt(3)
v_mfma_f32_32x32x16_bf16 v[80:95], v[32:35], v[40:43], v[80:95]
ds_read_b128 v[56:59], v133 offset:36864
ds_read_b128 v[60:63], v129 offset:36864
s_waitcnt lgkmcnt(4)
v_mfma_f32_32x32x16_bf16 v[96:111], v[44:47], v[36:39], v[96:111]
v_mfma_f32_32x32x16_bf16 v[112:127], v[44:47], v[40:43], v[112:127]
s_waitcnt lgkmcnt(2)
v_mfma_f32_32x32x16_bf16 v[64:79], v[48:51], v[52:55], v[64:79]
ds_read_b128 v[32:35], v130 offset:32768
ds_read_b128 v[36:39], v134 offset:32768
s_waitcnt lgkmcnt(3)
v_mfma_f32_32x32x16_bf16 v[80:95], v[48:51], v[56:59], v[80:95]
ds_read_b128 v[40:43], v134 offset:36864
ds_read_b128 v[44:47], v130 offset:36864
s_waitcnt lgkmcnt(4)
v_mfma_f32_32x32x16_bf16 v[96:111], v[60:63], v[52:55], v[96:111]
v_mfma_f32_32x32x16_bf16 v[112:127], v[60:63], v[56:59], v[112:127]
s_waitcnt lgkmcnt(2)
v_mfma_f32_32x32x16_bf16 v[64:79], v[32:35], v[36:39], v[64:79]
ds_read_b128 v[48:51], v131 offset:32768
ds_read_b128 v[52:55], v135 offset:32768
s_waitcnt lgkmcnt(3)
v_mfma_f32_32x32x16_bf16 v[80:95], v[32:35], v[40:43], v[80:95]
ds_read_b128 v[56:59], v135 offset:36864
ds_read_b128 v[60:63], v131 offset:36864
s_waitcnt lgkmcnt(4)
v_mfma_f32_32x32x16_bf16 v[96:111], v[44:47], v[36:39], v[96:111]
v_mfma_f32_32x32x16_bf16 v[112:127], v[44:47], v[40:43], v[112:127]
s_waitcnt lgkmcnt(0)
s_barrier
v_mfma_f32_32x32x16_bf16 v[64:79], v[48:51], v[52:55], v[64:79]
ds_read_b128 v[32:35], v136 offset:0
ds_read_b128 v[36:39], v140 offset:0
v_mfma_f32_32x32x16_bf16 v[80:95], v[48:51], v[56:59], v[80:95]
ds_read_b128 v[40:43], v140 offset:4096
ds_read_b128 v[44:47], v136 offset:4096
v_mfma_f32_32x32x16_bf16 v[96:111], v[60:63], v[52:55], v[96:111]
v_mfma_f32_32x32x16_bf16 v[112:127], v[60:63], v[56:59], v[112:127]
s_waitcnt lgkmcnt(2)
v_mfma_f32_32x32x16_bf16 v[64:79], v[32:35], v[36:39], v[64:79]
ds_read_b128 v[48:51], v137 offset:0
ds_read_b128 v[52:55], v141 offset:0
s_waitcnt lgkmcnt(3)
v_mfma_f32_32x32x16_bf16 v[80:95], v[32:35], v[40:43], v[80:95]
ds_read_b128 v[56:59], v141 offset:4096
ds_read_b128 v[60:63], v137 offset:4096
s_waitcnt lgkmcnt(4)
v_mfma_f32_32x32x16_bf16 v[96:111], v[44:47], v[36:39], v[96:111]
v_mfma_f32_32x32x16_bf16 v[112:127], v[44:47], v[40:43], v[112:127]
s_waitcnt lgkmcnt(2)
v_mfma_f32_32x32x16_bf16 v[64:79], v[48:51], v[52:55], v[64:79]
ds_read_b128 v[32:35], v138 offset:0
ds_read_b128 v[36:39], v142 offset:0
s_waitcnt lgkmcnt(3)
v_mfma_f32_32x32x16_bf16 v[80:95], v[48:51], v[56:59], v[80:95]
ds_read_b128 v[40:43], v142 offset:4096
ds_read_b128 v[44:47], v138 offset:4096
s_waitcnt lgkmcnt(4)
v_mfma_f32_32x32x16_bf16 v[96:111], v[60:63], v[52:55], v[96:111]
v_mfma_f32_32x32x16_bf16 v[112:127], v[60:63], v[56:59], v[112:127]
s_waitcnt lgkmcnt(2)
v_mfma_f32_32x32x16_bf16 v[64:79], v[32:35], v[36:39], v[64:79]
ds_read_b128 v[48:51], v139 offset:0
ds_read_b128 v[52:55], v143 offset:0
s_waitcnt lgkmcnt(3)
v_mfma_f32_32x32x16_bf16 v[80:95], v[32:35], v[40:43], v[80:95]
ds_read_b128 v[56:59], v143 offset:4096
ds_read_b128 v[60:63], v139 offset:4096
s_waitcnt lgkmcnt(4)
v_mfma_f32_32x32x16_bf16 v[96:111], v[44:47], v[36:39], v[96:111]
v_mfma_f32_32x32x16_bf16 v[112:127], v[44:47], v[40:43], v[112:127]
s_waitcnt lgkmcnt(0)
s_barrier
v_mfma_f32_32x32x16_bf16 v[64:79], v[48:51], v[52:55], v[64:79]
ds_read_b128 v[32:35], v128 offset:0
ds_read_b128 v[36:39], v132 offset:0
v_mfma_f32_32x32x16_bf16 v[80:95], v[48:51], v[56:59], v[80:95]
ds_read_b128 v[40:43], v132 offset:4096
ds_read_b128 v[44:47], v128 offset:4096
v_mfma_f32_32x32x16_bf16 v[96:111], v[60:63], v[52:55], v[96:111]
v_mfma_f32_32x32x16_bf16 v[112:127], v[60:63], v[56:59], v[112:127]
s_waitcnt lgkmcnt(2)
v_mov_b32 v12, 0
global_load_dword v13, v12, s[30:31] sc1
v_mfma_f32_32x32x16_bf16 v[64:79], v[32:35], v[36:39], v[64:79]
ds_read_b128 v[48:51], v129 offset:0
ds_read_b128 v[52:55], v133 offset:0
s_waitcnt lgkmcnt(3)
v_mfma_f32_32x32x16_bf16 v[80:95], v[32:35], v[40:43], v[80:95]
ds_read_b128 v[56:59], v133 offset:4096
ds_read_b128 v[60:63], v129 offset:4096
s_waitcnt lgkmcnt(4)
v_mfma_f32_32x32x16_bf16 v[96:111], v[44:47], v[36:39], v[96:111]
v_mfma_f32_32x32x16_bf16 v[112:127], v[44:47], v[40:43], v[112:127]
s_waitcnt lgkmcnt(2)
v_mfma_f32_32x32x16_bf16 v[64:79], v[48:51], v[52:55], v[64:79]
ds_read_b128 v[32:35], v130 offset:0
ds_read_b128 v[36:39], v134 offset:0
s_waitcnt lgkmcnt(3)
v_mfma_f32_32x32x16_bf16 v[80:95], v[48:51], v[56:59], v[80:95]
ds_read_b128 v[40:43], v134 offset:4096
ds_read_b128 v[44:47], v130 offset:4096
s_waitcnt lgkmcnt(4)
v_mfma_f32_32x32x16_bf16 v[96:111], v[60:63], v[52:55], v[96:111]
v_mfma_f32_32x32x16_bf16 v[112:127], v[60:63], v[56:59], v[112:127]
s_waitcnt lgkmcnt(2)
v_mfma_f32_32x32x16_bf16 v[64:79], v[32:35], v[36:39], v[64:79]
ds_read_b128 v[48:51], v131 offset:0
ds_read_b128 v[52:55], v135 offset:0
s_waitcnt lgkmcnt(3)
v_mfma_f32_32x32x16_bf16 v[80:95], v[32:35], v[40:43], v[80:95]
ds_read_b128 v[56:59], v135 offset:4096
ds_read_b128 v[60:63], v131 offset:4096
s_waitcnt lgkmcnt(4)
v_mfma_f32_32x32x16_bf16 v[96:111], v[44:47], v[36:39], v[96:111]
v_mfma_f32_32x32x16_bf16 v[112:127], v[44:47], v[40:43], v[112:127]
s_waitcnt lgkmcnt(0)
s_barrier
v_mfma_f32_32x32x16_bf16 v[64:79], v[48:51], v[52:55], v[64:79]
ds_read_b128 v[32:35], v128 offset:32768
ds_read_b128 v[36:39], v132 offset:32768
v_mfma_f32_32x32x16_bf16 v[80:95], v[48:51], v[56:59], v[80:95]
ds_read_b128 v[40:43], v132 offset:36864
ds_read_b128 v[44:47], v128 offset:36864
v_mfma_f32_32x32x16_bf16 v[96:111], v[60:63], v[52:55], v[96:111]
v_mfma_f32_32x32x16_bf16 v[112:127], v[60:63], v[56:59], v[112:127]
s_waitcnt lgkmcnt(2)
v_mfma_f32_32x32x16_bf16 v[64:79], v[32:35], v[36:39], v[64:79]
ds_read_b128 v[48:51], v129 offset:32768
ds_read_b128 v[52:55], v133 offset:32768
s_waitcnt lgkmcnt(3)
v_mfma_f32_32x32x16_bf16 v[80:95], v[32:35], v[40:43], v[80:95]
ds_read_b128 v[56:59], v133 offset:36864
ds_read_b128 v[60:63], v129 offset:36864
s_waitcnt lgkmcnt(4)
v_mfma_f32_32x32x16_bf16 v[96:111], v[44:47], v[36:39], v[96:111]
v_mfma_f32_32x32x16_bf16 v[112:127], v[44:47], v[40:43], v[112:127]
s_waitcnt lgkmcnt(2)
v_mfma_f32_32x32x16_bf16 v[64:79], v[48:51], v[52:55], v[64:79]
ds_read_b128 v[32:35], v130 offset:32768
ds_read_b128 v[36:39], v134 offset:32768
s_waitcnt lgkmcnt(3)
v_mfma_f32_32x32x16_bf16 v[80:95], v[48:51], v[56:59], v[80:95]
ds_read_b128 v[40:43], v134 offset:36864
ds_read_b128 v[44:47], v130 offset:36864
s_waitcnt lgkmcnt(4)
v_mfma_f32_32x32x16_bf16 v[96:111], v[60:63], v[52:55], v[96:111]
v_mfma_f32_32x32x16_bf16 v[112:127], v[60:63], v[56:59], v[112:127]
s_waitcnt lgkmcnt(2)
v_mfma_f32_32x32x16_bf16 v[64:79], v[32:35], v[36:39], v[64:79]
ds_read_b128 v[48:51], v131 offset:32768
ds_read_b128 v[52:55], v135 offset:32768
s_waitcnt lgkmcnt(3)
v_mfma_f32_32x32x16_bf16 v[80:95], v[32:35], v[40:43], v[80:95]
ds_read_b128 v[56:59], v135 offset:36864
ds_read_b128 v[60:63], v131 offset:36864
s_waitcnt lgkmcnt(4)
v_mfma_f32_32x32x16_bf16 v[96:111], v[44:47], v[36:39], v[96:111]
v_mfma_f32_32x32x16_bf16 v[112:127], v[44:47], v[40:43], v[112:127]
s_waitcnt lgkmcnt(0)
s_barrier
v_mfma_f32_32x32x16_bf16 v[64:79], v[48:51], v[52:55], v[64:79]
ds_read_b128 v[32:35], v136 offset:0
ds_read_b128 v[36:39], v140 offset:0
v_mfma_f32_32x32x16_bf16 v[80:95], v[48:51], v[56:59], v[80:95]
ds_read_b128 v[40:43], v140 offset:4096
ds_read_b128 v[44:47], v136 offset:4096
v_mfma_f32_32x32x16_bf16 v[96:111], v[60:63], v[52:55], v[96:111]
v_mfma_f32_32x32x16_bf16 v[112:127], v[60:63], v[56:59], v[112:127]
s_waitcnt lgkmcnt(2)
v_mfma_f32_32x32x16_bf16 v[64:79], v[32:35], v[36:39], v[64:79]
ds_read_b128 v[48:51], v137 offset:0
ds_read_b128 v[52:55], v141 offset:0
s_waitcnt lgkmcnt(3)
v_mfma_f32_32x32x16_bf16 v[80:95], v[32:35], v[40:43], v[80:95]
ds_read_b128 v[56:59], v141 offset:4096
ds_read_b128 v[60:63], v137 offset:4096
s_waitcnt lgkmcnt(4)
v_mfma_f32_32x32x16_bf16 v[96:111], v[44:47], v[36:39], v[96:111]
v_mfma_f32_32x32x16_bf16 v[112:127], v[44:47], v[40:43], v[112:127]
s_waitcnt lgkmcnt(2)
v_mfma_f32_32x32x16_bf16 v[64:79], v[48:51], v[52:55], v[64:79]
ds_read_b128 v[32:35], v138 offset:0
ds_read_b128 v[36:39], v142 offset:0
s_waitcnt lgkmcnt(3)
v_mfma_f32_32x32x16_bf16 v[80:95], v[48:51], v[56:59], v[80:95]
ds_read_b128 v[40:43], v142 offset:4096
ds_read_b128 v[44:47], v138 offset:4096
s_waitcnt lgkmcnt(4)
v_mfma_f32_32x32x16_bf16 v[96:111], v[60:63], v[52:55], v[96:111]
v_mfma_f32_32x32x16_bf16 v[112:127], v[60:63], v[56:59], v[112:127]
s_waitcnt lgkmcnt(2)
v_mfma_f32_32x32x16_bf16 v[64:79], v[32:35], v[36:39], v[64:79]
ds_read_b128 v[48:51], v139 offset:0
ds_read_b128 v[52:55], v143 offset:0
s_waitcnt lgkmcnt(3)
v_mfma_f32_32x32x16_bf16 v[80:95], v[32:35], v[40:43], v[80:95]
ds_read_b128 v[56:59], v143 offset:4096
ds_read_b128 v[60:63], v139 offset:4096
s_waitcnt lgkmcnt(4)
v_mfma_f32_32x32x16_bf16 v[96:111], v[44:47], v[36:39], v[96:111]
v_mfma_f32_32x32x16_bf16 v[112:127], v[44:47], v[40:43], v[112:127]
s_waitcnt lgkmcnt(0)
s_barrier
v_mfma_f32_32x32x16_bf16 v[64:79], v[48:51], v[52:55], v[64:79]
ds_read_b128 v[32:35], v128 offset:0
ds_read_b128 v[36:39], v132 offset:0
v_mfma_f32_32x32x16_bf16 v[80:95], v[48:51], v[56:59], v[80:95]
ds_read_b128 v[40:43], v132 offset:4096
ds_read_b128 v[44:47], v128 offset:4096
v_mfma_f32_32x32x16_bf16 v[96:111], v[60:63], v[52:55], v[96:111]
v_mfma_f32_32x32x16_bf16 v[112:127], v[60:63], v[56:59], v[112:127]
s_waitcnt lgkmcnt(2)
v_mfma_f32_32x32x16_bf16 v[64:79], v[32:35], v[36:39], v[64:79]
ds_read_b128 v[48:51], v129 offset:0
ds_read_b128 v[52:55], v133 offset:0
s_waitcnt lgkmcnt(3)
v_mfma_f32_32x32x16_bf16 v[80:95], v[32:35], v[40:43], v[80:95]
ds_read_b128 v[56:59], v133 offset:4096
ds_read_b128 v[60:63], v129 offset:4096
s_waitcnt lgkmcnt(4)
v_mfma_f32_32x32x16_bf16 v[96:111], v[44:47], v[36:39], v[96:111]
v_mfma_f32_32x32x16_bf16 v[112:127], v[44:47], v[40:43], v[112:127]
s_waitcnt lgkmcnt(2)
v_mfma_f32_32x32x16_bf16 v[64:79], v[48:51], v[52:55], v[64:79]
ds_read_b128 v[32:35], v130 offset:0
ds_read_b128 v[36:39], v134 offset:0
s_waitcnt lgkmcnt(3)
v_mfma_f32_32x32x16_bf16 v[80:95], v[48:51], v[56:59], v[80:95]
ds_read_b128 v[40:43], v134 offset:4096
ds_read_b128 v[44:47], v130 offset:4096
s_waitcnt lgkmcnt(4)
v_mfma_f32_32x32x16_bf16 v[96:111], v[60:63], v[52:55], v[96:111]
v_mfma_f32_32x32x16_bf16 v[112:127], v[60:63], v[56:59], v[112:127]
s_waitcnt lgkmcnt(2)
v_mfma_f32_32x32x16_bf16 v[64:79], v[32:35], v[36:39], v[64:79]
ds_read_b128 v[48:51], v131 offset:0
ds_read_b128 v[52:55], v135 offset:0
s_waitcnt lgkmcnt(3)
v_mfma_f32_32x32x16_bf16 v[80:95], v[32:35], v[40:43], v[80:95]
ds_read_b128 v[56:59], v135 offset:4096
ds_read_b128 v[60:63], v131 offset:4096
s_waitcnt lgkmcnt(4)
v_mfma_f32_32x32x16_bf16 v[96:111], v[44:47], v[36:39], v[96:111]
v_mfma_f32_32x32x16_bf16 v[112:127], v[44:47], v[40:43], v[112:127]
s_waitcnt lgkmcnt(0)
s_barrier
v_mfma_f32_32x32x16_bf16 v[64:79], v[48:51], v[52:55], v[64:79]
v_mfma_f32_32x32x16_bf16 v[80:95], v[48:51], v[56:59], v[80:95]
v_mfma_f32_32x32x16_bf16 v[96:111], v[60:63], v[52:55], v[96:111]
v_mfma_f32_32x32x16_bf16 v[112:127], v[60:63], v[56:59], v[112:127]
s_lshl_b32 s60, s66, 10
s_add_u32 s60, s60, 122880
s_lshl_b32 s61, s68, 4
v_lshl_add_u32 v14, v6, 5, s60
v_lshl_add_u32 v15, v5, 3, v14
v_add_u32 v15, s61, v15
s_nop 2
v_pk_fma_f32 v[40:41], v[24:25], v[64:65], v[66:67] op_sel_hi:[0,1,1]
v_pk_fma_f32 v[42:43], v[24:25], v[80:81], v[82:83] op_sel_hi:[0,1,1]
v_pk_fma_f32 v[66:67], v[24:25], v[80:81], v[40:41] op_sel:[1,0,0] neg_lo:[1,0,0] neg_hi:[1,0,0]
v_pk_fma_f32 v[82:83], v[24:25], v[64:65], v[42:43] op_sel:[1,0,0]
v_pk_fma_f32 v[40:41], v[24:25], v[66:67], v[68:69] op_sel_hi:[0,1,1]
v_pk_fma_f32 v[42:43], v[24:25], v[82:83], v[84:85] op_sel_hi:[0,1,1]
v_pk_fma_f32 v[68:69], v[24:25], v[82:83], v[40:41] op_sel:[1,0,0] neg_lo:[1,0,0] neg_hi:[1,0,0]
v_pk_fma_f32 v[84:85], v[24:25], v[66:67], v[42:43] op_sel:[1,0,0]
v_pk_fma_f32 v[40:41], v[24:25], v[68:69], v[70:71] op_sel_hi:[0,1,1]
v_pk_fma_f32 v[42:43], v[24:25], v[84:85], v[86:87] op_sel_hi:[0,1,1]
v_pk_fma_f32 v[70:71], v[24:25], v[84:85], v[40:41] op_sel:[1,0,0] neg_lo:[1,0,0] neg_hi:[1,0,0]
v_pk_fma_f32 v[86:87], v[24:25], v[68:69], v[42:43] op_sel:[1,0,0]
v_pk_fma_f32 v[40:41], v[24:25], v[70:71], v[72:73] op_sel_hi:[0,1,1]
v_pk_fma_f32 v[42:43], v[24:25], v[86:87], v[88:89] op_sel_hi:[0,1,1]
v_pk_fma_f32 v[72:73], v[24:25], v[86:87], v[40:41] op_sel:[1,0,0] neg_lo:[1,0,0] neg_hi:[1,0,0]
v_pk_fma_f32 v[88:89], v[24:25], v[70:71], v[42:43] op_sel:[1,0,0]
v_pk_fma_f32 v[40:41], v[24:25], v[72:73], v[74:75] op_sel_hi:[0,1,1]
v_pk_fma_f32 v[42:43], v[24:25], v[88:89], v[90:91] op_sel_hi:[0,1,1]
v_pk_fma_f32 v[74:75], v[24:25], v[88:89], v[40:41] op_sel:[1,0,0] neg_lo:[1,0,0] neg_hi:[1,0,0]
v_pk_fma_f32 v[90:91], v[24:25], v[72:73], v[42:43] op_sel:[1,0,0]
v_pk_fma_f32 v[40:41], v[24:25], v[74:75], v[76:77] op_sel_hi:[0,1,1]
v_pk_fma_f32 v[42:43], v[24:25], v[90:91], v[92:93] op_sel_hi:[0,1,1]
v_pk_fma_f32 v[76:77], v[24:25], v[90:91], v[40:41] op_sel:[1,0,0] neg_lo:[1,0,0] neg_hi:[1,0,0]
v_pk_fma_f32 v[92:93], v[24:25], v[74:75], v[42:43] op_sel:[1,0,0]
v_pk_fma_f32 v[40:41], v[24:25], v[76:77], v[78:79] op_sel_hi:[0,1,1]
v_pk_fma_f32 v[42:43], v[24:25], v[92:93], v[94:95] op_sel_hi:[0,1,1]
v_pk_fma_f32 v[78:79], v[24:25], v[92:93], v[40:41] op_sel:[1,0,0] neg_lo:[1,0,0] neg_hi:[1,0,0]
v_pk_fma_f32 v[94:95], v[24:25], v[76:77], v[42:43] op_sel:[1,0,0]
v_pk_fma_f32 v[40:41], v[24:25], v[78:79], v[96:97] op_sel_hi:[0,1,1]
v_pk_fma_f32 v[42:43], v[24:25], v[94:95], v[112:113] op_sel_hi:[0,1,1]
v_pk_fma_f32 v[96:97], v[24:25], v[94:95], v[40:41] op_sel:[1,0,0] neg_lo:[1,0,0] neg_hi:[1,0,0]
v_pk_fma_f32 v[112:113], v[24:25], v[78:79], v[42:43] op_sel:[1,0,0]
v_pk_fma_f32 v[40:41], v[24:25], v[96:97], v[98:99] op_sel_hi:[0,1,1]
v_pk_fma_f32 v[42:43], v[24:25], v[112:113], v[114:115] op_sel_hi:[0,1,1]
v_pk_fma_f32 v[98:99], v[24:25], v[112:113], v[40:41] op_sel:[1,0,0] neg_lo:[1,0,0] neg_hi:[1,0,0]
v_pk_fma_f32 v[114:115], v[24:25], v[96:97], v[42:43] op_sel:[1,0,0]
v_pk_fma_f32 v[40:41], v[24:25], v[98:99], v[100:101] op_sel_hi:[0,1,1]
v_pk_fma_f32 v[42:43], v[24:25], v[114:115], v[116:117] op_sel_hi:[0,1,1]
v_pk_fma_f32 v[100:101], v[24:25], v[114:115], v[40:41] op_sel:[1,0,0] neg_lo:[1,0,0] neg_hi:[1,0,0]
v_pk_fma_f32 v[116:117], v[24:25], v[98:99], v[42:43] op_sel:[1,0,0]
v_pk_fma_f32 v[40:41], v[24:25], v[100:101], v[102:103] op_sel_hi:[0,1,1]
v_pk_fma_f32 v[42:43], v[24:25], v[116:117], v[118:119] op_sel_hi:[0,1,1]
v_pk_fma_f32 v[102:103], v[24:25], v[116:117], v[40:41] op_sel:[1,0,0] neg_lo:[1,0,0] neg_hi:[1,0,0]
v_pk_fma_f32 v[118:119], v[24:25], v[100:101], v[42:43] op_sel:[1,0,0]
v_pk_fma_f32 v[40:41], v[24:25], v[102:103], v[104:105] op_sel_hi:[0,1,1]
v_pk_fma_f32 v[42:43], v[24:25], v[118:119], v[120:121] op_sel_hi:[0,1,1]
v_pk_fma_f32 v[104:105], v[24:25], v[118:119], v[40:41] op_sel:[1,0,0] neg_lo:[1,0,0] neg_hi:[1,0,0]
v_pk_fma_f32 v[120:121], v[24:25], v[102:103], v[42:43] op_sel:[1,0,0]
v_pk_fma_f32 v[40:41], v[24:25], v[104:105], v[106:107] op_sel_hi:[0,1,1]
v_pk_fma_f32 v[42:43], v[24:25], v[120:121], v[122:123] op_sel_hi:[0,1,1]
v_pk_fma_f32 v[106:107], v[24:25], v[120:121], v[40:41] op_sel:[1,0,0] neg_lo:[1,0,0] neg_hi:[1,0,0]
v_pk_fma_f32 v[122:123], v[24:25], v[104:105], v[42:43] op_sel:[1,0,0]
v_pk_fma_f32 v[40:41], v[24:25], v[106:107], v[108:109] op_sel_hi:[0,1,1]
v_pk_fma_f32 v[42:43], v[24:25], v[122:123], v[124:125] op_sel_hi:[0,1,1]
v_pk_fma_f32 v[108:109], v[24:25], v[122:123], v[40:41] op_sel:[1,0,0] neg_lo:[1,0,0] neg_hi:[1,0,0]
v_pk_fma_f32 v[124:125], v[24:25], v[106:107], v[42:43] op_sel:[1,0,0]
v_pk_fma_f32 v[40:41], v[24:25], v[108:109], v[110:111] op_sel_hi:[0,1,1]
v_pk_fma_f32 v[42:43], v[24:25], v[124:125], v[126:127] op_sel_hi:[0,1,1]
v_pk_fma_f32 v[110:111], v[24:25], v[124:125], v[40:41] op_sel:[1,0,0] neg_lo:[1,0,0] neg_hi:[1,0,0]
v_pk_fma_f32 v[126:127], v[24:25], v[108:109], v[42:43] op_sel:[1,0,0]
v_fma_f32 v40, v28, v110, v111
v_fma_f32 v41, v28, v126, v127
v_fma_f32 v32, -v29, v126, v40
v_fma_f32 v33, v29, v110, v41
ds_write_b64 v15, v[32:33]
s_sub_u32 s60, s35, 1
s_lshl_b32 s60, s60, 14
v_lshlrev_b32 v16, 4, v4
v_lshlrev_b32 v17, 14, v5
v_sub_u32 v17, v16, v17
v_add_u32 v128, s60, v17
s_lshl_b32 s60, s35, 14
v_add_u32 v16, s60, v16
v_lshlrev_b32 v17, 30, v5
v_or_b32 v16, v16, v17
s_waitcnt lgkmcnt(0)
s_barrier
ds_read_b128 v[144:147], v14
ds_read_b128 v[148:151], v14 offset:16
L_n44:
s_waitcnt vmcnt(0)
v_readfirstlane_b32 s37, v13
s_nop 0
s_cmp_lg_u32 s37, 0
s_cbranch_scc1 L_ng45
global_load_dword v13, v12, s[30:31] sc1
s_branch L_n44
L_ng45:
v_mov_b32 v46, s37
v_mov_b32 v47, s37
s_getreg_b32 s60, hwreg(HW_REG_XCC_ID, 0, 4)
s_lshl_b32 s61, s37, 4
s_or_b32 s100, s60, s61
v_mov_b32 v60, s100
s_lshr_b32 s101, s36, 3
s_lshl_b32 s60, s35, 11
s_add_u32 s60, s60, 32768
s_lshl_b32 s61, s36, 7
s_add_u32 s61, s61, s60
v_mov_b32 v61, s61
s_lshl_b32 s61, s101, 10
s_add_u32 s60, s60, s61
v_and_b32 v62, 7, v1
v_lshl_add_u32 v62, v62, 7, s60
s_waitcnt lgkmcnt(0)
v_fma_f32 v40, v20, v144, v146
v_fma_f32 v41, v20, v145, v147
v_fma_f32 v48, -v21, v145, v40
v_fma_f32 v49, v21, v144, v41
v_fma_f32 v40, v20, v48, v148
v_fma_f32 v41, v20, v49, v149
v_fma_f32 v50, -v21, v49, v40
v_fma_f32 v51, v21, v48, v41
v_fma_f32 v40, v20, v50, v150
v_fma_f32 v41, v20, v51, v151
v_fma_f32 v44, -v21, v51, v40
v_fma_f32 v45, v21, v50, v41
s_cmp_lg_u32 s68, 0
s_cbranch_scc1 L_np46
buffer_store_dwordx4 v[44:47], v16, s[40:43], 0 offen sc1
s_cmp_lg_u32 s66, 0
s_cbranch_scc1 L_np46
s_mov_b64 exec, 1
global_store_dword v61, v60, s[32:33] sc1
s_mov_b64 exec, -1
L_np46:
v_mov_b32 v17, 0x40000000
v_subrev_u32 v129, 32768, v128
v_subrev_u32 v130, 65536, v128
v_subrev_u32 v131, 98304, v128
v_subrev_u32 v132, 131072, v128
v_subrev_u32 v133, 163840, v128
v_subrev_u32 v134, 196608, v128
v_subrev_u32 v135, 229376, v128
v_cmp_le_i32 vcc, 0, v128
s_nop 1
v_cndmask_b32 v136, 0, v46, vcc
v_cndmask_b32 v128, v17, v128, vcc
v_cmp_le_i32 vcc, 0, v129
s_nop 1
v_cndmask_b32 v137, 0, v46, vcc
v_cndmask_b32 v129, v17, v129, vcc
v_cmp_le_i32 vcc, 0, v130
s_nop 1
v_cndmask_b32 v138, 0, v46, vcc
v_cndmask_b32 v130, v17, v130, vcc
v_cmp_le_i32 vcc, 0, v131
s_nop 1
v_cndmask_b32 v139, 0, v46, vcc
v_cndmask_b32 v131, v17, v131, vcc
v_cmp_le_i32 vcc, 0, v132
s_nop 1
v_cndmask_b32 v140, 0, v46, vcc
v_cndmask_b32 v132, v17, v132, vcc
v_cmp_le_i32 vcc, 0, v133
s_nop 1
v_cndmask_b32 v141, 0, v46, vcc
v_cndmask_b32 v133, v17, v133, vcc
v_cmp_le_i32 vcc, 0, v134
s_nop 1
v_cndmask_b32 v142, 0, v46, vcc
v_cndmask_b32 v134, v17, v134, vcc
v_cmp_le_i32 vcc, 0, v135
s_nop 1
v_cndmask_b32 v143, 0, v46, vcc
v_cndmask_b32 v135, v17, v135, vcc
s_lshl_b32 s60, s35, 1
s_add_u32 s60, s60, s68
s_lshl_b32 s60, s60, 12
s_add_u32 s60, s60, 393216
s_lshl_b32 s61, s101, 11
s_add_u32 s61, s61, s60
v_and_b32 v18, 15, v1
v_lshl_add_u32 v18, v18, 7, s61
s_lshl_b32 s61, s36, 8
s_add_u32 s60, s60, s61
s_lshl_b32 s61, s66, 7
s_add_u32 s60, s60, s61
v_mov_b32 v19, s60
global_load_dword v246, v18, s[32:33] sc1
v_mul_f32 v52, v27, v25
v_mul_f32 v53, v27, v24
v_fma_f32 v208, v26, v24, -v52
v_fma_f32 v209, v26, v25, v53
v_pk_mul_f32 v[52:53], v[26:27], v[64:65] op_sel_hi:[0,1]
v_pk_mul_f32 v[54:55], v[26:27], v[80:81] op_sel_hi:[0,1] neg_lo:[1,0] neg_hi:[1,0]
v_mul_f32 v58, v209, v25
v_mul_f32 v59, v209, v24
v_pk_fma_f32 v[54:55], v[26:27], v[64:65], v[54:55] op_sel:[1,0,0] neg_lo:[1,0,0] neg_hi:[1,0,0]
v_pk_fma_f32 v[64:65], v[26:27], v[80:81], v[52:53] op_sel:[1,0,0] neg_lo:[1,0,0] neg_hi:[1,0,0]
v_mov_b64 v[80:81], v[54:55]
v_fma_f32 v210, v208, v24, -v58
v_fma_f32 v211, v208, v25, v59
v_pk_mul_f32 v[52:53], v[26:27], v[66:67] op_sel_hi:[0,1]
v_pk_mul_f32 v[54:55], v[26:27], v[82:83] op_sel_hi:[0,1] neg_lo:[1,0] neg_hi:[1,0]
v_mul_f32 v58, v211, v25
v_mul_f32 v59, v211, v24
v_pk_fma_f32 v[54:55], v[26:27], v[66:67], v[54:55] op_sel:[1,0,0] neg_lo:[1,0,0] neg_hi:[1,0,0]
v_pk_fma_f32 v[66:67], v[26:27], v[82:83], v[52:53] op_sel:[1,0,0] neg_lo:[1,0,0] neg_hi:[1,0,0]
v_mov_b64 v[82:83], v[54:55]
v_fma_f32 v212, v210, v24, -v58
v_fma_f32 v213, v210, v25, v59
v_pk_mul_f32 v[52:53], v[26:27], v[68:69] op_sel_hi:[0,1]
v_pk_mul_f32 v[54:55], v[26:27], v[84:85] op_sel_hi:[0,1] neg_lo:[1,0] neg_hi:[1,0]
v_mul_f32 v58, v213, v25
v_mul_f32 v59, v213, v24
v_pk_fma_f32 v[54:55], v[26:27], v[68:69], v[54:55] op_sel:[1,0,0] neg_lo:[1,0,0] neg_hi:[1,0,0]
v_pk_fma_f32 v[68:69], v[26:27], v[84:85], v[52:53] op_sel:[1,0,0] neg_lo:[1,0,0] neg_hi:[1,0,0]
v_mov_b64 v[84:85], v[54:55]
v_fma_f32 v214, v212, v24, -v58
v_fma_f32 v215, v212, v25, v59
v_pk_mul_f32 v[52:53], v[26:27], v[70:71] op_sel_hi:[0,1]
v_pk_mul_f32 v[54:55], v[26:27], v[86:87] op_sel_hi:[0,1] neg_lo:[1,0] neg_hi:[1,0]
v_mul_f32 v58, v215, v25
v_mul_f32 v59, v215, v24
v_pk_fma_f32 v[54:55], v[26:27], v[70:71], v[54:55] op_sel:[1,0,0] neg_lo:[1,0,0] neg_hi:[1,0,0]
v_pk_fma_f32 v[70:71], v[26:27], v[86:87], v[52:53] op_sel:[1,0,0] neg_lo:[1,0,0] neg_hi:[1,0,0]
v_mov_b64 v[86:87], v[54:55]
v_fma_f32 v216, v214, v24, -v58
v_fma_f32 v217, v214, v25, v59
v_pk_mul_f32 v[52:53], v[26:27], v[72:73] op_sel_hi:[0,1]
v_pk_mul_f32 v[54:55], v[26:27], v[88:89] op_sel_hi:[0,1] neg_lo:[1,0] neg_hi:[1,0]
v_mul_f32 v58, v217, v25
v_mul_f32 v59, v217, v24
v_pk_fma_f32 v[54:55], v[26:27], v[72:73], v[54:55] op_sel:[1,0,0] neg_lo:[1,0,0] neg_hi:[1,0,0]
v_pk_fma_f32 v[72:73], v[26:27], v[88:89], v[52:53] op_sel:[1,0,0] neg_lo:[1,0,0] neg_hi:[1,0,0]
v_mov_b64 v[88:89], v[54:55]
v_fma_f32 v218, v216, v24, -v58
v_fma_f32 v219, v216, v25, v59
v_pk_mul_f32 v[52:53], v[26:27], v[74:75] op_sel_hi:[0,1]
v_pk_mul_f32 v[54:55], v[26:27], v[90:91] op_sel_hi:[0,1] neg_lo:[1,0] neg_hi:[1,0]
v_mul_f32 v58, v219, v25
v_mul_f32 v59, v219, v24
v_pk_fma_f32 v[54:55], v[26:27], v[74:75], v[54:55] op_sel:[1,0,0] neg_lo:[1,0,0] neg_hi:[1,0,0]
v_pk_fma_f32 v[74:75], v[26:27], v[90:91], v[52:53] op_sel:[1,0,0] neg_lo:[1,0,0] neg_hi:[1,0,0]
v_mov_b64 v[90:91], v[54:55]
v_fma_f32 v220, v218, v24, -v58
v_fma_f32 v221, v218, v25, v59
v_pk_mul_f32 v[52:53], v[26:27], v[76:77] op_sel_hi:[0,1]
v_pk_mul_f32 v[54:55], v[26:27], v[92:93] op_sel_hi:[0,1] neg_lo:[1,0] neg_hi:[1,0]
v_mul_f32 v58, v221, v25
v_mul_f32 v59, v221, v24
v_pk_fma_f32 v[54:55], v[26:27], v[76:77], v[54:55] op_sel:[1,0,0] neg_lo:[1,0,0] neg_hi:[1,0,0]
v_pk_fma_f32 v[76:77], v[26:27], v[92:93], v[52:53] op_sel:[1,0,0] neg_lo:[1,0,0] neg_hi:[1,0,0]
v_mov_b64 v[92:93], v[54:55]
v_fma_f32 v222, v220, v24, -v58
v_fma_f32 v223, v220, v25, v59
v_pk_mul_f32 v[52:53], v[26:27], v[78:79] op_sel_hi:[0,1]
v_pk_mul_f32 v[54:55], v[26:27], v[94:95] op_sel_hi:[0,1] neg_lo:[1,0] neg_hi:[1,0]
v_mul_f32 v58, v223, v25
v_mul_f32 v59, v223, v24
v_pk_fma_f32 v[54:55], v[26:27], v[78:79], v[54:55] op_sel:[1,0,0] neg_lo:[1,0,0] neg_hi:[1,0,0]
v_pk_fma_f32 v[78:79], v[26:27], v[94:95], v[52:53] op_sel:[1,0,0] neg_lo:[1,0,0] neg_hi:[1,0,0]
v_mov_b64 v[94:95], v[54:55]
v_fma_f32 v224, v222, v24, -v58
v_fma_f32 v225, v222, v25, v59
v_pk_mul_f32 v[52:53], v[26:27], v[96:97] op_sel_hi:[0,1]
v_pk_mul_f32 v[54:55], v[26:27], v[112:113] op_sel_hi:[0,1] neg_lo:[1,0] neg_hi:[1,0]
v_mul_f32 v58, v225, v25
v_mul_f32 v59, v225, v24
v_pk_fma_f32 v[54:55], v[26:27], v[96:97], v[54:55] op_sel:[1,0,0] neg_lo:[1,0,0] neg_hi:[1,0,0]
v_pk_fma_f32 v[96:97], v[26:27], v[112:113], v[52:53] op_sel:[1,0,0] neg_lo:[1,0,0] neg_hi:[1,0,0]
v_mov_b64 v[112:113], v[54:55]
v_fma_f32 v226, v224, v24, -v58
v_fma_f32 v227, v224, v25, v59
v_pk_mul_f32 v[52:53], v[26:27], v[98:99] op_sel_hi:[0,1]
v_pk_mul_f32 v[54:55], v[26:27], v[114:115] op_sel_hi:[0,1] neg_lo:[1,0] neg_hi:[1,0]
v_mul_f32 v58, v227, v25
v_mul_f32 v59, v227, v24
v_pk_fma_f32 v[54:55], v[26:27], v[98:99], v[54:55] op_sel:[1,0,0] neg_lo:[1,0,0] neg_hi:[1,0,0]
v_pk_fma_f32 v[98:99], v[26:27], v[114:115], v[52:53] op_sel:[1,0,0] neg_lo:[1,0,0] neg_hi:[1,0,0]
v_mov_b64 v[114:115], v[54:55]
v_fma_f32 v228, v226, v24, -v58
v_fma_f32 v229, v226, v25, v59
v_pk_mul_f32 v[52:53], v[26:27], v[100:101] op_sel_hi:[0,1]
v_pk_mul_f32 v[54:55], v[26:27], v[116:117] op_sel_hi:[0,1] neg_lo:[1,0] neg_hi:[1,0]
v_mul_f32 v58, v229, v25
v_mul_f32 v59, v229, v24
v_pk_fma_f32 v[54:55], v[26:27], v[100:101], v[54:55] op_sel:[1,0,0] neg_lo:[1,0,0] neg_hi:[1,0,0]
v_pk_fma_f32 v[100:101], v[26:27], v[116:117], v[52:53] op_sel:[1,0,0] neg_lo:[1,0,0] neg_hi:[1,0,0]
v_mov_b64 v[116:117], v[54:55]
v_fma_f32 v230, v228, v24, -v58
v_fma_f32 v231, v228, v25, v59
v_pk_mul_f32 v[52:53], v[26:27], v[102:103] op_sel_hi:[0,1]
v_pk_mul_f32 v[54:55], v[26:27], v[118:119] op_sel_hi:[0,1] neg_lo:[1,0] neg_hi:[1,0]
v_mul_f32 v58, v231, v25
v_mul_f32 v59, v231, v24
v_pk_fma_f32 v[54:55], v[26:27], v[102:103], v[54:55] op_sel:[1,0,0] neg_lo:[1,0,0] neg_hi:[1,0,0]
v_pk_fma_f32 v[102:103], v[26:27], v[118:119], v[52:53] op_sel:[1,0,0] neg_lo:[1,0,0] neg_hi:[1,0,0]
v_mov_b64 v[118:119], v[54:55]
v_fma_f32 v232, v230, v24, -v58
v_fma_f32 v233, v230, v25, v59
v_pk_mul_f32 v[52:53], v[26:27], v[104:105] op_sel_hi:[0,1]
v_pk_mul_f32 v[54:55], v[26:27], v[120:121] op_sel_hi:[0,1] neg_lo:[1,0] neg_hi:[1,0]
v_mul_f32 v58, v233, v25
v_mul_f32 v59, v233, v24
v_pk_fma_f32 v[54:55], v[26:27], v[104:105], v[54:55] op_sel:[1,0,0] neg_lo:[1,0,0] neg_hi:[1,0,0]
v_pk_fma_f32 v[104:105], v[26:27], v[120:121], v[52:53] op_sel:[1,0,0] neg_lo:[1,0,0] neg_hi:[1,0,0]
v_mov_b64 v[120:121], v[54:55]
v_fma_f32 v234, v232, v24, -v58
v_fma_f32 v235, v232, v25, v59
v_pk_mul_f32 v[52:53], v[26:27], v[106:107] op_sel_hi:[0,1]
v_pk_mul_f32 v[54:55], v[26:27], v[122:123] op_sel_hi:[0,1] neg_lo:[1,0] neg_hi:[1,0]
v_mul_f32 v58, v235, v25
v_mul_f32 v59, v235, v24
v_pk_fma_f32 v[54:55], v[26:27], v[106:107], v[54:55] op_sel:[1,0,0] neg_lo:[1,0,0] neg_hi:[1,0,0]
v_pk_fma_f32 v[106:107], v[26:27], v[122:123], v[52:53] op_sel:[1,0,0] neg_lo:[1,0,0] neg_hi:[1,0,0]
v_mov_b64 v[122:123], v[54:55]
v_fma_f32 v236, v234, v24, -v58
v_fma_f32 v237, v234, v25, v59
v_pk_mul_f32 v[52:53], v[26:27], v[108:109] op_sel_hi:[0,1]
v_pk_mul_f32 v[54:55], v[26:27], v[124:125] op_sel_hi:[0,1] neg_lo:[1,0] neg_hi:[1,0]
v_mul_f32 v58, v237, v25
v_mul_f32 v59, v237, v24
v_pk_fma_f32 v[54:55], v[26:27], v[108:109], v[54:55] op_sel:[1,0,0] neg_lo:[1,0,0] neg_hi:[1,0,0]
v_pk_fma_f32 v[108:109], v[26:27], v[124:125], v[52:53] op_sel:[1,0,0] neg_lo:[1,0,0] neg_hi:[1,0,0]
v_mov_b64 v[124:125], v[54:55]
v_fma_f32 v238, v236, v24, -v58
v_fma_f32 v239, v236, v25, v59
v_pk_mul_f32 v[52:53], v[26:27], v[110:111] op_sel_hi:[0,1]
v_pk_mul_f32 v[54:55], v[26:27], v[126:127] op_sel_hi:[0,1] neg_lo:[1,0] neg_hi:[1,0]
v_mov_b32 v56, v110
v_mov_b32 v57, v126
v_pk_fma_f32 v[54:55], v[26:27], v[110:111], v[54:55] op_sel:[1,0,0] neg_lo:[1,0,0] neg_hi:[1,0,0]
v_pk_fma_f32 v[110:111], v[26:27], v[126:127], v[52:53] op_sel:[1,0,0] neg_lo:[1,0,0] neg_hi:[1,0,0]
v_mov_b64 v[126:127], v[54:55]
buffer_load_dwordx4 v[160:163], v128, s[40:43], 0 offen sc1
buffer_load_dwordx4 v[164:167], v129, s[40:43], 0 offen sc1
buffer_load_dwordx4 v[168:171], v130, s[40:43], 0 offen sc1
buffer_load_dwordx4 v[172:175], v131, s[40:43], 0 offen sc1
buffer_load_dwordx4 v[176:179], v132, s[40:43], 0 offen sc1
buffer_load_dwordx4 v[180:183], v133, s[40:43], 0 offen sc1
buffer_load_dwordx4 v[184:187], v134, s[40:43], 0 offen sc1
buffer_load_dwordx4 v[188:191], v135, s[40:43], 0 offen sc1
global_load_dword v63, v62, s[32:33] sc1
s_mov_b32 s69, 0
L_poll47:
s_mov_b64 s[60:61], 0
s_waitcnt vmcnt(8)
v_cmp_ne_u32 vcc, v162, v136
s_nop 0
s_or_b64 s[60:61], s[60:61], vcc
v_cmp_ne_u32 vcc, v163, v136
s_nop 0
s_or_b64 s[60:61], s[60:61], vcc
s_waitcnt vmcnt(7)
v_cmp_ne_u32 vcc, v166, v137
s_nop 0
s_or_b64 s[60:61], s[60:61], vcc
v_cmp_ne_u32 vcc, v167, v137
s_nop 0
s_or_b64 s[60:61], s[60:61], vcc
s_waitcnt vmcnt(6)
v_cmp_ne_u32 vcc, v170, v138
s_nop 0
s_or_b64 s[60:61], s[60:61], vcc
v_cmp_ne_u32 vcc, v171, v138
s_nop 0
s_or_b64 s[60:61], s[60:61], vcc
s_waitcnt vmcnt(5)
v_cmp_ne_u32 vcc, v174, v139
s_nop 0
s_or_b64 s[60:61], s[60:61], vcc
v_cmp_ne_u32 vcc, v175, v139
s_nop 0
s_or_b64 s[60:61], s[60:61], vcc
s_waitcnt vmcnt(4)
v_cmp_ne_u32 vcc, v178, v140
s_nop 0
s_or_b64 s[60:61], s[60:61], vcc
v_cmp_ne_u32 vcc, v179, v140
s_nop 0
s_or_b64 s[60:61], s[60:61], vcc
s_waitcnt vmcnt(3)
v_cmp_ne_u32 vcc, v182, v141
s_nop 0
s_or_b64 s[60:61], s[60:61], vcc
v_cmp_ne_u32 vcc, v183, v141
s_nop 0
s_or_b64 s[60:61], s[60:61], vcc
s_waitcnt vmcnt(2)
v_cmp_ne_u32 vcc, v186, v142
s_nop 0
s_or_b64 s[60:61], s[60:61], vcc
v_cmp_ne_u32 vcc, v187, v142
s_nop 0
s_or_b64 s[60:61], s[60:61], vcc
s_waitcnt vmcnt(1)
v_cmp_ne_u32 vcc, v190, v143
s_nop 0
s_or_b64 s[60:61], s[60:61], vcc
v_cmp_ne_u32 vcc, v191, v143
s_nop 0
s_or_b64 s[60:61], s[60:61], vcc
s_waitcnt vmcnt(0)
v_xor_b32 v63, v60, v63
v_cmp_lt_u32 vcc, 15, v63
s_nop 0
s_or_b64 s[60:61], s[60:61], vcc
s_add_u32 s69, s69, 1
s_cmp_eq_u64 s[60:61], 0
s_cbranch_scc1 L_polled48
s_cmp_ge_u32 s69, 200000
s_cbranch_scc1 L_polled48
buffer_load_dwordx4 v[160:163], v128, s[40:43], 0 offen sc1
buffer_load_dwordx4 v[164:167], v129, s[40:43], 0 offen sc1
buffer_load_dwordx4 v[168:171], v130, s[40:43], 0 offen sc1
buffer_load_dwordx4 v[172:175], v131, s[40:43], 0 offen sc1
buffer_load_dwordx4 v[176:179], v132, s[40:43], 0 offen sc1
buffer_load_dwordx4 v[180:183], v133, s[40:43], 0 offen sc1
buffer_load_dwordx4 v[184:187], v134, s[40:43], 0 offen sc1
buffer_load_dwordx4 v[188:191], v135, s[40:43], 0 offen sc1
global_load_dword v63, v62, s[32:33] sc1
s_branch L_poll47
L_polled48:
v_cmp_ne_u32 vcc, 0, v63
s_nop 0
s_cmp_eq_u64 vcc, 0
s_cselect_b32 s100, 1, 0
s_cmp_lt_u32 s34, 2
s_cbranch_scc1 L_ct49
s_lshl_b32 s60, s101, 10
s_bfe_u32 s61, s2, 0x20001
s_lshl_b32 s61, s61, 19
s_add_u32 s60, s60, s61
s_lshr_b32 s61, s2, 3
s_lshl_b32 s61, s61, 14
s_add_u32 s60, s60, s61
v_lshrrev_b32 v8, 3, v1
v_lshlrev_b32 v8, 11, v8
v_and_b32 v9, 7, v1
v_lshl_add_u32 v8, v9, 7, v8
v_add_u32 v8, s60, v8
s_cmp_eq_u32 s66, 0
s_cselect_b32 s60, s20, s22
s_cselect_b32 s61, s21, s23
global_load_dword v246, v8, s[60:61]
L_ct49:
v_fma_f32 v40, v2, v188, v184
v_fma_f32 v41, v2, v189, v185
v_fma_f32 v48, -v3, v189, v40
v_fma_f32 v49, v3, v188, v41
v_fma_f32 v40, v2, v48, v180
v_fma_f32 v41, v2, v49, v181
v_fma_f32 v188, -v3, v49, v40
v_fma_f32 v189, v3, v48, v41
v_fma_f32 v40, v2, v188, v176
v_fma_f32 v41, v2, v189, v177
v_fma_f32 v48, -v3, v189, v40
v_fma_f32 v49, v3, v188, v41
v_fma_f32 v40, v2, v48, v172
v_fma_f32 v41, v2, v49, v173
v_fma_f32 v188, -v3, v49, v40
v_fma_f32 v189, v3, v48, v41
v_fma_f32 v40, v2, v188, v168
v_fma_f32 v41, v2, v189, v169
v_fma_f32 v48, -v3, v189, v40
v_fma_f32 v49, v3, v188, v41
v_fma_f32 v40, v2, v48, v164
v_fma_f32 v41, v2, v49, v165
v_fma_f32 v188, -v3, v49, v40
v_fma_f32 v189, v3, v48, v41
v_fma_f32 v40, v2, v188, v160
v_fma_f32 v41, v2, v189, v161
v_fma_f32 v48, -v3, v189, v40
v_fma_f32 v49, v3, v188, v41
v_mov_b32 v50, v48
v_mov_b32 v51, v49
s_nop 0
v_permlane32_swap_b32 v48, v50
v_permlane32_swap_b32 v49, v51
v_fma_f32 v40, v30, v50, v48
v_fma_f32 v41, v30, v51, v49
v_fma_f32 v192, -v31, v51, v40
v_fma_f32 v193, v31, v50, v41
v_fma_f32 v40, v20, v192, v144
v_fma_f32 v41, v20, v193, v145
v_fma_f32 v194, -v21, v193, v40
v_fma_f32 v195, v21, v192, v41
v_fma_f32 v40, v20, v194, v146
v_fma_f32 v41, v20, v195, v147
v_fma_f32 v196, -v21, v195, v40
v_fma_f32 v197, v21, v194, v41
v_fma_f32 v40, v20, v196, v148
v_fma_f32 v41, v20, v197, v149
v_fma_f32 v198, -v21, v197, v40
v_fma_f32 v199, v21, v196, v41
s_cmp_eq_u32 s68, 0
s_cbranch_scc1 L_wt050
v_mov_b64 v[192:193], v[196:197]
v_mov_b64 v[194:195], v[198:199]
L_wt050:
v_cmp_eq_u32 vcc, 1, v5
s_nop 1
v_cndmask_b32 v48, v192, v194, vcc
v_cndmask_b32 v50, v193, v195, vcc
v_fma_f32 v40, v28, v48, v56
v_fma_f32 v41, v28, v50, v57
v_fma_f32 v49, -v29, v50, v40
v_fma_f32 v51, v29, v48, v41
s_lshl_b32 s60, s35, 1
s_add_u32 s69, s60, s68
s_lshl_b32 s60, s69, 18
s_lshl_b32 s61, s36, 13
s_add_u32 s60, s60, s61
s_lshl_b32 s61, s66, 11
s_add_u32 s60, s60, s61
v_pk_fma_f32 v[64:65], v[208:209], v[48:49], v[64:65] op_sel_hi:[0,1,1]
v_pk_fma_f32 v[80:81], v[208:209], v[50:51], v[80:81] op_sel_hi:[0,1,1] neg_lo:[1,0,0] neg_hi:[1,0,0]
v_pk_fma_f32 v[64:65], v[208:209], v[50:51], v[64:65] op_sel:[1,0,0] neg_lo:[1,0,0] neg_hi:[1,0,0]
v_pk_fma_f32 v[80:81], v[208:209], v[48:49], v[80:81] op_sel:[1,0,0] neg_lo:[1,0,0] neg_hi:[1,0,0]
v_cvt_pk_bf16_f32 v128, v64, v65
v_cvt_pk_bf16_f32 v144, v80, v81
v_pk_fma_f32 v[66:67], v[210:211], v[48:49], v[66:67] op_sel_hi:[0,1,1]
v_pk_fma_f32 v[82:83], v[210:211], v[50:51], v[82:83] op_sel_hi:[0,1,1] neg_lo:[1,0,0] neg_hi:[1,0,0]
v_pk_fma_f32 v[66:67], v[210:211], v[50:51], v[66:67] op_sel:[1,0,0] neg_lo:[1,0,0] neg_hi:[1,0,0]
v_pk_fma_f32 v[82:83], v[210:211], v[48:49], v[82:83] op_sel:[1,0,0] neg_lo:[1,0,0] neg_hi:[1,0,0]
v_cvt_pk_bf16_f32 v129, v66, v67
v_cvt_pk_bf16_f32 v145, v82, v83
v_pk_fma_f32 v[68:69], v[212:213], v[48:49], v[68:69] op_sel_hi:[0,1,1]
v_pk_fma_f32 v[84:85], v[212:213], v[50:51], v[84:85] op_sel_hi:[0,1,1] neg_lo:[1,0,0] neg_hi:[1,0,0]
v_pk_fma_f32 v[68:69], v[212:213], v[50:51], v[68:69] op_sel:[1,0,0] neg_lo:[1,0,0] neg_hi:[1,0,0]
v_pk_fma_f32 v[84:85], v[212:213], v[48:49], v[84:85] op_sel:[1,0,0] neg_lo:[1,0,0] neg_hi:[1,0,0]
v_cvt_pk_bf16_f32 v130, v68, v69
v_cvt_pk_bf16_f32 v146, v84, v85
v_pk_fma_f32 v[70:71], v[214:215], v[48:49], v[70:71] op_sel_hi:[0,1,1]
v_pk_fma_f32 v[86:87], v[214:215], v[50:51], v[86:87] op_sel_hi:[0,1,1] neg_lo:[1,0,0] neg_hi:[1,0,0]
v_pk_fma_f32 v[70:71], v[214:215], v[50:51], v[70:71] op_sel:[1,0,0] neg_lo:[1,0,0] neg_hi:[1,0,0]
v_pk_fma_f32 v[86:87], v[214:215], v[48:49], v[86:87] op_sel:[1,0,0] neg_lo:[1,0,0] neg_hi:[1,0,0]
v_cvt_pk_bf16_f32 v131, v70, v71
v_cvt_pk_bf16_f32 v147, v86, v87
v_pk_fma_f32 v[72:73], v[216:217], v[48:49], v[72:73] op_sel_hi:[0,1,1]
v_pk_fma_f32 v[88:89], v[216:217], v[50:51], v[88:89] op_sel_hi:[0,1,1] neg_lo:[1,0,0] neg_hi:[1,0,0]
v_pk_fma_f32 v[72:73], v[216:217], v[50:51], v[72:73] op_sel:[1,0,0] neg_lo:[1,0,0] neg_hi:[1,0,0]
v_pk_fma_f32 v[88:89], v[216:217], v[48:49], v[88:89] op_sel:[1,0,0] neg_lo:[1,0,0] neg_hi:[1,0,0]
v_cvt_pk_bf16_f32 v132, v72, v73
v_cvt_pk_bf16_f32 v148, v88, v89
v_pk_fma_f32 v[74:75], v[218:219], v[48:49], v[74:75] op_sel_hi:[0,1,1]
v_pk_fma_f32 v[90:91], v[218:219], v[50:51], v[90:91] op_sel_hi:[0,1,1] neg_lo:[1,0,0] neg_hi:[1,0,0]
v_pk_fma_f32 v[74:75], v[218:219], v[50:51], v[74:75] op_sel:[1,0,0] neg_lo:[1,0,0] neg_hi:[1,0,0]
v_pk_fma_f32 v[90:91], v[218:219], v[48:49], v[90:91] op_sel:[1,0,0] neg_lo:[1,0,0] neg_hi:[1,0,0]
v_cvt_pk_bf16_f32 v133, v74, v75
v_cvt_pk_bf16_f32 v149, v90, v91
v_pk_fma_f32 v[76:77], v[220:221], v[48:49], v[76:77] op_sel_hi:[0,1,1]
v_pk_fma_f32 v[92:93], v[220:221], v[50:51], v[92:93] op_sel_hi:[0,1,1] neg_lo:[1,0,0] neg_hi:[1,0,0]
v_pk_fma_f32 v[76:77], v[220:221], v[50:51], v[76:77] op_sel:[1,0,0] neg_lo:[1,0,0] neg_hi:[1,0,0]
v_pk_fma_f32 v[92:93], v[220:221], v[48:49], v[92:93] op_sel:[1,0,0] neg_lo:[1,0,0] neg_hi:[1,0,0]
v_cvt_pk_bf16_f32 v134, v76, v77
v_cvt_pk_bf16_f32 v150, v92, v93
v_pk_fma_f32 v[78:79], v[222:223], v[48:49], v[78:79] op_sel_hi:[0,1,1]
v_pk_fma_f32 v[94:95], v[222:223], v[50:51], v[94:95] op_sel_hi:[0,1,1] neg_lo:[1,0,0] neg_hi:[1,0,0]
v_pk_fma_f32 v[78:79], v[222:223], v[50:51], v[78:79] op_sel:[1,0,0] neg_lo:[1,0,0] neg_hi:[1,0,0]
v_pk_fma_f32 v[94:95], v[222:223], v[48:49], v[94:95] op_sel:[1,0,0] neg_lo:[1,0,0] neg_hi:[1,0,0]
v_cvt_pk_bf16_f32 v135, v78, v79
v_cvt_pk_bf16_f32 v151, v94, v95
v_mfma_f32_32x32x16_bf16 v[160:175], v[128:131], v[248:251], 0
v_mfma_f32_32x32x16_bf16 v[160:175], v[132:135], v[252:255], v[160:175]
v_mfma_f32_32x32x16_bf16 v[176:191], v[144:147], v[248:251], 0
v_mfma_f32_32x32x16_bf16 v[176:191], v[148:151], v[252:255], v[176:191]
v_pk_fma_f32 v[96:97], v[224:225], v[48:49], v[96:97] op_sel_hi:[0,1,1]
v_pk_fma_f32 v[112:113], v[224:225], v[50:51], v[112:113] op_sel_hi:[0,1,1] neg_lo:[1,0,0] neg_hi:[1,0,0]
v_pk_fma_f32 v[96:97], v[224:225], v[50:51], v[96:97] op_sel:[1,0,0] neg_lo:[1,0,0] neg_hi:[1,0,0]
v_pk_fma_f32 v[112:113], v[224:225], v[48:49], v[112:113] op_sel:[1,0,0] neg_lo:[1,0,0] neg_hi:[1,0,0]
v_cvt_pk_bf16_f32 v136, v96, v97
v_cvt_pk_bf16_f32 v152, v112, v113
v_pk_fma_f32 v[98:99], v[226:227], v[48:49], v[98:99] op_sel_hi:[0,1,1]
v_pk_fma_f32 v[114:115], v[226:227], v[50:51], v[114:115] op_sel_hi:[0,1,1] neg_lo:[1,0,0] neg_hi:[1,0,0]
v_pk_fma_f32 v[98:99], v[226:227], v[50:51], v[98:99] op_sel:[1,0,0] neg_lo:[1,0,0] neg_hi:[1,0,0]
v_pk_fma_f32 v[114:115], v[226:227], v[48:49], v[114:115] op_sel:[1,0,0] neg_lo:[1,0,0] neg_hi:[1,0,0]
v_cvt_pk_bf16_f32 v137, v98, v99
v_cvt_pk_bf16_f32 v153, v114, v115
v_pk_fma_f32 v[100:101], v[228:229], v[48:49], v[100:101] op_sel_hi:[0,1,1]
v_pk_fma_f32 v[116:117], v[228:229], v[50:51], v[116:117] op_sel_hi:[0,1,1] neg_lo:[1,0,0] neg_hi:[1,0,0]
v_pk_fma_f32 v[100:101], v[228:229], v[50:51], v[100:101] op_sel:[1,0,0] neg_lo:[1,0,0] neg_hi:[1,0,0]
v_pk_fma_f32 v[116:117], v[228:229], v[48:49], v[116:117] op_sel:[1,0,0] neg_lo:[1,0,0] neg_hi:[1,0,0]
v_cvt_pk_bf16_f32 v138, v100, v101
v_cvt_pk_bf16_f32 v154, v116, v117
v_pk_fma_f32 v[102:103], v[230:231], v[48:49], v[102:103] op_sel_hi:[0,1,1]
v_pk_fma_f32 v[118:119], v[230:231], v[50:51], v[118:119] op_sel_hi:[0,1,1] neg_lo:[1,0,0] neg_hi:[1,0,0]
v_pk_fma_f32 v[102:103], v[230:231], v[50:51], v[102:103] op_sel:[1,0,0] neg_lo:[1,0,0] neg_hi:[1,0,0]
v_pk_fma_f32 v[118:119], v[230:231], v[48:49], v[118:119] op_sel:[1,0,0] neg_lo:[1,0,0] neg_hi:[1,0,0]
v_cvt_pk_bf16_f32 v139, v102, v103
v_cvt_pk_bf16_f32 v155, v118, v119
s_add_u32 s61, s60, 0
v_cvt_pk_bf16_f32 v64, v160, v161
v_cvt_pk_bf16_f32 v65, v162, v163
v_cvt_pk_bf16_f32 v66, v164, v165
v_cvt_pk_bf16_f32 v67, v166, v167
v_cvt_pk_bf16_f32 v68, v168, v169
v_cvt_pk_bf16_f32 v69, v170, v171
v_cvt_pk_bf16_f32 v70, v172, v173
v_cvt_pk_bf16_f32 v71, v174, v175
buffer_store_dwordx4 v[64:67], v11, s[44:47], s61 offen sc1
buffer_store_dwordx4 v[68:71], v11, s[44:47], s61 offen offset:1024 sc1
s_add_u32 s61, s60, 4096
v_cvt_pk_bf16_f32 v72, v176, v177
v_cvt_pk_bf16_f32 v73, v178, v179
v_cvt_pk_bf16_f32 v74, v180, v181
v_cvt_pk_bf16_f32 v75, v182, v183
v_cvt_pk_bf16_f32 v76, v184, v185
v_cvt_pk_bf16_f32 v77, v186, v187
v_cvt_pk_bf16_f32 v78, v188, v189
v_cvt_pk_bf16_f32 v79, v190, v191
buffer_store_dwordx4 v[72:75], v11, s[44:47], s61 offen sc1
buffer_store_dwordx4 v[76:79], v11, s[44:47], s61 offen offset:1024 sc1
v_pk_fma_f32 v[104:105], v[232:233], v[48:49], v[104:105] op_sel_hi:[0,1,1]
v_pk_fma_f32 v[120:121], v[232:233], v[50:51], v[120:121] op_sel_hi:[0,1,1] neg_lo:[1,0,0] neg_hi:[1,0,0]
v_pk_fma_f32 v[104:105], v[232:233], v[50:51], v[104:105] op_sel:[1,0,0] neg_lo:[1,0,0] neg_hi:[1,0,0]
v_pk_fma_f32 v[120:121], v[232:233], v[48:49], v[120:121] op_sel:[1,0,0] neg_lo:[1,0,0] neg_hi:[1,0,0]
v_cvt_pk_bf16_f32 v140, v104, v105
v_cvt_pk_bf16_f32 v156, v120, v121
v_pk_fma_f32 v[106:107], v[234:235], v[48:49], v[106:107] op_sel_hi:[0,1,1]
v_pk_fma_f32 v[122:123], v[234:235], v[50:51], v[122:123] op_sel_hi:[0,1,1] neg_lo:[1,0,0] neg_hi:[1,0,0]
v_pk_fma_f32 v[106:107], v[234:235], v[50:51], v[106:107] op_sel:[1,0,0] neg_lo:[1,0,0] neg_hi:[1,0,0]
v_pk_fma_f32 v[122:123], v[234:235], v[48:49], v[122:123] op_sel:[1,0,0] neg_lo:[1,0,0] neg_hi:[1,0,0]
v_cvt_pk_bf16_f32 v141, v106, v107
v_cvt_pk_bf16_f32 v157, v122, v123
v_pk_fma_f32 v[108:109], v[236:237], v[48:49], v[108:109] op_sel_hi:[0,1,1]
v_pk_fma_f32 v[124:125], v[236:237], v[50:51], v[124:125] op_sel_hi:[0,1,1] neg_lo:[1,0,0] neg_hi:[1,0,0]
v_pk_fma_f32 v[108:109], v[236:237], v[50:51], v[108:109] op_sel:[1,0,0] neg_lo:[1,0,0] neg_hi:[1,0,0]
v_pk_fma_f32 v[124:125], v[236:237], v[48:49], v[124:125] op_sel:[1,0,0] neg_lo:[1,0,0] neg_hi:[1,0,0]
v_cvt_pk_bf16_f32 v142, v108, v109
v_cvt_pk_bf16_f32 v158, v124, v125
v_pk_fma_f32 v[110:111], v[238:239], v[48:49], v[110:111] op_sel_hi:[0,1,1]
v_pk_fma_f32 v[126:127], v[238:239], v[50:51], v[126:127] op_sel_hi:[0,1,1] neg_lo:[1,0,0] neg_hi:[1,0,0]
v_pk_fma_f32 v[110:111], v[238:239], v[50:51], v[110:111] op_sel:[1,0,0] neg_lo:[1,0,0] neg_hi:[1,0,0]
v_pk_fma_f32 v[126:127], v[238:239], v[48:49], v[126:127] op_sel:[1,0,0] neg_lo:[1,0,0] neg_hi:[1,0,0]
v_cvt_pk_bf16_f32 v143, v110, v111
v_cvt_pk_bf16_f32 v159, v126, v127
v_mfma_f32_32x32x16_bf16 v[192:207], v[136:139], v[248:251], 0
v_mfma_f32_32x32x16_bf16 v[192:207], v[140:143], v[252:255], v[192:207]
v_mfma_f32_32x32x16_bf16 v[32:47], v[152:155], v[248:251], 0
v_mfma_f32_32x32x16_bf16 v[32:47], v[156:159], v[252:255], v[32:47]
s_add_u32 s61, s60, 131072
s_nop 8
v_cvt_pk_bf16_f32 v80, v192, v193
v_cvt_pk_bf16_f32 v81, v194, v195
v_cvt_pk_bf16_f32 v82, v196, v197
v_cvt_pk_bf16_f32 v83, v198, v199
v_cvt_pk_bf16_f32 v84, v200, v201
v_cvt_pk_bf16_f32 v85, v202, v203
v_cvt_pk_bf16_f32 v86, v204, v205
v_cvt_pk_bf16_f32 v87, v206, v207
buffer_store_dwordx4 v[80:83], v11, s[44:47], s61 offen sc1
buffer_store_dwordx4 v[84:87], v11, s[44:47], s61 offen offset:1024 sc1
s_add_u32 s61, s60, 135168
v_cvt_pk_bf16_f32 v88, v32, v33
v_cvt_pk_bf16_f32 v89, v34, v35
v_cvt_pk_bf16_f32 v90, v36, v37
v_cvt_pk_bf16_f32 v91, v38, v39
v_cvt_pk_bf16_f32 v92, v40, v41
v_cvt_pk_bf16_f32 v93, v42, v43
v_cvt_pk_bf16_f32 v94, v44, v45
v_cvt_pk_bf16_f32 v95, v46, v47
buffer_store_dwordx4 v[88:91], v11, s[44:47], s61 offen sc1
buffer_store_dwordx4 v[92:95], v11, s[44:47], s61 offen offset:1024 sc1
v_xor_b32 v20, 0, v7
v_add_u32 v24, 0x10000, v20
v_xor_b32 v21, 32, v7
v_add_u32 v25, 0x10000, v21
v_xor_b32 v22, 64, v7
v_add_u32 v26, 0x10000, v22
v_xor_b32 v23, 96, v7
v_add_u32 v27, 0x10000, v23
s_lshl_b32 s60, s66, 3
v_lshl_add_u32 v17, v5, 2, s60
v_lshlrev_b32 v28, 11, v17
v_lshl_add_u32 v28, v6, 2, v28
v_lshlrev_b32 v29, 13, v17
v_lshl_add_u32 v29, v6, 3, v29
v_lshlrev_b32 v30, 2, v6
v_mov_b32 v2, v11
v_mov_b32 v12, 126976
s_lshl_b32 s60, s34, 2
v_add_u32 v13, s60, v12
s_xor_b32 s60, s68, s101
s_xor_b32 s60, s60, 1
s_lshl_b32 s60, s60, 6
s_add_u32 s60, s60, s66
v_lshrrev_b32 v8, 3, v1
v_lshl_add_u32 v8, v8, 1, s60
v_lshlrev_b32 v8, 11, v8
v_and_b32 v9, 7, v1
v_lshrrev_b32 v10, 4, v1
v_xor_b32 v9, v9, v10
v_lshlrev_b32 v9, 4, v9
v_xor_b32 v10, 64, v9
v_add_u32 v144, v8, v9
v_add_u32 v145, v8, v10
v_add_u32 v145, 31744, v145
v_add_u32 v146, v8, v9
v_add_u32 v146, 63488, v146
v_add_u32 v147, v8, v10
v_add_u32 v147, 95232, v147
s_and_b32 s60, s36, 7
s_lshl_b32 s60, s60, 18
s_lshl_b32 s61, s101, 10
s_add_u32 s60, s60, s61
s_add_u32 s48, s20, s60
s_addc_u32 s49, s21, 0
s_sub_u32 s50, 262144, s61
s_mov_b32 s51, 0x20000
s_add_u32 s52, s22, s60
s_addc_u32 s53, s23, 0
s_sub_u32 s54, 262144, s61
s_mov_b32 s55, 0x20000
s_lshl_b32 s67, s34, 12
s_lshr_b32 s64, s35, 2
s_mul_i32 s64, s64, 256
s_and_b32 s60, s35, 0
s_mul_i32 s60, s60, 1024
s_add_u32 s64, s64, s60
s_lshl_b32 s65, s64, 6
s_and_b32 s61, s36, 7
s_lshl_b32 s61, s61, 1
s_add_u32 s61, s61, s101
s_lshl_b32 s61, s61, 7
s_lshl_b32 s60, s69, 17
s_add_u32 s60, s60, s61
s_add_u32 s56, s10, s60
s_addc_u32 s57, s11, 0
s_sub_u32 s58, 131072, s61
s_mov_b32 s59, 0x20000
s_add_u32 s26, s26, s61
s_addc_u32 s27, s27, 0
s_lshl_b32 s61, s61, 1
s_add_u32 s61, s61, 4096
s_lshl_b32 s60, s69, 19
s_add_u32 s60, s60, s61
s_add_u32 s28, s28, s60
s_addc_u32 s29, s29, 0
s_sub_u32 s24, 0x80000, s61
s_lshl_b32 s60, s35, 2
s_add_u32 s60, s60, s34
s_lshl_b32 s60, s60, 17
s_lshl_b32 s61, s101, 16
s_add_u32 s60, s60, s61
s_add_u32 s42, s60, 1048576
s_add_u32 s40, s32, s42
s_addc_u32 s41, s33, 0
s_mov_b32 s42, 65536
s_mov_b32 s43, 0x20000
s_add_u32 m0, s67, 0
s_add_u32 s62, s64, 0
s_and_b32 s62, s62, 0x3ff
buffer_load_dwordx4 v144, s[48:51], s62 offen offset:0 lds
buffer_load_dwordx4 v145, s[48:51], s62 offen offset:1024 lds
buffer_load_dwordx4 v146, s[48:51], s62 offen offset:2048 lds
buffer_load_dwordx4 v147, s[48:51], s62 offen offset:3072 lds
s_add_u32 m0, s67, 16384
s_nop 0
buffer_load_dwordx4 v144, s[52:55], s62 offen offset:0 lds
buffer_load_dwordx4 v145, s[52:55], s62 offen offset:1024 lds
buffer_load_dwordx4 v146, s[52:55], s62 offen offset:2048 lds
buffer_load_dwordx4 v147, s[52:55], s62 offen offset:3072 lds
v_mov_b32 v15, s37
s_waitcnt vmcnt(8)
s_mov_b64 exec, 1
s_cmp_eq_u32 s100, 0
s_cbranch_scc1 L_rs51
global_store_dword v19, v15, s[32:33]
s_branch L_rd52
L_rs51:
global_store_dword v19, v15, s[32:33] sc1
L_rd52:
s_mov_b64 exec, -1
s_mov_b32 s92, 0
L_w53:
global_load_dword v8, v18, s[32:33] sc1
s_waitcnt vmcnt(0)
v_cmp_ne_u32 vcc, s37, v8
s_nop 0
s_cbranch_vccz L_wd54
s_sleep 4
s_add_u32 s92, s92, 1
s_cmp_lt_u32 s92, 200000
s_cbranch_scc1 L_w53
L_wd54:
v_mov_b32 v14, 1
s_mov_b64 exec, 1
ds_write_b32 v13, v14
s_mov_b64 exec, -1
s_add_u32 m0, s67, 32768
s_add_u32 s62, s64, 128
s_and_b32 s62, s62, 0x3ff
buffer_load_dwordx4 v144, s[48:51], s62 offen offset:0 lds
buffer_load_dwordx4 v145, s[48:51], s62 offen offset:1024 lds
buffer_load_dwordx4 v146, s[48:51], s62 offen offset:2048 lds
buffer_load_dwordx4 v147, s[48:51], s62 offen offset:3072 lds
s_add_u32 s63, s65, 0
s_and_b32 s63, s63, 0xffff
buffer_load_dwordx4 v[148:151], v2, s[40:43], s63 offen offset:0 sc1
buffer_load_dwordx4 v[152:155], v2, s[40:43], s63 offen offset:1024 sc1
buffer_load_dwordx4 v[156:159], v2, s[40:43], s63 offen offset:2048 sc1
buffer_load_dwordx4 v[160:163], v2, s[40:43], s63 offen offset:3072 sc1
s_add_u32 m0, s67, 49152
s_nop 0
buffer_load_dwordx4 v144, s[52:55], s62 offen offset:0 lds
buffer_load_dwordx4 v145, s[52:55], s62 offen offset:1024 lds
buffer_load_dwordx4 v146, s[52:55], s62 offen offset:2048 lds
buffer_load_dwordx4 v147, s[52:55], s62 offen offset:3072 lds
s_add_u32 s63, s65, 4096
s_and_b32 s63, s63, 0xffff
buffer_load_dwordx4 v[164:167], v2, s[40:43], s63 offen offset:0 sc1
buffer_load_dwordx4 v[168:171], v2, s[40:43], s63 offen offset:1024 sc1
buffer_load_dwordx4 v[172:175], v2, s[40:43], s63 offen offset:2048 sc1
buffer_load_dwordx4 v[176:179], v2, s[40:43], s63 offen offset:3072 sc1
s_add_u32 s63, s65, 8192
s_and_b32 s63, s63, 0xffff
buffer_load_dwordx4 v[180:183], v2, s[40:43], s63 offen offset:0 sc1
buffer_load_dwordx4 v[184:187], v2, s[40:43], s63 offen offset:1024 sc1
buffer_load_dwordx4 v[188:191], v2, s[40:43], s63 offen offset:2048 sc1
buffer_load_dwordx4 v[192:195], v2, s[40:43], s63 offen offset:3072 sc1
ds_read_b128 v[8:11], v12
s_waitcnt lgkmcnt(0)
L_ck55:
v_min3_u32 v15, v8, v9, v10
v_min_u32 v15, v15, v11
s_nop 0
v_readfirstlane_b32 s60, v15
s_nop 0
s_cmp_ge_u32 s60, 1
s_cbranch_scc1 L_ckd56
ds_read_b128 v[8:11], v12
s_waitcnt lgkmcnt(0)
s_branch L_ck55
L_ckd56:
ds_read_b128 v[96:99], v20 offset:0
ds_read_b128 v[100:103], v20 offset:4096
ds_read_b128 v[104:107], v20 offset:8192
ds_read_b128 v[108:111], v20 offset:12288
s_waitcnt vmcnt(15) lgkmcnt(3)
v_mfma_f32_32x32x16_bf16 v[32:47], v[148:151], v[96:99], 0
ds_read_b128 v[112:115], v21 offset:0
ds_read_b128 v[116:119], v21 offset:4096
s_waitcnt lgkmcnt(4)
v_mfma_f32_32x32x16_bf16 v[48:63], v[148:151], v[100:103], 0
ds_read_b128 v[120:123], v21 offset:8192
ds_read_b128 v[124:127], v21 offset:12288
s_waitcnt lgkmcnt(5)
v_mfma_f32_32x32x16_bf16 v[64:79], v[148:151], v[104:107], 0
s_add_u32 m0, s67, 65536
s_add_u32 s62, s64, 256
s_and_b32 s62, s62, 0x3ff
buffer_load_dwordx4 v144, s[48:51], s62 offen offset:0 lds
s_waitcnt lgkmcnt(4)
v_mfma_f32_32x32x16_bf16 v[80:95], v[148:151], v[108:111], 0
s_add_u32 s63, s65, 12288
s_and_b32 s63, s63, 0xffff
buffer_load_dwordx4 v[148:151], v2, s[40:43], s63 offen offset:0 sc1
s_waitcnt vmcnt(16) lgkmcnt(3)
v_mfma_f32_32x32x16_bf16 v[32:47], v[152:155], v[112:115], v[32:47]
ds_read_b128 v[96:99], v22 offset:0
ds_read_b128 v[100:103], v22 offset:4096
s_waitcnt lgkmcnt(4)
v_mfma_f32_32x32x16_bf16 v[48:63], v[152:155], v[116:119], v[48:63]
ds_read_b128 v[104:107], v22 offset:8192
ds_read_b128 v[108:111], v22 offset:12288
s_waitcnt lgkmcnt(5)
v_mfma_f32_32x32x16_bf16 v[64:79], v[152:155], v[120:123], v[64:79]
buffer_load_dwordx4 v145, s[48:51], s62 offen offset:1024 lds
s_waitcnt lgkmcnt(4)
v_mfma_f32_32x32x16_bf16 v[80:95], v[152:155], v[124:127], v[80:95]
buffer_load_dwordx4 v[152:155], v2, s[40:43], s63 offen offset:1024 sc1
s_waitcnt vmcnt(17) lgkmcnt(3)
v_mfma_f32_32x32x16_bf16 v[32:47], v[156:159], v[96:99], v[32:47]
ds_read_b128 v[112:115], v23 offset:0
ds_read_b128 v[116:119], v23 offset:4096
s_waitcnt lgkmcnt(4)
v_mfma_f32_32x32x16_bf16 v[48:63], v[156:159], v[100:103], v[48:63]
ds_read_b128 v[120:123], v23 offset:8192
ds_read_b128 v[124:127], v23 offset:12288
s_waitcnt lgkmcnt(5)
v_mfma_f32_32x32x16_bf16 v[64:79], v[156:159], v[104:107], v[64:79]
buffer_load_dwordx4 v146, s[48:51], s62 offen offset:2048 lds
s_waitcnt lgkmcnt(4)
v_mfma_f32_32x32x16_bf16 v[80:95], v[156:159], v[108:111], v[80:95]
buffer_load_dwordx4 v[156:159], v2, s[40:43], s63 offen offset:2048 sc1
s_waitcnt vmcnt(18) lgkmcnt(3)
v_mfma_f32_32x32x16_bf16 v[32:47], v[160:163], v[112:115], v[32:47]
ds_read_b128 v[96:99], v20 offset:16384
ds_read_b128 v[100:103], v20 offset:20480
s_waitcnt lgkmcnt(4)
v_mfma_f32_32x32x16_bf16 v[48:63], v[160:163], v[116:119], v[48:63]
ds_read_b128 v[104:107], v20 offset:24576
ds_read_b128 v[108:111], v20 offset:28672
s_waitcnt lgkmcnt(5)
v_mfma_f32_32x32x16_bf16 v[64:79], v[160:163], v[120:123], v[64:79]
buffer_load_dwordx4 v147, s[48:51], s62 offen offset:3072 lds
s_waitcnt lgkmcnt(4)
v_mfma_f32_32x32x16_bf16 v[80:95], v[160:163], v[124:127], v[80:95]
buffer_load_dwordx4 v[160:163], v2, s[40:43], s63 offen offset:3072 sc1
s_waitcnt vmcnt(15) lgkmcnt(3)
v_mov_b32 v14, 2
s_mov_b64 exec, 1
ds_write_b32 v13, v14
s_mov_b64 exec, -1
v_mfma_f32_32x32x16_bf16 v[32:47], v[164:167], v[96:99], v[32:47]
ds_read_b128 v[112:115], v21 offset:16384
ds_read_b128 v[116:119], v21 offset:20480
s_waitcnt lgkmcnt(5)
v_mfma_f32_32x32x16_bf16 v[48:63], v[164:167], v[100:103], v[48:63]
ds_read_b128 v[120:123], v21 offset:24576
ds_read_b128 v[124:127], v21 offset:28672
s_waitcnt lgkmcnt(6)
v_mfma_f32_32x32x16_bf16 v[64:79], v[164:167], v[104:107], v[64:79]
s_add_u32 m0, s67, 81920
s_nop 0
buffer_load_dwordx4 v144, s[52:55], s62 offen offset:0 lds
s_waitcnt lgkmcnt(5)
v_mfma_f32_32x32x16_bf16 v[80:95], v[164:167], v[108:111], v[80:95]
s_add_u32 s63, s65, 16384
s_and_b32 s63, s63, 0xffff
buffer_load_dwordx4 v[164:167], v2, s[40:43], s63 offen offset:0 sc1
s_waitcnt vmcnt(16) lgkmcnt(3)
v_mfma_f32_32x32x16_bf16 v[32:47], v[168:171], v[112:115], v[32:47]
ds_read_b128 v[96:99], v22 offset:16384
ds_read_b128 v[100:103], v22 offset:20480
s_waitcnt lgkmcnt(4)
v_mfma_f32_32x32x16_bf16 v[48:63], v[168:171], v[116:119], v[48:63]
ds_read_b128 v[104:107], v22 offset:24576
ds_read_b128 v[108:111], v22 offset:28672
s_waitcnt lgkmcnt(5)
v_mfma_f32_32x32x16_bf16 v[64:79], v[168:171], v[120:123], v[64:79]
buffer_load_dwordx4 v145, s[52:55], s62 offen offset:1024 lds
s_waitcnt lgkmcnt(4)
v_mfma_f32_32x32x16_bf16 v[80:95], v[168:171], v[124:127], v[80:95]
buffer_load_dwordx4 v[168:171], v2, s[40:43], s63 offen offset:1024 sc1
s_waitcnt vmcnt(17) lgkmcnt(3)
v_mfma_f32_32x32x16_bf16 v[32:47], v[172:175], v[96:99], v[32:47]
ds_read_b128 v[112:115], v23 offset:16384
ds_read_b128 v[116:119], v23 offset:20480
s_waitcnt lgkmcnt(4)
v_mfma_f32_32x32x16_bf16 v[48:63], v[172:175], v[100:103], v[48:63]
ds_read_b128 v[120:123], v23 offset:24576
ds_read_b128 v[124:127], v23 offset:28672
s_waitcnt lgkmcnt(5)
v_mfma_f32_32x32x16_bf16 v[64:79], v[172:175], v[104:107], v[64:79]
buffer_load_dwordx4 v146, s[52:55], s62 offen offset:2048 lds
s_waitcnt lgkmcnt(4)
v_mfma_f32_32x32x16_bf16 v[80:95], v[172:175], v[108:111], v[80:95]
buffer_load_dwordx4 v[172:175], v2, s[40:43], s63 offen offset:2048 sc1
ds_read_b128 v[8:11], v12
s_waitcnt vmcnt(18) lgkmcnt(0)
L_ck57:
v_min3_u32 v15, v8, v9, v10
v_min_u32 v15, v15, v11
s_nop 0
v_readfirstlane_b32 s60, v15
s_nop 0
s_cmp_ge_u32 s60, 2
s_cbranch_scc1 L_ckd58
ds_read_b128 v[8:11], v12
s_waitcnt lgkmcnt(0)
s_branch L_ck57
L_ckd58:
v_mfma_f32_32x32x16_bf16 v[32:47], v[176:179], v[112:115], v[32:47]
ds_read_b128 v[96:99], v20 offset:32768
ds_read_b128 v[100:103], v20 offset:36864
v_mfma_f32_32x32x16_bf16 v[48:63], v[176:179], v[116:119], v[48:63]
ds_read_b128 v[104:107], v20 offset:40960
ds_read_b128 v[108:111], v20 offset:45056
v_mfma_f32_32x32x16_bf16 v[64:79], v[176:179], v[120:123], v[64:79]
buffer_load_dwordx4 v147, s[52:55], s62 offen offset:3072 lds
v_mfma_f32_32x32x16_bf16 v[80:95], v[176:179], v[124:127], v[80:95]
buffer_load_dwordx4 v[176:179], v2, s[40:43], s63 offen offset:3072 sc1
s_waitcnt vmcnt(19) lgkmcnt(3)
v_mfma_f32_32x32x16_bf16 v[32:47], v[180:183], v[96:99], v[32:47]
ds_read_b128 v[112:115], v21 offset:32768
ds_read_b128 v[116:119], v21 offset:36864
s_waitcnt lgkmcnt(4)
v_mfma_f32_32x32x16_bf16 v[48:63], v[180:183], v[100:103], v[48:63]
ds_read_b128 v[120:123], v21 offset:40960
ds_read_b128 v[124:127], v21 offset:45056
s_waitcnt lgkmcnt(5)
v_mfma_f32_32x32x16_bf16 v[64:79], v[180:183], v[104:107], v[64:79]
s_add_u32 m0, s67, 98304
s_add_u32 s62, s64, 384
s_and_b32 s62, s62, 0x3ff
buffer_load_dwordx4 v144, s[48:51], s62 offen offset:0 lds
s_waitcnt lgkmcnt(4)
v_mfma_f32_32x32x16_bf16 v[80:95], v[180:183], v[108:111], v[80:95]
s_add_u32 s63, s65, 20480
s_and_b32 s63, s63, 0xffff
buffer_load_dwordx4 v[180:183], v2, s[40:43], s63 offen offset:0 sc1
s_waitcnt vmcnt(20) lgkmcnt(3)
v_mfma_f32_32x32x16_bf16 v[32:47], v[184:187], v[112:115], v[32:47]
ds_read_b128 v[96:99], v22 offset:32768
ds_read_b128 v[100:103], v22 offset:36864
s_waitcnt lgkmcnt(4)
v_mfma_f32_32x32x16_bf16 v[48:63], v[184:187], v[116:119], v[48:63]
ds_read_b128 v[104:107], v22 offset:40960
ds_read_b128 v[108:111], v22 offset:45056
s_waitcnt lgkmcnt(5)
v_mfma_f32_32x32x16_bf16 v[64:79], v[184:187], v[120:123], v[64:79]
buffer_load_dwordx4 v145, s[48:51], s62 offen offset:1024 lds
s_waitcnt lgkmcnt(4)
v_mfma_f32_32x32x16_bf16 v[80:95], v[184:187], v[124:127], v[80:95]
buffer_load_dwordx4 v[184:187], v2, s[40:43], s63 offen offset:1024 sc1
s_waitcnt vmcnt(21) lgkmcnt(3)
v_mfma_f32_32x32x16_bf16 v[32:47], v[188:191], v[96:99], v[32:47]
ds_read_b128 v[112:115], v23 offset:32768
ds_read_b128 v[116:119], v23 offset:36864
s_waitcnt lgkmcnt(4)
v_mfma_f32_32x32x16_bf16 v[48:63], v[188:191], v[100:103], v[48:63]
ds_read_b128 v[120:123], v23 offset:40960
ds_read_b128 v[124:127], v23 offset:45056
s_waitcnt lgkmcnt(5)
v_mfma_f32_32x32x16_bf16 v[64:79], v[188:191], v[104:107], v[64:79]
buffer_load_dwordx4 v146, s[48:51], s62 offen offset:2048 lds
s_waitcnt lgkmcnt(4)
v_mfma_f32_32x32x16_bf16 v[80:95], v[188:191], v[108:111], v[80:95]
buffer_load_dwordx4 v[188:191], v2, s[40:43], s63 offen offset:2048 sc1
s_waitcnt vmcnt(22) lgkmcnt(3)
v_mfma_f32_32x32x16_bf16 v[32:47], v[192:195], v[112:115], v[32:47]
ds_read_b128 v[96:99], v20 offset:49152
ds_read_b128 v[100:103], v20 offset:53248
s_waitcnt lgkmcnt(4)
v_mfma_f32_32x32x16_bf16 v[48:63], v[192:195], v[116:119], v[48:63]
ds_read_b128 v[104:107], v20 offset:57344
ds_read_b128 v[108:111], v20 offset:61440
s_waitcnt lgkmcnt(5)
v_mfma_f32_32x32x16_bf16 v[64:79], v[192:195], v[120:123], v[64:79]
buffer_load_dwordx4 v147, s[48:51], s62 offen offset:3072 lds
s_waitcnt lgkmcnt(4)
v_mfma_f32_32x32x16_bf16 v[80:95], v[192:195], v[124:127], v[80:95]
buffer_load_dwordx4 v[192:195], v2, s[40:43], s63 offen offset:3072 sc1
s_waitcnt vmcnt(9) lgkmcnt(3)
v_mov_b32 v14, 3
s_mov_b64 exec, 1
ds_write_b32 v13, v14
s_mov_b64 exec, -1
v_mfma_f32_32x32x16_bf16 v[32:47], v[148:151], v[96:99], v[32:47]
ds_read_b128 v[112:115], v21 offset:49152
ds_read_b128 v[116:119], v21 offset:53248
s_waitcnt lgkmcnt(5)
v_mfma_f32_32x32x16_bf16 v[48:63], v[148:151], v[100:103], v[48:63]
ds_read_b128 v[120:123], v21 offset:57344
ds_read_b128 v[124:127], v21 offset:61440
s_waitcnt lgkmcnt(6)
v_mfma_f32_32x32x16_bf16 v[64:79], v[148:151], v[104:107], v[64:79]
s_add_u32 m0, s67, 0
s_nop 0
buffer_load_dwordx4 v144, s[52:55], s62 offen offset:0 lds
s_waitcnt lgkmcnt(5)
v_mfma_f32_32x32x16_bf16 v[80:95], v[148:151], v[108:111], v[80:95]
s_add_u32 s63, s65, 24576
s_and_b32 s63, s63, 0xffff
buffer_load_dwordx4 v[148:151], v2, s[40:43], s63 offen offset:0 sc1
s_waitcnt vmcnt(22) lgkmcnt(3)
v_mfma_f32_32x32x16_bf16 v[32:47], v[152:155], v[112:115], v[32:47]
ds_read_b128 v[96:99], v22 offset:49152
ds_read_b128 v[100:103], v22 offset:53248
s_waitcnt lgkmcnt(4)
v_mfma_f32_32x32x16_bf16 v[48:63], v[152:155], v[116:119], v[48:63]
ds_read_b128 v[104:107], v22 offset:57344
ds_read_b128 v[108:111], v22 offset:61440
s_waitcnt lgkmcnt(5)
v_mfma_f32_32x32x16_bf16 v[64:79], v[152:155], v[120:123], v[64:79]
buffer_load_dwordx4 v145, s[52:55], s62 offen offset:1024 lds
s_waitcnt lgkmcnt(4)
v_mfma_f32_32x32x16_bf16 v[80:95], v[152:155], v[124:127], v[80:95]
buffer_load_dwordx4 v[152:155], v2, s[40:43], s63 offen offset:1024 sc1
s_waitcnt vmcnt(22) lgkmcnt(3)
v_mfma_f32_32x32x16_bf16 v[32:47], v[156:159], v[96:99], v[32:47]
ds_read_b128 v[112:115], v23 offset:49152
ds_read_b128 v[116:119], v23 offset:53248
s_waitcnt lgkmcnt(4)
v_mfma_f32_32x32x16_bf16 v[48:63], v[156:159], v[100:103], v[48:63]
ds_read_b128 v[120:123], v23 offset:57344
ds_read_b128 v[124:127], v23 offset:61440
s_waitcnt lgkmcnt(5)
v_mfma_f32_32x32x16_bf16 v[64:79], v[156:159], v[104:107], v[64:79]
buffer_load_dwordx4 v146, s[52:55], s62 offen offset:2048 lds
s_waitcnt lgkmcnt(4)
v_mfma_f32_32x32x16_bf16 v[80:95], v[156:159], v[108:111], v[80:95]
buffer_load_dwordx4 v[156:159], v2, s[40:43], s63 offen offset:2048 sc1
ds_read_b128 v[8:11], v12
s_waitcnt vmcnt(22) lgkmcnt(0)
L_ck59:
v_min3_u32 v15, v8, v9, v10
v_min_u32 v15, v15, v11
s_nop 0
v_readfirstlane_b32 s60, v15
s_nop 0
s_cmp_ge_u32 s60, 3
s_cbranch_scc1 L_ckd60
ds_read_b128 v[8:11], v12
s_waitcnt lgkmcnt(0)
s_branch L_ck59
L_ckd60:
v_mfma_f32_32x32x16_bf16 v[32:47], v[160:163], v[112:115], v[32:47]
ds_read_b128 v[96:99], v24 offset:0
ds_read_b128 v[100:103], v24 offset:4096
v_mfma_f32_32x32x16_bf16 v[48:63], v[160:163], v[116:119], v[48:63]
ds_read_b128 v[104:107], v24 offset:8192
ds_read_b128 v[108:111], v24 offset:12288
v_mfma_f32_32x32x16_bf16 v[64:79], v[160:163], v[120:123], v[64:79]
buffer_load_dwordx4 v147, s[52:55], s62 offen offset:3072 lds
v_mfma_f32_32x32x16_bf16 v[80:95], v[160:163], v[124:127], v[80:95]
buffer_load_dwordx4 v[160:163], v2, s[40:43], s63 offen offset:3072 sc1
s_waitcnt vmcnt(22) lgkmcnt(3)
v_mfma_f32_32x32x16_bf16 v[32:47], v[164:167], v[96:99], v[32:47]
ds_read_b128 v[112:115], v25 offset:0
ds_read_b128 v[116:119], v25 offset:4096
s_waitcnt lgkmcnt(4)
v_mfma_f32_32x32x16_bf16 v[48:63], v[164:167], v[100:103], v[48:63]
ds_read_b128 v[120:123], v25 offset:8192
ds_read_b128 v[124:127], v25 offset:12288
s_waitcnt lgkmcnt(5)
v_mfma_f32_32x32x16_bf16 v[64:79], v[164:167], v[104:107], v[64:79]
s_add_u32 m0, s67, 16384
s_add_u32 s62, s64, 512
s_and_b32 s62, s62, 0x3ff
buffer_load_dwordx4 v144, s[48:51], s62 offen offset:0 lds
s_waitcnt lgkmcnt(4)
v_mfma_f32_32x32x16_bf16 v[80:95], v[164:167], v[108:111], v[80:95]
s_add_u32 s63, s65, 28672
s_and_b32 s63, s63, 0xffff
buffer_load_dwordx4 v[164:167], v2, s[40:43], s63 offen offset:0 sc1
s_waitcnt vmcnt(22) lgkmcnt(3)
v_mfma_f32_32x32x16_bf16 v[32:47], v[168:171], v[112:115], v[32:47]
ds_read_b128 v[96:99], v26 offset:0
ds_read_b128 v[100:103], v26 offset:4096
s_waitcnt lgkmcnt(4)
v_mfma_f32_32x32x16_bf16 v[48:63], v[168:171], v[116:119], v[48:63]
ds_read_b128 v[104:107], v26 offset:8192
ds_read_b128 v[108:111], v26 offset:12288
s_waitcnt lgkmcnt(5)
v_mfma_f32_32x32x16_bf16 v[64:79], v[168:171], v[120:123], v[64:79]
buffer_load_dwordx4 v145, s[48:51], s62 offen offset:1024 lds
s_waitcnt lgkmcnt(4)
v_mfma_f32_32x32x16_bf16 v[80:95], v[168:171], v[124:127], v[80:95]
buffer_load_dwordx4 v[168:171], v2, s[40:43], s63 offen offset:1024 sc1
s_waitcnt vmcnt(22) lgkmcnt(3)
v_mfma_f32_32x32x16_bf16 v[32:47], v[172:175], v[96:99], v[32:47]
ds_read_b128 v[112:115], v27 offset:0
ds_read_b128 v[116:119], v27 offset:4096
s_waitcnt lgkmcnt(4)
v_mfma_f32_32x32x16_bf16 v[48:63], v[172:175], v[100:103], v[48:63]
ds_read_b128 v[120:123], v27 offset:8192
ds_read_b128 v[124:127], v27 offset:12288
s_waitcnt lgkmcnt(5)
v_mfma_f32_32x32x16_bf16 v[64:79], v[172:175], v[104:107], v[64:79]
buffer_load_dwordx4 v146, s[48:51], s62 offen offset:2048 lds
s_waitcnt lgkmcnt(4)
v_mfma_f32_32x32x16_bf16 v[80:95], v[172:175], v[108:111], v[80:95]
buffer_load_dwordx4 v[172:175], v2, s[40:43], s63 offen offset:2048 sc1
s_waitcnt vmcnt(22) lgkmcnt(3)
v_mfma_f32_32x32x16_bf16 v[32:47], v[176:179], v[112:115], v[32:47]
ds_read_b128 v[96:99], v24 offset:16384
ds_read_b128 v[100:103], v24 offset:20480
s_waitcnt lgkmcnt(4)
v_mfma_f32_32x32x16_bf16 v[48:63], v[176:179], v[116:119], v[48:63]
ds_read_b128 v[104:107], v24 offset:24576
ds_read_b128 v[108:111], v24 offset:28672
s_waitcnt lgkmcnt(5)
v_mfma_f32_32x32x16_bf16 v[64:79], v[176:179], v[120:123], v[64:79]
buffer_load_dwordx4 v147, s[48:51], s62 offen offset:3072 lds
s_waitcnt lgkmcnt(4)
v_mfma_f32_32x32x16_bf16 v[80:95], v[176:179], v[124:127], v[80:95]
buffer_load_dwordx4 v[176:179], v2, s[40:43], s63 offen offset:3072 sc1
s_waitcnt vmcnt(9) lgkmcnt(3)
v_mov_b32 v14, 4
s_mov_b64 exec, 1
ds_write_b32 v13, v14
s_mov_b64 exec, -1
v_mfma_f32_32x32x16_bf16 v[32:47], v[180:183], v[96:99], v[32:47]
ds_read_b128 v[112:115], v25 offset:16384
ds_read_b128 v[116:119], v25 offset:20480
s_waitcnt lgkmcnt(5)
v_mfma_f32_32x32x16_bf16 v[48:63], v[180:183], v[100:103], v[48:63]
ds_read_b128 v[120:123], v25 offset:24576
ds_read_b128 v[124:127], v25 offset:28672
s_waitcnt lgkmcnt(6)
v_mfma_f32_32x32x16_bf16 v[64:79], v[180:183], v[104:107], v[64:79]
s_add_u32 m0, s67, 32768
s_nop 0
buffer_load_dwordx4 v144, s[52:55], s62 offen offset:0 lds
s_waitcnt lgkmcnt(5)
v_mfma_f32_32x32x16_bf16 v[80:95], v[180:183], v[108:111], v[80:95]
s_add_u32 s63, s65, 32768
s_and_b32 s63, s63, 0xffff
buffer_load_dwordx4 v[180:183], v2, s[40:43], s63 offen offset:0 sc1
s_waitcnt vmcnt(22) lgkmcnt(3)
v_mfma_f32_32x32x16_bf16 v[32:47], v[184:187], v[112:115], v[32:47]
ds_read_b128 v[96:99], v26 offset:16384
ds_read_b128 v[100:103], v26 offset:20480
s_waitcnt lgkmcnt(4)
v_mfma_f32_32x32x16_bf16 v[48:63], v[184:187], v[116:119], v[48:63]
ds_read_b128 v[104:107], v26 offset:24576
ds_read_b128 v[108:111], v26 offset:28672
s_waitcnt lgkmcnt(5)
v_mfma_f32_32x32x16_bf16 v[64:79], v[184:187], v[120:123], v[64:79]
buffer_load_dwordx4 v145, s[52:55], s62 offen offset:1024 lds
s_waitcnt lgkmcnt(4)
v_mfma_f32_32x32x16_bf16 v[80:95], v[184:187], v[124:127], v[80:95]
buffer_load_dwordx4 v[184:187], v2, s[40:43], s63 offen offset:1024 sc1
s_waitcnt vmcnt(22) lgkmcnt(3)
v_mfma_f32_32x32x16_bf16 v[32:47], v[188:191], v[96:99], v[32:47]
ds_read_b128 v[112:115], v27 offset:16384
ds_read_b128 v[116:119], v27 offset:20480
s_waitcnt lgkmcnt(4)
v_mfma_f32_32x32x16_bf16 v[48:63], v[188:191], v[100:103], v[48:63]
ds_read_b128 v[120:123], v27 offset:24576
ds_read_b128 v[124:127], v27 offset:28672
s_waitcnt lgkmcnt(5)
v_mfma_f32_32x32x16_bf16 v[64:79], v[188:191], v[104:107], v[64:79]
buffer_load_dwordx4 v146, s[52:55], s62 offen offset:2048 lds
s_waitcnt lgkmcnt(4)
v_mfma_f32_32x32x16_bf16 v[80:95], v[188:191], v[108:111], v[80:95]
buffer_load_dwordx4 v[188:191], v2, s[40:43], s63 offen offset:2048 sc1
ds_read_b128 v[8:11], v12
s_waitcnt vmcnt(22) lgkmcnt(0)
L_ck61:
v_min3_u32 v15, v8, v9, v10
v_min_u32 v15, v15, v11
s_nop 0
v_readfirstlane_b32 s60, v15
s_nop 0
s_cmp_ge_u32 s60, 4
s_cbranch_scc1 L_ckd62
ds_read_b128 v[8:11], v12
s_waitcnt lgkmcnt(0)
s_branch L_ck61
L_ckd62:
v_mfma_f32_32x32x16_bf16 v[32:47], v[192:195], v[112:115], v[32:47]
ds_read_b128 v[96:99], v24 offset:32768
ds_read_b128 v[100:103], v24 offset:36864
v_mfma_f32_32x32x16_bf16 v[48:63], v[192:195], v[116:119], v[48:63]
ds_read_b128 v[104:107], v24 offset:40960
ds_read_b128 v[108:111], v24 offset:45056
v_mfma_f32_32x32x16_bf16 v[64:79], v[192:195], v[120:123], v[64:79]
buffer_load_dwordx4 v147, s[52:55], s62 offen offset:3072 lds
v_mfma_f32_32x32x16_bf16 v[80:95], v[192:195], v[124:127], v[80:95]
buffer_load_dwordx4 v[192:195], v2, s[40:43], s63 offen offset:3072 sc1
s_waitcnt vmcnt(22) lgkmcnt(3)
v_mfma_f32_32x32x16_bf16 v[32:47], v[148:151], v[96:99], v[32:47]
ds_read_b128 v[112:115], v25 offset:32768
ds_read_b128 v[116:119], v25 offset:36864
s_waitcnt lgkmcnt(4)
v_mfma_f32_32x32x16_bf16 v[48:63], v[148:151], v[100:103], v[48:63]
ds_read_b128 v[120:123], v25 offset:40960
ds_read_b128 v[124:127], v25 offset:45056
s_waitcnt lgkmcnt(5)
v_mfma_f32_32x32x16_bf16 v[64:79], v[148:151], v[104:107], v[64:79]
s_add_u32 m0, s67, 49152
s_add_u32 s62, s64, 640
s_and_b32 s62, s62, 0x3ff
buffer_load_dwordx4 v144, s[48:51], s62 offen offset:0 lds
s_waitcnt lgkmcnt(4)
v_mfma_f32_32x32x16_bf16 v[80:95], v[148:151], v[108:111], v[80:95]
s_add_u32 s63, s65, 36864
s_and_b32 s63, s63, 0xffff
buffer_load_dwordx4 v[148:151], v2, s[40:43], s63 offen offset:0 sc1
s_waitcnt vmcnt(22) lgkmcnt(3)
v_mfma_f32_32x32x16_bf16 v[32:47], v[152:155], v[112:115], v[32:47]
ds_read_b128 v[96:99], v26 offset:32768
ds_read_b128 v[100:103], v26 offset:36864
s_waitcnt lgkmcnt(4)
v_mfma_f32_32x32x16_bf16 v[48:63], v[152:155], v[116:119], v[48:63]
ds_read_b128 v[104:107], v26 offset:40960
ds_read_b128 v[108:111], v26 offset:45056
s_waitcnt lgkmcnt(5)
v_mfma_f32_32x32x16_bf16 v[64:79], v[152:155], v[120:123], v[64:79]
buffer_load_dwordx4 v145, s[48:51], s62 offen offset:1024 lds
s_waitcnt lgkmcnt(4)
v_mfma_f32_32x32x16_bf16 v[80:95], v[152:155], v[124:127], v[80:95]
buffer_load_dwordx4 v[152:155], v2, s[40:43], s63 offen offset:1024 sc1
s_waitcnt vmcnt(22) lgkmcnt(3)
v_mfma_f32_32x32x16_bf16 v[32:47], v[156:159], v[96:99], v[32:47]
ds_read_b128 v[112:115], v27 offset:32768
ds_read_b128 v[116:119], v27 offset:36864
s_waitcnt lgkmcnt(4)
v_mfma_f32_32x32x16_bf16 v[48:63], v[156:159], v[100:103], v[48:63]
ds_read_b128 v[120:123], v27 offset:40960
ds_read_b128 v[124:127], v27 offset:45056
s_waitcnt lgkmcnt(5)
v_mfma_f32_32x32x16_bf16 v[64:79], v[156:159], v[104:107], v[64:79]
buffer_load_dwordx4 v146, s[48:51], s62 offen offset:2048 lds
s_waitcnt lgkmcnt(4)
v_mfma_f32_32x32x16_bf16 v[80:95], v[156:159], v[108:111], v[80:95]
buffer_load_dwordx4 v[156:159], v2, s[40:43], s63 offen offset:2048 sc1
s_waitcnt vmcnt(22) lgkmcnt(3)
v_mfma_f32_32x32x16_bf16 v[32:47], v[160:163], v[112:115], v[32:47]
ds_read_b128 v[96:99], v20 offset:0
ds_read_b128 v[100:103], v20 offset:4096
s_waitcnt lgkmcnt(4)
v_mfma_f32_32x32x16_bf16 v[48:63], v[160:163], v[116:119], v[48:63]
ds_read_b128 v[104:107], v20 offset:8192
ds_read_b128 v[108:111], v20 offset:12288
s_waitcnt lgkmcnt(5)
v_mfma_f32_32x32x16_bf16 v[64:79], v[160:163], v[120:123], v[64:79]
buffer_load_dwordx4 v147, s[48:51], s62 offen offset:3072 lds
s_waitcnt lgkmcnt(4)
v_mfma_f32_32x32x16_bf16 v[80:95], v[160:163], v[124:127], v[80:95]
buffer_load_dwordx4 v[160:163], v2, s[40:43], s63 offen offset:3072 sc1
s_waitcnt vmcnt(9) lgkmcnt(3)
v_mov_b32 v14, 5
s_mov_b64 exec, 1
ds_write_b32 v13, v14
s_mov_b64 exec, -1
v_mfma_f32_32x32x16_bf16 v[32:47], v[164:167], v[96:99], v[32:47]
ds_read_b128 v[112:115], v21 offset:0
ds_read_b128 v[116:119], v21 offset:4096
s_waitcnt lgkmcnt(5)
v_mfma_f32_32x32x16_bf16 v[48:63], v[164:167], v[100:103], v[48:63]
ds_read_b128 v[120:123], v21 offset:8192
ds_read_b128 v[124:127], v21 offset:12288
s_waitcnt lgkmcnt(6)
v_mfma_f32_32x32x16_bf16 v[64:79], v[164:167], v[104:107], v[64:79]
s_add_u32 m0, s67, 65536
s_nop 0
buffer_load_dwordx4 v144, s[52:55], s62 offen offset:0 lds
s_waitcnt lgkmcnt(5)
v_mfma_f32_32x32x16_bf16 v[80:95], v[164:167], v[108:111], v[80:95]
s_add_u32 s63, s65, 40960
s_and_b32 s63, s63, 0xffff
buffer_load_dwordx4 v[164:167], v2, s[40:43], s63 offen offset:0 sc1
s_waitcnt vmcnt(22) lgkmcnt(3)
v_mfma_f32_32x32x16_bf16 v[32:47], v[168:171], v[112:115], v[32:47]
ds_read_b128 v[96:99], v22 offset:0
ds_read_b128 v[100:103], v22 offset:4096
s_waitcnt lgkmcnt(4)
v_mfma_f32_32x32x16_bf16 v[48:63], v[168:171], v[116:119], v[48:63]
ds_read_b128 v[104:107], v22 offset:8192
ds_read_b128 v[108:111], v22 offset:12288
s_waitcnt lgkmcnt(5)
v_mfma_f32_32x32x16_bf16 v[64:79], v[168:171], v[120:123], v[64:79]
buffer_load_dwordx4 v145, s[52:55], s62 offen offset:1024 lds
s_waitcnt lgkmcnt(4)
v_mfma_f32_32x32x16_bf16 v[80:95], v[168:171], v[124:127], v[80:95]
buffer_load_dwordx4 v[168:171], v2, s[40:43], s63 offen offset:1024 sc1
s_waitcnt vmcnt(22) lgkmcnt(3)
v_mfma_f32_32x32x16_bf16 v[32:47], v[172:175], v[96:99], v[32:47]
ds_read_b128 v[112:115], v23 offset:0
ds_read_b128 v[116:119], v23 offset:4096
s_waitcnt lgkmcnt(4)
v_mfma_f32_32x32x16_bf16 v[48:63], v[172:175], v[100:103], v[48:63]
ds_read_b128 v[120:123], v23 offset:8192
ds_read_b128 v[124:127], v23 offset:12288
s_waitcnt lgkmcnt(5)
v_mfma_f32_32x32x16_bf16 v[64:79], v[172:175], v[104:107], v[64:79]
buffer_load_dwordx4 v146, s[52:55], s62 offen offset:2048 lds
s_waitcnt lgkmcnt(4)
v_mfma_f32_32x32x16_bf16 v[80:95], v[172:175], v[108:111], v[80:95]
buffer_load_dwordx4 v[172:175], v2, s[40:43], s63 offen offset:2048 sc1
ds_read_b128 v[8:11], v12
s_waitcnt vmcnt(22) lgkmcnt(0)
L_ck63:
v_min3_u32 v15, v8, v9, v10
v_min_u32 v15, v15, v11
s_nop 0
v_readfirstlane_b32 s60, v15
s_nop 0
s_cmp_ge_u32 s60, 5
s_cbranch_scc1 L_ckd64
ds_read_b128 v[8:11], v12
s_waitcnt lgkmcnt(0)
s_branch L_ck63
L_ckd64:
v_mfma_f32_32x32x16_bf16 v[32:47], v[176:179], v[112:115], v[32:47]
ds_read_b128 v[96:99], v20 offset:16384
ds_read_b128 v[100:103], v20 offset:20480
v_mfma_f32_32x32x16_bf16 v[48:63], v[176:179], v[116:119], v[48:63]
ds_read_b128 v[104:107], v20 offset:24576
ds_read_b128 v[108:111], v20 offset:28672
v_mfma_f32_32x32x16_bf16 v[64:79], v[176:179], v[120:123], v[64:79]
buffer_load_dwordx4 v147, s[52:55], s62 offen offset:3072 lds
v_mfma_f32_32x32x16_bf16 v[80:95], v[176:179], v[124:127], v[80:95]
buffer_load_dwordx4 v[176:179], v2, s[40:43], s63 offen offset:3072 sc1
s_waitcnt vmcnt(22) lgkmcnt(3)
v_mfma_f32_32x32x16_bf16 v[32:47], v[180:183], v[96:99], v[32:47]
ds_read_b128 v[112:115], v21 offset:16384
ds_read_b128 v[116:119], v21 offset:20480
s_waitcnt lgkmcnt(4)
v_mfma_f32_32x32x16_bf16 v[48:63], v[180:183], v[100:103], v[48:63]
ds_read_b128 v[120:123], v21 offset:24576
ds_read_b128 v[124:127], v21 offset:28672
s_waitcnt lgkmcnt(5)
v_mfma_f32_32x32x16_bf16 v[64:79], v[180:183], v[104:107], v[64:79]
s_add_u32 m0, s67, 81920
s_add_u32 s62, s64, 768
s_and_b32 s62, s62, 0x3ff
buffer_load_dwordx4 v144, s[48:51], s62 offen offset:0 lds
s_waitcnt lgkmcnt(4)
v_mfma_f32_32x32x16_bf16 v[80:95], v[180:183], v[108:111], v[80:95]
s_add_u32 s63, s65, 45056
s_and_b32 s63, s63, 0xffff
buffer_load_dwordx4 v[180:183], v2, s[40:43], s63 offen offset:0 sc1
s_waitcnt vmcnt(22) lgkmcnt(3)
v_mfma_f32_32x32x16_bf16 v[32:47], v[184:187], v[112:115], v[32:47]
ds_read_b128 v[96:99], v22 offset:16384
ds_read_b128 v[100:103], v22 offset:20480
s_waitcnt lgkmcnt(4)
v_mfma_f32_32x32x16_bf16 v[48:63], v[184:187], v[116:119], v[48:63]
ds_read_b128 v[104:107], v22 offset:24576
ds_read_b128 v[108:111], v22 offset:28672
s_waitcnt lgkmcnt(5)
v_mfma_f32_32x32x16_bf16 v[64:79], v[184:187], v[120:123], v[64:79]
buffer_load_dwordx4 v145, s[48:51], s62 offen offset:1024 lds
s_waitcnt lgkmcnt(4)
v_mfma_f32_32x32x16_bf16 v[80:95], v[184:187], v[124:127], v[80:95]
buffer_load_dwordx4 v[184:187], v2, s[40:43], s63 offen offset:1024 sc1
s_waitcnt vmcnt(22) lgkmcnt(3)
v_mfma_f32_32x32x16_bf16 v[32:47], v[188:191], v[96:99], v[32:47]
ds_read_b128 v[112:115], v23 offset:16384
ds_read_b128 v[116:119], v23 offset:20480
s_waitcnt lgkmcnt(4)
v_mfma_f32_32x32x16_bf16 v[48:63], v[188:191], v[100:103], v[48:63]
ds_read_b128 v[120:123], v23 offset:24576
ds_read_b128 v[124:127], v23 offset:28672
s_waitcnt lgkmcnt(5)
v_mfma_f32_32x32x16_bf16 v[64:79], v[188:191], v[104:107], v[64:79]
buffer_load_dwordx4 v146, s[48:51], s62 offen offset:2048 lds
s_waitcnt lgkmcnt(4)
v_mfma_f32_32x32x16_bf16 v[80:95], v[188:191], v[108:111], v[80:95]
buffer_load_dwordx4 v[188:191], v2, s[40:43], s63 offen offset:2048 sc1
s_waitcnt vmcnt(22) lgkmcnt(3)
v_mfma_f32_32x32x16_bf16 v[32:47], v[192:195], v[112:115], v[32:47]
ds_read_b128 v[96:99], v20 offset:32768
ds_read_b128 v[100:103], v20 offset:36864
s_waitcnt lgkmcnt(4)
v_mfma_f32_32x32x16_bf16 v[48:63], v[192:195], v[116:119], v[48:63]
ds_read_b128 v[104:107], v20 offset:40960
ds_read_b128 v[108:111], v20 offset:45056
s_waitcnt lgkmcnt(5)
v_mfma_f32_32x32x16_bf16 v[64:79], v[192:195], v[120:123], v[64:79]
buffer_load_dwordx4 v147, s[48:51], s62 offen offset:3072 lds
s_waitcnt lgkmcnt(4)
v_mfma_f32_32x32x16_bf16 v[80:95], v[192:195], v[124:127], v[80:95]
buffer_load_dwordx4 v[192:195], v2, s[40:43], s63 offen offset:3072 sc1
s_waitcnt vmcnt(9) lgkmcnt(3)
v_mov_b32 v14, 6
s_mov_b64 exec, 1
ds_write_b32 v13, v14
s_mov_b64 exec, -1
v_mfma_f32_32x32x16_bf16 v[32:47], v[148:151], v[96:99], v[32:47]
ds_read_b128 v[112:115], v21 offset:32768
ds_read_b128 v[116:119], v21 offset:36864
s_waitcnt lgkmcnt(5)
v_mfma_f32_32x32x16_bf16 v[48:63], v[148:151], v[100:103], v[48:63]
ds_read_b128 v[120:123], v21 offset:40960
ds_read_b128 v[124:127], v21 offset:45056
s_waitcnt lgkmcnt(6)
v_mfma_f32_32x32x16_bf16 v[64:79], v[148:151], v[104:107], v[64:79]
s_add_u32 m0, s67, 98304
s_nop 0
buffer_load_dwordx4 v144, s[52:55], s62 offen offset:0 lds
s_waitcnt lgkmcnt(5)
v_mfma_f32_32x32x16_bf16 v[80:95], v[148:151], v[108:111], v[80:95]
s_add_u32 s63, s65, 49152
s_and_b32 s63, s63, 0xffff
buffer_load_dwordx4 v[148:151], v2, s[40:43], s63 offen offset:0 sc1
s_waitcnt vmcnt(22) lgkmcnt(3)
v_mfma_f32_32x32x16_bf16 v[32:47], v[152:155], v[112:115], v[32:47]
ds_read_b128 v[96:99], v22 offset:32768
ds_read_b128 v[100:103], v22 offset:36864
s_waitcnt lgkmcnt(4)
v_mfma_f32_32x32x16_bf16 v[48:63], v[152:155], v[116:119], v[48:63]
ds_read_b128 v[104:107], v22 offset:40960
ds_read_b128 v[108:111], v22 offset:45056
s_waitcnt lgkmcnt(5)
v_mfma_f32_32x32x16_bf16 v[64:79], v[152:155], v[120:123], v[64:79]
buffer_load_dwordx4 v145, s[52:55], s62 offen offset:1024 lds
s_waitcnt lgkmcnt(4)
v_mfma_f32_32x32x16_bf16 v[80:95], v[152:155], v[124:127], v[80:95]
buffer_load_dwordx4 v[152:155], v2, s[40:43], s63 offen offset:1024 sc1
s_waitcnt vmcnt(22) lgkmcnt(3)
v_mfma_f32_32x32x16_bf16 v[32:47], v[156:159], v[96:99], v[32:47]
ds_read_b128 v[112:115], v23 offset:32768
ds_read_b128 v[116:119], v23 offset:36864
s_waitcnt lgkmcnt(4)
v_mfma_f32_32x32x16_bf16 v[48:63], v[156:159], v[100:103], v[48:63]
ds_read_b128 v[120:123], v23 offset:40960
ds_read_b128 v[124:127], v23 offset:45056
s_waitcnt lgkmcnt(5)
v_mfma_f32_32x32x16_bf16 v[64:79], v[156:159], v[104:107], v[64:79]
buffer_load_dwordx4 v146, s[52:55], s62 offen offset:2048 lds
s_waitcnt lgkmcnt(4)
v_mfma_f32_32x32x16_bf16 v[80:95], v[156:159], v[108:111], v[80:95]
buffer_load_dwordx4 v[156:159], v2, s[40:43], s63 offen offset:2048 sc1
ds_read_b128 v[8:11], v12
s_waitcnt vmcnt(22) lgkmcnt(0)
L_ck65:
v_min3_u32 v15, v8, v9, v10
v_min_u32 v15, v15, v11
s_nop 0
v_readfirstlane_b32 s60, v15
s_nop 0
s_cmp_ge_u32 s60, 6
s_cbranch_scc1 L_ckd66
ds_read_b128 v[8:11], v12
s_waitcnt lgkmcnt(0)
s_branch L_ck65
L_ckd66:
v_mfma_f32_32x32x16_bf16 v[32:47], v[160:163], v[112:115], v[32:47]
ds_read_b128 v[96:99], v20 offset:49152
ds_read_b128 v[100:103], v20 offset:53248
v_mfma_f32_32x32x16_bf16 v[48:63], v[160:163], v[116:119], v[48:63]
ds_read_b128 v[104:107], v20 offset:57344
ds_read_b128 v[108:111], v20 offset:61440
v_mfma_f32_32x32x16_bf16 v[64:79], v[160:163], v[120:123], v[64:79]
buffer_load_dwordx4 v147, s[52:55], s62 offen offset:3072 lds
v_mfma_f32_32x32x16_bf16 v[80:95], v[160:163], v[124:127], v[80:95]
buffer_load_dwordx4 v[160:163], v2, s[40:43], s63 offen offset:3072 sc1
s_waitcnt vmcnt(22) lgkmcnt(3)
v_mfma_f32_32x32x16_bf16 v[32:47], v[164:167], v[96:99], v[32:47]
ds_read_b128 v[112:115], v21 offset:49152
ds_read_b128 v[116:119], v21 offset:53248
s_waitcnt lgkmcnt(4)
v_mfma_f32_32x32x16_bf16 v[48:63], v[164:167], v[100:103], v[48:63]
ds_read_b128 v[120:123], v21 offset:57344
ds_read_b128 v[124:127], v21 offset:61440
s_waitcnt lgkmcnt(5)
v_mfma_f32_32x32x16_bf16 v[64:79], v[164:167], v[104:107], v[64:79]
s_add_u32 m0, s67, 0
s_add_u32 s62, s64, 896
s_and_b32 s62, s62, 0x3ff
buffer_load_dwordx4 v144, s[48:51], s62 offen offset:0 lds
s_waitcnt lgkmcnt(4)
v_mfma_f32_32x32x16_bf16 v[80:95], v[164:167], v[108:111], v[80:95]
s_add_u32 s63, s65, 53248
s_and_b32 s63, s63, 0xffff
buffer_load_dwordx4 v[164:167], v2, s[40:43], s63 offen offset:0 sc1
s_waitcnt vmcnt(22) lgkmcnt(3)
v_mfma_f32_32x32x16_bf16 v[32:47], v[168:171], v[112:115], v[32:47]
ds_read_b128 v[96:99], v22 offset:49152
ds_read_b128 v[100:103], v22 offset:53248
s_waitcnt lgkmcnt(4)
v_mfma_f32_32x32x16_bf16 v[48:63], v[168:171], v[116:119], v[48:63]
ds_read_b128 v[104:107], v22 offset:57344
ds_read_b128 v[108:111], v22 offset:61440
s_waitcnt lgkmcnt(5)
v_mfma_f32_32x32x16_bf16 v[64:79], v[168:171], v[120:123], v[64:79]
buffer_load_dwordx4 v145, s[48:51], s62 offen offset:1024 lds
s_waitcnt lgkmcnt(4)
v_mfma_f32_32x32x16_bf16 v[80:95], v[168:171], v[124:127], v[80:95]
buffer_load_dwordx4 v[168:171], v2, s[40:43], s63 offen offset:1024 sc1
s_waitcnt vmcnt(22) lgkmcnt(3)
v_mfma_f32_32x32x16_bf16 v[32:47], v[172:175], v[96:99], v[32:47]
ds_read_b128 v[112:115], v23 offset:49152
ds_read_b128 v[116:119], v23 offset:53248
s_waitcnt lgkmcnt(4)
v_mfma_f32_32x32x16_bf16 v[48:63], v[172:175], v[100:103], v[48:63]
ds_read_b128 v[120:123], v23 offset:57344
ds_read_b128 v[124:127], v23 offset:61440
s_waitcnt lgkmcnt(5)
v_mfma_f32_32x32x16_bf16 v[64:79], v[172:175], v[104:107], v[64:79]
buffer_load_dwordx4 v146, s[48:51], s62 offen offset:2048 lds
s_waitcnt lgkmcnt(4)
v_mfma_f32_32x32x16_bf16 v[80:95], v[172:175], v[108:111], v[80:95]
buffer_load_dwordx4 v[172:175], v2, s[40:43], s63 offen offset:2048 sc1
s_waitcnt vmcnt(22) lgkmcnt(3)
v_mfma_f32_32x32x16_bf16 v[32:47], v[176:179], v[112:115], v[32:47]
ds_read_b128 v[96:99], v24 offset:0
ds_read_b128 v[100:103], v24 offset:4096
s_waitcnt lgkmcnt(4)
v_mfma_f32_32x32x16_bf16 v[48:63], v[176:179], v[116:119], v[48:63]
ds_read_b128 v[104:107], v24 offset:8192
ds_read_b128 v[108:111], v24 offset:12288
s_waitcnt lgkmcnt(5)
v_mfma_f32_32x32x16_bf16 v[64:79], v[176:179], v[120:123], v[64:79]
buffer_load_dwordx4 v147, s[48:51], s62 offen offset:3072 lds
s_waitcnt lgkmcnt(4)
v_mfma_f32_32x32x16_bf16 v[80:95], v[176:179], v[124:127], v[80:95]
buffer_load_dwordx4 v[176:179], v2, s[40:43], s63 offen offset:3072 sc1
s_waitcnt vmcnt(9) lgkmcnt(3)
v_mov_b32 v14, 7
s_mov_b64 exec, 1
ds_write_b32 v13, v14
s_mov_b64 exec, -1
v_mfma_f32_32x32x16_bf16 v[32:47], v[180:183], v[96:99], v[32:47]
ds_read_b128 v[112:115], v25 offset:0
ds_read_b128 v[116:119], v25 offset:4096
s_waitcnt lgkmcnt(5)
v_mfma_f32_32x32x16_bf16 v[48:63], v[180:183], v[100:103], v[48:63]
ds_read_b128 v[120:123], v25 offset:8192
ds_read_b128 v[124:127], v25 offset:12288
s_waitcnt lgkmcnt(6)
v_mfma_f32_32x32x16_bf16 v[64:79], v[180:183], v[104:107], v[64:79]
s_add_u32 m0, s67, 16384
s_nop 0
buffer_load_dwordx4 v144, s[52:55], s62 offen offset:0 lds
s_waitcnt lgkmcnt(5)
v_mfma_f32_32x32x16_bf16 v[80:95], v[180:183], v[108:111], v[80:95]
s_add_u32 s63, s65, 57344
s_and_b32 s63, s63, 0xffff
buffer_load_dwordx4 v[180:183], v2, s[40:43], s63 offen offset:0 sc1
s_waitcnt vmcnt(22) lgkmcnt(3)
v_mfma_f32_32x32x16_bf16 v[32:47], v[184:187], v[112:115], v[32:47]
ds_read_b128 v[96:99], v26 offset:0
ds_read_b128 v[100:103], v26 offset:4096
s_waitcnt lgkmcnt(4)
v_mfma_f32_32x32x16_bf16 v[48:63], v[184:187], v[116:119], v[48:63]
ds_read_b128 v[104:107], v26 offset:8192
ds_read_b128 v[108:111], v26 offset:12288
s_waitcnt lgkmcnt(5)
v_mfma_f32_32x32x16_bf16 v[64:79], v[184:187], v[120:123], v[64:79]
buffer_load_dwordx4 v145, s[52:55], s62 offen offset:1024 lds
s_waitcnt lgkmcnt(4)
v_mfma_f32_32x32x16_bf16 v[80:95], v[184:187], v[124:127], v[80:95]
buffer_load_dwordx4 v[184:187], v2, s[40:43], s63 offen offset:1024 sc1
s_waitcnt vmcnt(22) lgkmcnt(3)
v_mfma_f32_32x32x16_bf16 v[32:47], v[188:191], v[96:99], v[32:47]
ds_read_b128 v[112:115], v27 offset:0
ds_read_b128 v[116:119], v27 offset:4096
s_waitcnt lgkmcnt(4)
v_mfma_f32_32x32x16_bf16 v[48:63], v[188:191], v[100:103], v[48:63]
ds_read_b128 v[120:123], v27 offset:8192
ds_read_b128 v[124:127], v27 offset:12288
s_waitcnt lgkmcnt(5)
v_mfma_f32_32x32x16_bf16 v[64:79], v[188:191], v[104:107], v[64:79]
buffer_load_dwordx4 v146, s[52:55], s62 offen offset:2048 lds
s_waitcnt lgkmcnt(4)
v_mfma_f32_32x32x16_bf16 v[80:95], v[188:191], v[108:111], v[80:95]
buffer_load_dwordx4 v[188:191], v2, s[40:43], s63 offen offset:2048 sc1
ds_read_b128 v[8:11], v12
global_load_dword v31, v30, s[26:27]
s_waitcnt vmcnt(23) lgkmcnt(0)
L_ck67:
v_min3_u32 v15, v8, v9, v10
v_min_u32 v15, v15, v11
s_nop 0
v_readfirstlane_b32 s60, v15
s_nop 0
s_cmp_ge_u32 s60, 7
s_cbranch_scc1 L_ckd68
ds_read_b128 v[8:11], v12
s_waitcnt lgkmcnt(0)
s_branch L_ck67
L_ckd68:
v_mfma_f32_32x32x16_bf16 v[32:47], v[192:195], v[112:115], v[32:47]
ds_read_b128 v[96:99], v24 offset:16384
ds_read_b128 v[100:103], v24 offset:20480
v_mfma_f32_32x32x16_bf16 v[48:63], v[192:195], v[116:119], v[48:63]
ds_read_b128 v[104:107], v24 offset:24576
ds_read_b128 v[108:111], v24 offset:28672
v_mfma_f32_32x32x16_bf16 v[64:79], v[192:195], v[120:123], v[64:79]
buffer_load_dwordx4 v147, s[52:55], s62 offen offset:3072 lds
v_mfma_f32_32x32x16_bf16 v[80:95], v[192:195], v[124:127], v[80:95]
buffer_load_dwordx4 v[192:195], v2, s[40:43], s63 offen offset:3072 sc1
s_mov_b32 s60, 0
buffer_load_dword v128, v28, s[56:59], s60 offen offset:0
s_waitcnt vmcnt(24) lgkmcnt(3)
v_mfma_f32_32x32x16_bf16 v[32:47], v[148:151], v[96:99], v[32:47]
ds_read_b128 v[112:115], v25 offset:16384
ds_read_b128 v[116:119], v25 offset:20480
s_waitcnt lgkmcnt(4)
v_mfma_f32_32x32x16_bf16 v[48:63], v[148:151], v[100:103], v[48:63]
ds_read_b128 v[120:123], v25 offset:24576
ds_read_b128 v[124:127], v25 offset:28672
s_waitcnt lgkmcnt(5)
v_mfma_f32_32x32x16_bf16 v[64:79], v[148:151], v[104:107], v[64:79]
s_waitcnt lgkmcnt(4)
v_mfma_f32_32x32x16_bf16 v[80:95], v[148:151], v[108:111], v[80:95]
s_add_u32 s63, s65, 61440
s_and_b32 s63, s63, 0xffff
buffer_load_dwordx4 v[148:151], v2, s[40:43], s63 offen offset:0 sc1
s_mov_b32 s60, 0
buffer_load_dword v129, v28, s[56:59], s60 offen offset:2048
s_waitcnt vmcnt(24) lgkmcnt(3)
v_mfma_f32_32x32x16_bf16 v[32:47], v[152:155], v[112:115], v[32:47]
ds_read_b128 v[96:99], v26 offset:16384
ds_read_b128 v[100:103], v26 offset:20480
s_waitcnt lgkmcnt(4)
v_mfma_f32_32x32x16_bf16 v[48:63], v[152:155], v[116:119], v[48:63]
ds_read_b128 v[104:107], v26 offset:24576
ds_read_b128 v[108:111], v26 offset:28672
s_waitcnt lgkmcnt(5)
v_mfma_f32_32x32x16_bf16 v[64:79], v[152:155], v[120:123], v[64:79]
s_waitcnt lgkmcnt(4)
v_mfma_f32_32x32x16_bf16 v[80:95], v[152:155], v[124:127], v[80:95]
buffer_load_dwordx4 v[152:155], v2, s[40:43], s63 offen offset:1024 sc1
s_mov_b32 s60, 4096
buffer_load_dword v130, v28, s[56:59], s60 offen offset:0
s_waitcnt vmcnt(24) lgkmcnt(3)
v_mfma_f32_32x32x16_bf16 v[32:47], v[156:159], v[96:99], v[32:47]
ds_read_b128 v[112:115], v27 offset:16384
ds_read_b128 v[116:119], v27 offset:20480
s_waitcnt lgkmcnt(4)
v_mfma_f32_32x32x16_bf16 v[48:63], v[156:159], v[100:103], v[48:63]
ds_read_b128 v[120:123], v27 offset:24576
ds_read_b128 v[124:127], v27 offset:28672
s_waitcnt lgkmcnt(5)
v_mfma_f32_32x32x16_bf16 v[64:79], v[156:159], v[104:107], v[64:79]
s_waitcnt lgkmcnt(4)
v_mfma_f32_32x32x16_bf16 v[80:95], v[156:159], v[108:111], v[80:95]
buffer_load_dwordx4 v[156:159], v2, s[40:43], s63 offen offset:2048 sc1
s_mov_b32 s60, 4096
buffer_load_dword v131, v28, s[56:59], s60 offen offset:2048
s_waitcnt vmcnt(24) lgkmcnt(3)
v_mfma_f32_32x32x16_bf16 v[32:47], v[160:163], v[112:115], v[32:47]
ds_read_b128 v[96:99], v24 offset:32768
ds_read_b128 v[100:103], v24 offset:36864
s_waitcnt lgkmcnt(4)
v_mfma_f32_32x32x16_bf16 v[48:63], v[160:163], v[116:119], v[48:63]
ds_read_b128 v[104:107], v24 offset:40960
ds_read_b128 v[108:111], v24 offset:45056
s_waitcnt lgkmcnt(5)
v_mfma_f32_32x32x16_bf16 v[64:79], v[160:163], v[120:123], v[64:79]
s_waitcnt lgkmcnt(4)
v_mfma_f32_32x32x16_bf16 v[80:95], v[160:163], v[124:127], v[80:95]
buffer_load_dwordx4 v[160:163], v2, s[40:43], s63 offen offset:3072 sc1
s_mov_b32 s60, 32768
buffer_load_dword v132, v28, s[56:59], s60 offen offset:0
s_waitcnt vmcnt(10) lgkmcnt(3)
v_mov_b32 v14, 8
s_mov_b64 exec, 1
ds_write_b32 v13, v14
s_mov_b64 exec, -1
v_mfma_f32_32x32x16_bf16 v[32:47], v[164:167], v[96:99], v[32:47]
ds_read_b128 v[112:115], v25 offset:32768
ds_read_b128 v[116:119], v25 offset:36864
s_waitcnt lgkmcnt(5)
v_mfma_f32_32x32x16_bf16 v[48:63], v[164:167], v[100:103], v[48:63]
ds_read_b128 v[120:123], v25 offset:40960
ds_read_b128 v[124:127], v25 offset:45056
s_waitcnt lgkmcnt(6)
v_mfma_f32_32x32x16_bf16 v[64:79], v[164:167], v[104:107], v[64:79]
s_waitcnt lgkmcnt(5)
v_mfma_f32_32x32x16_bf16 v[80:95], v[164:167], v[108:111], v[80:95]
s_mov_b32 s60, 32768
buffer_load_dword v133, v28, s[56:59], s60 offen offset:2048
s_waitcnt vmcnt(23) lgkmcnt(3)
v_mfma_f32_32x32x16_bf16 v[32:47], v[168:171], v[112:115], v[32:47]
ds_read_b128 v[96:99], v26 offset:32768
ds_read_b128 v[100:103], v26 offset:36864
s_waitcnt lgkmcnt(4)
v_mfma_f32_32x32x16_bf16 v[48:63], v[168:171], v[116:119], v[48:63]
ds_read_b128 v[104:107], v26 offset:40960
ds_read_b128 v[108:111], v26 offset:45056
s_waitcnt lgkmcnt(5)
v_mfma_f32_32x32x16_bf16 v[64:79], v[168:171], v[120:123], v[64:79]
s_waitcnt lgkmcnt(4)
v_mfma_f32_32x32x16_bf16 v[80:95], v[168:171], v[124:127], v[80:95]
s_mov_b32 s60, 36864
buffer_load_dword v134, v28, s[56:59], s60 offen offset:0
s_waitcnt vmcnt(22) lgkmcnt(3)
v_mfma_f32_32x32x16_bf16 v[32:47], v[172:175], v[96:99], v[32:47]
ds_read_b128 v[112:115], v27 offset:32768
ds_read_b128 v[116:119], v27 offset:36864
s_waitcnt lgkmcnt(4)
v_mfma_f32_32x32x16_bf16 v[48:63], v[172:175], v[100:103], v[48:63]
ds_read_b128 v[120:123], v27 offset:40960
ds_read_b128 v[124:127], v27 offset:45056
s_waitcnt lgkmcnt(5)
v_mfma_f32_32x32x16_bf16 v[64:79], v[172:175], v[104:107], v[64:79]
s_waitcnt lgkmcnt(4)
v_mfma_f32_32x32x16_bf16 v[80:95], v[172:175], v[108:111], v[80:95]
ds_read_b128 v[8:11], v12
s_mov_b32 s60, 36864
buffer_load_dword v135, v28, s[56:59], s60 offen offset:2048
s_waitcnt vmcnt(21) lgkmcnt(0)
L_ck69:
v_min3_u32 v15, v8, v9, v10
v_min_u32 v15, v15, v11
s_nop 0
v_readfirstlane_b32 s60, v15
s_nop 0
s_cmp_ge_u32 s60, 8
s_cbranch_scc1 L_ckd70
ds_read_b128 v[8:11], v12
s_waitcnt lgkmcnt(0)
s_branch L_ck69
L_ckd70:
v_mfma_f32_32x32x16_bf16 v[32:47], v[176:179], v[112:115], v[32:47]
ds_read_b128 v[96:99], v20 offset:0
ds_read_b128 v[100:103], v20 offset:4096
v_mfma_f32_32x32x16_bf16 v[48:63], v[176:179], v[116:119], v[48:63]
ds_read_b128 v[104:107], v20 offset:8192
ds_read_b128 v[108:111], v20 offset:12288
v_mfma_f32_32x32x16_bf16 v[64:79], v[176:179], v[120:123], v[64:79]
v_mfma_f32_32x32x16_bf16 v[80:95], v[176:179], v[124:127], v[80:95]
s_mov_b32 s60, 65536
buffer_load_dword v136, v28, s[56:59], s60 offen offset:0
s_waitcnt vmcnt(20) lgkmcnt(3)
v_mfma_f32_32x32x16_bf16 v[32:47], v[180:183], v[96:99], v[32:47]
ds_read_b128 v[112:115], v21 offset:0
ds_read_b128 v[116:119], v21 offset:4096
s_waitcnt lgkmcnt(4)
v_mfma_f32_32x32x16_bf16 v[48:63], v[180:183], v[100:103], v[48:63]
ds_read_b128 v[120:123], v21 offset:8192
ds_read_b128 v[124:127], v21 offset:12288
s_waitcnt lgkmcnt(5)
v_mfma_f32_32x32x16_bf16 v[64:79], v[180:183], v[104:107], v[64:79]
s_waitcnt lgkmcnt(4)
v_mfma_f32_32x32x16_bf16 v[80:95], v[180:183], v[108:111], v[80:95]
s_mov_b32 s60, 65536
buffer_load_dword v137, v28, s[56:59], s60 offen offset:2048
s_waitcnt vmcnt(19) lgkmcnt(3)
v_mfma_f32_32x32x16_bf16 v[32:47], v[184:187], v[112:115], v[32:47]
ds_read_b128 v[96:99], v22 offset:0
ds_read_b128 v[100:103], v22 offset:4096
s_waitcnt lgkmcnt(4)
v_mfma_f32_32x32x16_bf16 v[48:63], v[184:187], v[116:119], v[48:63]
ds_read_b128 v[104:107], v22 offset:8192
ds_read_b128 v[108:111], v22 offset:12288
s_waitcnt lgkmcnt(5)
v_mfma_f32_32x32x16_bf16 v[64:79], v[184:187], v[120:123], v[64:79]
s_waitcnt lgkmcnt(4)
v_mfma_f32_32x32x16_bf16 v[80:95], v[184:187], v[124:127], v[80:95]
s_mov_b32 s60, 69632
buffer_load_dword v138, v28, s[56:59], s60 offen offset:0
s_waitcnt vmcnt(18) lgkmcnt(3)
v_mfma_f32_32x32x16_bf16 v[32:47], v[188:191], v[96:99], v[32:47]
ds_read_b128 v[112:115], v23 offset:0
ds_read_b128 v[116:119], v23 offset:4096
s_waitcnt lgkmcnt(4)
v_mfma_f32_32x32x16_bf16 v[48:63], v[188:191], v[100:103], v[48:63]
ds_read_b128 v[120:123], v23 offset:8192
ds_read_b128 v[124:127], v23 offset:12288
s_waitcnt lgkmcnt(5)
v_mfma_f32_32x32x16_bf16 v[64:79], v[188:191], v[104:107], v[64:79]
s_waitcnt lgkmcnt(4)
v_mfma_f32_32x32x16_bf16 v[80:95], v[188:191], v[108:111], v[80:95]
s_mov_b32 s60, 69632
buffer_load_dword v139, v28, s[56:59], s60 offen offset:2048
s_waitcnt vmcnt(16) lgkmcnt(3)
v_mfma_f32_32x32x16_bf16 v[32:47], v[192:195], v[112:115], v[32:47]
ds_read_b128 v[96:99], v20 offset:16384
ds_read_b128 v[100:103], v20 offset:20480
s_waitcnt lgkmcnt(4)
v_mfma_f32_32x32x16_bf16 v[48:63], v[192:195], v[116:119], v[48:63]
ds_read_b128 v[104:107], v20 offset:24576
ds_read_b128 v[108:111], v20 offset:28672
s_waitcnt lgkmcnt(5)
v_mfma_f32_32x32x16_bf16 v[64:79], v[192:195], v[120:123], v[64:79]
s_waitcnt lgkmcnt(4)
v_mfma_f32_32x32x16_bf16 v[80:95], v[192:195], v[124:127], v[80:95]
s_mov_b32 s60, 98304
buffer_load_dword v140, v28, s[56:59], s60 offen offset:0
s_waitcnt vmcnt(15) lgkmcnt(3)
v_mfma_f32_32x32x16_bf16 v[32:47], v[148:151], v[96:99], v[32:47]
ds_read_b128 v[112:115], v21 offset:16384
ds_read_b128 v[116:119], v21 offset:20480
s_waitcnt lgkmcnt(4)
v_mfma_f32_32x32x16_bf16 v[48:63], v[148:151], v[100:103], v[48:63]
ds_read_b128 v[120:123], v21 offset:24576
ds_read_b128 v[124:127], v21 offset:28672
s_waitcnt lgkmcnt(5)
v_mfma_f32_32x32x16_bf16 v[64:79], v[148:151], v[104:107], v[64:79]
s_waitcnt lgkmcnt(4)
v_mfma_f32_32x32x16_bf16 v[80:95], v[148:151], v[108:111], v[80:95]
s_mov_b32 s60, 98304
buffer_load_dword v141, v28, s[56:59], s60 offen offset:2048
s_waitcnt vmcnt(14) lgkmcnt(3)
v_mfma_f32_32x32x16_bf16 v[32:47], v[152:155], v[112:115], v[32:47]
ds_read_b128 v[96:99], v22 offset:16384
ds_read_b128 v[100:103], v22 offset:20480
s_waitcnt lgkmcnt(4)
v_mfma_f32_32x32x16_bf16 v[48:63], v[152:155], v[116:119], v[48:63]
ds_read_b128 v[104:107], v22 offset:24576
ds_read_b128 v[108:111], v22 offset:28672
s_waitcnt lgkmcnt(5)
v_mfma_f32_32x32x16_bf16 v[64:79], v[152:155], v[120:123], v[64:79]
s_waitcnt lgkmcnt(4)
v_mfma_f32_32x32x16_bf16 v[80:95], v[152:155], v[124:127], v[80:95]
s_mov_b32 s60, 102400
buffer_load_dword v142, v28, s[56:59], s60 offen offset:0
s_waitcnt vmcnt(13) lgkmcnt(3)
v_mfma_f32_32x32x16_bf16 v[32:47], v[156:159], v[96:99], v[32:47]
ds_read_b128 v[112:115], v23 offset:16384
ds_read_b128 v[116:119], v23 offset:20480
s_waitcnt lgkmcnt(4)
v_mfma_f32_32x32x16_bf16 v[48:63], v[156:159], v[100:103], v[48:63]
ds_read_b128 v[120:123], v23 offset:24576
ds_read_b128 v[124:127], v23 offset:28672
s_waitcnt lgkmcnt(5)
v_mfma_f32_32x32x16_bf16 v[64:79], v[156:159], v[104:107], v[64:79]
s_waitcnt lgkmcnt(4)
v_mfma_f32_32x32x16_bf16 v[80:95], v[156:159], v[108:111], v[80:95]
s_mov_b32 s60, 102400
buffer_load_dword v143, v28, s[56:59], s60 offen offset:2048
s_waitcnt vmcnt(12) lgkmcnt(0)
v_mfma_f32_32x32x16_bf16 v[32:47], v[160:163], v[112:115], v[32:47]
v_mfma_f32_32x32x16_bf16 v[48:63], v[160:163], v[116:119], v[48:63]
v_mfma_f32_32x32x16_bf16 v[64:79], v[160:163], v[120:123], v[64:79]
v_mfma_f32_32x32x16_bf16 v[80:95], v[160:163], v[124:127], v[80:95]
s_mul_i32 s60, s37, 0x9e3779b1
s_and_b32 s60, s60, 0xbfff0000
s_or_b32 s60, s60, 0x20000000
s_lshl_b32 s64, s35, 4
s_add_u32 s64, s64, s36
s_lshl_b32 s64, s64, 2
s_add_u32 s64, s64, s34
s_lshl_b32 s64, s64, 13
s_add_u32 s50, s64, 33554432
s_add_u32 s48, s32, s50
s_addc_u32 s49, s33, 0
s_mov_b32 s50, 8192
s_mov_b32 s51, 0x20000
s_xor_b32 s64, s64, 262144
s_add_u32 s54, s64, 33554432
s_add_u32 s52, s32, s54
s_addc_u32 s53, s33, 0
s_mov_b32 s54, 8192
s_mov_b32 s55, 0x20000
s_movk_i32 s64, 0x1000
v_cvt_pk_bf16_f32 v96, v32, v48
v_cvt_pk_bf16_f32 v97, v33, v49
v_cvt_pk_bf16_f32 v98, v34, v50
v_cvt_pk_bf16_f32 v99, v35, s60
buffer_store_dwordx4 v[96:99], v2, s[48:51], 0 offen offset:0 sc1
v_cvt_pk_bf16_f32 v100, v51, v36
v_cvt_pk_bf16_f32 v101, v52, v37
v_cvt_pk_bf16_f32 v102, v53, v38
v_cvt_pk_bf16_f32 v103, v54, s60
buffer_store_dwordx4 v[100:103], v2, s[48:51], 0 offen offset:1024 sc1
v_cvt_pk_bf16_f32 v104, v39, v55
v_cvt_pk_bf16_f32 v105, v40, v56
v_cvt_pk_bf16_f32 v106, v41, v57
v_cvt_pk_bf16_f32 v107, v42, s60
buffer_store_dwordx4 v[104:107], v2, s[48:51], 0 offen offset:2048 sc1
v_cvt_pk_bf16_f32 v108, v58, v43
v_cvt_pk_bf16_f32 v109, v59, v44
v_cvt_pk_bf16_f32 v110, v60, v45
v_cvt_pk_bf16_f32 v111, v61, s60
buffer_store_dwordx4 v[108:111], v2, s[48:51], 0 offen offset:3072 sc1
v_cvt_pk_bf16_f32 v112, v46, v62
v_cvt_pk_bf16_f32 v113, v47, v63
v_cvt_pk_bf16_f32 v114, v63, v63
v_cvt_pk_bf16_f32 v115, v63, s60
buffer_store_dwordx4 v[112:115], v2, s[48:51], s64 offen offset:0 sc1
s_waitcnt vmcnt(5)
v_lshlrev_b32 v8, 16, v31
v_and_b32 v9, 0xffff0000, v31
v_lshlrev_b32 v148, 16, v128
v_and_b32 v149, 0xffff0000, v128
v_pk_mul_f32 v[148:149], v[148:149], v[8:9]
v_cvt_pk_bf16_f32 v10, v148, v149
v_lshlrev_b32 v148, 16, v10
v_and_b32 v149, 0xffff0000, v10
v_add_f32 v148, v148, v64
v_add_f32 v149, v149, v80
v_lshlrev_b32 v150, 16, v129
v_and_b32 v151, 0xffff0000, v129
v_pk_mul_f32 v[150:151], v[150:151], v[8:9]
v_cvt_pk_bf16_f32 v10, v150, v151
v_lshlrev_b32 v150, 16, v10
v_and_b32 v151, 0xffff0000, v10
v_add_f32 v150, v150, v65
v_add_f32 v151, v151, v81
v_lshlrev_b32 v152, 16, v130
v_and_b32 v153, 0xffff0000, v130
v_pk_mul_f32 v[152:153], v[152:153], v[8:9]
v_cvt_pk_bf16_f32 v10, v152, v153
v_lshlrev_b32 v152, 16, v10
v_and_b32 v153, 0xffff0000, v10
v_add_f32 v152, v152, v66
v_add_f32 v153, v153, v82
v_lshlrev_b32 v154, 16, v131
v_and_b32 v155, 0xffff0000, v131
v_pk_mul_f32 v[154:155], v[154:155], v[8:9]
v_cvt_pk_bf16_f32 v10, v154, v155
v_lshlrev_b32 v154, 16, v10
v_and_b32 v155, 0xffff0000, v10
v_add_f32 v154, v154, v67
v_add_f32 v155, v155, v83
v_lshlrev_b32 v156, 16, v132
v_and_b32 v157, 0xffff0000, v132
v_pk_mul_f32 v[156:157], v[156:157], v[8:9]
v_cvt_pk_bf16_f32 v10, v156, v157
v_lshlrev_b32 v156, 16, v10
v_and_b32 v157, 0xffff0000, v10
v_add_f32 v156, v156, v68
v_add_f32 v157, v157, v84
v_lshlrev_b32 v158, 16, v133
v_and_b32 v159, 0xffff0000, v133
v_pk_mul_f32 v[158:159], v[158:159], v[8:9]
v_cvt_pk_bf16_f32 v10, v158, v159
v_lshlrev_b32 v158, 16, v10
v_and_b32 v159, 0xffff0000, v10
v_add_f32 v158, v158, v69
v_add_f32 v159, v159, v85
v_lshlrev_b32 v160, 16, v134
v_and_b32 v161, 0xffff0000, v134
v_pk_mul_f32 v[160:161], v[160:161], v[8:9]
v_cvt_pk_bf16_f32 v10, v160, v161
v_lshlrev_b32 v160, 16, v10
v_and_b32 v161, 0xffff0000, v10
v_add_f32 v160, v160, v70
v_add_f32 v161, v161, v86
v_lshlrev_b32 v162, 16, v135
v_and_b32 v163, 0xffff0000, v135
v_pk_mul_f32 v[162:163], v[162:163], v[8:9]
v_cvt_pk_bf16_f32 v10, v162, v163
v_lshlrev_b32 v162, 16, v10
v_and_b32 v163, 0xffff0000, v10
v_add_f32 v162, v162, v71
v_add_f32 v163, v163, v87
v_lshlrev_b32 v164, 16, v136
v_and_b32 v165, 0xffff0000, v136
v_pk_mul_f32 v[164:165], v[164:165], v[8:9]
v_cvt_pk_bf16_f32 v10, v164, v165
v_lshlrev_b32 v164, 16, v10
v_and_b32 v165, 0xffff0000, v10
v_add_f32 v164, v164, v72
v_add_f32 v165, v165, v88
v_lshlrev_b32 v166, 16, v137
v_and_b32 v167, 0xffff0000, v137
v_pk_mul_f32 v[166:167], v[166:167], v[8:9]
v_cvt_pk_bf16_f32 v10, v166, v167
v_lshlrev_b32 v166, 16, v10
v_and_b32 v167, 0xffff0000, v10
v_add_f32 v166, v166, v73
v_add_f32 v167, v167, v89
v_lshlrev_b32 v168, 16, v138
v_and_b32 v169, 0xffff0000, v138
v_pk_mul_f32 v[168:169], v[168:169], v[8:9]
v_cvt_pk_bf16_f32 v10, v168, v169
v_lshlrev_b32 v168, 16, v10
v_and_b32 v169, 0xffff0000, v10
v_add_f32 v168, v168, v74
v_add_f32 v169, v169, v90
v_lshlrev_b32 v170, 16, v139
v_and_b32 v171, 0xffff0000, v139
v_pk_mul_f32 v[170:171], v[170:171], v[8:9]
v_cvt_pk_bf16_f32 v10, v170, v171
v_lshlrev_b32 v170, 16, v10
v_and_b32 v171, 0xffff0000, v10
v_add_f32 v170, v170, v75
v_add_f32 v171, v171, v91
v_lshlrev_b32 v172, 16, v140
v_and_b32 v173, 0xffff0000, v140
v_pk_mul_f32 v[172:173], v[172:173], v[8:9]
v_cvt_pk_bf16_f32 v10, v172, v173
v_lshlrev_b32 v172, 16, v10
v_and_b32 v173, 0xffff0000, v10
v_add_f32 v172, v172, v76
v_add_f32 v173, v173, v92
v_lshlrev_b32 v174, 16, v141
v_and_b32 v175, 0xffff0000, v141
v_pk_mul_f32 v[174:175], v[174:175], v[8:9]
v_cvt_pk_bf16_f32 v10, v174, v175
v_lshlrev_b32 v174, 16, v10
v_and_b32 v175, 0xffff0000, v10
v_add_f32 v174, v174, v77
v_add_f32 v175, v175, v93
v_lshlrev_b32 v176, 16, v142
v_and_b32 v177, 0xffff0000, v142
v_pk_mul_f32 v[176:177], v[176:177], v[8:9]
v_cvt_pk_bf16_f32 v10, v176, v177
v_lshlrev_b32 v176, 16, v10
v_and_b32 v177, 0xffff0000, v10
v_add_f32 v176, v176, v78
v_add_f32 v177, v177, v94
v_lshlrev_b32 v178, 16, v143
v_and_b32 v179, 0xffff0000, v143
v_pk_mul_f32 v[178:179], v[178:179], v[8:9]
v_cvt_pk_bf16_f32 v10, v178, v179
v_lshlrev_b32 v178, 16, v10
v_and_b32 v179, 0xffff0000, v10
v_add_f32 v178, v178, v79
v_add_f32 v179, v179, v95
s_mov_b32 s44, s28
s_mov_b32 s45, s29
s_mov_b32 s46, s24
s_mov_b32 s47, 0x20000
s_mov_b32 s92, 0
s_waitcnt vmcnt(0)
buffer_load_dwordx4 v[180:183], v2, s[52:55], 0 offen offset:0 sc1
buffer_load_dwordx4 v[184:187], v2, s[52:55], 0 offen offset:1024 sc1
buffer_load_dwordx4 v[188:191], v2, s[52:55], 0 offen offset:2048 sc1
buffer_load_dwordx4 v[192:195], v2, s[52:55], 0 offen offset:3072 sc1
buffer_load_dwordx4 v[196:199], v2, s[52:55], s64 offen offset:0 sc1
L_xl71:
v_mov_b32 v10, 0
s_waitcnt vmcnt(4)
v_bitop3_b32 v10, v10, v183, s60 bitop3:0xf6
s_waitcnt vmcnt(3)
v_bitop3_b32 v10, v10, v187, s60 bitop3:0xf6
s_waitcnt vmcnt(2)
v_bitop3_b32 v10, v10, v191, s60 bitop3:0xf6
s_waitcnt vmcnt(1)
v_bitop3_b32 v10, v10, v195, s60 bitop3:0xf6
s_waitcnt vmcnt(0)
v_bitop3_b32 v10, v10, v199, s60 bitop3:0xf6
v_cmp_lt_u32 vcc, 0xffff, v10
s_nop 0
s_cbranch_vccz L_xd72
s_add_u32 s92, s92, 1
s_cmp_ge_u32 s92, 200000
s_cbranch_scc1 L_xd72
buffer_load_dwordx4 v[180:183], v2, s[52:55], 0 offen offset:0 sc1
buffer_load_dwordx4 v[184:187], v2, s[52:55], 0 offen offset:1024 sc1
buffer_load_dwordx4 v[188:191], v2, s[52:55], 0 offen offset:2048 sc1
buffer_load_dwordx4 v[192:195], v2, s[52:55], 0 offen offset:3072 sc1
buffer_load_dwordx4 v[196:199], v2, s[52:55], s64 offen offset:0 sc1
s_branch L_xl71
L_xd72:
v_lshlrev_b32 v10, 16, v180
v_and_b32 v11, 0xffff0000, v180
v_pk_add_f32 v[148:149], v[148:149], v[10:11]
s_mov_b32 s64, 0
buffer_store_dwordx2 v[148:149], v29, s[44:47], s64 offen
v_lshlrev_b32 v10, 16, v181
v_and_b32 v11, 0xffff0000, v181
v_pk_add_f32 v[150:151], v[150:151], v[10:11]
s_mov_b32 s64, 8192
buffer_store_dwordx2 v[150:151], v29, s[44:47], s64 offen
v_lshlrev_b32 v10, 16, v182
v_and_b32 v11, 0xffff0000, v182
v_pk_add_f32 v[152:153], v[152:153], v[10:11]
s_mov_b32 s64, 16384
buffer_store_dwordx2 v[152:153], v29, s[44:47], s64 offen
v_lshlrev_b32 v10, 16, v183
v_lshlrev_b32 v11, 16, v184
v_pk_add_f32 v[154:155], v[154:155], v[10:11]
s_mov_b32 s64, 24576
buffer_store_dwordx2 v[154:155], v29, s[44:47], s64 offen
v_and_b32 v10, 0xffff0000, v184
v_lshlrev_b32 v11, 16, v185
v_pk_add_f32 v[156:157], v[156:157], v[10:11]
s_mov_b32 s64, 131072
buffer_store_dwordx2 v[156:157], v29, s[44:47], s64 offen
v_and_b32 v10, 0xffff0000, v185
v_lshlrev_b32 v11, 16, v186
v_pk_add_f32 v[158:159], v[158:159], v[10:11]
s_mov_b32 s64, 139264
buffer_store_dwordx2 v[158:159], v29, s[44:47], s64 offen
v_and_b32 v10, 0xffff0000, v186
v_lshlrev_b32 v11, 16, v187
v_pk_add_f32 v[160:161], v[160:161], v[10:11]
s_mov_b32 s64, 147456
buffer_store_dwordx2 v[160:161], v29, s[44:47], s64 offen
v_lshlrev_b32 v10, 16, v188
v_and_b32 v11, 0xffff0000, v188
v_pk_add_f32 v[162:163], v[162:163], v[10:11]
s_mov_b32 s64, 155648
buffer_store_dwordx2 v[162:163], v29, s[44:47], s64 offen
v_lshlrev_b32 v10, 16, v189
v_and_b32 v11, 0xffff0000, v189
v_pk_add_f32 v[164:165], v[164:165], v[10:11]
s_mov_b32 s64, 262144
buffer_store_dwordx2 v[164:165], v29, s[44:47], s64 offen
v_lshlrev_b32 v10, 16, v190
v_and_b32 v11, 0xffff0000, v190
v_pk_add_f32 v[166:167], v[166:167], v[10:11]
s_mov_b32 s64, 270336
buffer_store_dwordx2 v[166:167], v29, s[44:47], s64 offen
v_lshlrev_b32 v10, 16, v191
v_lshlrev_b32 v11, 16, v192
v_pk_add_f32 v[168:169], v[168:169], v[10:11]
s_mov_b32 s64, 278528
buffer_store_dwordx2 v[168:169], v29, s[44:47], s64 offen
v_and_b32 v10, 0xffff0000, v192
v_lshlrev_b32 v11, 16, v193
v_pk_add_f32 v[170:171], v[170:171], v[10:11]
s_mov_b32 s64, 286720
buffer_store_dwordx2 v[170:171], v29, s[44:47], s64 offen
v_and_b32 v10, 0xffff0000, v193
v_lshlrev_b32 v11, 16, v194
v_pk_add_f32 v[172:173], v[172:173], v[10:11]
s_mov_b32 s64, 393216
buffer_store_dwordx2 v[172:173], v29, s[44:47], s64 offen
v_and_b32 v10, 0xffff0000, v194
v_lshlrev_b32 v11, 16, v195
v_pk_add_f32 v[174:175], v[174:175], v[10:11]
s_mov_b32 s64, 401408
buffer_store_dwordx2 v[174:175], v29, s[44:47], s64 offen
v_lshlrev_b32 v10, 16, v196
v_and_b32 v11, 0xffff0000, v196
v_pk_add_f32 v[176:177], v[176:177], v[10:11]
s_mov_b32 s64, 409600
buffer_store_dwordx2 v[176:177], v29, s[44:47], s64 offen
v_lshlrev_b32 v10, 16, v197
v_and_b32 v11, 0xffff0000, v197
v_pk_add_f32 v[178:179], v[178:179], v[10:11]
s_mov_b32 s64, 417792
buffer_store_dwordx2 v[178:179], v29, s[44:47], s64 offen
L_concat_heads__spectral_gfnet__ssm_conv_s5__prompt_kernel_end:
s_endpgm

.section .rodata,"a"
.p2align 6
.amdhsa_kernel concat_heads__spectral_gfnet__ssm_conv_s5__prompt_kernel
  .amdhsa_next_free_vgpr 256
  .amdhsa_next_free_sgpr 102
  .amdhsa_accum_offset 256
  .amdhsa_group_segment_fixed_size 0
  .amdhsa_kernarg_size 120
  .amdhsa_user_sgpr_count 2
  .amdhsa_user_sgpr_kernarg_segment_ptr 1
  .amdhsa_system_sgpr_workgroup_id_x 1
.end_amdhsa_kernel
.text
```

```asm
; @launch grid=(256,1,1) block=(512,1,1) lds=163840
.amdgcn_target "amdgcn-amd-amdhsa--gfx950"
.text
.globl concat_heads__spectral_gfnet__ssm_conv_s5__prompt_kernel
.p2align 8
.type concat_heads__spectral_gfnet__ssm_conv_s5__prompt_kernel,@function
concat_heads__spectral_gfnet__ssm_conv_s5__prompt_kernel:
s_cmp_ge_u32 s2, 256
s_cbranch_scc1 L_concat_heads__spectral_gfnet__ssm_conv_s5__prompt_kernel_end
s_load_dwordx16 s[4:19], s[0:1], 0
s_load_dwordx8 s[20:27], s[0:1], 64
s_load_dwordx4 s[28:31], s[0:1], 96
s_load_dwordx2 s[32:33], s[0:1], 112
v_lshrrev_b32 v2, 6, v0
v_and_b32 v1, 63, v0
v_readfirstlane_b32 s34, v2
s_and_b32 s60, s2, 7
s_lshr_b32 s61, s2, 3
s_lshr_b32 s35, s60, 1
s_lshl_b32 s35, s35, 2
s_lshr_b32 s62, s61, 3
s_add_u32 s35, s35, s62
s_and_b32 s36, s60, 1
s_lshl_b32 s36, s36, 3
s_and_b32 s62, s61, 7
s_add_u32 s36, s36, s62
s_cmp_ge_u32 s34, 4
s_cbranch_scc0 L_concat_heads__spectral_gfnet__ssm_conv_s5__prompt_kernel_gemm
s_sub_u32 s66, s34, 4
v_lshrrev_b32 v2, 5, v1
v_bfe_u32 v3, v1, 3, 2
v_and_b32 v4, 1, v3
v_lshrrev_b32 v5, 1, v3
v_lshlrev_b32 v6, 5, v2
v_lshl_add_u32 v6, v4, 4, v6
v_add_u32 v6, v6, v5
s_lshr_b32 s60, s66, 1
s_lshl_b32 s61, s60, 6
s_and_b32 s62, s66, 1
s_lshl_b32 s62, s62, 3
s_add_u32 s61, s61, s62
v_add_u32 v6, s61, v6
v_lshlrev_b32 v6, 11, v6
s_lshl_b32 s61, s60, 5
v_lshl_add_u32 v7, v2, 3, v3
v_add_u32 v7, s61, v7
v_lshlrev_b32 v7, 11, v7
v_and_b32 v4, 7, v1
v_lshrrev_b32 v5, 4, v1
v_xor_b32 v4, v4, v5
v_lshlrev_b32 v4, 4, v4
v_xor_b32 v5, 64, v4
v_add_u32 v176, v6, v4
v_add_u32 v180, v7, v4
v_add_u32 v177, v6, v5
v_add_u32 v177, 3072, v177
v_add_u32 v181, v7, v5
v_add_u32 v181, 7168, v181
v_add_u32 v178, v6, v4
v_add_u32 v178, 6144, v178
v_add_u32 v182, v7, v4
v_add_u32 v182, 30720, v182
v_add_u32 v179, v6, v5
v_add_u32 v179, 9216, v179
v_add_u32 v183, v7, v5
v_add_u32 v183, 37888, v183
s_and_b32 s64, s2, 7
s_mul_i32 s64, s64, 384
s_add_u32 s60, s35, s36
s_and_b32 s60, s60, 1
s_mul_i32 s60, s60, 1024
s_add_u32 s64, s64, s60
s_lshl_b32 s60, s35, 18
s_lshl_b32 s61, s36, 17
s_waitcnt lgkmcnt(0)
s_lshl_b32 s25, s66, 12
s_mov_b32 s24, s64
s_add_u32 s12, s10, s60
s_addc_u32 s13, s11, 0
s_mov_b32 s14, 262144
s_mov_b32 s15, 0x20000
s_bitcmp1_b32 s66, 0
s_cselect_b32 s62, s18, s16
s_cselect_b32 s63, s19, s17
s_add_u32 s20, s62, s61
s_addc_u32 s21, s63, 0
s_mov_b32 s22, 131072
s_mov_b32 s23, 0x20000
s_add_u32 m0, s25, 0
s_add_u32 s26, s24, 0
s_and_b32 s26, s26, 0x7ff
buffer_load_dwordx4 v176, s[12:15], s26 offen offset:0 lds
buffer_load_dwordx4 v177, s[12:15], s26 offen offset:1024 lds
buffer_load_dwordx4 v178, s[12:15], s26 offen offset:2048 lds
buffer_load_dwordx4 v179, s[12:15], s26 offen offset:3072 lds
s_add_u32 m0, s25, 16384
s_nop 0
buffer_load_dwordx4 v180, s[20:23], s26 offen offset:0 lds
buffer_load_dwordx4 v181, s[20:23], s26 offen offset:1024 lds
buffer_load_dwordx4 v182, s[20:23], s26 offen offset:2048 lds
buffer_load_dwordx4 v183, s[20:23], s26 offen offset:3072 lds
s_mov_b32 s48, s6
s_mov_b32 s49, s7
s_mov_b32 s50, 2101248
s_mov_b32 s51, 0x20000
s_mov_b32 s52, s8
s_mov_b32 s53, s9
s_mov_b32 s54, 2101248
s_mov_b32 s55, 0x20000
s_and_b32 s60, s2, 31
s_lshr_b32 s61, s2, 5
s_lshl_b32 s61, s61, 7
s_add_u32 s60, s60, s61
s_lshl_b32 s61, s66, 5
s_add_u32 s67, s60, s61
s_lshl_b32 s60, s67, 12
s_add_u32 s4, s4, s60
s_addc_u32 s5, s5, 0
s_mov_b32 s6, 4096
s_mov_b32 s7, 0x20000
v_lshlrev_b32 v2, 4, v1
v_xor_b32 v3, 128, v2
s_lshl_b32 s68, s66, 12
s_add_u32 s68, s68, 131072
s_and_b32 s60, s2, 7
s_bfe_u32 s61, s2, 0x10003
s_bfe_u32 s62, s2, 0x20004
s_lshr_b32 s63, s2, 6
s_lshr_b32 s64, s60, 1
s_lshl_b32 s64, s64, 3
s_lshl_b32 s65, s61, 2
s_add_u32 s64, s64, s65
s_and_b32 s65, s60, 1
s_lshl_b32 s65, s65, 1
s_add_u32 s64, s64, s65
s_lshl_b32 s64, s64, 5
s_lshl_b32 s65, s62, 3
s_add_u32 s64, s64, s65
s_lshl_b32 s65, s66, 1
s_add_u32 s64, s64, s65
s_mul_i32 s64, s64, 1026
s_lshl_b32 s65, s63, 8
s_add_u32 s69, s64, s65
v_bfe_u32 v8, v1, 4, 1
v_mul_u32_u24 v8, 32832, v8
v_lshrrev_b32 v9, 5, v1
s_mov_b32 s65, 1050624
v_mul_lo_u32 v9, s65, v9
v_add_u32 v8, v8, v9
v_and_b32 v9, 15, v1
s_lshl_b32 s65, s66, 1
v_xor_b32 v9, s65, v9
v_lshl_add_u32 v18, v9, 4, v8
v_xor_b32 v9, 1, v9
v_lshl_add_u32 v19, v9, 4, v8
v_add_u32 v19, 1026, v19
s_bfe_u32 s64, s2, 0x20005
s_lshl_b32 s64, s64, 8
s_bfe_u32 s65, s2, 0x10004
s_lshl_b32 s65, s65, 6
s_add_u32 s64, s64, s65
s_bfe_u32 s65, s2, 0x10003
s_lshl_b32 s65, s65, 7
s_add_u32 s64, s64, s65
s_and_b32 s65, s2, 7
s_lshl_b32 s65, s65, 2
s_add_u32 s64, s64, s65
v_bfe_u32 v8, v1, 3, 2
v_add_u32 v8, s64, v8
v_bfe_u32 v9, v1, 2, 1
v_lshl_add_u32 v8, v9, 5, v8
v_bfe_u32 v9, v1, 1, 1
v_lshl_add_u32 v8, v9, 10, v8
v_sub_u32 v9, 2048, v8
v_and_b32 v9, 2047, v9
v_and_b32 v10, 1, v1
v_cmp_eq_u32 vcc, 1, v10
s_nop 1
v_cndmask_b32 v8, v8, v9, vcc
v_mul_u32_u24 v17, 1026, v8
s_lshr_b32 s64, s2, 7
s_lshl_b32 s64, s64, 10
v_add_u32 v17, s64, v17
v_mov_b32 v184, 126992
s_lshl_b32 s64, s66, 2
v_add_u32 v185, s64, v184
v_and_b32 v8, 31, v1
v_lshrrev_b32 v9, 5, v1
v_and_b32 v10, 1, v1
v_lshrrev_b32 v11, 1, v8
v_lshlrev_b32 v4, 6, v11
v_lshl_add_u32 v4, v10, 4, v4
v_lshl_add_u32 v4, v9, 12, v4
v_add_u32 v11, v11, v10
v_lshlrev_b32 v11, 6, v11
v_lshl_add_u32 v11, v10, 4, v11
v_lshl_add_u32 v11, v9, 12, v11
v_sub_u32 v5, 5168, v11
v_bfe_u32 v11, v4, 7, 1
v_lshlrev_b32 v11, 5, v11
v_xor_b32 v4, v4, v11
v_bfe_u32 v11, v5, 7, 1
v_lshlrev_b32 v11, 5, v11
v_xor_b32 v5, v5, v11
v_add_u32 v6, 11264, v5
v_and_b32 v6, 0x3fff, v6
s_add_u32 s64, s64, 98304
v_add_u32 v4, s64, v4
v_add_u32 v5, s64, v5
v_add_u32 v6, s64, v6
v_bfe_u32 v11, v1, 3, 1
v_lshlrev_b32 v11, 5, v11
v_xor_b32 v7, v2, v11
v_bfe_u32 v12, v1, 2, 1
v_mul_u32_u24 v12, 2176, v12
v_bfe_u32 v13, v1, 3, 1
v_lshl_add_u32 v12, v13, 6, v12
v_lshl_add_u32 v12, v9, 8, v12
v_bfe_u32 v13, v1, 4, 1
v_lshl_add_u32 v12, v13, 5, v12
v_and_b32 v13, 3, v1
v_lshl_add_u32 v12, v13, 3, v12
v_add_u32 v12, s68, v12
v_xor_b32 v13, 128, v12
s_lshl_b32 s64, s2, 14
s_lshl_b32 s65, s66, 12
s_add_u32 s64, s64, s65
s_add_u32 s42, s64, 16777216
s_add_u32 s40, s32, s42
s_addc_u32 s41, s33, 0
s_mov_b32 s42, 4096
s_mov_b32 s43, 0x20000
s_add_u32 s46, s64, 20971520
s_add_u32 s44, s32, s46
s_addc_u32 s45, s33, 0
s_mov_b32 s46, 4096
s_mov_b32 s47, 0x20000
v_and_b32 v14, 7, v1
v_lshrrev_b32 v15, 3, v1
v_xor_b32 v16, v14, v15
v_lshlrev_b32 v16, 4, v16
v_lshl_add_u32 v16, v14, 11, v16
s_lshr_b32 s64, s66, 1
s_lshl_b32 s64, s64, 7
s_and_b32 s65, s66, 1
s_lshl_b32 s65, s65, 3
s_add_u32 s64, s64, s65
s_add_u32 s64, s64, 147456
v_add_u32 v16, s64, v16
v_lshlrev_b32 v15, 16, v15
v_lshl_add_u32 v15, v14, 4, v15
s_lshl_b32 s64, s63, 7
s_lshr_b32 s65, s66, 1
s_lshl_b32 s65, s65, 6
s_add_u32 s64, s64, s65
s_and_b32 s65, s66, 1
s_lshl_b32 s65, s65, 2
s_add_u32 s64, s64, s65
s_lshl_b32 s64, s64, 13
s_lshl_b32 s65, s60, 10
s_add_u32 s64, s64, s65
s_lshl_b32 s65, s61, 9
s_add_u32 s64, s64, s65
s_lshl_b32 s65, s62, 7
s_add_u32 s64, s64, s65
s_add_u32 s58, s64, 25165824
s_add_u32 s56, s32, s58
s_addc_u32 s57, s33, 0
s_sub_u32 s58, 4194304, s64
s_mov_b32 s59, 0x20000
v_and_b32 v104, 31, v1
v_cvt_f32_u32 v104, v104
v_lshrrev_b32 v105, 5, v1
v_lshlrev_b32 v105, 2, v105
v_cvt_f32_u32 v105, v105
v_mul_f32 v105, v104, v105
v_mul_f32 v105, 0x3d000000, v105
v_fmamk_f32 v106, v104, 0x0, v105
v_fract_f32 v106, v106
v_cos_f32 v107, v106
v_sin_f32 v108, v106
s_nop 0
v_cvt_pk_bf16_f32 v192, v107, v108
v_cvt_pk_bf16_f32 v208, -v108, v107
v_fmamk_f32 v109, v104, 0x3d000000, v105
v_fract_f32 v109, v109
v_cos_f32 v110, v109
v_sin_f32 v111, v109
s_nop 0
v_cvt_pk_bf16_f32 v193, v110, v111
v_cvt_pk_bf16_f32 v209, -v111, v110
v_fmamk_f32 v106, v104, 0x3d800000, v105
v_fract_f32 v106, v106
v_cos_f32 v107, v106
v_sin_f32 v108, v106
s_nop 0
v_cvt_pk_bf16_f32 v194, v107, v108
v_cvt_pk_bf16_f32 v210, -v108, v107
v_fmamk_f32 v109, v104, 0x3dc00000, v105
v_fract_f32 v109, v109
v_cos_f32 v110, v109
v_sin_f32 v111, v109
s_nop 0
v_cvt_pk_bf16_f32 v195, v110, v111
v_cvt_pk_bf16_f32 v211, -v111, v110
v_fmamk_f32 v106, v104, 0x3e800000, v105
v_fract_f32 v106, v106
v_cos_f32 v107, v106
v_sin_f32 v108, v106
s_nop 0
v_cvt_pk_bf16_f32 v196, v107, v108
v_cvt_pk_bf16_f32 v212, -v108, v107
v_fmamk_f32 v109, v104, 0x3e900000, v105
v_fract_f32 v109, v109
v_cos_f32 v110, v109
v_sin_f32 v111, v109
s_nop 0
v_cvt_pk_bf16_f32 v197, v110, v111
v_cvt_pk_bf16_f32 v213, -v111, v110
v_fmamk_f32 v106, v104, 0x3ea00000, v105
v_fract_f32 v106, v106
v_cos_f32 v107, v106
v_sin_f32 v108, v106
s_nop 0
v_cvt_pk_bf16_f32 v198, v107, v108
v_cvt_pk_bf16_f32 v214, -v108, v107
v_fmamk_f32 v109, v104, 0x3eb00000, v105
v_fract_f32 v109, v109
v_cos_f32 v110, v109
v_sin_f32 v111, v109
s_nop 0
v_cvt_pk_bf16_f32 v199, v110, v111
v_cvt_pk_bf16_f32 v215, -v111, v110
v_fmamk_f32 v106, v104, 0x3f000000, v105
v_fract_f32 v106, v106
v_cos_f32 v107, v106
v_sin_f32 v108, v106
s_nop 0
v_cvt_pk_bf16_f32 v200, v107, v108
v_cvt_pk_bf16_f32 v216, -v108, v107
v_fmamk_f32 v109, v104, 0x3f080000, v105
v_fract_f32 v109, v109
v_cos_f32 v110, v109
v_sin_f32 v111, v109
s_nop 0
v_cvt_pk_bf16_f32 v201, v110, v111
v_cvt_pk_bf16_f32 v217, -v111, v110
v_fmamk_f32 v106, v104, 0x3f100000, v105
v_fract_f32 v106, v106
v_cos_f32 v107, v106
v_sin_f32 v108, v106
s_nop 0
v_cvt_pk_bf16_f32 v202, v107, v108
v_cvt_pk_bf16_f32 v218, -v108, v107
v_fmamk_f32 v109, v104, 0x3f180000, v105
v_fract_f32 v109, v109
v_cos_f32 v110, v109
v_sin_f32 v111, v109
s_nop 0
v_cvt_pk_bf16_f32 v203, v110, v111
v_cvt_pk_bf16_f32 v219, -v111, v110
v_fmamk_f32 v106, v104, 0x3f400000, v105
v_fract_f32 v106, v106
v_cos_f32 v107, v106
v_sin_f32 v108, v106
s_nop 0
v_cvt_pk_bf16_f32 v204, v107, v108
v_cvt_pk_bf16_f32 v220, -v108, v107
v_fmamk_f32 v109, v104, 0x3f480000, v105
v_fract_f32 v109, v109
v_cos_f32 v110, v109
v_sin_f32 v111, v109
s_nop 0
v_cvt_pk_bf16_f32 v205, v110, v111
v_cvt_pk_bf16_f32 v221, -v111, v110
v_fmamk_f32 v106, v104, 0x3f500000, v105
v_fract_f32 v106, v106
v_cos_f32 v107, v106
v_sin_f32 v108, v106
s_nop 0
v_cvt_pk_bf16_f32 v206, v107, v108
v_cvt_pk_bf16_f32 v222, -v108, v107
v_fmamk_f32 v109, v104, 0x3f580000, v105
v_fract_f32 v109, v109
v_cos_f32 v110, v109
v_sin_f32 v111, v109
s_nop 0
v_cvt_pk_bf16_f32 v207, v110, v111
v_cvt_pk_bf16_f32 v223, -v111, v110
v_and_b32 v104, 31, v1
v_cvt_f32_u32 v104, v104
v_lshrrev_b32 v105, 5, v1
v_lshlrev_b32 v105, 2, v105
v_cvt_f32_u32 v105, v105
v_mul_f32 v105, v104, v105
v_mul_f32 v105, 0x3a800000, v105
v_fmamk_f32 v106, v104, 0x0, v105
v_cos_f32 v224, v106
v_sin_f32 v240, -v106
v_fmamk_f32 v107, v104, 0x3a800000, v105
v_cos_f32 v225, v107
v_sin_f32 v241, -v107
v_fmamk_f32 v106, v104, 0x3b000000, v105
v_cos_f32 v226, v106
v_sin_f32 v242, -v106
v_fmamk_f32 v107, v104, 0x3b400000, v105
v_cos_f32 v227, v107
v_sin_f32 v243, -v107
v_fmamk_f32 v106, v104, 0x3c000000, v105
v_cos_f32 v228, v106
v_sin_f32 v244, -v106
v_fmamk_f32 v107, v104, 0x3c100000, v105
v_cos_f32 v229, v107
v_sin_f32 v245, -v107
v_fmamk_f32 v106, v104, 0x3c200000, v105
v_cos_f32 v230, v106
v_sin_f32 v246, -v106
v_fmamk_f32 v107, v104, 0x3c300000, v105
v_cos_f32 v231, v107
v_sin_f32 v247, -v107
v_fmamk_f32 v106, v104, 0x3c800000, v105
v_cos_f32 v232, v106
v_sin_f32 v248, -v106
v_fmamk_f32 v107, v104, 0x3c880000, v105
v_cos_f32 v233, v107
v_sin_f32 v249, -v107
v_fmamk_f32 v106, v104, 0x3c900000, v105
v_cos_f32 v234, v106
v_sin_f32 v250, -v106
v_fmamk_f32 v107, v104, 0x3c980000, v105
v_cos_f32 v235, v107
v_sin_f32 v251, -v107
v_fmamk_f32 v106, v104, 0x3cc00000, v105
v_cos_f32 v236, v106
v_sin_f32 v252, -v106
v_fmamk_f32 v107, v104, 0x3cc80000, v105
v_cos_f32 v237, v107
v_sin_f32 v253, -v107
v_fmamk_f32 v106, v104, 0x3cd00000, v105
v_cos_f32 v238, v106
v_sin_f32 v254, -v106
v_fmamk_f32 v107, v104, 0x3cd80000, v105
v_cos_f32 v239, v107
v_sin_f32 v255, -v107
s_add_u32 m0, s25, 32768
s_add_u32 s26, s24, 128
s_and_b32 s26, s26, 0x7ff
buffer_load_dwordx4 v176, s[12:15], s26 offen offset:0 lds
buffer_load_dwordx4 v177, s[12:15], s26 offen offset:1024 lds
buffer_load_dwordx4 v178, s[12:15], s26 offen offset:2048 lds
buffer_load_dwordx4 v179, s[12:15], s26 offen offset:3072 lds
s_add_u32 m0, s25, 49152
s_nop 0
buffer_load_dwordx4 v180, s[20:23], s26 offen offset:0 lds
buffer_load_dwordx4 v181, s[20:23], s26 offen offset:1024 lds
buffer_load_dwordx4 v182, s[20:23], s26 offen offset:2048 lds
buffer_load_dwordx4 v183, s[20:23], s26 offen offset:3072 lds
s_waitcnt vmcnt(8)
s_barrier
s_add_u32 m0, s25, 65536
s_add_u32 s26, s24, 256
s_and_b32 s26, s26, 0x7ff
buffer_load_dwordx4 v176, s[12:15], s26 offen offset:0 lds
buffer_load_dwordx4 v177, s[12:15], s26 offen offset:1024 lds
buffer_load_dwordx4 v178, s[12:15], s26 offen offset:2048 lds
buffer_load_dwordx4 v179, s[12:15], s26 offen offset:3072 lds
s_add_u32 m0, s25, 81920
s_nop 0
buffer_load_dwordx4 v180, s[20:23], s26 offen offset:0 lds
buffer_load_dwordx4 v181, s[20:23], s26 offen offset:1024 lds
buffer_load_dwordx4 v182, s[20:23], s26 offen offset:2048 lds
buffer_load_dwordx4 v183, s[20:23], s26 offen offset:3072 lds
s_waitcnt vmcnt(8)
s_barrier
s_add_u32 m0, s25, 0
s_add_u32 s26, s24, 384
s_and_b32 s26, s26, 0x7ff
buffer_load_dwordx4 v176, s[12:15], s26 offen offset:0 lds
buffer_load_dwordx4 v177, s[12:15], s26 offen offset:1024 lds
buffer_load_dwordx4 v178, s[12:15], s26 offen offset:2048 lds
buffer_load_dwordx4 v179, s[12:15], s26 offen offset:3072 lds
s_add_u32 m0, s25, 16384
s_nop 0
buffer_load_dwordx4 v180, s[20:23], s26 offen offset:0 lds
buffer_load_dwordx4 v181, s[20:23], s26 offen offset:1024 lds
buffer_load_dwordx4 v182, s[20:23], s26 offen offset:2048 lds
buffer_load_dwordx4 v183, s[20:23], s26 offen offset:3072 lds
s_waitcnt vmcnt(8)
s_barrier
s_add_u32 m0, s25, 32768
s_add_u32 s26, s24, 512
s_and_b32 s26, s26, 0x7ff
buffer_load_dwordx4 v176, s[12:15], s26 offen offset:0 lds
buffer_load_dwordx4 v177, s[12:15], s26 offen offset:1024 lds
buffer_load_dwordx4 v178, s[12:15], s26 offen offset:2048 lds
buffer_load_dwordx4 v179, s[12:15], s26 offen offset:3072 lds
s_add_u32 m0, s25, 49152
s_nop 0
buffer_load_dwordx4 v180, s[20:23], s26 offen offset:0 lds
buffer_load_dwordx4 v181, s[20:23], s26 offen offset:1024 lds
buffer_load_dwordx4 v182, s[20:23], s26 offen offset:2048 lds
buffer_load_dwordx4 v183, s[20:23], s26 offen offset:3072 lds
s_waitcnt vmcnt(8)
s_barrier
s_add_u32 m0, s25, 65536
s_add_u32 s26, s24, 640
s_and_b32 s26, s26, 0x7ff
buffer_load_dwordx4 v176, s[12:15], s26 offen offset:0 lds
buffer_load_dwordx4 v177, s[12:15], s26 offen offset:1024 lds
buffer_load_dwordx4 v178, s[12:15], s26 offen offset:2048 lds
buffer_load_dwordx4 v179, s[12:15], s26 offen offset:3072 lds
s_add_u32 m0, s25, 81920
s_nop 0
buffer_load_dwordx4 v180, s[20:23], s26 offen offset:0 lds
buffer_load_dwordx4 v181, s[20:23], s26 offen offset:1024 lds
buffer_load_dwordx4 v182, s[20:23], s26 offen offset:2048 lds
buffer_load_dwordx4 v183, s[20:23], s26 offen offset:3072 lds
s_waitcnt vmcnt(8)
s_barrier
s_add_u32 m0, s25, 0
s_add_u32 s26, s24, 768
s_and_b32 s26, s26, 0x7ff
buffer_load_dwordx4 v176, s[12:15], s26 offen offset:0 lds
buffer_load_dwordx4 v177, s[12:15], s26 offen offset:1024 lds
buffer_load_dwordx4 v178, s[12:15], s26 offen offset:2048 lds
buffer_load_dwordx4 v179, s[12:15], s26 offen offset:3072 lds
s_add_u32 m0, s25, 16384
s_nop 0
buffer_load_dwordx4 v180, s[20:23], s26 offen offset:0 lds
buffer_load_dwordx4 v181, s[20:23], s26 offen offset:1024 lds
buffer_load_dwordx4 v182, s[20:23], s26 offen offset:2048 lds
buffer_load_dwordx4 v183, s[20:23], s26 offen offset:3072 lds
s_waitcnt vmcnt(8)
s_barrier
s_add_u32 m0, s25, 32768
s_add_u32 s26, s24, 896
s_and_b32 s26, s26, 0x7ff
buffer_load_dwordx4 v176, s[12:15], s26 offen offset:0 lds
buffer_load_dwordx4 v177, s[12:15], s26 offen offset:1024 lds
buffer_load_dwordx4 v178, s[12:15], s26 offen offset:2048 lds
buffer_load_dwordx4 v179, s[12:15], s26 offen offset:3072 lds
s_add_u32 m0, s25, 49152
s_nop 0
buffer_load_dwordx4 v180, s[20:23], s26 offen offset:0 lds
buffer_load_dwordx4 v181, s[20:23], s26 offen offset:1024 lds
buffer_load_dwordx4 v182, s[20:23], s26 offen offset:2048 lds
buffer_load_dwordx4 v183, s[20:23], s26 offen offset:3072 lds
v_and_b32 v104, 31, v1
v_cvt_f32_u32 v104, v104
v_lshrrev_b32 v105, 5, v1
v_lshlrev_b32 v105, 2, v105
v_cvt_f32_u32 v105, v105
v_mul_f32 v104, 0x3a000000, v104
v_fmamk_f32 v105, v105, 0x3c800000, v104
v_add_f32 v106, 0x0, v105
v_cos_f32 v136, v106
v_sin_f32 v152, -v106
v_add_f32 v107, 0x3c800000, v105
v_cos_f32 v137, v107
v_sin_f32 v153, -v107
v_add_f32 v106, 0x3d000000, v105
v_cos_f32 v138, v106
v_sin_f32 v154, -v106
v_add_f32 v107, 0x3d400000, v105
v_cos_f32 v139, v107
v_sin_f32 v155, -v107
v_add_f32 v106, 0x3e000000, v105
v_cos_f32 v140, v106
v_sin_f32 v156, -v106
v_add_f32 v107, 0x3e100000, v105
v_cos_f32 v141, v107
v_sin_f32 v157, -v107
v_add_f32 v106, 0x3e200000, v105
v_cos_f32 v142, v106
v_sin_f32 v158, -v106
v_add_f32 v107, 0x3e300000, v105
v_cos_f32 v143, v107
v_sin_f32 v159, -v107
v_add_f32 v106, 0x3e800000, v105
v_cos_f32 v144, v106
v_sin_f32 v160, -v106
v_add_f32 v107, 0x3e880000, v105
v_cos_f32 v145, v107
v_sin_f32 v161, -v107
v_add_f32 v106, 0x3e900000, v105
v_cos_f32 v146, v106
v_sin_f32 v162, -v106
v_add_f32 v107, 0x3e980000, v105
v_cos_f32 v147, v107
v_sin_f32 v163, -v107
v_add_f32 v106, 0x3ec00000, v105
v_cos_f32 v148, v106
v_sin_f32 v164, -v106
v_add_f32 v107, 0x3ec80000, v105
v_cos_f32 v149, v107
v_sin_f32 v165, -v107
v_add_f32 v106, 0x3ed00000, v105
v_cos_f32 v150, v106
v_sin_f32 v166, -v106
v_add_f32 v107, 0x3ed80000, v105
v_cos_f32 v151, v107
v_sin_f32 v167, -v107
s_waitcnt vmcnt(8)
s_barrier
s_add_u32 m0, s25, 65536
s_add_u32 s26, s24, 1024
s_and_b32 s26, s26, 0x7ff
buffer_load_dwordx4 v176, s[12:15], s26 offen offset:0 lds
buffer_load_dwordx4 v177, s[12:15], s26 offen offset:1024 lds
buffer_load_dwordx4 v178, s[12:15], s26 offen offset:2048 lds
buffer_load_dwordx4 v179, s[12:15], s26 offen offset:3072 lds
s_add_u32 m0, s25, 81920
s_nop 0
buffer_load_dwordx4 v180, s[20:23], s26 offen offset:0 lds
buffer_load_dwordx4 v181, s[20:23], s26 offen offset:1024 lds
buffer_load_dwordx4 v182, s[20:23], s26 offen offset:2048 lds
buffer_load_dwordx4 v183, s[20:23], s26 offen offset:3072 lds
s_waitcnt vmcnt(8)
s_barrier
s_add_u32 m0, s25, 0
s_add_u32 s26, s24, 1152
s_and_b32 s26, s26, 0x7ff
buffer_load_dwordx4 v176, s[12:15], s26 offen offset:0 lds
buffer_load_dwordx4 v177, s[12:15], s26 offen offset:1024 lds
buffer_load_dwordx4 v178, s[12:15], s26 offen offset:2048 lds
buffer_load_dwordx4 v179, s[12:15], s26 offen offset:3072 lds
s_add_u32 m0, s25, 16384
s_nop 0
buffer_load_dwordx4 v180, s[20:23], s26 offen offset:0 lds
buffer_load_dwordx4 v181, s[20:23], s26 offen offset:1024 lds
buffer_load_dwordx4 v182, s[20:23], s26 offen offset:2048 lds
buffer_load_dwordx4 v183, s[20:23], s26 offen offset:3072 lds
v_mov_b32 v20, 0
global_load_dword v21, v20, s[30:31] sc1
s_waitcnt vmcnt(9)
s_barrier
s_add_u32 m0, s25, 32768
s_add_u32 s26, s24, 1280
s_and_b32 s26, s26, 0x7ff
buffer_load_dwordx4 v176, s[12:15], s26 offen offset:0 lds
buffer_load_dwordx4 v177, s[12:15], s26 offen offset:1024 lds
buffer_load_dwordx4 v178, s[12:15], s26 offen offset:2048 lds
buffer_load_dwordx4 v179, s[12:15], s26 offen offset:3072 lds
s_add_u32 m0, s25, 49152
s_nop 0
buffer_load_dwordx4 v180, s[20:23], s26 offen offset:0 lds
buffer_load_dwordx4 v181, s[20:23], s26 offen offset:1024 lds
buffer_load_dwordx4 v182, s[20:23], s26 offen offset:2048 lds
buffer_load_dwordx4 v183, s[20:23], s26 offen offset:3072 lds
s_waitcnt vmcnt(9)
s_barrier
s_add_u32 m0, s25, 65536
s_add_u32 s26, s24, 1408
s_and_b32 s26, s26, 0x7ff
buffer_load_dwordx4 v176, s[12:15], s26 offen offset:0 lds
buffer_load_dwordx4 v177, s[12:15], s26 offen offset:1024 lds
buffer_load_dwordx4 v178, s[12:15], s26 offen offset:2048 lds
buffer_load_dwordx4 v179, s[12:15], s26 offen offset:3072 lds
s_add_u32 m0, s25, 81920
s_nop 0
buffer_load_dwordx4 v180, s[20:23], s26 offen offset:0 lds
buffer_load_dwordx4 v181, s[20:23], s26 offen offset:1024 lds
buffer_load_dwordx4 v182, s[20:23], s26 offen offset:2048 lds
buffer_load_dwordx4 v183, s[20:23], s26 offen offset:3072 lds
s_waitcnt vmcnt(8)
s_barrier
s_add_u32 m0, s25, 0
s_add_u32 s26, s24, 1536
s_and_b32 s26, s26, 0x7ff
buffer_load_dwordx4 v176, s[12:15], s26 offen offset:0 lds
buffer_load_dwordx4 v177, s[12:15], s26 offen offset:1024 lds
buffer_load_dwordx4 v178, s[12:15], s26 offen offset:2048 lds
buffer_load_dwordx4 v179, s[12:15], s26 offen offset:3072 lds
s_add_u32 m0, s25, 16384
s_nop 0
buffer_load_dwordx4 v180, s[20:23], s26 offen offset:0 lds
buffer_load_dwordx4 v181, s[20:23], s26 offen offset:1024 lds
buffer_load_dwordx4 v182, s[20:23], s26 offen offset:2048 lds
buffer_load_dwordx4 v183, s[20:23], s26 offen offset:3072 lds
s_waitcnt vmcnt(8)
s_barrier
s_add_u32 m0, s25, 32768
s_add_u32 s26, s24, 1664
s_and_b32 s26, s26, 0x7ff
buffer_load_dwordx4 v176, s[12:15], s26 offen offset:0 lds
buffer_load_dwordx4 v177, s[12:15], s26 offen offset:1024 lds
buffer_load_dwordx4 v178, s[12:15], s26 offen offset:2048 lds
buffer_load_dwordx4 v179, s[12:15], s26 offen offset:3072 lds
s_add_u32 m0, s25, 49152
s_nop 0
buffer_load_dwordx4 v180, s[20:23], s26 offen offset:0 lds
buffer_load_dwordx4 v181, s[20:23], s26 offen offset:1024 lds
buffer_load_dwordx4 v182, s[20:23], s26 offen offset:2048 lds
buffer_load_dwordx4 v183, s[20:23], s26 offen offset:3072 lds
s_waitcnt vmcnt(8)
s_barrier
s_add_u32 m0, s25, 65536
s_add_u32 s26, s24, 1792
s_and_b32 s26, s26, 0x7ff
buffer_load_dwordx4 v176, s[12:15], s26 offen offset:0 lds
buffer_load_dwordx4 v177, s[12:15], s26 offen offset:1024 lds
buffer_load_dwordx4 v178, s[12:15], s26 offen offset:2048 lds
buffer_load_dwordx4 v179, s[12:15], s26 offen offset:3072 lds
s_add_u32 m0, s25, 81920
s_nop 0
buffer_load_dwordx4 v180, s[20:23], s26 offen offset:0 lds
buffer_load_dwordx4 v181, s[20:23], s26 offen offset:1024 lds
buffer_load_dwordx4 v182, s[20:23], s26 offen offset:2048 lds
buffer_load_dwordx4 v183, s[20:23], s26 offen offset:3072 lds
s_waitcnt vmcnt(8)
s_barrier
s_add_u32 m0, s25, 0
s_add_u32 s26, s24, 1920
s_and_b32 s26, s26, 0x7ff
buffer_load_dwordx4 v176, s[12:15], s26 offen offset:0 lds
buffer_load_dwordx4 v177, s[12:15], s26 offen offset:1024 lds
buffer_load_dwordx4 v178, s[12:15], s26 offen offset:2048 lds
buffer_load_dwordx4 v179, s[12:15], s26 offen offset:3072 lds
s_add_u32 m0, s25, 16384
s_nop 0
buffer_load_dwordx4 v180, s[20:23], s26 offen offset:0 lds
buffer_load_dwordx4 v181, s[20:23], s26 offen offset:1024 lds
buffer_load_dwordx4 v182, s[20:23], s26 offen offset:2048 lds
buffer_load_dwordx4 v183, s[20:23], s26 offen offset:3072 lds
s_waitcnt vmcnt(8)
s_barrier
s_waitcnt vmcnt(0)
s_barrier
s_add_u32 m0, s68, 0
s_mov_b32 s92, 0
buffer_load_dwordx4 v2, s[4:7], s92 offen offset:0 nt lds
buffer_load_dwordx4 v2, s[4:7], s92 offen offset:1024 nt lds
s_add_u32 m0, s68, 2048
s_mov_b32 s92, 2048
buffer_load_dwordx4 v3, s[4:7], s92 offen offset:0 nt lds
buffer_load_dwordx4 v3, s[4:7], s92 offen offset:1024 nt lds
s_add_u32 m0, s68, 16384
s_nop 0
buffer_load_dwordx4 v18, s[48:51], s69 offen nt lds
s_add_u32 m0, s68, 17408
s_nop 0
buffer_load_dwordx4 v18, s[52:55], s69 offen nt lds
s_add_u32 m0, s68, 18432
s_nop 0
buffer_load_dwordx4 v19, s[48:51], s69 offen nt lds
s_add_u32 m0, s68, 19456
s_nop 0
buffer_load_dwordx4 v19, s[52:55], s69 offen nt lds
s_cmp_lg_u32 s66, 3
s_cbranch_scc1 L_nw1
s_mov_b32 exec_hi, 0
buffer_load_ushort v88, v17, s[48:51], 0 offen nt
buffer_load_ushort v89, v17, s[52:55], 0 offen nt
s_mov_b64 exec, -1
L_nw1:
s_barrier
s_barrier
s_setprio 3
v_readfirstlane_b32 s37, v21
s_nop 0
s_cmp_lg_u32 s37, 0
s_cbranch_scc1 L_sg2
v_mov_b32 v20, 0
L_n3:
global_load_dword v21, v20, s[30:31] sc1
s_waitcnt vmcnt(0)
v_readfirstlane_b32 s37, v21
s_nop 0
s_cmp_eq_u32 s37, 0
s_cbranch_scc1 L_n3
L_sg2:
s_waitcnt vmcnt(4)
ds_read_b64_tr_b16 v[24:25], v12 offset:0
ds_read_b64_tr_b16 v[26:27], v13 offset:0
ds_read_b64_tr_b16 v[28:29], v12 offset:512
ds_read_b64_tr_b16 v[30:31], v13 offset:512
ds_read_b64_tr_b16 v[32:33], v12 offset:1024
ds_read_b64_tr_b16 v[34:35], v13 offset:1024
ds_read_b64_tr_b16 v[36:37], v12 offset:1536
ds_read_b64_tr_b16 v[38:39], v13 offset:1536
s_waitcnt lgkmcnt(0)
v_mfma_f32_32x32x16_bf16 v[40:55], v[24:27], v[192:195], 0
v_mfma_f32_32x32x16_bf16 v[40:55], v[28:31], v[196:199], v[40:55]
v_mfma_f32_32x32x16_bf16 v[40:55], v[32:35], v[200:203], v[40:55]
v_mfma_f32_32x32x16_bf16 v[40:55], v[36:39], v[204:207], v[40:55]
v_mfma_f32_32x32x16_bf16 v[56:71], v[24:27], v[208:211], 0
v_mfma_f32_32x32x16_bf16 v[56:71], v[28:31], v[212:215], v[56:71]
v_mfma_f32_32x32x16_bf16 v[56:71], v[32:35], v[216:219], v[56:71]
v_mfma_f32_32x32x16_bf16 v[56:71], v[36:39], v[220:223], v[56:71]
s_nop 7
v_mul_f32 v168, v40, v224
v_mul_f32 v169, v40, v240
s_nop 1
v_fma_f32 v168, -v56, v240, v168
v_fmac_f32 v169, v56, v224
v_cvt_pk_bf16_f32 v72, v168, v169
v_mul_f32 v170, v41, v225
v_mul_f32 v171, v41, v241
v_fma_f32 v170, -v57, v241, v170
v_fmac_f32 v171, v57, v225
v_cvt_pk_bf16_f32 v73, v170, v171
v_mul_f32 v172, v42, v226
v_mul_f32 v173, v42, v242
v_fma_f32 v172, -v58, v242, v172
v_fmac_f32 v173, v58, v226
v_cvt_pk_bf16_f32 v74, v172, v173
v_mul_f32 v174, v43, v227
v_mul_f32 v175, v43, v243
v_fma_f32 v174, -v59, v243, v174
v_fmac_f32 v175, v59, v227
v_cvt_pk_bf16_f32 v75, v174, v175
v_mul_f32 v168, v44, v228
v_mul_f32 v169, v44, v244
v_fma_f32 v168, -v60, v244, v168
v_fmac_f32 v169, v60, v228
v_cvt_pk_bf16_f32 v76, v168, v169
v_mul_f32 v170, v45, v229
v_mul_f32 v171, v45, v245
v_fma_f32 v170, -v61, v245, v170
v_fmac_f32 v171, v61, v229
v_cvt_pk_bf16_f32 v77, v170, v171
v_mul_f32 v172, v46, v230
v_mul_f32 v173, v46, v246
v_fma_f32 v172, -v62, v246, v172
v_fmac_f32 v173, v62, v230
v_cvt_pk_bf16_f32 v78, v172, v173
v_mul_f32 v174, v47, v231
v_mul_f32 v175, v47, v247
v_fma_f32 v174, -v63, v247, v174
v_fmac_f32 v175, v63, v231
v_cvt_pk_bf16_f32 v79, v174, v175
v_mul_f32 v168, v48, v232
v_mul_f32 v169, v48, v248
v_fma_f32 v168, -v64, v248, v168
v_fmac_f32 v169, v64, v232
v_cvt_pk_bf16_f32 v80, v168, v169
v_mul_f32 v170, v49, v233
v_mul_f32 v171, v49, v249
v_fma_f32 v170, -v65, v249, v170
v_fmac_f32 v171, v65, v233
v_cvt_pk_bf16_f32 v81, v170, v171
v_mul_f32 v172, v50, v234
v_mul_f32 v173, v50, v250
v_fma_f32 v172, -v66, v250, v172
v_fmac_f32 v173, v66, v234
v_cvt_pk_bf16_f32 v82, v172, v173
v_mul_f32 v174, v51, v235
v_mul_f32 v175, v51, v251
v_fma_f32 v174, -v67, v251, v174
v_fmac_f32 v175, v67, v235
v_cvt_pk_bf16_f32 v83, v174, v175
v_mul_f32 v168, v52, v236
v_mul_f32 v169, v52, v252
v_fma_f32 v168, -v68, v252, v168
v_fmac_f32 v169, v68, v236
v_cvt_pk_bf16_f32 v84, v168, v169
v_mul_f32 v170, v53, v237
v_mul_f32 v171, v53, v253
v_fma_f32 v170, -v69, v253, v170
v_fmac_f32 v171, v69, v237
v_cvt_pk_bf16_f32 v85, v170, v171
v_mul_f32 v172, v54, v238
v_mul_f32 v173, v54, v254
v_fma_f32 v172, -v70, v254, v172
v_fmac_f32 v173, v70, v238
v_cvt_pk_bf16_f32 v86, v172, v173
v_mul_f32 v174, v55, v239
v_mul_f32 v175, v55, v255
v_fma_f32 v174, -v71, v255, v174
v_fmac_f32 v175, v71, v239
v_cvt_pk_bf16_f32 v87, v174, v175
v_mfma_f32_32x32x16_bf16 v[40:55], v[192:195], v[72:75], 0
v_mfma_f32_32x32x16_bf16 v[40:55], v[196:199], v[76:79], v[40:55]
v_mfma_f32_32x32x16_bf16 v[40:55], v[200:203], v[80:83], v[40:55]
v_mfma_f32_32x32x16_bf16 v[40:55], v[204:207], v[84:87], v[40:55]
v_mfma_f32_32x32x16_bf16 v[56:71], v[208:211], v[72:75], 0
v_mfma_f32_32x32x16_bf16 v[56:71], v[212:215], v[76:79], v[56:71]
v_mfma_f32_32x32x16_bf16 v[56:71], v[216:219], v[80:83], v[56:71]
v_mfma_f32_32x32x16_bf16 v[56:71], v[220:223], v[84:87], v[56:71]
s_mov_b32 s64, 0x05040100
s_mov_b32 s65, 0x07060302
s_lshl_b32 s92, s66, 12
s_add_u32 s92, s92, 98304
v_add_u32 v8, s92, v7
s_nop 6
v_cvt_pk_bf16_f32 v72, v40, v56
ds_write_b32 v4, v72 offset:0
v_cvt_pk_bf16_f32 v73, v41, v57
ds_write_b32 v4, v73 offset:1024
v_cvt_pk_bf16_f32 v74, v42, v58
ds_write_b32 v4, v74 offset:2048
v_cvt_pk_bf16_f32 v75, v43, v59
ds_write_b32 v4, v75 offset:3072
v_cvt_pk_bf16_f32 v76, v44, v60
ds_write_b32 v4, v76 offset:8192
v_cvt_pk_bf16_f32 v77, v45, v61
ds_write_b32 v4, v77 offset:9216
v_cvt_pk_bf16_f32 v78, v46, v62
ds_write_b32 v4, v78 offset:10240
v_cvt_pk_bf16_f32 v79, v47, v63
ds_write_b32 v4, v79 offset:11264
v_cvt_pk_bf16_f32 v80, v48, v64
ds_write_b32 v6, v80 offset:0
v_cvt_pk_bf16_f32 v81, v49, v65
ds_write_b32 v5, v81 offset:10240
v_cvt_pk_bf16_f32 v82, v50, v66
ds_write_b32 v5, v82 offset:9216
v_cvt_pk_bf16_f32 v83, v51, v67
ds_write_b32 v5, v83 offset:8192
v_cvt_pk_bf16_f32 v84, v52, v68
ds_write_b32 v5, v84 offset:3072
v_cvt_pk_bf16_f32 v85, v53, v69
ds_write_b32 v5, v85 offset:2048
v_cvt_pk_bf16_f32 v86, v54, v70
ds_write_b32 v5, v86 offset:1024
v_cvt_pk_bf16_f32 v87, v55, v71
ds_write_b32 v5, v87 offset:0
s_waitcnt vmcnt(0) lgkmcnt(0)
v_mov_b32 v190, 1
s_mov_b64 exec, 1
ds_write_b32 v185, v190
s_mov_b64 exec, -1
L_lc5:
ds_read_b128 v[186:189], v184
s_waitcnt lgkmcnt(0)
v_min3_u32 v186, v186, v187, v188
v_min_u32 v186, v186, v189
s_nop 0
v_readfirstlane_b32 s92, v186
s_nop 0
s_cmp_ge_u32 s92, 1
s_cbranch_scc1 L_lcd6
s_sleep 1
s_branch L_lc5
L_lcd6:
ds_read_b128 v[72:75], v8 offset:0
ds_read_b128 v[76:79], v8 offset:1024
ds_read_b128 v[80:83], v8 offset:2048
ds_read_b128 v[84:87], v8 offset:3072
ds_read_b64 v[104:105], v16 offset:0
ds_read_b64 v[106:107], v16 offset:256
ds_read_b64 v[108:109], v16 offset:512
ds_read_b64 v[110:111], v16 offset:768
ds_read_b64 v[112:113], v16 offset:1024
ds_read_b64 v[114:115], v16 offset:1280
ds_read_b64 v[116:117], v16 offset:1536
ds_read_b64 v[118:119], v16 offset:1792
v_add_u32 v4, 32768, v4
v_add_u32 v5, 32768, v5
v_add_u32 v6, 32768, v6
v_lshlrev_b32 v88, 16, v88
v_lshlrev_b32 v89, 16, v89
v_lshlrev_b32 v9, 1, v1
v_add_f32_dpp v90, v88, v88 quad_perm:[1,0,3,2] row_mask:0xf bank_mask:0xf
v_subrev_f32_dpp v91, v89, v89 quad_perm:[1,0,3,2] row_mask:0xf bank_mask:0xf
v_mul_f32 v90, 0.5, v90
v_mul_f32 v91, 0.5, v91
v_cvt_pk_bf16_f32 v88, v90, v91
s_waitcnt lgkmcnt(0)
v_mov_b32 v190, 2
s_mov_b64 exec, 1
ds_write_b32 v185, v190
s_mov_b64 exec, -1
v_perm_b32 v120, v112, v104, s64
v_perm_b32 v121, v116, v108, s64
v_perm_b32 v122, v114, v106, s64
v_perm_b32 v123, v118, v110, s64
v_perm_b32 v124, v112, v104, s65
v_perm_b32 v125, v116, v108, s65
v_perm_b32 v126, v114, v106, s65
v_perm_b32 v127, v118, v110, s65
v_perm_b32 v128, v113, v105, s64
v_perm_b32 v129, v117, v109, s64
v_perm_b32 v130, v115, v107, s64
v_perm_b32 v131, v119, v111, s64
v_perm_b32 v132, v113, v105, s65
v_perm_b32 v133, v117, v109, s65
v_perm_b32 v134, v115, v107, s65
v_perm_b32 v135, v119, v111, s65
buffer_store_dwordx4 v[72:75], v2, s[40:43], 0 offen offset:0 sc1
buffer_store_dwordx4 v[76:79], v2, s[40:43], 0 offen offset:1024 sc1
buffer_store_dwordx4 v[80:83], v2, s[40:43], 0 offen offset:2048 sc1
buffer_store_dwordx4 v[84:87], v2, s[40:43], 0 offen offset:3072 sc1
s_mov_b32 s92, 0
buffer_store_dwordx4 v[120:123], v15, s[56:59], s92 offen sc1
s_mov_b32 s92, 8192
buffer_store_dwordx4 v[124:127], v15, s[56:59], s92 offen sc1
s_mov_b32 s92, 16384
buffer_store_dwordx4 v[128:131], v15, s[56:59], s92 offen sc1
s_mov_b32 s92, 24576
buffer_store_dwordx4 v[132:135], v15, s[56:59], s92 offen sc1
s_cmp_lg_u32 s66, 3
s_cbranch_scc1 L_nw7
s_lshr_b32 s64, s2, 7
s_sub_u32 s64, 513, s64
s_lshl_b32 s64, s64, 13
s_and_b32 s65, s2, 127
s_lshl_b32 s65, s65, 6
s_add_u32 s64, s64, s65
s_add_u32 s58, s64, 25165824
s_add_u32 s56, s32, s58
s_addc_u32 s57, s33, 0
s_mov_b32 s58, 64
s_mov_b32 s59, 0x20000
s_mov_b32 exec_lo, 0x55555555
s_mov_b32 exec_hi, 0
buffer_store_dword v88, v9, s[56:59], 0 offen sc1
s_mov_b64 exec, -1
L_nw7:
s_and_b32 s60, s2, 7
s_lshl_b32 s60, s60, 5
s_lshr_b32 s64, s2, 3
s_add_u32 s60, s60, s64
s_lshr_b32 s64, s66, 1
s_xor_b32 s64, s64, s66
s_and_b32 s64, s64, 1
s_or_b32 s65, s64, s60
s_cmp_eq_u32 s65, 0
s_cselect_b32 s61, 1, 0
s_lshl_b32 s65, s60, 1
s_add_u32 s64, s64, s65
s_lshr_b32 s65, s66, 1
s_sub_u32 s69, 513, s65
s_cmp_eq_u32 s61, 1
s_cselect_b32 s64, s69, s64
s_cselect_b32 s65, 0, s65
s_lshl_b32 s62, s65, 31
s_or_b32 s63, s62, 0x3f800000
s_lshl_b32 s64, s64, 13
s_add_u32 s50, s64, 25165824
s_add_u32 s48, s32, s50
s_addc_u32 s49, s33, 0
s_mov_b32 s50, 8192
s_mov_b32 s51, 0x20000
s_lshl_b32 s64, s66, 20
s_lshl_b32 s65, s60, 6
s_add_u32 s64, s64, s65
s_add_u32 s54, s64, 16777216
s_add_u32 s52, s32, s54
s_addc_u32 s53, s33, 0
s_sub_u32 s54, 1048576, s65
s_mov_b32 s55, 0x20000
s_add_u32 s58, s64, 20971520
s_add_u32 s56, s32, s58
s_addc_u32 s57, s33, 0
s_sub_u32 s58, 1048576, s65
s_mov_b32 s59, 0x20000
v_lshrrev_b32 v8, 2, v1
v_lshlrev_b32 v8, 14, v8
v_and_b32 v9, 3, v1
v_lshrrev_b32 v10, 4, v1
v_xor_b32 v9, v9, v10
v_lshl_add_u32 v14, v9, 4, v8
v_and_b32 v8, 31, v1
v_bfe_u32 v9, v1, 2, 2
v_xor_b32 v9, s66, v9
v_lshlrev_b32 v9, 4, v9
v_lshl_add_u32 v9, v8, 6, v9
v_lshrrev_b32 v8, 5, v1
v_lshl_add_u32 v9, v8, 11, v9
v_add_u32 v15, 131072, v9
s_lshl_b32 s64, s66, 13
s_add_u32 s64, s64, 131072
v_add_u32 v16, s64, v2
s_xor_b32 s65, s64, 24576
s_cmp_eq_u32 s61, 1
s_cselect_b32 s65, s64, s65
v_add_u32 v17, s65, v2
v_add_u32 v18, s68, v2
v_pk_mul_f32 v[136:137], s[62:63], v[136:137] op_sel:[1,0]
v_pk_mul_f32 v[138:139], s[62:63], v[138:139] op_sel:[1,0]
v_pk_mul_f32 v[140:141], s[62:63], v[140:141] op_sel:[1,0]
v_pk_mul_f32 v[142:143], s[62:63], v[142:143] op_sel:[1,0]
v_pk_mul_f32 v[144:145], s[62:63], v[144:145] op_sel:[1,0]
v_pk_mul_f32 v[146:147], s[62:63], v[146:147] op_sel:[1,0]
v_pk_mul_f32 v[148:149], s[62:63], v[148:149] op_sel:[1,0]
v_pk_mul_f32 v[150:151], s[62:63], v[150:151] op_sel:[1,0]
v_pk_mul_f32 v[152:153], s[62:63], v[152:153] op_sel:[1,0]
v_pk_mul_f32 v[154:155], s[62:63], v[154:155] op_sel:[1,0]
v_pk_mul_f32 v[156:157], s[62:63], v[156:157] op_sel:[1,0]
v_pk_mul_f32 v[158:159], s[62:63], v[158:159] op_sel:[1,0]
v_pk_mul_f32 v[160:161], s[62:63], v[160:161] op_sel:[1,0]
v_pk_mul_f32 v[162:163], s[62:63], v[162:163] op_sel:[1,0]
v_pk_mul_f32 v[164:165], s[62:63], v[164:165] op_sel:[1,0]
v_pk_mul_f32 v[166:167], s[62:63], v[166:167] op_sel:[1,0]
s_waitcnt vmcnt(0)
v_mov_b32 v190, 3
s_mov_b64 exec, 1
ds_write_b32 v185, v190
s_mov_b64 exec, -1
s_cmp_lg_u32 s66, 0
s_cbranch_scc1 L_ph8
L_lc9:
ds_read_b128 v[186:189], v184
s_waitcnt lgkmcnt(0)
v_min3_u32 v186, v186, v187, v188
v_min_u32 v186, v186, v189
s_nop 0
v_readfirstlane_b32 s92, v186
s_nop 0
s_cmp_ge_u32 s92, 3
s_cbranch_scc1 L_lcd10
s_sleep 1
s_branch L_lc9
L_lcd10:
s_and_b32 s64, s2, 15
s_lshl_b32 s65, s64, 7
s_add_u32 s65, s65, 4096
s_add_u32 s90, s32, s65
s_addc_u32 s91, s33, 0
s_mov_b32 s65, 1
s_atomic_add s65, s[90:91], 0x0 glc
s_lshl_b32 s64, s64, 2
s_add_u32 s64, s64, 540672
v_lshl_add_u32 v20, v1, 7, s64
v_mov_b32 v21, s37
s_and_b32 s64, s2, 63
s_lshl_b32 s64, s64, 7
s_add_u32 s64, s64, 540672
s_waitcnt lgkmcnt(0)
s_cmp_lg_u32 s65, 15
s_cbranch_scc1 L_sg11
global_store_dword v20, v21, s[32:33] sc1
L_sg11:
s_add_u32 s90, s32, s64
s_addc_u32 s91, s33, 0
s_mov_b32 s64, s37
s_mov_b32 s65, s37
s_mov_b32 s92, 0
s_branch L_sp12
L_nok13:
s_add_u32 s92, s92, 1
s_cmp_ge_u32 s92, 200000
s_cbranch_scc1 L_ph8
s_sleep 2
L_sp12:
s_load_dwordx16 s[4:19], s[90:91], 0x0 glc
s_waitcnt lgkmcnt(0)
s_cmp_eq_u64 s[4:5], s[64:65]
s_cbranch_scc0 L_nok13
s_cmp_eq_u64 s[6:7], s[64:65]
s_cbranch_scc0 L_nok13
s_cmp_eq_u64 s[8:9], s[64:65]
s_cbranch_scc0 L_nok13
s_cmp_eq_u64 s[10:11], s[64:65]
s_cbranch_scc0 L_nok13
s_cmp_eq_u64 s[12:13], s[64:65]
s_cbranch_scc0 L_nok13
s_cmp_eq_u64 s[14:15], s[64:65]
s_cbranch_scc0 L_nok13
s_cmp_eq_u64 s[16:17], s[64:65]
s_cbranch_scc0 L_nok13
s_cmp_eq_u64 s[18:19], s[64:65]
s_cbranch_scc0 L_nok13
L_ph8:
v_mov_b32 v190, 4
s_mov_b64 exec, 1
ds_write_b32 v185, v190
s_mov_b64 exec, -1
L_lc14:
ds_read_b128 v[186:189], v184
s_waitcnt lgkmcnt(0)
v_min3_u32 v186, v186, v187, v188
v_min_u32 v186, v186, v189
s_nop 0
v_readfirstlane_b32 s92, v186
s_nop 0
s_cmp_ge_u32 s92, 4
s_cbranch_scc1 L_lcd15
s_sleep 1
s_branch L_lc14
L_lcd15:
s_setprio 3
s_add_u32 m0, s68, 0
s_mov_b32 s64, 0
buffer_load_dwordx4 v14, s[52:55], s64 offen sc1 lds
s_add_u32 m0, s68, 1024
s_mov_b32 s64, 262144
buffer_load_dwordx4 v14, s[52:55], s64 offen sc1 lds
s_add_u32 m0, s68, 2048
s_mov_b32 s64, 524288
buffer_load_dwordx4 v14, s[52:55], s64 offen sc1 lds
s_add_u32 m0, s68, 3072
s_mov_b32 s64, 786432
buffer_load_dwordx4 v14, s[52:55], s64 offen sc1 lds
s_movk_i32 s64, 0x1000
buffer_load_dwordx4 v[104:107], v2, s[48:51], 0 offen offset:0 sc1
buffer_load_dwordx4 v[108:111], v2, s[48:51], 0 offen offset:1024 sc1
buffer_load_dwordx4 v[112:115], v2, s[48:51], 0 offen offset:2048 sc1
buffer_load_dwordx4 v[116:119], v2, s[48:51], 0 offen offset:3072 sc1
buffer_load_dwordx4 v[120:123], v2, s[48:51], s64 offen offset:0 sc1
buffer_load_dwordx4 v[124:127], v2, s[48:51], s64 offen offset:1024 sc1
buffer_load_dwordx4 v[128:131], v2, s[48:51], s64 offen offset:2048 sc1
buffer_load_dwordx4 v[132:135], v2, s[48:51], s64 offen offset:3072 sc1
s_waitcnt vmcnt(8)
v_mov_b32 v190, 5
s_mov_b64 exec, 1
ds_write_b32 v185, v190
s_mov_b64 exec, -1
L_lc16:
ds_read_b128 v[186:189], v184
s_waitcnt lgkmcnt(0)
v_min3_u32 v186, v186, v187, v188
v_min_u32 v186, v186, v189
s_nop 0
v_readfirstlane_b32 s92, v186
s_nop 0
s_cmp_ge_u32 s92, 5
s_cbranch_scc1 L_lcd17
s_sleep 1
s_branch L_lc16
L_lcd17:
ds_read_b128 v[72:75], v15 offset:0
ds_read_b128 v[76:79], v15 offset:4096
ds_read_b128 v[80:83], v15 offset:8192
ds_read_b128 v[84:87], v15 offset:12288
s_waitcnt lgkmcnt(0)
v_mov_b32 v190, 6
s_mov_b64 exec, 1
ds_write_b32 v185, v190
s_mov_b64 exec, -1
s_lshl_b32 s64, s61, 31
s_or_b32 s64, s64, s62
L_fft18:
v_xor_b32 v24, s64, v72
v_xor_b32 v25, s64, v73
v_xor_b32 v26, s64, v74
v_xor_b32 v27, s64, v75
v_xor_b32 v28, s64, v76
v_xor_b32 v29, s64, v77
v_xor_b32 v30, s64, v78
v_xor_b32 v31, s64, v79
v_xor_b32 v32, s64, v80
v_xor_b32 v33, s64, v81
v_xor_b32 v34, s64, v82
v_xor_b32 v35, s64, v83
v_xor_b32 v36, s64, v84
v_xor_b32 v37, s64, v85
v_xor_b32 v38, s64, v86
v_xor_b32 v39, s64, v87
v_mfma_f32_32x32x16_bf16 v[40:55], v[24:27], v[192:195], 0
v_mfma_f32_32x32x16_bf16 v[40:55], v[28:31], v[196:199], v[40:55]
v_mfma_f32_32x32x16_bf16 v[40:55], v[32:35], v[200:203], v[40:55]
v_mfma_f32_32x32x16_bf16 v[40:55], v[36:39], v[204:207], v[40:55]
v_mfma_f32_32x32x16_bf16 v[56:71], v[24:27], v[208:211], 0
v_mfma_f32_32x32x16_bf16 v[56:71], v[28:31], v[212:215], v[56:71]
v_mfma_f32_32x32x16_bf16 v[56:71], v[32:35], v[216:219], v[56:71]
v_mfma_f32_32x32x16_bf16 v[56:71], v[36:39], v[220:223], v[56:71]
s_nop 7
v_mul_f32 v168, v40, v224
v_mul_f32 v169, v40, v240
s_nop 1
v_fma_f32 v168, -v56, v240, v168
v_fmac_f32 v169, v56, v224
v_cvt_pk_bf16_f32 v24, v168, v169
v_mul_f32 v170, v41, v225
v_mul_f32 v171, v41, v241
v_fma_f32 v170, -v57, v241, v170
v_fmac_f32 v171, v57, v225
v_cvt_pk_bf16_f32 v25, v170, v171
v_mul_f32 v172, v42, v226
v_mul_f32 v173, v42, v242
v_fma_f32 v172, -v58, v242, v172
v_fmac_f32 v173, v58, v226
v_cvt_pk_bf16_f32 v26, v172, v173
v_mul_f32 v174, v43, v227
v_mul_f32 v175, v43, v243
v_fma_f32 v174, -v59, v243, v174
v_fmac_f32 v175, v59, v227
v_cvt_pk_bf16_f32 v27, v174, v175
v_mul_f32 v168, v44, v228
v_mul_f32 v169, v44, v244
v_fma_f32 v168, -v60, v244, v168
v_fmac_f32 v169, v60, v228
v_cvt_pk_bf16_f32 v28, v168, v169
v_mul_f32 v170, v45, v229
v_mul_f32 v171, v45, v245
v_fma_f32 v170, -v61, v245, v170
v_fmac_f32 v171, v61, v229
v_cvt_pk_bf16_f32 v29, v170, v171
v_mul_f32 v172, v46, v230
v_mul_f32 v173, v46, v246
v_fma_f32 v172, -v62, v246, v172
v_fmac_f32 v173, v62, v230
v_cvt_pk_bf16_f32 v30, v172, v173
v_mul_f32 v174, v47, v231
v_mul_f32 v175, v47, v247
v_fma_f32 v174, -v63, v247, v174
v_fmac_f32 v175, v63, v231
v_cvt_pk_bf16_f32 v31, v174, v175
v_mul_f32 v168, v48, v232
v_mul_f32 v169, v48, v248
v_fma_f32 v168, -v64, v248, v168
v_fmac_f32 v169, v64, v232
v_cvt_pk_bf16_f32 v32, v168, v169
v_mul_f32 v170, v49, v233
v_mul_f32 v171, v49, v249
v_fma_f32 v170, -v65, v249, v170
v_fmac_f32 v171, v65, v233
v_cvt_pk_bf16_f32 v33, v170, v171
v_mul_f32 v172, v50, v234
v_mul_f32 v173, v50, v250
v_fma_f32 v172, -v66, v250, v172
v_fmac_f32 v173, v66, v234
v_cvt_pk_bf16_f32 v34, v172, v173
v_mul_f32 v174, v51, v235
v_mul_f32 v175, v51, v251
v_fma_f32 v174, -v67, v251, v174
v_fmac_f32 v175, v67, v235
v_cvt_pk_bf16_f32 v35, v174, v175
v_mul_f32 v168, v52, v236
v_mul_f32 v169, v52, v252
v_fma_f32 v168, -v68, v252, v168
v_fmac_f32 v169, v68, v236
v_cvt_pk_bf16_f32 v36, v168, v169
v_mul_f32 v170, v53, v237
v_mul_f32 v171, v53, v253
v_fma_f32 v170, -v69, v253, v170
v_fmac_f32 v171, v69, v237
v_cvt_pk_bf16_f32 v37, v170, v171
v_mul_f32 v172, v54, v238
v_mul_f32 v173, v54, v254
v_fma_f32 v172, -v70, v254, v172
v_fmac_f32 v173, v70, v238
v_cvt_pk_bf16_f32 v38, v172, v173
v_mul_f32 v174, v55, v239
v_mul_f32 v175, v55, v255
v_fma_f32 v174, -v71, v255, v174
v_fmac_f32 v175, v71, v239
v_cvt_pk_bf16_f32 v39, v174, v175
v_mfma_f32_32x32x16_bf16 v[40:55], v[192:195], v[24:27], 0
v_mfma_f32_32x32x16_bf16 v[40:55], v[196:199], v[28:31], v[40:55]
v_mfma_f32_32x32x16_bf16 v[40:55], v[200:203], v[32:35], v[40:55]
v_mfma_f32_32x32x16_bf16 v[40:55], v[204:207], v[36:39], v[40:55]
v_mfma_f32_32x32x16_bf16 v[56:71], v[208:211], v[24:27], 0
v_mfma_f32_32x32x16_bf16 v[56:71], v[212:215], v[28:31], v[56:71]
v_mfma_f32_32x32x16_bf16 v[56:71], v[216:219], v[32:35], v[56:71]
v_mfma_f32_32x32x16_bf16 v[56:71], v[220:223], v[36:39], v[56:71]
L_lc20:
ds_read_b128 v[186:189], v184
s_waitcnt lgkmcnt(0)
v_min3_u32 v186, v186, v187, v188
v_min_u32 v186, v186, v189
s_nop 0
v_readfirstlane_b32 s92, v186
s_nop 0
s_cmp_ge_u32 s92, 6
s_cbranch_scc1 L_lcd21
s_sleep 1
s_branch L_lc20
L_lcd21:
s_cmp_eq_u32 s61, 2
s_cbranch_scc1 L_nwr19
ds_write_b128 v16, v[40:43] offset:0
ds_write_b128 v16, v[44:47] offset:1024
ds_write_b128 v16, v[48:51] offset:2048
ds_write_b128 v16, v[52:55] offset:3072
ds_write_b128 v16, v[56:59] offset:4096
ds_write_b128 v16, v[60:63] offset:5120
ds_write_b128 v16, v[64:67] offset:6144
ds_write_b128 v16, v[68:71] offset:7168
s_cmp_eq_u32 s61, 0
s_cbranch_scc1 L_nwr19
s_mov_b32 s61, 2
s_mov_b32 s64, 0
s_branch L_fft18
L_nwr19:
s_waitcnt lgkmcnt(0)
v_mov_b32 v190, 7
s_mov_b64 exec, 1
ds_write_b32 v185, v190
s_mov_b64 exec, -1
L_lc22:
ds_read_b128 v[186:189], v184
s_waitcnt lgkmcnt(0)
v_min3_u32 v186, v186, v187, v188
v_min_u32 v186, v186, v189
s_nop 0
v_readfirstlane_b32 s92, v186
s_nop 0
s_cmp_ge_u32 s92, 7
s_cbranch_scc1 L_lcd23
s_sleep 1
s_branch L_lc22
L_lcd23:
ds_read_b128 v[72:75], v17 offset:0
ds_read_b128 v[76:79], v17 offset:1024
ds_read_b128 v[80:83], v17 offset:2048
ds_read_b128 v[84:87], v17 offset:3072
ds_read_b128 v[88:91], v17 offset:4096
ds_read_b128 v[92:95], v17 offset:5120
ds_read_b128 v[96:99], v17 offset:6144
ds_read_b128 v[100:103], v17 offset:7168
s_waitcnt vmcnt(0) lgkmcnt(0)
v_mov_b32 v190, 8
s_mov_b64 exec, 1
ds_write_b32 v185, v190
s_mov_b64 exec, -1
v_lshlrev_b32 v168, 16, v104
v_and_b32 v169, 0xffff0000, v104
v_lshlrev_b32 v170, 16, v105
v_and_b32 v171, 0xffff0000, v105
v_add_f32 v172, v168, v170
v_add_f32 v173, v169, v171
v_sub_f32 v168, v168, v170
v_sub_f32 v169, v169, v171
v_mul_f32 v170, v152, v40
v_mul_f32 v171, v152, v56
v_mul_f32 v174, v172, v40
v_mul_f32 v175, v172, v56
v_fma_f32 v170, -v136, v88, v170
v_fmac_f32 v171, v136, v72
v_fma_f32 v174, -v173, v56, v174
v_fmac_f32 v175, v173, v40
v_fmac_f32 v174, v168, v170
v_fmac_f32 v175, v168, v171
v_fma_f32 v174, -v169, v171, v174
v_fmac_f32 v175, v169, v170
v_cvt_pk_bf16_f32 v24, v175, v174
v_lshlrev_b32 v176, 16, v106
v_and_b32 v177, 0xffff0000, v106
v_lshlrev_b32 v178, 16, v107
v_and_b32 v179, 0xffff0000, v107
v_add_f32 v180, v176, v178
v_add_f32 v181, v177, v179
v_sub_f32 v176, v176, v178
v_sub_f32 v177, v177, v179
v_mul_f32 v178, v153, v41
v_mul_f32 v179, v153, v57
v_mul_f32 v182, v180, v41
v_mul_f32 v183, v180, v57
v_fma_f32 v178, -v137, v89, v178
v_fmac_f32 v179, v137, v73
v_fma_f32 v182, -v181, v57, v182
v_fmac_f32 v183, v181, v41
v_fmac_f32 v182, v176, v178
v_fmac_f32 v183, v176, v179
v_fma_f32 v182, -v177, v179, v182
v_fmac_f32 v183, v177, v178
v_cvt_pk_bf16_f32 v25, v183, v182
v_lshlrev_b32 v168, 16, v108
v_and_b32 v169, 0xffff0000, v108
v_lshlrev_b32 v170, 16, v109
v_and_b32 v171, 0xffff0000, v109
v_add_f32 v172, v168, v170
v_add_f32 v173, v169, v171
v_sub_f32 v168, v168, v170
v_sub_f32 v169, v169, v171
v_mul_f32 v170, v154, v42
v_mul_f32 v171, v154, v58
v_mul_f32 v174, v172, v42
v_mul_f32 v175, v172, v58
v_fma_f32 v170, -v138, v90, v170
v_fmac_f32 v171, v138, v74
v_fma_f32 v174, -v173, v58, v174
v_fmac_f32 v175, v173, v42
v_fmac_f32 v174, v168, v170
v_fmac_f32 v175, v168, v171
v_fma_f32 v174, -v169, v171, v174
v_fmac_f32 v175, v169, v170
v_cvt_pk_bf16_f32 v26, v175, v174
v_lshlrev_b32 v176, 16, v110
v_and_b32 v177, 0xffff0000, v110
v_lshlrev_b32 v178, 16, v111
v_and_b32 v179, 0xffff0000, v111
v_add_f32 v180, v176, v178
v_add_f32 v181, v177, v179
v_sub_f32 v176, v176, v178
v_sub_f32 v177, v177, v179
v_mul_f32 v178, v155, v43
v_mul_f32 v179, v155, v59
v_mul_f32 v182, v180, v43
v_mul_f32 v183, v180, v59
v_fma_f32 v178, -v139, v91, v178
v_fmac_f32 v179, v139, v75
v_fma_f32 v182, -v181, v59, v182
v_fmac_f32 v183, v181, v43
v_fmac_f32 v182, v176, v178
v_fmac_f32 v183, v176, v179
v_fma_f32 v182, -v177, v179, v182
v_fmac_f32 v183, v177, v178
v_cvt_pk_bf16_f32 v27, v183, v182
v_lshlrev_b32 v168, 16, v112
v_and_b32 v169, 0xffff0000, v112
v_lshlrev_b32 v170, 16, v113
v_and_b32 v171, 0xffff0000, v113
v_add_f32 v172, v168, v170
v_add_f32 v173, v169, v171
v_sub_f32 v168, v168, v170
v_sub_f32 v169, v169, v171
v_mul_f32 v170, v156, v44
v_mul_f32 v171, v156, v60
v_mul_f32 v174, v172, v44
v_mul_f32 v175, v172, v60
v_fma_f32 v170, -v140, v92, v170
v_fmac_f32 v171, v140, v76
v_fma_f32 v174, -v173, v60, v174
v_fmac_f32 v175, v173, v44
v_fmac_f32 v174, v168, v170
v_fmac_f32 v175, v168, v171
v_fma_f32 v174, -v169, v171, v174
v_fmac_f32 v175, v169, v170
v_cvt_pk_bf16_f32 v28, v175, v174
v_lshlrev_b32 v176, 16, v114
v_and_b32 v177, 0xffff0000, v114
v_lshlrev_b32 v178, 16, v115
v_and_b32 v179, 0xffff0000, v115
v_add_f32 v180, v176, v178
v_add_f32 v181, v177, v179
v_sub_f32 v176, v176, v178
v_sub_f32 v177, v177, v179
v_mul_f32 v178, v157, v45
v_mul_f32 v179, v157, v61
v_mul_f32 v182, v180, v45
v_mul_f32 v183, v180, v61
v_fma_f32 v178, -v141, v93, v178
v_fmac_f32 v179, v141, v77
v_fma_f32 v182, -v181, v61, v182
v_fmac_f32 v183, v181, v45
v_fmac_f32 v182, v176, v178
v_fmac_f32 v183, v176, v179
v_fma_f32 v182, -v177, v179, v182
v_fmac_f32 v183, v177, v178
v_cvt_pk_bf16_f32 v29, v183, v182
v_lshlrev_b32 v168, 16, v116
v_and_b32 v169, 0xffff0000, v116
v_lshlrev_b32 v170, 16, v117
v_and_b32 v171, 0xffff0000, v117
v_add_f32 v172, v168, v170
v_add_f32 v173, v169, v171
v_sub_f32 v168, v168, v170
v_sub_f32 v169, v169, v171
v_mul_f32 v170, v158, v46
v_mul_f32 v171, v158, v62
v_mul_f32 v174, v172, v46
v_mul_f32 v175, v172, v62
v_fma_f32 v170, -v142, v94, v170
v_fmac_f32 v171, v142, v78
v_fma_f32 v174, -v173, v62, v174
v_fmac_f32 v175, v173, v46
v_fmac_f32 v174, v168, v170
v_fmac_f32 v175, v168, v171
v_fma_f32 v174, -v169, v171, v174
v_fmac_f32 v175, v169, v170
v_cvt_pk_bf16_f32 v30, v175, v174
v_lshlrev_b32 v176, 16, v118
v_and_b32 v177, 0xffff0000, v118
v_lshlrev_b32 v178, 16, v119
v_and_b32 v179, 0xffff0000, v119
v_add_f32 v180, v176, v178
v_add_f32 v181, v177, v179
v_sub_f32 v176, v176, v178
v_sub_f32 v177, v177, v179
v_mul_f32 v178, v159, v47
v_mul_f32 v179, v159, v63
v_mul_f32 v182, v180, v47
v_mul_f32 v183, v180, v63
v_fma_f32 v178, -v143, v95, v178
v_fmac_f32 v179, v143, v79
v_fma_f32 v182, -v181, v63, v182
v_fmac_f32 v183, v181, v47
v_fmac_f32 v182, v176, v178
v_fmac_f32 v183, v176, v179
v_fma_f32 v182, -v177, v179, v182
v_fmac_f32 v183, v177, v178
v_cvt_pk_bf16_f32 v31, v183, v182
v_lshlrev_b32 v168, 16, v120
v_and_b32 v169, 0xffff0000, v120
v_lshlrev_b32 v170, 16, v121
v_and_b32 v171, 0xffff0000, v121
v_add_f32 v172, v168, v170
v_add_f32 v173, v169, v171
v_sub_f32 v168, v168, v170
v_sub_f32 v169, v169, v171
v_mul_f32 v170, v160, v48
v_mul_f32 v171, v160, v64
v_mul_f32 v174, v172, v48
v_mul_f32 v175, v172, v64
v_fma_f32 v170, -v144, v96, v170
v_fmac_f32 v171, v144, v80
v_fma_f32 v174, -v173, v64, v174
v_fmac_f32 v175, v173, v48
v_fmac_f32 v174, v168, v170
v_fmac_f32 v175, v168, v171
v_fma_f32 v174, -v169, v171, v174
v_fmac_f32 v175, v169, v170
v_cvt_pk_bf16_f32 v32, v175, v174
v_lshlrev_b32 v176, 16, v122
v_and_b32 v177, 0xffff0000, v122
v_lshlrev_b32 v178, 16, v123
v_and_b32 v179, 0xffff0000, v123
v_add_f32 v180, v176, v178
v_add_f32 v181, v177, v179
v_sub_f32 v176, v176, v178
v_sub_f32 v177, v177, v179
v_mul_f32 v178, v161, v49
v_mul_f32 v179, v161, v65
v_mul_f32 v182, v180, v49
v_mul_f32 v183, v180, v65
v_fma_f32 v178, -v145, v97, v178
v_fmac_f32 v179, v145, v81
v_fma_f32 v182, -v181, v65, v182
v_fmac_f32 v183, v181, v49
v_fmac_f32 v182, v176, v178
v_fmac_f32 v183, v176, v179
v_fma_f32 v182, -v177, v179, v182
v_fmac_f32 v183, v177, v178
v_cvt_pk_bf16_f32 v33, v183, v182
v_lshlrev_b32 v168, 16, v124
v_and_b32 v169, 0xffff0000, v124
v_lshlrev_b32 v170, 16, v125
v_and_b32 v171, 0xffff0000, v125
v_add_f32 v172, v168, v170
v_add_f32 v173, v169, v171
v_sub_f32 v168, v168, v170
v_sub_f32 v169, v169, v171
v_mul_f32 v170, v162, v50
v_mul_f32 v171, v162, v66
v_mul_f32 v174, v172, v50
v_mul_f32 v175, v172, v66
v_fma_f32 v170, -v146, v98, v170
v_fmac_f32 v171, v146, v82
v_fma_f32 v174, -v173, v66, v174
v_fmac_f32 v175, v173, v50
v_fmac_f32 v174, v168, v170
v_fmac_f32 v175, v168, v171
v_fma_f32 v174, -v169, v171, v174
v_fmac_f32 v175, v169, v170
v_cvt_pk_bf16_f32 v34, v175, v174
v_lshlrev_b32 v176, 16, v126
v_and_b32 v177, 0xffff0000, v126
v_lshlrev_b32 v178, 16, v127
v_and_b32 v179, 0xffff0000, v127
v_add_f32 v180, v176, v178
v_add_f32 v181, v177, v179
v_sub_f32 v176, v176, v178
v_sub_f32 v177, v177, v179
v_mul_f32 v178, v163, v51
v_mul_f32 v179, v163, v67
v_mul_f32 v182, v180, v51
v_mul_f32 v183, v180, v67
v_fma_f32 v178, -v147, v99, v178
v_fmac_f32 v179, v147, v83
v_fma_f32 v182, -v181, v67, v182
v_fmac_f32 v183, v181, v51
v_fmac_f32 v182, v176, v178
v_fmac_f32 v183, v176, v179
v_fma_f32 v182, -v177, v179, v182
v_fmac_f32 v183, v177, v178
v_cvt_pk_bf16_f32 v35, v183, v182
v_lshlrev_b32 v168, 16, v128
v_and_b32 v169, 0xffff0000, v128
v_lshlrev_b32 v170, 16, v129
v_and_b32 v171, 0xffff0000, v129
v_add_f32 v172, v168, v170
v_add_f32 v173, v169, v171
v_sub_f32 v168, v168, v170
v_sub_f32 v169, v169, v171
v_mul_f32 v170, v164, v52
v_mul_f32 v171, v164, v68
v_mul_f32 v174, v172, v52
v_mul_f32 v175, v172, v68
v_fma_f32 v170, -v148, v100, v170
v_fmac_f32 v171, v148, v84
v_fma_f32 v174, -v173, v68, v174
v_fmac_f32 v175, v173, v52
v_fmac_f32 v174, v168, v170
v_fmac_f32 v175, v168, v171
v_fma_f32 v174, -v169, v171, v174
v_fmac_f32 v175, v169, v170
v_cvt_pk_bf16_f32 v36, v175, v174
v_lshlrev_b32 v176, 16, v130
v_and_b32 v177, 0xffff0000, v130
v_lshlrev_b32 v178, 16, v131
v_and_b32 v179, 0xffff0000, v131
v_add_f32 v180, v176, v178
v_add_f32 v181, v177, v179
v_sub_f32 v176, v176, v178
v_sub_f32 v177, v177, v179
v_mul_f32 v178, v165, v53
v_mul_f32 v179, v165, v69
v_mul_f32 v182, v180, v53
v_mul_f32 v183, v180, v69
v_fma_f32 v178, -v149, v101, v178
v_fmac_f32 v179, v149, v85
v_fma_f32 v182, -v181, v69, v182
v_fmac_f32 v183, v181, v53
v_fmac_f32 v182, v176, v178
v_fmac_f32 v183, v176, v179
v_fma_f32 v182, -v177, v179, v182
v_fmac_f32 v183, v177, v178
v_cvt_pk_bf16_f32 v37, v183, v182
v_lshlrev_b32 v168, 16, v132
v_and_b32 v169, 0xffff0000, v132
v_lshlrev_b32 v170, 16, v133
v_and_b32 v171, 0xffff0000, v133
v_add_f32 v172, v168, v170
v_add_f32 v173, v169, v171
v_sub_f32 v168, v168, v170
v_sub_f32 v169, v169, v171
v_mul_f32 v170, v166, v54
v_mul_f32 v171, v166, v70
v_mul_f32 v174, v172, v54
v_mul_f32 v175, v172, v70
v_fma_f32 v170, -v150, v102, v170
v_fmac_f32 v171, v150, v86
v_fma_f32 v174, -v173, v70, v174
v_fmac_f32 v175, v173, v54
v_fmac_f32 v174, v168, v170
v_fmac_f32 v175, v168, v171
v_fma_f32 v174, -v169, v171, v174
v_fmac_f32 v175, v169, v170
v_cvt_pk_bf16_f32 v38, v175, v174
v_lshlrev_b32 v176, 16, v134
v_and_b32 v177, 0xffff0000, v134
v_lshlrev_b32 v178, 16, v135
v_and_b32 v179, 0xffff0000, v135
v_add_f32 v180, v176, v178
v_add_f32 v181, v177, v179
v_sub_f32 v176, v176, v178
v_sub_f32 v177, v177, v179
v_mul_f32 v178, v167, v55
v_mul_f32 v179, v167, v71
v_mul_f32 v182, v180, v55
v_mul_f32 v183, v180, v71
v_fma_f32 v178, -v151, v103, v178
v_fmac_f32 v179, v151, v87
v_fma_f32 v182, -v181, v71, v182
v_fmac_f32 v183, v181, v55
v_fmac_f32 v182, v176, v178
v_fmac_f32 v183, v176, v179
v_fma_f32 v182, -v177, v179, v182
v_fmac_f32 v183, v177, v178
v_cvt_pk_bf16_f32 v39, v183, v182
v_mfma_f32_32x32x16_bf16 v[40:55], v[24:27], v[192:195], 0
v_mfma_f32_32x32x16_bf16 v[40:55], v[28:31], v[196:199], v[40:55]
v_mfma_f32_32x32x16_bf16 v[40:55], v[32:35], v[200:203], v[40:55]
v_mfma_f32_32x32x16_bf16 v[40:55], v[36:39], v[204:207], v[40:55]
v_mfma_f32_32x32x16_bf16 v[56:71], v[24:27], v[208:211], 0
v_mfma_f32_32x32x16_bf16 v[56:71], v[28:31], v[212:215], v[56:71]
v_mfma_f32_32x32x16_bf16 v[56:71], v[32:35], v[216:219], v[56:71]
v_mfma_f32_32x32x16_bf16 v[56:71], v[36:39], v[220:223], v[56:71]
s_nop 7
v_mul_f32 v168, v40, v224
v_mul_f32 v169, v40, v240
s_nop 1
v_fma_f32 v168, -v56, v240, v168
v_fmac_f32 v169, v56, v224
v_cvt_pk_bf16_f32 v24, v168, v169
v_mul_f32 v170, v41, v225
v_mul_f32 v171, v41, v241
v_fma_f32 v170, -v57, v241, v170
v_fmac_f32 v171, v57, v225
v_cvt_pk_bf16_f32 v25, v170, v171
v_mul_f32 v172, v42, v226
v_mul_f32 v173, v42, v242
v_fma_f32 v172, -v58, v242, v172
v_fmac_f32 v173, v58, v226
v_cvt_pk_bf16_f32 v26, v172, v173
v_mul_f32 v174, v43, v227
v_mul_f32 v175, v43, v243
v_fma_f32 v174, -v59, v243, v174
v_fmac_f32 v175, v59, v227
v_cvt_pk_bf16_f32 v27, v174, v175
v_mul_f32 v168, v44, v228
v_mul_f32 v169, v44, v244
v_fma_f32 v168, -v60, v244, v168
v_fmac_f32 v169, v60, v228
v_cvt_pk_bf16_f32 v28, v168, v169
v_mul_f32 v170, v45, v229
v_mul_f32 v171, v45, v245
v_fma_f32 v170, -v61, v245, v170
v_fmac_f32 v171, v61, v229
v_cvt_pk_bf16_f32 v29, v170, v171
v_mul_f32 v172, v46, v230
v_mul_f32 v173, v46, v246
v_fma_f32 v172, -v62, v246, v172
v_fmac_f32 v173, v62, v230
v_cvt_pk_bf16_f32 v30, v172, v173
v_mul_f32 v174, v47, v231
v_mul_f32 v175, v47, v247
v_fma_f32 v174, -v63, v247, v174
v_fmac_f32 v175, v63, v231
v_cvt_pk_bf16_f32 v31, v174, v175
v_mul_f32 v168, v48, v232
v_mul_f32 v169, v48, v248
v_fma_f32 v168, -v64, v248, v168
v_fmac_f32 v169, v64, v232
v_cvt_pk_bf16_f32 v32, v168, v169
v_mul_f32 v170, v49, v233
v_mul_f32 v171, v49, v249
v_fma_f32 v170, -v65, v249, v170
v_fmac_f32 v171, v65, v233
v_cvt_pk_bf16_f32 v33, v170, v171
v_mul_f32 v172, v50, v234
v_mul_f32 v173, v50, v250
v_fma_f32 v172, -v66, v250, v172
v_fmac_f32 v173, v66, v234
v_cvt_pk_bf16_f32 v34, v172, v173
v_mul_f32 v174, v51, v235
v_mul_f32 v175, v51, v251
v_fma_f32 v174, -v67, v251, v174
v_fmac_f32 v175, v67, v235
v_cvt_pk_bf16_f32 v35, v174, v175
v_mul_f32 v168, v52, v236
v_mul_f32 v169, v52, v252
v_fma_f32 v168, -v68, v252, v168
v_fmac_f32 v169, v68, v236
v_cvt_pk_bf16_f32 v36, v168, v169
v_mul_f32 v170, v53, v237
v_mul_f32 v171, v53, v253
v_fma_f32 v170, -v69, v253, v170
v_fmac_f32 v171, v69, v237
v_cvt_pk_bf16_f32 v37, v170, v171
v_mul_f32 v172, v54, v238
v_mul_f32 v173, v54, v254
v_fma_f32 v172, -v70, v254, v172
v_fmac_f32 v173, v70, v238
v_cvt_pk_bf16_f32 v38, v172, v173
v_mul_f32 v174, v55, v239
v_mul_f32 v175, v55, v255
v_fma_f32 v174, -v71, v255, v174
v_fmac_f32 v175, v71, v239
v_cvt_pk_bf16_f32 v39, v174, v175
v_mfma_f32_32x32x16_bf16 v[40:55], v[192:195], v[24:27], 0
v_mfma_f32_32x32x16_bf16 v[40:55], v[196:199], v[28:31], v[40:55]
v_mfma_f32_32x32x16_bf16 v[40:55], v[200:203], v[32:35], v[40:55]
v_mfma_f32_32x32x16_bf16 v[40:55], v[204:207], v[36:39], v[40:55]
v_mfma_f32_32x32x16_bf16 v[56:71], v[208:211], v[24:27], 0
v_mfma_f32_32x32x16_bf16 v[56:71], v[212:215], v[28:31], v[56:71]
v_mfma_f32_32x32x16_bf16 v[56:71], v[216:219], v[32:35], v[56:71]
v_mfma_f32_32x32x16_bf16 v[56:71], v[220:223], v[36:39], v[56:71]
s_lshr_b32 s64, s62, 16
L_lc24:
ds_read_b128 v[186:189], v184
s_waitcnt lgkmcnt(0)
v_min3_u32 v186, v186, v187, v188
v_min_u32 v186, v186, v189
s_nop 0
v_readfirstlane_b32 s92, v186
s_nop 0
s_cmp_ge_u32 s92, 8
s_cbranch_scc1 L_lcd25
s_sleep 1
s_branch L_lc24
L_lcd25:
s_nop 1
v_cvt_pk_bf16_f32 v24, v40, v56
v_xor_b32 v24, s64, v24
v_cvt_pk_bf16_f32 v25, v41, v57
v_xor_b32 v25, s64, v25
v_cvt_pk_bf16_f32 v26, v42, v58
v_xor_b32 v26, s64, v26
v_cvt_pk_bf16_f32 v27, v43, v59
v_xor_b32 v27, s64, v27
ds_write_b128 v15, v[24:27] offset:0
v_cvt_pk_bf16_f32 v28, v44, v60
v_xor_b32 v28, s64, v28
v_cvt_pk_bf16_f32 v29, v45, v61
v_xor_b32 v29, s64, v29
v_cvt_pk_bf16_f32 v30, v46, v62
v_xor_b32 v30, s64, v30
v_cvt_pk_bf16_f32 v31, v47, v63
v_xor_b32 v31, s64, v31
ds_write_b128 v15, v[28:31] offset:4096
v_cvt_pk_bf16_f32 v32, v48, v64
v_xor_b32 v32, s64, v32
v_cvt_pk_bf16_f32 v33, v49, v65
v_xor_b32 v33, s64, v33
v_cvt_pk_bf16_f32 v34, v50, v66
v_xor_b32 v34, s64, v34
v_cvt_pk_bf16_f32 v35, v51, v67
v_xor_b32 v35, s64, v35
ds_write_b128 v15, v[32:35] offset:8192
v_cvt_pk_bf16_f32 v36, v52, v68
v_xor_b32 v36, s64, v36
v_cvt_pk_bf16_f32 v37, v53, v69
v_xor_b32 v37, s64, v37
v_cvt_pk_bf16_f32 v38, v54, v70
v_xor_b32 v38, s64, v38
v_cvt_pk_bf16_f32 v39, v55, v71
v_xor_b32 v39, s64, v39
ds_write_b128 v15, v[36:39] offset:12288
s_waitcnt lgkmcnt(0)
v_mov_b32 v190, 9
s_mov_b64 exec, 1
ds_write_b32 v185, v190
s_mov_b64 exec, -1
L_lc26:
ds_read_b128 v[186:189], v184
s_waitcnt lgkmcnt(0)
v_min3_u32 v186, v186, v187, v188
v_min_u32 v186, v186, v189
s_nop 0
v_readfirstlane_b32 s92, v186
s_nop 0
s_cmp_ge_u32 s92, 9
s_cbranch_scc1 L_lcd27
s_sleep 1
s_branch L_lc26
L_lcd27:
ds_read_b128 v[24:27], v18 offset:0
ds_read_b128 v[28:31], v18 offset:1024
ds_read_b128 v[32:35], v18 offset:2048
ds_read_b128 v[36:39], v18 offset:3072
s_mov_b32 s64, 0
s_waitcnt lgkmcnt(3)
buffer_store_dwordx4 v[24:27], v14, s[56:59], s64 offen sc1
s_mov_b32 s64, 262144
s_waitcnt lgkmcnt(2)
buffer_store_dwordx4 v[28:31], v14, s[56:59], s64 offen sc1
s_mov_b32 s64, 524288
s_waitcnt lgkmcnt(1)
buffer_store_dwordx4 v[32:35], v14, s[56:59], s64 offen sc1
s_mov_b32 s64, 786432
s_waitcnt lgkmcnt(0)
buffer_store_dwordx4 v[36:39], v14, s[56:59], s64 offen sc1
s_lshl_b32 s64, s67, 14
s_add_u32 s40, s28, s64
s_addc_u32 s41, s29, 0
s_mov_b32 s42, 16384
s_mov_b32 s43, 0x20000
v_and_b32 v8, 31, v1
v_lshrrev_b32 v9, 5, v1
v_lshlrev_b32 v14, 2, v8
v_lshl_add_u32 v14, v9, 9, v14
s_mov_b32 s64, 0x35000000
v_mul_f32 v224, s64, v224
v_mul_f32 v225, s64, v225
v_mul_f32 v226, s64, v226
v_mul_f32 v227, s64, v227
v_mul_f32 v228, s64, v228
v_mul_f32 v229, s64, v229
v_mul_f32 v230, s64, v230
v_mul_f32 v231, s64, v231
v_mul_f32 v232, s64, v232
v_mul_f32 v233, s64, v233
v_mul_f32 v234, s64, v234
v_mul_f32 v235, s64, v235
v_mul_f32 v236, s64, v236
v_mul_f32 v237, s64, v237
v_mul_f32 v238, s64, v238
v_mul_f32 v239, s64, v239
v_mul_f32 v240, s64, v240
v_mul_f32 v241, s64, v241
v_mul_f32 v242, s64, v242
v_mul_f32 v243, s64, v243
v_mul_f32 v244, s64, v244
v_mul_f32 v245, s64, v245
v_mul_f32 v246, s64, v246
v_mul_f32 v247, s64, v247
v_mul_f32 v248, s64, v248
v_mul_f32 v249, s64, v249
v_mul_f32 v250, s64, v250
v_mul_f32 v251, s64, v251
v_mul_f32 v252, s64, v252
v_mul_f32 v253, s64, v253
v_mul_f32 v254, s64, v254
v_mul_f32 v255, s64, v255
s_waitcnt vmcnt(0)
v_mov_b32 v190, 10
s_mov_b64 exec, 1
ds_write_b32 v185, v190
s_mov_b64 exec, -1
s_cmp_lg_u32 s66, 0
s_cbranch_scc1 L_ph28
L_lc29:
ds_read_b128 v[186:189], v184
s_waitcnt lgkmcnt(0)
v_min3_u32 v186, v186, v187, v188
v_min_u32 v186, v186, v189
s_nop 0
v_readfirstlane_b32 s92, v186
s_nop 0
s_cmp_ge_u32 s92, 10
s_cbranch_scc1 L_lcd30
s_sleep 1
s_branch L_lc29
L_lcd30:
s_and_b32 s64, s2, 15
s_lshl_b32 s65, s64, 7
s_add_u32 s65, s65, 6144
s_add_u32 s90, s32, s65
s_addc_u32 s91, s33, 0
s_mov_b32 s65, 1
s_atomic_add s65, s[90:91], 0x0 glc
s_lshl_b32 s64, s64, 2
s_add_u32 s64, s64, 548864
v_lshl_add_u32 v20, v1, 7, s64
v_mov_b32 v21, s37
s_and_b32 s64, s2, 63
s_lshl_b32 s64, s64, 7
s_add_u32 s64, s64, 548864
s_waitcnt lgkmcnt(0)
s_cmp_lg_u32 s65, 15
s_cbranch_scc1 L_sg31
global_store_dword v20, v21, s[32:33] sc1
L_sg31:
s_add_u32 s90, s32, s64
s_addc_u32 s91, s33, 0
s_mov_b32 s64, s37
s_mov_b32 s65, s37
s_mov_b32 s92, 0
s_branch L_sp32
L_nok33:
s_add_u32 s92, s92, 1
s_cmp_ge_u32 s92, 200000
s_cbranch_scc1 L_ph28
s_sleep 2
L_sp32:
s_load_dwordx16 s[4:19], s[90:91], 0x0 glc
s_waitcnt lgkmcnt(0)
s_cmp_eq_u64 s[4:5], s[64:65]
s_cbranch_scc0 L_nok33
s_cmp_eq_u64 s[6:7], s[64:65]
s_cbranch_scc0 L_nok33
s_cmp_eq_u64 s[8:9], s[64:65]
s_cbranch_scc0 L_nok33
s_cmp_eq_u64 s[10:11], s[64:65]
s_cbranch_scc0 L_nok33
s_cmp_eq_u64 s[12:13], s[64:65]
s_cbranch_scc0 L_nok33
s_cmp_eq_u64 s[14:15], s[64:65]
s_cbranch_scc0 L_nok33
s_cmp_eq_u64 s[16:17], s[64:65]
s_cbranch_scc0 L_nok33
s_cmp_eq_u64 s[18:19], s[64:65]
s_cbranch_scc0 L_nok33
L_ph28:
v_mov_b32 v190, 11
s_mov_b64 exec, 1
ds_write_b32 v185, v190
s_mov_b64 exec, -1
L_lc34:
ds_read_b128 v[186:189], v184
s_waitcnt lgkmcnt(0)
v_min3_u32 v186, v186, v187, v188
v_min_u32 v186, v186, v189
s_nop 0
v_readfirstlane_b32 s92, v186
s_nop 0
s_cmp_ge_u32 s92, 11
s_cbranch_scc1 L_lcd35
s_sleep 1
s_branch L_lc34
L_lcd35:
s_mov_b32 m0, s68
s_nop 0
buffer_load_dwordx4 v7, s[44:47], 0 offen offset:0 sc1 lds
buffer_load_dwordx4 v7, s[44:47], 0 offen offset:1024 sc1 lds
buffer_load_dwordx4 v7, s[44:47], 0 offen offset:2048 sc1 lds
buffer_load_dwordx4 v7, s[44:47], 0 offen offset:3072 sc1 lds
s_waitcnt vmcnt(0)
v_mov_b32 v190, 12
s_mov_b64 exec, 1
ds_write_b32 v185, v190
s_mov_b64 exec, -1
L_lc36:
ds_read_b128 v[186:189], v184
s_waitcnt lgkmcnt(0)
v_min3_u32 v186, v186, v187, v188
v_min_u32 v186, v186, v189
s_nop 0
v_readfirstlane_b32 s92, v186
s_nop 0
s_cmp_ge_u32 s92, 12
s_cbranch_scc1 L_lcd37
s_sleep 1
s_branch L_lc36
L_lcd37:
ds_read_b32 v24, v4 offset:0
ds_read_b32 v25, v4 offset:1024
ds_read_b32 v26, v4 offset:2048
ds_read_b32 v27, v4 offset:3072
ds_read_b32 v28, v4 offset:8192
ds_read_b32 v29, v4 offset:9216
ds_read_b32 v30, v4 offset:10240
ds_read_b32 v31, v4 offset:11264
ds_read_b32 v32, v6 offset:0
ds_read_b32 v33, v5 offset:10240
ds_read_b32 v34, v5 offset:9216
ds_read_b32 v35, v5 offset:8192
ds_read_b32 v36, v5 offset:3072
ds_read_b32 v37, v5 offset:2048
ds_read_b32 v38, v5 offset:1024
ds_read_b32 v39, v5 offset:0
s_waitcnt lgkmcnt(0)
v_mfma_f32_32x32x16_bf16 v[40:55], v[24:27], v[192:195], 0
v_mfma_f32_32x32x16_bf16 v[40:55], v[28:31], v[196:199], v[40:55]
v_mfma_f32_32x32x16_bf16 v[40:55], v[32:35], v[200:203], v[40:55]
v_mfma_f32_32x32x16_bf16 v[40:55], v[36:39], v[204:207], v[40:55]
v_mfma_f32_32x32x16_bf16 v[56:71], v[24:27], v[208:211], 0
v_mfma_f32_32x32x16_bf16 v[56:71], v[28:31], v[212:215], v[56:71]
v_mfma_f32_32x32x16_bf16 v[56:71], v[32:35], v[216:219], v[56:71]
v_mfma_f32_32x32x16_bf16 v[56:71], v[36:39], v[220:223], v[56:71]
s_nop 7
v_mul_f32 v168, v40, v224
v_mul_f32 v169, v40, v240
s_nop 1
v_fma_f32 v168, -v56, v240, v168
v_fmac_f32 v169, v56, v224
v_cvt_pk_bf16_f32 v24, v168, v169
v_mul_f32 v170, v41, v225
v_mul_f32 v171, v41, v241
v_fma_f32 v170, -v57, v241, v170
v_fmac_f32 v171, v57, v225
v_cvt_pk_bf16_f32 v25, v170, v171
v_mul_f32 v172, v42, v226
v_mul_f32 v173, v42, v242
v_fma_f32 v172, -v58, v242, v172
v_fmac_f32 v173, v58, v226
v_cvt_pk_bf16_f32 v26, v172, v173
v_mul_f32 v174, v43, v227
v_mul_f32 v175, v43, v243
v_fma_f32 v174, -v59, v243, v174
v_fmac_f32 v175, v59, v227
v_cvt_pk_bf16_f32 v27, v174, v175
v_mul_f32 v168, v44, v228
v_mul_f32 v169, v44, v244
v_fma_f32 v168, -v60, v244, v168
v_fmac_f32 v169, v60, v228
v_cvt_pk_bf16_f32 v28, v168, v169
v_mul_f32 v170, v45, v229
v_mul_f32 v171, v45, v245
v_fma_f32 v170, -v61, v245, v170
v_fmac_f32 v171, v61, v229
v_cvt_pk_bf16_f32 v29, v170, v171
v_mul_f32 v172, v46, v230
v_mul_f32 v173, v46, v246
v_fma_f32 v172, -v62, v246, v172
v_fmac_f32 v173, v62, v230
v_cvt_pk_bf16_f32 v30, v172, v173
v_mul_f32 v174, v47, v231
v_mul_f32 v175, v47, v247
v_fma_f32 v174, -v63, v247, v174
v_fmac_f32 v175, v63, v231
v_cvt_pk_bf16_f32 v31, v174, v175
v_mul_f32 v168, v48, v232
v_mul_f32 v169, v48, v248
v_fma_f32 v168, -v64, v248, v168
v_fmac_f32 v169, v64, v232
v_cvt_pk_bf16_f32 v32, v168, v169
v_mul_f32 v170, v49, v233
v_mul_f32 v171, v49, v249
v_fma_f32 v170, -v65, v249, v170
v_fmac_f32 v171, v65, v233
v_cvt_pk_bf16_f32 v33, v170, v171
v_mul_f32 v172, v50, v234
v_mul_f32 v173, v50, v250
v_fma_f32 v172, -v66, v250, v172
v_fmac_f32 v173, v66, v234
v_cvt_pk_bf16_f32 v34, v172, v173
v_mul_f32 v174, v51, v235
v_mul_f32 v175, v51, v251
v_fma_f32 v174, -v67, v251, v174
v_fmac_f32 v175, v67, v235
v_cvt_pk_bf16_f32 v35, v174, v175
v_mul_f32 v168, v52, v236
v_mul_f32 v169, v52, v252
v_fma_f32 v168, -v68, v252, v168
v_fmac_f32 v169, v68, v236
v_cvt_pk_bf16_f32 v36, v168, v169
v_mul_f32 v170, v53, v237
v_mul_f32 v171, v53, v253
v_fma_f32 v170, -v69, v253, v170
v_fmac_f32 v171, v69, v237
v_cvt_pk_bf16_f32 v37, v170, v171
v_mul_f32 v172, v54, v238
v_mul_f32 v173, v54, v254
v_fma_f32 v172, -v70, v254, v172
v_fmac_f32 v173, v70, v238
v_cvt_pk_bf16_f32 v38, v172, v173
v_mul_f32 v174, v55, v239
v_mul_f32 v175, v55, v255
v_fma_f32 v174, -v71, v255, v174
v_fmac_f32 v175, v71, v239
v_cvt_pk_bf16_f32 v39, v174, v175
v_mfma_f32_32x32x16_bf16 v[40:55], v[192:195], v[24:27], 0
v_mfma_f32_32x32x16_bf16 v[40:55], v[196:199], v[28:31], v[40:55]
v_mfma_f32_32x32x16_bf16 v[40:55], v[200:203], v[32:35], v[40:55]
v_mfma_f32_32x32x16_bf16 v[40:55], v[204:207], v[36:39], v[40:55]
v_mfma_f32_32x32x16_bf16 v[56:71], v[208:211], v[24:27], 0
v_mfma_f32_32x32x16_bf16 v[56:71], v[212:215], v[28:31], v[56:71]
v_mfma_f32_32x32x16_bf16 v[56:71], v[216:219], v[32:35], v[56:71]
v_mfma_f32_32x32x16_bf16 v[56:71], v[220:223], v[36:39], v[56:71]
s_movk_i32 s64, 0x2000
s_nop 10
v_cvt_pk_bf16_f32 v73, v56, v40
v_lshlrev_b32 v72, 16, v73
v_and_b32 v73, 0xffff0000, v73
buffer_store_dword v72, v14, s[40:43], 0 offen offset:0 nt
buffer_store_dword v73, v14, s[40:43], s64 offen offset:0 nt
v_cvt_pk_bf16_f32 v75, v57, v41
v_lshlrev_b32 v74, 16, v75
v_and_b32 v75, 0xffff0000, v75
buffer_store_dword v74, v14, s[40:43], 0 offen offset:128 nt
buffer_store_dword v75, v14, s[40:43], s64 offen offset:128 nt
v_cvt_pk_bf16_f32 v77, v58, v42
v_lshlrev_b32 v76, 16, v77
v_and_b32 v77, 0xffff0000, v77
buffer_store_dword v76, v14, s[40:43], 0 offen offset:256 nt
buffer_store_dword v77, v14, s[40:43], s64 offen offset:256 nt
v_cvt_pk_bf16_f32 v79, v59, v43
v_lshlrev_b32 v78, 16, v79
v_and_b32 v79, 0xffff0000, v79
buffer_store_dword v78, v14, s[40:43], 0 offen offset:384 nt
buffer_store_dword v79, v14, s[40:43], s64 offen offset:384 nt
v_cvt_pk_bf16_f32 v81, v60, v44
v_lshlrev_b32 v80, 16, v81
v_and_b32 v81, 0xffff0000, v81
buffer_store_dword v80, v14, s[40:43], 0 offen offset:1024 nt
buffer_store_dword v81, v14, s[40:43], s64 offen offset:1024 nt
v_cvt_pk_bf16_f32 v83, v61, v45
v_lshlrev_b32 v82, 16, v83
v_and_b32 v83, 0xffff0000, v83
buffer_store_dword v82, v14, s[40:43], 0 offen offset:1152 nt
buffer_store_dword v83, v14, s[40:43], s64 offen offset:1152 nt
v_cvt_pk_bf16_f32 v85, v62, v46
v_lshlrev_b32 v84, 16, v85
v_and_b32 v85, 0xffff0000, v85
buffer_store_dword v84, v14, s[40:43], 0 offen offset:1280 nt
buffer_store_dword v85, v14, s[40:43], s64 offen offset:1280 nt
v_cvt_pk_bf16_f32 v87, v63, v47
v_lshlrev_b32 v86, 16, v87
v_and_b32 v87, 0xffff0000, v87
buffer_store_dword v86, v14, s[40:43], 0 offen offset:1408 nt
buffer_store_dword v87, v14, s[40:43], s64 offen offset:1408 nt
v_cvt_pk_bf16_f32 v89, v64, v48
v_lshlrev_b32 v88, 16, v89
v_and_b32 v89, 0xffff0000, v89
buffer_store_dword v88, v14, s[40:43], 0 offen offset:2048 nt
buffer_store_dword v89, v14, s[40:43], s64 offen offset:2048 nt
v_cvt_pk_bf16_f32 v91, v65, v49
v_lshlrev_b32 v90, 16, v91
v_and_b32 v91, 0xffff0000, v91
buffer_store_dword v90, v14, s[40:43], 0 offen offset:2176 nt
buffer_store_dword v91, v14, s[40:43], s64 offen offset:2176 nt
v_cvt_pk_bf16_f32 v93, v66, v50
v_lshlrev_b32 v92, 16, v93
v_and_b32 v93, 0xffff0000, v93
buffer_store_dword v92, v14, s[40:43], 0 offen offset:2304 nt
buffer_store_dword v93, v14, s[40:43], s64 offen offset:2304 nt
v_cvt_pk_bf16_f32 v95, v67, v51
v_lshlrev_b32 v94, 16, v95
v_and_b32 v95, 0xffff0000, v95
buffer_store_dword v94, v14, s[40:43], 0 offen offset:2432 nt
buffer_store_dword v95, v14, s[40:43], s64 offen offset:2432 nt
v_cvt_pk_bf16_f32 v97, v68, v52
v_lshlrev_b32 v96, 16, v97
v_and_b32 v97, 0xffff0000, v97
buffer_store_dword v96, v14, s[40:43], 0 offen offset:3072 nt
buffer_store_dword v97, v14, s[40:43], s64 offen offset:3072 nt
v_cvt_pk_bf16_f32 v99, v69, v53
v_lshlrev_b32 v98, 16, v99
v_and_b32 v99, 0xffff0000, v99
buffer_store_dword v98, v14, s[40:43], 0 offen offset:3200 nt
buffer_store_dword v99, v14, s[40:43], s64 offen offset:3200 nt
v_cvt_pk_bf16_f32 v101, v70, v54
v_lshlrev_b32 v100, 16, v101
v_and_b32 v101, 0xffff0000, v101
buffer_store_dword v100, v14, s[40:43], 0 offen offset:3328 nt
buffer_store_dword v101, v14, s[40:43], s64 offen offset:3328 nt
v_cvt_pk_bf16_f32 v103, v71, v55
v_lshlrev_b32 v102, 16, v103
v_and_b32 v103, 0xffff0000, v103
buffer_store_dword v102, v14, s[40:43], 0 offen offset:3456 nt
buffer_store_dword v103, v14, s[40:43], s64 offen offset:3456 nt
s_endpgm
L_concat_heads__spectral_gfnet__ssm_conv_s5__prompt_kernel_gemm:
s_lshr_b32 s68, s34, 1
s_and_b32 s66, s34, 1
v_and_b32 v6, 31, v1
v_lshrrev_b32 v5, 5, v1
v_and_b32 v4, 0x13, v6
v_bfe_u32 v7, v6, 2, 1
v_lshl_or_b32 v4, v7, 3, v4
v_bfe_u32 v7, v6, 3, 1
v_lshl_or_b32 v4, v7, 2, v4
s_lshl_b32 s60, s36, 6
s_lshl_b32 s61, s66, 5
s_add_u32 s60, s60, s61
v_add_u32 v4, s60, v4
v_lshlrev_b32 v7, 1, v4
v_lshlrev_b32 v11, 4, v1
s_waitcnt lgkmcnt(0)
global_load_ushort v8, v7, s[12:13]
global_load_ushort v9, v7, s[14:15]
global_load_ushort v10, v7, s[24:25]
s_lshl_b32 s60, s2, 3
s_add_u32 s60, s60, s34
s_cmp_lg_u32 s60, 1
s_cbranch_scc1 L_nn38
s_load_dword s60, s[32:33], 0
v_mov_b32 v16, 0
v_and_b32 v17, 31, v1
v_lshlrev_b32 v17, 7, v17
v_add_u32 v17, 4096, v17
global_store_dword v17, v16, s[32:33] sc1
s_waitcnt vmcnt(0) lgkmcnt(0)
s_add_u32 s60, s60, 1
s_cmp_eq_u32 s60, 0
s_cselect_b32 s60, 1, s60
v_mov_b32 v17, s60
s_mov_b64 exec, 1
global_store_dword v16, v17, s[30:31] sc1
global_store_dword v16, v17, s[32:33] offset:0
s_mov_b64 exec, -1
L_nn38:
s_cmp_lg_u32 s34, 0
s_cbranch_scc1 L_pf39
s_lshr_b32 s60, s2, 3
s_lshl_b32 s60, s60, 11
v_and_b32 v12, 15, v1
v_lshl_add_u32 v12, v12, 7, s60
v_min_u32 v12, L_concat_heads__spectral_gfnet__ssm_conv_s5__prompt_kernel_end-concat_heads__spectral_gfnet__ssm_conv_s5__prompt_kernel, v12
s_getpc_b64 s[60:61]
L_pc40:
s_sub_u32 s60, s60, L_pc40-concat_heads__spectral_gfnet__ssm_conv_s5__prompt_kernel
s_subb_u32 s61, s61, 0
global_load_dword v247, v12, s[60:61]
L_pf39:
v_bfe_u32 v7, v6, 1, 3
v_xor_b32 v7, v7, v5
v_lshlrev_b32 v7, 4, v7
v_lshl_add_u32 v7, v6, 7, v7
s_lshl_b32 s60, s68, 13
s_lshl_b32 s61, s66, 13
s_add_u32 s61, s61, 16384
v_xor_b32 v12, 0, v7
v_add_u32 v128, s60, v12
v_add_u32 v132, s61, v12
v_add_u32 v136, 0x10000, v128
v_add_u32 v140, 0x10000, v132
v_xor_b32 v12, 32, v7
v_add_u32 v129, s60, v12
v_add_u32 v133, s61, v12
v_add_u32 v137, 0x10000, v129
v_add_u32 v141, 0x10000, v133
v_xor_b32 v12, 64, v7
v_add_u32 v130, s60, v12
v_add_u32 v134, s61, v12
v_add_u32 v138, 0x10000, v130
v_add_u32 v142, 0x10000, v134
v_xor_b32 v12, 96, v7
v_add_u32 v131, s60, v12
v_add_u32 v135, s61, v12
v_add_u32 v139, 0x10000, v131
v_add_u32 v143, 0x10000, v135
v_mov_b64 v[64:65], 0
v_mov_b64 v[66:67], 0
v_mov_b64 v[68:69], 0
v_mov_b64 v[70:71], 0
v_mov_b64 v[72:73], 0
v_mov_b64 v[74:75], 0
v_mov_b64 v[76:77], 0
v_mov_b64 v[78:79], 0
v_mov_b64 v[80:81], 0
v_mov_b64 v[82:83], 0
v_mov_b64 v[84:85], 0
v_mov_b64 v[86:87], 0
v_mov_b64 v[88:89], 0
v_mov_b64 v[90:91], 0
v_mov_b64 v[92:93], 0
v_mov_b64 v[94:95], 0
v_mov_b64 v[96:97], 0
v_mov_b64 v[98:99], 0
v_mov_b64 v[100:101], 0
v_mov_b64 v[102:103], 0
v_mov_b64 v[104:105], 0
v_mov_b64 v[106:107], 0
v_mov_b64 v[108:109], 0
v_mov_b64 v[110:111], 0
v_mov_b64 v[112:113], 0
v_mov_b64 v[114:115], 0
v_mov_b64 v[116:117], 0
v_mov_b64 v[118:119], 0
v_mov_b64 v[120:121], 0
v_mov_b64 v[122:123], 0
v_mov_b64 v[124:125], 0
v_mov_b64 v[126:127], 0
v_mov_b32 v34, 126976
v_mov_b64 v[36:37], 0
v_mov_b64 v[38:39], 0
s_mov_b64 exec, 1
ds_write_b128 v34, v[36:39]
ds_write_b128 v34, v[36:39] offset:16
s_mov_b64 exec, -1
v_lshlrev_b32 v12, 4, v5
v_sub_u32 v12, v6, v12
v_mov_b32 v13, 0x3f80
v_mov_b32 v14, 1.0
v_cmp_eq_u32 vcc, 0, v12
v_cmp_eq_u32 s[60:61], 8, v12
s_nop 0
v_cndmask_b32 v248, 0, v13, vcc
v_cndmask_b32 v248, v248, v14, s[60:61]
v_cmp_eq_u32 vcc, 1, v12
v_cmp_eq_u32 s[60:61], 9, v12
s_nop 0
v_cndmask_b32 v249, 0, v13, vcc
v_cndmask_b32 v249, v249, v14, s[60:61]
v_cmp_eq_u32 vcc, 2, v12
v_cmp_eq_u32 s[60:61], 10, v12
s_nop 0
v_cndmask_b32 v250, 0, v13, vcc
v_cndmask_b32 v250, v250, v14, s[60:61]
v_cmp_eq_u32 vcc, 3, v12
v_cmp_eq_u32 s[60:61], 11, v12
s_nop 0
v_cndmask_b32 v251, 0, v13, vcc
v_cndmask_b32 v251, v251, v14, s[60:61]
v_cmp_eq_u32 vcc, 4, v12
v_cmp_eq_u32 s[60:61], 12, v12
s_nop 0
v_cndmask_b32 v252, 0, v13, vcc
v_cndmask_b32 v252, v252, v14, s[60:61]
v_cmp_eq_u32 vcc, 5, v12
v_cmp_eq_u32 s[60:61], 13, v12
s_nop 0
v_cndmask_b32 v253, 0, v13, vcc
v_cndmask_b32 v253, v253, v14, s[60:61]
v_cmp_eq_u32 vcc, 6, v12
v_cmp_eq_u32 s[60:61], 14, v12
s_nop 0
v_cndmask_b32 v254, 0, v13, vcc
v_cndmask_b32 v254, v254, v14, s[60:61]
v_cmp_eq_u32 vcc, 7, v12
v_cmp_eq_u32 s[60:61], 15, v12
s_nop 0
v_cndmask_b32 v255, 0, v13, vcc
v_cndmask_b32 v255, v255, v14, s[60:61]
s_add_u32 s40, s32, 65536
s_addc_u32 s41, s33, 0
s_mov_b32 s42, 262144
s_mov_b32 s43, 0x20000
s_add_u32 s44, s32, 1048576
s_addc_u32 s45, s33, 0
s_mov_b32 s46, 8388608
s_mov_b32 s47, 0x20000
s_waitcnt vmcnt(0)
v_lshlrev_b32 v8, 16, v8
v_lshlrev_b32 v9, 16, v9
v_lshlrev_b32 v10, 16, v10
v_mul_f32 v10, 0x3fb8aa3b, v10
v_exp_f32 v10, v10
s_nop 0
v_cvt_pk_bf16_f32 v10, v10, v10
v_lshlrev_b32 v10, 16, v10
v_mul_f32 v12, v10, v8
v_mul_f32 v13, v10, v9
v_mul_f32 v12, 0x3fb8aa3b, v12
v_exp_f32 v12, v12
v_mul_f32 v13, 0.15915494, v13
v_rndne_f32 v14, v13
v_sub_f32 v13, v13, v14
v_cos_f32 v14, v13
v_sin_f32 v15, v13
v_mul_f32 v24, v12, v14
v_mul_f32 v25, v12, v15
v_add_f32 v12, -1.0, v24
v_mul_f32 v13, v8, v8
v_fma_f32 v13, v9, v9, v13
v_rcp_f32 v13, v13
s_nop 0
v_add_f32 v13, v13, v13
v_mul_f32 v14, v12, v8
v_fma_f32 v14, v25, v9, v14
v_mul_f32 v26, v14, v13
v_mul_f32 v14, v25, v8
v_fma_f32 v14, -v12, v9, v14
v_mul_f32 v27, v14, v13
v_mul_f32 v12, v25, v25
v_mul_f32 v13, v24, v25
v_fma_f32 v28, v24, v24, -v12
v_add_f32 v29, v13, v13
v_mul_f32 v12, v29, v29
v_mul_f32 v13, v28, v29
v_fma_f32 v28, v28, v28, -v12
v_add_f32 v29, v13, v13
v_mul_f32 v12, v29, v29
v_mul_f32 v13, v28, v29
v_fma_f32 v28, v28, v28, -v12
v_add_f32 v29, v13, v13
v_mul_f32 v12, v29, v29
v_mul_f32 v13, v28, v29
v_fma_f32 v28, v28, v28, -v12
v_add_f32 v29, v13, v13
v_mul_f32 v12, v29, v29
v_mul_f32 v13, v28, v29
v_fma_f32 v20, v28, v28, -v12
v_add_f32 v21, v13, v13
v_mul_f32 v12, v21, v21
v_mul_f32 v13, v20, v21
v_fma_f32 v30, v20, v20, -v12
v_add_f32 v31, v13, v13
v_mul_f32 v12, v31, v31
v_mul_f32 v13, v30, v31
v_fma_f32 v30, v30, v30, -v12
v_add_f32 v31, v13, v13
v_mul_f32 v12, v31, v31
v_mul_f32 v13, v30, v31
v_fma_f32 v2, v30, v30, -v12
v_add_f32 v3, v13, v13
s_waitcnt lgkmcnt(0)
s_barrier
ds_read_b128 v[32:35], v128 offset:0
ds_read_b128 v[36:39], v132 offset:0
ds_read_b128 v[40:43], v132 offset:4096
ds_read_b128 v[44:47], v128 offset:4096
s_waitcnt lgkmcnt(2)
v_mfma_f32_32x32x16_bf16 v[64:79], v[32:35], v[36:39], v[64:79]
ds_read_b128 v[48:51], v129 offset:0
ds_read_b128 v[52:55], v133 offset:0
s_waitcnt lgkmcnt(3)
v_mfma_f32_32x32x16_bf16 v[80:95], v[32:35], v[40:43], v[80:95]
ds_read_b128 v[56:59], v133 offset:4096
ds_read_b128 v[60:63], v129 offset:4096
s_waitcnt lgkmcnt(4)
v_mfma_f32_32x32x16_bf16 v[96:111], v[44:47], v[36:39], v[96:111]
v_mfma_f32_32x32x16_bf16 v[112:127], v[44:47], v[40:43], v[112:127]
s_waitcnt lgkmcnt(2)
v_mfma_f32_32x32x16_bf16 v[64:79], v[48:51], v[52:55], v[64:79]
ds_read_b128 v[32:35], v130 offset:0
ds_read_b128 v[36:39], v134 offset:0
s_waitcnt lgkmcnt(3)
v_mfma_f32_32x32x16_bf16 v[80:95], v[48:51], v[56:59], v[80:95]
ds_read_b128 v[40:43], v134 offset:4096
ds_read_b128 v[44:47], v130 offset:4096
s_waitcnt lgkmcnt(4)
v_mfma_f32_32x32x16_bf16 v[96:111], v[60:63], v[52:55], v[96:111]
v_mfma_f32_32x32x16_bf16 v[112:127], v[60:63], v[56:59], v[112:127]
s_waitcnt lgkmcnt(2)
v_mfma_f32_32x32x16_bf16 v[64:79], v[32:35], v[36:39], v[64:79]
ds_read_b128 v[48:51], v131 offset:0
ds_read_b128 v[52:55], v135 offset:0
s_waitcnt lgkmcnt(3)
v_mfma_f32_32x32x16_bf16 v[80:95], v[32:35], v[40:43], v[80:95]
ds_read_b128 v[56:59], v135 offset:4096
ds_read_b128 v[60:63], v131 offset:4096
s_waitcnt lgkmcnt(4)
v_mfma_f32_32x32x16_bf16 v[96:111], v[44:47], v[36:39], v[96:111]
v_mfma_f32_32x32x16_bf16 v[112:127], v[44:47], v[40:43], v[112:127]
s_waitcnt lgkmcnt(0)
s_barrier
v_mfma_f32_32x32x16_bf16 v[64:79], v[48:51], v[52:55], v[64:79]
ds_read_b128 v[32:35], v128 offset:32768
ds_read_b128 v[36:39], v132 offset:32768
v_mfma_f32_32x32x16_bf16 v[80:95], v[48:51], v[56:59], v[80:95]
ds_read_b128 v[40:43], v132 offset:36864
ds_read_b128 v[44:47], v128 offset:36864
v_mfma_f32_32x32x16_bf16 v[96:111], v[60:63], v[52:55], v[96:111]
v_mfma_f32_32x32x16_bf16 v[112:127], v[60:63], v[56:59], v[112:127]
s_waitcnt lgkmcnt(2)
v_mfma_f32_32x32x16_bf16 v[64:79], v[32:35], v[36:39], v[64:79]
ds_read_b128 v[48:51], v129 offset:32768
ds_read_b128 v[52:55], v133 offset:32768
s_waitcnt lgkmcnt(3)
v_mfma_f32_32x32x16_bf16 v[80:95], v[32:35], v[40:43], v[80:95]
ds_read_b128 v[56:59], v133 offset:36864
ds_read_b128 v[60:63], v129 offset:36864
s_waitcnt lgkmcnt(4)
v_mfma_f32_32x32x16_bf16 v[96:111], v[44:47], v[36:39], v[96:111]
v_mfma_f32_32x32x16_bf16 v[112:127], v[44:47], v[40:43], v[112:127]
s_waitcnt lgkmcnt(2)
v_mfma_f32_32x32x16_bf16 v[64:79], v[48:51], v[52:55], v[64:79]
ds_read_b128 v[32:35], v130 offset:32768
ds_read_b128 v[36:39], v134 offset:32768
s_waitcnt lgkmcnt(3)
v_mfma_f32_32x32x16_bf16 v[80:95], v[48:51], v[56:59], v[80:95]
ds_read_b128 v[40:43], v134 offset:36864
ds_read_b128 v[44:47], v130 offset:36864
s_waitcnt lgkmcnt(4)
v_mfma_f32_32x32x16_bf16 v[96:111], v[60:63], v[52:55], v[96:111]
v_mfma_f32_32x32x16_bf16 v[112:127], v[60:63], v[56:59], v[112:127]
s_waitcnt lgkmcnt(2)
v_mfma_f32_32x32x16_bf16 v[64:79], v[32:35], v[36:39], v[64:79]
ds_read_b128 v[48:51], v131 offset:32768
ds_read_b128 v[52:55], v135 offset:32768
s_waitcnt lgkmcnt(3)
v_mfma_f32_32x32x16_bf16 v[80:95], v[32:35], v[40:43], v[80:95]
ds_read_b128 v[56:59], v135 offset:36864
ds_read_b128 v[60:63], v131 offset:36864
s_waitcnt lgkmcnt(4)
v_mfma_f32_32x32x16_bf16 v[96:111], v[44:47], v[36:39], v[96:111]
v_mfma_f32_32x32x16_bf16 v[112:127], v[44:47], v[40:43], v[112:127]
s_waitcnt lgkmcnt(0)
s_barrier
v_mfma_f32_32x32x16_bf16 v[64:79], v[48:51], v[52:55], v[64:79]
ds_read_b128 v[32:35], v136 offset:0
ds_read_b128 v[36:39], v140 offset:0
v_mfma_f32_32x32x16_bf16 v[80:95], v[48:51], v[56:59], v[80:95]
ds_read_b128 v[40:43], v140 offset:4096
ds_read_b128 v[44:47], v136 offset:4096
v_mfma_f32_32x32x16_bf16 v[96:111], v[60:63], v[52:55], v[96:111]
v_mfma_f32_32x32x16_bf16 v[112:127], v[60:63], v[56:59], v[112:127]
s_waitcnt lgkmcnt(2)
v_mfma_f32_32x32x16_bf16 v[64:79], v[32:35], v[36:39], v[64:79]
ds_read_b128 v[48:51], v137 offset:0
ds_read_b128 v[52:55], v141 offset:0
s_waitcnt lgkmcnt(3)
v_mfma_f32_32x32x16_bf16 v[80:95], v[32:35], v[40:43], v[80:95]
ds_read_b128 v[56:59], v141 offset:4096
ds_read_b128 v[60:63], v137 offset:4096
s_waitcnt lgkmcnt(4)
v_mfma_f32_32x32x16_bf16 v[96:111], v[44:47], v[36:39], v[96:111]
v_mfma_f32_32x32x16_bf16 v[112:127], v[44:47], v[40:43], v[112:127]
s_waitcnt lgkmcnt(2)
v_mfma_f32_32x32x16_bf16 v[64:79], v[48:51], v[52:55], v[64:79]
ds_read_b128 v[32:35], v138 offset:0
ds_read_b128 v[36:39], v142 offset:0
s_waitcnt lgkmcnt(3)
v_mfma_f32_32x32x16_bf16 v[80:95], v[48:51], v[56:59], v[80:95]
ds_read_b128 v[40:43], v142 offset:4096
ds_read_b128 v[44:47], v138 offset:4096
s_waitcnt lgkmcnt(4)
v_mfma_f32_32x32x16_bf16 v[96:111], v[60:63], v[52:55], v[96:111]
v_mfma_f32_32x32x16_bf16 v[112:127], v[60:63], v[56:59], v[112:127]
s_waitcnt lgkmcnt(2)
v_mfma_f32_32x32x16_bf16 v[64:79], v[32:35], v[36:39], v[64:79]
ds_read_b128 v[48:51], v139 offset:0
ds_read_b128 v[52:55], v143 offset:0
s_waitcnt lgkmcnt(3)
v_mfma_f32_32x32x16_bf16 v[80:95], v[32:35], v[40:43], v[80:95]
ds_read_b128 v[56:59], v143 offset:4096
ds_read_b128 v[60:63], v139 offset:4096
s_waitcnt lgkmcnt(4)
v_mfma_f32_32x32x16_bf16 v[96:111], v[44:47], v[36:39], v[96:111]
v_mfma_f32_32x32x16_bf16 v[112:127], v[44:47], v[40:43], v[112:127]
s_waitcnt lgkmcnt(0)
s_barrier
v_mfma_f32_32x32x16_bf16 v[64:79], v[48:51], v[52:55], v[64:79]
ds_read_b128 v[32:35], v128 offset:0
ds_read_b128 v[36:39], v132 offset:0
v_mfma_f32_32x32x16_bf16 v[80:95], v[48:51], v[56:59], v[80:95]
ds_read_b128 v[40:43], v132 offset:4096
ds_read_b128 v[44:47], v128 offset:4096
v_mfma_f32_32x32x16_bf16 v[96:111], v[60:63], v[52:55], v[96:111]
v_mfma_f32_32x32x16_bf16 v[112:127], v[60:63], v[56:59], v[112:127]
s_waitcnt lgkmcnt(2)
v_mfma_f32_32x32x16_bf16 v[64:79], v[32:35], v[36:39], v[64:79]
ds_read_b128 v[48:51], v129 offset:0
ds_read_b128 v[52:55], v133 offset:0
s_waitcnt lgkmcnt(3)
v_mfma_f32_32x32x16_bf16 v[80:95], v[32:35], v[40:43], v[80:95]
ds_read_b128 v[56:59], v133 offset:4096
ds_read_b128 v[60:63], v129 offset:4096
s_waitcnt lgkmcnt(4)
v_mfma_f32_32x32x16_bf16 v[96:111], v[44:47], v[36:39], v[96:111]
v_mfma_f32_32x32x16_bf16 v[112:127], v[44:47], v[40:43], v[112:127]
s_waitcnt lgkmcnt(2)
v_mfma_f32_32x32x16_bf16 v[64:79], v[48:51], v[52:55], v[64:79]
ds_read_b128 v[32:35], v130 offset:0
ds_read_b128 v[36:39], v134 offset:0
s_waitcnt lgkmcnt(3)
v_mfma_f32_32x32x16_bf16 v[80:95], v[48:51], v[56:59], v[80:95]
ds_read_b128 v[40:43], v134 offset:4096
ds_read_b128 v[44:47], v130 offset:4096
s_waitcnt lgkmcnt(4)
v_mfma_f32_32x32x16_bf16 v[96:111], v[60:63], v[52:55], v[96:111]
v_mfma_f32_32x32x16_bf16 v[112:127], v[60:63], v[56:59], v[112:127]
s_waitcnt lgkmcnt(2)
v_mfma_f32_32x32x16_bf16 v[64:79], v[32:35], v[36:39], v[64:79]
ds_read_b128 v[48:51], v131 offset:0
ds_read_b128 v[52:55], v135 offset:0
s_waitcnt lgkmcnt(3)
v_mfma_f32_32x32x16_bf16 v[80:95], v[32:35], v[40:43], v[80:95]
ds_read_b128 v[56:59], v135 offset:4096
ds_read_b128 v[60:63], v131 offset:4096
s_waitcnt lgkmcnt(4)
v_mfma_f32_32x32x16_bf16 v[96:111], v[44:47], v[36:39], v[96:111]
v_mfma_f32_32x32x16_bf16 v[112:127], v[44:47], v[40:43], v[112:127]
s_waitcnt lgkmcnt(0)
s_barrier
v_mfma_f32_32x32x16_bf16 v[64:79], v[48:51], v[52:55], v[64:79]
ds_read_b128 v[32:35], v128 offset:32768
ds_read_b128 v[36:39], v132 offset:32768
v_mfma_f32_32x32x16_bf16 v[80:95], v[48:51], v[56:59], v[80:95]
ds_read_b128 v[40:43], v132 offset:36864
ds_read_b128 v[44:47], v128 offset:36864
v_mfma_f32_32x32x16_bf16 v[96:111], v[60:63], v[52:55], v[96:111]
v_mfma_f32_32x32x16_bf16 v[112:127], v[60:63], v[56:59], v[112:127]
s_waitcnt lgkmcnt(2)
v_mfma_f32_32x32x16_bf16 v[64:79], v[32:35], v[36:39], v[64:79]
ds_read_b128 v[48:51], v129 offset:32768
ds_read_b128 v[52:55], v133 offset:32768
s_waitcnt lgkmcnt(3)
v_mfma_f32_32x32x16_bf16 v[80:95], v[32:35], v[40:43], v[80:95]
ds_read_b128 v[56:59], v133 offset:36864
ds_read_b128 v[60:63], v129 offset:36864
s_waitcnt lgkmcnt(4)
v_mfma_f32_32x32x16_bf16 v[96:111], v[44:47], v[36:39], v[96:111]
v_mfma_f32_32x32x16_bf16 v[112:127], v[44:47], v[40:43], v[112:127]
s_waitcnt lgkmcnt(2)
v_mfma_f32_32x32x16_bf16 v[64:79], v[48:51], v[52:55], v[64:79]
ds_read_b128 v[32:35], v130 offset:32768
ds_read_b128 v[36:39], v134 offset:32768
s_waitcnt lgkmcnt(3)
v_mfma_f32_32x32x16_bf16 v[80:95], v[48:51], v[56:59], v[80:95]
ds_read_b128 v[40:43], v134 offset:36864
ds_read_b128 v[44:47], v130 offset:36864
s_waitcnt lgkmcnt(4)
v_mfma_f32_32x32x16_bf16 v[96:111], v[60:63], v[52:55], v[96:111]
v_mfma_f32_32x32x16_bf16 v[112:127], v[60:63], v[56:59], v[112:127]
s_waitcnt lgkmcnt(2)
v_mfma_f32_32x32x16_bf16 v[64:79], v[32:35], v[36:39], v[64:79]
ds_read_b128 v[48:51], v131 offset:32768
ds_read_b128 v[52:55], v135 offset:32768
s_waitcnt lgkmcnt(3)
v_mfma_f32_32x32x16_bf16 v[80:95], v[32:35], v[40:43], v[80:95]
ds_read_b128 v[56:59], v135 offset:36864
ds_read_b128 v[60:63], v131 offset:36864
s_waitcnt lgkmcnt(4)
v_mfma_f32_32x32x16_bf16 v[96:111], v[44:47], v[36:39], v[96:111]
v_mfma_f32_32x32x16_bf16 v[112:127], v[44:47], v[40:43], v[112:127]
s_waitcnt lgkmcnt(0)
s_barrier
v_mfma_f32_32x32x16_bf16 v[64:79], v[48:51], v[52:55], v[64:79]
ds_read_b128 v[32:35], v136 offset:0
ds_read_b128 v[36:39], v140 offset:0
v_mfma_f32_32x32x16_bf16 v[80:95], v[48:51], v[56:59], v[80:95]
ds_read_b128 v[40:43], v140 offset:4096
ds_read_b128 v[44:47], v136 offset:4096
v_mfma_f32_32x32x16_bf16 v[96:111], v[60:63], v[52:55], v[96:111]
v_mfma_f32_32x32x16_bf16 v[112:127], v[60:63], v[56:59], v[112:127]
s_waitcnt lgkmcnt(2)
v_mfma_f32_32x32x16_bf16 v[64:79], v[32:35], v[36:39], v[64:79]
ds_read_b128 v[48:51], v137 offset:0
ds_read_b128 v[52:55], v141 offset:0
s_waitcnt lgkmcnt(3)
v_mfma_f32_32x32x16_bf16 v[80:95], v[32:35], v[40:43], v[80:95]
ds_read_b128 v[56:59], v141 offset:4096
ds_read_b128 v[60:63], v137 offset:4096
s_waitcnt lgkmcnt(4)
v_mfma_f32_32x32x16_bf16 v[96:111], v[44:47], v[36:39], v[96:111]
v_mfma_f32_32x32x16_bf16 v[112:127], v[44:47], v[40:43], v[112:127]
s_waitcnt lgkmcnt(2)
v_mfma_f32_32x32x16_bf16 v[64:79], v[48:51], v[52:55], v[64:79]
ds_read_b128 v[32:35], v138 offset:0
ds_read_b128 v[36:39], v142 offset:0
s_waitcnt lgkmcnt(3)
v_mfma_f32_32x32x16_bf16 v[80:95], v[48:51], v[56:59], v[80:95]
ds_read_b128 v[40:43], v142 offset:4096
ds_read_b128 v[44:47], v138 offset:4096
s_waitcnt lgkmcnt(4)
v_mfma_f32_32x32x16_bf16 v[96:111], v[60:63], v[52:55], v[96:111]
v_mfma_f32_32x32x16_bf16 v[112:127], v[60:63], v[56:59], v[112:127]
s_waitcnt lgkmcnt(2)
v_mfma_f32_32x32x16_bf16 v[64:79], v[32:35], v[36:39], v[64:79]
ds_read_b128 v[48:51], v139 offset:0
ds_read_b128 v[52:55], v143 offset:0
s_waitcnt lgkmcnt(3)
v_mfma_f32_32x32x16_bf16 v[80:95], v[32:35], v[40:43], v[80:95]
ds_read_b128 v[56:59], v143 offset:4096
ds_read_b128 v[60:63], v139 offset:4096
s_waitcnt lgkmcnt(4)
v_mfma_f32_32x32x16_bf16 v[96:111], v[44:47], v[36:39], v[96:111]
v_mfma_f32_32x32x16_bf16 v[112:127], v[44:47], v[40:43], v[112:127]
s_waitcnt lgkmcnt(0)
s_barrier
v_mfma_f32_32x32x16_bf16 v[64:79], v[48:51], v[52:55], v[64:79]
ds_read_b128 v[32:35], v128 offset:0
ds_read_b128 v[36:39], v132 offset:0
v_mfma_f32_32x32x16_bf16 v[80:95], v[48:51], v[56:59], v[80:95]
ds_read_b128 v[40:43], v132 offset:4096
ds_read_b128 v[44:47], v128 offset:4096
v_mfma_f32_32x32x16_bf16 v[96:111], v[60:63], v[52:55], v[96:111]
v_mfma_f32_32x32x16_bf16 v[112:127], v[60:63], v[56:59], v[112:127]
s_waitcnt lgkmcnt(2)
v_mfma_f32_32x32x16_bf16 v[64:79], v[32:35], v[36:39], v[64:79]
ds_read_b128 v[48:51], v129 offset:0
ds_read_b128 v[52:55], v133 offset:0
s_waitcnt lgkmcnt(3)
v_mfma_f32_32x32x16_bf16 v[80:95], v[32:35], v[40:43], v[80:95]
ds_read_b128 v[56:59], v133 offset:4096
ds_read_b128 v[60:63], v129 offset:4096
s_waitcnt lgkmcnt(4)
v_mfma_f32_32x32x16_bf16 v[96:111], v[44:47], v[36:39], v[96:111]
v_mfma_f32_32x32x16_bf16 v[112:127], v[44:47], v[40:43], v[112:127]
s_waitcnt lgkmcnt(2)
v_mfma_f32_32x32x16_bf16 v[64:79], v[48:51], v[52:55], v[64:79]
ds_read_b128 v[32:35], v130 offset:0
ds_read_b128 v[36:39], v134 offset:0
s_waitcnt lgkmcnt(3)
v_mfma_f32_32x32x16_bf16 v[80:95], v[48:51], v[56:59], v[80:95]
ds_read_b128 v[40:43], v134 offset:4096
ds_read_b128 v[44:47], v130 offset:4096
s_waitcnt lgkmcnt(4)
v_mfma_f32_32x32x16_bf16 v[96:111], v[60:63], v[52:55], v[96:111]
v_mfma_f32_32x32x16_bf16 v[112:127], v[60:63], v[56:59], v[112:127]
s_waitcnt lgkmcnt(2)
v_mfma_f32_32x32x16_bf16 v[64:79], v[32:35], v[36:39], v[64:79]
ds_read_b128 v[48:51], v131 offset:0
ds_read_b128 v[52:55], v135 offset:0
s_waitcnt lgkmcnt(3)
v_mfma_f32_32x32x16_bf16 v[80:95], v[32:35], v[40:43], v[80:95]
ds_read_b128 v[56:59], v135 offset:4096
ds_read_b128 v[60:63], v131 offset:4096
s_waitcnt lgkmcnt(4)
v_mfma_f32_32x32x16_bf16 v[96:111], v[44:47], v[36:39], v[96:111]
v_mfma_f32_32x32x16_bf16 v[112:127], v[44:47], v[40:43], v[112:127]
s_waitcnt lgkmcnt(0)
s_barrier
v_mfma_f32_32x32x16_bf16 v[64:79], v[48:51], v[52:55], v[64:79]
ds_read_b128 v[32:35], v128 offset:32768
ds_read_b128 v[36:39], v132 offset:32768
v_mfma_f32_32x32x16_bf16 v[80:95], v[48:51], v[56:59], v[80:95]
ds_read_b128 v[40:43], v132 offset:36864
ds_read_b128 v[44:47], v128 offset:36864
v_mfma_f32_32x32x16_bf16 v[96:111], v[60:63], v[52:55], v[96:111]
v_mfma_f32_32x32x16_bf16 v[112:127], v[60:63], v[56:59], v[112:127]
s_waitcnt lgkmcnt(2)
v_mfma_f32_32x32x16_bf16 v[64:79], v[32:35], v[36:39], v[64:79]
ds_read_b128 v[48:51], v129 offset:32768
ds_read_b128 v[52:55], v133 offset:32768
s_waitcnt lgkmcnt(3)
v_mfma_f32_32x32x16_bf16 v[80:95], v[32:35], v[40:43], v[80:95]
ds_read_b128 v[56:59], v133 offset:36864
ds_read_b128 v[60:63], v129 offset:36864
s_waitcnt lgkmcnt(4)
v_mfma_f32_32x32x16_bf16 v[96:111], v[44:47], v[36:39], v[96:111]
v_mfma_f32_32x32x16_bf16 v[112:127], v[44:47], v[40:43], v[112:127]
s_waitcnt lgkmcnt(2)
v_mfma_f32_32x32x16_bf16 v[64:79], v[48:51], v[52:55], v[64:79]
ds_read_b128 v[32:35], v130 offset:32768
ds_read_b128 v[36:39], v134 offset:32768
s_waitcnt lgkmcnt(3)
v_mfma_f32_32x32x16_bf16 v[80:95], v[48:51], v[56:59], v[80:95]
ds_read_b128 v[40:43], v134 offset:36864
ds_read_b128 v[44:47], v130 offset:36864
s_waitcnt lgkmcnt(4)
v_mfma_f32_32x32x16_bf16 v[96:111], v[60:63], v[52:55], v[96:111]
v_mfma_f32_32x32x16_bf16 v[112:127], v[60:63], v[56:59], v[112:127]
s_waitcnt lgkmcnt(2)
v_mfma_f32_32x32x16_bf16 v[64:79], v[32:35], v[36:39], v[64:79]
ds_read_b128 v[48:51], v131 offset:32768
ds_read_b128 v[52:55], v135 offset:32768
s_waitcnt lgkmcnt(3)
v_mfma_f32_32x32x16_bf16 v[80:95], v[32:35], v[40:43], v[80:95]
ds_read_b128 v[56:59], v135 offset:36864
ds_read_b128 v[60:63], v131 offset:36864
s_waitcnt lgkmcnt(4)
v_mfma_f32_32x32x16_bf16 v[96:111], v[44:47], v[36:39], v[96:111]
v_mfma_f32_32x32x16_bf16 v[112:127], v[44:47], v[40:43], v[112:127]
s_waitcnt lgkmcnt(0)
s_barrier
v_mfma_f32_32x32x16_bf16 v[64:79], v[48:51], v[52:55], v[64:79]
ds_read_b128 v[32:35], v136 offset:0
ds_read_b128 v[36:39], v140 offset:0
v_mfma_f32_32x32x16_bf16 v[80:95], v[48:51], v[56:59], v[80:95]
ds_read_b128 v[40:43], v140 offset:4096
ds_read_b128 v[44:47], v136 offset:4096
v_mfma_f32_32x32x16_bf16 v[96:111], v[60:63], v[52:55], v[96:111]
v_mfma_f32_32x32x16_bf16 v[112:127], v[60:63], v[56:59], v[112:127]
s_waitcnt lgkmcnt(2)
v_mfma_f32_32x32x16_bf16 v[64:79], v[32:35], v[36:39], v[64:79]
ds_read_b128 v[48:51], v137 offset:0
ds_read_b128 v[52:55], v141 offset:0
s_waitcnt lgkmcnt(3)
v_mfma_f32_32x32x16_bf16 v[80:95], v[32:35], v[40:43], v[80:95]
ds_read_b128 v[56:59], v141 offset:4096
ds_read_b128 v[60:63], v137 offset:4096
s_waitcnt lgkmcnt(4)
v_mfma_f32_32x32x16_bf16 v[96:111], v[44:47], v[36:39], v[96:111]
v_mfma_f32_32x32x16_bf16 v[112:127], v[44:47], v[40:43], v[112:127]
s_waitcnt lgkmcnt(2)
v_mfma_f32_32x32x16_bf16 v[64:79], v[48:51], v[52:55], v[64:79]
ds_read_b128 v[32:35], v138 offset:0
ds_read_b128 v[36:39], v142 offset:0
s_waitcnt lgkmcnt(3)
v_mfma_f32_32x32x16_bf16 v[80:95], v[48:51], v[56:59], v[80:95]
ds_read_b128 v[40:43], v142 offset:4096
ds_read_b128 v[44:47], v138 offset:4096
s_waitcnt lgkmcnt(4)
v_mfma_f32_32x32x16_bf16 v[96:111], v[60:63], v[52:55], v[96:111]
v_mfma_f32_32x32x16_bf16 v[112:127], v[60:63], v[56:59], v[112:127]
s_waitcnt lgkmcnt(2)
v_mfma_f32_32x32x16_bf16 v[64:79], v[32:35], v[36:39], v[64:79]
ds_read_b128 v[48:51], v139 offset:0
ds_read_b128 v[52:55], v143 offset:0
s_waitcnt lgkmcnt(3)
v_mfma_f32_32x32x16_bf16 v[80:95], v[32:35], v[40:43], v[80:95]
ds_read_b128 v[56:59], v143 offset:4096
ds_read_b128 v[60:63], v139 offset:4096
s_waitcnt lgkmcnt(4)
v_mfma_f32_32x32x16_bf16 v[96:111], v[44:47], v[36:39], v[96:111]
v_mfma_f32_32x32x16_bf16 v[112:127], v[44:47], v[40:43], v[112:127]
s_waitcnt lgkmcnt(0)
s_barrier
v_mfma_f32_32x32x16_bf16 v[64:79], v[48:51], v[52:55], v[64:79]
ds_read_b128 v[32:35], v128 offset:0
ds_read_b128 v[36:39], v132 offset:0
v_mfma_f32_32x32x16_bf16 v[80:95], v[48:51], v[56:59], v[80:95]
ds_read_b128 v[40:43], v132 offset:4096
ds_read_b128 v[44:47], v128 offset:4096
v_mfma_f32_32x32x16_bf16 v[96:111], v[60:63], v[52:55], v[96:111]
v_mfma_f32_32x32x16_bf16 v[112:127], v[60:63], v[56:59], v[112:127]
s_waitcnt lgkmcnt(2)
v_mfma_f32_32x32x16_bf16 v[64:79], v[32:35], v[36:39], v[64:79]
ds_read_b128 v[48:51], v129 offset:0
ds_read_b128 v[52:55], v133 offset:0
s_waitcnt lgkmcnt(3)
v_mfma_f32_32x32x16_bf16 v[80:95], v[32:35], v[40:43], v[80:95]
ds_read_b128 v[56:59], v133 offset:4096
ds_read_b128 v[60:63], v129 offset:4096
s_waitcnt lgkmcnt(4)
v_mfma_f32_32x32x16_bf16 v[96:111], v[44:47], v[36:39], v[96:111]
v_mfma_f32_32x32x16_bf16 v[112:127], v[44:47], v[40:43], v[112:127]
s_waitcnt lgkmcnt(2)
v_mfma_f32_32x32x16_bf16 v[64:79], v[48:51], v[52:55], v[64:79]
ds_read_b128 v[32:35], v130 offset:0
ds_read_b128 v[36:39], v134 offset:0
s_waitcnt lgkmcnt(3)
v_mfma_f32_32x32x16_bf16 v[80:95], v[48:51], v[56:59], v[80:95]
ds_read_b128 v[40:43], v134 offset:4096
ds_read_b128 v[44:47], v130 offset:4096
s_waitcnt lgkmcnt(4)
v_mfma_f32_32x32x16_bf16 v[96:111], v[60:63], v[52:55], v[96:111]
v_mfma_f32_32x32x16_bf16 v[112:127], v[60:63], v[56:59], v[112:127]
s_waitcnt lgkmcnt(2)
v_mfma_f32_32x32x16_bf16 v[64:79], v[32:35], v[36:39], v[64:79]
ds_read_b128 v[48:51], v131 offset:0
ds_read_b128 v[52:55], v135 offset:0
s_waitcnt lgkmcnt(3)
v_mfma_f32_32x32x16_bf16 v[80:95], v[32:35], v[40:43], v[80:95]
ds_read_b128 v[56:59], v135 offset:4096
ds_read_b128 v[60:63], v131 offset:4096
s_waitcnt lgkmcnt(4)
v_mfma_f32_32x32x16_bf16 v[96:111], v[44:47], v[36:39], v[96:111]
v_mfma_f32_32x32x16_bf16 v[112:127], v[44:47], v[40:43], v[112:127]
s_waitcnt lgkmcnt(0)
s_barrier
v_mfma_f32_32x32x16_bf16 v[64:79], v[48:51], v[52:55], v[64:79]
ds_read_b128 v[32:35], v128 offset:32768
ds_read_b128 v[36:39], v132 offset:32768
v_mfma_f32_32x32x16_bf16 v[80:95], v[48:51], v[56:59], v[80:95]
ds_read_b128 v[40:43], v132 offset:36864
ds_read_b128 v[44:47], v128 offset:36864
v_mfma_f32_32x32x16_bf16 v[96:111], v[60:63], v[52:55], v[96:111]
v_mfma_f32_32x32x16_bf16 v[112:127], v[60:63], v[56:59], v[112:127]
s_waitcnt lgkmcnt(2)
v_mfma_f32_32x32x16_bf16 v[64:79], v[32:35], v[36:39], v[64:79]
ds_read_b128 v[48:51], v129 offset:32768
ds_read_b128 v[52:55], v133 offset:32768
s_waitcnt lgkmcnt(3)
v_mfma_f32_32x32x16_bf16 v[80:95], v[32:35], v[40:43], v[80:95]
ds_read_b128 v[56:59], v133 offset:36864
ds_read_b128 v[60:63], v129 offset:36864
s_waitcnt lgkmcnt(4)
v_mfma_f32_32x32x16_bf16 v[96:111], v[44:47], v[36:39], v[96:111]
v_mfma_f32_32x32x16_bf16 v[112:127], v[44:47], v[40:43], v[112:127]
s_waitcnt lgkmcnt(2)
v_mfma_f32_32x32x16_bf16 v[64:79], v[48:51], v[52:55], v[64:79]
ds_read_b128 v[32:35], v130 offset:32768
ds_read_b128 v[36:39], v134 offset:32768
s_waitcnt lgkmcnt(3)
v_mfma_f32_32x32x16_bf16 v[80:95], v[48:51], v[56:59], v[80:95]
ds_read_b128 v[40:43], v134 offset:36864
ds_read_b128 v[44:47], v130 offset:36864
s_waitcnt lgkmcnt(4)
v_mfma_f32_32x32x16_bf16 v[96:111], v[60:63], v[52:55], v[96:111]
v_mfma_f32_32x32x16_bf16 v[112:127], v[60:63], v[56:59], v[112:127]
s_waitcnt lgkmcnt(2)
v_mfma_f32_32x32x16_bf16 v[64:79], v[32:35], v[36:39], v[64:79]
ds_read_b128 v[48:51], v131 offset:32768
ds_read_b128 v[52:55], v135 offset:32768
s_waitcnt lgkmcnt(3)
v_mfma_f32_32x32x16_bf16 v[80:95], v[32:35], v[40:43], v[80:95]
ds_read_b128 v[56:59], v135 offset:36864
ds_read_b128 v[60:63], v131 offset:36864
s_waitcnt lgkmcnt(4)
v_mfma_f32_32x32x16_bf16 v[96:111], v[44:47], v[36:39], v[96:111]
v_mfma_f32_32x32x16_bf16 v[112:127], v[44:47], v[40:43], v[112:127]
s_waitcnt lgkmcnt(0)
s_barrier
v_mfma_f32_32x32x16_bf16 v[64:79], v[48:51], v[52:55], v[64:79]
ds_read_b128 v[32:35], v136 offset:0
ds_read_b128 v[36:39], v140 offset:0
v_mfma_f32_32x32x16_bf16 v[80:95], v[48:51], v[56:59], v[80:95]
ds_read_b128 v[40:43], v140 offset:4096
ds_read_b128 v[44:47], v136 offset:4096
v_mfma_f32_32x32x16_bf16 v[96:111], v[60:63], v[52:55], v[96:111]
v_mfma_f32_32x32x16_bf16 v[112:127], v[60:63], v[56:59], v[112:127]
s_waitcnt lgkmcnt(2)
v_mfma_f32_32x32x16_bf16 v[64:79], v[32:35], v[36:39], v[64:79]
ds_read_b128 v[48:51], v137 offset:0
ds_read_b128 v[52:55], v141 offset:0
s_waitcnt lgkmcnt(3)
v_mfma_f32_32x32x16_bf16 v[80:95], v[32:35], v[40:43], v[80:95]
ds_read_b128 v[56:59], v141 offset:4096
ds_read_b128 v[60:63], v137 offset:4096
s_waitcnt lgkmcnt(4)
v_mfma_f32_32x32x16_bf16 v[96:111], v[44:47], v[36:39], v[96:111]
v_mfma_f32_32x32x16_bf16 v[112:127], v[44:47], v[40:43], v[112:127]
s_waitcnt lgkmcnt(2)
v_mfma_f32_32x32x16_bf16 v[64:79], v[48:51], v[52:55], v[64:79]
ds_read_b128 v[32:35], v138 offset:0
ds_read_b128 v[36:39], v142 offset:0
s_waitcnt lgkmcnt(3)
v_mfma_f32_32x32x16_bf16 v[80:95], v[48:51], v[56:59], v[80:95]
ds_read_b128 v[40:43], v142 offset:4096
ds_read_b128 v[44:47], v138 offset:4096
s_waitcnt lgkmcnt(4)
v_mfma_f32_32x32x16_bf16 v[96:111], v[60:63], v[52:55], v[96:111]
v_mfma_f32_32x32x16_bf16 v[112:127], v[60:63], v[56:59], v[112:127]
s_waitcnt lgkmcnt(2)
v_mfma_f32_32x32x16_bf16 v[64:79], v[32:35], v[36:39], v[64:79]
ds_read_b128 v[48:51], v139 offset:0
ds_read_b128 v[52:55], v143 offset:0
s_waitcnt lgkmcnt(3)
v_mfma_f32_32x32x16_bf16 v[80:95], v[32:35], v[40:43], v[80:95]
ds_read_b128 v[56:59], v143 offset:4096
ds_read_b128 v[60:63], v139 offset:4096
s_waitcnt lgkmcnt(4)
v_mfma_f32_32x32x16_bf16 v[96:111], v[44:47], v[36:39], v[96:111]
v_mfma_f32_32x32x16_bf16 v[112:127], v[44:47], v[40:43], v[112:127]
s_waitcnt lgkmcnt(0)
s_barrier
v_mfma_f32_32x32x16_bf16 v[64:79], v[48:51], v[52:55], v[64:79]
ds_read_b128 v[32:35], v128 offset:0
ds_read_b128 v[36:39], v132 offset:0
v_mfma_f32_32x32x16_bf16 v[80:95], v[48:51], v[56:59], v[80:95]
ds_read_b128 v[40:43], v132 offset:4096
ds_read_b128 v[44:47], v128 offset:4096
v_mfma_f32_32x32x16_bf16 v[96:111], v[60:63], v[52:55], v[96:111]
v_mfma_f32_32x32x16_bf16 v[112:127], v[60:63], v[56:59], v[112:127]
s_waitcnt lgkmcnt(2)
v_mov_b32 v12, 0
global_load_dword v13, v12, s[30:31] sc1
v_mfma_f32_32x32x16_bf16 v[64:79], v[32:35], v[36:39], v[64:79]
ds_read_b128 v[48:51], v129 offset:0
ds_read_b128 v[52:55], v133 offset:0
s_waitcnt lgkmcnt(3)
v_mfma_f32_32x32x16_bf16 v[80:95], v[32:35], v[40:43], v[80:95]
ds_read_b128 v[56:59], v133 offset:4096
ds_read_b128 v[60:63], v129 offset:4096
s_waitcnt lgkmcnt(4)
v_mfma_f32_32x32x16_bf16 v[96:111], v[44:47], v[36:39], v[96:111]
v_mfma_f32_32x32x16_bf16 v[112:127], v[44:47], v[40:43], v[112:127]
s_waitcnt lgkmcnt(2)
v_mfma_f32_32x32x16_bf16 v[64:79], v[48:51], v[52:55], v[64:79]
ds_read_b128 v[32:35], v130 offset:0
ds_read_b128 v[36:39], v134 offset:0
s_waitcnt lgkmcnt(3)
v_mfma_f32_32x32x16_bf16 v[80:95], v[48:51], v[56:59], v[80:95]
ds_read_b128 v[40:43], v134 offset:4096
ds_read_b128 v[44:47], v130 offset:4096
s_waitcnt lgkmcnt(4)
v_mfma_f32_32x32x16_bf16 v[96:111], v[60:63], v[52:55], v[96:111]
v_mfma_f32_32x32x16_bf16 v[112:127], v[60:63], v[56:59], v[112:127]
s_waitcnt lgkmcnt(2)
v_mfma_f32_32x32x16_bf16 v[64:79], v[32:35], v[36:39], v[64:79]
ds_read_b128 v[48:51], v131 offset:0
ds_read_b128 v[52:55], v135 offset:0
s_waitcnt lgkmcnt(3)
v_mfma_f32_32x32x16_bf16 v[80:95], v[32:35], v[40:43], v[80:95]
ds_read_b128 v[56:59], v135 offset:4096
ds_read_b128 v[60:63], v131 offset:4096
s_waitcnt lgkmcnt(4)
v_mfma_f32_32x32x16_bf16 v[96:111], v[44:47], v[36:39], v[96:111]
v_mfma_f32_32x32x16_bf16 v[112:127], v[44:47], v[40:43], v[112:127]
s_waitcnt lgkmcnt(0)
s_barrier
v_mfma_f32_32x32x16_bf16 v[64:79], v[48:51], v[52:55], v[64:79]
ds_read_b128 v[32:35], v128 offset:32768
ds_read_b128 v[36:39], v132 offset:32768
v_mfma_f32_32x32x16_bf16 v[80:95], v[48:51], v[56:59], v[80:95]
ds_read_b128 v[40:43], v132 offset:36864
ds_read_b128 v[44:47], v128 offset:36864
v_mfma_f32_32x32x16_bf16 v[96:111], v[60:63], v[52:55], v[96:111]
v_mfma_f32_32x32x16_bf16 v[112:127], v[60:63], v[56:59], v[112:127]
s_waitcnt lgkmcnt(2)
v_mfma_f32_32x32x16_bf16 v[64:79], v[32:35], v[36:39], v[64:79]
ds_read_b128 v[48:51], v129 offset:32768
ds_read_b128 v[52:55], v133 offset:32768
s_waitcnt lgkmcnt(3)
v_mfma_f32_32x32x16_bf16 v[80:95], v[32:35], v[40:43], v[80:95]
ds_read_b128 v[56:59], v133 offset:36864
ds_read_b128 v[60:63], v129 offset:36864
s_waitcnt lgkmcnt(4)
v_mfma_f32_32x32x16_bf16 v[96:111], v[44:47], v[36:39], v[96:111]
v_mfma_f32_32x32x16_bf16 v[112:127], v[44:47], v[40:43], v[112:127]
s_waitcnt lgkmcnt(2)
v_mfma_f32_32x32x16_bf16 v[64:79], v[48:51], v[52:55], v[64:79]
ds_read_b128 v[32:35], v130 offset:32768
ds_read_b128 v[36:39], v134 offset:32768
s_waitcnt lgkmcnt(3)
v_mfma_f32_32x32x16_bf16 v[80:95], v[48:51], v[56:59], v[80:95]
ds_read_b128 v[40:43], v134 offset:36864
ds_read_b128 v[44:47], v130 offset:36864
s_waitcnt lgkmcnt(4)
v_mfma_f32_32x32x16_bf16 v[96:111], v[60:63], v[52:55], v[96:111]
v_mfma_f32_32x32x16_bf16 v[112:127], v[60:63], v[56:59], v[112:127]
s_waitcnt lgkmcnt(2)
v_mfma_f32_32x32x16_bf16 v[64:79], v[32:35], v[36:39], v[64:79]
ds_read_b128 v[48:51], v131 offset:32768
ds_read_b128 v[52:55], v135 offset:32768
s_waitcnt lgkmcnt(3)
v_mfma_f32_32x32x16_bf16 v[80:95], v[32:35], v[40:43], v[80:95]
ds_read_b128 v[56:59], v135 offset:36864
ds_read_b128 v[60:63], v131 offset:36864
s_waitcnt lgkmcnt(4)
v_mfma_f32_32x32x16_bf16 v[96:111], v[44:47], v[36:39], v[96:111]
v_mfma_f32_32x32x16_bf16 v[112:127], v[44:47], v[40:43], v[112:127]
s_waitcnt lgkmcnt(0)
s_barrier
v_mfma_f32_32x32x16_bf16 v[64:79], v[48:51], v[52:55], v[64:79]
ds_read_b128 v[32:35], v136 offset:0
ds_read_b128 v[36:39], v140 offset:0
v_mfma_f32_32x32x16_bf16 v[80:95], v[48:51], v[56:59], v[80:95]
ds_read_b128 v[40:43], v140 offset:4096
ds_read_b128 v[44:47], v136 offset:4096
v_mfma_f32_32x32x16_bf16 v[96:111], v[60:63], v[52:55], v[96:111]
v_mfma_f32_32x32x16_bf16 v[112:127], v[60:63], v[56:59], v[112:127]
s_waitcnt lgkmcnt(2)
v_mfma_f32_32x32x16_bf16 v[64:79], v[32:35], v[36:39], v[64:79]
ds_read_b128 v[48:51], v137 offset:0
ds_read_b128 v[52:55], v141 offset:0
s_waitcnt lgkmcnt(3)
v_mfma_f32_32x32x16_bf16 v[80:95], v[32:35], v[40:43], v[80:95]
ds_read_b128 v[56:59], v141 offset:4096
ds_read_b128 v[60:63], v137 offset:4096
s_waitcnt lgkmcnt(4)
v_mfma_f32_32x32x16_bf16 v[96:111], v[44:47], v[36:39], v[96:111]
v_mfma_f32_32x32x16_bf16 v[112:127], v[44:47], v[40:43], v[112:127]
s_waitcnt lgkmcnt(2)
v_mfma_f32_32x32x16_bf16 v[64:79], v[48:51], v[52:55], v[64:79]
ds_read_b128 v[32:35], v138 offset:0
ds_read_b128 v[36:39], v142 offset:0
s_waitcnt lgkmcnt(3)
v_mfma_f32_32x32x16_bf16 v[80:95], v[48:51], v[56:59], v[80:95]
ds_read_b128 v[40:43], v142 offset:4096
ds_read_b128 v[44:47], v138 offset:4096
s_waitcnt lgkmcnt(4)
v_mfma_f32_32x32x16_bf16 v[96:111], v[60:63], v[52:55], v[96:111]
v_mfma_f32_32x32x16_bf16 v[112:127], v[60:63], v[56:59], v[112:127]
s_waitcnt lgkmcnt(2)
v_mfma_f32_32x32x16_bf16 v[64:79], v[32:35], v[36:39], v[64:79]
ds_read_b128 v[48:51], v139 offset:0
ds_read_b128 v[52:55], v143 offset:0
s_waitcnt lgkmcnt(3)
v_mfma_f32_32x32x16_bf16 v[80:95], v[32:35], v[40:43], v[80:95]
ds_read_b128 v[56:59], v143 offset:4096
ds_read_b128 v[60:63], v139 offset:4096
s_waitcnt lgkmcnt(4)
v_mfma_f32_32x32x16_bf16 v[96:111], v[44:47], v[36:39], v[96:111]
v_mfma_f32_32x32x16_bf16 v[112:127], v[44:47], v[40:43], v[112:127]
s_waitcnt lgkmcnt(0)
s_barrier
v_mfma_f32_32x32x16_bf16 v[64:79], v[48:51], v[52:55], v[64:79]
ds_read_b128 v[32:35], v128 offset:0
ds_read_b128 v[36:39], v132 offset:0
v_mfma_f32_32x32x16_bf16 v[80:95], v[48:51], v[56:59], v[80:95]
ds_read_b128 v[40:43], v132 offset:4096
ds_read_b128 v[44:47], v128 offset:4096
v_mfma_f32_32x32x16_bf16 v[96:111], v[60:63], v[52:55], v[96:111]
v_mfma_f32_32x32x16_bf16 v[112:127], v[60:63], v[56:59], v[112:127]
s_waitcnt lgkmcnt(2)
v_mfma_f32_32x32x16_bf16 v[64:79], v[32:35], v[36:39], v[64:79]
ds_read_b128 v[48:51], v129 offset:0
ds_read_b128 v[52:55], v133 offset:0
s_waitcnt lgkmcnt(3)
v_mfma_f32_32x32x16_bf16 v[80:95], v[32:35], v[40:43], v[80:95]
ds_read_b128 v[56:59], v133 offset:4096
ds_read_b128 v[60:63], v129 offset:4096
s_waitcnt lgkmcnt(4)
v_mfma_f32_32x32x16_bf16 v[96:111], v[44:47], v[36:39], v[96:111]
v_mfma_f32_32x32x16_bf16 v[112:127], v[44:47], v[40:43], v[112:127]
s_waitcnt lgkmcnt(2)
v_mfma_f32_32x32x16_bf16 v[64:79], v[48:51], v[52:55], v[64:79]
ds_read_b128 v[32:35], v130 offset:0
ds_read_b128 v[36:39], v134 offset:0
s_waitcnt lgkmcnt(3)
v_mfma_f32_32x32x16_bf16 v[80:95], v[48:51], v[56:59], v[80:95]
ds_read_b128 v[40:43], v134 offset:4096
ds_read_b128 v[44:47], v130 offset:4096
s_waitcnt lgkmcnt(4)
v_mfma_f32_32x32x16_bf16 v[96:111], v[60:63], v[52:55], v[96:111]
v_mfma_f32_32x32x16_bf16 v[112:127], v[60:63], v[56:59], v[112:127]
s_waitcnt lgkmcnt(2)
v_mfma_f32_32x32x16_bf16 v[64:79], v[32:35], v[36:39], v[64:79]
ds_read_b128 v[48:51], v131 offset:0
ds_read_b128 v[52:55], v135 offset:0
s_waitcnt lgkmcnt(3)
v_mfma_f32_32x32x16_bf16 v[80:95], v[32:35], v[40:43], v[80:95]
ds_read_b128 v[56:59], v135 offset:4096
ds_read_b128 v[60:63], v131 offset:4096
s_waitcnt lgkmcnt(4)
v_mfma_f32_32x32x16_bf16 v[96:111], v[44:47], v[36:39], v[96:111]
v_mfma_f32_32x32x16_bf16 v[112:127], v[44:47], v[40:43], v[112:127]
s_waitcnt lgkmcnt(0)
s_barrier
v_mfma_f32_32x32x16_bf16 v[64:79], v[48:51], v[52:55], v[64:79]
v_mfma_f32_32x32x16_bf16 v[80:95], v[48:51], v[56:59], v[80:95]
v_mfma_f32_32x32x16_bf16 v[96:111], v[60:63], v[52:55], v[96:111]
v_mfma_f32_32x32x16_bf16 v[112:127], v[60:63], v[56:59], v[112:127]
s_lshl_b32 s60, s66, 10
s_add_u32 s60, s60, 122880
s_lshl_b32 s61, s68, 4
v_lshl_add_u32 v14, v6, 5, s60
v_lshl_add_u32 v15, v5, 3, v14
v_add_u32 v15, s61, v15
s_nop 2
v_pk_fma_f32 v[40:41], v[24:25], v[64:65], v[66:67] op_sel_hi:[0,1,1]
v_pk_fma_f32 v[42:43], v[24:25], v[80:81], v[82:83] op_sel_hi:[0,1,1]
v_pk_fma_f32 v[66:67], v[24:25], v[80:81], v[40:41] op_sel:[1,0,0] neg_lo:[1,0,0] neg_hi:[1,0,0]
v_pk_fma_f32 v[82:83], v[24:25], v[64:65], v[42:43] op_sel:[1,0,0]
v_pk_fma_f32 v[40:41], v[24:25], v[66:67], v[68:69] op_sel_hi:[0,1,1]
v_pk_fma_f32 v[42:43], v[24:25], v[82:83], v[84:85] op_sel_hi:[0,1,1]
v_pk_fma_f32 v[68:69], v[24:25], v[82:83], v[40:41] op_sel:[1,0,0] neg_lo:[1,0,0] neg_hi:[1,0,0]
v_pk_fma_f32 v[84:85], v[24:25], v[66:67], v[42:43] op_sel:[1,0,0]
v_pk_fma_f32 v[40:41], v[24:25], v[68:69], v[70:71] op_sel_hi:[0,1,1]
v_pk_fma_f32 v[42:43], v[24:25], v[84:85], v[86:87] op_sel_hi:[0,1,1]
v_pk_fma_f32 v[70:71], v[24:25], v[84:85], v[40:41] op_sel:[1,0,0] neg_lo:[1,0,0] neg_hi:[1,0,0]
v_pk_fma_f32 v[86:87], v[24:25], v[68:69], v[42:43] op_sel:[1,0,0]
v_pk_fma_f32 v[40:41], v[24:25], v[70:71], v[72:73] op_sel_hi:[0,1,1]
v_pk_fma_f32 v[42:43], v[24:25], v[86:87], v[88:89] op_sel_hi:[0,1,1]
v_pk_fma_f32 v[72:73], v[24:25], v[86:87], v[40:41] op_sel:[1,0,0] neg_lo:[1,0,0] neg_hi:[1,0,0]
v_pk_fma_f32 v[88:89], v[24:25], v[70:71], v[42:43] op_sel:[1,0,0]
v_pk_fma_f32 v[40:41], v[24:25], v[72:73], v[74:75] op_sel_hi:[0,1,1]
v_pk_fma_f32 v[42:43], v[24:25], v[88:89], v[90:91] op_sel_hi:[0,1,1]
v_pk_fma_f32 v[74:75], v[24:25], v[88:89], v[40:41] op_sel:[1,0,0] neg_lo:[1,0,0] neg_hi:[1,0,0]
v_pk_fma_f32 v[90:91], v[24:25], v[72:73], v[42:43] op_sel:[1,0,0]
v_pk_fma_f32 v[40:41], v[24:25], v[74:75], v[76:77] op_sel_hi:[0,1,1]
v_pk_fma_f32 v[42:43], v[24:25], v[90:91], v[92:93] op_sel_hi:[0,1,1]
v_pk_fma_f32 v[76:77], v[24:25], v[90:91], v[40:41] op_sel:[1,0,0] neg_lo:[1,0,0] neg_hi:[1,0,0]
v_pk_fma_f32 v[92:93], v[24:25], v[74:75], v[42:43] op_sel:[1,0,0]
v_pk_fma_f32 v[40:41], v[24:25], v[76:77], v[78:79] op_sel_hi:[0,1,1]
v_pk_fma_f32 v[42:43], v[24:25], v[92:93], v[94:95] op_sel_hi:[0,1,1]
v_pk_fma_f32 v[78:79], v[24:25], v[92:93], v[40:41] op_sel:[1,0,0] neg_lo:[1,0,0] neg_hi:[1,0,0]
v_pk_fma_f32 v[94:95], v[24:25], v[76:77], v[42:43] op_sel:[1,0,0]
v_pk_fma_f32 v[40:41], v[24:25], v[78:79], v[96:97] op_sel_hi:[0,1,1]
v_pk_fma_f32 v[42:43], v[24:25], v[94:95], v[112:113] op_sel_hi:[0,1,1]
v_pk_fma_f32 v[96:97], v[24:25], v[94:95], v[40:41] op_sel:[1,0,0] neg_lo:[1,0,0] neg_hi:[1,0,0]
v_pk_fma_f32 v[112:113], v[24:25], v[78:79], v[42:43] op_sel:[1,0,0]
v_pk_fma_f32 v[40:41], v[24:25], v[96:97], v[98:99] op_sel_hi:[0,1,1]
v_pk_fma_f32 v[42:43], v[24:25], v[112:113], v[114:115] op_sel_hi:[0,1,1]
v_pk_fma_f32 v[98:99], v[24:25], v[112:113], v[40:41] op_sel:[1,0,0] neg_lo:[1,0,0] neg_hi:[1,0,0]
v_pk_fma_f32 v[114:115], v[24:25], v[96:97], v[42:43] op_sel:[1,0,0]
v_pk_fma_f32 v[40:41], v[24:25], v[98:99], v[100:101] op_sel_hi:[0,1,1]
v_pk_fma_f32 v[42:43], v[24:25], v[114:115], v[116:117] op_sel_hi:[0,1,1]
v_pk_fma_f32 v[100:101], v[24:25], v[114:115], v[40:41] op_sel:[1,0,0] neg_lo:[1,0,0] neg_hi:[1,0,0]
v_pk_fma_f32 v[116:117], v[24:25], v[98:99], v[42:43] op_sel:[1,0,0]
v_pk_fma_f32 v[40:41], v[24:25], v[100:101], v[102:103] op_sel_hi:[0,1,1]
v_pk_fma_f32 v[42:43], v[24:25], v[116:117], v[118:119] op_sel_hi:[0,1,1]
v_pk_fma_f32 v[102:103], v[24:25], v[116:117], v[40:41] op_sel:[1,0,0] neg_lo:[1,0,0] neg_hi:[1,0,0]
v_pk_fma_f32 v[118:119], v[24:25], v[100:101], v[42:43] op_sel:[1,0,0]
v_pk_fma_f32 v[40:41], v[24:25], v[102:103], v[104:105] op_sel_hi:[0,1,1]
v_pk_fma_f32 v[42:43], v[24:25], v[118:119], v[120:121] op_sel_hi:[0,1,1]
v_pk_fma_f32 v[104:105], v[24:25], v[118:119], v[40:41] op_sel:[1,0,0] neg_lo:[1,0,0] neg_hi:[1,0,0]
v_pk_fma_f32 v[120:121], v[24:25], v[102:103], v[42:43] op_sel:[1,0,0]
v_pk_fma_f32 v[40:41], v[24:25], v[104:105], v[106:107] op_sel_hi:[0,1,1]
v_pk_fma_f32 v[42:43], v[24:25], v[120:121], v[122:123] op_sel_hi:[0,1,1]
v_pk_fma_f32 v[106:107], v[24:25], v[120:121], v[40:41] op_sel:[1,0,0] neg_lo:[1,0,0] neg_hi:[1,0,0]
v_pk_fma_f32 v[122:123], v[24:25], v[104:105], v[42:43] op_sel:[1,0,0]
v_pk_fma_f32 v[40:41], v[24:25], v[106:107], v[108:109] op_sel_hi:[0,1,1]
v_pk_fma_f32 v[42:43], v[24:25], v[122:123], v[124:125] op_sel_hi:[0,1,1]
v_pk_fma_f32 v[108:109], v[24:25], v[122:123], v[40:41] op_sel:[1,0,0] neg_lo:[1,0,0] neg_hi:[1,0,0]
v_pk_fma_f32 v[124:125], v[24:25], v[106:107], v[42:43] op_sel:[1,0,0]
v_pk_fma_f32 v[40:41], v[24:25], v[108:109], v[110:111] op_sel_hi:[0,1,1]
v_pk_fma_f32 v[42:43], v[24:25], v[124:125], v[126:127] op_sel_hi:[0,1,1]
v_pk_fma_f32 v[110:111], v[24:25], v[124:125], v[40:41] op_sel:[1,0,0] neg_lo:[1,0,0] neg_hi:[1,0,0]
v_pk_fma_f32 v[126:127], v[24:25], v[108:109], v[42:43] op_sel:[1,0,0]
v_fma_f32 v40, v28, v110, v111
v_fma_f32 v41, v28, v126, v127
v_fma_f32 v32, -v29, v126, v40
v_fma_f32 v33, v29, v110, v41
ds_write_b64 v15, v[32:33]
s_sub_u32 s60, s35, 1
s_lshl_b32 s60, s60, 14
v_lshlrev_b32 v16, 4, v4
v_lshlrev_b32 v17, 14, v5
v_sub_u32 v17, v16, v17
v_add_u32 v128, s60, v17
s_lshl_b32 s60, s35, 14
v_add_u32 v16, s60, v16
v_lshlrev_b32 v17, 30, v5
v_or_b32 v16, v16, v17
s_waitcnt lgkmcnt(0)
s_barrier
ds_read_b128 v[144:147], v14
ds_read_b128 v[148:151], v14 offset:16
L_n41:
s_waitcnt vmcnt(0)
v_readfirstlane_b32 s37, v13
s_nop 0
s_cmp_lg_u32 s37, 0
s_cbranch_scc1 L_ng42
global_load_dword v13, v12, s[30:31] sc1
s_branch L_n41
L_ng42:
v_mov_b32 v46, s37
v_mov_b32 v47, s37
s_getreg_b32 s60, hwreg(HW_REG_XCC_ID, 0, 4)
s_lshl_b32 s61, s37, 4
s_or_b32 s100, s60, s61
v_mov_b32 v60, s100
s_lshr_b32 s101, s36, 3
s_lshl_b32 s60, s35, 11
s_add_u32 s60, s60, 32768
s_lshl_b32 s61, s36, 7
s_add_u32 s61, s61, s60
v_mov_b32 v61, s61
s_lshl_b32 s61, s101, 10
s_add_u32 s60, s60, s61
v_and_b32 v62, 7, v1
v_lshl_add_u32 v62, v62, 7, s60
s_waitcnt lgkmcnt(0)
v_fma_f32 v40, v20, v144, v146
v_fma_f32 v41, v20, v145, v147
v_fma_f32 v48, -v21, v145, v40
v_fma_f32 v49, v21, v144, v41
v_fma_f32 v40, v20, v48, v148
v_fma_f32 v41, v20, v49, v149
v_fma_f32 v50, -v21, v49, v40
v_fma_f32 v51, v21, v48, v41
v_fma_f32 v40, v20, v50, v150
v_fma_f32 v41, v20, v51, v151
v_fma_f32 v44, -v21, v51, v40
v_fma_f32 v45, v21, v50, v41
s_cmp_lg_u32 s68, 0
s_cbranch_scc1 L_np43
buffer_store_dwordx4 v[44:47], v16, s[40:43], 0 offen sc1
s_cmp_lg_u32 s66, 0
s_cbranch_scc1 L_np43
s_mov_b64 exec, 1
global_store_dword v61, v60, s[32:33] sc1
s_mov_b64 exec, -1
L_np43:
v_mov_b32 v17, 0x40000000
v_subrev_u32 v129, 32768, v128
v_subrev_u32 v130, 65536, v128
v_subrev_u32 v131, 98304, v128
v_subrev_u32 v132, 131072, v128
v_subrev_u32 v133, 163840, v128
v_subrev_u32 v134, 196608, v128
v_subrev_u32 v135, 229376, v128
v_cmp_le_i32 vcc, 0, v128
s_nop 1
v_cndmask_b32 v136, 0, v46, vcc
v_cndmask_b32 v128, v17, v128, vcc
v_cmp_le_i32 vcc, 0, v129
s_nop 1
v_cndmask_b32 v137, 0, v46, vcc
v_cndmask_b32 v129, v17, v129, vcc
v_cmp_le_i32 vcc, 0, v130
s_nop 1
v_cndmask_b32 v138, 0, v46, vcc
v_cndmask_b32 v130, v17, v130, vcc
v_cmp_le_i32 vcc, 0, v131
s_nop 1
v_cndmask_b32 v139, 0, v46, vcc
v_cndmask_b32 v131, v17, v131, vcc
v_cmp_le_i32 vcc, 0, v132
s_nop 1
v_cndmask_b32 v140, 0, v46, vcc
v_cndmask_b32 v132, v17, v132, vcc
v_cmp_le_i32 vcc, 0, v133
s_nop 1
v_cndmask_b32 v141, 0, v46, vcc
v_cndmask_b32 v133, v17, v133, vcc
v_cmp_le_i32 vcc, 0, v134
s_nop 1
v_cndmask_b32 v142, 0, v46, vcc
v_cndmask_b32 v134, v17, v134, vcc
v_cmp_le_i32 vcc, 0, v135
s_nop 1
v_cndmask_b32 v143, 0, v46, vcc
v_cndmask_b32 v135, v17, v135, vcc
s_lshl_b32 s60, s35, 1
s_add_u32 s60, s60, s68
s_lshl_b32 s60, s60, 12
s_add_u32 s60, s60, 393216
s_lshl_b32 s61, s101, 11
s_add_u32 s61, s61, s60
v_and_b32 v18, 15, v1
v_lshl_add_u32 v18, v18, 7, s61
s_lshl_b32 s61, s36, 8
s_add_u32 s60, s60, s61
s_lshl_b32 s61, s66, 7
s_add_u32 s60, s60, s61
v_mov_b32 v19, s60
global_load_dword v246, v18, s[32:33] sc1
v_mul_f32 v52, v27, v25
v_mul_f32 v53, v27, v24
v_fma_f32 v208, v26, v24, -v52
v_fma_f32 v209, v26, v25, v53
v_pk_mul_f32 v[52:53], v[26:27], v[64:65] op_sel_hi:[0,1]
v_pk_mul_f32 v[54:55], v[26:27], v[80:81] op_sel_hi:[0,1] neg_lo:[1,0] neg_hi:[1,0]
v_mul_f32 v58, v209, v25
v_mul_f32 v59, v209, v24
v_pk_fma_f32 v[54:55], v[26:27], v[64:65], v[54:55] op_sel:[1,0,0] neg_lo:[1,0,0] neg_hi:[1,0,0]
v_pk_fma_f32 v[64:65], v[26:27], v[80:81], v[52:53] op_sel:[1,0,0] neg_lo:[1,0,0] neg_hi:[1,0,0]
v_mov_b64 v[80:81], v[54:55]
v_fma_f32 v210, v208, v24, -v58
v_fma_f32 v211, v208, v25, v59
v_pk_mul_f32 v[52:53], v[26:27], v[66:67] op_sel_hi:[0,1]
v_pk_mul_f32 v[54:55], v[26:27], v[82:83] op_sel_hi:[0,1] neg_lo:[1,0] neg_hi:[1,0]
v_mul_f32 v58, v211, v25
v_mul_f32 v59, v211, v24
v_pk_fma_f32 v[54:55], v[26:27], v[66:67], v[54:55] op_sel:[1,0,0] neg_lo:[1,0,0] neg_hi:[1,0,0]
v_pk_fma_f32 v[66:67], v[26:27], v[82:83], v[52:53] op_sel:[1,0,0] neg_lo:[1,0,0] neg_hi:[1,0,0]
v_mov_b64 v[82:83], v[54:55]
v_fma_f32 v212, v210, v24, -v58
v_fma_f32 v213, v210, v25, v59
v_pk_mul_f32 v[52:53], v[26:27], v[68:69] op_sel_hi:[0,1]
v_pk_mul_f32 v[54:55], v[26:27], v[84:85] op_sel_hi:[0,1] neg_lo:[1,0] neg_hi:[1,0]
v_mul_f32 v58, v213, v25
v_mul_f32 v59, v213, v24
v_pk_fma_f32 v[54:55], v[26:27], v[68:69], v[54:55] op_sel:[1,0,0] neg_lo:[1,0,0] neg_hi:[1,0,0]
v_pk_fma_f32 v[68:69], v[26:27], v[84:85], v[52:53] op_sel:[1,0,0] neg_lo:[1,0,0] neg_hi:[1,0,0]
v_mov_b64 v[84:85], v[54:55]
v_fma_f32 v214, v212, v24, -v58
v_fma_f32 v215, v212, v25, v59
v_pk_mul_f32 v[52:53], v[26:27], v[70:71] op_sel_hi:[0,1]
v_pk_mul_f32 v[54:55], v[26:27], v[86:87] op_sel_hi:[0,1] neg_lo:[1,0] neg_hi:[1,0]
v_mul_f32 v58, v215, v25
v_mul_f32 v59, v215, v24
v_pk_fma_f32 v[54:55], v[26:27], v[70:71], v[54:55] op_sel:[1,0,0] neg_lo:[1,0,0] neg_hi:[1,0,0]
v_pk_fma_f32 v[70:71], v[26:27], v[86:87], v[52:53] op_sel:[1,0,0] neg_lo:[1,0,0] neg_hi:[1,0,0]
v_mov_b64 v[86:87], v[54:55]
v_fma_f32 v216, v214, v24, -v58
v_fma_f32 v217, v214, v25, v59
v_pk_mul_f32 v[52:53], v[26:27], v[72:73] op_sel_hi:[0,1]
v_pk_mul_f32 v[54:55], v[26:27], v[88:89] op_sel_hi:[0,1] neg_lo:[1,0] neg_hi:[1,0]
v_mul_f32 v58, v217, v25
v_mul_f32 v59, v217, v24
v_pk_fma_f32 v[54:55], v[26:27], v[72:73], v[54:55] op_sel:[1,0,0] neg_lo:[1,0,0] neg_hi:[1,0,0]
v_pk_fma_f32 v[72:73], v[26:27], v[88:89], v[52:53] op_sel:[1,0,0] neg_lo:[1,0,0] neg_hi:[1,0,0]
v_mov_b64 v[88:89], v[54:55]
v_fma_f32 v218, v216, v24, -v58
v_fma_f32 v219, v216, v25, v59
v_pk_mul_f32 v[52:53], v[26:27], v[74:75] op_sel_hi:[0,1]
v_pk_mul_f32 v[54:55], v[26:27], v[90:91] op_sel_hi:[0,1] neg_lo:[1,0] neg_hi:[1,0]
v_mul_f32 v58, v219, v25
v_mul_f32 v59, v219, v24
v_pk_fma_f32 v[54:55], v[26:27], v[74:75], v[54:55] op_sel:[1,0,0] neg_lo:[1,0,0] neg_hi:[1,0,0]
v_pk_fma_f32 v[74:75], v[26:27], v[90:91], v[52:53] op_sel:[1,0,0] neg_lo:[1,0,0] neg_hi:[1,0,0]
v_mov_b64 v[90:91], v[54:55]
v_fma_f32 v220, v218, v24, -v58
v_fma_f32 v221, v218, v25, v59
v_pk_mul_f32 v[52:53], v[26:27], v[76:77] op_sel_hi:[0,1]
v_pk_mul_f32 v[54:55], v[26:27], v[92:93] op_sel_hi:[0,1] neg_lo:[1,0] neg_hi:[1,0]
v_mul_f32 v58, v221, v25
v_mul_f32 v59, v221, v24
v_pk_fma_f32 v[54:55], v[26:27], v[76:77], v[54:55] op_sel:[1,0,0] neg_lo:[1,0,0] neg_hi:[1,0,0]
v_pk_fma_f32 v[76:77], v[26:27], v[92:93], v[52:53] op_sel:[1,0,0] neg_lo:[1,0,0] neg_hi:[1,0,0]
v_mov_b64 v[92:93], v[54:55]
v_fma_f32 v222, v220, v24, -v58
v_fma_f32 v223, v220, v25, v59
v_pk_mul_f32 v[52:53], v[26:27], v[78:79] op_sel_hi:[0,1]
v_pk_mul_f32 v[54:55], v[26:27], v[94:95] op_sel_hi:[0,1] neg_lo:[1,0] neg_hi:[1,0]
v_mul_f32 v58, v223, v25
v_mul_f32 v59, v223, v24
v_pk_fma_f32 v[54:55], v[26:27], v[78:79], v[54:55] op_sel:[1,0,0] neg_lo:[1,0,0] neg_hi:[1,0,0]
v_pk_fma_f32 v[78:79], v[26:27], v[94:95], v[52:53] op_sel:[1,0,0] neg_lo:[1,0,0] neg_hi:[1,0,0]
v_mov_b64 v[94:95], v[54:55]
v_fma_f32 v224, v222, v24, -v58
v_fma_f32 v225, v222, v25, v59
v_pk_mul_f32 v[52:53], v[26:27], v[96:97] op_sel_hi:[0,1]
v_pk_mul_f32 v[54:55], v[26:27], v[112:113] op_sel_hi:[0,1] neg_lo:[1,0] neg_hi:[1,0]
v_mul_f32 v58, v225, v25
v_mul_f32 v59, v225, v24
v_pk_fma_f32 v[54:55], v[26:27], v[96:97], v[54:55] op_sel:[1,0,0] neg_lo:[1,0,0] neg_hi:[1,0,0]
v_pk_fma_f32 v[96:97], v[26:27], v[112:113], v[52:53] op_sel:[1,0,0] neg_lo:[1,0,0] neg_hi:[1,0,0]
v_mov_b64 v[112:113], v[54:55]
v_fma_f32 v226, v224, v24, -v58
v_fma_f32 v227, v224, v25, v59
v_pk_mul_f32 v[52:53], v[26:27], v[98:99] op_sel_hi:[0,1]
v_pk_mul_f32 v[54:55], v[26:27], v[114:115] op_sel_hi:[0,1] neg_lo:[1,0] neg_hi:[1,0]
v_mul_f32 v58, v227, v25
v_mul_f32 v59, v227, v24
v_pk_fma_f32 v[54:55], v[26:27], v[98:99], v[54:55] op_sel:[1,0,0] neg_lo:[1,0,0] neg_hi:[1,0,0]
v_pk_fma_f32 v[98:99], v[26:27], v[114:115], v[52:53] op_sel:[1,0,0] neg_lo:[1,0,0] neg_hi:[1,0,0]
v_mov_b64 v[114:115], v[54:55]
v_fma_f32 v228, v226, v24, -v58
v_fma_f32 v229, v226, v25, v59
v_pk_mul_f32 v[52:53], v[26:27], v[100:101] op_sel_hi:[0,1]
v_pk_mul_f32 v[54:55], v[26:27], v[116:117] op_sel_hi:[0,1] neg_lo:[1,0] neg_hi:[1,0]
v_mul_f32 v58, v229, v25
v_mul_f32 v59, v229, v24
v_pk_fma_f32 v[54:55], v[26:27], v[100:101], v[54:55] op_sel:[1,0,0] neg_lo:[1,0,0] neg_hi:[1,0,0]
v_pk_fma_f32 v[100:101], v[26:27], v[116:117], v[52:53] op_sel:[1,0,0] neg_lo:[1,0,0] neg_hi:[1,0,0]
v_mov_b64 v[116:117], v[54:55]
v_fma_f32 v230, v228, v24, -v58
v_fma_f32 v231, v228, v25, v59
v_pk_mul_f32 v[52:53], v[26:27], v[102:103] op_sel_hi:[0,1]
v_pk_mul_f32 v[54:55], v[26:27], v[118:119] op_sel_hi:[0,1] neg_lo:[1,0] neg_hi:[1,0]
v_mul_f32 v58, v231, v25
v_mul_f32 v59, v231, v24
v_pk_fma_f32 v[54:55], v[26:27], v[102:103], v[54:55] op_sel:[1,0,0] neg_lo:[1,0,0] neg_hi:[1,0,0]
v_pk_fma_f32 v[102:103], v[26:27], v[118:119], v[52:53] op_sel:[1,0,0] neg_lo:[1,0,0] neg_hi:[1,0,0]
v_mov_b64 v[118:119], v[54:55]
v_fma_f32 v232, v230, v24, -v58
v_fma_f32 v233, v230, v25, v59
v_pk_mul_f32 v[52:53], v[26:27], v[104:105] op_sel_hi:[0,1]
v_pk_mul_f32 v[54:55], v[26:27], v[120:121] op_sel_hi:[0,1] neg_lo:[1,0] neg_hi:[1,0]
v_mul_f32 v58, v233, v25
v_mul_f32 v59, v233, v24
v_pk_fma_f32 v[54:55], v[26:27], v[104:105], v[54:55] op_sel:[1,0,0] neg_lo:[1,0,0] neg_hi:[1,0,0]
v_pk_fma_f32 v[104:105], v[26:27], v[120:121], v[52:53] op_sel:[1,0,0] neg_lo:[1,0,0] neg_hi:[1,0,0]
v_mov_b64 v[120:121], v[54:55]
v_fma_f32 v234, v232, v24, -v58
v_fma_f32 v235, v232, v25, v59
v_pk_mul_f32 v[52:53], v[26:27], v[106:107] op_sel_hi:[0,1]
v_pk_mul_f32 v[54:55], v[26:27], v[122:123] op_sel_hi:[0,1] neg_lo:[1,0] neg_hi:[1,0]
v_mul_f32 v58, v235, v25
v_mul_f32 v59, v235, v24
v_pk_fma_f32 v[54:55], v[26:27], v[106:107], v[54:55] op_sel:[1,0,0] neg_lo:[1,0,0] neg_hi:[1,0,0]
v_pk_fma_f32 v[106:107], v[26:27], v[122:123], v[52:53] op_sel:[1,0,0] neg_lo:[1,0,0] neg_hi:[1,0,0]
v_mov_b64 v[122:123], v[54:55]
v_fma_f32 v236, v234, v24, -v58
v_fma_f32 v237, v234, v25, v59
v_pk_mul_f32 v[52:53], v[26:27], v[108:109] op_sel_hi:[0,1]
v_pk_mul_f32 v[54:55], v[26:27], v[124:125] op_sel_hi:[0,1] neg_lo:[1,0] neg_hi:[1,0]
v_mul_f32 v58, v237, v25
v_mul_f32 v59, v237, v24
v_pk_fma_f32 v[54:55], v[26:27], v[108:109], v[54:55] op_sel:[1,0,0] neg_lo:[1,0,0] neg_hi:[1,0,0]
v_pk_fma_f32 v[108:109], v[26:27], v[124:125], v[52:53] op_sel:[1,0,0] neg_lo:[1,0,0] neg_hi:[1,0,0]
v_mov_b64 v[124:125], v[54:55]
v_fma_f32 v238, v236, v24, -v58
v_fma_f32 v239, v236, v25, v59
v_pk_mul_f32 v[52:53], v[26:27], v[110:111] op_sel_hi:[0,1]
v_pk_mul_f32 v[54:55], v[26:27], v[126:127] op_sel_hi:[0,1] neg_lo:[1,0] neg_hi:[1,0]
v_mov_b32 v56, v110
v_mov_b32 v57, v126
v_pk_fma_f32 v[54:55], v[26:27], v[110:111], v[54:55] op_sel:[1,0,0] neg_lo:[1,0,0] neg_hi:[1,0,0]
v_pk_fma_f32 v[110:111], v[26:27], v[126:127], v[52:53] op_sel:[1,0,0] neg_lo:[1,0,0] neg_hi:[1,0,0]
v_mov_b64 v[126:127], v[54:55]
buffer_load_dwordx4 v[160:163], v128, s[40:43], 0 offen sc1
buffer_load_dwordx4 v[164:167], v129, s[40:43], 0 offen sc1
buffer_load_dwordx4 v[168:171], v130, s[40:43], 0 offen sc1
buffer_load_dwordx4 v[172:175], v131, s[40:43], 0 offen sc1
buffer_load_dwordx4 v[176:179], v132, s[40:43], 0 offen sc1
buffer_load_dwordx4 v[180:183], v133, s[40:43], 0 offen sc1
buffer_load_dwordx4 v[184:187], v134, s[40:43], 0 offen sc1
buffer_load_dwordx4 v[188:191], v135, s[40:43], 0 offen sc1
global_load_dword v63, v62, s[32:33] sc1
s_mov_b32 s69, 0
L_poll44:
s_mov_b64 s[60:61], 0
s_waitcnt vmcnt(8)
v_cmp_ne_u32 vcc, v162, v136
s_nop 0
s_or_b64 s[60:61], s[60:61], vcc
v_cmp_ne_u32 vcc, v163, v136
s_nop 0
s_or_b64 s[60:61], s[60:61], vcc
s_waitcnt vmcnt(7)
v_cmp_ne_u32 vcc, v166, v137
s_nop 0
s_or_b64 s[60:61], s[60:61], vcc
v_cmp_ne_u32 vcc, v167, v137
s_nop 0
s_or_b64 s[60:61], s[60:61], vcc
s_waitcnt vmcnt(6)
v_cmp_ne_u32 vcc, v170, v138
s_nop 0
s_or_b64 s[60:61], s[60:61], vcc
v_cmp_ne_u32 vcc, v171, v138
s_nop 0
s_or_b64 s[60:61], s[60:61], vcc
s_waitcnt vmcnt(5)
v_cmp_ne_u32 vcc, v174, v139
s_nop 0
s_or_b64 s[60:61], s[60:61], vcc
v_cmp_ne_u32 vcc, v175, v139
s_nop 0
s_or_b64 s[60:61], s[60:61], vcc
s_waitcnt vmcnt(4)
v_cmp_ne_u32 vcc, v178, v140
s_nop 0
s_or_b64 s[60:61], s[60:61], vcc
v_cmp_ne_u32 vcc, v179, v140
s_nop 0
s_or_b64 s[60:61], s[60:61], vcc
s_waitcnt vmcnt(3)
v_cmp_ne_u32 vcc, v182, v141
s_nop 0
s_or_b64 s[60:61], s[60:61], vcc
v_cmp_ne_u32 vcc, v183, v141
s_nop 0
s_or_b64 s[60:61], s[60:61], vcc
s_waitcnt vmcnt(2)
v_cmp_ne_u32 vcc, v186, v142
s_nop 0
s_or_b64 s[60:61], s[60:61], vcc
v_cmp_ne_u32 vcc, v187, v142
s_nop 0
s_or_b64 s[60:61], s[60:61], vcc
s_waitcnt vmcnt(1)
v_cmp_ne_u32 vcc, v190, v143
s_nop 0
s_or_b64 s[60:61], s[60:61], vcc
v_cmp_ne_u32 vcc, v191, v143
s_nop 0
s_or_b64 s[60:61], s[60:61], vcc
s_waitcnt vmcnt(0)
v_xor_b32 v63, v60, v63
v_cmp_lt_u32 vcc, 15, v63
s_nop 0
s_or_b64 s[60:61], s[60:61], vcc
s_add_u32 s69, s69, 1
s_cmp_eq_u64 s[60:61], 0
s_cbranch_scc1 L_polled45
s_cmp_ge_u32 s69, 200000
s_cbranch_scc1 L_polled45
buffer_load_dwordx4 v[160:163], v128, s[40:43], 0 offen sc1
buffer_load_dwordx4 v[164:167], v129, s[40:43], 0 offen sc1
buffer_load_dwordx4 v[168:171], v130, s[40:43], 0 offen sc1
buffer_load_dwordx4 v[172:175], v131, s[40:43], 0 offen sc1
buffer_load_dwordx4 v[176:179], v132, s[40:43], 0 offen sc1
buffer_load_dwordx4 v[180:183], v133, s[40:43], 0 offen sc1
buffer_load_dwordx4 v[184:187], v134, s[40:43], 0 offen sc1
buffer_load_dwordx4 v[188:191], v135, s[40:43], 0 offen sc1
global_load_dword v63, v62, s[32:33] sc1
s_branch L_poll44
L_polled45:
v_cmp_ne_u32 vcc, 0, v63
s_nop 0
s_cmp_eq_u64 vcc, 0
s_cselect_b32 s100, 1, 0
v_mov_b32 v12, 126976
s_lshl_b32 s60, s34, 2
v_add_u32 v13, s60, v12
v_mov_b32 v14, 1
s_mov_b64 exec, 1
ds_write_b32 v13, v14
s_mov_b64 exec, -1
s_cmp_lt_u32 s34, 2
s_cbranch_scc1 L_ct46
s_lshl_b32 s60, s101, 10
s_bfe_u32 s61, s2, 0x20001
s_lshl_b32 s61, s61, 19
s_add_u32 s60, s60, s61
s_lshr_b32 s61, s2, 3
s_lshl_b32 s61, s61, 14
s_add_u32 s60, s60, s61
v_lshrrev_b32 v8, 3, v1
v_lshlrev_b32 v8, 11, v8
v_and_b32 v9, 7, v1
v_lshl_add_u32 v8, v9, 7, v8
v_add_u32 v8, s60, v8
s_cmp_eq_u32 s66, 0
s_cselect_b32 s60, s20, s22
s_cselect_b32 s61, s21, s23
global_load_dword v246, v8, s[60:61]
L_ct46:
v_fma_f32 v40, v2, v188, v184
v_fma_f32 v41, v2, v189, v185
v_fma_f32 v48, -v3, v189, v40
v_fma_f32 v49, v3, v188, v41
v_fma_f32 v40, v2, v48, v180
v_fma_f32 v41, v2, v49, v181
v_fma_f32 v188, -v3, v49, v40
v_fma_f32 v189, v3, v48, v41
v_fma_f32 v40, v2, v188, v176
v_fma_f32 v41, v2, v189, v177
v_fma_f32 v48, -v3, v189, v40
v_fma_f32 v49, v3, v188, v41
v_fma_f32 v40, v2, v48, v172
v_fma_f32 v41, v2, v49, v173
v_fma_f32 v188, -v3, v49, v40
v_fma_f32 v189, v3, v48, v41
v_fma_f32 v40, v2, v188, v168
v_fma_f32 v41, v2, v189, v169
v_fma_f32 v48, -v3, v189, v40
v_fma_f32 v49, v3, v188, v41
v_fma_f32 v40, v2, v48, v164
v_fma_f32 v41, v2, v49, v165
v_fma_f32 v188, -v3, v49, v40
v_fma_f32 v189, v3, v48, v41
v_fma_f32 v40, v2, v188, v160
v_fma_f32 v41, v2, v189, v161
v_fma_f32 v48, -v3, v189, v40
v_fma_f32 v49, v3, v188, v41
v_mov_b32 v50, v48
v_mov_b32 v51, v49
s_nop 0
v_permlane32_swap_b32 v48, v50
v_permlane32_swap_b32 v49, v51
v_fma_f32 v40, v30, v50, v48
v_fma_f32 v41, v30, v51, v49
v_fma_f32 v192, -v31, v51, v40
v_fma_f32 v193, v31, v50, v41
v_fma_f32 v40, v20, v192, v144
v_fma_f32 v41, v20, v193, v145
v_fma_f32 v194, -v21, v193, v40
v_fma_f32 v195, v21, v192, v41
v_fma_f32 v40, v20, v194, v146
v_fma_f32 v41, v20, v195, v147
v_fma_f32 v196, -v21, v195, v40
v_fma_f32 v197, v21, v194, v41
v_fma_f32 v40, v20, v196, v148
v_fma_f32 v41, v20, v197, v149
v_fma_f32 v198, -v21, v197, v40
v_fma_f32 v199, v21, v196, v41
s_cmp_eq_u32 s68, 0
s_cbranch_scc1 L_wt047
v_mov_b64 v[192:193], v[196:197]
v_mov_b64 v[194:195], v[198:199]
L_wt047:
v_cmp_eq_u32 vcc, 1, v5
s_nop 1
v_cndmask_b32 v48, v192, v194, vcc
v_cndmask_b32 v50, v193, v195, vcc
v_fma_f32 v40, v28, v48, v56
v_fma_f32 v41, v28, v50, v57
v_fma_f32 v49, -v29, v50, v40
v_fma_f32 v51, v29, v48, v41
s_lshl_b32 s60, s35, 1
s_add_u32 s69, s60, s68
s_lshl_b32 s60, s69, 18
s_lshl_b32 s61, s36, 13
s_add_u32 s60, s60, s61
s_lshl_b32 s61, s66, 11
s_add_u32 s60, s60, s61
v_pk_fma_f32 v[64:65], v[208:209], v[48:49], v[64:65] op_sel_hi:[0,1,1]
v_pk_fma_f32 v[80:81], v[208:209], v[50:51], v[80:81] op_sel_hi:[0,1,1] neg_lo:[1,0,0] neg_hi:[1,0,0]
v_pk_fma_f32 v[64:65], v[208:209], v[50:51], v[64:65] op_sel:[1,0,0] neg_lo:[1,0,0] neg_hi:[1,0,0]
v_pk_fma_f32 v[80:81], v[208:209], v[48:49], v[80:81] op_sel:[1,0,0] neg_lo:[1,0,0] neg_hi:[1,0,0]
v_cvt_pk_bf16_f32 v128, v64, v65
v_cvt_pk_bf16_f32 v144, v80, v81
v_pk_fma_f32 v[66:67], v[210:211], v[48:49], v[66:67] op_sel_hi:[0,1,1]
v_pk_fma_f32 v[82:83], v[210:211], v[50:51], v[82:83] op_sel_hi:[0,1,1] neg_lo:[1,0,0] neg_hi:[1,0,0]
v_pk_fma_f32 v[66:67], v[210:211], v[50:51], v[66:67] op_sel:[1,0,0] neg_lo:[1,0,0] neg_hi:[1,0,0]
v_pk_fma_f32 v[82:83], v[210:211], v[48:49], v[82:83] op_sel:[1,0,0] neg_lo:[1,0,0] neg_hi:[1,0,0]
v_cvt_pk_bf16_f32 v129, v66, v67
v_cvt_pk_bf16_f32 v145, v82, v83
v_pk_fma_f32 v[68:69], v[212:213], v[48:49], v[68:69] op_sel_hi:[0,1,1]
v_pk_fma_f32 v[84:85], v[212:213], v[50:51], v[84:85] op_sel_hi:[0,1,1] neg_lo:[1,0,0] neg_hi:[1,0,0]
v_pk_fma_f32 v[68:69], v[212:213], v[50:51], v[68:69] op_sel:[1,0,0] neg_lo:[1,0,0] neg_hi:[1,0,0]
v_pk_fma_f32 v[84:85], v[212:213], v[48:49], v[84:85] op_sel:[1,0,0] neg_lo:[1,0,0] neg_hi:[1,0,0]
v_cvt_pk_bf16_f32 v130, v68, v69
v_cvt_pk_bf16_f32 v146, v84, v85
v_pk_fma_f32 v[70:71], v[214:215], v[48:49], v[70:71] op_sel_hi:[0,1,1]
v_pk_fma_f32 v[86:87], v[214:215], v[50:51], v[86:87] op_sel_hi:[0,1,1] neg_lo:[1,0,0] neg_hi:[1,0,0]
v_pk_fma_f32 v[70:71], v[214:215], v[50:51], v[70:71] op_sel:[1,0,0] neg_lo:[1,0,0] neg_hi:[1,0,0]
v_pk_fma_f32 v[86:87], v[214:215], v[48:49], v[86:87] op_sel:[1,0,0] neg_lo:[1,0,0] neg_hi:[1,0,0]
v_cvt_pk_bf16_f32 v131, v70, v71
v_cvt_pk_bf16_f32 v147, v86, v87
v_pk_fma_f32 v[72:73], v[216:217], v[48:49], v[72:73] op_sel_hi:[0,1,1]
v_pk_fma_f32 v[88:89], v[216:217], v[50:51], v[88:89] op_sel_hi:[0,1,1] neg_lo:[1,0,0] neg_hi:[1,0,0]
v_pk_fma_f32 v[72:73], v[216:217], v[50:51], v[72:73] op_sel:[1,0,0] neg_lo:[1,0,0] neg_hi:[1,0,0]
v_pk_fma_f32 v[88:89], v[216:217], v[48:49], v[88:89] op_sel:[1,0,0] neg_lo:[1,0,0] neg_hi:[1,0,0]
v_cvt_pk_bf16_f32 v132, v72, v73
v_cvt_pk_bf16_f32 v148, v88, v89
v_pk_fma_f32 v[74:75], v[218:219], v[48:49], v[74:75] op_sel_hi:[0,1,1]
v_pk_fma_f32 v[90:91], v[218:219], v[50:51], v[90:91] op_sel_hi:[0,1,1] neg_lo:[1,0,0] neg_hi:[1,0,0]
v_pk_fma_f32 v[74:75], v[218:219], v[50:51], v[74:75] op_sel:[1,0,0] neg_lo:[1,0,0] neg_hi:[1,0,0]
v_pk_fma_f32 v[90:91], v[218:219], v[48:49], v[90:91] op_sel:[1,0,0] neg_lo:[1,0,0] neg_hi:[1,0,0]
v_cvt_pk_bf16_f32 v133, v74, v75
v_cvt_pk_bf16_f32 v149, v90, v91
v_pk_fma_f32 v[76:77], v[220:221], v[48:49], v[76:77] op_sel_hi:[0,1,1]
v_pk_fma_f32 v[92:93], v[220:221], v[50:51], v[92:93] op_sel_hi:[0,1,1] neg_lo:[1,0,0] neg_hi:[1,0,0]
v_pk_fma_f32 v[76:77], v[220:221], v[50:51], v[76:77] op_sel:[1,0,0] neg_lo:[1,0,0] neg_hi:[1,0,0]
v_pk_fma_f32 v[92:93], v[220:221], v[48:49], v[92:93] op_sel:[1,0,0] neg_lo:[1,0,0] neg_hi:[1,0,0]
v_cvt_pk_bf16_f32 v134, v76, v77
v_cvt_pk_bf16_f32 v150, v92, v93
v_pk_fma_f32 v[78:79], v[222:223], v[48:49], v[78:79] op_sel_hi:[0,1,1]
v_pk_fma_f32 v[94:95], v[222:223], v[50:51], v[94:95] op_sel_hi:[0,1,1] neg_lo:[1,0,0] neg_hi:[1,0,0]
v_pk_fma_f32 v[78:79], v[222:223], v[50:51], v[78:79] op_sel:[1,0,0] neg_lo:[1,0,0] neg_hi:[1,0,0]
v_pk_fma_f32 v[94:95], v[222:223], v[48:49], v[94:95] op_sel:[1,0,0] neg_lo:[1,0,0] neg_hi:[1,0,0]
v_cvt_pk_bf16_f32 v135, v78, v79
v_cvt_pk_bf16_f32 v151, v94, v95
v_mfma_f32_32x32x16_bf16 v[160:175], v[128:131], v[248:251], 0
v_mfma_f32_32x32x16_bf16 v[160:175], v[132:135], v[252:255], v[160:175]
v_mfma_f32_32x32x16_bf16 v[176:191], v[144:147], v[248:251], 0
v_mfma_f32_32x32x16_bf16 v[176:191], v[148:151], v[252:255], v[176:191]
v_pk_fma_f32 v[96:97], v[224:225], v[48:49], v[96:97] op_sel_hi:[0,1,1]
v_pk_fma_f32 v[112:113], v[224:225], v[50:51], v[112:113] op_sel_hi:[0,1,1] neg_lo:[1,0,0] neg_hi:[1,0,0]
v_pk_fma_f32 v[96:97], v[224:225], v[50:51], v[96:97] op_sel:[1,0,0] neg_lo:[1,0,0] neg_hi:[1,0,0]
v_pk_fma_f32 v[112:113], v[224:225], v[48:49], v[112:113] op_sel:[1,0,0] neg_lo:[1,0,0] neg_hi:[1,0,0]
v_cvt_pk_bf16_f32 v136, v96, v97
v_cvt_pk_bf16_f32 v152, v112, v113
v_pk_fma_f32 v[98:99], v[226:227], v[48:49], v[98:99] op_sel_hi:[0,1,1]
v_pk_fma_f32 v[114:115], v[226:227], v[50:51], v[114:115] op_sel_hi:[0,1,1] neg_lo:[1,0,0] neg_hi:[1,0,0]
v_pk_fma_f32 v[98:99], v[226:227], v[50:51], v[98:99] op_sel:[1,0,0] neg_lo:[1,0,0] neg_hi:[1,0,0]
v_pk_fma_f32 v[114:115], v[226:227], v[48:49], v[114:115] op_sel:[1,0,0] neg_lo:[1,0,0] neg_hi:[1,0,0]
v_cvt_pk_bf16_f32 v137, v98, v99
v_cvt_pk_bf16_f32 v153, v114, v115
v_pk_fma_f32 v[100:101], v[228:229], v[48:49], v[100:101] op_sel_hi:[0,1,1]
v_pk_fma_f32 v[116:117], v[228:229], v[50:51], v[116:117] op_sel_hi:[0,1,1] neg_lo:[1,0,0] neg_hi:[1,0,0]
v_pk_fma_f32 v[100:101], v[228:229], v[50:51], v[100:101] op_sel:[1,0,0] neg_lo:[1,0,0] neg_hi:[1,0,0]
v_pk_fma_f32 v[116:117], v[228:229], v[48:49], v[116:117] op_sel:[1,0,0] neg_lo:[1,0,0] neg_hi:[1,0,0]
v_cvt_pk_bf16_f32 v138, v100, v101
v_cvt_pk_bf16_f32 v154, v116, v117
v_pk_fma_f32 v[102:103], v[230:231], v[48:49], v[102:103] op_sel_hi:[0,1,1]
v_pk_fma_f32 v[118:119], v[230:231], v[50:51], v[118:119] op_sel_hi:[0,1,1] neg_lo:[1,0,0] neg_hi:[1,0,0]
v_pk_fma_f32 v[102:103], v[230:231], v[50:51], v[102:103] op_sel:[1,0,0] neg_lo:[1,0,0] neg_hi:[1,0,0]
v_pk_fma_f32 v[118:119], v[230:231], v[48:49], v[118:119] op_sel:[1,0,0] neg_lo:[1,0,0] neg_hi:[1,0,0]
v_cvt_pk_bf16_f32 v139, v102, v103
v_cvt_pk_bf16_f32 v155, v118, v119
s_add_u32 s61, s60, 0
v_cvt_pk_bf16_f32 v64, v160, v161
v_cvt_pk_bf16_f32 v65, v162, v163
v_cvt_pk_bf16_f32 v66, v164, v165
v_cvt_pk_bf16_f32 v67, v166, v167
v_cvt_pk_bf16_f32 v68, v168, v169
v_cvt_pk_bf16_f32 v69, v170, v171
v_cvt_pk_bf16_f32 v70, v172, v173
v_cvt_pk_bf16_f32 v71, v174, v175
buffer_store_dwordx4 v[64:67], v11, s[44:47], s61 offen sc1
buffer_store_dwordx4 v[68:71], v11, s[44:47], s61 offen offset:1024 sc1
s_add_u32 s61, s60, 4096
v_cvt_pk_bf16_f32 v72, v176, v177
v_cvt_pk_bf16_f32 v73, v178, v179
v_cvt_pk_bf16_f32 v74, v180, v181
v_cvt_pk_bf16_f32 v75, v182, v183
v_cvt_pk_bf16_f32 v76, v184, v185
v_cvt_pk_bf16_f32 v77, v186, v187
v_cvt_pk_bf16_f32 v78, v188, v189
v_cvt_pk_bf16_f32 v79, v190, v191
buffer_store_dwordx4 v[72:75], v11, s[44:47], s61 offen sc1
buffer_store_dwordx4 v[76:79], v11, s[44:47], s61 offen offset:1024 sc1
v_pk_fma_f32 v[104:105], v[232:233], v[48:49], v[104:105] op_sel_hi:[0,1,1]
v_pk_fma_f32 v[120:121], v[232:233], v[50:51], v[120:121] op_sel_hi:[0,1,1] neg_lo:[1,0,0] neg_hi:[1,0,0]
v_pk_fma_f32 v[104:105], v[232:233], v[50:51], v[104:105] op_sel:[1,0,0] neg_lo:[1,0,0] neg_hi:[1,0,0]
v_pk_fma_f32 v[120:121], v[232:233], v[48:49], v[120:121] op_sel:[1,0,0] neg_lo:[1,0,0] neg_hi:[1,0,0]
v_cvt_pk_bf16_f32 v140, v104, v105
v_cvt_pk_bf16_f32 v156, v120, v121
v_pk_fma_f32 v[106:107], v[234:235], v[48:49], v[106:107] op_sel_hi:[0,1,1]
v_pk_fma_f32 v[122:123], v[234:235], v[50:51], v[122:123] op_sel_hi:[0,1,1] neg_lo:[1,0,0] neg_hi:[1,0,0]
v_pk_fma_f32 v[106:107], v[234:235], v[50:51], v[106:107] op_sel:[1,0,0] neg_lo:[1,0,0] neg_hi:[1,0,0]
v_pk_fma_f32 v[122:123], v[234:235], v[48:49], v[122:123] op_sel:[1,0,0] neg_lo:[1,0,0] neg_hi:[1,0,0]
v_cvt_pk_bf16_f32 v141, v106, v107
v_cvt_pk_bf16_f32 v157, v122, v123
v_pk_fma_f32 v[108:109], v[236:237], v[48:49], v[108:109] op_sel_hi:[0,1,1]
v_pk_fma_f32 v[124:125], v[236:237], v[50:51], v[124:125] op_sel_hi:[0,1,1] neg_lo:[1,0,0] neg_hi:[1,0,0]
v_pk_fma_f32 v[108:109], v[236:237], v[50:51], v[108:109] op_sel:[1,0,0] neg_lo:[1,0,0] neg_hi:[1,0,0]
v_pk_fma_f32 v[124:125], v[236:237], v[48:49], v[124:125] op_sel:[1,0,0] neg_lo:[1,0,0] neg_hi:[1,0,0]
v_cvt_pk_bf16_f32 v142, v108, v109
v_cvt_pk_bf16_f32 v158, v124, v125
v_pk_fma_f32 v[110:111], v[238:239], v[48:49], v[110:111] op_sel_hi:[0,1,1]
v_pk_fma_f32 v[126:127], v[238:239], v[50:51], v[126:127] op_sel_hi:[0,1,1] neg_lo:[1,0,0] neg_hi:[1,0,0]
v_pk_fma_f32 v[110:111], v[238:239], v[50:51], v[110:111] op_sel:[1,0,0] neg_lo:[1,0,0] neg_hi:[1,0,0]
v_pk_fma_f32 v[126:127], v[238:239], v[48:49], v[126:127] op_sel:[1,0,0] neg_lo:[1,0,0] neg_hi:[1,0,0]
v_cvt_pk_bf16_f32 v143, v110, v111
v_cvt_pk_bf16_f32 v159, v126, v127
v_mfma_f32_32x32x16_bf16 v[192:207], v[136:139], v[248:251], 0
v_mfma_f32_32x32x16_bf16 v[192:207], v[140:143], v[252:255], v[192:207]
v_mfma_f32_32x32x16_bf16 v[32:47], v[152:155], v[248:251], 0
v_mfma_f32_32x32x16_bf16 v[32:47], v[156:159], v[252:255], v[32:47]
s_add_u32 s61, s60, 131072
s_nop 8
v_cvt_pk_bf16_f32 v80, v192, v193
v_cvt_pk_bf16_f32 v81, v194, v195
v_cvt_pk_bf16_f32 v82, v196, v197
v_cvt_pk_bf16_f32 v83, v198, v199
v_cvt_pk_bf16_f32 v84, v200, v201
v_cvt_pk_bf16_f32 v85, v202, v203
v_cvt_pk_bf16_f32 v86, v204, v205
v_cvt_pk_bf16_f32 v87, v206, v207
buffer_store_dwordx4 v[80:83], v11, s[44:47], s61 offen sc1
buffer_store_dwordx4 v[84:87], v11, s[44:47], s61 offen offset:1024 sc1
s_add_u32 s61, s60, 135168
v_cvt_pk_bf16_f32 v88, v32, v33
v_cvt_pk_bf16_f32 v89, v34, v35
v_cvt_pk_bf16_f32 v90, v36, v37
v_cvt_pk_bf16_f32 v91, v38, v39
v_cvt_pk_bf16_f32 v92, v40, v41
v_cvt_pk_bf16_f32 v93, v42, v43
v_cvt_pk_bf16_f32 v94, v44, v45
v_cvt_pk_bf16_f32 v95, v46, v47
buffer_store_dwordx4 v[88:91], v11, s[44:47], s61 offen sc1
buffer_store_dwordx4 v[92:95], v11, s[44:47], s61 offen offset:1024 sc1
v_xor_b32 v20, 0, v7
v_add_u32 v24, 0x10000, v20
v_xor_b32 v21, 32, v7
v_add_u32 v25, 0x10000, v21
v_xor_b32 v22, 64, v7
v_add_u32 v26, 0x10000, v22
v_xor_b32 v23, 96, v7
v_add_u32 v27, 0x10000, v23
s_lshl_b32 s60, s66, 3
v_lshl_add_u32 v17, v5, 2, s60
v_lshlrev_b32 v28, 11, v17
v_lshl_add_u32 v28, v6, 2, v28
v_lshlrev_b32 v29, 13, v17
v_lshl_add_u32 v29, v6, 3, v29
v_lshlrev_b32 v30, 2, v6
v_mov_b32 v2, v11
s_xor_b32 s60, s68, s101
s_xor_b32 s60, s60, 1
s_lshl_b32 s60, s60, 6
s_add_u32 s60, s60, s66
v_lshrrev_b32 v8, 3, v1
v_lshl_add_u32 v8, v8, 1, s60
v_lshlrev_b32 v8, 11, v8
v_and_b32 v9, 7, v1
v_lshrrev_b32 v10, 4, v1
v_xor_b32 v9, v9, v10
v_lshlrev_b32 v9, 4, v9
v_xor_b32 v10, 64, v9
v_add_u32 v144, v8, v9
v_add_u32 v145, v8, v10
v_add_u32 v145, 31744, v145
v_add_u32 v146, v8, v9
v_add_u32 v146, 63488, v146
v_add_u32 v147, v8, v10
v_add_u32 v147, 95232, v147
s_and_b32 s60, s36, 7
s_lshl_b32 s60, s60, 18
s_lshl_b32 s61, s101, 10
s_add_u32 s60, s60, s61
s_add_u32 s48, s20, s60
s_addc_u32 s49, s21, 0
s_sub_u32 s50, 262144, s61
s_mov_b32 s51, 0x20000
s_add_u32 s52, s22, s60
s_addc_u32 s53, s23, 0
s_sub_u32 s54, 262144, s61
s_mov_b32 s55, 0x20000
s_lshl_b32 s67, s34, 12
s_lshr_b32 s64, s35, 2
s_mul_i32 s64, s64, 256
s_and_b32 s60, s35, 0
s_mul_i32 s60, s60, 1024
s_add_u32 s64, s64, s60
s_lshl_b32 s65, s64, 6
s_and_b32 s61, s36, 7
s_lshl_b32 s61, s61, 1
s_add_u32 s61, s61, s101
s_lshl_b32 s61, s61, 7
s_lshl_b32 s60, s69, 17
s_add_u32 s60, s60, s61
s_add_u32 s56, s10, s60
s_addc_u32 s57, s11, 0
s_sub_u32 s58, 131072, s61
s_mov_b32 s59, 0x20000
s_add_u32 s26, s26, s61
s_addc_u32 s27, s27, 0
s_lshl_b32 s61, s61, 1
s_add_u32 s61, s61, 4096
s_lshl_b32 s60, s69, 19
s_add_u32 s60, s60, s61
s_add_u32 s28, s28, s60
s_addc_u32 s29, s29, 0
s_sub_u32 s24, 0x80000, s61
s_lshl_b32 s60, s35, 2
s_add_u32 s60, s60, s34
s_lshl_b32 s60, s60, 17
s_lshl_b32 s61, s101, 16
s_add_u32 s60, s60, s61
s_add_u32 s42, s60, 1048576
s_add_u32 s40, s32, s42
s_addc_u32 s41, s33, 0
s_mov_b32 s42, 65536
s_mov_b32 s43, 0x20000
s_add_u32 m0, s67, 0
s_add_u32 s62, s64, 0
s_and_b32 s62, s62, 0x3ff
buffer_load_dwordx4 v144, s[48:51], s62 offen offset:0 lds
buffer_load_dwordx4 v145, s[48:51], s62 offen offset:1024 lds
buffer_load_dwordx4 v146, s[48:51], s62 offen offset:2048 lds
buffer_load_dwordx4 v147, s[48:51], s62 offen offset:3072 lds
s_add_u32 m0, s67, 16384
s_nop 0
buffer_load_dwordx4 v144, s[52:55], s62 offen offset:0 lds
buffer_load_dwordx4 v145, s[52:55], s62 offen offset:1024 lds
buffer_load_dwordx4 v146, s[52:55], s62 offen offset:2048 lds
buffer_load_dwordx4 v147, s[52:55], s62 offen offset:3072 lds
v_mov_b32 v15, s37
s_waitcnt vmcnt(8)
s_mov_b64 exec, 1
s_cmp_eq_u32 s100, 0
s_cbranch_scc1 L_rs48
global_store_dword v19, v15, s[32:33]
s_branch L_rd49
L_rs48:
global_store_dword v19, v15, s[32:33] sc1
L_rd49:
s_mov_b64 exec, -1
s_mov_b32 s92, 0
L_w50:
global_load_dword v8, v18, s[32:33] sc1
s_waitcnt vmcnt(0)
v_cmp_ne_u32 vcc, s37, v8
s_nop 0
s_cbranch_vccz L_wd51
s_sleep 4
s_add_u32 s92, s92, 1
s_cmp_lt_u32 s92, 200000
s_cbranch_scc1 L_w50
L_wd51:
v_mov_b32 v14, 2
s_mov_b64 exec, 1
ds_write_b32 v13, v14
s_mov_b64 exec, -1
s_add_u32 m0, s67, 32768
s_add_u32 s62, s64, 128
s_and_b32 s62, s62, 0x3ff
buffer_load_dwordx4 v144, s[48:51], s62 offen offset:0 lds
buffer_load_dwordx4 v145, s[48:51], s62 offen offset:1024 lds
buffer_load_dwordx4 v146, s[48:51], s62 offen offset:2048 lds
buffer_load_dwordx4 v147, s[48:51], s62 offen offset:3072 lds
s_add_u32 s63, s65, 0
s_and_b32 s63, s63, 0xffff
buffer_load_dwordx4 v[148:151], v2, s[40:43], s63 offen offset:0 sc1
buffer_load_dwordx4 v[152:155], v2, s[40:43], s63 offen offset:1024 sc1
buffer_load_dwordx4 v[156:159], v2, s[40:43], s63 offen offset:2048 sc1
buffer_load_dwordx4 v[160:163], v2, s[40:43], s63 offen offset:3072 sc1
s_add_u32 m0, s67, 49152
s_nop 0
buffer_load_dwordx4 v144, s[52:55], s62 offen offset:0 lds
buffer_load_dwordx4 v145, s[52:55], s62 offen offset:1024 lds
buffer_load_dwordx4 v146, s[52:55], s62 offen offset:2048 lds
buffer_load_dwordx4 v147, s[52:55], s62 offen offset:3072 lds
s_add_u32 s63, s65, 4096
s_and_b32 s63, s63, 0xffff
buffer_load_dwordx4 v[164:167], v2, s[40:43], s63 offen offset:0 sc1
buffer_load_dwordx4 v[168:171], v2, s[40:43], s63 offen offset:1024 sc1
buffer_load_dwordx4 v[172:175], v2, s[40:43], s63 offen offset:2048 sc1
buffer_load_dwordx4 v[176:179], v2, s[40:43], s63 offen offset:3072 sc1
s_add_u32 s63, s65, 8192
s_and_b32 s63, s63, 0xffff
buffer_load_dwordx4 v[180:183], v2, s[40:43], s63 offen offset:0 sc1
buffer_load_dwordx4 v[184:187], v2, s[40:43], s63 offen offset:1024 sc1
buffer_load_dwordx4 v[188:191], v2, s[40:43], s63 offen offset:2048 sc1
buffer_load_dwordx4 v[192:195], v2, s[40:43], s63 offen offset:3072 sc1
ds_read_b128 v[8:11], v12 offset:16
s_waitcnt lgkmcnt(0)
L_ck52:
v_min3_u32 v15, v8, v9, v10
v_min_u32 v15, v15, v11
s_nop 0
v_readfirstlane_b32 s60, v15
s_nop 0
s_cmp_ge_u32 s60, 2
s_cbranch_scc1 L_ckd53
ds_read_b128 v[8:11], v12 offset:16
s_waitcnt lgkmcnt(0)
s_branch L_ck52
L_ckd53:
ds_read_b128 v[8:11], v12
s_waitcnt lgkmcnt(0)
L_ck54:
v_min3_u32 v15, v8, v9, v10
v_min_u32 v15, v15, v11
s_nop 0
v_readfirstlane_b32 s60, v15
s_nop 0
s_cmp_ge_u32 s60, 2
s_cbranch_scc1 L_ckd55
ds_read_b128 v[8:11], v12 offset:0
s_waitcnt lgkmcnt(0)
s_branch L_ck54
L_ckd55:
ds_read_b128 v[96:99], v20 offset:0
ds_read_b128 v[100:103], v20 offset:4096
ds_read_b128 v[104:107], v20 offset:8192
ds_read_b128 v[108:111], v20 offset:12288
s_waitcnt vmcnt(15) lgkmcnt(3)
v_mfma_f32_32x32x16_bf16 v[32:47], v[148:151], v[96:99], 0
ds_read_b128 v[112:115], v21 offset:0
ds_read_b128 v[116:119], v21 offset:4096
s_waitcnt lgkmcnt(4)
v_mfma_f32_32x32x16_bf16 v[48:63], v[148:151], v[100:103], 0
ds_read_b128 v[120:123], v21 offset:8192
ds_read_b128 v[124:127], v21 offset:12288
s_waitcnt lgkmcnt(5)
v_mfma_f32_32x32x16_bf16 v[64:79], v[148:151], v[104:107], 0
s_add_u32 m0, s67, 65536
s_add_u32 s62, s64, 256
s_and_b32 s62, s62, 0x3ff
buffer_load_dwordx4 v144, s[48:51], s62 offen offset:0 lds
s_waitcnt lgkmcnt(4)
v_mfma_f32_32x32x16_bf16 v[80:95], v[148:151], v[108:111], 0
s_add_u32 s63, s65, 12288
s_and_b32 s63, s63, 0xffff
buffer_load_dwordx4 v[148:151], v2, s[40:43], s63 offen offset:0 sc1
s_waitcnt vmcnt(16) lgkmcnt(3)
v_mfma_f32_32x32x16_bf16 v[32:47], v[152:155], v[112:115], v[32:47]
ds_read_b128 v[96:99], v22 offset:0
ds_read_b128 v[100:103], v22 offset:4096
s_waitcnt lgkmcnt(4)
v_mfma_f32_32x32x16_bf16 v[48:63], v[152:155], v[116:119], v[48:63]
ds_read_b128 v[104:107], v22 offset:8192
ds_read_b128 v[108:111], v22 offset:12288
s_waitcnt lgkmcnt(5)
v_mfma_f32_32x32x16_bf16 v[64:79], v[152:155], v[120:123], v[64:79]
buffer_load_dwordx4 v145, s[48:51], s62 offen offset:1024 lds
s_waitcnt lgkmcnt(4)
v_mfma_f32_32x32x16_bf16 v[80:95], v[152:155], v[124:127], v[80:95]
buffer_load_dwordx4 v[152:155], v2, s[40:43], s63 offen offset:1024 sc1
s_waitcnt vmcnt(17) lgkmcnt(3)
v_mfma_f32_32x32x16_bf16 v[32:47], v[156:159], v[96:99], v[32:47]
ds_read_b128 v[112:115], v23 offset:0
ds_read_b128 v[116:119], v23 offset:4096
s_waitcnt lgkmcnt(4)
v_mfma_f32_32x32x16_bf16 v[48:63], v[156:159], v[100:103], v[48:63]
ds_read_b128 v[120:123], v23 offset:8192
ds_read_b128 v[124:127], v23 offset:12288
s_waitcnt lgkmcnt(5)
v_mfma_f32_32x32x16_bf16 v[64:79], v[156:159], v[104:107], v[64:79]
buffer_load_dwordx4 v146, s[48:51], s62 offen offset:2048 lds
s_waitcnt lgkmcnt(4)
v_mfma_f32_32x32x16_bf16 v[80:95], v[156:159], v[108:111], v[80:95]
buffer_load_dwordx4 v[156:159], v2, s[40:43], s63 offen offset:2048 sc1
s_waitcnt vmcnt(18) lgkmcnt(3)
v_mfma_f32_32x32x16_bf16 v[32:47], v[160:163], v[112:115], v[32:47]
ds_read_b128 v[96:99], v20 offset:16384
ds_read_b128 v[100:103], v20 offset:20480
s_waitcnt lgkmcnt(4)
v_mfma_f32_32x32x16_bf16 v[48:63], v[160:163], v[116:119], v[48:63]
ds_read_b128 v[104:107], v20 offset:24576
ds_read_b128 v[108:111], v20 offset:28672
s_waitcnt lgkmcnt(5)
v_mfma_f32_32x32x16_bf16 v[64:79], v[160:163], v[120:123], v[64:79]
buffer_load_dwordx4 v147, s[48:51], s62 offen offset:3072 lds
s_waitcnt lgkmcnt(4)
v_mfma_f32_32x32x16_bf16 v[80:95], v[160:163], v[124:127], v[80:95]
buffer_load_dwordx4 v[160:163], v2, s[40:43], s63 offen offset:3072 sc1
s_waitcnt vmcnt(15) lgkmcnt(3)
v_mov_b32 v14, 3
s_mov_b64 exec, 1
ds_write_b32 v13, v14
s_mov_b64 exec, -1
v_mfma_f32_32x32x16_bf16 v[32:47], v[164:167], v[96:99], v[32:47]
ds_read_b128 v[112:115], v21 offset:16384
ds_read_b128 v[116:119], v21 offset:20480
s_waitcnt lgkmcnt(5)
v_mfma_f32_32x32x16_bf16 v[48:63], v[164:167], v[100:103], v[48:63]
ds_read_b128 v[120:123], v21 offset:24576
ds_read_b128 v[124:127], v21 offset:28672
s_waitcnt lgkmcnt(6)
v_mfma_f32_32x32x16_bf16 v[64:79], v[164:167], v[104:107], v[64:79]
s_add_u32 m0, s67, 81920
s_nop 0
buffer_load_dwordx4 v144, s[52:55], s62 offen offset:0 lds
s_waitcnt lgkmcnt(5)
v_mfma_f32_32x32x16_bf16 v[80:95], v[164:167], v[108:111], v[80:95]
s_add_u32 s63, s65, 16384
s_and_b32 s63, s63, 0xffff
buffer_load_dwordx4 v[164:167], v2, s[40:43], s63 offen offset:0 sc1
s_waitcnt vmcnt(16) lgkmcnt(3)
v_mfma_f32_32x32x16_bf16 v[32:47], v[168:171], v[112:115], v[32:47]
ds_read_b128 v[96:99], v22 offset:16384
ds_read_b128 v[100:103], v22 offset:20480
s_waitcnt lgkmcnt(4)
v_mfma_f32_32x32x16_bf16 v[48:63], v[168:171], v[116:119], v[48:63]
ds_read_b128 v[104:107], v22 offset:24576
ds_read_b128 v[108:111], v22 offset:28672
s_waitcnt lgkmcnt(5)
v_mfma_f32_32x32x16_bf16 v[64:79], v[168:171], v[120:123], v[64:79]
buffer_load_dwordx4 v145, s[52:55], s62 offen offset:1024 lds
s_waitcnt lgkmcnt(4)
v_mfma_f32_32x32x16_bf16 v[80:95], v[168:171], v[124:127], v[80:95]
buffer_load_dwordx4 v[168:171], v2, s[40:43], s63 offen offset:1024 sc1
s_waitcnt vmcnt(17) lgkmcnt(3)
v_mfma_f32_32x32x16_bf16 v[32:47], v[172:175], v[96:99], v[32:47]
ds_read_b128 v[112:115], v23 offset:16384
ds_read_b128 v[116:119], v23 offset:20480
s_waitcnt lgkmcnt(4)
v_mfma_f32_32x32x16_bf16 v[48:63], v[172:175], v[100:103], v[48:63]
ds_read_b128 v[120:123], v23 offset:24576
ds_read_b128 v[124:127], v23 offset:28672
s_waitcnt lgkmcnt(5)
v_mfma_f32_32x32x16_bf16 v[64:79], v[172:175], v[104:107], v[64:79]
buffer_load_dwordx4 v146, s[52:55], s62 offen offset:2048 lds
s_waitcnt lgkmcnt(4)
v_mfma_f32_32x32x16_bf16 v[80:95], v[172:175], v[108:111], v[80:95]
buffer_load_dwordx4 v[172:175], v2, s[40:43], s63 offen offset:2048 sc1
ds_read_b128 v[8:11], v12
s_waitcnt vmcnt(18) lgkmcnt(0)
L_ck56:
v_min3_u32 v15, v8, v9, v10
v_min_u32 v15, v15, v11
s_nop 0
v_readfirstlane_b32 s60, v15
s_nop 0
s_cmp_ge_u32 s60, 3
s_cbranch_scc1 L_ckd57
ds_read_b128 v[8:11], v12 offset:0
s_waitcnt lgkmcnt(0)
s_branch L_ck56
L_ckd57:
v_mfma_f32_32x32x16_bf16 v[32:47], v[176:179], v[112:115], v[32:47]
ds_read_b128 v[96:99], v20 offset:32768
ds_read_b128 v[100:103], v20 offset:36864
v_mfma_f32_32x32x16_bf16 v[48:63], v[176:179], v[116:119], v[48:63]
ds_read_b128 v[104:107], v20 offset:40960
ds_read_b128 v[108:111], v20 offset:45056
v_mfma_f32_32x32x16_bf16 v[64:79], v[176:179], v[120:123], v[64:79]
buffer_load_dwordx4 v147, s[52:55], s62 offen offset:3072 lds
v_mfma_f32_32x32x16_bf16 v[80:95], v[176:179], v[124:127], v[80:95]
buffer_load_dwordx4 v[176:179], v2, s[40:43], s63 offen offset:3072 sc1
s_waitcnt vmcnt(19) lgkmcnt(3)
v_mfma_f32_32x32x16_bf16 v[32:47], v[180:183], v[96:99], v[32:47]
ds_read_b128 v[112:115], v21 offset:32768
ds_read_b128 v[116:119], v21 offset:36864
s_waitcnt lgkmcnt(4)
v_mfma_f32_32x32x16_bf16 v[48:63], v[180:183], v[100:103], v[48:63]
ds_read_b128 v[120:123], v21 offset:40960
ds_read_b128 v[124:127], v21 offset:45056
s_waitcnt lgkmcnt(5)
v_mfma_f32_32x32x16_bf16 v[64:79], v[180:183], v[104:107], v[64:79]
s_add_u32 m0, s67, 98304
s_add_u32 s62, s64, 384
s_and_b32 s62, s62, 0x3ff
buffer_load_dwordx4 v144, s[48:51], s62 offen offset:0 lds
s_waitcnt lgkmcnt(4)
v_mfma_f32_32x32x16_bf16 v[80:95], v[180:183], v[108:111], v[80:95]
s_add_u32 s63, s65, 20480
s_and_b32 s63, s63, 0xffff
buffer_load_dwordx4 v[180:183], v2, s[40:43], s63 offen offset:0 sc1
s_waitcnt vmcnt(20) lgkmcnt(3)
v_mfma_f32_32x32x16_bf16 v[32:47], v[184:187], v[112:115], v[32:47]
ds_read_b128 v[96:99], v22 offset:32768
ds_read_b128 v[100:103], v22 offset:36864
s_waitcnt lgkmcnt(4)
v_mfma_f32_32x32x16_bf16 v[48:63], v[184:187], v[116:119], v[48:63]
ds_read_b128 v[104:107], v22 offset:40960
ds_read_b128 v[108:111], v22 offset:45056
s_waitcnt lgkmcnt(5)
v_mfma_f32_32x32x16_bf16 v[64:79], v[184:187], v[120:123], v[64:79]
buffer_load_dwordx4 v145, s[48:51], s62 offen offset:1024 lds
s_waitcnt lgkmcnt(4)
v_mfma_f32_32x32x16_bf16 v[80:95], v[184:187], v[124:127], v[80:95]
buffer_load_dwordx4 v[184:187], v2, s[40:43], s63 offen offset:1024 sc1
s_waitcnt vmcnt(21) lgkmcnt(3)
v_mfma_f32_32x32x16_bf16 v[32:47], v[188:191], v[96:99], v[32:47]
ds_read_b128 v[112:115], v23 offset:32768
ds_read_b128 v[116:119], v23 offset:36864
s_waitcnt lgkmcnt(4)
v_mfma_f32_32x32x16_bf16 v[48:63], v[188:191], v[100:103], v[48:63]
ds_read_b128 v[120:123], v23 offset:40960
ds_read_b128 v[124:127], v23 offset:45056
s_waitcnt lgkmcnt(5)
v_mfma_f32_32x32x16_bf16 v[64:79], v[188:191], v[104:107], v[64:79]
buffer_load_dwordx4 v146, s[48:51], s62 offen offset:2048 lds
s_waitcnt lgkmcnt(4)
v_mfma_f32_32x32x16_bf16 v[80:95], v[188:191], v[108:111], v[80:95]
buffer_load_dwordx4 v[188:191], v2, s[40:43], s63 offen offset:2048 sc1
s_waitcnt vmcnt(22) lgkmcnt(3)
v_mfma_f32_32x32x16_bf16 v[32:47], v[192:195], v[112:115], v[32:47]
ds_read_b128 v[96:99], v20 offset:49152
ds_read_b128 v[100:103], v20 offset:53248
s_waitcnt lgkmcnt(4)
v_mfma_f32_32x32x16_bf16 v[48:63], v[192:195], v[116:119], v[48:63]
ds_read_b128 v[104:107], v20 offset:57344
ds_read_b128 v[108:111], v20 offset:61440
s_waitcnt lgkmcnt(5)
v_mfma_f32_32x32x16_bf16 v[64:79], v[192:195], v[120:123], v[64:79]
buffer_load_dwordx4 v147, s[48:51], s62 offen offset:3072 lds
s_waitcnt lgkmcnt(4)
v_mfma_f32_32x32x16_bf16 v[80:95], v[192:195], v[124:127], v[80:95]
buffer_load_dwordx4 v[192:195], v2, s[40:43], s63 offen offset:3072 sc1
s_waitcnt vmcnt(9) lgkmcnt(3)
v_mov_b32 v14, 4
s_mov_b64 exec, 1
ds_write_b32 v13, v14
s_mov_b64 exec, -1
v_mfma_f32_32x32x16_bf16 v[32:47], v[148:151], v[96:99], v[32:47]
ds_read_b128 v[112:115], v21 offset:49152
ds_read_b128 v[116:119], v21 offset:53248
s_waitcnt lgkmcnt(5)
v_mfma_f32_32x32x16_bf16 v[48:63], v[148:151], v[100:103], v[48:63]
ds_read_b128 v[120:123], v21 offset:57344
ds_read_b128 v[124:127], v21 offset:61440
s_waitcnt lgkmcnt(6)
v_mfma_f32_32x32x16_bf16 v[64:79], v[148:151], v[104:107], v[64:79]
s_add_u32 m0, s67, 0
s_nop 0
buffer_load_dwordx4 v144, s[52:55], s62 offen offset:0 lds
s_waitcnt lgkmcnt(5)
v_mfma_f32_32x32x16_bf16 v[80:95], v[148:151], v[108:111], v[80:95]
s_add_u32 s63, s65, 24576
s_and_b32 s63, s63, 0xffff
buffer_load_dwordx4 v[148:151], v2, s[40:43], s63 offen offset:0 sc1
s_waitcnt vmcnt(22) lgkmcnt(3)
v_mfma_f32_32x32x16_bf16 v[32:47], v[152:155], v[112:115], v[32:47]
ds_read_b128 v[96:99], v22 offset:49152
ds_read_b128 v[100:103], v22 offset:53248
s_waitcnt lgkmcnt(4)
v_mfma_f32_32x32x16_bf16 v[48:63], v[152:155], v[116:119], v[48:63]
ds_read_b128 v[104:107], v22 offset:57344
ds_read_b128 v[108:111], v22 offset:61440
s_waitcnt lgkmcnt(5)
v_mfma_f32_32x32x16_bf16 v[64:79], v[152:155], v[120:123], v[64:79]
buffer_load_dwordx4 v145, s[52:55], s62 offen offset:1024 lds
s_waitcnt lgkmcnt(4)
v_mfma_f32_32x32x16_bf16 v[80:95], v[152:155], v[124:127], v[80:95]
buffer_load_dwordx4 v[152:155], v2, s[40:43], s63 offen offset:1024 sc1
s_waitcnt vmcnt(22) lgkmcnt(3)
v_mfma_f32_32x32x16_bf16 v[32:47], v[156:159], v[96:99], v[32:47]
ds_read_b128 v[112:115], v23 offset:49152
ds_read_b128 v[116:119], v23 offset:53248
s_waitcnt lgkmcnt(4)
v_mfma_f32_32x32x16_bf16 v[48:63], v[156:159], v[100:103], v[48:63]
ds_read_b128 v[120:123], v23 offset:57344
ds_read_b128 v[124:127], v23 offset:61440
s_waitcnt lgkmcnt(5)
v_mfma_f32_32x32x16_bf16 v[64:79], v[156:159], v[104:107], v[64:79]
buffer_load_dwordx4 v146, s[52:55], s62 offen offset:2048 lds
s_waitcnt lgkmcnt(4)
v_mfma_f32_32x32x16_bf16 v[80:95], v[156:159], v[108:111], v[80:95]
buffer_load_dwordx4 v[156:159], v2, s[40:43], s63 offen offset:2048 sc1
ds_read_b128 v[8:11], v12
s_waitcnt vmcnt(22) lgkmcnt(0)
L_ck58:
v_min3_u32 v15, v8, v9, v10
v_min_u32 v15, v15, v11
s_nop 0
v_readfirstlane_b32 s60, v15
s_nop 0
s_cmp_ge_u32 s60, 4
s_cbranch_scc1 L_ckd59
ds_read_b128 v[8:11], v12 offset:0
s_waitcnt lgkmcnt(0)
s_branch L_ck58
L_ckd59:
v_mfma_f32_32x32x16_bf16 v[32:47], v[160:163], v[112:115], v[32:47]
ds_read_b128 v[96:99], v24 offset:0
ds_read_b128 v[100:103], v24 offset:4096
v_mfma_f32_32x32x16_bf16 v[48:63], v[160:163], v[116:119], v[48:63]
ds_read_b128 v[104:107], v24 offset:8192
ds_read_b128 v[108:111], v24 offset:12288
v_mfma_f32_32x32x16_bf16 v[64:79], v[160:163], v[120:123], v[64:79]
buffer_load_dwordx4 v147, s[52:55], s62 offen offset:3072 lds
v_mfma_f32_32x32x16_bf16 v[80:95], v[160:163], v[124:127], v[80:95]
buffer_load_dwordx4 v[160:163], v2, s[40:43], s63 offen offset:3072 sc1
s_waitcnt vmcnt(22) lgkmcnt(3)
v_mfma_f32_32x32x16_bf16 v[32:47], v[164:167], v[96:99], v[32:47]
ds_read_b128 v[112:115], v25 offset:0
ds_read_b128 v[116:119], v25 offset:4096
s_waitcnt lgkmcnt(4)
v_mfma_f32_32x32x16_bf16 v[48:63], v[164:167], v[100:103], v[48:63]
ds_read_b128 v[120:123], v25 offset:8192
ds_read_b128 v[124:127], v25 offset:12288
s_waitcnt lgkmcnt(5)
v_mfma_f32_32x32x16_bf16 v[64:79], v[164:167], v[104:107], v[64:79]
s_add_u32 m0, s67, 16384
s_add_u32 s62, s64, 512
s_and_b32 s62, s62, 0x3ff
buffer_load_dwordx4 v144, s[48:51], s62 offen offset:0 lds
s_waitcnt lgkmcnt(4)
v_mfma_f32_32x32x16_bf16 v[80:95], v[164:167], v[108:111], v[80:95]
s_add_u32 s63, s65, 28672
s_and_b32 s63, s63, 0xffff
buffer_load_dwordx4 v[164:167], v2, s[40:43], s63 offen offset:0 sc1
s_waitcnt vmcnt(22) lgkmcnt(3)
v_mfma_f32_32x32x16_bf16 v[32:47], v[168:171], v[112:115], v[32:47]
ds_read_b128 v[96:99], v26 offset:0
ds_read_b128 v[100:103], v26 offset:4096
s_waitcnt lgkmcnt(4)
v_mfma_f32_32x32x16_bf16 v[48:63], v[168:171], v[116:119], v[48:63]
ds_read_b128 v[104:107], v26 offset:8192
ds_read_b128 v[108:111], v26 offset:12288
s_waitcnt lgkmcnt(5)
v_mfma_f32_32x32x16_bf16 v[64:79], v[168:171], v[120:123], v[64:79]
buffer_load_dwordx4 v145, s[48:51], s62 offen offset:1024 lds
s_waitcnt lgkmcnt(4)
v_mfma_f32_32x32x16_bf16 v[80:95], v[168:171], v[124:127], v[80:95]
buffer_load_dwordx4 v[168:171], v2, s[40:43], s63 offen offset:1024 sc1
s_waitcnt vmcnt(22) lgkmcnt(3)
v_mfma_f32_32x32x16_bf16 v[32:47], v[172:175], v[96:99], v[32:47]
ds_read_b128 v[112:115], v27 offset:0
ds_read_b128 v[116:119], v27 offset:4096
s_waitcnt lgkmcnt(4)
v_mfma_f32_32x32x16_bf16 v[48:63], v[172:175], v[100:103], v[48:63]
ds_read_b128 v[120:123], v27 offset:8192
ds_read_b128 v[124:127], v27 offset:12288
s_waitcnt lgkmcnt(5)
v_mfma_f32_32x32x16_bf16 v[64:79], v[172:175], v[104:107], v[64:79]
buffer_load_dwordx4 v146, s[48:51], s62 offen offset:2048 lds
s_waitcnt lgkmcnt(4)
v_mfma_f32_32x32x16_bf16 v[80:95], v[172:175], v[108:111], v[80:95]
buffer_load_dwordx4 v[172:175], v2, s[40:43], s63 offen offset:2048 sc1
s_waitcnt vmcnt(22) lgkmcnt(3)
v_mfma_f32_32x32x16_bf16 v[32:47], v[176:179], v[112:115], v[32:47]
ds_read_b128 v[96:99], v24 offset:16384
ds_read_b128 v[100:103], v24 offset:20480
s_waitcnt lgkmcnt(4)
v_mfma_f32_32x32x16_bf16 v[48:63], v[176:179], v[116:119], v[48:63]
ds_read_b128 v[104:107], v24 offset:24576
ds_read_b128 v[108:111], v24 offset:28672
s_waitcnt lgkmcnt(5)
v_mfma_f32_32x32x16_bf16 v[64:79], v[176:179], v[120:123], v[64:79]
buffer_load_dwordx4 v147, s[48:51], s62 offen offset:3072 lds
s_waitcnt lgkmcnt(4)
v_mfma_f32_32x32x16_bf16 v[80:95], v[176:179], v[124:127], v[80:95]
buffer_load_dwordx4 v[176:179], v2, s[40:43], s63 offen offset:3072 sc1
s_waitcnt vmcnt(9) lgkmcnt(3)
v_mov_b32 v14, 5
s_mov_b64 exec, 1
ds_write_b32 v13, v14
s_mov_b64 exec, -1
v_mfma_f32_32x32x16_bf16 v[32:47], v[180:183], v[96:99], v[32:47]
ds_read_b128 v[112:115], v25 offset:16384
ds_read_b128 v[116:119], v25 offset:20480
s_waitcnt lgkmcnt(5)
v_mfma_f32_32x32x16_bf16 v[48:63], v[180:183], v[100:103], v[48:63]
ds_read_b128 v[120:123], v25 offset:24576
ds_read_b128 v[124:127], v25 offset:28672
s_waitcnt lgkmcnt(6)
v_mfma_f32_32x32x16_bf16 v[64:79], v[180:183], v[104:107], v[64:79]
s_add_u32 m0, s67, 32768
s_nop 0
buffer_load_dwordx4 v144, s[52:55], s62 offen offset:0 lds
s_waitcnt lgkmcnt(5)
v_mfma_f32_32x32x16_bf16 v[80:95], v[180:183], v[108:111], v[80:95]
s_add_u32 s63, s65, 32768
s_and_b32 s63, s63, 0xffff
buffer_load_dwordx4 v[180:183], v2, s[40:43], s63 offen offset:0 sc1
s_waitcnt vmcnt(22) lgkmcnt(3)
v_mfma_f32_32x32x16_bf16 v[32:47], v[184:187], v[112:115], v[32:47]
ds_read_b128 v[96:99], v26 offset:16384
ds_read_b128 v[100:103], v26 offset:20480
s_waitcnt lgkmcnt(4)
v_mfma_f32_32x32x16_bf16 v[48:63], v[184:187], v[116:119], v[48:63]
ds_read_b128 v[104:107], v26 offset:24576
ds_read_b128 v[108:111], v26 offset:28672
s_waitcnt lgkmcnt(5)
v_mfma_f32_32x32x16_bf16 v[64:79], v[184:187], v[120:123], v[64:79]
buffer_load_dwordx4 v145, s[52:55], s62 offen offset:1024 lds
s_waitcnt lgkmcnt(4)
v_mfma_f32_32x32x16_bf16 v[80:95], v[184:187], v[124:127], v[80:95]
buffer_load_dwordx4 v[184:187], v2, s[40:43], s63 offen offset:1024 sc1
s_waitcnt vmcnt(22) lgkmcnt(3)
v_mfma_f32_32x32x16_bf16 v[32:47], v[188:191], v[96:99], v[32:47]
ds_read_b128 v[112:115], v27 offset:16384
ds_read_b128 v[116:119], v27 offset:20480
s_waitcnt lgkmcnt(4)
v_mfma_f32_32x32x16_bf16 v[48:63], v[188:191], v[100:103], v[48:63]
ds_read_b128 v[120:123], v27 offset:24576
ds_read_b128 v[124:127], v27 offset:28672
s_waitcnt lgkmcnt(5)
v_mfma_f32_32x32x16_bf16 v[64:79], v[188:191], v[104:107], v[64:79]
buffer_load_dwordx4 v146, s[52:55], s62 offen offset:2048 lds
s_waitcnt lgkmcnt(4)
v_mfma_f32_32x32x16_bf16 v[80:95], v[188:191], v[108:111], v[80:95]
buffer_load_dwordx4 v[188:191], v2, s[40:43], s63 offen offset:2048 sc1
ds_read_b128 v[8:11], v12
s_waitcnt vmcnt(22) lgkmcnt(0)
L_ck60:
v_min3_u32 v15, v8, v9, v10
v_min_u32 v15, v15, v11
s_nop 0
v_readfirstlane_b32 s60, v15
s_nop 0
s_cmp_ge_u32 s60, 5
s_cbranch_scc1 L_ckd61
ds_read_b128 v[8:11], v12 offset:0
s_waitcnt lgkmcnt(0)
s_branch L_ck60
L_ckd61:
v_mfma_f32_32x32x16_bf16 v[32:47], v[192:195], v[112:115], v[32:47]
ds_read_b128 v[96:99], v24 offset:32768
ds_read_b128 v[100:103], v24 offset:36864
v_mfma_f32_32x32x16_bf16 v[48:63], v[192:195], v[116:119], v[48:63]
ds_read_b128 v[104:107], v24 offset:40960
ds_read_b128 v[108:111], v24 offset:45056
v_mfma_f32_32x32x16_bf16 v[64:79], v[192:195], v[120:123], v[64:79]
buffer_load_dwordx4 v147, s[52:55], s62 offen offset:3072 lds
v_mfma_f32_32x32x16_bf16 v[80:95], v[192:195], v[124:127], v[80:95]
buffer_load_dwordx4 v[192:195], v2, s[40:43], s63 offen offset:3072 sc1
s_waitcnt vmcnt(22) lgkmcnt(3)
v_mfma_f32_32x32x16_bf16 v[32:47], v[148:151], v[96:99], v[32:47]
ds_read_b128 v[112:115], v25 offset:32768
ds_read_b128 v[116:119], v25 offset:36864
s_waitcnt lgkmcnt(4)
v_mfma_f32_32x32x16_bf16 v[48:63], v[148:151], v[100:103], v[48:63]
ds_read_b128 v[120:123], v25 offset:40960
ds_read_b128 v[124:127], v25 offset:45056
s_waitcnt lgkmcnt(5)
v_mfma_f32_32x32x16_bf16 v[64:79], v[148:151], v[104:107], v[64:79]
s_add_u32 m0, s67, 49152
s_add_u32 s62, s64, 640
s_and_b32 s62, s62, 0x3ff
buffer_load_dwordx4 v144, s[48:51], s62 offen offset:0 lds
s_waitcnt lgkmcnt(4)
v_mfma_f32_32x32x16_bf16 v[80:95], v[148:151], v[108:111], v[80:95]
s_add_u32 s63, s65, 36864
s_and_b32 s63, s63, 0xffff
buffer_load_dwordx4 v[148:151], v2, s[40:43], s63 offen offset:0 sc1
s_waitcnt vmcnt(22) lgkmcnt(3)
v_mfma_f32_32x32x16_bf16 v[32:47], v[152:155], v[112:115], v[32:47]
ds_read_b128 v[96:99], v26 offset:32768
ds_read_b128 v[100:103], v26 offset:36864
s_waitcnt lgkmcnt(4)
v_mfma_f32_32x32x16_bf16 v[48:63], v[152:155], v[116:119], v[48:63]
ds_read_b128 v[104:107], v26 offset:40960
ds_read_b128 v[108:111], v26 offset:45056
s_waitcnt lgkmcnt(5)
v_mfma_f32_32x32x16_bf16 v[64:79], v[152:155], v[120:123], v[64:79]
buffer_load_dwordx4 v145, s[48:51], s62 offen offset:1024 lds
s_waitcnt lgkmcnt(4)
v_mfma_f32_32x32x16_bf16 v[80:95], v[152:155], v[124:127], v[80:95]
buffer_load_dwordx4 v[152:155], v2, s[40:43], s63 offen offset:1024 sc1
s_waitcnt vmcnt(22) lgkmcnt(3)
v_mfma_f32_32x32x16_bf16 v[32:47], v[156:159], v[96:99], v[32:47]
ds_read_b128 v[112:115], v27 offset:32768
ds_read_b128 v[116:119], v27 offset:36864
s_waitcnt lgkmcnt(4)
v_mfma_f32_32x32x16_bf16 v[48:63], v[156:159], v[100:103], v[48:63]
ds_read_b128 v[120:123], v27 offset:40960
ds_read_b128 v[124:127], v27 offset:45056
s_waitcnt lgkmcnt(5)
v_mfma_f32_32x32x16_bf16 v[64:79], v[156:159], v[104:107], v[64:79]
buffer_load_dwordx4 v146, s[48:51], s62 offen offset:2048 lds
s_waitcnt lgkmcnt(4)
v_mfma_f32_32x32x16_bf16 v[80:95], v[156:159], v[108:111], v[80:95]
buffer_load_dwordx4 v[156:159], v2, s[40:43], s63 offen offset:2048 sc1
s_waitcnt vmcnt(22) lgkmcnt(3)
v_mfma_f32_32x32x16_bf16 v[32:47], v[160:163], v[112:115], v[32:47]
ds_read_b128 v[96:99], v20 offset:0
ds_read_b128 v[100:103], v20 offset:4096
s_waitcnt lgkmcnt(4)
v_mfma_f32_32x32x16_bf16 v[48:63], v[160:163], v[116:119], v[48:63]
ds_read_b128 v[104:107], v20 offset:8192
ds_read_b128 v[108:111], v20 offset:12288
s_waitcnt lgkmcnt(5)
v_mfma_f32_32x32x16_bf16 v[64:79], v[160:163], v[120:123], v[64:79]
buffer_load_dwordx4 v147, s[48:51], s62 offen offset:3072 lds
s_waitcnt lgkmcnt(4)
v_mfma_f32_32x32x16_bf16 v[80:95], v[160:163], v[124:127], v[80:95]
buffer_load_dwordx4 v[160:163], v2, s[40:43], s63 offen offset:3072 sc1
s_waitcnt vmcnt(9) lgkmcnt(3)
v_mov_b32 v14, 6
s_mov_b64 exec, 1
ds_write_b32 v13, v14
s_mov_b64 exec, -1
v_mfma_f32_32x32x16_bf16 v[32:47], v[164:167], v[96:99], v[32:47]
ds_read_b128 v[112:115], v21 offset:0
ds_read_b128 v[116:119], v21 offset:4096
s_waitcnt lgkmcnt(5)
v_mfma_f32_32x32x16_bf16 v[48:63], v[164:167], v[100:103], v[48:63]
ds_read_b128 v[120:123], v21 offset:8192
ds_read_b128 v[124:127], v21 offset:12288
s_waitcnt lgkmcnt(6)
v_mfma_f32_32x32x16_bf16 v[64:79], v[164:167], v[104:107], v[64:79]
s_add_u32 m0, s67, 65536
s_nop 0
buffer_load_dwordx4 v144, s[52:55], s62 offen offset:0 lds
s_waitcnt lgkmcnt(5)
v_mfma_f32_32x32x16_bf16 v[80:95], v[164:167], v[108:111], v[80:95]
s_add_u32 s63, s65, 40960
s_and_b32 s63, s63, 0xffff
buffer_load_dwordx4 v[164:167], v2, s[40:43], s63 offen offset:0 sc1
s_waitcnt vmcnt(22) lgkmcnt(3)
v_mfma_f32_32x32x16_bf16 v[32:47], v[168:171], v[112:115], v[32:47]
ds_read_b128 v[96:99], v22 offset:0
ds_read_b128 v[100:103], v22 offset:4096
s_waitcnt lgkmcnt(4)
v_mfma_f32_32x32x16_bf16 v[48:63], v[168:171], v[116:119], v[48:63]
ds_read_b128 v[104:107], v22 offset:8192
ds_read_b128 v[108:111], v22 offset:12288
s_waitcnt lgkmcnt(5)
v_mfma_f32_32x32x16_bf16 v[64:79], v[168:171], v[120:123], v[64:79]
buffer_load_dwordx4 v145, s[52:55], s62 offen offset:1024 lds
s_waitcnt lgkmcnt(4)
v_mfma_f32_32x32x16_bf16 v[80:95], v[168:171], v[124:127], v[80:95]
buffer_load_dwordx4 v[168:171], v2, s[40:43], s63 offen offset:1024 sc1
s_waitcnt vmcnt(22) lgkmcnt(3)
v_mfma_f32_32x32x16_bf16 v[32:47], v[172:175], v[96:99], v[32:47]
ds_read_b128 v[112:115], v23 offset:0
ds_read_b128 v[116:119], v23 offset:4096
s_waitcnt lgkmcnt(4)
v_mfma_f32_32x32x16_bf16 v[48:63], v[172:175], v[100:103], v[48:63]
ds_read_b128 v[120:123], v23 offset:8192
ds_read_b128 v[124:127], v23 offset:12288
s_waitcnt lgkmcnt(5)
v_mfma_f32_32x32x16_bf16 v[64:79], v[172:175], v[104:107], v[64:79]
buffer_load_dwordx4 v146, s[52:55], s62 offen offset:2048 lds
s_waitcnt lgkmcnt(4)
v_mfma_f32_32x32x16_bf16 v[80:95], v[172:175], v[108:111], v[80:95]
buffer_load_dwordx4 v[172:175], v2, s[40:43], s63 offen offset:2048 sc1
ds_read_b128 v[8:11], v12
s_waitcnt vmcnt(22) lgkmcnt(0)
L_ck62:
v_min3_u32 v15, v8, v9, v10
v_min_u32 v15, v15, v11
s_nop 0
v_readfirstlane_b32 s60, v15
s_nop 0
s_cmp_ge_u32 s60, 6
s_cbranch_scc1 L_ckd63
ds_read_b128 v[8:11], v12 offset:0
s_waitcnt lgkmcnt(0)
s_branch L_ck62
L_ckd63:
v_mfma_f32_32x32x16_bf16 v[32:47], v[176:179], v[112:115], v[32:47]
ds_read_b128 v[96:99], v20 offset:16384
ds_read_b128 v[100:103], v20 offset:20480
v_mfma_f32_32x32x16_bf16 v[48:63], v[176:179], v[116:119], v[48:63]
ds_read_b128 v[104:107], v20 offset:24576
ds_read_b128 v[108:111], v20 offset:28672
v_mfma_f32_32x32x16_bf16 v[64:79], v[176:179], v[120:123], v[64:79]
buffer_load_dwordx4 v147, s[52:55], s62 offen offset:3072 lds
v_mfma_f32_32x32x16_bf16 v[80:95], v[176:179], v[124:127], v[80:95]
buffer_load_dwordx4 v[176:179], v2, s[40:43], s63 offen offset:3072 sc1
s_waitcnt vmcnt(22) lgkmcnt(3)
v_mfma_f32_32x32x16_bf16 v[32:47], v[180:183], v[96:99], v[32:47]
ds_read_b128 v[112:115], v21 offset:16384
ds_read_b128 v[116:119], v21 offset:20480
s_waitcnt lgkmcnt(4)
v_mfma_f32_32x32x16_bf16 v[48:63], v[180:183], v[100:103], v[48:63]
ds_read_b128 v[120:123], v21 offset:24576
ds_read_b128 v[124:127], v21 offset:28672
s_waitcnt lgkmcnt(5)
v_mfma_f32_32x32x16_bf16 v[64:79], v[180:183], v[104:107], v[64:79]
s_add_u32 m0, s67, 81920
s_add_u32 s62, s64, 768
s_and_b32 s62, s62, 0x3ff
buffer_load_dwordx4 v144, s[48:51], s62 offen offset:0 lds
s_waitcnt lgkmcnt(4)
v_mfma_f32_32x32x16_bf16 v[80:95], v[180:183], v[108:111], v[80:95]
s_add_u32 s63, s65, 45056
s_and_b32 s63, s63, 0xffff
buffer_load_dwordx4 v[180:183], v2, s[40:43], s63 offen offset:0 sc1
s_waitcnt vmcnt(22) lgkmcnt(3)
v_mfma_f32_32x32x16_bf16 v[32:47], v[184:187], v[112:115], v[32:47]
ds_read_b128 v[96:99], v22 offset:16384
ds_read_b128 v[100:103], v22 offset:20480
s_waitcnt lgkmcnt(4)
v_mfma_f32_32x32x16_bf16 v[48:63], v[184:187], v[116:119], v[48:63]
ds_read_b128 v[104:107], v22 offset:24576
ds_read_b128 v[108:111], v22 offset:28672
s_waitcnt lgkmcnt(5)
v_mfma_f32_32x32x16_bf16 v[64:79], v[184:187], v[120:123], v[64:79]
buffer_load_dwordx4 v145, s[48:51], s62 offen offset:1024 lds
s_waitcnt lgkmcnt(4)
v_mfma_f32_32x32x16_bf16 v[80:95], v[184:187], v[124:127], v[80:95]
buffer_load_dwordx4 v[184:187], v2, s[40:43], s63 offen offset:1024 sc1
s_waitcnt vmcnt(22) lgkmcnt(3)
v_mfma_f32_32x32x16_bf16 v[32:47], v[188:191], v[96:99], v[32:47]
ds_read_b128 v[112:115], v23 offset:16384
ds_read_b128 v[116:119], v23 offset:20480
s_waitcnt lgkmcnt(4)
v_mfma_f32_32x32x16_bf16 v[48:63], v[188:191], v[100:103], v[48:63]
ds_read_b128 v[120:123], v23 offset:24576
ds_read_b128 v[124:127], v23 offset:28672
s_waitcnt lgkmcnt(5)
v_mfma_f32_32x32x16_bf16 v[64:79], v[188:191], v[104:107], v[64:79]
buffer_load_dwordx4 v146, s[48:51], s62 offen offset:2048 lds
s_waitcnt lgkmcnt(4)
v_mfma_f32_32x32x16_bf16 v[80:95], v[188:191], v[108:111], v[80:95]
buffer_load_dwordx4 v[188:191], v2, s[40:43], s63 offen offset:2048 sc1
s_waitcnt vmcnt(22) lgkmcnt(3)
v_mfma_f32_32x32x16_bf16 v[32:47], v[192:195], v[112:115], v[32:47]
ds_read_b128 v[96:99], v20 offset:32768
ds_read_b128 v[100:103], v20 offset:36864
s_waitcnt lgkmcnt(4)
v_mfma_f32_32x32x16_bf16 v[48:63], v[192:195], v[116:119], v[48:63]
ds_read_b128 v[104:107], v20 offset:40960
ds_read_b128 v[108:111], v20 offset:45056
s_waitcnt lgkmcnt(5)
v_mfma_f32_32x32x16_bf16 v[64:79], v[192:195], v[120:123], v[64:79]
buffer_load_dwordx4 v147, s[48:51], s62 offen offset:3072 lds
s_waitcnt lgkmcnt(4)
v_mfma_f32_32x32x16_bf16 v[80:95], v[192:195], v[124:127], v[80:95]
buffer_load_dwordx4 v[192:195], v2, s[40:43], s63 offen offset:3072 sc1
s_waitcnt vmcnt(9) lgkmcnt(3)
v_mov_b32 v14, 7
s_mov_b64 exec, 1
ds_write_b32 v13, v14
s_mov_b64 exec, -1
v_mfma_f32_32x32x16_bf16 v[32:47], v[148:151], v[96:99], v[32:47]
ds_read_b128 v[112:115], v21 offset:32768
ds_read_b128 v[116:119], v21 offset:36864
s_waitcnt lgkmcnt(5)
v_mfma_f32_32x32x16_bf16 v[48:63], v[148:151], v[100:103], v[48:63]
ds_read_b128 v[120:123], v21 offset:40960
ds_read_b128 v[124:127], v21 offset:45056
s_waitcnt lgkmcnt(6)
v_mfma_f32_32x32x16_bf16 v[64:79], v[148:151], v[104:107], v[64:79]
s_add_u32 m0, s67, 98304
s_nop 0
buffer_load_dwordx4 v144, s[52:55], s62 offen offset:0 lds
s_waitcnt lgkmcnt(5)
v_mfma_f32_32x32x16_bf16 v[80:95], v[148:151], v[108:111], v[80:95]
s_add_u32 s63, s65, 49152
s_and_b32 s63, s63, 0xffff
buffer_load_dwordx4 v[148:151], v2, s[40:43], s63 offen offset:0 sc1
s_waitcnt vmcnt(22) lgkmcnt(3)
v_mfma_f32_32x32x16_bf16 v[32:47], v[152:155], v[112:115], v[32:47]
ds_read_b128 v[96:99], v22 offset:32768
ds_read_b128 v[100:103], v22 offset:36864
s_waitcnt lgkmcnt(4)
v_mfma_f32_32x32x16_bf16 v[48:63], v[152:155], v[116:119], v[48:63]
ds_read_b128 v[104:107], v22 offset:40960
ds_read_b128 v[108:111], v22 offset:45056
s_waitcnt lgkmcnt(5)
v_mfma_f32_32x32x16_bf16 v[64:79], v[152:155], v[120:123], v[64:79]
buffer_load_dwordx4 v145, s[52:55], s62 offen offset:1024 lds
s_waitcnt lgkmcnt(4)
v_mfma_f32_32x32x16_bf16 v[80:95], v[152:155], v[124:127], v[80:95]
buffer_load_dwordx4 v[152:155], v2, s[40:43], s63 offen offset:1024 sc1
s_waitcnt vmcnt(22) lgkmcnt(3)
v_mfma_f32_32x32x16_bf16 v[32:47], v[156:159], v[96:99], v[32:47]
ds_read_b128 v[112:115], v23 offset:32768
ds_read_b128 v[116:119], v23 offset:36864
s_waitcnt lgkmcnt(4)
v_mfma_f32_32x32x16_bf16 v[48:63], v[156:159], v[100:103], v[48:63]
ds_read_b128 v[120:123], v23 offset:40960
ds_read_b128 v[124:127], v23 offset:45056
s_waitcnt lgkmcnt(5)
v_mfma_f32_32x32x16_bf16 v[64:79], v[156:159], v[104:107], v[64:79]
buffer_load_dwordx4 v146, s[52:55], s62 offen offset:2048 lds
s_waitcnt lgkmcnt(4)
v_mfma_f32_32x32x16_bf16 v[80:95], v[156:159], v[108:111], v[80:95]
buffer_load_dwordx4 v[156:159], v2, s[40:43], s63 offen offset:2048 sc1
ds_read_b128 v[8:11], v12
s_waitcnt vmcnt(22) lgkmcnt(0)
L_ck64:
v_min3_u32 v15, v8, v9, v10
v_min_u32 v15, v15, v11
s_nop 0
v_readfirstlane_b32 s60, v15
s_nop 0
s_cmp_ge_u32 s60, 7
s_cbranch_scc1 L_ckd65
ds_read_b128 v[8:11], v12 offset:0
s_waitcnt lgkmcnt(0)
s_branch L_ck64
L_ckd65:
v_mfma_f32_32x32x16_bf16 v[32:47], v[160:163], v[112:115], v[32:47]
ds_read_b128 v[96:99], v20 offset:49152
ds_read_b128 v[100:103], v20 offset:53248
v_mfma_f32_32x32x16_bf16 v[48:63], v[160:163], v[116:119], v[48:63]
ds_read_b128 v[104:107], v20 offset:57344
ds_read_b128 v[108:111], v20 offset:61440
v_mfma_f32_32x32x16_bf16 v[64:79], v[160:163], v[120:123], v[64:79]
buffer_load_dwordx4 v147, s[52:55], s62 offen offset:3072 lds
v_mfma_f32_32x32x16_bf16 v[80:95], v[160:163], v[124:127], v[80:95]
buffer_load_dwordx4 v[160:163], v2, s[40:43], s63 offen offset:3072 sc1
s_waitcnt vmcnt(22) lgkmcnt(3)
v_mfma_f32_32x32x16_bf16 v[32:47], v[164:167], v[96:99], v[32:47]
ds_read_b128 v[112:115], v21 offset:49152
ds_read_b128 v[116:119], v21 offset:53248
s_waitcnt lgkmcnt(4)
v_mfma_f32_32x32x16_bf16 v[48:63], v[164:167], v[100:103], v[48:63]
ds_read_b128 v[120:123], v21 offset:57344
ds_read_b128 v[124:127], v21 offset:61440
s_waitcnt lgkmcnt(5)
v_mfma_f32_32x32x16_bf16 v[64:79], v[164:167], v[104:107], v[64:79]
s_add_u32 m0, s67, 0
s_add_u32 s62, s64, 896
s_and_b32 s62, s62, 0x3ff
buffer_load_dwordx4 v144, s[48:51], s62 offen offset:0 lds
s_waitcnt lgkmcnt(4)
v_mfma_f32_32x32x16_bf16 v[80:95], v[164:167], v[108:111], v[80:95]
s_add_u32 s63, s65, 53248
s_and_b32 s63, s63, 0xffff
buffer_load_dwordx4 v[164:167], v2, s[40:43], s63 offen offset:0 sc1
s_waitcnt vmcnt(22) lgkmcnt(3)
v_mfma_f32_32x32x16_bf16 v[32:47], v[168:171], v[112:115], v[32:47]
ds_read_b128 v[96:99], v22 offset:49152
ds_read_b128 v[100:103], v22 offset:53248
s_waitcnt lgkmcnt(4)
v_mfma_f32_32x32x16_bf16 v[48:63], v[168:171], v[116:119], v[48:63]
ds_read_b128 v[104:107], v22 offset:57344
ds_read_b128 v[108:111], v22 offset:61440
s_waitcnt lgkmcnt(5)
v_mfma_f32_32x32x16_bf16 v[64:79], v[168:171], v[120:123], v[64:79]
buffer_load_dwordx4 v145, s[48:51], s62 offen offset:1024 lds
s_waitcnt lgkmcnt(4)
v_mfma_f32_32x32x16_bf16 v[80:95], v[168:171], v[124:127], v[80:95]
buffer_load_dwordx4 v[168:171], v2, s[40:43], s63 offen offset:1024 sc1
s_waitcnt vmcnt(22) lgkmcnt(3)
v_mfma_f32_32x32x16_bf16 v[32:47], v[172:175], v[96:99], v[32:47]
ds_read_b128 v[112:115], v23 offset:49152
ds_read_b128 v[116:119], v23 offset:53248
s_waitcnt lgkmcnt(4)
v_mfma_f32_32x32x16_bf16 v[48:63], v[172:175], v[100:103], v[48:63]
ds_read_b128 v[120:123], v23 offset:57344
ds_read_b128 v[124:127], v23 offset:61440
s_waitcnt lgkmcnt(5)
v_mfma_f32_32x32x16_bf16 v[64:79], v[172:175], v[104:107], v[64:79]
buffer_load_dwordx4 v146, s[48:51], s62 offen offset:2048 lds
s_waitcnt lgkmcnt(4)
v_mfma_f32_32x32x16_bf16 v[80:95], v[172:175], v[108:111], v[80:95]
buffer_load_dwordx4 v[172:175], v2, s[40:43], s63 offen offset:2048 sc1
s_waitcnt vmcnt(22) lgkmcnt(3)
v_mfma_f32_32x32x16_bf16 v[32:47], v[176:179], v[112:115], v[32:47]
ds_read_b128 v[96:99], v24 offset:0
ds_read_b128 v[100:103], v24 offset:4096
s_waitcnt lgkmcnt(4)
v_mfma_f32_32x32x16_bf16 v[48:63], v[176:179], v[116:119], v[48:63]
ds_read_b128 v[104:107], v24 offset:8192
ds_read_b128 v[108:111], v24 offset:12288
s_waitcnt lgkmcnt(5)
v_mfma_f32_32x32x16_bf16 v[64:79], v[176:179], v[120:123], v[64:79]
buffer_load_dwordx4 v147, s[48:51], s62 offen offset:3072 lds
s_waitcnt lgkmcnt(4)
v_mfma_f32_32x32x16_bf16 v[80:95], v[176:179], v[124:127], v[80:95]
buffer_load_dwordx4 v[176:179], v2, s[40:43], s63 offen offset:3072 sc1
s_waitcnt vmcnt(9) lgkmcnt(3)
v_mov_b32 v14, 8
s_mov_b64 exec, 1
ds_write_b32 v13, v14
s_mov_b64 exec, -1
v_mfma_f32_32x32x16_bf16 v[32:47], v[180:183], v[96:99], v[32:47]
ds_read_b128 v[112:115], v25 offset:0
ds_read_b128 v[116:119], v25 offset:4096
s_waitcnt lgkmcnt(5)
v_mfma_f32_32x32x16_bf16 v[48:63], v[180:183], v[100:103], v[48:63]
ds_read_b128 v[120:123], v25 offset:8192
ds_read_b128 v[124:127], v25 offset:12288
s_waitcnt lgkmcnt(6)
v_mfma_f32_32x32x16_bf16 v[64:79], v[180:183], v[104:107], v[64:79]
s_add_u32 m0, s67, 16384
s_nop 0
buffer_load_dwordx4 v144, s[52:55], s62 offen offset:0 lds
s_waitcnt lgkmcnt(5)
v_mfma_f32_32x32x16_bf16 v[80:95], v[180:183], v[108:111], v[80:95]
s_add_u32 s63, s65, 57344
s_and_b32 s63, s63, 0xffff
buffer_load_dwordx4 v[180:183], v2, s[40:43], s63 offen offset:0 sc1
s_waitcnt vmcnt(22) lgkmcnt(3)
v_mfma_f32_32x32x16_bf16 v[32:47], v[184:187], v[112:115], v[32:47]
ds_read_b128 v[96:99], v26 offset:0
ds_read_b128 v[100:103], v26 offset:4096
s_waitcnt lgkmcnt(4)
v_mfma_f32_32x32x16_bf16 v[48:63], v[184:187], v[116:119], v[48:63]
ds_read_b128 v[104:107], v26 offset:8192
ds_read_b128 v[108:111], v26 offset:12288
s_waitcnt lgkmcnt(5)
v_mfma_f32_32x32x16_bf16 v[64:79], v[184:187], v[120:123], v[64:79]
buffer_load_dwordx4 v145, s[52:55], s62 offen offset:1024 lds
s_waitcnt lgkmcnt(4)
v_mfma_f32_32x32x16_bf16 v[80:95], v[184:187], v[124:127], v[80:95]
buffer_load_dwordx4 v[184:187], v2, s[40:43], s63 offen offset:1024 sc1
s_waitcnt vmcnt(22) lgkmcnt(3)
v_mfma_f32_32x32x16_bf16 v[32:47], v[188:191], v[96:99], v[32:47]
ds_read_b128 v[112:115], v27 offset:0
ds_read_b128 v[116:119], v27 offset:4096
s_waitcnt lgkmcnt(4)
v_mfma_f32_32x32x16_bf16 v[48:63], v[188:191], v[100:103], v[48:63]
ds_read_b128 v[120:123], v27 offset:8192
ds_read_b128 v[124:127], v27 offset:12288
s_waitcnt lgkmcnt(5)
v_mfma_f32_32x32x16_bf16 v[64:79], v[188:191], v[104:107], v[64:79]
buffer_load_dwordx4 v146, s[52:55], s62 offen offset:2048 lds
s_waitcnt lgkmcnt(4)
v_mfma_f32_32x32x16_bf16 v[80:95], v[188:191], v[108:111], v[80:95]
buffer_load_dwordx4 v[188:191], v2, s[40:43], s63 offen offset:2048 sc1
ds_read_b128 v[8:11], v12
global_load_dword v31, v30, s[26:27]
s_waitcnt vmcnt(23) lgkmcnt(0)
L_ck66:
v_min3_u32 v15, v8, v9, v10
v_min_u32 v15, v15, v11
s_nop 0
v_readfirstlane_b32 s60, v15
s_nop 0
s_cmp_ge_u32 s60, 8
s_cbranch_scc1 L_ckd67
ds_read_b128 v[8:11], v12 offset:0
s_waitcnt lgkmcnt(0)
s_branch L_ck66
L_ckd67:
v_mfma_f32_32x32x16_bf16 v[32:47], v[192:195], v[112:115], v[32:47]
ds_read_b128 v[96:99], v24 offset:16384
ds_read_b128 v[100:103], v24 offset:20480
v_mfma_f32_32x32x16_bf16 v[48:63], v[192:195], v[116:119], v[48:63]
ds_read_b128 v[104:107], v24 offset:24576
ds_read_b128 v[108:111], v24 offset:28672
v_mfma_f32_32x32x16_bf16 v[64:79], v[192:195], v[120:123], v[64:79]
buffer_load_dwordx4 v147, s[52:55], s62 offen offset:3072 lds
v_mfma_f32_32x32x16_bf16 v[80:95], v[192:195], v[124:127], v[80:95]
buffer_load_dwordx4 v[192:195], v2, s[40:43], s63 offen offset:3072 sc1
s_mov_b32 s60, 0
buffer_load_dword v128, v28, s[56:59], s60 offen offset:0
s_waitcnt vmcnt(24) lgkmcnt(3)
v_mfma_f32_32x32x16_bf16 v[32:47], v[148:151], v[96:99], v[32:47]
ds_read_b128 v[112:115], v25 offset:16384
ds_read_b128 v[116:119], v25 offset:20480
s_waitcnt lgkmcnt(4)
v_mfma_f32_32x32x16_bf16 v[48:63], v[148:151], v[100:103], v[48:63]
ds_read_b128 v[120:123], v25 offset:24576
ds_read_b128 v[124:127], v25 offset:28672
s_waitcnt lgkmcnt(5)
v_mfma_f32_32x32x16_bf16 v[64:79], v[148:151], v[104:107], v[64:79]
s_waitcnt lgkmcnt(4)
v_mfma_f32_32x32x16_bf16 v[80:95], v[148:151], v[108:111], v[80:95]
s_add_u32 s63, s65, 61440
s_and_b32 s63, s63, 0xffff
buffer_load_dwordx4 v[148:151], v2, s[40:43], s63 offen offset:0 sc1
s_mov_b32 s60, 0
buffer_load_dword v129, v28, s[56:59], s60 offen offset:2048
s_waitcnt vmcnt(24) lgkmcnt(3)
v_mfma_f32_32x32x16_bf16 v[32:47], v[152:155], v[112:115], v[32:47]
ds_read_b128 v[96:99], v26 offset:16384
ds_read_b128 v[100:103], v26 offset:20480
s_waitcnt lgkmcnt(4)
v_mfma_f32_32x32x16_bf16 v[48:63], v[152:155], v[116:119], v[48:63]
ds_read_b128 v[104:107], v26 offset:24576
ds_read_b128 v[108:111], v26 offset:28672
s_waitcnt lgkmcnt(5)
v_mfma_f32_32x32x16_bf16 v[64:79], v[152:155], v[120:123], v[64:79]
s_waitcnt lgkmcnt(4)
v_mfma_f32_32x32x16_bf16 v[80:95], v[152:155], v[124:127], v[80:95]
buffer_load_dwordx4 v[152:155], v2, s[40:43], s63 offen offset:1024 sc1
s_mov_b32 s60, 4096
buffer_load_dword v130, v28, s[56:59], s60 offen offset:0
s_waitcnt vmcnt(24) lgkmcnt(3)
v_mfma_f32_32x32x16_bf16 v[32:47], v[156:159], v[96:99], v[32:47]
ds_read_b128 v[112:115], v27 offset:16384
ds_read_b128 v[116:119], v27 offset:20480
s_waitcnt lgkmcnt(4)
v_mfma_f32_32x32x16_bf16 v[48:63], v[156:159], v[100:103], v[48:63]
ds_read_b128 v[120:123], v27 offset:24576
ds_read_b128 v[124:127], v27 offset:28672
s_waitcnt lgkmcnt(5)
v_mfma_f32_32x32x16_bf16 v[64:79], v[156:159], v[104:107], v[64:79]
s_waitcnt lgkmcnt(4)
v_mfma_f32_32x32x16_bf16 v[80:95], v[156:159], v[108:111], v[80:95]
buffer_load_dwordx4 v[156:159], v2, s[40:43], s63 offen offset:2048 sc1
s_mov_b32 s60, 4096
buffer_load_dword v131, v28, s[56:59], s60 offen offset:2048
s_waitcnt vmcnt(24) lgkmcnt(3)
v_mfma_f32_32x32x16_bf16 v[32:47], v[160:163], v[112:115], v[32:47]
ds_read_b128 v[96:99], v24 offset:32768
ds_read_b128 v[100:103], v24 offset:36864
s_waitcnt lgkmcnt(4)
v_mfma_f32_32x32x16_bf16 v[48:63], v[160:163], v[116:119], v[48:63]
ds_read_b128 v[104:107], v24 offset:40960
ds_read_b128 v[108:111], v24 offset:45056
s_waitcnt lgkmcnt(5)
v_mfma_f32_32x32x16_bf16 v[64:79], v[160:163], v[120:123], v[64:79]
s_waitcnt lgkmcnt(4)
v_mfma_f32_32x32x16_bf16 v[80:95], v[160:163], v[124:127], v[80:95]
buffer_load_dwordx4 v[160:163], v2, s[40:43], s63 offen offset:3072 sc1
s_mov_b32 s60, 32768
buffer_load_dword v132, v28, s[56:59], s60 offen offset:0
s_waitcnt vmcnt(10) lgkmcnt(3)
v_mov_b32 v14, 9
s_mov_b64 exec, 1
ds_write_b32 v13, v14
s_mov_b64 exec, -1
v_mfma_f32_32x32x16_bf16 v[32:47], v[164:167], v[96:99], v[32:47]
ds_read_b128 v[112:115], v25 offset:32768
ds_read_b128 v[116:119], v25 offset:36864
s_waitcnt lgkmcnt(5)
v_mfma_f32_32x32x16_bf16 v[48:63], v[164:167], v[100:103], v[48:63]
ds_read_b128 v[120:123], v25 offset:40960
ds_read_b128 v[124:127], v25 offset:45056
s_waitcnt lgkmcnt(6)
v_mfma_f32_32x32x16_bf16 v[64:79], v[164:167], v[104:107], v[64:79]
s_waitcnt lgkmcnt(5)
v_mfma_f32_32x32x16_bf16 v[80:95], v[164:167], v[108:111], v[80:95]
s_mov_b32 s60, 32768
buffer_load_dword v133, v28, s[56:59], s60 offen offset:2048
s_waitcnt vmcnt(23) lgkmcnt(3)
v_mfma_f32_32x32x16_bf16 v[32:47], v[168:171], v[112:115], v[32:47]
ds_read_b128 v[96:99], v26 offset:32768
ds_read_b128 v[100:103], v26 offset:36864
s_waitcnt lgkmcnt(4)
v_mfma_f32_32x32x16_bf16 v[48:63], v[168:171], v[116:119], v[48:63]
ds_read_b128 v[104:107], v26 offset:40960
ds_read_b128 v[108:111], v26 offset:45056
s_waitcnt lgkmcnt(5)
v_mfma_f32_32x32x16_bf16 v[64:79], v[168:171], v[120:123], v[64:79]
s_waitcnt lgkmcnt(4)
v_mfma_f32_32x32x16_bf16 v[80:95], v[168:171], v[124:127], v[80:95]
s_mov_b32 s60, 36864
buffer_load_dword v134, v28, s[56:59], s60 offen offset:0
s_waitcnt vmcnt(22) lgkmcnt(3)
v_mfma_f32_32x32x16_bf16 v[32:47], v[172:175], v[96:99], v[32:47]
ds_read_b128 v[112:115], v27 offset:32768
ds_read_b128 v[116:119], v27 offset:36864
s_waitcnt lgkmcnt(4)
v_mfma_f32_32x32x16_bf16 v[48:63], v[172:175], v[100:103], v[48:63]
ds_read_b128 v[120:123], v27 offset:40960
ds_read_b128 v[124:127], v27 offset:45056
s_waitcnt lgkmcnt(5)
v_mfma_f32_32x32x16_bf16 v[64:79], v[172:175], v[104:107], v[64:79]
s_waitcnt lgkmcnt(4)
v_mfma_f32_32x32x16_bf16 v[80:95], v[172:175], v[108:111], v[80:95]
ds_read_b128 v[8:11], v12
s_mov_b32 s60, 36864
buffer_load_dword v135, v28, s[56:59], s60 offen offset:2048
s_waitcnt vmcnt(21) lgkmcnt(0)
L_ck68:
v_min3_u32 v15, v8, v9, v10
v_min_u32 v15, v15, v11
s_nop 0
v_readfirstlane_b32 s60, v15
s_nop 0
s_cmp_ge_u32 s60, 9
s_cbranch_scc1 L_ckd69
ds_read_b128 v[8:11], v12 offset:0
s_waitcnt lgkmcnt(0)
s_branch L_ck68
L_ckd69:
v_mfma_f32_32x32x16_bf16 v[32:47], v[176:179], v[112:115], v[32:47]
ds_read_b128 v[96:99], v20 offset:0
ds_read_b128 v[100:103], v20 offset:4096
v_mfma_f32_32x32x16_bf16 v[48:63], v[176:179], v[116:119], v[48:63]
ds_read_b128 v[104:107], v20 offset:8192
ds_read_b128 v[108:111], v20 offset:12288
v_mfma_f32_32x32x16_bf16 v[64:79], v[176:179], v[120:123], v[64:79]
v_mfma_f32_32x32x16_bf16 v[80:95], v[176:179], v[124:127], v[80:95]
s_mov_b32 s60, 65536
buffer_load_dword v136, v28, s[56:59], s60 offen offset:0
s_waitcnt vmcnt(20) lgkmcnt(3)
v_mfma_f32_32x32x16_bf16 v[32:47], v[180:183], v[96:99], v[32:47]
ds_read_b128 v[112:115], v21 offset:0
ds_read_b128 v[116:119], v21 offset:4096
s_waitcnt lgkmcnt(4)
v_mfma_f32_32x32x16_bf16 v[48:63], v[180:183], v[100:103], v[48:63]
ds_read_b128 v[120:123], v21 offset:8192
ds_read_b128 v[124:127], v21 offset:12288
s_waitcnt lgkmcnt(5)
v_mfma_f32_32x32x16_bf16 v[64:79], v[180:183], v[104:107], v[64:79]
s_waitcnt lgkmcnt(4)
v_mfma_f32_32x32x16_bf16 v[80:95], v[180:183], v[108:111], v[80:95]
s_mov_b32 s60, 65536
buffer_load_dword v137, v28, s[56:59], s60 offen offset:2048
s_waitcnt vmcnt(19) lgkmcnt(3)
v_mfma_f32_32x32x16_bf16 v[32:47], v[184:187], v[112:115], v[32:47]
ds_read_b128 v[96:99], v22 offset:0
ds_read_b128 v[100:103], v22 offset:4096
s_waitcnt lgkmcnt(4)
v_mfma_f32_32x32x16_bf16 v[48:63], v[184:187], v[116:119], v[48:63]
ds_read_b128 v[104:107], v22 offset:8192
ds_read_b128 v[108:111], v22 offset:12288
s_waitcnt lgkmcnt(5)
v_mfma_f32_32x32x16_bf16 v[64:79], v[184:187], v[120:123], v[64:79]
s_waitcnt lgkmcnt(4)
v_mfma_f32_32x32x16_bf16 v[80:95], v[184:187], v[124:127], v[80:95]
s_mov_b32 s60, 69632
buffer_load_dword v138, v28, s[56:59], s60 offen offset:0
s_waitcnt vmcnt(18) lgkmcnt(3)
v_mfma_f32_32x32x16_bf16 v[32:47], v[188:191], v[96:99], v[32:47]
ds_read_b128 v[112:115], v23 offset:0
ds_read_b128 v[116:119], v23 offset:4096
s_waitcnt lgkmcnt(4)
v_mfma_f32_32x32x16_bf16 v[48:63], v[188:191], v[100:103], v[48:63]
ds_read_b128 v[120:123], v23 offset:8192
ds_read_b128 v[124:127], v23 offset:12288
s_waitcnt lgkmcnt(5)
v_mfma_f32_32x32x16_bf16 v[64:79], v[188:191], v[104:107], v[64:79]
s_waitcnt lgkmcnt(4)
v_mfma_f32_32x32x16_bf16 v[80:95], v[188:191], v[108:111], v[80:95]
s_mov_b32 s60, 69632
buffer_load_dword v139, v28, s[56:59], s60 offen offset:2048
s_waitcnt vmcnt(16) lgkmcnt(3)
v_mfma_f32_32x32x16_bf16 v[32:47], v[192:195], v[112:115], v[32:47]
ds_read_b128 v[96:99], v20 offset:16384
ds_read_b128 v[100:103], v20 offset:20480
s_waitcnt lgkmcnt(4)
v_mfma_f32_32x32x16_bf16 v[48:63], v[192:195], v[116:119], v[48:63]
ds_read_b128 v[104:107], v20 offset:24576
ds_read_b128 v[108:111], v20 offset:28672
s_waitcnt lgkmcnt(5)
v_mfma_f32_32x32x16_bf16 v[64:79], v[192:195], v[120:123], v[64:79]
s_waitcnt lgkmcnt(4)
v_mfma_f32_32x32x16_bf16 v[80:95], v[192:195], v[124:127], v[80:95]
s_mov_b32 s60, 98304
buffer_load_dword v140, v28, s[56:59], s60 offen offset:0
s_waitcnt vmcnt(15) lgkmcnt(3)
v_mfma_f32_32x32x16_bf16 v[32:47], v[148:151], v[96:99], v[32:47]
ds_read_b128 v[112:115], v21 offset:16384
ds_read_b128 v[116:119], v21 offset:20480
s_waitcnt lgkmcnt(4)
v_mfma_f32_32x32x16_bf16 v[48:63], v[148:151], v[100:103], v[48:63]
ds_read_b128 v[120:123], v21 offset:24576
ds_read_b128 v[124:127], v21 offset:28672
s_waitcnt lgkmcnt(5)
v_mfma_f32_32x32x16_bf16 v[64:79], v[148:151], v[104:107], v[64:79]
s_waitcnt lgkmcnt(4)
v_mfma_f32_32x32x16_bf16 v[80:95], v[148:151], v[108:111], v[80:95]
s_mov_b32 s60, 98304
buffer_load_dword v141, v28, s[56:59], s60 offen offset:2048
s_waitcnt vmcnt(14) lgkmcnt(3)
v_mfma_f32_32x32x16_bf16 v[32:47], v[152:155], v[112:115], v[32:47]
ds_read_b128 v[96:99], v22 offset:16384
ds_read_b128 v[100:103], v22 offset:20480
s_waitcnt lgkmcnt(4)
v_mfma_f32_32x32x16_bf16 v[48:63], v[152:155], v[116:119], v[48:63]
ds_read_b128 v[104:107], v22 offset:24576
ds_read_b128 v[108:111], v22 offset:28672
s_waitcnt lgkmcnt(5)
v_mfma_f32_32x32x16_bf16 v[64:79], v[152:155], v[120:123], v[64:79]
s_waitcnt lgkmcnt(4)
v_mfma_f32_32x32x16_bf16 v[80:95], v[152:155], v[124:127], v[80:95]
s_mov_b32 s60, 102400
buffer_load_dword v142, v28, s[56:59], s60 offen offset:0
s_waitcnt vmcnt(13) lgkmcnt(3)
v_mfma_f32_32x32x16_bf16 v[32:47], v[156:159], v[96:99], v[32:47]
ds_read_b128 v[112:115], v23 offset:16384
ds_read_b128 v[116:119], v23 offset:20480
s_waitcnt lgkmcnt(4)
v_mfma_f32_32x32x16_bf16 v[48:63], v[156:159], v[100:103], v[48:63]
ds_read_b128 v[120:123], v23 offset:24576
ds_read_b128 v[124:127], v23 offset:28672
s_waitcnt lgkmcnt(5)
v_mfma_f32_32x32x16_bf16 v[64:79], v[156:159], v[104:107], v[64:79]
s_waitcnt lgkmcnt(4)
v_mfma_f32_32x32x16_bf16 v[80:95], v[156:159], v[108:111], v[80:95]
s_mov_b32 s60, 102400
buffer_load_dword v143, v28, s[56:59], s60 offen offset:2048
s_waitcnt vmcnt(12) lgkmcnt(0)
v_mfma_f32_32x32x16_bf16 v[32:47], v[160:163], v[112:115], v[32:47]
v_mfma_f32_32x32x16_bf16 v[48:63], v[160:163], v[116:119], v[48:63]
v_mfma_f32_32x32x16_bf16 v[64:79], v[160:163], v[120:123], v[64:79]
v_mfma_f32_32x32x16_bf16 v[80:95], v[160:163], v[124:127], v[80:95]
s_mul_i32 s60, s37, 0x9e3779b1
s_and_b32 s60, s60, 0xbfff0000
s_or_b32 s60, s60, 0x20000000
s_lshl_b32 s64, s35, 4
s_add_u32 s64, s64, s36
s_lshl_b32 s64, s64, 2
s_add_u32 s64, s64, s34
s_lshl_b32 s64, s64, 13
s_add_u32 s50, s64, 33554432
s_add_u32 s48, s32, s50
s_addc_u32 s49, s33, 0
s_mov_b32 s50, 8192
s_mov_b32 s51, 0x20000
s_xor_b32 s64, s64, 262144
s_add_u32 s54, s64, 33554432
s_add_u32 s52, s32, s54
s_addc_u32 s53, s33, 0
s_mov_b32 s54, 8192
s_mov_b32 s55, 0x20000
s_movk_i32 s64, 0x1000
v_cvt_pk_bf16_f32 v96, v32, v48
v_cvt_pk_bf16_f32 v97, v33, v49
v_cvt_pk_bf16_f32 v98, v34, v50
v_cvt_pk_bf16_f32 v99, v35, s60
buffer_store_dwordx4 v[96:99], v2, s[48:51], 0 offen offset:0 sc1
v_cvt_pk_bf16_f32 v100, v51, v36
v_cvt_pk_bf16_f32 v101, v52, v37
v_cvt_pk_bf16_f32 v102, v53, v38
v_cvt_pk_bf16_f32 v103, v54, s60
buffer_store_dwordx4 v[100:103], v2, s[48:51], 0 offen offset:1024 sc1
v_cvt_pk_bf16_f32 v104, v39, v55
v_cvt_pk_bf16_f32 v105, v40, v56
v_cvt_pk_bf16_f32 v106, v41, v57
v_cvt_pk_bf16_f32 v107, v42, s60
buffer_store_dwordx4 v[104:107], v2, s[48:51], 0 offen offset:2048 sc1
v_cvt_pk_bf16_f32 v108, v58, v43
v_cvt_pk_bf16_f32 v109, v59, v44
v_cvt_pk_bf16_f32 v110, v60, v45
v_cvt_pk_bf16_f32 v111, v61, s60
buffer_store_dwordx4 v[108:111], v2, s[48:51], 0 offen offset:3072 sc1
v_cvt_pk_bf16_f32 v112, v46, v62
v_cvt_pk_bf16_f32 v113, v47, v63
v_cvt_pk_bf16_f32 v114, v63, v63
v_cvt_pk_bf16_f32 v115, v63, s60
buffer_store_dwordx4 v[112:115], v2, s[48:51], s64 offen offset:0 sc1
s_waitcnt vmcnt(5)
v_lshlrev_b32 v8, 16, v31
v_and_b32 v9, 0xffff0000, v31
v_lshlrev_b32 v148, 16, v128
v_and_b32 v149, 0xffff0000, v128
v_pk_mul_f32 v[148:149], v[148:149], v[8:9]
v_cvt_pk_bf16_f32 v10, v148, v149
v_lshlrev_b32 v148, 16, v10
v_and_b32 v149, 0xffff0000, v10
v_add_f32 v148, v148, v64
v_add_f32 v149, v149, v80
v_lshlrev_b32 v150, 16, v129
v_and_b32 v151, 0xffff0000, v129
v_pk_mul_f32 v[150:151], v[150:151], v[8:9]
v_cvt_pk_bf16_f32 v10, v150, v151
v_lshlrev_b32 v150, 16, v10
v_and_b32 v151, 0xffff0000, v10
v_add_f32 v150, v150, v65
v_add_f32 v151, v151, v81
v_lshlrev_b32 v152, 16, v130
v_and_b32 v153, 0xffff0000, v130
v_pk_mul_f32 v[152:153], v[152:153], v[8:9]
v_cvt_pk_bf16_f32 v10, v152, v153
v_lshlrev_b32 v152, 16, v10
v_and_b32 v153, 0xffff0000, v10
v_add_f32 v152, v152, v66
v_add_f32 v153, v153, v82
v_lshlrev_b32 v154, 16, v131
v_and_b32 v155, 0xffff0000, v131
v_pk_mul_f32 v[154:155], v[154:155], v[8:9]
v_cvt_pk_bf16_f32 v10, v154, v155
v_lshlrev_b32 v154, 16, v10
v_and_b32 v155, 0xffff0000, v10
v_add_f32 v154, v154, v67
v_add_f32 v155, v155, v83
v_lshlrev_b32 v156, 16, v132
v_and_b32 v157, 0xffff0000, v132
v_pk_mul_f32 v[156:157], v[156:157], v[8:9]
v_cvt_pk_bf16_f32 v10, v156, v157
v_lshlrev_b32 v156, 16, v10
v_and_b32 v157, 0xffff0000, v10
v_add_f32 v156, v156, v68
v_add_f32 v157, v157, v84
v_lshlrev_b32 v158, 16, v133
v_and_b32 v159, 0xffff0000, v133
v_pk_mul_f32 v[158:159], v[158:159], v[8:9]
v_cvt_pk_bf16_f32 v10, v158, v159
v_lshlrev_b32 v158, 16, v10
v_and_b32 v159, 0xffff0000, v10
v_add_f32 v158, v158, v69
v_add_f32 v159, v159, v85
v_lshlrev_b32 v160, 16, v134
v_and_b32 v161, 0xffff0000, v134
v_pk_mul_f32 v[160:161], v[160:161], v[8:9]
v_cvt_pk_bf16_f32 v10, v160, v161
v_lshlrev_b32 v160, 16, v10
v_and_b32 v161, 0xffff0000, v10
v_add_f32 v160, v160, v70
v_add_f32 v161, v161, v86
v_lshlrev_b32 v162, 16, v135
v_and_b32 v163, 0xffff0000, v135
v_pk_mul_f32 v[162:163], v[162:163], v[8:9]
v_cvt_pk_bf16_f32 v10, v162, v163
v_lshlrev_b32 v162, 16, v10
v_and_b32 v163, 0xffff0000, v10
v_add_f32 v162, v162, v71
v_add_f32 v163, v163, v87
v_lshlrev_b32 v164, 16, v136
v_and_b32 v165, 0xffff0000, v136
v_pk_mul_f32 v[164:165], v[164:165], v[8:9]
v_cvt_pk_bf16_f32 v10, v164, v165
v_lshlrev_b32 v164, 16, v10
v_and_b32 v165, 0xffff0000, v10
v_add_f32 v164, v164, v72
v_add_f32 v165, v165, v88
v_lshlrev_b32 v166, 16, v137
v_and_b32 v167, 0xffff0000, v137
v_pk_mul_f32 v[166:167], v[166:167], v[8:9]
v_cvt_pk_bf16_f32 v10, v166, v167
v_lshlrev_b32 v166, 16, v10
v_and_b32 v167, 0xffff0000, v10
v_add_f32 v166, v166, v73
v_add_f32 v167, v167, v89
v_lshlrev_b32 v168, 16, v138
v_and_b32 v169, 0xffff0000, v138
v_pk_mul_f32 v[168:169], v[168:169], v[8:9]
v_cvt_pk_bf16_f32 v10, v168, v169
v_lshlrev_b32 v168, 16, v10
v_and_b32 v169, 0xffff0000, v10
v_add_f32 v168, v168, v74
v_add_f32 v169, v169, v90
v_lshlrev_b32 v170, 16, v139
v_and_b32 v171, 0xffff0000, v139
v_pk_mul_f32 v[170:171], v[170:171], v[8:9]
v_cvt_pk_bf16_f32 v10, v170, v171
v_lshlrev_b32 v170, 16, v10
v_and_b32 v171, 0xffff0000, v10
v_add_f32 v170, v170, v75
v_add_f32 v171, v171, v91
v_lshlrev_b32 v172, 16, v140
v_and_b32 v173, 0xffff0000, v140
v_pk_mul_f32 v[172:173], v[172:173], v[8:9]
v_cvt_pk_bf16_f32 v10, v172, v173
v_lshlrev_b32 v172, 16, v10
v_and_b32 v173, 0xffff0000, v10
v_add_f32 v172, v172, v76
v_add_f32 v173, v173, v92
v_lshlrev_b32 v174, 16, v141
v_and_b32 v175, 0xffff0000, v141
v_pk_mul_f32 v[174:175], v[174:175], v[8:9]
v_cvt_pk_bf16_f32 v10, v174, v175
v_lshlrev_b32 v174, 16, v10
v_and_b32 v175, 0xffff0000, v10
v_add_f32 v174, v174, v77
v_add_f32 v175, v175, v93
v_lshlrev_b32 v176, 16, v142
v_and_b32 v177, 0xffff0000, v142
v_pk_mul_f32 v[176:177], v[176:177], v[8:9]
v_cvt_pk_bf16_f32 v10, v176, v177
v_lshlrev_b32 v176, 16, v10
v_and_b32 v177, 0xffff0000, v10
v_add_f32 v176, v176, v78
v_add_f32 v177, v177, v94
v_lshlrev_b32 v178, 16, v143
v_and_b32 v179, 0xffff0000, v143
v_pk_mul_f32 v[178:179], v[178:179], v[8:9]
v_cvt_pk_bf16_f32 v10, v178, v179
v_lshlrev_b32 v178, 16, v10
v_and_b32 v179, 0xffff0000, v10
v_add_f32 v178, v178, v79
v_add_f32 v179, v179, v95
s_mov_b32 s44, s28
s_mov_b32 s45, s29
s_mov_b32 s46, s24
s_mov_b32 s47, 0x20000
s_mov_b32 s92, 0
s_waitcnt vmcnt(0)
buffer_load_dwordx4 v[180:183], v2, s[52:55], 0 offen offset:0 sc1
buffer_load_dwordx4 v[184:187], v2, s[52:55], 0 offen offset:1024 sc1
buffer_load_dwordx4 v[188:191], v2, s[52:55], 0 offen offset:2048 sc1
buffer_load_dwordx4 v[192:195], v2, s[52:55], 0 offen offset:3072 sc1
buffer_load_dwordx4 v[196:199], v2, s[52:55], s64 offen offset:0 sc1
L_xl70:
v_mov_b32 v10, 0
s_waitcnt vmcnt(4)
v_bitop3_b32 v10, v10, v183, s60 bitop3:0xf6
s_waitcnt vmcnt(3)
v_bitop3_b32 v10, v10, v187, s60 bitop3:0xf6
s_waitcnt vmcnt(2)
v_bitop3_b32 v10, v10, v191, s60 bitop3:0xf6
s_waitcnt vmcnt(1)
v_bitop3_b32 v10, v10, v195, s60 bitop3:0xf6
s_waitcnt vmcnt(0)
v_bitop3_b32 v10, v10, v199, s60 bitop3:0xf6
v_cmp_lt_u32 vcc, 0xffff, v10
s_nop 0
s_cbranch_vccz L_xd71
s_add_u32 s92, s92, 1
s_cmp_ge_u32 s92, 200000
s_cbranch_scc1 L_xd71
buffer_load_dwordx4 v[180:183], v2, s[52:55], 0 offen offset:0 sc1
buffer_load_dwordx4 v[184:187], v2, s[52:55], 0 offen offset:1024 sc1
buffer_load_dwordx4 v[188:191], v2, s[52:55], 0 offen offset:2048 sc1
buffer_load_dwordx4 v[192:195], v2, s[52:55], 0 offen offset:3072 sc1
buffer_load_dwordx4 v[196:199], v2, s[52:55], s64 offen offset:0 sc1
s_branch L_xl70
L_xd71:
v_lshlrev_b32 v10, 16, v180
v_and_b32 v11, 0xffff0000, v180
v_pk_add_f32 v[148:149], v[148:149], v[10:11]
s_mov_b32 s64, 0
buffer_store_dwordx2 v[148:149], v29, s[44:47], s64 offen nt
v_lshlrev_b32 v10, 16, v181
v_and_b32 v11, 0xffff0000, v181
v_pk_add_f32 v[150:151], v[150:151], v[10:11]
s_mov_b32 s64, 8192
buffer_store_dwordx2 v[150:151], v29, s[44:47], s64 offen nt
v_lshlrev_b32 v10, 16, v182
v_and_b32 v11, 0xffff0000, v182
v_pk_add_f32 v[152:153], v[152:153], v[10:11]
s_mov_b32 s64, 16384
buffer_store_dwordx2 v[152:153], v29, s[44:47], s64 offen nt
v_lshlrev_b32 v10, 16, v183
v_lshlrev_b32 v11, 16, v184
v_pk_add_f32 v[154:155], v[154:155], v[10:11]
s_mov_b32 s64, 24576
buffer_store_dwordx2 v[154:155], v29, s[44:47], s64 offen nt
v_and_b32 v10, 0xffff0000, v184
v_lshlrev_b32 v11, 16, v185
v_pk_add_f32 v[156:157], v[156:157], v[10:11]
s_mov_b32 s64, 131072
buffer_store_dwordx2 v[156:157], v29, s[44:47], s64 offen nt
v_and_b32 v10, 0xffff0000, v185
v_lshlrev_b32 v11, 16, v186
v_pk_add_f32 v[158:159], v[158:159], v[10:11]
s_mov_b32 s64, 139264
buffer_store_dwordx2 v[158:159], v29, s[44:47], s64 offen nt
v_and_b32 v10, 0xffff0000, v186
v_lshlrev_b32 v11, 16, v187
v_pk_add_f32 v[160:161], v[160:161], v[10:11]
s_mov_b32 s64, 147456
buffer_store_dwordx2 v[160:161], v29, s[44:47], s64 offen nt
v_lshlrev_b32 v10, 16, v188
v_and_b32 v11, 0xffff0000, v188
v_pk_add_f32 v[162:163], v[162:163], v[10:11]
s_mov_b32 s64, 155648
buffer_store_dwordx2 v[162:163], v29, s[44:47], s64 offen nt
v_lshlrev_b32 v10, 16, v189
v_and_b32 v11, 0xffff0000, v189
v_pk_add_f32 v[164:165], v[164:165], v[10:11]
s_mov_b32 s64, 262144
buffer_store_dwordx2 v[164:165], v29, s[44:47], s64 offen nt
v_lshlrev_b32 v10, 16, v190
v_and_b32 v11, 0xffff0000, v190
v_pk_add_f32 v[166:167], v[166:167], v[10:11]
s_mov_b32 s64, 270336
buffer_store_dwordx2 v[166:167], v29, s[44:47], s64 offen nt
v_lshlrev_b32 v10, 16, v191
v_lshlrev_b32 v11, 16, v192
v_pk_add_f32 v[168:169], v[168:169], v[10:11]
s_mov_b32 s64, 278528
buffer_store_dwordx2 v[168:169], v29, s[44:47], s64 offen nt
v_and_b32 v10, 0xffff0000, v192
v_lshlrev_b32 v11, 16, v193
v_pk_add_f32 v[170:171], v[170:171], v[10:11]
s_mov_b32 s64, 286720
buffer_store_dwordx2 v[170:171], v29, s[44:47], s64 offen nt
v_and_b32 v10, 0xffff0000, v193
v_lshlrev_b32 v11, 16, v194
v_pk_add_f32 v[172:173], v[172:173], v[10:11]
s_mov_b32 s64, 393216
buffer_store_dwordx2 v[172:173], v29, s[44:47], s64 offen nt
v_and_b32 v10, 0xffff0000, v194
v_lshlrev_b32 v11, 16, v195
v_pk_add_f32 v[174:175], v[174:175], v[10:11]
s_mov_b32 s64, 401408
buffer_store_dwordx2 v[174:175], v29, s[44:47], s64 offen nt
v_lshlrev_b32 v10, 16, v196
v_and_b32 v11, 0xffff0000, v196
v_pk_add_f32 v[176:177], v[176:177], v[10:11]
s_mov_b32 s64, 409600
buffer_store_dwordx2 v[176:177], v29, s[44:47], s64 offen nt
v_lshlrev_b32 v10, 16, v197
v_and_b32 v11, 0xffff0000, v197
v_pk_add_f32 v[178:179], v[178:179], v[10:11]
s_mov_b32 s64, 417792
buffer_store_dwordx2 v[178:179], v29, s[44:47], s64 offen nt
L_concat_heads__spectral_gfnet__ssm_conv_s5__prompt_kernel_end:
s_endpgm

.section .rodata,"a"
.p2align 6
.amdhsa_kernel concat_heads__spectral_gfnet__ssm_conv_s5__prompt_kernel
  .amdhsa_next_free_vgpr 256
  .amdhsa_next_free_sgpr 102
  .amdhsa_accum_offset 256
  .amdhsa_group_segment_fixed_size 0
  .amdhsa_kernarg_size 120
  .amdhsa_user_sgpr_count 2
  .amdhsa_user_sgpr_kernarg_segment_ptr 1
  .amdhsa_system_sgpr_workgroup_id_x 1
.end_amdhsa_kernel
.text
```

```asm
; @launch grid=(256,1,1) block=(512,1,1) lds=163840
.amdgcn_target "amdgcn-amd-amdhsa--gfx950"
.text
.globl concat_heads__spectral_gfnet__ssm_conv_s5__prompt_kernel
.p2align 8
.type concat_heads__spectral_gfnet__ssm_conv_s5__prompt_kernel,@function
concat_heads__spectral_gfnet__ssm_conv_s5__prompt_kernel:
s_cmp_ge_u32 s2, 256
s_cbranch_scc1 L_concat_heads__spectral_gfnet__ssm_conv_s5__prompt_kernel_end
s_load_dwordx16 s[4:19], s[0:1], 0
s_load_dwordx8 s[20:27], s[0:1], 64
s_load_dwordx4 s[28:31], s[0:1], 96
s_load_dwordx2 s[32:33], s[0:1], 112
v_lshrrev_b32 v2, 6, v0
v_and_b32 v1, 63, v0
v_readfirstlane_b32 s34, v2
s_and_b32 s60, s2, 7
s_lshr_b32 s61, s2, 3
s_lshr_b32 s35, s60, 1
s_lshl_b32 s35, s35, 2
s_lshr_b32 s62, s61, 3
s_add_u32 s35, s35, s62
s_and_b32 s36, s60, 1
s_lshl_b32 s36, s36, 3
s_and_b32 s62, s61, 7
s_add_u32 s36, s36, s62
s_cmp_ge_u32 s34, 4
s_cbranch_scc0 L_concat_heads__spectral_gfnet__ssm_conv_s5__prompt_kernel_gemm
s_sub_u32 s66, s34, 4
v_lshrrev_b32 v2, 5, v1
v_bfe_u32 v3, v1, 3, 2
v_and_b32 v4, 1, v3
v_lshrrev_b32 v5, 1, v3
v_lshlrev_b32 v6, 5, v2
v_lshl_add_u32 v6, v4, 4, v6
v_add_u32 v6, v6, v5
s_lshr_b32 s60, s66, 1
s_lshl_b32 s61, s60, 6
s_and_b32 s62, s66, 1
s_lshl_b32 s62, s62, 3
s_add_u32 s61, s61, s62
v_add_u32 v6, s61, v6
v_lshlrev_b32 v6, 11, v6
s_lshl_b32 s61, s60, 5
v_lshl_add_u32 v7, v2, 3, v3
v_add_u32 v7, s61, v7
v_lshlrev_b32 v7, 11, v7
v_and_b32 v4, 7, v1
v_lshrrev_b32 v5, 4, v1
v_xor_b32 v4, v4, v5
v_lshlrev_b32 v4, 4, v4
v_xor_b32 v5, 64, v4
v_add_u32 v176, v6, v4
v_add_u32 v180, v7, v4
v_add_u32 v177, v6, v5
v_add_u32 v177, 3072, v177
v_add_u32 v181, v7, v5
v_add_u32 v181, 7168, v181
v_add_u32 v178, v6, v4
v_add_u32 v178, 6144, v178
v_add_u32 v182, v7, v4
v_add_u32 v182, 30720, v182
v_add_u32 v179, v6, v5
v_add_u32 v179, 9216, v179
v_add_u32 v183, v7, v5
v_add_u32 v183, 37888, v183
s_and_b32 s64, s2, 7
s_mul_i32 s64, s64, 0
s_add_u32 s60, s35, s36
s_and_b32 s60, s60, 0
s_mul_i32 s60, s60, 2048
s_add_u32 s64, s64, s60
s_mul_i32 s60, s35, 128
s_add_u32 s64, s64, s60
s_mul_i32 s60, s36, 128
s_add_u32 s64, s64, s60
s_lshl_b32 s60, s35, 18
s_lshl_b32 s61, s36, 17
s_waitcnt lgkmcnt(0)
s_lshl_b32 s25, s66, 12
s_mov_b32 s24, s64
s_add_u32 s12, s10, s60
s_addc_u32 s13, s11, 0
s_mov_b32 s14, 262144
s_mov_b32 s15, 0x20000
s_bitcmp1_b32 s66, 0
s_cselect_b32 s62, s18, s16
s_cselect_b32 s63, s19, s17
s_add_u32 s20, s62, s61
s_addc_u32 s21, s63, 0
s_mov_b32 s22, 131072
s_mov_b32 s23, 0x20000
s_add_u32 m0, s25, 0
s_add_u32 s26, s24, 0
s_and_b32 s26, s26, 0x7ff
buffer_load_dwordx4 v176, s[12:15], s26 offen offset:0 lds
buffer_load_dwordx4 v177, s[12:15], s26 offen offset:1024 lds
buffer_load_dwordx4 v178, s[12:15], s26 offen offset:2048 lds
buffer_load_dwordx4 v179, s[12:15], s26 offen offset:3072 lds
s_add_u32 m0, s25, 16384
s_nop 0
buffer_load_dwordx4 v180, s[20:23], s26 offen offset:0 lds
buffer_load_dwordx4 v181, s[20:23], s26 offen offset:1024 lds
buffer_load_dwordx4 v182, s[20:23], s26 offen offset:2048 lds
buffer_load_dwordx4 v183, s[20:23], s26 offen offset:3072 lds
s_mov_b32 s48, s6
s_mov_b32 s49, s7
s_mov_b32 s50, 2101248
s_mov_b32 s51, 0x20000
s_mov_b32 s52, s8
s_mov_b32 s53, s9
s_mov_b32 s54, 2101248
s_mov_b32 s55, 0x20000
s_and_b32 s60, s2, 31
s_lshr_b32 s61, s2, 5
s_lshl_b32 s61, s61, 7
s_add_u32 s60, s60, s61
s_lshl_b32 s61, s66, 5
s_add_u32 s67, s60, s61
s_lshl_b32 s60, s67, 12
s_add_u32 s4, s4, s60
s_addc_u32 s5, s5, 0
s_mov_b32 s6, 4096
s_mov_b32 s7, 0x20000
v_lshlrev_b32 v2, 4, v1
v_xor_b32 v3, 128, v2
s_lshl_b32 s68, s66, 12
s_add_u32 s68, s68, 131072
s_and_b32 s60, s2, 7
s_bfe_u32 s61, s2, 0x10003
s_bfe_u32 s62, s2, 0x20004
s_lshr_b32 s63, s2, 6
s_lshr_b32 s64, s60, 1
s_lshl_b32 s64, s64, 3
s_lshl_b32 s65, s61, 2
s_add_u32 s64, s64, s65
s_and_b32 s65, s60, 1
s_lshl_b32 s65, s65, 1
s_add_u32 s64, s64, s65
s_lshl_b32 s64, s64, 5
s_lshl_b32 s65, s62, 3
s_add_u32 s64, s64, s65
s_lshl_b32 s65, s66, 1
s_add_u32 s64, s64, s65
s_mul_i32 s64, s64, 1026
s_lshl_b32 s65, s63, 8
s_add_u32 s69, s64, s65
v_bfe_u32 v8, v1, 4, 1
v_mul_u32_u24 v8, 32832, v8
v_lshrrev_b32 v9, 5, v1
s_mov_b32 s65, 1050624
v_mul_lo_u32 v9, s65, v9
v_add_u32 v8, v8, v9
v_and_b32 v9, 15, v1
s_lshl_b32 s65, s66, 1
v_xor_b32 v9, s65, v9
v_lshl_add_u32 v18, v9, 4, v8
v_xor_b32 v9, 1, v9
v_lshl_add_u32 v19, v9, 4, v8
v_add_u32 v19, 1026, v19
s_bfe_u32 s64, s2, 0x20005
s_lshl_b32 s64, s64, 8
s_bfe_u32 s65, s2, 0x10004
s_lshl_b32 s65, s65, 6
s_add_u32 s64, s64, s65
s_bfe_u32 s65, s2, 0x10003
s_lshl_b32 s65, s65, 7
s_add_u32 s64, s64, s65
s_and_b32 s65, s2, 7
s_lshl_b32 s65, s65, 2
s_add_u32 s64, s64, s65
v_bfe_u32 v8, v1, 3, 2
v_add_u32 v8, s64, v8
v_bfe_u32 v9, v1, 2, 1
v_lshl_add_u32 v8, v9, 5, v8
v_bfe_u32 v9, v1, 1, 1
v_lshl_add_u32 v8, v9, 10, v8
v_sub_u32 v9, 2048, v8
v_and_b32 v9, 2047, v9
v_and_b32 v10, 1, v1
v_cmp_eq_u32 vcc, 1, v10
s_nop 1
v_cndmask_b32 v8, v8, v9, vcc
v_mul_u32_u24 v17, 1026, v8
s_lshr_b32 s64, s2, 7
s_lshl_b32 s64, s64, 10
v_add_u32 v17, s64, v17
v_mov_b32 v184, 126992
s_lshl_b32 s64, s66, 2
v_add_u32 v185, s64, v184
v_and_b32 v8, 31, v1
v_lshrrev_b32 v9, 5, v1
v_and_b32 v10, 1, v1
v_lshrrev_b32 v11, 1, v8
v_lshlrev_b32 v4, 6, v11
v_lshl_add_u32 v4, v10, 4, v4
v_lshl_add_u32 v4, v9, 12, v4
v_add_u32 v11, v11, v10
v_lshlrev_b32 v11, 6, v11
v_lshl_add_u32 v11, v10, 4, v11
v_lshl_add_u32 v11, v9, 12, v11
v_sub_u32 v5, 5168, v11
v_bfe_u32 v11, v4, 7, 1
v_lshlrev_b32 v11, 5, v11
v_xor_b32 v4, v4, v11
v_bfe_u32 v11, v5, 7, 1
v_lshlrev_b32 v11, 5, v11
v_xor_b32 v5, v5, v11
v_add_u32 v6, 11264, v5
v_and_b32 v6, 0x3fff, v6
s_add_u32 s64, s64, 98304
v_add_u32 v4, s64, v4
v_add_u32 v5, s64, v5
v_add_u32 v6, s64, v6
v_bfe_u32 v11, v1, 3, 1
v_lshlrev_b32 v11, 5, v11
v_xor_b32 v7, v2, v11
v_bfe_u32 v12, v1, 2, 1
v_mul_u32_u24 v12, 2176, v12
v_bfe_u32 v13, v1, 3, 1
v_lshl_add_u32 v12, v13, 6, v12
v_lshl_add_u32 v12, v9, 8, v12
v_bfe_u32 v13, v1, 4, 1
v_lshl_add_u32 v12, v13, 5, v12
v_and_b32 v13, 3, v1
v_lshl_add_u32 v12, v13, 3, v12
v_add_u32 v12, s68, v12
v_xor_b32 v13, 128, v12
s_lshl_b32 s64, s2, 14
s_lshl_b32 s65, s66, 12
s_add_u32 s64, s64, s65
s_add_u32 s42, s64, 16777216
s_add_u32 s40, s32, s42
s_addc_u32 s41, s33, 0
s_mov_b32 s42, 4096
s_mov_b32 s43, 0x20000
s_add_u32 s46, s64, 16777216
s_add_u32 s44, s32, s46
s_addc_u32 s45, s33, 0
s_mov_b32 s46, 4096
s_mov_b32 s47, 0x20000
v_and_b32 v14, 7, v1
v_lshrrev_b32 v15, 3, v1
v_xor_b32 v16, v14, v15
v_lshlrev_b32 v16, 4, v16
v_lshl_add_u32 v16, v14, 11, v16
s_lshr_b32 s64, s66, 1
s_lshl_b32 s64, s64, 7
s_and_b32 s65, s66, 1
s_lshl_b32 s65, s65, 3
s_add_u32 s64, s64, s65
s_add_u32 s64, s64, 147456
v_add_u32 v16, s64, v16
v_lshlrev_b32 v15, 16, v15
v_lshl_add_u32 v15, v14, 4, v15
s_lshl_b32 s64, s63, 7
s_lshr_b32 s65, s66, 1
s_lshl_b32 s65, s65, 6
s_add_u32 s64, s64, s65
s_and_b32 s65, s66, 1
s_lshl_b32 s65, s65, 2
s_add_u32 s64, s64, s65
s_lshl_b32 s64, s64, 13
s_lshl_b32 s65, s60, 10
s_add_u32 s64, s64, s65
s_lshl_b32 s65, s61, 9
s_add_u32 s64, s64, s65
s_lshl_b32 s65, s62, 7
s_add_u32 s64, s64, s65
s_add_u32 s58, s64, 25165824
s_add_u32 s56, s32, s58
s_addc_u32 s57, s33, 0
s_sub_u32 s58, 4194304, s64
s_mov_b32 s59, 0x20000
v_and_b32 v104, 31, v1
v_cvt_f32_u32 v104, v104
v_lshrrev_b32 v105, 5, v1
v_lshlrev_b32 v105, 2, v105
v_cvt_f32_u32 v105, v105
v_mul_f32 v105, v104, v105
v_mul_f32 v105, 0x3d000000, v105
v_fmamk_f32 v106, v104, 0x0, v105
v_fract_f32 v106, v106
v_cos_f32 v107, v106
v_sin_f32 v108, v106
s_nop 0
v_cvt_pk_bf16_f32 v192, v107, v108
v_cvt_pk_bf16_f32 v208, -v108, v107
v_fmamk_f32 v109, v104, 0x3d000000, v105
v_fract_f32 v109, v109
v_cos_f32 v110, v109
v_sin_f32 v111, v109
s_nop 0
v_cvt_pk_bf16_f32 v193, v110, v111
v_cvt_pk_bf16_f32 v209, -v111, v110
v_fmamk_f32 v106, v104, 0x3d800000, v105
v_fract_f32 v106, v106
v_cos_f32 v107, v106
v_sin_f32 v108, v106
s_nop 0
v_cvt_pk_bf16_f32 v194, v107, v108
v_cvt_pk_bf16_f32 v210, -v108, v107
v_fmamk_f32 v109, v104, 0x3dc00000, v105
v_fract_f32 v109, v109
v_cos_f32 v110, v109
v_sin_f32 v111, v109
s_nop 0
v_cvt_pk_bf16_f32 v195, v110, v111
v_cvt_pk_bf16_f32 v211, -v111, v110
v_fmamk_f32 v106, v104, 0x3e800000, v105
v_fract_f32 v106, v106
v_cos_f32 v107, v106
v_sin_f32 v108, v106
s_nop 0
v_cvt_pk_bf16_f32 v196, v107, v108
v_cvt_pk_bf16_f32 v212, -v108, v107
v_fmamk_f32 v109, v104, 0x3e900000, v105
v_fract_f32 v109, v109
v_cos_f32 v110, v109
v_sin_f32 v111, v109
s_nop 0
v_cvt_pk_bf16_f32 v197, v110, v111
v_cvt_pk_bf16_f32 v213, -v111, v110
v_fmamk_f32 v106, v104, 0x3ea00000, v105
v_fract_f32 v106, v106
v_cos_f32 v107, v106
v_sin_f32 v108, v106
s_nop 0
v_cvt_pk_bf16_f32 v198, v107, v108
v_cvt_pk_bf16_f32 v214, -v108, v107
v_fmamk_f32 v109, v104, 0x3eb00000, v105
v_fract_f32 v109, v109
v_cos_f32 v110, v109
v_sin_f32 v111, v109
s_nop 0
v_cvt_pk_bf16_f32 v199, v110, v111
v_cvt_pk_bf16_f32 v215, -v111, v110
v_fmamk_f32 v106, v104, 0x3f000000, v105
v_fract_f32 v106, v106
v_cos_f32 v107, v106
v_sin_f32 v108, v106
s_nop 0
v_cvt_pk_bf16_f32 v200, v107, v108
v_cvt_pk_bf16_f32 v216, -v108, v107
v_fmamk_f32 v109, v104, 0x3f080000, v105
v_fract_f32 v109, v109
v_cos_f32 v110, v109
v_sin_f32 v111, v109
s_nop 0
v_cvt_pk_bf16_f32 v201, v110, v111
v_cvt_pk_bf16_f32 v217, -v111, v110
v_fmamk_f32 v106, v104, 0x3f100000, v105
v_fract_f32 v106, v106
v_cos_f32 v107, v106
v_sin_f32 v108, v106
s_nop 0
v_cvt_pk_bf16_f32 v202, v107, v108
v_cvt_pk_bf16_f32 v218, -v108, v107
v_fmamk_f32 v109, v104, 0x3f180000, v105
v_fract_f32 v109, v109
v_cos_f32 v110, v109
v_sin_f32 v111, v109
s_nop 0
v_cvt_pk_bf16_f32 v203, v110, v111
v_cvt_pk_bf16_f32 v219, -v111, v110
v_fmamk_f32 v106, v104, 0x3f400000, v105
v_fract_f32 v106, v106
v_cos_f32 v107, v106
v_sin_f32 v108, v106
s_nop 0
v_cvt_pk_bf16_f32 v204, v107, v108
v_cvt_pk_bf16_f32 v220, -v108, v107
v_fmamk_f32 v109, v104, 0x3f480000, v105
v_fract_f32 v109, v109
v_cos_f32 v110, v109
v_sin_f32 v111, v109
s_nop 0
v_cvt_pk_bf16_f32 v205, v110, v111
v_cvt_pk_bf16_f32 v221, -v111, v110
v_fmamk_f32 v106, v104, 0x3f500000, v105
v_fract_f32 v106, v106
v_cos_f32 v107, v106
v_sin_f32 v108, v106
s_nop 0
v_cvt_pk_bf16_f32 v206, v107, v108
v_cvt_pk_bf16_f32 v222, -v108, v107
v_fmamk_f32 v109, v104, 0x3f580000, v105
v_fract_f32 v109, v109
v_cos_f32 v110, v109
v_sin_f32 v111, v109
s_nop 0
v_cvt_pk_bf16_f32 v207, v110, v111
v_cvt_pk_bf16_f32 v223, -v111, v110
v_and_b32 v104, 31, v1
v_cvt_f32_u32 v104, v104
v_lshrrev_b32 v105, 5, v1
v_lshlrev_b32 v105, 2, v105
v_cvt_f32_u32 v105, v105
v_mul_f32 v105, v104, v105
v_mul_f32 v105, 0x3a800000, v105
v_fmamk_f32 v106, v104, 0x0, v105
v_cos_f32 v224, v106
v_sin_f32 v240, -v106
v_fmamk_f32 v107, v104, 0x3a800000, v105
v_cos_f32 v225, v107
v_sin_f32 v241, -v107
v_fmamk_f32 v106, v104, 0x3b000000, v105
v_cos_f32 v226, v106
v_sin_f32 v242, -v106
v_fmamk_f32 v107, v104, 0x3b400000, v105
v_cos_f32 v227, v107
v_sin_f32 v243, -v107
v_fmamk_f32 v106, v104, 0x3c000000, v105
v_cos_f32 v228, v106
v_sin_f32 v244, -v106
v_fmamk_f32 v107, v104, 0x3c100000, v105
v_cos_f32 v229, v107
v_sin_f32 v245, -v107
v_fmamk_f32 v106, v104, 0x3c200000, v105
v_cos_f32 v230, v106
v_sin_f32 v246, -v106
v_fmamk_f32 v107, v104, 0x3c300000, v105
v_cos_f32 v231, v107
v_sin_f32 v247, -v107
v_fmamk_f32 v106, v104, 0x3c800000, v105
v_cos_f32 v232, v106
v_sin_f32 v248, -v106
v_fmamk_f32 v107, v104, 0x3c880000, v105
v_cos_f32 v233, v107
v_sin_f32 v249, -v107
v_fmamk_f32 v106, v104, 0x3c900000, v105
v_cos_f32 v234, v106
v_sin_f32 v250, -v106
v_fmamk_f32 v107, v104, 0x3c980000, v105
v_cos_f32 v235, v107
v_sin_f32 v251, -v107
v_fmamk_f32 v106, v104, 0x3cc00000, v105
v_cos_f32 v236, v106
v_sin_f32 v252, -v106
v_fmamk_f32 v107, v104, 0x3cc80000, v105
v_cos_f32 v237, v107
v_sin_f32 v253, -v107
v_fmamk_f32 v106, v104, 0x3cd00000, v105
v_cos_f32 v238, v106
v_sin_f32 v254, -v106
v_fmamk_f32 v107, v104, 0x3cd80000, v105
v_cos_f32 v239, v107
v_sin_f32 v255, -v107
s_add_u32 m0, s25, 32768
s_add_u32 s26, s24, 128
s_and_b32 s26, s26, 0x7ff
buffer_load_dwordx4 v176, s[12:15], s26 offen offset:0 lds
buffer_load_dwordx4 v177, s[12:15], s26 offen offset:1024 lds
buffer_load_dwordx4 v178, s[12:15], s26 offen offset:2048 lds
buffer_load_dwordx4 v179, s[12:15], s26 offen offset:3072 lds
s_add_u32 m0, s25, 49152
s_nop 0
buffer_load_dwordx4 v180, s[20:23], s26 offen offset:0 lds
buffer_load_dwordx4 v181, s[20:23], s26 offen offset:1024 lds
buffer_load_dwordx4 v182, s[20:23], s26 offen offset:2048 lds
buffer_load_dwordx4 v183, s[20:23], s26 offen offset:3072 lds
s_waitcnt vmcnt(8)
s_barrier
s_add_u32 m0, s25, 65536
s_add_u32 s26, s24, 256
s_and_b32 s26, s26, 0x7ff
buffer_load_dwordx4 v176, s[12:15], s26 offen offset:0 lds
buffer_load_dwordx4 v177, s[12:15], s26 offen offset:1024 lds
buffer_load_dwordx4 v178, s[12:15], s26 offen offset:2048 lds
buffer_load_dwordx4 v179, s[12:15], s26 offen offset:3072 lds
s_add_u32 m0, s25, 81920
s_nop 0
buffer_load_dwordx4 v180, s[20:23], s26 offen offset:0 lds
buffer_load_dwordx4 v181, s[20:23], s26 offen offset:1024 lds
buffer_load_dwordx4 v182, s[20:23], s26 offen offset:2048 lds
buffer_load_dwordx4 v183, s[20:23], s26 offen offset:3072 lds
s_waitcnt vmcnt(8)
s_barrier
s_add_u32 m0, s25, 0
s_add_u32 s26, s24, 384
s_and_b32 s26, s26, 0x7ff
buffer_load_dwordx4 v176, s[12:15], s26 offen offset:0 lds
buffer_load_dwordx4 v177, s[12:15], s26 offen offset:1024 lds
buffer_load_dwordx4 v178, s[12:15], s26 offen offset:2048 lds
buffer_load_dwordx4 v179, s[12:15], s26 offen offset:3072 lds
s_add_u32 m0, s25, 16384
s_nop 0
buffer_load_dwordx4 v180, s[20:23], s26 offen offset:0 lds
buffer_load_dwordx4 v181, s[20:23], s26 offen offset:1024 lds
buffer_load_dwordx4 v182, s[20:23], s26 offen offset:2048 lds
buffer_load_dwordx4 v183, s[20:23], s26 offen offset:3072 lds
s_waitcnt vmcnt(8)
s_barrier
s_add_u32 m0, s25, 32768
s_add_u32 s26, s24, 512
s_and_b32 s26, s26, 0x7ff
buffer_load_dwordx4 v176, s[12:15], s26 offen offset:0 lds
buffer_load_dwordx4 v177, s[12:15], s26 offen offset:1024 lds
buffer_load_dwordx4 v178, s[12:15], s26 offen offset:2048 lds
buffer_load_dwordx4 v179, s[12:15], s26 offen offset:3072 lds
s_add_u32 m0, s25, 49152
s_nop 0
buffer_load_dwordx4 v180, s[20:23], s26 offen offset:0 lds
buffer_load_dwordx4 v181, s[20:23], s26 offen offset:1024 lds
buffer_load_dwordx4 v182, s[20:23], s26 offen offset:2048 lds
buffer_load_dwordx4 v183, s[20:23], s26 offen offset:3072 lds
s_waitcnt vmcnt(8)
s_barrier
s_add_u32 m0, s25, 65536
s_add_u32 s26, s24, 640
s_and_b32 s26, s26, 0x7ff
buffer_load_dwordx4 v176, s[12:15], s26 offen offset:0 lds
buffer_load_dwordx4 v177, s[12:15], s26 offen offset:1024 lds
buffer_load_dwordx4 v178, s[12:15], s26 offen offset:2048 lds
buffer_load_dwordx4 v179, s[12:15], s26 offen offset:3072 lds
s_add_u32 m0, s25, 81920
s_nop 0
buffer_load_dwordx4 v180, s[20:23], s26 offen offset:0 lds
buffer_load_dwordx4 v181, s[20:23], s26 offen offset:1024 lds
buffer_load_dwordx4 v182, s[20:23], s26 offen offset:2048 lds
buffer_load_dwordx4 v183, s[20:23], s26 offen offset:3072 lds
s_waitcnt vmcnt(8)
s_barrier
s_add_u32 m0, s25, 0
s_add_u32 s26, s24, 768
s_and_b32 s26, s26, 0x7ff
buffer_load_dwordx4 v176, s[12:15], s26 offen offset:0 lds
buffer_load_dwordx4 v177, s[12:15], s26 offen offset:1024 lds
buffer_load_dwordx4 v178, s[12:15], s26 offen offset:2048 lds
buffer_load_dwordx4 v179, s[12:15], s26 offen offset:3072 lds
s_add_u32 m0, s25, 16384
s_nop 0
buffer_load_dwordx4 v180, s[20:23], s26 offen offset:0 lds
buffer_load_dwordx4 v181, s[20:23], s26 offen offset:1024 lds
buffer_load_dwordx4 v182, s[20:23], s26 offen offset:2048 lds
buffer_load_dwordx4 v183, s[20:23], s26 offen offset:3072 lds
s_waitcnt vmcnt(8)
s_barrier
s_add_u32 m0, s25, 32768
s_add_u32 s26, s24, 896
s_and_b32 s26, s26, 0x7ff
buffer_load_dwordx4 v176, s[12:15], s26 offen offset:0 lds
buffer_load_dwordx4 v177, s[12:15], s26 offen offset:1024 lds
buffer_load_dwordx4 v178, s[12:15], s26 offen offset:2048 lds
buffer_load_dwordx4 v179, s[12:15], s26 offen offset:3072 lds
s_add_u32 m0, s25, 49152
s_nop 0
buffer_load_dwordx4 v180, s[20:23], s26 offen offset:0 lds
buffer_load_dwordx4 v181, s[20:23], s26 offen offset:1024 lds
buffer_load_dwordx4 v182, s[20:23], s26 offen offset:2048 lds
buffer_load_dwordx4 v183, s[20:23], s26 offen offset:3072 lds
v_and_b32 v104, 31, v1
v_cvt_f32_u32 v104, v104
v_lshrrev_b32 v105, 5, v1
v_lshlrev_b32 v105, 2, v105
v_cvt_f32_u32 v105, v105
v_mul_f32 v104, 0x3a000000, v104
v_fmamk_f32 v105, v105, 0x3c800000, v104
v_add_f32 v106, 0x0, v105
v_cos_f32 v136, v106
v_sin_f32 v152, -v106
v_add_f32 v107, 0x3c800000, v105
v_cos_f32 v137, v107
v_sin_f32 v153, -v107
v_add_f32 v106, 0x3d000000, v105
v_cos_f32 v138, v106
v_sin_f32 v154, -v106
v_add_f32 v107, 0x3d400000, v105
v_cos_f32 v139, v107
v_sin_f32 v155, -v107
v_add_f32 v106, 0x3e000000, v105
v_cos_f32 v140, v106
v_sin_f32 v156, -v106
v_add_f32 v107, 0x3e100000, v105
v_cos_f32 v141, v107
v_sin_f32 v157, -v107
v_add_f32 v106, 0x3e200000, v105
v_cos_f32 v142, v106
v_sin_f32 v158, -v106
v_add_f32 v107, 0x3e300000, v105
v_cos_f32 v143, v107
v_sin_f32 v159, -v107
v_add_f32 v106, 0x3e800000, v105
v_cos_f32 v144, v106
v_sin_f32 v160, -v106
v_add_f32 v107, 0x3e880000, v105
v_cos_f32 v145, v107
v_sin_f32 v161, -v107
v_add_f32 v106, 0x3e900000, v105
v_cos_f32 v146, v106
v_sin_f32 v162, -v106
v_add_f32 v107, 0x3e980000, v105
v_cos_f32 v147, v107
v_sin_f32 v163, -v107
v_add_f32 v106, 0x3ec00000, v105
v_cos_f32 v148, v106
v_sin_f32 v164, -v106
v_add_f32 v107, 0x3ec80000, v105
v_cos_f32 v149, v107
v_sin_f32 v165, -v107
v_add_f32 v106, 0x3ed00000, v105
v_cos_f32 v150, v106
v_sin_f32 v166, -v106
v_add_f32 v107, 0x3ed80000, v105
v_cos_f32 v151, v107
v_sin_f32 v167, -v107
s_waitcnt vmcnt(8)
s_barrier
s_add_u32 m0, s25, 65536
s_add_u32 s26, s24, 1024
s_and_b32 s26, s26, 0x7ff
buffer_load_dwordx4 v176, s[12:15], s26 offen offset:0 lds
buffer_load_dwordx4 v177, s[12:15], s26 offen offset:1024 lds
buffer_load_dwordx4 v178, s[12:15], s26 offen offset:2048 lds
buffer_load_dwordx4 v179, s[12:15], s26 offen offset:3072 lds
s_add_u32 m0, s25, 81920
s_nop 0
buffer_load_dwordx4 v180, s[20:23], s26 offen offset:0 lds
buffer_load_dwordx4 v181, s[20:23], s26 offen offset:1024 lds
buffer_load_dwordx4 v182, s[20:23], s26 offen offset:2048 lds
buffer_load_dwordx4 v183, s[20:23], s26 offen offset:3072 lds
s_waitcnt vmcnt(8)
s_barrier
s_add_u32 m0, s25, 0
s_add_u32 s26, s24, 1152
s_and_b32 s26, s26, 0x7ff
buffer_load_dwordx4 v176, s[12:15], s26 offen offset:0 lds
buffer_load_dwordx4 v177, s[12:15], s26 offen offset:1024 lds
buffer_load_dwordx4 v178, s[12:15], s26 offen offset:2048 lds
buffer_load_dwordx4 v179, s[12:15], s26 offen offset:3072 lds
s_add_u32 m0, s25, 16384
s_nop 0
buffer_load_dwordx4 v180, s[20:23], s26 offen offset:0 lds
buffer_load_dwordx4 v181, s[20:23], s26 offen offset:1024 lds
buffer_load_dwordx4 v182, s[20:23], s26 offen offset:2048 lds
buffer_load_dwordx4 v183, s[20:23], s26 offen offset:3072 lds
v_mov_b32 v20, 0
global_load_dword v21, v20, s[30:31] sc1
s_waitcnt vmcnt(9)
s_barrier
s_add_u32 m0, s25, 32768
s_add_u32 s26, s24, 1280
s_and_b32 s26, s26, 0x7ff
buffer_load_dwordx4 v176, s[12:15], s26 offen offset:0 lds
buffer_load_dwordx4 v177, s[12:15], s26 offen offset:1024 lds
buffer_load_dwordx4 v178, s[12:15], s26 offen offset:2048 lds
buffer_load_dwordx4 v179, s[12:15], s26 offen offset:3072 lds
s_add_u32 m0, s25, 49152
s_nop 0
buffer_load_dwordx4 v180, s[20:23], s26 offen offset:0 lds
buffer_load_dwordx4 v181, s[20:23], s26 offen offset:1024 lds
buffer_load_dwordx4 v182, s[20:23], s26 offen offset:2048 lds
buffer_load_dwordx4 v183, s[20:23], s26 offen offset:3072 lds
s_waitcnt vmcnt(9)
s_barrier
s_add_u32 m0, s25, 65536
s_add_u32 s26, s24, 1408
s_and_b32 s26, s26, 0x7ff
buffer_load_dwordx4 v176, s[12:15], s26 offen offset:0 lds
buffer_load_dwordx4 v177, s[12:15], s26 offen offset:1024 lds
buffer_load_dwordx4 v178, s[12:15], s26 offen offset:2048 lds
buffer_load_dwordx4 v179, s[12:15], s26 offen offset:3072 lds
s_add_u32 m0, s25, 81920
s_nop 0
buffer_load_dwordx4 v180, s[20:23], s26 offen offset:0 lds
buffer_load_dwordx4 v181, s[20:23], s26 offen offset:1024 lds
buffer_load_dwordx4 v182, s[20:23], s26 offen offset:2048 lds
buffer_load_dwordx4 v183, s[20:23], s26 offen offset:3072 lds
s_waitcnt vmcnt(8)
s_barrier
s_add_u32 m0, s25, 0
s_add_u32 s26, s24, 1536
s_and_b32 s26, s26, 0x7ff
buffer_load_dwordx4 v176, s[12:15], s26 offen offset:0 lds
buffer_load_dwordx4 v177, s[12:15], s26 offen offset:1024 lds
buffer_load_dwordx4 v178, s[12:15], s26 offen offset:2048 lds
buffer_load_dwordx4 v179, s[12:15], s26 offen offset:3072 lds
s_add_u32 m0, s25, 16384
s_nop 0
buffer_load_dwordx4 v180, s[20:23], s26 offen offset:0 lds
buffer_load_dwordx4 v181, s[20:23], s26 offen offset:1024 lds
buffer_load_dwordx4 v182, s[20:23], s26 offen offset:2048 lds
buffer_load_dwordx4 v183, s[20:23], s26 offen offset:3072 lds
s_waitcnt vmcnt(8)
s_barrier
s_add_u32 m0, s25, 32768
s_add_u32 s26, s24, 1664
s_and_b32 s26, s26, 0x7ff
buffer_load_dwordx4 v176, s[12:15], s26 offen offset:0 lds
buffer_load_dwordx4 v177, s[12:15], s26 offen offset:1024 lds
buffer_load_dwordx4 v178, s[12:15], s26 offen offset:2048 lds
buffer_load_dwordx4 v179, s[12:15], s26 offen offset:3072 lds
s_add_u32 m0, s25, 49152
s_nop 0
buffer_load_dwordx4 v180, s[20:23], s26 offen offset:0 lds
buffer_load_dwordx4 v181, s[20:23], s26 offen offset:1024 lds
buffer_load_dwordx4 v182, s[20:23], s26 offen offset:2048 lds
buffer_load_dwordx4 v183, s[20:23], s26 offen offset:3072 lds
s_waitcnt vmcnt(8)
s_barrier
s_add_u32 m0, s25, 65536
s_add_u32 s26, s24, 1792
s_and_b32 s26, s26, 0x7ff
buffer_load_dwordx4 v176, s[12:15], s26 offen offset:0 lds
buffer_load_dwordx4 v177, s[12:15], s26 offen offset:1024 lds
buffer_load_dwordx4 v178, s[12:15], s26 offen offset:2048 lds
buffer_load_dwordx4 v179, s[12:15], s26 offen offset:3072 lds
s_add_u32 m0, s25, 81920
s_nop 0
buffer_load_dwordx4 v180, s[20:23], s26 offen offset:0 lds
buffer_load_dwordx4 v181, s[20:23], s26 offen offset:1024 lds
buffer_load_dwordx4 v182, s[20:23], s26 offen offset:2048 lds
buffer_load_dwordx4 v183, s[20:23], s26 offen offset:3072 lds
s_waitcnt vmcnt(8)
s_barrier
s_add_u32 m0, s25, 0
s_add_u32 s26, s24, 1920
s_and_b32 s26, s26, 0x7ff
buffer_load_dwordx4 v176, s[12:15], s26 offen offset:0 lds
buffer_load_dwordx4 v177, s[12:15], s26 offen offset:1024 lds
buffer_load_dwordx4 v178, s[12:15], s26 offen offset:2048 lds
buffer_load_dwordx4 v179, s[12:15], s26 offen offset:3072 lds
s_add_u32 m0, s25, 16384
s_nop 0
buffer_load_dwordx4 v180, s[20:23], s26 offen offset:0 lds
buffer_load_dwordx4 v181, s[20:23], s26 offen offset:1024 lds
buffer_load_dwordx4 v182, s[20:23], s26 offen offset:2048 lds
buffer_load_dwordx4 v183, s[20:23], s26 offen offset:3072 lds
s_waitcnt vmcnt(8)
s_barrier
s_waitcnt vmcnt(0)
s_barrier
s_add_u32 m0, s68, 0
s_mov_b32 s92, 0
buffer_load_dwordx4 v2, s[4:7], s92 offen offset:0 nt lds
buffer_load_dwordx4 v2, s[4:7], s92 offen offset:1024 nt lds
s_add_u32 m0, s68, 2048
s_mov_b32 s92, 2048
buffer_load_dwordx4 v3, s[4:7], s92 offen offset:0 nt lds
buffer_load_dwordx4 v3, s[4:7], s92 offen offset:1024 nt lds
s_add_u32 m0, s68, 16384
s_nop 0
buffer_load_dwordx4 v18, s[48:51], s69 offen nt lds
s_add_u32 m0, s68, 17408
s_nop 0
buffer_load_dwordx4 v18, s[52:55], s69 offen nt lds
s_add_u32 m0, s68, 18432
s_nop 0
buffer_load_dwordx4 v19, s[48:51], s69 offen nt lds
s_add_u32 m0, s68, 19456
s_nop 0
buffer_load_dwordx4 v19, s[52:55], s69 offen nt lds
s_cmp_lg_u32 s66, 3
s_cbranch_scc1 L_nw1
s_mov_b32 exec_hi, 0
buffer_load_ushort v88, v17, s[48:51], 0 offen nt
buffer_load_ushort v89, v17, s[52:55], 0 offen nt
s_mov_b64 exec, -1
L_nw1:
s_barrier
s_barrier
s_setprio 3
v_readfirstlane_b32 s37, v21
s_nop 0
s_cmp_lg_u32 s37, 0
s_cbranch_scc1 L_sg2
v_mov_b32 v20, 0
L_n3:
global_load_dword v21, v20, s[30:31] sc1
s_waitcnt vmcnt(0)
v_readfirstlane_b32 s37, v21
s_nop 0
s_cmp_eq_u32 s37, 0
s_cbranch_scc1 L_n3
L_sg2:
s_waitcnt vmcnt(4)
ds_read_b64_tr_b16 v[24:25], v12 offset:0
ds_read_b64_tr_b16 v[26:27], v13 offset:0
ds_read_b64_tr_b16 v[28:29], v12 offset:512
ds_read_b64_tr_b16 v[30:31], v13 offset:512
ds_read_b64_tr_b16 v[32:33], v12 offset:1024
ds_read_b64_tr_b16 v[34:35], v13 offset:1024
ds_read_b64_tr_b16 v[36:37], v12 offset:1536
ds_read_b64_tr_b16 v[38:39], v13 offset:1536
s_waitcnt lgkmcnt(0)
v_mfma_f32_32x32x16_bf16 v[40:55], v[24:27], v[192:195], 0
v_mfma_f32_32x32x16_bf16 v[40:55], v[28:31], v[196:199], v[40:55]
v_mfma_f32_32x32x16_bf16 v[40:55], v[32:35], v[200:203], v[40:55]
v_mfma_f32_32x32x16_bf16 v[40:55], v[36:39], v[204:207], v[40:55]
v_mfma_f32_32x32x16_bf16 v[56:71], v[24:27], v[208:211], 0
v_mfma_f32_32x32x16_bf16 v[56:71], v[28:31], v[212:215], v[56:71]
v_mfma_f32_32x32x16_bf16 v[56:71], v[32:35], v[216:219], v[56:71]
v_mfma_f32_32x32x16_bf16 v[56:71], v[36:39], v[220:223], v[56:71]
s_nop 7
v_mul_f32 v168, v40, v224
v_mul_f32 v169, v40, v240
s_nop 1
v_fma_f32 v168, -v56, v240, v168
v_fmac_f32 v169, v56, v224
v_cvt_pk_bf16_f32 v72, v168, v169
v_mul_f32 v170, v41, v225
v_mul_f32 v171, v41, v241
v_fma_f32 v170, -v57, v241, v170
v_fmac_f32 v171, v57, v225
v_cvt_pk_bf16_f32 v73, v170, v171
v_mul_f32 v172, v42, v226
v_mul_f32 v173, v42, v242
v_fma_f32 v172, -v58, v242, v172
v_fmac_f32 v173, v58, v226
v_cvt_pk_bf16_f32 v74, v172, v173
v_mul_f32 v174, v43, v227
v_mul_f32 v175, v43, v243
v_fma_f32 v174, -v59, v243, v174
v_fmac_f32 v175, v59, v227
v_cvt_pk_bf16_f32 v75, v174, v175
v_mul_f32 v168, v44, v228
v_mul_f32 v169, v44, v244
v_fma_f32 v168, -v60, v244, v168
v_fmac_f32 v169, v60, v228
v_cvt_pk_bf16_f32 v76, v168, v169
v_mul_f32 v170, v45, v229
v_mul_f32 v171, v45, v245
v_fma_f32 v170, -v61, v245, v170
v_fmac_f32 v171, v61, v229
v_cvt_pk_bf16_f32 v77, v170, v171
v_mul_f32 v172, v46, v230
v_mul_f32 v173, v46, v246
v_fma_f32 v172, -v62, v246, v172
v_fmac_f32 v173, v62, v230
v_cvt_pk_bf16_f32 v78, v172, v173
v_mul_f32 v174, v47, v231
v_mul_f32 v175, v47, v247
v_fma_f32 v174, -v63, v247, v174
v_fmac_f32 v175, v63, v231
v_cvt_pk_bf16_f32 v79, v174, v175
v_mul_f32 v168, v48, v232
v_mul_f32 v169, v48, v248
v_fma_f32 v168, -v64, v248, v168
v_fmac_f32 v169, v64, v232
v_cvt_pk_bf16_f32 v80, v168, v169
v_mul_f32 v170, v49, v233
v_mul_f32 v171, v49, v249
v_fma_f32 v170, -v65, v249, v170
v_fmac_f32 v171, v65, v233
v_cvt_pk_bf16_f32 v81, v170, v171
v_mul_f32 v172, v50, v234
v_mul_f32 v173, v50, v250
v_fma_f32 v172, -v66, v250, v172
v_fmac_f32 v173, v66, v234
v_cvt_pk_bf16_f32 v82, v172, v173
v_mul_f32 v174, v51, v235
v_mul_f32 v175, v51, v251
v_fma_f32 v174, -v67, v251, v174
v_fmac_f32 v175, v67, v235
v_cvt_pk_bf16_f32 v83, v174, v175
v_mul_f32 v168, v52, v236
v_mul_f32 v169, v52, v252
v_fma_f32 v168, -v68, v252, v168
v_fmac_f32 v169, v68, v236
v_cvt_pk_bf16_f32 v84, v168, v169
v_mul_f32 v170, v53, v237
v_mul_f32 v171, v53, v253
v_fma_f32 v170, -v69, v253, v170
v_fmac_f32 v171, v69, v237
v_cvt_pk_bf16_f32 v85, v170, v171
v_mul_f32 v172, v54, v238
v_mul_f32 v173, v54, v254
v_fma_f32 v172, -v70, v254, v172
v_fmac_f32 v173, v70, v238
v_cvt_pk_bf16_f32 v86, v172, v173
v_mul_f32 v174, v55, v239
v_mul_f32 v175, v55, v255
v_fma_f32 v174, -v71, v255, v174
v_fmac_f32 v175, v71, v239
v_cvt_pk_bf16_f32 v87, v174, v175
v_mfma_f32_32x32x16_bf16 v[40:55], v[192:195], v[72:75], 0
v_mfma_f32_32x32x16_bf16 v[40:55], v[196:199], v[76:79], v[40:55]
v_mfma_f32_32x32x16_bf16 v[40:55], v[200:203], v[80:83], v[40:55]
v_mfma_f32_32x32x16_bf16 v[40:55], v[204:207], v[84:87], v[40:55]
v_mfma_f32_32x32x16_bf16 v[56:71], v[208:211], v[72:75], 0
v_mfma_f32_32x32x16_bf16 v[56:71], v[212:215], v[76:79], v[56:71]
v_mfma_f32_32x32x16_bf16 v[56:71], v[216:219], v[80:83], v[56:71]
v_mfma_f32_32x32x16_bf16 v[56:71], v[220:223], v[84:87], v[56:71]
s_mov_b32 s64, 0x05040100
s_mov_b32 s65, 0x07060302
s_lshl_b32 s92, s66, 12
s_add_u32 s92, s92, 98304
v_add_u32 v8, s92, v7
s_nop 6
v_cvt_pk_bf16_f32 v72, v40, v56
ds_write_b32 v4, v72 offset:0
v_cvt_pk_bf16_f32 v73, v41, v57
ds_write_b32 v4, v73 offset:1024
v_cvt_pk_bf16_f32 v74, v42, v58
ds_write_b32 v4, v74 offset:2048
v_cvt_pk_bf16_f32 v75, v43, v59
ds_write_b32 v4, v75 offset:3072
v_cvt_pk_bf16_f32 v76, v44, v60
ds_write_b32 v4, v76 offset:8192
v_cvt_pk_bf16_f32 v77, v45, v61
ds_write_b32 v4, v77 offset:9216
v_cvt_pk_bf16_f32 v78, v46, v62
ds_write_b32 v4, v78 offset:10240
v_cvt_pk_bf16_f32 v79, v47, v63
ds_write_b32 v4, v79 offset:11264
v_cvt_pk_bf16_f32 v80, v48, v64
ds_write_b32 v6, v80 offset:0
v_cvt_pk_bf16_f32 v81, v49, v65
ds_write_b32 v5, v81 offset:10240
v_cvt_pk_bf16_f32 v82, v50, v66
ds_write_b32 v5, v82 offset:9216
v_cvt_pk_bf16_f32 v83, v51, v67
ds_write_b32 v5, v83 offset:8192
v_cvt_pk_bf16_f32 v84, v52, v68
ds_write_b32 v5, v84 offset:3072
v_cvt_pk_bf16_f32 v85, v53, v69
ds_write_b32 v5, v85 offset:2048
v_cvt_pk_bf16_f32 v86, v54, v70
ds_write_b32 v5, v86 offset:1024
v_cvt_pk_bf16_f32 v87, v55, v71
ds_write_b32 v5, v87 offset:0
s_waitcnt vmcnt(0) lgkmcnt(0)
v_mov_b32 v190, 1
s_mov_b64 exec, 1
ds_write_b32 v185, v190
s_mov_b64 exec, -1
L_lc5:
ds_read_b128 v[186:189], v184
s_waitcnt lgkmcnt(0)
v_min3_u32 v186, v186, v187, v188
v_min_u32 v186, v186, v189
s_nop 0
v_readfirstlane_b32 s92, v186
s_nop 0
s_cmp_ge_u32 s92, 1
s_cbranch_scc1 L_lcd6
s_sleep 1
s_branch L_lc5
L_lcd6:
ds_read_b128 v[72:75], v8 offset:0
ds_read_b128 v[76:79], v8 offset:1024
ds_read_b128 v[80:83], v8 offset:2048
ds_read_b128 v[84:87], v8 offset:3072
ds_read_b64 v[104:105], v16 offset:0
ds_read_b64 v[106:107], v16 offset:256
ds_read_b64 v[108:109], v16 offset:512
ds_read_b64 v[110:111], v16 offset:768
ds_read_b64 v[112:113], v16 offset:1024
ds_read_b64 v[114:115], v16 offset:1280
ds_read_b64 v[116:117], v16 offset:1536
ds_read_b64 v[118:119], v16 offset:1792
v_add_u32 v4, 32768, v4
v_add_u32 v5, 32768, v5
v_add_u32 v6, 32768, v6
v_lshlrev_b32 v88, 16, v88
v_lshlrev_b32 v89, 16, v89
v_lshlrev_b32 v9, 1, v1
v_add_f32_dpp v90, v88, v88 quad_perm:[1,0,3,2] row_mask:0xf bank_mask:0xf
v_subrev_f32_dpp v91, v89, v89 quad_perm:[1,0,3,2] row_mask:0xf bank_mask:0xf
v_mul_f32 v90, 0.5, v90
v_mul_f32 v91, 0.5, v91
v_cvt_pk_bf16_f32 v88, v90, v91
s_waitcnt lgkmcnt(0)
v_mov_b32 v190, 2
s_mov_b64 exec, 1
ds_write_b32 v185, v190
s_mov_b64 exec, -1
v_perm_b32 v120, v112, v104, s64
v_perm_b32 v121, v116, v108, s64
v_perm_b32 v122, v114, v106, s64
v_perm_b32 v123, v118, v110, s64
v_perm_b32 v124, v112, v104, s65
v_perm_b32 v125, v116, v108, s65
v_perm_b32 v126, v114, v106, s65
v_perm_b32 v127, v118, v110, s65
v_perm_b32 v128, v113, v105, s64
v_perm_b32 v129, v117, v109, s64
v_perm_b32 v130, v115, v107, s64
v_perm_b32 v131, v119, v111, s64
v_perm_b32 v132, v113, v105, s65
v_perm_b32 v133, v117, v109, s65
v_perm_b32 v134, v115, v107, s65
v_perm_b32 v135, v119, v111, s65
buffer_store_dwordx4 v[72:75], v2, s[40:43], 0 offen offset:0 sc1
buffer_store_dwordx4 v[76:79], v2, s[40:43], 0 offen offset:1024 sc1
buffer_store_dwordx4 v[80:83], v2, s[40:43], 0 offen offset:2048 sc1
buffer_store_dwordx4 v[84:87], v2, s[40:43], 0 offen offset:3072 sc1
s_mov_b32 s92, 0
buffer_store_dwordx4 v[120:123], v15, s[56:59], s92 offen sc1
s_mov_b32 s92, 8192
buffer_store_dwordx4 v[124:127], v15, s[56:59], s92 offen sc1
s_mov_b32 s92, 16384
buffer_store_dwordx4 v[128:131], v15, s[56:59], s92 offen sc1
s_mov_b32 s92, 24576
buffer_store_dwordx4 v[132:135], v15, s[56:59], s92 offen sc1
s_cmp_lg_u32 s66, 3
s_cbranch_scc1 L_nw7
s_lshr_b32 s64, s2, 7
s_sub_u32 s64, 513, s64
s_lshl_b32 s64, s64, 13
s_and_b32 s65, s2, 127
s_lshl_b32 s65, s65, 6
s_add_u32 s64, s64, s65
s_add_u32 s58, s64, 25165824
s_add_u32 s56, s32, s58
s_addc_u32 s57, s33, 0
s_mov_b32 s58, 64
s_mov_b32 s59, 0x20000
s_mov_b32 exec_lo, 0x55555555
s_mov_b32 exec_hi, 0
buffer_store_dword v88, v9, s[56:59], 0 offen sc1
s_mov_b64 exec, -1
L_nw7:
s_and_b32 s60, s2, 7
s_lshl_b32 s60, s60, 5
s_lshr_b32 s64, s2, 3
s_add_u32 s60, s60, s64
s_lshr_b32 s64, s66, 1
s_xor_b32 s64, s64, s66
s_and_b32 s64, s64, 1
s_or_b32 s65, s64, s60
s_cmp_eq_u32 s65, 0
s_cselect_b32 s61, 1, 0
s_lshl_b32 s65, s60, 1
s_add_u32 s64, s64, s65
s_lshr_b32 s65, s66, 1
s_sub_u32 s69, 513, s65
s_cmp_eq_u32 s61, 1
s_cselect_b32 s64, s69, s64
s_cselect_b32 s65, 0, s65
s_lshl_b32 s62, s65, 31
s_or_b32 s63, s62, 0x3f800000
s_lshl_b32 s64, s64, 13
s_add_u32 s50, s64, 25165824
s_add_u32 s48, s32, s50
s_addc_u32 s49, s33, 0
s_mov_b32 s50, 8192
s_mov_b32 s51, 0x20000
s_lshl_b32 s64, s66, 20
s_lshl_b32 s65, s60, 6
s_add_u32 s64, s64, s65
s_add_u32 s54, s64, 16777216
s_add_u32 s52, s32, s54
s_addc_u32 s53, s33, 0
s_sub_u32 s54, 1048576, s65
s_mov_b32 s55, 0x20000
s_add_u32 s58, s64, 16777216
s_add_u32 s56, s32, s58
s_addc_u32 s57, s33, 0
s_sub_u32 s58, 1048576, s65
s_mov_b32 s59, 0x20000
v_lshrrev_b32 v8, 2, v1
v_lshlrev_b32 v8, 14, v8
v_and_b32 v9, 3, v1
v_lshrrev_b32 v10, 4, v1
v_xor_b32 v9, v9, v10
v_lshl_add_u32 v14, v9, 4, v8
v_and_b32 v8, 31, v1
v_bfe_u32 v9, v1, 2, 2
v_xor_b32 v9, s66, v9
v_lshlrev_b32 v9, 4, v9
v_lshl_add_u32 v9, v8, 6, v9
v_lshrrev_b32 v8, 5, v1
v_lshl_add_u32 v9, v8, 11, v9
v_add_u32 v15, 131072, v9
s_lshl_b32 s64, s66, 13
s_add_u32 s64, s64, 131072
v_add_u32 v16, s64, v2
s_xor_b32 s65, s64, 24576
s_cmp_eq_u32 s61, 1
s_cselect_b32 s65, s64, s65
v_add_u32 v17, s65, v2
v_add_u32 v18, s68, v2
v_pk_mul_f32 v[136:137], s[62:63], v[136:137] op_sel:[1,0]
v_pk_mul_f32 v[138:139], s[62:63], v[138:139] op_sel:[1,0]
v_pk_mul_f32 v[140:141], s[62:63], v[140:141] op_sel:[1,0]
v_pk_mul_f32 v[142:143], s[62:63], v[142:143] op_sel:[1,0]
v_pk_mul_f32 v[144:145], s[62:63], v[144:145] op_sel:[1,0]
v_pk_mul_f32 v[146:147], s[62:63], v[146:147] op_sel:[1,0]
v_pk_mul_f32 v[148:149], s[62:63], v[148:149] op_sel:[1,0]
v_pk_mul_f32 v[150:151], s[62:63], v[150:151] op_sel:[1,0]
v_pk_mul_f32 v[152:153], s[62:63], v[152:153] op_sel:[1,0]
v_pk_mul_f32 v[154:155], s[62:63], v[154:155] op_sel:[1,0]
v_pk_mul_f32 v[156:157], s[62:63], v[156:157] op_sel:[1,0]
v_pk_mul_f32 v[158:159], s[62:63], v[158:159] op_sel:[1,0]
v_pk_mul_f32 v[160:161], s[62:63], v[160:161] op_sel:[1,0]
v_pk_mul_f32 v[162:163], s[62:63], v[162:163] op_sel:[1,0]
v_pk_mul_f32 v[164:165], s[62:63], v[164:165] op_sel:[1,0]
v_pk_mul_f32 v[166:167], s[62:63], v[166:167] op_sel:[1,0]
s_waitcnt vmcnt(0)
v_mov_b32 v190, 3
s_mov_b64 exec, 1
ds_write_b32 v185, v190
s_mov_b64 exec, -1
s_cmp_lg_u32 s66, 0
s_cbranch_scc1 L_ph8
L_lc9:
ds_read_b128 v[186:189], v184
s_waitcnt lgkmcnt(0)
v_min3_u32 v186, v186, v187, v188
v_min_u32 v186, v186, v189
s_nop 0
v_readfirstlane_b32 s92, v186
s_nop 0
s_cmp_ge_u32 s92, 3
s_cbranch_scc1 L_lcd10
s_sleep 1
s_branch L_lc9
L_lcd10:
s_and_b32 s64, s2, 15
s_lshl_b32 s65, s64, 7
s_add_u32 s65, s65, 4096
s_add_u32 s90, s32, s65
s_addc_u32 s91, s33, 0
s_mov_b32 s65, 1
s_atomic_add s65, s[90:91], 0x0 glc
s_lshl_b32 s64, s64, 2
s_add_u32 s64, s64, 540672
v_lshl_add_u32 v20, v1, 7, s64
v_mov_b32 v21, s37
s_add_u32 s4, s32, s64
s_addc_u32 s5, s33, 0
s_and_b32 s64, s2, 31
s_lshl_b32 s64, s64, 7
s_add_u32 s64, s64, 540672
s_waitcnt lgkmcnt(0)
s_cmp_lg_u32 s65, 15
s_cbranch_scc1 L_sg11
s_atomic_swap s37, s[4:5], 0x0
s_atomic_swap s37, s[4:5], 0x80
s_atomic_swap s37, s[4:5], 0x100
s_atomic_swap s37, s[4:5], 0x180
s_atomic_swap s37, s[4:5], 0x200
s_atomic_swap s37, s[4:5], 0x280
s_atomic_swap s37, s[4:5], 0x300
s_atomic_swap s37, s[4:5], 0x380
s_atomic_swap s37, s[4:5], 0x400
s_atomic_swap s37, s[4:5], 0x480
s_atomic_swap s37, s[4:5], 0x500
s_atomic_swap s37, s[4:5], 0x580
s_atomic_swap s37, s[4:5], 0x600
s_atomic_swap s37, s[4:5], 0x680
s_atomic_swap s37, s[4:5], 0x700
s_atomic_swap s37, s[4:5], 0x780
s_atomic_swap s37, s[4:5], 0x800
s_atomic_swap s37, s[4:5], 0x880
s_atomic_swap s37, s[4:5], 0x900
s_atomic_swap s37, s[4:5], 0x980
s_atomic_swap s37, s[4:5], 0xa00
s_atomic_swap s37, s[4:5], 0xa80
s_atomic_swap s37, s[4:5], 0xb00
s_atomic_swap s37, s[4:5], 0xb80
s_atomic_swap s37, s[4:5], 0xc00
s_atomic_swap s37, s[4:5], 0xc80
s_atomic_swap s37, s[4:5], 0xd00
s_atomic_swap s37, s[4:5], 0xd80
s_atomic_swap s37, s[4:5], 0xe00
s_atomic_swap s37, s[4:5], 0xe80
s_atomic_swap s37, s[4:5], 0xf00
s_atomic_swap s37, s[4:5], 0xf80
s_waitcnt lgkmcnt(0)
L_sg11:
s_add_u32 s90, s32, s64
s_addc_u32 s91, s33, 0
s_mov_b32 s64, s37
s_mov_b32 s65, s37
s_mov_b32 s92, 0
s_branch L_sp12
L_nok13:
s_add_u32 s92, s92, 1
s_cmp_ge_u32 s92, 200000
s_cbranch_scc1 L_ph8
s_sleep 2
L_sp12:
s_load_dwordx16 s[4:19], s[90:91], 0x0 glc
s_waitcnt lgkmcnt(0)
s_cmp_eq_u64 s[4:5], s[64:65]
s_cbranch_scc0 L_nok13
s_cmp_eq_u64 s[6:7], s[64:65]
s_cbranch_scc0 L_nok13
s_cmp_eq_u64 s[8:9], s[64:65]
s_cbranch_scc0 L_nok13
s_cmp_eq_u64 s[10:11], s[64:65]
s_cbranch_scc0 L_nok13
s_cmp_eq_u64 s[12:13], s[64:65]
s_cbranch_scc0 L_nok13
s_cmp_eq_u64 s[14:15], s[64:65]
s_cbranch_scc0 L_nok13
s_cmp_eq_u64 s[16:17], s[64:65]
s_cbranch_scc0 L_nok13
s_cmp_eq_u64 s[18:19], s[64:65]
s_cbranch_scc0 L_nok13
L_ph8:
v_mov_b32 v190, 4
s_mov_b64 exec, 1
ds_write_b32 v185, v190
s_mov_b64 exec, -1
L_lc14:
ds_read_b128 v[186:189], v184
s_waitcnt lgkmcnt(0)
v_min3_u32 v186, v186, v187, v188
v_min_u32 v186, v186, v189
s_nop 0
v_readfirstlane_b32 s92, v186
s_nop 0
s_cmp_ge_u32 s92, 4
s_cbranch_scc1 L_lcd15
s_sleep 1
s_branch L_lc14
L_lcd15:
s_setprio 3
s_add_u32 m0, s68, 0
s_mov_b32 s64, 0
buffer_load_dwordx4 v14, s[52:55], s64 offen sc1 lds
s_add_u32 m0, s68, 1024
s_mov_b32 s64, 262144
buffer_load_dwordx4 v14, s[52:55], s64 offen sc1 lds
s_add_u32 m0, s68, 2048
s_mov_b32 s64, 524288
buffer_load_dwordx4 v14, s[52:55], s64 offen sc1 lds
s_add_u32 m0, s68, 3072
s_mov_b32 s64, 786432
buffer_load_dwordx4 v14, s[52:55], s64 offen sc1 lds
s_movk_i32 s64, 0x1000
buffer_load_dwordx4 v[104:107], v2, s[48:51], 0 offen offset:0 sc1
buffer_load_dwordx4 v[108:111], v2, s[48:51], 0 offen offset:1024 sc1
buffer_load_dwordx4 v[112:115], v2, s[48:51], 0 offen offset:2048 sc1
buffer_load_dwordx4 v[116:119], v2, s[48:51], 0 offen offset:3072 sc1
buffer_load_dwordx4 v[120:123], v2, s[48:51], s64 offen offset:0 sc1
buffer_load_dwordx4 v[124:127], v2, s[48:51], s64 offen offset:1024 sc1
buffer_load_dwordx4 v[128:131], v2, s[48:51], s64 offen offset:2048 sc1
buffer_load_dwordx4 v[132:135], v2, s[48:51], s64 offen offset:3072 sc1
s_waitcnt vmcnt(8)
v_mov_b32 v190, 5
s_mov_b64 exec, 1
ds_write_b32 v185, v190
s_mov_b64 exec, -1
L_lc16:
ds_read_b128 v[186:189], v184
s_waitcnt lgkmcnt(0)
v_min3_u32 v186, v186, v187, v188
v_min_u32 v186, v186, v189
s_nop 0
v_readfirstlane_b32 s92, v186
s_nop 0
s_cmp_ge_u32 s92, 5
s_cbranch_scc1 L_lcd17
s_sleep 1
s_branch L_lc16
L_lcd17:
ds_read_b128 v[72:75], v15 offset:0
ds_read_b128 v[76:79], v15 offset:4096
ds_read_b128 v[80:83], v15 offset:8192
ds_read_b128 v[84:87], v15 offset:12288
s_waitcnt lgkmcnt(0)
v_mov_b32 v190, 6
s_mov_b64 exec, 1
ds_write_b32 v185, v190
s_mov_b64 exec, -1
s_lshl_b32 s64, s61, 31
s_or_b32 s64, s64, s62
L_fft18:
v_xor_b32 v24, s64, v72
v_xor_b32 v25, s64, v73
v_xor_b32 v26, s64, v74
v_xor_b32 v27, s64, v75
v_xor_b32 v28, s64, v76
v_xor_b32 v29, s64, v77
v_xor_b32 v30, s64, v78
v_xor_b32 v31, s64, v79
v_xor_b32 v32, s64, v80
v_xor_b32 v33, s64, v81
v_xor_b32 v34, s64, v82
v_xor_b32 v35, s64, v83
v_xor_b32 v36, s64, v84
v_xor_b32 v37, s64, v85
v_xor_b32 v38, s64, v86
v_xor_b32 v39, s64, v87
v_mfma_f32_32x32x16_bf16 v[40:55], v[24:27], v[192:195], 0
v_mfma_f32_32x32x16_bf16 v[40:55], v[28:31], v[196:199], v[40:55]
v_mfma_f32_32x32x16_bf16 v[40:55], v[32:35], v[200:203], v[40:55]
v_mfma_f32_32x32x16_bf16 v[40:55], v[36:39], v[204:207], v[40:55]
v_mfma_f32_32x32x16_bf16 v[56:71], v[24:27], v[208:211], 0
v_mfma_f32_32x32x16_bf16 v[56:71], v[28:31], v[212:215], v[56:71]
v_mfma_f32_32x32x16_bf16 v[56:71], v[32:35], v[216:219], v[56:71]
v_mfma_f32_32x32x16_bf16 v[56:71], v[36:39], v[220:223], v[56:71]
s_nop 7
v_mul_f32 v168, v40, v224
v_mul_f32 v169, v40, v240
s_nop 1
v_fma_f32 v168, -v56, v240, v168
v_fmac_f32 v169, v56, v224
v_cvt_pk_bf16_f32 v24, v168, v169
v_mul_f32 v170, v41, v225
v_mul_f32 v171, v41, v241
v_fma_f32 v170, -v57, v241, v170
v_fmac_f32 v171, v57, v225
v_cvt_pk_bf16_f32 v25, v170, v171
v_mul_f32 v172, v42, v226
v_mul_f32 v173, v42, v242
v_fma_f32 v172, -v58, v242, v172
v_fmac_f32 v173, v58, v226
v_cvt_pk_bf16_f32 v26, v172, v173
v_mul_f32 v174, v43, v227
v_mul_f32 v175, v43, v243
v_fma_f32 v174, -v59, v243, v174
v_fmac_f32 v175, v59, v227
v_cvt_pk_bf16_f32 v27, v174, v175
v_mul_f32 v168, v44, v228
v_mul_f32 v169, v44, v244
v_fma_f32 v168, -v60, v244, v168
v_fmac_f32 v169, v60, v228
v_cvt_pk_bf16_f32 v28, v168, v169
v_mul_f32 v170, v45, v229
v_mul_f32 v171, v45, v245
v_fma_f32 v170, -v61, v245, v170
v_fmac_f32 v171, v61, v229
v_cvt_pk_bf16_f32 v29, v170, v171
v_mul_f32 v172, v46, v230
v_mul_f32 v173, v46, v246
v_fma_f32 v172, -v62, v246, v172
v_fmac_f32 v173, v62, v230
v_cvt_pk_bf16_f32 v30, v172, v173
v_mul_f32 v174, v47, v231
v_mul_f32 v175, v47, v247
v_fma_f32 v174, -v63, v247, v174
v_fmac_f32 v175, v63, v231
v_cvt_pk_bf16_f32 v31, v174, v175
v_mul_f32 v168, v48, v232
v_mul_f32 v169, v48, v248
v_fma_f32 v168, -v64, v248, v168
v_fmac_f32 v169, v64, v232
v_cvt_pk_bf16_f32 v32, v168, v169
v_mul_f32 v170, v49, v233
v_mul_f32 v171, v49, v249
v_fma_f32 v170, -v65, v249, v170
v_fmac_f32 v171, v65, v233
v_cvt_pk_bf16_f32 v33, v170, v171
v_mul_f32 v172, v50, v234
v_mul_f32 v173, v50, v250
v_fma_f32 v172, -v66, v250, v172
v_fmac_f32 v173, v66, v234
v_cvt_pk_bf16_f32 v34, v172, v173
v_mul_f32 v174, v51, v235
v_mul_f32 v175, v51, v251
v_fma_f32 v174, -v67, v251, v174
v_fmac_f32 v175, v67, v235
v_cvt_pk_bf16_f32 v35, v174, v175
v_mul_f32 v168, v52, v236
v_mul_f32 v169, v52, v252
v_fma_f32 v168, -v68, v252, v168
v_fmac_f32 v169, v68, v236
v_cvt_pk_bf16_f32 v36, v168, v169
v_mul_f32 v170, v53, v237
v_mul_f32 v171, v53, v253
v_fma_f32 v170, -v69, v253, v170
v_fmac_f32 v171, v69, v237
v_cvt_pk_bf16_f32 v37, v170, v171
v_mul_f32 v172, v54, v238
v_mul_f32 v173, v54, v254
v_fma_f32 v172, -v70, v254, v172
v_fmac_f32 v173, v70, v238
v_cvt_pk_bf16_f32 v38, v172, v173
v_mul_f32 v174, v55, v239
v_mul_f32 v175, v55, v255
v_fma_f32 v174, -v71, v255, v174
v_fmac_f32 v175, v71, v239
v_cvt_pk_bf16_f32 v39, v174, v175
v_mfma_f32_32x32x16_bf16 v[40:55], v[192:195], v[24:27], 0
v_mfma_f32_32x32x16_bf16 v[40:55], v[196:199], v[28:31], v[40:55]
v_mfma_f32_32x32x16_bf16 v[40:55], v[200:203], v[32:35], v[40:55]
v_mfma_f32_32x32x16_bf16 v[40:55], v[204:207], v[36:39], v[40:55]
v_mfma_f32_32x32x16_bf16 v[56:71], v[208:211], v[24:27], 0
v_mfma_f32_32x32x16_bf16 v[56:71], v[212:215], v[28:31], v[56:71]
v_mfma_f32_32x32x16_bf16 v[56:71], v[216:219], v[32:35], v[56:71]
v_mfma_f32_32x32x16_bf16 v[56:71], v[220:223], v[36:39], v[56:71]
L_lc20:
ds_read_b128 v[186:189], v184
s_waitcnt lgkmcnt(0)
v_min3_u32 v186, v186, v187, v188
v_min_u32 v186, v186, v189
s_nop 0
v_readfirstlane_b32 s92, v186
s_nop 0
s_cmp_ge_u32 s92, 6
s_cbranch_scc1 L_lcd21
s_sleep 1
s_branch L_lc20
L_lcd21:
s_cmp_eq_u32 s61, 2
s_cbranch_scc1 L_nwr19
ds_write_b128 v16, v[40:43] offset:0
ds_write_b128 v16, v[44:47] offset:1024
ds_write_b128 v16, v[48:51] offset:2048
ds_write_b128 v16, v[52:55] offset:3072
ds_write_b128 v16, v[56:59] offset:4096
ds_write_b128 v16, v[60:63] offset:5120
ds_write_b128 v16, v[64:67] offset:6144
ds_write_b128 v16, v[68:71] offset:7168
s_cmp_eq_u32 s61, 0
s_cbranch_scc1 L_nwr19
s_mov_b32 s61, 2
s_mov_b32 s64, 0
s_branch L_fft18
L_nwr19:
s_waitcnt lgkmcnt(0)
v_mov_b32 v190, 7
s_mov_b64 exec, 1
ds_write_b32 v185, v190
s_mov_b64 exec, -1
L_lc22:
ds_read_b128 v[186:189], v184
s_waitcnt lgkmcnt(0)
v_min3_u32 v186, v186, v187, v188
v_min_u32 v186, v186, v189
s_nop 0
v_readfirstlane_b32 s92, v186
s_nop 0
s_cmp_ge_u32 s92, 7
s_cbranch_scc1 L_lcd23
s_sleep 1
s_branch L_lc22
L_lcd23:
ds_read_b128 v[72:75], v17 offset:0
ds_read_b128 v[76:79], v17 offset:1024
ds_read_b128 v[80:83], v17 offset:2048
ds_read_b128 v[84:87], v17 offset:3072
ds_read_b128 v[88:91], v17 offset:4096
ds_read_b128 v[92:95], v17 offset:5120
ds_read_b128 v[96:99], v17 offset:6144
ds_read_b128 v[100:103], v17 offset:7168
s_waitcnt vmcnt(0) lgkmcnt(0)
v_mov_b32 v190, 8
s_mov_b64 exec, 1
ds_write_b32 v185, v190
s_mov_b64 exec, -1
v_lshlrev_b32 v168, 16, v104
v_and_b32 v169, 0xffff0000, v104
v_lshlrev_b32 v170, 16, v105
v_and_b32 v171, 0xffff0000, v105
v_add_f32 v172, v168, v170
v_add_f32 v173, v169, v171
v_sub_f32 v168, v168, v170
v_sub_f32 v169, v169, v171
v_mul_f32 v170, v152, v40
v_mul_f32 v171, v152, v56
v_mul_f32 v174, v172, v40
v_mul_f32 v175, v172, v56
v_fma_f32 v170, -v136, v88, v170
v_fmac_f32 v171, v136, v72
v_fma_f32 v174, -v173, v56, v174
v_fmac_f32 v175, v173, v40
v_fmac_f32 v174, v168, v170
v_fmac_f32 v175, v168, v171
v_fma_f32 v174, -v169, v171, v174
v_fmac_f32 v175, v169, v170
v_cvt_pk_bf16_f32 v24, v175, v174
v_lshlrev_b32 v176, 16, v106
v_and_b32 v177, 0xffff0000, v106
v_lshlrev_b32 v178, 16, v107
v_and_b32 v179, 0xffff0000, v107
v_add_f32 v180, v176, v178
v_add_f32 v181, v177, v179
v_sub_f32 v176, v176, v178
v_sub_f32 v177, v177, v179
v_mul_f32 v178, v153, v41
v_mul_f32 v179, v153, v57
v_mul_f32 v182, v180, v41
v_mul_f32 v183, v180, v57
v_fma_f32 v178, -v137, v89, v178
v_fmac_f32 v179, v137, v73
v_fma_f32 v182, -v181, v57, v182
v_fmac_f32 v183, v181, v41
v_fmac_f32 v182, v176, v178
v_fmac_f32 v183, v176, v179
v_fma_f32 v182, -v177, v179, v182
v_fmac_f32 v183, v177, v178
v_cvt_pk_bf16_f32 v25, v183, v182
v_lshlrev_b32 v168, 16, v108
v_and_b32 v169, 0xffff0000, v108
v_lshlrev_b32 v170, 16, v109
v_and_b32 v171, 0xffff0000, v109
v_add_f32 v172, v168, v170
v_add_f32 v173, v169, v171
v_sub_f32 v168, v168, v170
v_sub_f32 v169, v169, v171
v_mul_f32 v170, v154, v42
v_mul_f32 v171, v154, v58
v_mul_f32 v174, v172, v42
v_mul_f32 v175, v172, v58
v_fma_f32 v170, -v138, v90, v170
v_fmac_f32 v171, v138, v74
v_fma_f32 v174, -v173, v58, v174
v_fmac_f32 v175, v173, v42
v_fmac_f32 v174, v168, v170
v_fmac_f32 v175, v168, v171
v_fma_f32 v174, -v169, v171, v174
v_fmac_f32 v175, v169, v170
v_cvt_pk_bf16_f32 v26, v175, v174
v_lshlrev_b32 v176, 16, v110
v_and_b32 v177, 0xffff0000, v110
v_lshlrev_b32 v178, 16, v111
v_and_b32 v179, 0xffff0000, v111
v_add_f32 v180, v176, v178
v_add_f32 v181, v177, v179
v_sub_f32 v176, v176, v178
v_sub_f32 v177, v177, v179
v_mul_f32 v178, v155, v43
v_mul_f32 v179, v155, v59
v_mul_f32 v182, v180, v43
v_mul_f32 v183, v180, v59
v_fma_f32 v178, -v139, v91, v178
v_fmac_f32 v179, v139, v75
v_fma_f32 v182, -v181, v59, v182
v_fmac_f32 v183, v181, v43
v_fmac_f32 v182, v176, v178
v_fmac_f32 v183, v176, v179
v_fma_f32 v182, -v177, v179, v182
v_fmac_f32 v183, v177, v178
v_cvt_pk_bf16_f32 v27, v183, v182
v_lshlrev_b32 v168, 16, v112
v_and_b32 v169, 0xffff0000, v112
v_lshlrev_b32 v170, 16, v113
v_and_b32 v171, 0xffff0000, v113
v_add_f32 v172, v168, v170
v_add_f32 v173, v169, v171
v_sub_f32 v168, v168, v170
v_sub_f32 v169, v169, v171
v_mul_f32 v170, v156, v44
v_mul_f32 v171, v156, v60
v_mul_f32 v174, v172, v44
v_mul_f32 v175, v172, v60
v_fma_f32 v170, -v140, v92, v170
v_fmac_f32 v171, v140, v76
v_fma_f32 v174, -v173, v60, v174
v_fmac_f32 v175, v173, v44
v_fmac_f32 v174, v168, v170
v_fmac_f32 v175, v168, v171
v_fma_f32 v174, -v169, v171, v174
v_fmac_f32 v175, v169, v170
v_cvt_pk_bf16_f32 v28, v175, v174
v_lshlrev_b32 v176, 16, v114
v_and_b32 v177, 0xffff0000, v114
v_lshlrev_b32 v178, 16, v115
v_and_b32 v179, 0xffff0000, v115
v_add_f32 v180, v176, v178
v_add_f32 v181, v177, v179
v_sub_f32 v176, v176, v178
v_sub_f32 v177, v177, v179
v_mul_f32 v178, v157, v45
v_mul_f32 v179, v157, v61
v_mul_f32 v182, v180, v45
v_mul_f32 v183, v180, v61
v_fma_f32 v178, -v141, v93, v178
v_fmac_f32 v179, v141, v77
v_fma_f32 v182, -v181, v61, v182
v_fmac_f32 v183, v181, v45
v_fmac_f32 v182, v176, v178
v_fmac_f32 v183, v176, v179
v_fma_f32 v182, -v177, v179, v182
v_fmac_f32 v183, v177, v178
v_cvt_pk_bf16_f32 v29, v183, v182
v_lshlrev_b32 v168, 16, v116
v_and_b32 v169, 0xffff0000, v116
v_lshlrev_b32 v170, 16, v117
v_and_b32 v171, 0xffff0000, v117
v_add_f32 v172, v168, v170
v_add_f32 v173, v169, v171
v_sub_f32 v168, v168, v170
v_sub_f32 v169, v169, v171
v_mul_f32 v170, v158, v46
v_mul_f32 v171, v158, v62
v_mul_f32 v174, v172, v46
v_mul_f32 v175, v172, v62
v_fma_f32 v170, -v142, v94, v170
v_fmac_f32 v171, v142, v78
v_fma_f32 v174, -v173, v62, v174
v_fmac_f32 v175, v173, v46
v_fmac_f32 v174, v168, v170
v_fmac_f32 v175, v168, v171
v_fma_f32 v174, -v169, v171, v174
v_fmac_f32 v175, v169, v170
v_cvt_pk_bf16_f32 v30, v175, v174
v_lshlrev_b32 v176, 16, v118
v_and_b32 v177, 0xffff0000, v118
v_lshlrev_b32 v178, 16, v119
v_and_b32 v179, 0xffff0000, v119
v_add_f32 v180, v176, v178
v_add_f32 v181, v177, v179
v_sub_f32 v176, v176, v178
v_sub_f32 v177, v177, v179
v_mul_f32 v178, v159, v47
v_mul_f32 v179, v159, v63
v_mul_f32 v182, v180, v47
v_mul_f32 v183, v180, v63
v_fma_f32 v178, -v143, v95, v178
v_fmac_f32 v179, v143, v79
v_fma_f32 v182, -v181, v63, v182
v_fmac_f32 v183, v181, v47
v_fmac_f32 v182, v176, v178
v_fmac_f32 v183, v176, v179
v_fma_f32 v182, -v177, v179, v182
v_fmac_f32 v183, v177, v178
v_cvt_pk_bf16_f32 v31, v183, v182
v_lshlrev_b32 v168, 16, v120
v_and_b32 v169, 0xffff0000, v120
v_lshlrev_b32 v170, 16, v121
v_and_b32 v171, 0xffff0000, v121
v_add_f32 v172, v168, v170
v_add_f32 v173, v169, v171
v_sub_f32 v168, v168, v170
v_sub_f32 v169, v169, v171
v_mul_f32 v170, v160, v48
v_mul_f32 v171, v160, v64
v_mul_f32 v174, v172, v48
v_mul_f32 v175, v172, v64
v_fma_f32 v170, -v144, v96, v170
v_fmac_f32 v171, v144, v80
v_fma_f32 v174, -v173, v64, v174
v_fmac_f32 v175, v173, v48
v_fmac_f32 v174, v168, v170
v_fmac_f32 v175, v168, v171
v_fma_f32 v174, -v169, v171, v174
v_fmac_f32 v175, v169, v170
v_cvt_pk_bf16_f32 v32, v175, v174
v_lshlrev_b32 v176, 16, v122
v_and_b32 v177, 0xffff0000, v122
v_lshlrev_b32 v178, 16, v123
v_and_b32 v179, 0xffff0000, v123
v_add_f32 v180, v176, v178
v_add_f32 v181, v177, v179
v_sub_f32 v176, v176, v178
v_sub_f32 v177, v177, v179
v_mul_f32 v178, v161, v49
v_mul_f32 v179, v161, v65
v_mul_f32 v182, v180, v49
v_mul_f32 v183, v180, v65
v_fma_f32 v178, -v145, v97, v178
v_fmac_f32 v179, v145, v81
v_fma_f32 v182, -v181, v65, v182
v_fmac_f32 v183, v181, v49
v_fmac_f32 v182, v176, v178
v_fmac_f32 v183, v176, v179
v_fma_f32 v182, -v177, v179, v182
v_fmac_f32 v183, v177, v178
v_cvt_pk_bf16_f32 v33, v183, v182
v_lshlrev_b32 v168, 16, v124
v_and_b32 v169, 0xffff0000, v124
v_lshlrev_b32 v170, 16, v125
v_and_b32 v171, 0xffff0000, v125
v_add_f32 v172, v168, v170
v_add_f32 v173, v169, v171
v_sub_f32 v168, v168, v170
v_sub_f32 v169, v169, v171
v_mul_f32 v170, v162, v50
v_mul_f32 v171, v162, v66
v_mul_f32 v174, v172, v50
v_mul_f32 v175, v172, v66
v_fma_f32 v170, -v146, v98, v170
v_fmac_f32 v171, v146, v82
v_fma_f32 v174, -v173, v66, v174
v_fmac_f32 v175, v173, v50
v_fmac_f32 v174, v168, v170
v_fmac_f32 v175, v168, v171
v_fma_f32 v174, -v169, v171, v174
v_fmac_f32 v175, v169, v170
v_cvt_pk_bf16_f32 v34, v175, v174
v_lshlrev_b32 v176, 16, v126
v_and_b32 v177, 0xffff0000, v126
v_lshlrev_b32 v178, 16, v127
v_and_b32 v179, 0xffff0000, v127
v_add_f32 v180, v176, v178
v_add_f32 v181, v177, v179
v_sub_f32 v176, v176, v178
v_sub_f32 v177, v177, v179
v_mul_f32 v178, v163, v51
v_mul_f32 v179, v163, v67
v_mul_f32 v182, v180, v51
v_mul_f32 v183, v180, v67
v_fma_f32 v178, -v147, v99, v178
v_fmac_f32 v179, v147, v83
v_fma_f32 v182, -v181, v67, v182
v_fmac_f32 v183, v181, v51
v_fmac_f32 v182, v176, v178
v_fmac_f32 v183, v176, v179
v_fma_f32 v182, -v177, v179, v182
v_fmac_f32 v183, v177, v178
v_cvt_pk_bf16_f32 v35, v183, v182
v_lshlrev_b32 v168, 16, v128
v_and_b32 v169, 0xffff0000, v128
v_lshlrev_b32 v170, 16, v129
v_and_b32 v171, 0xffff0000, v129
v_add_f32 v172, v168, v170
v_add_f32 v173, v169, v171
v_sub_f32 v168, v168, v170
v_sub_f32 v169, v169, v171
v_mul_f32 v170, v164, v52
v_mul_f32 v171, v164, v68
v_mul_f32 v174, v172, v52
v_mul_f32 v175, v172, v68
v_fma_f32 v170, -v148, v100, v170
v_fmac_f32 v171, v148, v84
v_fma_f32 v174, -v173, v68, v174
v_fmac_f32 v175, v173, v52
v_fmac_f32 v174, v168, v170
v_fmac_f32 v175, v168, v171
v_fma_f32 v174, -v169, v171, v174
v_fmac_f32 v175, v169, v170
v_cvt_pk_bf16_f32 v36, v175, v174
v_lshlrev_b32 v176, 16, v130
v_and_b32 v177, 0xffff0000, v130
v_lshlrev_b32 v178, 16, v131
v_and_b32 v179, 0xffff0000, v131
v_add_f32 v180, v176, v178
v_add_f32 v181, v177, v179
v_sub_f32 v176, v176, v178
v_sub_f32 v177, v177, v179
v_mul_f32 v178, v165, v53
v_mul_f32 v179, v165, v69
v_mul_f32 v182, v180, v53
v_mul_f32 v183, v180, v69
v_fma_f32 v178, -v149, v101, v178
v_fmac_f32 v179, v149, v85
v_fma_f32 v182, -v181, v69, v182
v_fmac_f32 v183, v181, v53
v_fmac_f32 v182, v176, v178
v_fmac_f32 v183, v176, v179
v_fma_f32 v182, -v177, v179, v182
v_fmac_f32 v183, v177, v178
v_cvt_pk_bf16_f32 v37, v183, v182
v_lshlrev_b32 v168, 16, v132
v_and_b32 v169, 0xffff0000, v132
v_lshlrev_b32 v170, 16, v133
v_and_b32 v171, 0xffff0000, v133
v_add_f32 v172, v168, v170
v_add_f32 v173, v169, v171
v_sub_f32 v168, v168, v170
v_sub_f32 v169, v169, v171
v_mul_f32 v170, v166, v54
v_mul_f32 v171, v166, v70
v_mul_f32 v174, v172, v54
v_mul_f32 v175, v172, v70
v_fma_f32 v170, -v150, v102, v170
v_fmac_f32 v171, v150, v86
v_fma_f32 v174, -v173, v70, v174
v_fmac_f32 v175, v173, v54
v_fmac_f32 v174, v168, v170
v_fmac_f32 v175, v168, v171
v_fma_f32 v174, -v169, v171, v174
v_fmac_f32 v175, v169, v170
v_cvt_pk_bf16_f32 v38, v175, v174
v_lshlrev_b32 v176, 16, v134
v_and_b32 v177, 0xffff0000, v134
v_lshlrev_b32 v178, 16, v135
v_and_b32 v179, 0xffff0000, v135
v_add_f32 v180, v176, v178
v_add_f32 v181, v177, v179
v_sub_f32 v176, v176, v178
v_sub_f32 v177, v177, v179
v_mul_f32 v178, v167, v55
v_mul_f32 v179, v167, v71
v_mul_f32 v182, v180, v55
v_mul_f32 v183, v180, v71
v_fma_f32 v178, -v151, v103, v178
v_fmac_f32 v179, v151, v87
v_fma_f32 v182, -v181, v71, v182
v_fmac_f32 v183, v181, v55
v_fmac_f32 v182, v176, v178
v_fmac_f32 v183, v176, v179
v_fma_f32 v182, -v177, v179, v182
v_fmac_f32 v183, v177, v178
v_cvt_pk_bf16_f32 v39, v183, v182
v_mfma_f32_32x32x16_bf16 v[40:55], v[24:27], v[192:195], 0
v_mfma_f32_32x32x16_bf16 v[40:55], v[28:31], v[196:199], v[40:55]
v_mfma_f32_32x32x16_bf16 v[40:55], v[32:35], v[200:203], v[40:55]
v_mfma_f32_32x32x16_bf16 v[40:55], v[36:39], v[204:207], v[40:55]
v_mfma_f32_32x32x16_bf16 v[56:71], v[24:27], v[208:211], 0
v_mfma_f32_32x32x16_bf16 v[56:71], v[28:31], v[212:215], v[56:71]
v_mfma_f32_32x32x16_bf16 v[56:71], v[32:35], v[216:219], v[56:71]
v_mfma_f32_32x32x16_bf16 v[56:71], v[36:39], v[220:223], v[56:71]
s_nop 7
v_mul_f32 v168, v40, v224
v_mul_f32 v169, v40, v240
s_nop 1
v_fma_f32 v168, -v56, v240, v168
v_fmac_f32 v169, v56, v224
v_cvt_pk_bf16_f32 v24, v168, v169
v_mul_f32 v170, v41, v225
v_mul_f32 v171, v41, v241
v_fma_f32 v170, -v57, v241, v170
v_fmac_f32 v171, v57, v225
v_cvt_pk_bf16_f32 v25, v170, v171
v_mul_f32 v172, v42, v226
v_mul_f32 v173, v42, v242
v_fma_f32 v172, -v58, v242, v172
v_fmac_f32 v173, v58, v226
v_cvt_pk_bf16_f32 v26, v172, v173
v_mul_f32 v174, v43, v227
v_mul_f32 v175, v43, v243
v_fma_f32 v174, -v59, v243, v174
v_fmac_f32 v175, v59, v227
v_cvt_pk_bf16_f32 v27, v174, v175
v_mul_f32 v168, v44, v228
v_mul_f32 v169, v44, v244
v_fma_f32 v168, -v60, v244, v168
v_fmac_f32 v169, v60, v228
v_cvt_pk_bf16_f32 v28, v168, v169
v_mul_f32 v170, v45, v229
v_mul_f32 v171, v45, v245
v_fma_f32 v170, -v61, v245, v170
v_fmac_f32 v171, v61, v229
v_cvt_pk_bf16_f32 v29, v170, v171
v_mul_f32 v172, v46, v230
v_mul_f32 v173, v46, v246
v_fma_f32 v172, -v62, v246, v172
v_fmac_f32 v173, v62, v230
v_cvt_pk_bf16_f32 v30, v172, v173
v_mul_f32 v174, v47, v231
v_mul_f32 v175, v47, v247
v_fma_f32 v174, -v63, v247, v174
v_fmac_f32 v175, v63, v231
v_cvt_pk_bf16_f32 v31, v174, v175
v_mul_f32 v168, v48, v232
v_mul_f32 v169, v48, v248
v_fma_f32 v168, -v64, v248, v168
v_fmac_f32 v169, v64, v232
v_cvt_pk_bf16_f32 v32, v168, v169
v_mul_f32 v170, v49, v233
v_mul_f32 v171, v49, v249
v_fma_f32 v170, -v65, v249, v170
v_fmac_f32 v171, v65, v233
v_cvt_pk_bf16_f32 v33, v170, v171
v_mul_f32 v172, v50, v234
v_mul_f32 v173, v50, v250
v_fma_f32 v172, -v66, v250, v172
v_fmac_f32 v173, v66, v234
v_cvt_pk_bf16_f32 v34, v172, v173
v_mul_f32 v174, v51, v235
v_mul_f32 v175, v51, v251
v_fma_f32 v174, -v67, v251, v174
v_fmac_f32 v175, v67, v235
v_cvt_pk_bf16_f32 v35, v174, v175
v_mul_f32 v168, v52, v236
v_mul_f32 v169, v52, v252
v_fma_f32 v168, -v68, v252, v168
v_fmac_f32 v169, v68, v236
v_cvt_pk_bf16_f32 v36, v168, v169
v_mul_f32 v170, v53, v237
v_mul_f32 v171, v53, v253
v_fma_f32 v170, -v69, v253, v170
v_fmac_f32 v171, v69, v237
v_cvt_pk_bf16_f32 v37, v170, v171
v_mul_f32 v172, v54, v238
v_mul_f32 v173, v54, v254
v_fma_f32 v172, -v70, v254, v172
v_fmac_f32 v173, v70, v238
v_cvt_pk_bf16_f32 v38, v172, v173
v_mul_f32 v174, v55, v239
v_mul_f32 v175, v55, v255
v_fma_f32 v174, -v71, v255, v174
v_fmac_f32 v175, v71, v239
v_cvt_pk_bf16_f32 v39, v174, v175
v_mfma_f32_32x32x16_bf16 v[40:55], v[192:195], v[24:27], 0
v_mfma_f32_32x32x16_bf16 v[40:55], v[196:199], v[28:31], v[40:55]
v_mfma_f32_32x32x16_bf16 v[40:55], v[200:203], v[32:35], v[40:55]
v_mfma_f32_32x32x16_bf16 v[40:55], v[204:207], v[36:39], v[40:55]
v_mfma_f32_32x32x16_bf16 v[56:71], v[208:211], v[24:27], 0
v_mfma_f32_32x32x16_bf16 v[56:71], v[212:215], v[28:31], v[56:71]
v_mfma_f32_32x32x16_bf16 v[56:71], v[216:219], v[32:35], v[56:71]
v_mfma_f32_32x32x16_bf16 v[56:71], v[220:223], v[36:39], v[56:71]
s_lshr_b32 s64, s62, 16
L_lc24:
ds_read_b128 v[186:189], v184
s_waitcnt lgkmcnt(0)
v_min3_u32 v186, v186, v187, v188
v_min_u32 v186, v186, v189
s_nop 0
v_readfirstlane_b32 s92, v186
s_nop 0
s_cmp_ge_u32 s92, 8
s_cbranch_scc1 L_lcd25
s_sleep 1
s_branch L_lc24
L_lcd25:
s_nop 1
v_cvt_pk_bf16_f32 v24, v40, v56
v_xor_b32 v24, s64, v24
v_cvt_pk_bf16_f32 v25, v41, v57
v_xor_b32 v25, s64, v25
v_cvt_pk_bf16_f32 v26, v42, v58
v_xor_b32 v26, s64, v26
v_cvt_pk_bf16_f32 v27, v43, v59
v_xor_b32 v27, s64, v27
ds_write_b128 v15, v[24:27] offset:0
v_cvt_pk_bf16_f32 v28, v44, v60
v_xor_b32 v28, s64, v28
v_cvt_pk_bf16_f32 v29, v45, v61
v_xor_b32 v29, s64, v29
v_cvt_pk_bf16_f32 v30, v46, v62
v_xor_b32 v30, s64, v30
v_cvt_pk_bf16_f32 v31, v47, v63
v_xor_b32 v31, s64, v31
ds_write_b128 v15, v[28:31] offset:4096
v_cvt_pk_bf16_f32 v32, v48, v64
v_xor_b32 v32, s64, v32
v_cvt_pk_bf16_f32 v33, v49, v65
v_xor_b32 v33, s64, v33
v_cvt_pk_bf16_f32 v34, v50, v66
v_xor_b32 v34, s64, v34
v_cvt_pk_bf16_f32 v35, v51, v67
v_xor_b32 v35, s64, v35
ds_write_b128 v15, v[32:35] offset:8192
v_cvt_pk_bf16_f32 v36, v52, v68
v_xor_b32 v36, s64, v36
v_cvt_pk_bf16_f32 v37, v53, v69
v_xor_b32 v37, s64, v37
v_cvt_pk_bf16_f32 v38, v54, v70
v_xor_b32 v38, s64, v38
v_cvt_pk_bf16_f32 v39, v55, v71
v_xor_b32 v39, s64, v39
ds_write_b128 v15, v[36:39] offset:12288
s_waitcnt lgkmcnt(0)
v_mov_b32 v190, 9
s_mov_b64 exec, 1
ds_write_b32 v185, v190
s_mov_b64 exec, -1
L_lc26:
ds_read_b128 v[186:189], v184
s_waitcnt lgkmcnt(0)
v_min3_u32 v186, v186, v187, v188
v_min_u32 v186, v186, v189
s_nop 0
v_readfirstlane_b32 s92, v186
s_nop 0
s_cmp_ge_u32 s92, 9
s_cbranch_scc1 L_lcd27
s_sleep 1
s_branch L_lc26
L_lcd27:
ds_read_b128 v[24:27], v18 offset:0
ds_read_b128 v[28:31], v18 offset:1024
ds_read_b128 v[32:35], v18 offset:2048
ds_read_b128 v[36:39], v18 offset:3072
s_mov_b32 s64, 0
s_waitcnt lgkmcnt(3)
buffer_store_dwordx4 v[24:27], v14, s[56:59], s64 offen sc1
s_mov_b32 s64, 262144
s_waitcnt lgkmcnt(2)
buffer_store_dwordx4 v[28:31], v14, s[56:59], s64 offen sc1
s_mov_b32 s64, 524288
s_waitcnt lgkmcnt(1)
buffer_store_dwordx4 v[32:35], v14, s[56:59], s64 offen sc1
s_mov_b32 s64, 786432
s_waitcnt lgkmcnt(0)
buffer_store_dwordx4 v[36:39], v14, s[56:59], s64 offen sc1
s_lshl_b32 s64, s67, 14
s_add_u32 s40, s28, s64
s_addc_u32 s41, s29, 0
s_mov_b32 s42, 16384
s_mov_b32 s43, 0x20000
v_and_b32 v8, 31, v1
v_lshrrev_b32 v9, 5, v1
v_lshlrev_b32 v14, 2, v8
v_lshl_add_u32 v14, v9, 9, v14
s_mov_b32 s64, 0x35000000
v_mul_f32 v224, s64, v224
v_mul_f32 v225, s64, v225
v_mul_f32 v226, s64, v226
v_mul_f32 v227, s64, v227
v_mul_f32 v228, s64, v228
v_mul_f32 v229, s64, v229
v_mul_f32 v230, s64, v230
v_mul_f32 v231, s64, v231
v_mul_f32 v232, s64, v232
v_mul_f32 v233, s64, v233
v_mul_f32 v234, s64, v234
v_mul_f32 v235, s64, v235
v_mul_f32 v236, s64, v236
v_mul_f32 v237, s64, v237
v_mul_f32 v238, s64, v238
v_mul_f32 v239, s64, v239
v_mul_f32 v240, s64, v240
v_mul_f32 v241, s64, v241
v_mul_f32 v242, s64, v242
v_mul_f32 v243, s64, v243
v_mul_f32 v244, s64, v244
v_mul_f32 v245, s64, v245
v_mul_f32 v246, s64, v246
v_mul_f32 v247, s64, v247
v_mul_f32 v248, s64, v248
v_mul_f32 v249, s64, v249
v_mul_f32 v250, s64, v250
v_mul_f32 v251, s64, v251
v_mul_f32 v252, s64, v252
v_mul_f32 v253, s64, v253
v_mul_f32 v254, s64, v254
v_mul_f32 v255, s64, v255
s_waitcnt vmcnt(0)
v_mov_b32 v190, 10
s_mov_b64 exec, 1
ds_write_b32 v185, v190
s_mov_b64 exec, -1
s_cmp_lg_u32 s66, 0
s_cbranch_scc1 L_ph28
L_lc29:
ds_read_b128 v[186:189], v184
s_waitcnt lgkmcnt(0)
v_min3_u32 v186, v186, v187, v188
v_min_u32 v186, v186, v189
s_nop 0
v_readfirstlane_b32 s92, v186
s_nop 0
s_cmp_ge_u32 s92, 10
s_cbranch_scc1 L_lcd30
s_sleep 1
s_branch L_lc29
L_lcd30:
s_and_b32 s64, s2, 15
s_lshl_b32 s65, s64, 7
s_add_u32 s65, s65, 6144
s_add_u32 s90, s32, s65
s_addc_u32 s91, s33, 0
s_mov_b32 s65, 1
s_atomic_add s65, s[90:91], 0x0 glc
s_lshl_b32 s64, s64, 2
s_add_u32 s64, s64, 548864
v_lshl_add_u32 v20, v1, 7, s64
v_mov_b32 v21, s37
s_add_u32 s4, s32, s64
s_addc_u32 s5, s33, 0
s_and_b32 s64, s2, 31
s_lshl_b32 s64, s64, 7
s_add_u32 s64, s64, 548864
s_waitcnt lgkmcnt(0)
s_cmp_lg_u32 s65, 15
s_cbranch_scc1 L_sg31
s_atomic_swap s37, s[4:5], 0x0
s_atomic_swap s37, s[4:5], 0x80
s_atomic_swap s37, s[4:5], 0x100
s_atomic_swap s37, s[4:5], 0x180
s_atomic_swap s37, s[4:5], 0x200
s_atomic_swap s37, s[4:5], 0x280
s_atomic_swap s37, s[4:5], 0x300
s_atomic_swap s37, s[4:5], 0x380
s_atomic_swap s37, s[4:5], 0x400
s_atomic_swap s37, s[4:5], 0x480
s_atomic_swap s37, s[4:5], 0x500
s_atomic_swap s37, s[4:5], 0x580
s_atomic_swap s37, s[4:5], 0x600
s_atomic_swap s37, s[4:5], 0x680
s_atomic_swap s37, s[4:5], 0x700
s_atomic_swap s37, s[4:5], 0x780
s_atomic_swap s37, s[4:5], 0x800
s_atomic_swap s37, s[4:5], 0x880
s_atomic_swap s37, s[4:5], 0x900
s_atomic_swap s37, s[4:5], 0x980
s_atomic_swap s37, s[4:5], 0xa00
s_atomic_swap s37, s[4:5], 0xa80
s_atomic_swap s37, s[4:5], 0xb00
s_atomic_swap s37, s[4:5], 0xb80
s_atomic_swap s37, s[4:5], 0xc00
s_atomic_swap s37, s[4:5], 0xc80
s_atomic_swap s37, s[4:5], 0xd00
s_atomic_swap s37, s[4:5], 0xd80
s_atomic_swap s37, s[4:5], 0xe00
s_atomic_swap s37, s[4:5], 0xe80
s_atomic_swap s37, s[4:5], 0xf00
s_atomic_swap s37, s[4:5], 0xf80
s_waitcnt lgkmcnt(0)
L_sg31:
s_add_u32 s90, s32, s64
s_addc_u32 s91, s33, 0
s_mov_b32 s64, s37
s_mov_b32 s65, s37
s_mov_b32 s92, 0
s_branch L_sp32
L_nok33:
s_add_u32 s92, s92, 1
s_cmp_ge_u32 s92, 200000
s_cbranch_scc1 L_ph28
s_sleep 2
L_sp32:
s_load_dwordx16 s[4:19], s[90:91], 0x0 glc
s_waitcnt lgkmcnt(0)
s_cmp_eq_u64 s[4:5], s[64:65]
s_cbranch_scc0 L_nok33
s_cmp_eq_u64 s[6:7], s[64:65]
s_cbranch_scc0 L_nok33
s_cmp_eq_u64 s[8:9], s[64:65]
s_cbranch_scc0 L_nok33
s_cmp_eq_u64 s[10:11], s[64:65]
s_cbranch_scc0 L_nok33
s_cmp_eq_u64 s[12:13], s[64:65]
s_cbranch_scc0 L_nok33
s_cmp_eq_u64 s[14:15], s[64:65]
s_cbranch_scc0 L_nok33
s_cmp_eq_u64 s[16:17], s[64:65]
s_cbranch_scc0 L_nok33
s_cmp_eq_u64 s[18:19], s[64:65]
s_cbranch_scc0 L_nok33
L_ph28:
v_mov_b32 v190, 11
s_mov_b64 exec, 1
ds_write_b32 v185, v190
s_mov_b64 exec, -1
L_lc34:
ds_read_b128 v[186:189], v184
s_waitcnt lgkmcnt(0)
v_min3_u32 v186, v186, v187, v188
v_min_u32 v186, v186, v189
s_nop 0
v_readfirstlane_b32 s92, v186
s_nop 0
s_cmp_ge_u32 s92, 11
s_cbranch_scc1 L_lcd35
s_sleep 1
s_branch L_lc34
L_lcd35:
s_mov_b32 m0, s68
s_nop 0
buffer_load_dwordx4 v7, s[44:47], 0 offen offset:0 sc1 lds
buffer_load_dwordx4 v7, s[44:47], 0 offen offset:1024 sc1 lds
buffer_load_dwordx4 v7, s[44:47], 0 offen offset:2048 sc1 lds
buffer_load_dwordx4 v7, s[44:47], 0 offen offset:3072 sc1 lds
s_waitcnt vmcnt(0)
v_mov_b32 v190, 12
s_mov_b64 exec, 1
ds_write_b32 v185, v190
s_mov_b64 exec, -1
L_lc36:
ds_read_b128 v[186:189], v184
s_waitcnt lgkmcnt(0)
v_min3_u32 v186, v186, v187, v188
v_min_u32 v186, v186, v189
s_nop 0
v_readfirstlane_b32 s92, v186
s_nop 0
s_cmp_ge_u32 s92, 12
s_cbranch_scc1 L_lcd37
s_sleep 1
s_branch L_lc36
L_lcd37:
ds_read_b32 v24, v4 offset:0
ds_read_b32 v25, v4 offset:1024
ds_read_b32 v26, v4 offset:2048
ds_read_b32 v27, v4 offset:3072
ds_read_b32 v28, v4 offset:8192
ds_read_b32 v29, v4 offset:9216
ds_read_b32 v30, v4 offset:10240
ds_read_b32 v31, v4 offset:11264
ds_read_b32 v32, v6 offset:0
ds_read_b32 v33, v5 offset:10240
ds_read_b32 v34, v5 offset:9216
ds_read_b32 v35, v5 offset:8192
ds_read_b32 v36, v5 offset:3072
ds_read_b32 v37, v5 offset:2048
ds_read_b32 v38, v5 offset:1024
ds_read_b32 v39, v5 offset:0
s_waitcnt lgkmcnt(0)
v_mfma_f32_32x32x16_bf16 v[40:55], v[24:27], v[192:195], 0
v_mfma_f32_32x32x16_bf16 v[40:55], v[28:31], v[196:199], v[40:55]
v_mfma_f32_32x32x16_bf16 v[40:55], v[32:35], v[200:203], v[40:55]
v_mfma_f32_32x32x16_bf16 v[40:55], v[36:39], v[204:207], v[40:55]
v_mfma_f32_32x32x16_bf16 v[56:71], v[24:27], v[208:211], 0
v_mfma_f32_32x32x16_bf16 v[56:71], v[28:31], v[212:215], v[56:71]
v_mfma_f32_32x32x16_bf16 v[56:71], v[32:35], v[216:219], v[56:71]
v_mfma_f32_32x32x16_bf16 v[56:71], v[36:39], v[220:223], v[56:71]
s_nop 7
v_mul_f32 v168, v40, v224
v_mul_f32 v169, v40, v240
s_nop 1
v_fma_f32 v168, -v56, v240, v168
v_fmac_f32 v169, v56, v224
v_cvt_pk_bf16_f32 v24, v168, v169
v_mul_f32 v170, v41, v225
v_mul_f32 v171, v41, v241
v_fma_f32 v170, -v57, v241, v170
v_fmac_f32 v171, v57, v225
v_cvt_pk_bf16_f32 v25, v170, v171
v_mul_f32 v172, v42, v226
v_mul_f32 v173, v42, v242
v_fma_f32 v172, -v58, v242, v172
v_fmac_f32 v173, v58, v226
v_cvt_pk_bf16_f32 v26, v172, v173
v_mul_f32 v174, v43, v227
v_mul_f32 v175, v43, v243
v_fma_f32 v174, -v59, v243, v174
v_fmac_f32 v175, v59, v227
v_cvt_pk_bf16_f32 v27, v174, v175
v_mul_f32 v168, v44, v228
v_mul_f32 v169, v44, v244
v_fma_f32 v168, -v60, v244, v168
v_fmac_f32 v169, v60, v228
v_cvt_pk_bf16_f32 v28, v168, v169
v_mul_f32 v170, v45, v229
v_mul_f32 v171, v45, v245
v_fma_f32 v170, -v61, v245, v170
v_fmac_f32 v171, v61, v229
v_cvt_pk_bf16_f32 v29, v170, v171
v_mul_f32 v172, v46, v230
v_mul_f32 v173, v46, v246
v_fma_f32 v172, -v62, v246, v172
v_fmac_f32 v173, v62, v230
v_cvt_pk_bf16_f32 v30, v172, v173
v_mul_f32 v174, v47, v231
v_mul_f32 v175, v47, v247
v_fma_f32 v174, -v63, v247, v174
v_fmac_f32 v175, v63, v231
v_cvt_pk_bf16_f32 v31, v174, v175
v_mul_f32 v168, v48, v232
v_mul_f32 v169, v48, v248
v_fma_f32 v168, -v64, v248, v168
v_fmac_f32 v169, v64, v232
v_cvt_pk_bf16_f32 v32, v168, v169
v_mul_f32 v170, v49, v233
v_mul_f32 v171, v49, v249
v_fma_f32 v170, -v65, v249, v170
v_fmac_f32 v171, v65, v233
v_cvt_pk_bf16_f32 v33, v170, v171
v_mul_f32 v172, v50, v234
v_mul_f32 v173, v50, v250
v_fma_f32 v172, -v66, v250, v172
v_fmac_f32 v173, v66, v234
v_cvt_pk_bf16_f32 v34, v172, v173
v_mul_f32 v174, v51, v235
v_mul_f32 v175, v51, v251
v_fma_f32 v174, -v67, v251, v174
v_fmac_f32 v175, v67, v235
v_cvt_pk_bf16_f32 v35, v174, v175
v_mul_f32 v168, v52, v236
v_mul_f32 v169, v52, v252
v_fma_f32 v168, -v68, v252, v168
v_fmac_f32 v169, v68, v236
v_cvt_pk_bf16_f32 v36, v168, v169
v_mul_f32 v170, v53, v237
v_mul_f32 v171, v53, v253
v_fma_f32 v170, -v69, v253, v170
v_fmac_f32 v171, v69, v237
v_cvt_pk_bf16_f32 v37, v170, v171
v_mul_f32 v172, v54, v238
v_mul_f32 v173, v54, v254
v_fma_f32 v172, -v70, v254, v172
v_fmac_f32 v173, v70, v238
v_cvt_pk_bf16_f32 v38, v172, v173
v_mul_f32 v174, v55, v239
v_mul_f32 v175, v55, v255
v_fma_f32 v174, -v71, v255, v174
v_fmac_f32 v175, v71, v239
v_cvt_pk_bf16_f32 v39, v174, v175
v_mfma_f32_32x32x16_bf16 v[40:55], v[192:195], v[24:27], 0
v_mfma_f32_32x32x16_bf16 v[40:55], v[196:199], v[28:31], v[40:55]
v_mfma_f32_32x32x16_bf16 v[40:55], v[200:203], v[32:35], v[40:55]
v_mfma_f32_32x32x16_bf16 v[40:55], v[204:207], v[36:39], v[40:55]
v_mfma_f32_32x32x16_bf16 v[56:71], v[208:211], v[24:27], 0
v_mfma_f32_32x32x16_bf16 v[56:71], v[212:215], v[28:31], v[56:71]
v_mfma_f32_32x32x16_bf16 v[56:71], v[216:219], v[32:35], v[56:71]
v_mfma_f32_32x32x16_bf16 v[56:71], v[220:223], v[36:39], v[56:71]
s_movk_i32 s64, 0x2000
s_nop 10
v_cvt_pk_bf16_f32 v73, v56, v40
v_lshlrev_b32 v72, 16, v73
v_and_b32 v73, 0xffff0000, v73
buffer_store_dword v72, v14, s[40:43], 0 offen offset:0 nt
buffer_store_dword v73, v14, s[40:43], s64 offen offset:0 nt
v_cvt_pk_bf16_f32 v75, v57, v41
v_lshlrev_b32 v74, 16, v75
v_and_b32 v75, 0xffff0000, v75
buffer_store_dword v74, v14, s[40:43], 0 offen offset:128 nt
buffer_store_dword v75, v14, s[40:43], s64 offen offset:128 nt
v_cvt_pk_bf16_f32 v77, v58, v42
v_lshlrev_b32 v76, 16, v77
v_and_b32 v77, 0xffff0000, v77
buffer_store_dword v76, v14, s[40:43], 0 offen offset:256 nt
buffer_store_dword v77, v14, s[40:43], s64 offen offset:256 nt
v_cvt_pk_bf16_f32 v79, v59, v43
v_lshlrev_b32 v78, 16, v79
v_and_b32 v79, 0xffff0000, v79
buffer_store_dword v78, v14, s[40:43], 0 offen offset:384 nt
buffer_store_dword v79, v14, s[40:43], s64 offen offset:384 nt
v_cvt_pk_bf16_f32 v81, v60, v44
v_lshlrev_b32 v80, 16, v81
v_and_b32 v81, 0xffff0000, v81
buffer_store_dword v80, v14, s[40:43], 0 offen offset:1024 nt
buffer_store_dword v81, v14, s[40:43], s64 offen offset:1024 nt
v_cvt_pk_bf16_f32 v83, v61, v45
v_lshlrev_b32 v82, 16, v83
v_and_b32 v83, 0xffff0000, v83
buffer_store_dword v82, v14, s[40:43], 0 offen offset:1152 nt
buffer_store_dword v83, v14, s[40:43], s64 offen offset:1152 nt
v_cvt_pk_bf16_f32 v85, v62, v46
v_lshlrev_b32 v84, 16, v85
v_and_b32 v85, 0xffff0000, v85
buffer_store_dword v84, v14, s[40:43], 0 offen offset:1280 nt
buffer_store_dword v85, v14, s[40:43], s64 offen offset:1280 nt
v_cvt_pk_bf16_f32 v87, v63, v47
v_lshlrev_b32 v86, 16, v87
v_and_b32 v87, 0xffff0000, v87
buffer_store_dword v86, v14, s[40:43], 0 offen offset:1408 nt
buffer_store_dword v87, v14, s[40:43], s64 offen offset:1408 nt
v_cvt_pk_bf16_f32 v89, v64, v48
v_lshlrev_b32 v88, 16, v89
v_and_b32 v89, 0xffff0000, v89
buffer_store_dword v88, v14, s[40:43], 0 offen offset:2048 nt
buffer_store_dword v89, v14, s[40:43], s64 offen offset:2048 nt
v_cvt_pk_bf16_f32 v91, v65, v49
v_lshlrev_b32 v90, 16, v91
v_and_b32 v91, 0xffff0000, v91
buffer_store_dword v90, v14, s[40:43], 0 offen offset:2176 nt
buffer_store_dword v91, v14, s[40:43], s64 offen offset:2176 nt
v_cvt_pk_bf16_f32 v93, v66, v50
v_lshlrev_b32 v92, 16, v93
v_and_b32 v93, 0xffff0000, v93
buffer_store_dword v92, v14, s[40:43], 0 offen offset:2304 nt
buffer_store_dword v93, v14, s[40:43], s64 offen offset:2304 nt
v_cvt_pk_bf16_f32 v95, v67, v51
v_lshlrev_b32 v94, 16, v95
v_and_b32 v95, 0xffff0000, v95
buffer_store_dword v94, v14, s[40:43], 0 offen offset:2432 nt
buffer_store_dword v95, v14, s[40:43], s64 offen offset:2432 nt
v_cvt_pk_bf16_f32 v97, v68, v52
v_lshlrev_b32 v96, 16, v97
v_and_b32 v97, 0xffff0000, v97
buffer_store_dword v96, v14, s[40:43], 0 offen offset:3072 nt
buffer_store_dword v97, v14, s[40:43], s64 offen offset:3072 nt
v_cvt_pk_bf16_f32 v99, v69, v53
v_lshlrev_b32 v98, 16, v99
v_and_b32 v99, 0xffff0000, v99
buffer_store_dword v98, v14, s[40:43], 0 offen offset:3200 nt
buffer_store_dword v99, v14, s[40:43], s64 offen offset:3200 nt
v_cvt_pk_bf16_f32 v101, v70, v54
v_lshlrev_b32 v100, 16, v101
v_and_b32 v101, 0xffff0000, v101
buffer_store_dword v100, v14, s[40:43], 0 offen offset:3328 nt
buffer_store_dword v101, v14, s[40:43], s64 offen offset:3328 nt
v_cvt_pk_bf16_f32 v103, v71, v55
v_lshlrev_b32 v102, 16, v103
v_and_b32 v103, 0xffff0000, v103
buffer_store_dword v102, v14, s[40:43], 0 offen offset:3456 nt
buffer_store_dword v103, v14, s[40:43], s64 offen offset:3456 nt
s_endpgm
L_concat_heads__spectral_gfnet__ssm_conv_s5__prompt_kernel_gemm:
s_lshr_b32 s68, s34, 1
s_and_b32 s66, s34, 1
v_and_b32 v6, 31, v1
v_lshrrev_b32 v5, 5, v1
v_and_b32 v4, 0x13, v6
v_bfe_u32 v7, v6, 2, 1
v_lshl_or_b32 v4, v7, 3, v4
v_bfe_u32 v7, v6, 3, 1
v_lshl_or_b32 v4, v7, 2, v4
s_lshl_b32 s60, s36, 6
s_lshl_b32 s61, s66, 5
s_add_u32 s60, s60, s61
v_add_u32 v4, s60, v4
v_lshlrev_b32 v7, 1, v4
v_lshlrev_b32 v11, 4, v1
s_waitcnt lgkmcnt(0)
global_load_ushort v8, v7, s[12:13]
global_load_ushort v9, v7, s[14:15]
global_load_ushort v10, v7, s[24:25]
s_lshl_b32 s60, s2, 3
s_add_u32 s60, s60, s34
s_cmp_lg_u32 s60, 1
s_cbranch_scc1 L_nn38
s_load_dword s60, s[32:33], 0
v_mov_b32 v16, 0
v_and_b32 v17, 31, v1
v_lshlrev_b32 v17, 7, v17
v_add_u32 v17, 4096, v17
global_store_dword v17, v16, s[32:33] sc1
s_waitcnt vmcnt(0) lgkmcnt(0)
s_add_u32 s60, s60, 1
s_cmp_eq_u32 s60, 0
s_cselect_b32 s60, 1, s60
v_mov_b32 v17, s60
s_mov_b64 exec, 1
global_store_dword v16, v17, s[30:31] sc1
global_store_dword v16, v17, s[32:33] offset:0
s_mov_b64 exec, -1
L_nn38:
s_cmp_lg_u32 s34, 0
s_cbranch_scc1 L_pf39
s_lshr_b32 s60, s2, 3
s_lshl_b32 s60, s60, 11
v_and_b32 v12, 15, v1
v_lshl_add_u32 v12, v12, 7, s60
v_min_u32 v12, L_concat_heads__spectral_gfnet__ssm_conv_s5__prompt_kernel_end-concat_heads__spectral_gfnet__ssm_conv_s5__prompt_kernel, v12
s_getpc_b64 s[60:61]
L_pc40:
s_sub_u32 s60, s60, L_pc40-concat_heads__spectral_gfnet__ssm_conv_s5__prompt_kernel
s_subb_u32 s61, s61, 0
global_load_dword v247, v12, s[60:61]
L_pf39:
v_bfe_u32 v7, v6, 1, 3
v_xor_b32 v7, v7, v5
v_lshlrev_b32 v7, 4, v7
v_lshl_add_u32 v7, v6, 7, v7
s_lshl_b32 s60, s68, 13
s_lshl_b32 s61, s66, 13
s_add_u32 s61, s61, 16384
v_xor_b32 v12, 0, v7
v_add_u32 v128, s60, v12
v_add_u32 v132, s61, v12
v_add_u32 v136, 0x10000, v128
v_add_u32 v140, 0x10000, v132
v_xor_b32 v12, 32, v7
v_add_u32 v129, s60, v12
v_add_u32 v133, s61, v12
v_add_u32 v137, 0x10000, v129
v_add_u32 v141, 0x10000, v133
v_xor_b32 v12, 64, v7
v_add_u32 v130, s60, v12
v_add_u32 v134, s61, v12
v_add_u32 v138, 0x10000, v130
v_add_u32 v142, 0x10000, v134
v_xor_b32 v12, 96, v7
v_add_u32 v131, s60, v12
v_add_u32 v135, s61, v12
v_add_u32 v139, 0x10000, v131
v_add_u32 v143, 0x10000, v135
v_mov_b64 v[64:65], 0
v_mov_b64 v[66:67], 0
v_mov_b64 v[68:69], 0
v_mov_b64 v[70:71], 0
v_mov_b64 v[72:73], 0
v_mov_b64 v[74:75], 0
v_mov_b64 v[76:77], 0
v_mov_b64 v[78:79], 0
v_mov_b64 v[80:81], 0
v_mov_b64 v[82:83], 0
v_mov_b64 v[84:85], 0
v_mov_b64 v[86:87], 0
v_mov_b64 v[88:89], 0
v_mov_b64 v[90:91], 0
v_mov_b64 v[92:93], 0
v_mov_b64 v[94:95], 0
v_mov_b64 v[96:97], 0
v_mov_b64 v[98:99], 0
v_mov_b64 v[100:101], 0
v_mov_b64 v[102:103], 0
v_mov_b64 v[104:105], 0
v_mov_b64 v[106:107], 0
v_mov_b64 v[108:109], 0
v_mov_b64 v[110:111], 0
v_mov_b64 v[112:113], 0
v_mov_b64 v[114:115], 0
v_mov_b64 v[116:117], 0
v_mov_b64 v[118:119], 0
v_mov_b64 v[120:121], 0
v_mov_b64 v[122:123], 0
v_mov_b64 v[124:125], 0
v_mov_b64 v[126:127], 0
v_mov_b32 v34, 126976
v_mov_b64 v[36:37], 0
v_mov_b64 v[38:39], 0
s_mov_b64 exec, 1
ds_write_b128 v34, v[36:39]
ds_write_b128 v34, v[36:39] offset:16
s_mov_b64 exec, -1
v_lshlrev_b32 v12, 4, v5
v_sub_u32 v12, v6, v12
v_mov_b32 v13, 0x3f80
v_mov_b32 v14, 1.0
v_cmp_eq_u32 vcc, 0, v12
v_cmp_eq_u32 s[60:61], 8, v12
s_nop 0
v_cndmask_b32 v248, 0, v13, vcc
v_cndmask_b32 v248, v248, v14, s[60:61]
v_cmp_eq_u32 vcc, 1, v12
v_cmp_eq_u32 s[60:61], 9, v12
s_nop 0
v_cndmask_b32 v249, 0, v13, vcc
v_cndmask_b32 v249, v249, v14, s[60:61]
v_cmp_eq_u32 vcc, 2, v12
v_cmp_eq_u32 s[60:61], 10, v12
s_nop 0
v_cndmask_b32 v250, 0, v13, vcc
v_cndmask_b32 v250, v250, v14, s[60:61]
v_cmp_eq_u32 vcc, 3, v12
v_cmp_eq_u32 s[60:61], 11, v12
s_nop 0
v_cndmask_b32 v251, 0, v13, vcc
v_cndmask_b32 v251, v251, v14, s[60:61]
v_cmp_eq_u32 vcc, 4, v12
v_cmp_eq_u32 s[60:61], 12, v12
s_nop 0
v_cndmask_b32 v252, 0, v13, vcc
v_cndmask_b32 v252, v252, v14, s[60:61]
v_cmp_eq_u32 vcc, 5, v12
v_cmp_eq_u32 s[60:61], 13, v12
s_nop 0
v_cndmask_b32 v253, 0, v13, vcc
v_cndmask_b32 v253, v253, v14, s[60:61]
v_cmp_eq_u32 vcc, 6, v12
v_cmp_eq_u32 s[60:61], 14, v12
s_nop 0
v_cndmask_b32 v254, 0, v13, vcc
v_cndmask_b32 v254, v254, v14, s[60:61]
v_cmp_eq_u32 vcc, 7, v12
v_cmp_eq_u32 s[60:61], 15, v12
s_nop 0
v_cndmask_b32 v255, 0, v13, vcc
v_cndmask_b32 v255, v255, v14, s[60:61]
s_add_u32 s40, s32, 65536
s_addc_u32 s41, s33, 0
s_mov_b32 s42, 262144
s_mov_b32 s43, 0x20000
s_add_u32 s44, s32, 1048576
s_addc_u32 s45, s33, 0
s_mov_b32 s46, 8388608
s_mov_b32 s47, 0x20000
s_waitcnt vmcnt(0)
v_lshlrev_b32 v8, 16, v8
v_lshlrev_b32 v9, 16, v9
v_lshlrev_b32 v10, 16, v10
v_mul_f32 v10, 0x3fb8aa3b, v10
v_exp_f32 v10, v10
s_nop 0
v_cvt_pk_bf16_f32 v10, v10, v10
v_lshlrev_b32 v10, 16, v10
v_mul_f32 v12, v10, v8
v_mul_f32 v13, v10, v9
v_mul_f32 v12, 0x3fb8aa3b, v12
v_exp_f32 v12, v12
v_mul_f32 v13, 0.15915494, v13
v_rndne_f32 v14, v13
v_sub_f32 v13, v13, v14
v_cos_f32 v14, v13
v_sin_f32 v15, v13
v_mul_f32 v24, v12, v14
v_mul_f32 v25, v12, v15
v_add_f32 v12, -1.0, v24
v_mul_f32 v13, v8, v8
v_fma_f32 v13, v9, v9, v13
v_rcp_f32 v13, v13
s_nop 0
v_add_f32 v13, v13, v13
v_mul_f32 v14, v12, v8
v_fma_f32 v14, v25, v9, v14
v_mul_f32 v26, v14, v13
v_mul_f32 v14, v25, v8
v_fma_f32 v14, -v12, v9, v14
v_mul_f32 v27, v14, v13
v_mul_f32 v12, v25, v25
v_mul_f32 v13, v24, v25
v_fma_f32 v28, v24, v24, -v12
v_add_f32 v29, v13, v13
v_mul_f32 v12, v29, v29
v_mul_f32 v13, v28, v29
v_fma_f32 v28, v28, v28, -v12
v_add_f32 v29, v13, v13
v_mul_f32 v12, v29, v29
v_mul_f32 v13, v28, v29
v_fma_f32 v28, v28, v28, -v12
v_add_f32 v29, v13, v13
v_mul_f32 v12, v29, v29
v_mul_f32 v13, v28, v29
v_fma_f32 v28, v28, v28, -v12
v_add_f32 v29, v13, v13
v_mul_f32 v12, v29, v29
v_mul_f32 v13, v28, v29
v_fma_f32 v20, v28, v28, -v12
v_add_f32 v21, v13, v13
v_mul_f32 v12, v21, v21
v_mul_f32 v13, v20, v21
v_fma_f32 v30, v20, v20, -v12
v_add_f32 v31, v13, v13
v_mul_f32 v12, v31, v31
v_mul_f32 v13, v30, v31
v_fma_f32 v30, v30, v30, -v12
v_add_f32 v31, v13, v13
v_mul_f32 v12, v31, v31
v_mul_f32 v13, v30, v31
v_fma_f32 v2, v30, v30, -v12
v_add_f32 v3, v13, v13
s_waitcnt lgkmcnt(0)
s_barrier
ds_read_b128 v[32:35], v128 offset:0
ds_read_b128 v[36:39], v132 offset:0
ds_read_b128 v[40:43], v132 offset:4096
ds_read_b128 v[44:47], v128 offset:4096
s_waitcnt lgkmcnt(2)
v_mfma_f32_32x32x16_bf16 v[64:79], v[32:35], v[36:39], v[64:79]
ds_read_b128 v[48:51], v129 offset:0
ds_read_b128 v[52:55], v133 offset:0
s_waitcnt lgkmcnt(3)
v_mfma_f32_32x32x16_bf16 v[80:95], v[32:35], v[40:43], v[80:95]
ds_read_b128 v[56:59], v133 offset:4096
ds_read_b128 v[60:63], v129 offset:4096
s_waitcnt lgkmcnt(4)
v_mfma_f32_32x32x16_bf16 v[96:111], v[44:47], v[36:39], v[96:111]
v_mfma_f32_32x32x16_bf16 v[112:127], v[44:47], v[40:43], v[112:127]
s_waitcnt lgkmcnt(2)
v_mfma_f32_32x32x16_bf16 v[64:79], v[48:51], v[52:55], v[64:79]
ds_read_b128 v[32:35], v130 offset:0
ds_read_b128 v[36:39], v134 offset:0
s_waitcnt lgkmcnt(3)
v_mfma_f32_32x32x16_bf16 v[80:95], v[48:51], v[56:59], v[80:95]
ds_read_b128 v[40:43], v134 offset:4096
ds_read_b128 v[44:47], v130 offset:4096
s_waitcnt lgkmcnt(4)
v_mfma_f32_32x32x16_bf16 v[96:111], v[60:63], v[52:55], v[96:111]
v_mfma_f32_32x32x16_bf16 v[112:127], v[60:63], v[56:59], v[112:127]
s_waitcnt lgkmcnt(2)
v_mfma_f32_32x32x16_bf16 v[64:79], v[32:35], v[36:39], v[64:79]
ds_read_b128 v[48:51], v131 offset:0
ds_read_b128 v[52:55], v135 offset:0
s_waitcnt lgkmcnt(3)
v_mfma_f32_32x32x16_bf16 v[80:95], v[32:35], v[40:43], v[80:95]
ds_read_b128 v[56:59], v135 offset:4096
ds_read_b128 v[60:63], v131 offset:4096
s_waitcnt lgkmcnt(4)
v_mfma_f32_32x32x16_bf16 v[96:111], v[44:47], v[36:39], v[96:111]
v_mfma_f32_32x32x16_bf16 v[112:127], v[44:47], v[40:43], v[112:127]
s_waitcnt lgkmcnt(0)
s_barrier
v_mfma_f32_32x32x16_bf16 v[64:79], v[48:51], v[52:55], v[64:79]
ds_read_b128 v[32:35], v128 offset:32768
ds_read_b128 v[36:39], v132 offset:32768
v_mfma_f32_32x32x16_bf16 v[80:95], v[48:51], v[56:59], v[80:95]
ds_read_b128 v[40:43], v132 offset:36864
ds_read_b128 v[44:47], v128 offset:36864
v_mfma_f32_32x32x16_bf16 v[96:111], v[60:63], v[52:55], v[96:111]
v_mfma_f32_32x32x16_bf16 v[112:127], v[60:63], v[56:59], v[112:127]
s_waitcnt lgkmcnt(2)
v_mfma_f32_32x32x16_bf16 v[64:79], v[32:35], v[36:39], v[64:79]
ds_read_b128 v[48:51], v129 offset:32768
ds_read_b128 v[52:55], v133 offset:32768
s_waitcnt lgkmcnt(3)
v_mfma_f32_32x32x16_bf16 v[80:95], v[32:35], v[40:43], v[80:95]
ds_read_b128 v[56:59], v133 offset:36864
ds_read_b128 v[60:63], v129 offset:36864
s_waitcnt lgkmcnt(4)
v_mfma_f32_32x32x16_bf16 v[96:111], v[44:47], v[36:39], v[96:111]
v_mfma_f32_32x32x16_bf16 v[112:127], v[44:47], v[40:43], v[112:127]
s_waitcnt lgkmcnt(2)
v_mfma_f32_32x32x16_bf16 v[64:79], v[48:51], v[52:55], v[64:79]
ds_read_b128 v[32:35], v130 offset:32768
ds_read_b128 v[36:39], v134 offset:32768
s_waitcnt lgkmcnt(3)
v_mfma_f32_32x32x16_bf16 v[80:95], v[48:51], v[56:59], v[80:95]
ds_read_b128 v[40:43], v134 offset:36864
ds_read_b128 v[44:47], v130 offset:36864
s_waitcnt lgkmcnt(4)
v_mfma_f32_32x32x16_bf16 v[96:111], v[60:63], v[52:55], v[96:111]
v_mfma_f32_32x32x16_bf16 v[112:127], v[60:63], v[56:59], v[112:127]
s_waitcnt lgkmcnt(2)
v_mfma_f32_32x32x16_bf16 v[64:79], v[32:35], v[36:39], v[64:79]
ds_read_b128 v[48:51], v131 offset:32768
ds_read_b128 v[52:55], v135 offset:32768
s_waitcnt lgkmcnt(3)
v_mfma_f32_32x32x16_bf16 v[80:95], v[32:35], v[40:43], v[80:95]
ds_read_b128 v[56:59], v135 offset:36864
ds_read_b128 v[60:63], v131 offset:36864
s_waitcnt lgkmcnt(4)
v_mfma_f32_32x32x16_bf16 v[96:111], v[44:47], v[36:39], v[96:111]
v_mfma_f32_32x32x16_bf16 v[112:127], v[44:47], v[40:43], v[112:127]
s_waitcnt lgkmcnt(0)
s_barrier
v_mfma_f32_32x32x16_bf16 v[64:79], v[48:51], v[52:55], v[64:79]
ds_read_b128 v[32:35], v136 offset:0
ds_read_b128 v[36:39], v140 offset:0
v_mfma_f32_32x32x16_bf16 v[80:95], v[48:51], v[56:59], v[80:95]
ds_read_b128 v[40:43], v140 offset:4096
ds_read_b128 v[44:47], v136 offset:4096
v_mfma_f32_32x32x16_bf16 v[96:111], v[60:63], v[52:55], v[96:111]
v_mfma_f32_32x32x16_bf16 v[112:127], v[60:63], v[56:59], v[112:127]
s_waitcnt lgkmcnt(2)
v_mfma_f32_32x32x16_bf16 v[64:79], v[32:35], v[36:39], v[64:79]
ds_read_b128 v[48:51], v137 offset:0
ds_read_b128 v[52:55], v141 offset:0
s_waitcnt lgkmcnt(3)
v_mfma_f32_32x32x16_bf16 v[80:95], v[32:35], v[40:43], v[80:95]
ds_read_b128 v[56:59], v141 offset:4096
ds_read_b128 v[60:63], v137 offset:4096
s_waitcnt lgkmcnt(4)
v_mfma_f32_32x32x16_bf16 v[96:111], v[44:47], v[36:39], v[96:111]
v_mfma_f32_32x32x16_bf16 v[112:127], v[44:47], v[40:43], v[112:127]
s_waitcnt lgkmcnt(2)
v_mfma_f32_32x32x16_bf16 v[64:79], v[48:51], v[52:55], v[64:79]
ds_read_b128 v[32:35], v138 offset:0
ds_read_b128 v[36:39], v142 offset:0
s_waitcnt lgkmcnt(3)
v_mfma_f32_32x32x16_bf16 v[80:95], v[48:51], v[56:59], v[80:95]
ds_read_b128 v[40:43], v142 offset:4096
ds_read_b128 v[44:47], v138 offset:4096
s_waitcnt lgkmcnt(4)
v_mfma_f32_32x32x16_bf16 v[96:111], v[60:63], v[52:55], v[96:111]
v_mfma_f32_32x32x16_bf16 v[112:127], v[60:63], v[56:59], v[112:127]
s_waitcnt lgkmcnt(2)
v_mfma_f32_32x32x16_bf16 v[64:79], v[32:35], v[36:39], v[64:79]
ds_read_b128 v[48:51], v139 offset:0
ds_read_b128 v[52:55], v143 offset:0
s_waitcnt lgkmcnt(3)
v_mfma_f32_32x32x16_bf16 v[80:95], v[32:35], v[40:43], v[80:95]
ds_read_b128 v[56:59], v143 offset:4096
ds_read_b128 v[60:63], v139 offset:4096
s_waitcnt lgkmcnt(4)
v_mfma_f32_32x32x16_bf16 v[96:111], v[44:47], v[36:39], v[96:111]
v_mfma_f32_32x32x16_bf16 v[112:127], v[44:47], v[40:43], v[112:127]
s_waitcnt lgkmcnt(0)
s_barrier
v_mfma_f32_32x32x16_bf16 v[64:79], v[48:51], v[52:55], v[64:79]
ds_read_b128 v[32:35], v128 offset:0
ds_read_b128 v[36:39], v132 offset:0
v_mfma_f32_32x32x16_bf16 v[80:95], v[48:51], v[56:59], v[80:95]
ds_read_b128 v[40:43], v132 offset:4096
ds_read_b128 v[44:47], v128 offset:4096
v_mfma_f32_32x32x16_bf16 v[96:111], v[60:63], v[52:55], v[96:111]
v_mfma_f32_32x32x16_bf16 v[112:127], v[60:63], v[56:59], v[112:127]
s_waitcnt lgkmcnt(2)
v_mfma_f32_32x32x16_bf16 v[64:79], v[32:35], v[36:39], v[64:79]
ds_read_b128 v[48:51], v129 offset:0
ds_read_b128 v[52:55], v133 offset:0
s_waitcnt lgkmcnt(3)
v_mfma_f32_32x32x16_bf16 v[80:95], v[32:35], v[40:43], v[80:95]
ds_read_b128 v[56:59], v133 offset:4096
ds_read_b128 v[60:63], v129 offset:4096
s_waitcnt lgkmcnt(4)
v_mfma_f32_32x32x16_bf16 v[96:111], v[44:47], v[36:39], v[96:111]
v_mfma_f32_32x32x16_bf16 v[112:127], v[44:47], v[40:43], v[112:127]
s_waitcnt lgkmcnt(2)
v_mfma_f32_32x32x16_bf16 v[64:79], v[48:51], v[52:55], v[64:79]
ds_read_b128 v[32:35], v130 offset:0
ds_read_b128 v[36:39], v134 offset:0
s_waitcnt lgkmcnt(3)
v_mfma_f32_32x32x16_bf16 v[80:95], v[48:51], v[56:59], v[80:95]
ds_read_b128 v[40:43], v134 offset:4096
ds_read_b128 v[44:47], v130 offset:4096
s_waitcnt lgkmcnt(4)
v_mfma_f32_32x32x16_bf16 v[96:111], v[60:63], v[52:55], v[96:111]
v_mfma_f32_32x32x16_bf16 v[112:127], v[60:63], v[56:59], v[112:127]
s_waitcnt lgkmcnt(2)
v_mfma_f32_32x32x16_bf16 v[64:79], v[32:35], v[36:39], v[64:79]
ds_read_b128 v[48:51], v131 offset:0
ds_read_b128 v[52:55], v135 offset:0
s_waitcnt lgkmcnt(3)
v_mfma_f32_32x32x16_bf16 v[80:95], v[32:35], v[40:43], v[80:95]
ds_read_b128 v[56:59], v135 offset:4096
ds_read_b128 v[60:63], v131 offset:4096
s_waitcnt lgkmcnt(4)
v_mfma_f32_32x32x16_bf16 v[96:111], v[44:47], v[36:39], v[96:111]
v_mfma_f32_32x32x16_bf16 v[112:127], v[44:47], v[40:43], v[112:127]
s_waitcnt lgkmcnt(0)
s_barrier
v_mfma_f32_32x32x16_bf16 v[64:79], v[48:51], v[52:55], v[64:79]
ds_read_b128 v[32:35], v128 offset:32768
ds_read_b128 v[36:39], v132 offset:32768
v_mfma_f32_32x32x16_bf16 v[80:95], v[48:51], v[56:59], v[80:95]
ds_read_b128 v[40:43], v132 offset:36864
ds_read_b128 v[44:47], v128 offset:36864
v_mfma_f32_32x32x16_bf16 v[96:111], v[60:63], v[52:55], v[96:111]
v_mfma_f32_32x32x16_bf16 v[112:127], v[60:63], v[56:59], v[112:127]
s_waitcnt lgkmcnt(2)
v_mfma_f32_32x32x16_bf16 v[64:79], v[32:35], v[36:39], v[64:79]
ds_read_b128 v[48:51], v129 offset:32768
ds_read_b128 v[52:55], v133 offset:32768
s_waitcnt lgkmcnt(3)
v_mfma_f32_32x32x16_bf16 v[80:95], v[32:35], v[40:43], v[80:95]
ds_read_b128 v[56:59], v133 offset:36864
ds_read_b128 v[60:63], v129 offset:36864
s_waitcnt lgkmcnt(4)
v_mfma_f32_32x32x16_bf16 v[96:111], v[44:47], v[36:39], v[96:111]
v_mfma_f32_32x32x16_bf16 v[112:127], v[44:47], v[40:43], v[112:127]
s_waitcnt lgkmcnt(2)
v_mfma_f32_32x32x16_bf16 v[64:79], v[48:51], v[52:55], v[64:79]
ds_read_b128 v[32:35], v130 offset:32768
ds_read_b128 v[36:39], v134 offset:32768
s_waitcnt lgkmcnt(3)
v_mfma_f32_32x32x16_bf16 v[80:95], v[48:51], v[56:59], v[80:95]
ds_read_b128 v[40:43], v134 offset:36864
ds_read_b128 v[44:47], v130 offset:36864
s_waitcnt lgkmcnt(4)
v_mfma_f32_32x32x16_bf16 v[96:111], v[60:63], v[52:55], v[96:111]
v_mfma_f32_32x32x16_bf16 v[112:127], v[60:63], v[56:59], v[112:127]
s_waitcnt lgkmcnt(2)
v_mfma_f32_32x32x16_bf16 v[64:79], v[32:35], v[36:39], v[64:79]
ds_read_b128 v[48:51], v131 offset:32768
ds_read_b128 v[52:55], v135 offset:32768
s_waitcnt lgkmcnt(3)
v_mfma_f32_32x32x16_bf16 v[80:95], v[32:35], v[40:43], v[80:95]
ds_read_b128 v[56:59], v135 offset:36864
ds_read_b128 v[60:63], v131 offset:36864
s_waitcnt lgkmcnt(4)
v_mfma_f32_32x32x16_bf16 v[96:111], v[44:47], v[36:39], v[96:111]
v_mfma_f32_32x32x16_bf16 v[112:127], v[44:47], v[40:43], v[112:127]
s_waitcnt lgkmcnt(0)
s_barrier
v_mfma_f32_32x32x16_bf16 v[64:79], v[48:51], v[52:55], v[64:79]
ds_read_b128 v[32:35], v136 offset:0
ds_read_b128 v[36:39], v140 offset:0
v_mfma_f32_32x32x16_bf16 v[80:95], v[48:51], v[56:59], v[80:95]
ds_read_b128 v[40:43], v140 offset:4096
ds_read_b128 v[44:47], v136 offset:4096
v_mfma_f32_32x32x16_bf16 v[96:111], v[60:63], v[52:55], v[96:111]
v_mfma_f32_32x32x16_bf16 v[112:127], v[60:63], v[56:59], v[112:127]
s_waitcnt lgkmcnt(2)
v_mfma_f32_32x32x16_bf16 v[64:79], v[32:35], v[36:39], v[64:79]
ds_read_b128 v[48:51], v137 offset:0
ds_read_b128 v[52:55], v141 offset:0
s_waitcnt lgkmcnt(3)
v_mfma_f32_32x32x16_bf16 v[80:95], v[32:35], v[40:43], v[80:95]
ds_read_b128 v[56:59], v141 offset:4096
ds_read_b128 v[60:63], v137 offset:4096
s_waitcnt lgkmcnt(4)
v_mfma_f32_32x32x16_bf16 v[96:111], v[44:47], v[36:39], v[96:111]
v_mfma_f32_32x32x16_bf16 v[112:127], v[44:47], v[40:43], v[112:127]
s_waitcnt lgkmcnt(2)
v_mfma_f32_32x32x16_bf16 v[64:79], v[48:51], v[52:55], v[64:79]
ds_read_b128 v[32:35], v138 offset:0
ds_read_b128 v[36:39], v142 offset:0
s_waitcnt lgkmcnt(3)
v_mfma_f32_32x32x16_bf16 v[80:95], v[48:51], v[56:59], v[80:95]
ds_read_b128 v[40:43], v142 offset:4096
ds_read_b128 v[44:47], v138 offset:4096
s_waitcnt lgkmcnt(4)
v_mfma_f32_32x32x16_bf16 v[96:111], v[60:63], v[52:55], v[96:111]
v_mfma_f32_32x32x16_bf16 v[112:127], v[60:63], v[56:59], v[112:127]
s_waitcnt lgkmcnt(2)
v_mfma_f32_32x32x16_bf16 v[64:79], v[32:35], v[36:39], v[64:79]
ds_read_b128 v[48:51], v139 offset:0
ds_read_b128 v[52:55], v143 offset:0
s_waitcnt lgkmcnt(3)
v_mfma_f32_32x32x16_bf16 v[80:95], v[32:35], v[40:43], v[80:95]
ds_read_b128 v[56:59], v143 offset:4096
ds_read_b128 v[60:63], v139 offset:4096
s_waitcnt lgkmcnt(4)
v_mfma_f32_32x32x16_bf16 v[96:111], v[44:47], v[36:39], v[96:111]
v_mfma_f32_32x32x16_bf16 v[112:127], v[44:47], v[40:43], v[112:127]
s_waitcnt lgkmcnt(0)
s_barrier
v_mfma_f32_32x32x16_bf16 v[64:79], v[48:51], v[52:55], v[64:79]
ds_read_b128 v[32:35], v128 offset:0
ds_read_b128 v[36:39], v132 offset:0
v_mfma_f32_32x32x16_bf16 v[80:95], v[48:51], v[56:59], v[80:95]
ds_read_b128 v[40:43], v132 offset:4096
ds_read_b128 v[44:47], v128 offset:4096
v_mfma_f32_32x32x16_bf16 v[96:111], v[60:63], v[52:55], v[96:111]
v_mfma_f32_32x32x16_bf16 v[112:127], v[60:63], v[56:59], v[112:127]
s_waitcnt lgkmcnt(2)
v_mfma_f32_32x32x16_bf16 v[64:79], v[32:35], v[36:39], v[64:79]
ds_read_b128 v[48:51], v129 offset:0
ds_read_b128 v[52:55], v133 offset:0
s_waitcnt lgkmcnt(3)
v_mfma_f32_32x32x16_bf16 v[80:95], v[32:35], v[40:43], v[80:95]
ds_read_b128 v[56:59], v133 offset:4096
ds_read_b128 v[60:63], v129 offset:4096
s_waitcnt lgkmcnt(4)
v_mfma_f32_32x32x16_bf16 v[96:111], v[44:47], v[36:39], v[96:111]
v_mfma_f32_32x32x16_bf16 v[112:127], v[44:47], v[40:43], v[112:127]
s_waitcnt lgkmcnt(2)
v_mfma_f32_32x32x16_bf16 v[64:79], v[48:51], v[52:55], v[64:79]
ds_read_b128 v[32:35], v130 offset:0
ds_read_b128 v[36:39], v134 offset:0
s_waitcnt lgkmcnt(3)
v_mfma_f32_32x32x16_bf16 v[80:95], v[48:51], v[56:59], v[80:95]
ds_read_b128 v[40:43], v134 offset:4096
ds_read_b128 v[44:47], v130 offset:4096
s_waitcnt lgkmcnt(4)
v_mfma_f32_32x32x16_bf16 v[96:111], v[60:63], v[52:55], v[96:111]
v_mfma_f32_32x32x16_bf16 v[112:127], v[60:63], v[56:59], v[112:127]
s_waitcnt lgkmcnt(2)
v_mfma_f32_32x32x16_bf16 v[64:79], v[32:35], v[36:39], v[64:79]
ds_read_b128 v[48:51], v131 offset:0
ds_read_b128 v[52:55], v135 offset:0
s_waitcnt lgkmcnt(3)
v_mfma_f32_32x32x16_bf16 v[80:95], v[32:35], v[40:43], v[80:95]
ds_read_b128 v[56:59], v135 offset:4096
ds_read_b128 v[60:63], v131 offset:4096
s_waitcnt lgkmcnt(4)
v_mfma_f32_32x32x16_bf16 v[96:111], v[44:47], v[36:39], v[96:111]
v_mfma_f32_32x32x16_bf16 v[112:127], v[44:47], v[40:43], v[112:127]
s_waitcnt lgkmcnt(0)
s_barrier
v_mfma_f32_32x32x16_bf16 v[64:79], v[48:51], v[52:55], v[64:79]
ds_read_b128 v[32:35], v128 offset:32768
ds_read_b128 v[36:39], v132 offset:32768
v_mfma_f32_32x32x16_bf16 v[80:95], v[48:51], v[56:59], v[80:95]
ds_read_b128 v[40:43], v132 offset:36864
ds_read_b128 v[44:47], v128 offset:36864
v_mfma_f32_32x32x16_bf16 v[96:111], v[60:63], v[52:55], v[96:111]
v_mfma_f32_32x32x16_bf16 v[112:127], v[60:63], v[56:59], v[112:127]
s_waitcnt lgkmcnt(2)
v_mfma_f32_32x32x16_bf16 v[64:79], v[32:35], v[36:39], v[64:79]
ds_read_b128 v[48:51], v129 offset:32768
ds_read_b128 v[52:55], v133 offset:32768
s_waitcnt lgkmcnt(3)
v_mfma_f32_32x32x16_bf16 v[80:95], v[32:35], v[40:43], v[80:95]
ds_read_b128 v[56:59], v133 offset:36864
ds_read_b128 v[60:63], v129 offset:36864
s_waitcnt lgkmcnt(4)
v_mfma_f32_32x32x16_bf16 v[96:111], v[44:47], v[36:39], v[96:111]
v_mfma_f32_32x32x16_bf16 v[112:127], v[44:47], v[40:43], v[112:127]
s_waitcnt lgkmcnt(2)
v_mfma_f32_32x32x16_bf16 v[64:79], v[48:51], v[52:55], v[64:79]
ds_read_b128 v[32:35], v130 offset:32768
ds_read_b128 v[36:39], v134 offset:32768
s_waitcnt lgkmcnt(3)
v_mfma_f32_32x32x16_bf16 v[80:95], v[48:51], v[56:59], v[80:95]
ds_read_b128 v[40:43], v134 offset:36864
ds_read_b128 v[44:47], v130 offset:36864
s_waitcnt lgkmcnt(4)
v_mfma_f32_32x32x16_bf16 v[96:111], v[60:63], v[52:55], v[96:111]
v_mfma_f32_32x32x16_bf16 v[112:127], v[60:63], v[56:59], v[112:127]
s_waitcnt lgkmcnt(2)
v_mfma_f32_32x32x16_bf16 v[64:79], v[32:35], v[36:39], v[64:79]
ds_read_b128 v[48:51], v131 offset:32768
ds_read_b128 v[52:55], v135 offset:32768
s_waitcnt lgkmcnt(3)
v_mfma_f32_32x32x16_bf16 v[80:95], v[32:35], v[40:43], v[80:95]
ds_read_b128 v[56:59], v135 offset:36864
ds_read_b128 v[60:63], v131 offset:36864
s_waitcnt lgkmcnt(4)
v_mfma_f32_32x32x16_bf16 v[96:111], v[44:47], v[36:39], v[96:111]
v_mfma_f32_32x32x16_bf16 v[112:127], v[44:47], v[40:43], v[112:127]
s_waitcnt lgkmcnt(0)
s_barrier
v_mfma_f32_32x32x16_bf16 v[64:79], v[48:51], v[52:55], v[64:79]
ds_read_b128 v[32:35], v136 offset:0
ds_read_b128 v[36:39], v140 offset:0
v_mfma_f32_32x32x16_bf16 v[80:95], v[48:51], v[56:59], v[80:95]
ds_read_b128 v[40:43], v140 offset:4096
ds_read_b128 v[44:47], v136 offset:4096
v_mfma_f32_32x32x16_bf16 v[96:111], v[60:63], v[52:55], v[96:111]
v_mfma_f32_32x32x16_bf16 v[112:127], v[60:63], v[56:59], v[112:127]
s_waitcnt lgkmcnt(2)
v_mfma_f32_32x32x16_bf16 v[64:79], v[32:35], v[36:39], v[64:79]
ds_read_b128 v[48:51], v137 offset:0
ds_read_b128 v[52:55], v141 offset:0
s_waitcnt lgkmcnt(3)
v_mfma_f32_32x32x16_bf16 v[80:95], v[32:35], v[40:43], v[80:95]
ds_read_b128 v[56:59], v141 offset:4096
ds_read_b128 v[60:63], v137 offset:4096
s_waitcnt lgkmcnt(4)
v_mfma_f32_32x32x16_bf16 v[96:111], v[44:47], v[36:39], v[96:111]
v_mfma_f32_32x32x16_bf16 v[112:127], v[44:47], v[40:43], v[112:127]
s_waitcnt lgkmcnt(2)
v_mfma_f32_32x32x16_bf16 v[64:79], v[48:51], v[52:55], v[64:79]
ds_read_b128 v[32:35], v138 offset:0
ds_read_b128 v[36:39], v142 offset:0
s_waitcnt lgkmcnt(3)
v_mfma_f32_32x32x16_bf16 v[80:95], v[48:51], v[56:59], v[80:95]
ds_read_b128 v[40:43], v142 offset:4096
ds_read_b128 v[44:47], v138 offset:4096
s_waitcnt lgkmcnt(4)
v_mfma_f32_32x32x16_bf16 v[96:111], v[60:63], v[52:55], v[96:111]
v_mfma_f32_32x32x16_bf16 v[112:127], v[60:63], v[56:59], v[112:127]
s_waitcnt lgkmcnt(2)
v_mfma_f32_32x32x16_bf16 v[64:79], v[32:35], v[36:39], v[64:79]
ds_read_b128 v[48:51], v139 offset:0
ds_read_b128 v[52:55], v143 offset:0
s_waitcnt lgkmcnt(3)
v_mfma_f32_32x32x16_bf16 v[80:95], v[32:35], v[40:43], v[80:95]
ds_read_b128 v[56:59], v143 offset:4096
ds_read_b128 v[60:63], v139 offset:4096
s_waitcnt lgkmcnt(4)
v_mfma_f32_32x32x16_bf16 v[96:111], v[44:47], v[36:39], v[96:111]
v_mfma_f32_32x32x16_bf16 v[112:127], v[44:47], v[40:43], v[112:127]
s_waitcnt lgkmcnt(0)
s_barrier
v_mfma_f32_32x32x16_bf16 v[64:79], v[48:51], v[52:55], v[64:79]
ds_read_b128 v[32:35], v128 offset:0
ds_read_b128 v[36:39], v132 offset:0
v_mfma_f32_32x32x16_bf16 v[80:95], v[48:51], v[56:59], v[80:95]
ds_read_b128 v[40:43], v132 offset:4096
ds_read_b128 v[44:47], v128 offset:4096
v_mfma_f32_32x32x16_bf16 v[96:111], v[60:63], v[52:55], v[96:111]
v_mfma_f32_32x32x16_bf16 v[112:127], v[60:63], v[56:59], v[112:127]
s_waitcnt lgkmcnt(2)
v_mfma_f32_32x32x16_bf16 v[64:79], v[32:35], v[36:39], v[64:79]
ds_read_b128 v[48:51], v129 offset:0
ds_read_b128 v[52:55], v133 offset:0
s_waitcnt lgkmcnt(3)
v_mfma_f32_32x32x16_bf16 v[80:95], v[32:35], v[40:43], v[80:95]
ds_read_b128 v[56:59], v133 offset:4096
ds_read_b128 v[60:63], v129 offset:4096
s_waitcnt lgkmcnt(4)
v_mfma_f32_32x32x16_bf16 v[96:111], v[44:47], v[36:39], v[96:111]
v_mfma_f32_32x32x16_bf16 v[112:127], v[44:47], v[40:43], v[112:127]
s_waitcnt lgkmcnt(2)
v_mfma_f32_32x32x16_bf16 v[64:79], v[48:51], v[52:55], v[64:79]
ds_read_b128 v[32:35], v130 offset:0
ds_read_b128 v[36:39], v134 offset:0
s_waitcnt lgkmcnt(3)
v_mfma_f32_32x32x16_bf16 v[80:95], v[48:51], v[56:59], v[80:95]
ds_read_b128 v[40:43], v134 offset:4096
ds_read_b128 v[44:47], v130 offset:4096
s_waitcnt lgkmcnt(4)
v_mfma_f32_32x32x16_bf16 v[96:111], v[60:63], v[52:55], v[96:111]
v_mfma_f32_32x32x16_bf16 v[112:127], v[60:63], v[56:59], v[112:127]
s_waitcnt lgkmcnt(2)
v_mfma_f32_32x32x16_bf16 v[64:79], v[32:35], v[36:39], v[64:79]
ds_read_b128 v[48:51], v131 offset:0
ds_read_b128 v[52:55], v135 offset:0
s_waitcnt lgkmcnt(3)
v_mfma_f32_32x32x16_bf16 v[80:95], v[32:35], v[40:43], v[80:95]
ds_read_b128 v[56:59], v135 offset:4096
ds_read_b128 v[60:63], v131 offset:4096
s_waitcnt lgkmcnt(4)
v_mfma_f32_32x32x16_bf16 v[96:111], v[44:47], v[36:39], v[96:111]
v_mfma_f32_32x32x16_bf16 v[112:127], v[44:47], v[40:43], v[112:127]
s_waitcnt lgkmcnt(0)
s_barrier
v_mfma_f32_32x32x16_bf16 v[64:79], v[48:51], v[52:55], v[64:79]
ds_read_b128 v[32:35], v128 offset:32768
ds_read_b128 v[36:39], v132 offset:32768
v_mfma_f32_32x32x16_bf16 v[80:95], v[48:51], v[56:59], v[80:95]
ds_read_b128 v[40:43], v132 offset:36864
ds_read_b128 v[44:47], v128 offset:36864
v_mfma_f32_32x32x16_bf16 v[96:111], v[60:63], v[52:55], v[96:111]
v_mfma_f32_32x32x16_bf16 v[112:127], v[60:63], v[56:59], v[112:127]
s_waitcnt lgkmcnt(2)
v_mfma_f32_32x32x16_bf16 v[64:79], v[32:35], v[36:39], v[64:79]
ds_read_b128 v[48:51], v129 offset:32768
ds_read_b128 v[52:55], v133 offset:32768
s_waitcnt lgkmcnt(3)
v_mfma_f32_32x32x16_bf16 v[80:95], v[32:35], v[40:43], v[80:95]
ds_read_b128 v[56:59], v133 offset:36864
ds_read_b128 v[60:63], v129 offset:36864
s_waitcnt lgkmcnt(4)
v_mfma_f32_32x32x16_bf16 v[96:111], v[44:47], v[36:39], v[96:111]
v_mfma_f32_32x32x16_bf16 v[112:127], v[44:47], v[40:43], v[112:127]
s_waitcnt lgkmcnt(2)
v_mfma_f32_32x32x16_bf16 v[64:79], v[48:51], v[52:55], v[64:79]
ds_read_b128 v[32:35], v130 offset:32768
ds_read_b128 v[36:39], v134 offset:32768
s_waitcnt lgkmcnt(3)
v_mfma_f32_32x32x16_bf16 v[80:95], v[48:51], v[56:59], v[80:95]
ds_read_b128 v[40:43], v134 offset:36864
ds_read_b128 v[44:47], v130 offset:36864
s_waitcnt lgkmcnt(4)
v_mfma_f32_32x32x16_bf16 v[96:111], v[60:63], v[52:55], v[96:111]
v_mfma_f32_32x32x16_bf16 v[112:127], v[60:63], v[56:59], v[112:127]
s_waitcnt lgkmcnt(2)
v_mfma_f32_32x32x16_bf16 v[64:79], v[32:35], v[36:39], v[64:79]
ds_read_b128 v[48:51], v131 offset:32768
ds_read_b128 v[52:55], v135 offset:32768
s_waitcnt lgkmcnt(3)
v_mfma_f32_32x32x16_bf16 v[80:95], v[32:35], v[40:43], v[80:95]
ds_read_b128 v[56:59], v135 offset:36864
ds_read_b128 v[60:63], v131 offset:36864
s_waitcnt lgkmcnt(4)
v_mfma_f32_32x32x16_bf16 v[96:111], v[44:47], v[36:39], v[96:111]
v_mfma_f32_32x32x16_bf16 v[112:127], v[44:47], v[40:43], v[112:127]
s_waitcnt lgkmcnt(0)
s_barrier
v_mfma_f32_32x32x16_bf16 v[64:79], v[48:51], v[52:55], v[64:79]
ds_read_b128 v[32:35], v136 offset:0
ds_read_b128 v[36:39], v140 offset:0
v_mfma_f32_32x32x16_bf16 v[80:95], v[48:51], v[56:59], v[80:95]
ds_read_b128 v[40:43], v140 offset:4096
ds_read_b128 v[44:47], v136 offset:4096
v_mfma_f32_32x32x16_bf16 v[96:111], v[60:63], v[52:55], v[96:111]
v_mfma_f32_32x32x16_bf16 v[112:127], v[60:63], v[56:59], v[112:127]
s_waitcnt lgkmcnt(2)
v_mfma_f32_32x32x16_bf16 v[64:79], v[32:35], v[36:39], v[64:79]
ds_read_b128 v[48:51], v137 offset:0
ds_read_b128 v[52:55], v141 offset:0
s_waitcnt lgkmcnt(3)
v_mfma_f32_32x32x16_bf16 v[80:95], v[32:35], v[40:43], v[80:95]
ds_read_b128 v[56:59], v141 offset:4096
ds_read_b128 v[60:63], v137 offset:4096
s_waitcnt lgkmcnt(4)
v_mfma_f32_32x32x16_bf16 v[96:111], v[44:47], v[36:39], v[96:111]
v_mfma_f32_32x32x16_bf16 v[112:127], v[44:47], v[40:43], v[112:127]
s_waitcnt lgkmcnt(2)
v_mfma_f32_32x32x16_bf16 v[64:79], v[48:51], v[52:55], v[64:79]
ds_read_b128 v[32:35], v138 offset:0
ds_read_b128 v[36:39], v142 offset:0
s_waitcnt lgkmcnt(3)
v_mfma_f32_32x32x16_bf16 v[80:95], v[48:51], v[56:59], v[80:95]
ds_read_b128 v[40:43], v142 offset:4096
ds_read_b128 v[44:47], v138 offset:4096
s_waitcnt lgkmcnt(4)
v_mfma_f32_32x32x16_bf16 v[96:111], v[60:63], v[52:55], v[96:111]
v_mfma_f32_32x32x16_bf16 v[112:127], v[60:63], v[56:59], v[112:127]
s_waitcnt lgkmcnt(2)
v_mfma_f32_32x32x16_bf16 v[64:79], v[32:35], v[36:39], v[64:79]
ds_read_b128 v[48:51], v139 offset:0
ds_read_b128 v[52:55], v143 offset:0
s_waitcnt lgkmcnt(3)
v_mfma_f32_32x32x16_bf16 v[80:95], v[32:35], v[40:43], v[80:95]
ds_read_b128 v[56:59], v143 offset:4096
ds_read_b128 v[60:63], v139 offset:4096
s_waitcnt lgkmcnt(4)
v_mfma_f32_32x32x16_bf16 v[96:111], v[44:47], v[36:39], v[96:111]
v_mfma_f32_32x32x16_bf16 v[112:127], v[44:47], v[40:43], v[112:127]
s_waitcnt lgkmcnt(0)
s_barrier
v_mfma_f32_32x32x16_bf16 v[64:79], v[48:51], v[52:55], v[64:79]
ds_read_b128 v[32:35], v128 offset:0
ds_read_b128 v[36:39], v132 offset:0
v_mfma_f32_32x32x16_bf16 v[80:95], v[48:51], v[56:59], v[80:95]
ds_read_b128 v[40:43], v132 offset:4096
ds_read_b128 v[44:47], v128 offset:4096
v_mfma_f32_32x32x16_bf16 v[96:111], v[60:63], v[52:55], v[96:111]
v_mfma_f32_32x32x16_bf16 v[112:127], v[60:63], v[56:59], v[112:127]
s_waitcnt lgkmcnt(2)
v_mov_b32 v12, 0
global_load_dword v13, v12, s[30:31] sc1
v_mfma_f32_32x32x16_bf16 v[64:79], v[32:35], v[36:39], v[64:79]
ds_read_b128 v[48:51], v129 offset:0
ds_read_b128 v[52:55], v133 offset:0
s_waitcnt lgkmcnt(3)
v_mfma_f32_32x32x16_bf16 v[80:95], v[32:35], v[40:43], v[80:95]
ds_read_b128 v[56:59], v133 offset:4096
ds_read_b128 v[60:63], v129 offset:4096
s_waitcnt lgkmcnt(4)
v_mfma_f32_32x32x16_bf16 v[96:111], v[44:47], v[36:39], v[96:111]
v_mfma_f32_32x32x16_bf16 v[112:127], v[44:47], v[40:43], v[112:127]
s_waitcnt lgkmcnt(2)
v_mfma_f32_32x32x16_bf16 v[64:79], v[48:51], v[52:55], v[64:79]
ds_read_b128 v[32:35], v130 offset:0
ds_read_b128 v[36:39], v134 offset:0
s_waitcnt lgkmcnt(3)
v_mfma_f32_32x32x16_bf16 v[80:95], v[48:51], v[56:59], v[80:95]
ds_read_b128 v[40:43], v134 offset:4096
ds_read_b128 v[44:47], v130 offset:4096
s_waitcnt lgkmcnt(4)
v_mfma_f32_32x32x16_bf16 v[96:111], v[60:63], v[52:55], v[96:111]
v_mfma_f32_32x32x16_bf16 v[112:127], v[60:63], v[56:59], v[112:127]
s_waitcnt lgkmcnt(2)
v_mfma_f32_32x32x16_bf16 v[64:79], v[32:35], v[36:39], v[64:79]
ds_read_b128 v[48:51], v131 offset:0
ds_read_b128 v[52:55], v135 offset:0
s_waitcnt lgkmcnt(3)
v_mfma_f32_32x32x16_bf16 v[80:95], v[32:35], v[40:43], v[80:95]
ds_read_b128 v[56:59], v135 offset:4096
ds_read_b128 v[60:63], v131 offset:4096
s_waitcnt lgkmcnt(4)
v_mfma_f32_32x32x16_bf16 v[96:111], v[44:47], v[36:39], v[96:111]
v_mfma_f32_32x32x16_bf16 v[112:127], v[44:47], v[40:43], v[112:127]
s_waitcnt lgkmcnt(0)
s_barrier
v_mfma_f32_32x32x16_bf16 v[64:79], v[48:51], v[52:55], v[64:79]
ds_read_b128 v[32:35], v128 offset:32768
ds_read_b128 v[36:39], v132 offset:32768
v_mfma_f32_32x32x16_bf16 v[80:95], v[48:51], v[56:59], v[80:95]
ds_read_b128 v[40:43], v132 offset:36864
ds_read_b128 v[44:47], v128 offset:36864
v_mfma_f32_32x32x16_bf16 v[96:111], v[60:63], v[52:55], v[96:111]
v_mfma_f32_32x32x16_bf16 v[112:127], v[60:63], v[56:59], v[112:127]
s_waitcnt lgkmcnt(2)
v_mfma_f32_32x32x16_bf16 v[64:79], v[32:35], v[36:39], v[64:79]
ds_read_b128 v[48:51], v129 offset:32768
ds_read_b128 v[52:55], v133 offset:32768
s_waitcnt lgkmcnt(3)
v_mfma_f32_32x32x16_bf16 v[80:95], v[32:35], v[40:43], v[80:95]
ds_read_b128 v[56:59], v133 offset:36864
ds_read_b128 v[60:63], v129 offset:36864
s_waitcnt lgkmcnt(4)
v_mfma_f32_32x32x16_bf16 v[96:111], v[44:47], v[36:39], v[96:111]
v_mfma_f32_32x32x16_bf16 v[112:127], v[44:47], v[40:43], v[112:127]
s_waitcnt lgkmcnt(2)
v_mfma_f32_32x32x16_bf16 v[64:79], v[48:51], v[52:55], v[64:79]
ds_read_b128 v[32:35], v130 offset:32768
ds_read_b128 v[36:39], v134 offset:32768
s_waitcnt lgkmcnt(3)
v_mfma_f32_32x32x16_bf16 v[80:95], v[48:51], v[56:59], v[80:95]
ds_read_b128 v[40:43], v134 offset:36864
ds_read_b128 v[44:47], v130 offset:36864
s_waitcnt lgkmcnt(4)
v_mfma_f32_32x32x16_bf16 v[96:111], v[60:63], v[52:55], v[96:111]
v_mfma_f32_32x32x16_bf16 v[112:127], v[60:63], v[56:59], v[112:127]
s_waitcnt lgkmcnt(2)
v_mfma_f32_32x32x16_bf16 v[64:79], v[32:35], v[36:39], v[64:79]
ds_read_b128 v[48:51], v131 offset:32768
ds_read_b128 v[52:55], v135 offset:32768
s_waitcnt lgkmcnt(3)
v_mfma_f32_32x32x16_bf16 v[80:95], v[32:35], v[40:43], v[80:95]
ds_read_b128 v[56:59], v135 offset:36864
ds_read_b128 v[60:63], v131 offset:36864
s_waitcnt lgkmcnt(4)
v_mfma_f32_32x32x16_bf16 v[96:111], v[44:47], v[36:39], v[96:111]
v_mfma_f32_32x32x16_bf16 v[112:127], v[44:47], v[40:43], v[112:127]
s_waitcnt lgkmcnt(0)
s_barrier
v_mfma_f32_32x32x16_bf16 v[64:79], v[48:51], v[52:55], v[64:79]
ds_read_b128 v[32:35], v136 offset:0
ds_read_b128 v[36:39], v140 offset:0
v_mfma_f32_32x32x16_bf16 v[80:95], v[48:51], v[56:59], v[80:95]
ds_read_b128 v[40:43], v140 offset:4096
ds_read_b128 v[44:47], v136 offset:4096
v_mfma_f32_32x32x16_bf16 v[96:111], v[60:63], v[52:55], v[96:111]
v_mfma_f32_32x32x16_bf16 v[112:127], v[60:63], v[56:59], v[112:127]
s_waitcnt lgkmcnt(2)
v_mfma_f32_32x32x16_bf16 v[64:79], v[32:35], v[36:39], v[64:79]
ds_read_b128 v[48:51], v137 offset:0
ds_read_b128 v[52:55], v141 offset:0
s_waitcnt lgkmcnt(3)
v_mfma_f32_32x32x16_bf16 v[80:95], v[32:35], v[40:43], v[80:95]
ds_read_b128 v[56:59], v141 offset:4096
ds_read_b128 v[60:63], v137 offset:4096
s_waitcnt lgkmcnt(4)
v_mfma_f32_32x32x16_bf16 v[96:111], v[44:47], v[36:39], v[96:111]
v_mfma_f32_32x32x16_bf16 v[112:127], v[44:47], v[40:43], v[112:127]
s_waitcnt lgkmcnt(2)
v_mfma_f32_32x32x16_bf16 v[64:79], v[48:51], v[52:55], v[64:79]
ds_read_b128 v[32:35], v138 offset:0
ds_read_b128 v[36:39], v142 offset:0
s_waitcnt lgkmcnt(3)
v_mfma_f32_32x32x16_bf16 v[80:95], v[48:51], v[56:59], v[80:95]
ds_read_b128 v[40:43], v142 offset:4096
ds_read_b128 v[44:47], v138 offset:4096
s_waitcnt lgkmcnt(4)
v_mfma_f32_32x32x16_bf16 v[96:111], v[60:63], v[52:55], v[96:111]
v_mfma_f32_32x32x16_bf16 v[112:127], v[60:63], v[56:59], v[112:127]
s_waitcnt lgkmcnt(2)
v_mfma_f32_32x32x16_bf16 v[64:79], v[32:35], v[36:39], v[64:79]
ds_read_b128 v[48:51], v139 offset:0
ds_read_b128 v[52:55], v143 offset:0
s_waitcnt lgkmcnt(3)
v_mfma_f32_32x32x16_bf16 v[80:95], v[32:35], v[40:43], v[80:95]
ds_read_b128 v[56:59], v143 offset:4096
ds_read_b128 v[60:63], v139 offset:4096
s_waitcnt lgkmcnt(4)
v_mfma_f32_32x32x16_bf16 v[96:111], v[44:47], v[36:39], v[96:111]
v_mfma_f32_32x32x16_bf16 v[112:127], v[44:47], v[40:43], v[112:127]
s_waitcnt lgkmcnt(0)
s_barrier
v_mfma_f32_32x32x16_bf16 v[64:79], v[48:51], v[52:55], v[64:79]
ds_read_b128 v[32:35], v128 offset:0
ds_read_b128 v[36:39], v132 offset:0
v_mfma_f32_32x32x16_bf16 v[80:95], v[48:51], v[56:59], v[80:95]
ds_read_b128 v[40:43], v132 offset:4096
ds_read_b128 v[44:47], v128 offset:4096
v_mfma_f32_32x32x16_bf16 v[96:111], v[60:63], v[52:55], v[96:111]
v_mfma_f32_32x32x16_bf16 v[112:127], v[60:63], v[56:59], v[112:127]
s_waitcnt lgkmcnt(2)
v_mfma_f32_32x32x16_bf16 v[64:79], v[32:35], v[36:39], v[64:79]
ds_read_b128 v[48:51], v129 offset:0
ds_read_b128 v[52:55], v133 offset:0
s_waitcnt lgkmcnt(3)
v_mfma_f32_32x32x16_bf16 v[80:95], v[32:35], v[40:43], v[80:95]
ds_read_b128 v[56:59], v133 offset:4096
ds_read_b128 v[60:63], v129 offset:4096
s_waitcnt lgkmcnt(4)
v_mfma_f32_32x32x16_bf16 v[96:111], v[44:47], v[36:39], v[96:111]
v_mfma_f32_32x32x16_bf16 v[112:127], v[44:47], v[40:43], v[112:127]
s_waitcnt lgkmcnt(2)
v_mfma_f32_32x32x16_bf16 v[64:79], v[48:51], v[52:55], v[64:79]
ds_read_b128 v[32:35], v130 offset:0
ds_read_b128 v[36:39], v134 offset:0
s_waitcnt lgkmcnt(3)
v_mfma_f32_32x32x16_bf16 v[80:95], v[48:51], v[56:59], v[80:95]
ds_read_b128 v[40:43], v134 offset:4096
ds_read_b128 v[44:47], v130 offset:4096
s_waitcnt lgkmcnt(4)
v_mfma_f32_32x32x16_bf16 v[96:111], v[60:63], v[52:55], v[96:111]
v_mfma_f32_32x32x16_bf16 v[112:127], v[60:63], v[56:59], v[112:127]
s_waitcnt lgkmcnt(2)
v_mfma_f32_32x32x16_bf16 v[64:79], v[32:35], v[36:39], v[64:79]
ds_read_b128 v[48:51], v131 offset:0
ds_read_b128 v[52:55], v135 offset:0
s_waitcnt lgkmcnt(3)
v_mfma_f32_32x32x16_bf16 v[80:95], v[32:35], v[40:43], v[80:95]
ds_read_b128 v[56:59], v135 offset:4096
ds_read_b128 v[60:63], v131 offset:4096
s_waitcnt lgkmcnt(4)
v_mfma_f32_32x32x16_bf16 v[96:111], v[44:47], v[36:39], v[96:111]
v_mfma_f32_32x32x16_bf16 v[112:127], v[44:47], v[40:43], v[112:127]
s_waitcnt lgkmcnt(0)
s_barrier
v_mfma_f32_32x32x16_bf16 v[64:79], v[48:51], v[52:55], v[64:79]
v_mfma_f32_32x32x16_bf16 v[80:95], v[48:51], v[56:59], v[80:95]
v_mfma_f32_32x32x16_bf16 v[96:111], v[60:63], v[52:55], v[96:111]
v_mfma_f32_32x32x16_bf16 v[112:127], v[60:63], v[56:59], v[112:127]
s_lshl_b32 s60, s66, 10
s_add_u32 s60, s60, 122880
s_lshl_b32 s61, s68, 4
v_lshl_add_u32 v14, v6, 5, s60
v_lshl_add_u32 v15, v5, 3, v14
v_add_u32 v15, s61, v15
s_nop 2
v_pk_fma_f32 v[40:41], v[24:25], v[64:65], v[66:67] op_sel_hi:[0,1,1]
v_pk_fma_f32 v[42:43], v[24:25], v[80:81], v[82:83] op_sel_hi:[0,1,1]
v_pk_fma_f32 v[66:67], v[24:25], v[80:81], v[40:41] op_sel:[1,0,0] neg_lo:[1,0,0] neg_hi:[1,0,0]
v_pk_fma_f32 v[82:83], v[24:25], v[64:65], v[42:43] op_sel:[1,0,0]
v_pk_fma_f32 v[40:41], v[24:25], v[66:67], v[68:69] op_sel_hi:[0,1,1]
v_pk_fma_f32 v[42:43], v[24:25], v[82:83], v[84:85] op_sel_hi:[0,1,1]
v_pk_fma_f32 v[68:69], v[24:25], v[82:83], v[40:41] op_sel:[1,0,0] neg_lo:[1,0,0] neg_hi:[1,0,0]
v_pk_fma_f32 v[84:85], v[24:25], v[66:67], v[42:43] op_sel:[1,0,0]
v_pk_fma_f32 v[40:41], v[24:25], v[68:69], v[70:71] op_sel_hi:[0,1,1]
v_pk_fma_f32 v[42:43], v[24:25], v[84:85], v[86:87] op_sel_hi:[0,1,1]
v_pk_fma_f32 v[70:71], v[24:25], v[84:85], v[40:41] op_sel:[1,0,0] neg_lo:[1,0,0] neg_hi:[1,0,0]
v_pk_fma_f32 v[86:87], v[24:25], v[68:69], v[42:43] op_sel:[1,0,0]
v_pk_fma_f32 v[40:41], v[24:25], v[70:71], v[72:73] op_sel_hi:[0,1,1]
v_pk_fma_f32 v[42:43], v[24:25], v[86:87], v[88:89] op_sel_hi:[0,1,1]
v_pk_fma_f32 v[72:73], v[24:25], v[86:87], v[40:41] op_sel:[1,0,0] neg_lo:[1,0,0] neg_hi:[1,0,0]
v_pk_fma_f32 v[88:89], v[24:25], v[70:71], v[42:43] op_sel:[1,0,0]
v_pk_fma_f32 v[40:41], v[24:25], v[72:73], v[74:75] op_sel_hi:[0,1,1]
v_pk_fma_f32 v[42:43], v[24:25], v[88:89], v[90:91] op_sel_hi:[0,1,1]
v_pk_fma_f32 v[74:75], v[24:25], v[88:89], v[40:41] op_sel:[1,0,0] neg_lo:[1,0,0] neg_hi:[1,0,0]
v_pk_fma_f32 v[90:91], v[24:25], v[72:73], v[42:43] op_sel:[1,0,0]
v_pk_fma_f32 v[40:41], v[24:25], v[74:75], v[76:77] op_sel_hi:[0,1,1]
v_pk_fma_f32 v[42:43], v[24:25], v[90:91], v[92:93] op_sel_hi:[0,1,1]
v_pk_fma_f32 v[76:77], v[24:25], v[90:91], v[40:41] op_sel:[1,0,0] neg_lo:[1,0,0] neg_hi:[1,0,0]
v_pk_fma_f32 v[92:93], v[24:25], v[74:75], v[42:43] op_sel:[1,0,0]
v_pk_fma_f32 v[40:41], v[24:25], v[76:77], v[78:79] op_sel_hi:[0,1,1]
v_pk_fma_f32 v[42:43], v[24:25], v[92:93], v[94:95] op_sel_hi:[0,1,1]
v_pk_fma_f32 v[78:79], v[24:25], v[92:93], v[40:41] op_sel:[1,0,0] neg_lo:[1,0,0] neg_hi:[1,0,0]
v_pk_fma_f32 v[94:95], v[24:25], v[76:77], v[42:43] op_sel:[1,0,0]
v_pk_fma_f32 v[40:41], v[24:25], v[78:79], v[96:97] op_sel_hi:[0,1,1]
v_pk_fma_f32 v[42:43], v[24:25], v[94:95], v[112:113] op_sel_hi:[0,1,1]
v_pk_fma_f32 v[96:97], v[24:25], v[94:95], v[40:41] op_sel:[1,0,0] neg_lo:[1,0,0] neg_hi:[1,0,0]
v_pk_fma_f32 v[112:113], v[24:25], v[78:79], v[42:43] op_sel:[1,0,0]
v_pk_fma_f32 v[40:41], v[24:25], v[96:97], v[98:99] op_sel_hi:[0,1,1]
v_pk_fma_f32 v[42:43], v[24:25], v[112:113], v[114:115] op_sel_hi:[0,1,1]
v_pk_fma_f32 v[98:99], v[24:25], v[112:113], v[40:41] op_sel:[1,0,0] neg_lo:[1,0,0] neg_hi:[1,0,0]
v_pk_fma_f32 v[114:115], v[24:25], v[96:97], v[42:43] op_sel:[1,0,0]
v_pk_fma_f32 v[40:41], v[24:25], v[98:99], v[100:101] op_sel_hi:[0,1,1]
v_pk_fma_f32 v[42:43], v[24:25], v[114:115], v[116:117] op_sel_hi:[0,1,1]
v_pk_fma_f32 v[100:101], v[24:25], v[114:115], v[40:41] op_sel:[1,0,0] neg_lo:[1,0,0] neg_hi:[1,0,0]
v_pk_fma_f32 v[116:117], v[24:25], v[98:99], v[42:43] op_sel:[1,0,0]
v_pk_fma_f32 v[40:41], v[24:25], v[100:101], v[102:103] op_sel_hi:[0,1,1]
v_pk_fma_f32 v[42:43], v[24:25], v[116:117], v[118:119] op_sel_hi:[0,1,1]
v_pk_fma_f32 v[102:103], v[24:25], v[116:117], v[40:41] op_sel:[1,0,0] neg_lo:[1,0,0] neg_hi:[1,0,0]
v_pk_fma_f32 v[118:119], v[24:25], v[100:101], v[42:43] op_sel:[1,0,0]
v_pk_fma_f32 v[40:41], v[24:25], v[102:103], v[104:105] op_sel_hi:[0,1,1]
v_pk_fma_f32 v[42:43], v[24:25], v[118:119], v[120:121] op_sel_hi:[0,1,1]
v_pk_fma_f32 v[104:105], v[24:25], v[118:119], v[40:41] op_sel:[1,0,0] neg_lo:[1,0,0] neg_hi:[1,0,0]
v_pk_fma_f32 v[120:121], v[24:25], v[102:103], v[42:43] op_sel:[1,0,0]
v_pk_fma_f32 v[40:41], v[24:25], v[104:105], v[106:107] op_sel_hi:[0,1,1]
v_pk_fma_f32 v[42:43], v[24:25], v[120:121], v[122:123] op_sel_hi:[0,1,1]
v_pk_fma_f32 v[106:107], v[24:25], v[120:121], v[40:41] op_sel:[1,0,0] neg_lo:[1,0,0] neg_hi:[1,0,0]
v_pk_fma_f32 v[122:123], v[24:25], v[104:105], v[42:43] op_sel:[1,0,0]
v_pk_fma_f32 v[40:41], v[24:25], v[106:107], v[108:109] op_sel_hi:[0,1,1]
v_pk_fma_f32 v[42:43], v[24:25], v[122:123], v[124:125] op_sel_hi:[0,1,1]
v_pk_fma_f32 v[108:109], v[24:25], v[122:123], v[40:41] op_sel:[1,0,0] neg_lo:[1,0,0] neg_hi:[1,0,0]
v_pk_fma_f32 v[124:125], v[24:25], v[106:107], v[42:43] op_sel:[1,0,0]
v_pk_fma_f32 v[40:41], v[24:25], v[108:109], v[110:111] op_sel_hi:[0,1,1]
v_pk_fma_f32 v[42:43], v[24:25], v[124:125], v[126:127] op_sel_hi:[0,1,1]
v_pk_fma_f32 v[110:111], v[24:25], v[124:125], v[40:41] op_sel:[1,0,0] neg_lo:[1,0,0] neg_hi:[1,0,0]
v_pk_fma_f32 v[126:127], v[24:25], v[108:109], v[42:43] op_sel:[1,0,0]
v_fma_f32 v40, v28, v110, v111
v_fma_f32 v41, v28, v126, v127
v_fma_f32 v32, -v29, v126, v40
v_fma_f32 v33, v29, v110, v41
ds_write_b64 v15, v[32:33]
s_sub_u32 s60, s35, 1
s_lshl_b32 s60, s60, 14
v_lshlrev_b32 v16, 4, v4
v_lshlrev_b32 v17, 14, v5
v_sub_u32 v17, v16, v17
v_add_u32 v128, s60, v17
s_lshl_b32 s60, s35, 14
v_add_u32 v16, s60, v16
v_lshlrev_b32 v17, 30, v5
v_or_b32 v16, v16, v17
s_waitcnt lgkmcnt(0)
s_barrier
ds_read_b128 v[144:147], v14
ds_read_b128 v[148:151], v14 offset:16
L_n41:
s_waitcnt vmcnt(0)
v_readfirstlane_b32 s37, v13
s_nop 0
s_cmp_lg_u32 s37, 0
s_cbranch_scc1 L_ng42
global_load_dword v13, v12, s[30:31] sc1
s_branch L_n41
L_ng42:
v_mov_b32 v46, s37
v_mov_b32 v47, s37
s_getreg_b32 s60, hwreg(HW_REG_XCC_ID, 0, 4)
s_lshl_b32 s61, s37, 4
s_or_b32 s100, s60, s61
v_mov_b32 v60, s100
s_lshr_b32 s101, s36, 3
s_lshl_b32 s60, s35, 11
s_add_u32 s60, s60, 32768
s_lshl_b32 s61, s36, 7
s_add_u32 s61, s61, s60
v_mov_b32 v61, s61
s_lshl_b32 s61, s101, 10
s_add_u32 s60, s60, s61
v_and_b32 v62, 7, v1
v_lshl_add_u32 v62, v62, 7, s60
s_waitcnt lgkmcnt(0)
v_fma_f32 v40, v20, v144, v146
v_fma_f32 v41, v20, v145, v147
v_fma_f32 v48, -v21, v145, v40
v_fma_f32 v49, v21, v144, v41
v_fma_f32 v40, v20, v48, v148
v_fma_f32 v41, v20, v49, v149
v_fma_f32 v50, -v21, v49, v40
v_fma_f32 v51, v21, v48, v41
v_fma_f32 v40, v20, v50, v150
v_fma_f32 v41, v20, v51, v151
v_fma_f32 v44, -v21, v51, v40
v_fma_f32 v45, v21, v50, v41
s_cmp_lg_u32 s68, 0
s_cbranch_scc1 L_np43
buffer_store_dwordx4 v[44:47], v16, s[40:43], 0 offen sc1
s_cmp_lg_u32 s66, 0
s_cbranch_scc1 L_np43
s_mov_b64 exec, 1
global_store_dword v61, v60, s[32:33] sc1
s_mov_b64 exec, -1
L_np43:
v_mov_b32 v17, 0x40000000
v_subrev_u32 v129, 32768, v128
v_subrev_u32 v130, 65536, v128
v_subrev_u32 v131, 98304, v128
v_subrev_u32 v132, 131072, v128
v_subrev_u32 v133, 163840, v128
v_subrev_u32 v134, 196608, v128
v_subrev_u32 v135, 229376, v128
v_cmp_le_i32 vcc, 0, v128
s_nop 1
v_cndmask_b32 v136, 0, v46, vcc
v_cndmask_b32 v128, v17, v128, vcc
v_cmp_le_i32 vcc, 0, v129
s_nop 1
v_cndmask_b32 v137, 0, v46, vcc
v_cndmask_b32 v129, v17, v129, vcc
v_cmp_le_i32 vcc, 0, v130
s_nop 1
v_cndmask_b32 v138, 0, v46, vcc
v_cndmask_b32 v130, v17, v130, vcc
v_cmp_le_i32 vcc, 0, v131
s_nop 1
v_cndmask_b32 v139, 0, v46, vcc
v_cndmask_b32 v131, v17, v131, vcc
v_cmp_le_i32 vcc, 0, v132
s_nop 1
v_cndmask_b32 v140, 0, v46, vcc
v_cndmask_b32 v132, v17, v132, vcc
v_cmp_le_i32 vcc, 0, v133
s_nop 1
v_cndmask_b32 v141, 0, v46, vcc
v_cndmask_b32 v133, v17, v133, vcc
v_cmp_le_i32 vcc, 0, v134
s_nop 1
v_cndmask_b32 v142, 0, v46, vcc
v_cndmask_b32 v134, v17, v134, vcc
v_cmp_le_i32 vcc, 0, v135
s_nop 1
v_cndmask_b32 v143, 0, v46, vcc
v_cndmask_b32 v135, v17, v135, vcc
s_lshl_b32 s60, s35, 1
s_add_u32 s60, s60, s68
s_lshl_b32 s60, s60, 12
s_add_u32 s60, s60, 393216
s_lshl_b32 s61, s101, 11
s_add_u32 s61, s61, s60
v_and_b32 v18, 15, v1
v_lshl_add_u32 v18, v18, 7, s61
s_lshl_b32 s61, s36, 8
s_add_u32 s60, s60, s61
s_lshl_b32 s61, s66, 7
s_add_u32 s60, s60, s61
v_mov_b32 v19, s60
global_load_dword v243, v18, s[32:33] sc1
v_mul_f32 v52, v27, v25
v_mul_f32 v53, v27, v24
v_fma_f32 v208, v26, v24, -v52
v_fma_f32 v209, v26, v25, v53
v_pk_mul_f32 v[52:53], v[26:27], v[64:65] op_sel_hi:[0,1]
v_pk_mul_f32 v[54:55], v[26:27], v[80:81] op_sel_hi:[0,1] neg_lo:[1,0] neg_hi:[1,0]
v_mul_f32 v58, v209, v25
v_mul_f32 v59, v209, v24
v_pk_fma_f32 v[54:55], v[26:27], v[64:65], v[54:55] op_sel:[1,0,0] neg_lo:[1,0,0] neg_hi:[1,0,0]
v_pk_fma_f32 v[64:65], v[26:27], v[80:81], v[52:53] op_sel:[1,0,0] neg_lo:[1,0,0] neg_hi:[1,0,0]
v_mov_b64 v[80:81], v[54:55]
v_fma_f32 v210, v208, v24, -v58
v_fma_f32 v211, v208, v25, v59
v_pk_mul_f32 v[52:53], v[26:27], v[66:67] op_sel_hi:[0,1]
v_pk_mul_f32 v[54:55], v[26:27], v[82:83] op_sel_hi:[0,1] neg_lo:[1,0] neg_hi:[1,0]
v_mul_f32 v58, v211, v25
v_mul_f32 v59, v211, v24
v_pk_fma_f32 v[54:55], v[26:27], v[66:67], v[54:55] op_sel:[1,0,0] neg_lo:[1,0,0] neg_hi:[1,0,0]
v_pk_fma_f32 v[66:67], v[26:27], v[82:83], v[52:53] op_sel:[1,0,0] neg_lo:[1,0,0] neg_hi:[1,0,0]
v_mov_b64 v[82:83], v[54:55]
v_fma_f32 v212, v210, v24, -v58
v_fma_f32 v213, v210, v25, v59
v_pk_mul_f32 v[52:53], v[26:27], v[68:69] op_sel_hi:[0,1]
v_pk_mul_f32 v[54:55], v[26:27], v[84:85] op_sel_hi:[0,1] neg_lo:[1,0] neg_hi:[1,0]
v_mul_f32 v58, v213, v25
v_mul_f32 v59, v213, v24
v_pk_fma_f32 v[54:55], v[26:27], v[68:69], v[54:55] op_sel:[1,0,0] neg_lo:[1,0,0] neg_hi:[1,0,0]
v_pk_fma_f32 v[68:69], v[26:27], v[84:85], v[52:53] op_sel:[1,0,0] neg_lo:[1,0,0] neg_hi:[1,0,0]
v_mov_b64 v[84:85], v[54:55]
v_fma_f32 v214, v212, v24, -v58
v_fma_f32 v215, v212, v25, v59
v_pk_mul_f32 v[52:53], v[26:27], v[70:71] op_sel_hi:[0,1]
v_pk_mul_f32 v[54:55], v[26:27], v[86:87] op_sel_hi:[0,1] neg_lo:[1,0] neg_hi:[1,0]
v_mul_f32 v58, v215, v25
v_mul_f32 v59, v215, v24
v_pk_fma_f32 v[54:55], v[26:27], v[70:71], v[54:55] op_sel:[1,0,0] neg_lo:[1,0,0] neg_hi:[1,0,0]
v_pk_fma_f32 v[70:71], v[26:27], v[86:87], v[52:53] op_sel:[1,0,0] neg_lo:[1,0,0] neg_hi:[1,0,0]
v_mov_b64 v[86:87], v[54:55]
v_fma_f32 v216, v214, v24, -v58
v_fma_f32 v217, v214, v25, v59
v_pk_mul_f32 v[52:53], v[26:27], v[72:73] op_sel_hi:[0,1]
v_pk_mul_f32 v[54:55], v[26:27], v[88:89] op_sel_hi:[0,1] neg_lo:[1,0] neg_hi:[1,0]
v_mul_f32 v58, v217, v25
v_mul_f32 v59, v217, v24
v_pk_fma_f32 v[54:55], v[26:27], v[72:73], v[54:55] op_sel:[1,0,0] neg_lo:[1,0,0] neg_hi:[1,0,0]
v_pk_fma_f32 v[72:73], v[26:27], v[88:89], v[52:53] op_sel:[1,0,0] neg_lo:[1,0,0] neg_hi:[1,0,0]
v_mov_b64 v[88:89], v[54:55]
v_fma_f32 v218, v216, v24, -v58
v_fma_f32 v219, v216, v25, v59
v_pk_mul_f32 v[52:53], v[26:27], v[74:75] op_sel_hi:[0,1]
v_pk_mul_f32 v[54:55], v[26:27], v[90:91] op_sel_hi:[0,1] neg_lo:[1,0] neg_hi:[1,0]
v_mul_f32 v58, v219, v25
v_mul_f32 v59, v219, v24
v_pk_fma_f32 v[54:55], v[26:27], v[74:75], v[54:55] op_sel:[1,0,0] neg_lo:[1,0,0] neg_hi:[1,0,0]
v_pk_fma_f32 v[74:75], v[26:27], v[90:91], v[52:53] op_sel:[1,0,0] neg_lo:[1,0,0] neg_hi:[1,0,0]
v_mov_b64 v[90:91], v[54:55]
v_fma_f32 v220, v218, v24, -v58
v_fma_f32 v221, v218, v25, v59
v_pk_mul_f32 v[52:53], v[26:27], v[76:77] op_sel_hi:[0,1]
v_pk_mul_f32 v[54:55], v[26:27], v[92:93] op_sel_hi:[0,1] neg_lo:[1,0] neg_hi:[1,0]
v_mul_f32 v58, v221, v25
v_mul_f32 v59, v221, v24
v_pk_fma_f32 v[54:55], v[26:27], v[76:77], v[54:55] op_sel:[1,0,0] neg_lo:[1,0,0] neg_hi:[1,0,0]
v_pk_fma_f32 v[76:77], v[26:27], v[92:93], v[52:53] op_sel:[1,0,0] neg_lo:[1,0,0] neg_hi:[1,0,0]
v_mov_b64 v[92:93], v[54:55]
v_fma_f32 v222, v220, v24, -v58
v_fma_f32 v223, v220, v25, v59
v_pk_mul_f32 v[52:53], v[26:27], v[78:79] op_sel_hi:[0,1]
v_pk_mul_f32 v[54:55], v[26:27], v[94:95] op_sel_hi:[0,1] neg_lo:[1,0] neg_hi:[1,0]
v_mul_f32 v58, v223, v25
v_mul_f32 v59, v223, v24
v_pk_fma_f32 v[54:55], v[26:27], v[78:79], v[54:55] op_sel:[1,0,0] neg_lo:[1,0,0] neg_hi:[1,0,0]
v_pk_fma_f32 v[78:79], v[26:27], v[94:95], v[52:53] op_sel:[1,0,0] neg_lo:[1,0,0] neg_hi:[1,0,0]
v_mov_b64 v[94:95], v[54:55]
v_fma_f32 v224, v222, v24, -v58
v_fma_f32 v225, v222, v25, v59
v_pk_mul_f32 v[52:53], v[26:27], v[96:97] op_sel_hi:[0,1]
v_pk_mul_f32 v[54:55], v[26:27], v[112:113] op_sel_hi:[0,1] neg_lo:[1,0] neg_hi:[1,0]
v_mul_f32 v58, v225, v25
v_mul_f32 v59, v225, v24
v_pk_fma_f32 v[54:55], v[26:27], v[96:97], v[54:55] op_sel:[1,0,0] neg_lo:[1,0,0] neg_hi:[1,0,0]
v_pk_fma_f32 v[96:97], v[26:27], v[112:113], v[52:53] op_sel:[1,0,0] neg_lo:[1,0,0] neg_hi:[1,0,0]
v_mov_b64 v[112:113], v[54:55]
v_fma_f32 v226, v224, v24, -v58
v_fma_f32 v227, v224, v25, v59
v_pk_mul_f32 v[52:53], v[26:27], v[98:99] op_sel_hi:[0,1]
v_pk_mul_f32 v[54:55], v[26:27], v[114:115] op_sel_hi:[0,1] neg_lo:[1,0] neg_hi:[1,0]
v_mul_f32 v58, v227, v25
v_mul_f32 v59, v227, v24
v_pk_fma_f32 v[54:55], v[26:27], v[98:99], v[54:55] op_sel:[1,0,0] neg_lo:[1,0,0] neg_hi:[1,0,0]
v_pk_fma_f32 v[98:99], v[26:27], v[114:115], v[52:53] op_sel:[1,0,0] neg_lo:[1,0,0] neg_hi:[1,0,0]
v_mov_b64 v[114:115], v[54:55]
v_fma_f32 v228, v226, v24, -v58
v_fma_f32 v229, v226, v25, v59
v_pk_mul_f32 v[52:53], v[26:27], v[100:101] op_sel_hi:[0,1]
v_pk_mul_f32 v[54:55], v[26:27], v[116:117] op_sel_hi:[0,1] neg_lo:[1,0] neg_hi:[1,0]
v_mul_f32 v58, v229, v25
v_mul_f32 v59, v229, v24
v_pk_fma_f32 v[54:55], v[26:27], v[100:101], v[54:55] op_sel:[1,0,0] neg_lo:[1,0,0] neg_hi:[1,0,0]
v_pk_fma_f32 v[100:101], v[26:27], v[116:117], v[52:53] op_sel:[1,0,0] neg_lo:[1,0,0] neg_hi:[1,0,0]
v_mov_b64 v[116:117], v[54:55]
v_fma_f32 v230, v228, v24, -v58
v_fma_f32 v231, v228, v25, v59
v_pk_mul_f32 v[52:53], v[26:27], v[102:103] op_sel_hi:[0,1]
v_pk_mul_f32 v[54:55], v[26:27], v[118:119] op_sel_hi:[0,1] neg_lo:[1,0] neg_hi:[1,0]
v_mul_f32 v58, v231, v25
v_mul_f32 v59, v231, v24
v_pk_fma_f32 v[54:55], v[26:27], v[102:103], v[54:55] op_sel:[1,0,0] neg_lo:[1,0,0] neg_hi:[1,0,0]
v_pk_fma_f32 v[102:103], v[26:27], v[118:119], v[52:53] op_sel:[1,0,0] neg_lo:[1,0,0] neg_hi:[1,0,0]
v_mov_b64 v[118:119], v[54:55]
v_fma_f32 v232, v230, v24, -v58
v_fma_f32 v233, v230, v25, v59
v_pk_mul_f32 v[52:53], v[26:27], v[104:105] op_sel_hi:[0,1]
v_pk_mul_f32 v[54:55], v[26:27], v[120:121] op_sel_hi:[0,1] neg_lo:[1,0] neg_hi:[1,0]
v_mul_f32 v58, v233, v25
v_mul_f32 v59, v233, v24
v_pk_fma_f32 v[54:55], v[26:27], v[104:105], v[54:55] op_sel:[1,0,0] neg_lo:[1,0,0] neg_hi:[1,0,0]
v_pk_fma_f32 v[104:105], v[26:27], v[120:121], v[52:53] op_sel:[1,0,0] neg_lo:[1,0,0] neg_hi:[1,0,0]
v_mov_b64 v[120:121], v[54:55]
v_fma_f32 v234, v232, v24, -v58
v_fma_f32 v235, v232, v25, v59
v_pk_mul_f32 v[52:53], v[26:27], v[106:107] op_sel_hi:[0,1]
v_pk_mul_f32 v[54:55], v[26:27], v[122:123] op_sel_hi:[0,1] neg_lo:[1,0] neg_hi:[1,0]
v_mul_f32 v58, v235, v25
v_mul_f32 v59, v235, v24
v_pk_fma_f32 v[54:55], v[26:27], v[106:107], v[54:55] op_sel:[1,0,0] neg_lo:[1,0,0] neg_hi:[1,0,0]
v_pk_fma_f32 v[106:107], v[26:27], v[122:123], v[52:53] op_sel:[1,0,0] neg_lo:[1,0,0] neg_hi:[1,0,0]
v_mov_b64 v[122:123], v[54:55]
v_fma_f32 v236, v234, v24, -v58
v_fma_f32 v237, v234, v25, v59
v_pk_mul_f32 v[52:53], v[26:27], v[108:109] op_sel_hi:[0,1]
v_pk_mul_f32 v[54:55], v[26:27], v[124:125] op_sel_hi:[0,1] neg_lo:[1,0] neg_hi:[1,0]
v_mul_f32 v58, v237, v25
v_mul_f32 v59, v237, v24
v_pk_fma_f32 v[54:55], v[26:27], v[108:109], v[54:55] op_sel:[1,0,0] neg_lo:[1,0,0] neg_hi:[1,0,0]
v_pk_fma_f32 v[108:109], v[26:27], v[124:125], v[52:53] op_sel:[1,0,0] neg_lo:[1,0,0] neg_hi:[1,0,0]
v_mov_b64 v[124:125], v[54:55]
v_fma_f32 v238, v236, v24, -v58
v_fma_f32 v239, v236, v25, v59
v_pk_mul_f32 v[52:53], v[26:27], v[110:111] op_sel_hi:[0,1]
v_pk_mul_f32 v[54:55], v[26:27], v[126:127] op_sel_hi:[0,1] neg_lo:[1,0] neg_hi:[1,0]
v_mov_b32 v56, v110
v_mov_b32 v57, v126
v_pk_fma_f32 v[54:55], v[26:27], v[110:111], v[54:55] op_sel:[1,0,0] neg_lo:[1,0,0] neg_hi:[1,0,0]
v_pk_fma_f32 v[110:111], v[26:27], v[126:127], v[52:53] op_sel:[1,0,0] neg_lo:[1,0,0] neg_hi:[1,0,0]
v_mov_b64 v[126:127], v[54:55]
buffer_load_dwordx4 v[160:163], v128, s[40:43], 0 offen sc1
buffer_load_dwordx4 v[164:167], v129, s[40:43], 0 offen sc1
buffer_load_dwordx4 v[168:171], v130, s[40:43], 0 offen sc1
buffer_load_dwordx4 v[172:175], v131, s[40:43], 0 offen sc1
buffer_load_dwordx4 v[176:179], v132, s[40:43], 0 offen sc1
buffer_load_dwordx4 v[180:183], v133, s[40:43], 0 offen sc1
buffer_load_dwordx4 v[184:187], v134, s[40:43], 0 offen sc1
buffer_load_dwordx4 v[188:191], v135, s[40:43], 0 offen sc1
global_load_dword v63, v62, s[32:33] sc1
s_xor_b32 s60, s68, s101
s_xor_b32 s60, s60, 1
s_lshl_b32 s60, s60, 6
s_add_u32 s60, s60, s66
v_lshrrev_b32 v8, 3, v1
v_lshl_add_u32 v8, v8, 1, s60
v_lshlrev_b32 v8, 11, v8
v_and_b32 v9, 7, v1
v_lshrrev_b32 v10, 4, v1
v_xor_b32 v9, v9, v10
v_lshlrev_b32 v9, 4, v9
v_xor_b32 v10, 64, v9
v_add_u32 v244, v8, v9
v_add_u32 v245, v8, v10
v_add_u32 v245, 31744, v245
v_add_u32 v246, v8, v9
v_add_u32 v246, 63488, v246
v_add_u32 v247, v8, v10
v_add_u32 v247, 95232, v247
s_and_b32 s64, s36, 7
s_lshl_b32 s60, s64, 18
s_lshl_b32 s61, s101, 10
s_add_u32 s60, s60, s61
s_add_u32 s48, s20, s60
s_addc_u32 s49, s21, 0
s_sub_u32 s50, 262144, s61
s_mov_b32 s51, 0x20000
s_add_u32 s52, s22, s60
s_addc_u32 s53, s23, 0
s_sub_u32 s54, 262144, s61
s_mov_b32 s55, 0x20000
s_lshl_b32 s61, s64, 1
s_add_u32 s61, s61, s101
s_lshl_b32 s61, s61, 7
s_lshl_b32 s63, s35, 1
s_add_u32 s63, s63, s68
s_lshl_b32 s60, s63, 17
s_add_u32 s60, s60, s61
s_add_u32 s56, s10, s60
s_addc_u32 s57, s11, 0
s_sub_u32 s58, 131072, s61
s_mov_b32 s59, 0x20000
s_add_u32 s26, s26, s61
s_addc_u32 s27, s27, 0
s_lshl_b32 s61, s61, 1
s_add_u32 s61, s61, 4096
s_lshl_b32 s60, s63, 19
s_add_u32 s60, s60, s61
s_add_u32 s28, s28, s60
s_addc_u32 s29, s29, 0
s_sub_u32 s24, 0x80000, s61
s_lshl_b32 s67, s34, 12
s_lshl_b32 s65, s64, 13
s_lshl_b32 s64, s64, 7
s_lshl_b32 s60, s68, 14
s_lshl_b32 s61, s66, 11
s_add_u32 s60, s60, s61
s_add_u32 s60, s60, 65536
v_add_u32 v16, s60, v11
s_lshl_b32 s60, s34, 13
s_add_u32 s60, s60, 65536
v_add_u32 v17, s60, v11
s_mov_b32 s69, 0
L_poll44:
s_mov_b64 s[60:61], 0
s_waitcnt vmcnt(8)
v_cmp_ne_u32 vcc, v162, v136
s_nop 0
s_or_b64 s[60:61], s[60:61], vcc
v_cmp_ne_u32 vcc, v163, v136
s_nop 0
s_or_b64 s[60:61], s[60:61], vcc
s_waitcnt vmcnt(7)
v_cmp_ne_u32 vcc, v166, v137
s_nop 0
s_or_b64 s[60:61], s[60:61], vcc
v_cmp_ne_u32 vcc, v167, v137
s_nop 0
s_or_b64 s[60:61], s[60:61], vcc
s_waitcnt vmcnt(6)
v_cmp_ne_u32 vcc, v170, v138
s_nop 0
s_or_b64 s[60:61], s[60:61], vcc
v_cmp_ne_u32 vcc, v171, v138
s_nop 0
s_or_b64 s[60:61], s[60:61], vcc
s_waitcnt vmcnt(5)
v_cmp_ne_u32 vcc, v174, v139
s_nop 0
s_or_b64 s[60:61], s[60:61], vcc
v_cmp_ne_u32 vcc, v175, v139
s_nop 0
s_or_b64 s[60:61], s[60:61], vcc
s_waitcnt vmcnt(4)
v_cmp_ne_u32 vcc, v178, v140
s_nop 0
s_or_b64 s[60:61], s[60:61], vcc
v_cmp_ne_u32 vcc, v179, v140
s_nop 0
s_or_b64 s[60:61], s[60:61], vcc
s_waitcnt vmcnt(3)
v_cmp_ne_u32 vcc, v182, v141
s_nop 0
s_or_b64 s[60:61], s[60:61], vcc
v_cmp_ne_u32 vcc, v183, v141
s_nop 0
s_or_b64 s[60:61], s[60:61], vcc
s_waitcnt vmcnt(2)
v_cmp_ne_u32 vcc, v186, v142
s_nop 0
s_or_b64 s[60:61], s[60:61], vcc
v_cmp_ne_u32 vcc, v187, v142
s_nop 0
s_or_b64 s[60:61], s[60:61], vcc
s_waitcnt vmcnt(1)
v_cmp_ne_u32 vcc, v190, v143
s_nop 0
s_or_b64 s[60:61], s[60:61], vcc
v_cmp_ne_u32 vcc, v191, v143
s_nop 0
s_or_b64 s[60:61], s[60:61], vcc
s_waitcnt vmcnt(0)
v_xor_b32 v63, v60, v63
v_cmp_lt_u32 vcc, 15, v63
s_nop 0
s_or_b64 s[60:61], s[60:61], vcc
s_add_u32 s69, s69, 1
s_cmp_eq_u64 s[60:61], 0
s_cbranch_scc1 L_polled45
s_cmp_ge_u32 s69, 200000
s_cbranch_scc1 L_polled45
buffer_load_dwordx4 v[160:163], v128, s[40:43], 0 offen sc1
buffer_load_dwordx4 v[164:167], v129, s[40:43], 0 offen sc1
buffer_load_dwordx4 v[168:171], v130, s[40:43], 0 offen sc1
buffer_load_dwordx4 v[172:175], v131, s[40:43], 0 offen sc1
buffer_load_dwordx4 v[176:179], v132, s[40:43], 0 offen sc1
buffer_load_dwordx4 v[180:183], v133, s[40:43], 0 offen sc1
buffer_load_dwordx4 v[184:187], v134, s[40:43], 0 offen sc1
buffer_load_dwordx4 v[188:191], v135, s[40:43], 0 offen sc1
global_load_dword v63, v62, s[32:33] sc1
s_branch L_poll44
L_polled45:
v_cmp_ne_u32 vcc, 0, v63
s_nop 0
s_cmp_eq_u64 vcc, 0
s_cselect_b32 s100, 1, 0
v_mov_b32 v12, 126976
s_lshl_b32 s60, s34, 2
v_add_u32 v13, s60, v12
v_mov_b32 v14, 1
s_mov_b64 exec, 1
ds_write_b32 v13, v14
s_mov_b64 exec, -1
s_add_u32 m0, s67, 0
s_add_u32 s62, s64, 0
s_and_b32 s62, s62, 0x3ff
buffer_load_dwordx4 v244, s[48:51], s62 offen offset:0 lds
buffer_load_dwordx4 v245, s[48:51], s62 offen offset:1024 lds
buffer_load_dwordx4 v246, s[48:51], s62 offen offset:2048 lds
buffer_load_dwordx4 v247, s[48:51], s62 offen offset:3072 lds
s_add_u32 m0, s67, 16384
s_nop 0
buffer_load_dwordx4 v244, s[52:55], s62 offen offset:0 lds
buffer_load_dwordx4 v245, s[52:55], s62 offen offset:1024 lds
buffer_load_dwordx4 v246, s[52:55], s62 offen offset:2048 lds
buffer_load_dwordx4 v247, s[52:55], s62 offen offset:3072 lds
v_fma_f32 v40, v2, v188, v184
v_fma_f32 v41, v2, v189, v185
v_fma_f32 v48, -v3, v189, v40
v_fma_f32 v49, v3, v188, v41
v_fma_f32 v40, v2, v48, v180
v_fma_f32 v41, v2, v49, v181
v_fma_f32 v188, -v3, v49, v40
v_fma_f32 v189, v3, v48, v41
v_fma_f32 v40, v2, v188, v176
v_fma_f32 v41, v2, v189, v177
v_fma_f32 v48, -v3, v189, v40
v_fma_f32 v49, v3, v188, v41
v_fma_f32 v40, v2, v48, v172
v_fma_f32 v41, v2, v49, v173
v_fma_f32 v188, -v3, v49, v40
v_fma_f32 v189, v3, v48, v41
v_fma_f32 v40, v2, v188, v168
v_fma_f32 v41, v2, v189, v169
v_fma_f32 v48, -v3, v189, v40
v_fma_f32 v49, v3, v188, v41
v_fma_f32 v40, v2, v48, v164
v_fma_f32 v41, v2, v49, v165
v_fma_f32 v188, -v3, v49, v40
v_fma_f32 v189, v3, v48, v41
v_fma_f32 v40, v2, v188, v160
v_fma_f32 v41, v2, v189, v161
v_fma_f32 v48, -v3, v189, v40
v_fma_f32 v49, v3, v188, v41
v_mov_b32 v50, v48
v_mov_b32 v51, v49
s_nop 0
v_permlane32_swap_b32 v48, v50
v_permlane32_swap_b32 v49, v51
v_fma_f32 v40, v30, v50, v48
v_fma_f32 v41, v30, v51, v49
v_fma_f32 v192, -v31, v51, v40
v_fma_f32 v193, v31, v50, v41
v_fma_f32 v40, v20, v192, v144
v_fma_f32 v41, v20, v193, v145
v_fma_f32 v194, -v21, v193, v40
v_fma_f32 v195, v21, v192, v41
v_fma_f32 v40, v20, v194, v146
v_fma_f32 v41, v20, v195, v147
v_fma_f32 v196, -v21, v195, v40
v_fma_f32 v197, v21, v194, v41
v_fma_f32 v40, v20, v196, v148
v_fma_f32 v41, v20, v197, v149
v_fma_f32 v198, -v21, v197, v40
v_fma_f32 v199, v21, v196, v41
s_cmp_eq_u32 s68, 0
s_cbranch_scc1 L_wt046
v_mov_b64 v[192:193], v[196:197]
v_mov_b64 v[194:195], v[198:199]
L_wt046:
v_cmp_eq_u32 vcc, 1, v5
s_nop 1
v_cndmask_b32 v48, v192, v194, vcc
v_cndmask_b32 v50, v193, v195, vcc
v_fma_f32 v40, v28, v48, v56
v_fma_f32 v41, v28, v50, v57
v_fma_f32 v49, -v29, v50, v40
v_fma_f32 v51, v29, v48, v41
s_lshl_b32 s60, s35, 1
s_add_u32 s69, s60, s68
s_mul_i32 s60, s69, 262144
s_lshl_b32 s61, s36, 13
s_add_u32 s60, s60, s61
s_lshl_b32 s61, s66, 11
s_add_u32 s60, s60, s61
v_xor_b32 v20, 0, v7
v_add_u32 v24, 0x10000, v20
v_xor_b32 v21, 32, v7
v_add_u32 v25, 0x10000, v21
v_xor_b32 v22, 64, v7
v_add_u32 v26, 0x10000, v22
v_xor_b32 v23, 96, v7
v_add_u32 v27, 0x10000, v23
v_pk_fma_f32 v[64:65], v[208:209], v[48:49], v[64:65] op_sel_hi:[0,1,1]
v_pk_fma_f32 v[80:81], v[208:209], v[50:51], v[80:81] op_sel_hi:[0,1,1] neg_lo:[1,0,0] neg_hi:[1,0,0]
v_pk_fma_f32 v[64:65], v[208:209], v[50:51], v[64:65] op_sel:[1,0,0] neg_lo:[1,0,0] neg_hi:[1,0,0]
v_pk_fma_f32 v[80:81], v[208:209], v[48:49], v[80:81] op_sel:[1,0,0] neg_lo:[1,0,0] neg_hi:[1,0,0]
v_cvt_pk_bf16_f32 v128, v64, v65
v_cvt_pk_bf16_f32 v144, v80, v81
v_pk_fma_f32 v[66:67], v[210:211], v[48:49], v[66:67] op_sel_hi:[0,1,1]
v_pk_fma_f32 v[82:83], v[210:211], v[50:51], v[82:83] op_sel_hi:[0,1,1] neg_lo:[1,0,0] neg_hi:[1,0,0]
v_pk_fma_f32 v[66:67], v[210:211], v[50:51], v[66:67] op_sel:[1,0,0] neg_lo:[1,0,0] neg_hi:[1,0,0]
v_pk_fma_f32 v[82:83], v[210:211], v[48:49], v[82:83] op_sel:[1,0,0] neg_lo:[1,0,0] neg_hi:[1,0,0]
v_cvt_pk_bf16_f32 v129, v66, v67
v_cvt_pk_bf16_f32 v145, v82, v83
v_pk_fma_f32 v[68:69], v[212:213], v[48:49], v[68:69] op_sel_hi:[0,1,1]
v_pk_fma_f32 v[84:85], v[212:213], v[50:51], v[84:85] op_sel_hi:[0,1,1] neg_lo:[1,0,0] neg_hi:[1,0,0]
v_pk_fma_f32 v[68:69], v[212:213], v[50:51], v[68:69] op_sel:[1,0,0] neg_lo:[1,0,0] neg_hi:[1,0,0]
v_pk_fma_f32 v[84:85], v[212:213], v[48:49], v[84:85] op_sel:[1,0,0] neg_lo:[1,0,0] neg_hi:[1,0,0]
v_cvt_pk_bf16_f32 v130, v68, v69
v_cvt_pk_bf16_f32 v146, v84, v85
v_pk_fma_f32 v[70:71], v[214:215], v[48:49], v[70:71] op_sel_hi:[0,1,1]
v_pk_fma_f32 v[86:87], v[214:215], v[50:51], v[86:87] op_sel_hi:[0,1,1] neg_lo:[1,0,0] neg_hi:[1,0,0]
v_pk_fma_f32 v[70:71], v[214:215], v[50:51], v[70:71] op_sel:[1,0,0] neg_lo:[1,0,0] neg_hi:[1,0,0]
v_pk_fma_f32 v[86:87], v[214:215], v[48:49], v[86:87] op_sel:[1,0,0] neg_lo:[1,0,0] neg_hi:[1,0,0]
v_cvt_pk_bf16_f32 v131, v70, v71
v_cvt_pk_bf16_f32 v147, v86, v87
v_pk_fma_f32 v[72:73], v[216:217], v[48:49], v[72:73] op_sel_hi:[0,1,1]
v_pk_fma_f32 v[88:89], v[216:217], v[50:51], v[88:89] op_sel_hi:[0,1,1] neg_lo:[1,0,0] neg_hi:[1,0,0]
v_pk_fma_f32 v[72:73], v[216:217], v[50:51], v[72:73] op_sel:[1,0,0] neg_lo:[1,0,0] neg_hi:[1,0,0]
v_pk_fma_f32 v[88:89], v[216:217], v[48:49], v[88:89] op_sel:[1,0,0] neg_lo:[1,0,0] neg_hi:[1,0,0]
v_cvt_pk_bf16_f32 v132, v72, v73
v_cvt_pk_bf16_f32 v148, v88, v89
v_pk_fma_f32 v[74:75], v[218:219], v[48:49], v[74:75] op_sel_hi:[0,1,1]
v_pk_fma_f32 v[90:91], v[218:219], v[50:51], v[90:91] op_sel_hi:[0,1,1] neg_lo:[1,0,0] neg_hi:[1,0,0]
v_pk_fma_f32 v[74:75], v[218:219], v[50:51], v[74:75] op_sel:[1,0,0] neg_lo:[1,0,0] neg_hi:[1,0,0]
v_pk_fma_f32 v[90:91], v[218:219], v[48:49], v[90:91] op_sel:[1,0,0] neg_lo:[1,0,0] neg_hi:[1,0,0]
v_cvt_pk_bf16_f32 v133, v74, v75
v_cvt_pk_bf16_f32 v149, v90, v91
v_pk_fma_f32 v[76:77], v[220:221], v[48:49], v[76:77] op_sel_hi:[0,1,1]
v_pk_fma_f32 v[92:93], v[220:221], v[50:51], v[92:93] op_sel_hi:[0,1,1] neg_lo:[1,0,0] neg_hi:[1,0,0]
v_pk_fma_f32 v[76:77], v[220:221], v[50:51], v[76:77] op_sel:[1,0,0] neg_lo:[1,0,0] neg_hi:[1,0,0]
v_pk_fma_f32 v[92:93], v[220:221], v[48:49], v[92:93] op_sel:[1,0,0] neg_lo:[1,0,0] neg_hi:[1,0,0]
v_cvt_pk_bf16_f32 v134, v76, v77
v_cvt_pk_bf16_f32 v150, v92, v93
v_pk_fma_f32 v[78:79], v[222:223], v[48:49], v[78:79] op_sel_hi:[0,1,1]
v_pk_fma_f32 v[94:95], v[222:223], v[50:51], v[94:95] op_sel_hi:[0,1,1] neg_lo:[1,0,0] neg_hi:[1,0,0]
v_pk_fma_f32 v[78:79], v[222:223], v[50:51], v[78:79] op_sel:[1,0,0] neg_lo:[1,0,0] neg_hi:[1,0,0]
v_pk_fma_f32 v[94:95], v[222:223], v[48:49], v[94:95] op_sel:[1,0,0] neg_lo:[1,0,0] neg_hi:[1,0,0]
v_cvt_pk_bf16_f32 v135, v78, v79
v_cvt_pk_bf16_f32 v151, v94, v95
v_mfma_f32_32x32x16_bf16 v[160:175], v[128:131], v[248:251], 0
v_mfma_f32_32x32x16_bf16 v[160:175], v[132:135], v[252:255], v[160:175]
v_mfma_f32_32x32x16_bf16 v[176:191], v[144:147], v[248:251], 0
v_mfma_f32_32x32x16_bf16 v[176:191], v[148:151], v[252:255], v[176:191]
v_pk_fma_f32 v[96:97], v[224:225], v[48:49], v[96:97] op_sel_hi:[0,1,1]
v_pk_fma_f32 v[112:113], v[224:225], v[50:51], v[112:113] op_sel_hi:[0,1,1] neg_lo:[1,0,0] neg_hi:[1,0,0]
v_pk_fma_f32 v[96:97], v[224:225], v[50:51], v[96:97] op_sel:[1,0,0] neg_lo:[1,0,0] neg_hi:[1,0,0]
v_pk_fma_f32 v[112:113], v[224:225], v[48:49], v[112:113] op_sel:[1,0,0] neg_lo:[1,0,0] neg_hi:[1,0,0]
v_cvt_pk_bf16_f32 v136, v96, v97
v_cvt_pk_bf16_f32 v152, v112, v113
v_pk_fma_f32 v[98:99], v[226:227], v[48:49], v[98:99] op_sel_hi:[0,1,1]
v_pk_fma_f32 v[114:115], v[226:227], v[50:51], v[114:115] op_sel_hi:[0,1,1] neg_lo:[1,0,0] neg_hi:[1,0,0]
v_pk_fma_f32 v[98:99], v[226:227], v[50:51], v[98:99] op_sel:[1,0,0] neg_lo:[1,0,0] neg_hi:[1,0,0]
v_pk_fma_f32 v[114:115], v[226:227], v[48:49], v[114:115] op_sel:[1,0,0] neg_lo:[1,0,0] neg_hi:[1,0,0]
v_cvt_pk_bf16_f32 v137, v98, v99
v_cvt_pk_bf16_f32 v153, v114, v115
v_pk_fma_f32 v[100:101], v[228:229], v[48:49], v[100:101] op_sel_hi:[0,1,1]
v_pk_fma_f32 v[116:117], v[228:229], v[50:51], v[116:117] op_sel_hi:[0,1,1] neg_lo:[1,0,0] neg_hi:[1,0,0]
v_pk_fma_f32 v[100:101], v[228:229], v[50:51], v[100:101] op_sel:[1,0,0] neg_lo:[1,0,0] neg_hi:[1,0,0]
v_pk_fma_f32 v[116:117], v[228:229], v[48:49], v[116:117] op_sel:[1,0,0] neg_lo:[1,0,0] neg_hi:[1,0,0]
v_cvt_pk_bf16_f32 v138, v100, v101
v_cvt_pk_bf16_f32 v154, v116, v117
v_pk_fma_f32 v[102:103], v[230:231], v[48:49], v[102:103] op_sel_hi:[0,1,1]
v_pk_fma_f32 v[118:119], v[230:231], v[50:51], v[118:119] op_sel_hi:[0,1,1] neg_lo:[1,0,0] neg_hi:[1,0,0]
v_pk_fma_f32 v[102:103], v[230:231], v[50:51], v[102:103] op_sel:[1,0,0] neg_lo:[1,0,0] neg_hi:[1,0,0]
v_pk_fma_f32 v[118:119], v[230:231], v[48:49], v[118:119] op_sel:[1,0,0] neg_lo:[1,0,0] neg_hi:[1,0,0]
v_cvt_pk_bf16_f32 v139, v102, v103
v_cvt_pk_bf16_f32 v155, v118, v119
s_add_u32 s61, s60, 0
v_cvt_pk_bf16_f32 v64, v160, v161
v_cvt_pk_bf16_f32 v65, v162, v163
v_cvt_pk_bf16_f32 v66, v164, v165
v_cvt_pk_bf16_f32 v67, v166, v167
v_cvt_pk_bf16_f32 v68, v168, v169
v_cvt_pk_bf16_f32 v69, v170, v171
v_cvt_pk_bf16_f32 v70, v172, v173
v_cvt_pk_bf16_f32 v71, v174, v175
buffer_store_dwordx4 v[64:67], v11, s[44:47], s61 offen sc1
buffer_store_dwordx4 v[68:71], v11, s[44:47], s61 offen offset:1024 sc1
ds_write_b128 v16, v[64:67] offset:0
ds_write_b128 v16, v[68:71] offset:1024
s_add_u32 s61, s60, 4096
v_cvt_pk_bf16_f32 v72, v176, v177
v_cvt_pk_bf16_f32 v73, v178, v179
v_cvt_pk_bf16_f32 v74, v180, v181
v_cvt_pk_bf16_f32 v75, v182, v183
v_cvt_pk_bf16_f32 v76, v184, v185
v_cvt_pk_bf16_f32 v77, v186, v187
v_cvt_pk_bf16_f32 v78, v188, v189
v_cvt_pk_bf16_f32 v79, v190, v191
buffer_store_dwordx4 v[72:75], v11, s[44:47], s61 offen sc1
buffer_store_dwordx4 v[76:79], v11, s[44:47], s61 offen offset:1024 sc1
ds_write_b128 v16, v[72:75] offset:4096
ds_write_b128 v16, v[76:79] offset:5120
v_pk_fma_f32 v[104:105], v[232:233], v[48:49], v[104:105] op_sel_hi:[0,1,1]
v_pk_fma_f32 v[120:121], v[232:233], v[50:51], v[120:121] op_sel_hi:[0,1,1] neg_lo:[1,0,0] neg_hi:[1,0,0]
v_pk_fma_f32 v[104:105], v[232:233], v[50:51], v[104:105] op_sel:[1,0,0] neg_lo:[1,0,0] neg_hi:[1,0,0]
v_pk_fma_f32 v[120:121], v[232:233], v[48:49], v[120:121] op_sel:[1,0,0] neg_lo:[1,0,0] neg_hi:[1,0,0]
v_cvt_pk_bf16_f32 v140, v104, v105
v_cvt_pk_bf16_f32 v156, v120, v121
v_pk_fma_f32 v[106:107], v[234:235], v[48:49], v[106:107] op_sel_hi:[0,1,1]
v_pk_fma_f32 v[122:123], v[234:235], v[50:51], v[122:123] op_sel_hi:[0,1,1] neg_lo:[1,0,0] neg_hi:[1,0,0]
v_pk_fma_f32 v[106:107], v[234:235], v[50:51], v[106:107] op_sel:[1,0,0] neg_lo:[1,0,0] neg_hi:[1,0,0]
v_pk_fma_f32 v[122:123], v[234:235], v[48:49], v[122:123] op_sel:[1,0,0] neg_lo:[1,0,0] neg_hi:[1,0,0]
v_cvt_pk_bf16_f32 v141, v106, v107
v_cvt_pk_bf16_f32 v157, v122, v123
v_pk_fma_f32 v[108:109], v[236:237], v[48:49], v[108:109] op_sel_hi:[0,1,1]
v_pk_fma_f32 v[124:125], v[236:237], v[50:51], v[124:125] op_sel_hi:[0,1,1] neg_lo:[1,0,0] neg_hi:[1,0,0]
v_pk_fma_f32 v[108:109], v[236:237], v[50:51], v[108:109] op_sel:[1,0,0] neg_lo:[1,0,0] neg_hi:[1,0,0]
v_pk_fma_f32 v[124:125], v[236:237], v[48:49], v[124:125] op_sel:[1,0,0] neg_lo:[1,0,0] neg_hi:[1,0,0]
v_cvt_pk_bf16_f32 v142, v108, v109
v_cvt_pk_bf16_f32 v158, v124, v125
v_pk_fma_f32 v[110:111], v[238:239], v[48:49], v[110:111] op_sel_hi:[0,1,1]
v_pk_fma_f32 v[126:127], v[238:239], v[50:51], v[126:127] op_sel_hi:[0,1,1] neg_lo:[1,0,0] neg_hi:[1,0,0]
v_pk_fma_f32 v[110:111], v[238:239], v[50:51], v[110:111] op_sel:[1,0,0] neg_lo:[1,0,0] neg_hi:[1,0,0]
v_pk_fma_f32 v[126:127], v[238:239], v[48:49], v[126:127] op_sel:[1,0,0] neg_lo:[1,0,0] neg_hi:[1,0,0]
v_cvt_pk_bf16_f32 v143, v110, v111
v_cvt_pk_bf16_f32 v159, v126, v127
v_mfma_f32_32x32x16_bf16 v[192:207], v[136:139], v[248:251], 0
v_mfma_f32_32x32x16_bf16 v[192:207], v[140:143], v[252:255], v[192:207]
v_mfma_f32_32x32x16_bf16 v[32:47], v[152:155], v[248:251], 0
v_mfma_f32_32x32x16_bf16 v[32:47], v[156:159], v[252:255], v[32:47]
s_add_u32 s61, s60, 131072
s_nop 8
v_cvt_pk_bf16_f32 v80, v192, v193
v_cvt_pk_bf16_f32 v81, v194, v195
v_cvt_pk_bf16_f32 v82, v196, v197
v_cvt_pk_bf16_f32 v83, v198, v199
v_cvt_pk_bf16_f32 v84, v200, v201
v_cvt_pk_bf16_f32 v85, v202, v203
v_cvt_pk_bf16_f32 v86, v204, v205
v_cvt_pk_bf16_f32 v87, v206, v207
buffer_store_dwordx4 v[80:83], v11, s[44:47], s61 offen sc1
buffer_store_dwordx4 v[84:87], v11, s[44:47], s61 offen offset:1024 sc1
ds_write_b128 v16, v[80:83] offset:8192
ds_write_b128 v16, v[84:87] offset:9216
s_add_u32 s61, s60, 135168
v_cvt_pk_bf16_f32 v88, v32, v33
v_cvt_pk_bf16_f32 v89, v34, v35
v_cvt_pk_bf16_f32 v90, v36, v37
v_cvt_pk_bf16_f32 v91, v38, v39
v_cvt_pk_bf16_f32 v92, v40, v41
v_cvt_pk_bf16_f32 v93, v42, v43
v_cvt_pk_bf16_f32 v94, v44, v45
v_cvt_pk_bf16_f32 v95, v46, v47
buffer_store_dwordx4 v[88:91], v11, s[44:47], s61 offen sc1
buffer_store_dwordx4 v[92:95], v11, s[44:47], s61 offen offset:1024 sc1
ds_write_b128 v16, v[88:91] offset:12288
ds_write_b128 v16, v[92:95] offset:13312
s_lshl_b32 s90, s101, 10
s_bfe_u32 s92, s2, 0x20001
s_lshl_b32 s92, s92, 19
s_add_u32 s90, s90, s92
s_lshr_b32 s92, s2, 3
s_lshl_b32 s92, s92, 14
s_add_u32 s90, s90, s92
s_lshl_b32 s92, s68, 13
s_add_u32 s92, s90, s92
v_bfe_u32 v8, v1, 3, 2
v_lshlrev_b32 v8, 11, v8
v_and_b32 v9, 7, v1
v_lshl_add_u32 v8, v9, 7, v8
v_add_u32 v8, s92, v8
s_cmp_eq_u32 s66, 0
s_cselect_b32 s90, s20, s22
s_cselect_b32 s91, s21, s23
s_mov_b32 exec_hi, 0
global_load_dword v243, v8, s[90:91]
s_mov_b64 exec, -1
v_mov_b32 v2, v11
s_lshl_b32 s60, s35, 2
s_add_u32 s60, s60, s34
s_mul_i32 s60, s60, 131072
s_lshl_b32 s61, s101, 16
s_add_u32 s60, s60, s61
s_add_u32 s42, s60, 1048576
s_add_u32 s40, s32, s42
s_addc_u32 s41, s33, 0
s_mov_b32 s42, 65536
s_mov_b32 s43, 0x20000
s_waitcnt vmcnt(9) lgkmcnt(0)
v_mov_b32 v14, 2
s_mov_b64 exec, 1
ds_write_b32 v13, v14
s_mov_b64 exec, -1
ds_read_b128 v[8:11], v12 offset:0
s_waitcnt lgkmcnt(0)
L_ck47:
v_min3_u32 v15, v8, v9, v10
v_min_u32 v15, v15, v11
s_nop 0
v_readfirstlane_b32 s60, v15
s_nop 0
s_cmp_ge_u32 s60, 2
s_cbranch_scc1 L_ckd48
ds_read_b128 v[8:11], v12 offset:0
s_waitcnt lgkmcnt(0)
s_branch L_ck47
L_ckd48:
ds_read_b128 v[148:151], v17 offset:0
ds_read_b128 v[152:155], v17 offset:1024
ds_read_b128 v[156:159], v17 offset:2048
ds_read_b128 v[160:163], v17 offset:3072
ds_read_b128 v[164:167], v17 offset:4096
ds_read_b128 v[168:171], v17 offset:5120
ds_read_b128 v[172:175], v17 offset:6144
ds_read_b128 v[176:179], v17 offset:7168
ds_read_b128 v[96:99], v20 offset:0
ds_read_b128 v[100:103], v20 offset:4096
ds_read_b128 v[104:107], v20 offset:8192
ds_read_b128 v[108:111], v20 offset:12288
s_waitcnt lgkmcnt(4)
v_mov_b32 v14, 3
s_mov_b64 exec, 1
ds_write_b32 v13, v14
s_mov_b64 exec, -1
s_waitcnt lgkmcnt(0)
v_mfma_f32_32x32x16_bf16 v[32:47], v[148:151], v[96:99], 0
ds_read_b128 v[112:115], v21 offset:0
ds_read_b128 v[116:119], v21 offset:4096
v_mfma_f32_32x32x16_bf16 v[48:63], v[148:151], v[100:103], 0
ds_read_b128 v[120:123], v21 offset:8192
ds_read_b128 v[124:127], v21 offset:12288
v_mfma_f32_32x32x16_bf16 v[64:79], v[148:151], v[104:107], 0
s_add_u32 m0, s67, 32768
s_add_u32 s62, s64, 128
s_and_b32 s62, s62, 0x3ff
buffer_load_dwordx4 v244, s[48:51], s62 offen offset:0 lds
v_mfma_f32_32x32x16_bf16 v[80:95], v[148:151], v[108:111], 0
s_waitcnt lgkmcnt(3)
v_mfma_f32_32x32x16_bf16 v[32:47], v[152:155], v[112:115], v[32:47]
ds_read_b128 v[96:99], v22 offset:0
ds_read_b128 v[100:103], v22 offset:4096
s_waitcnt lgkmcnt(4)
v_mfma_f32_32x32x16_bf16 v[48:63], v[152:155], v[116:119], v[48:63]
ds_read_b128 v[104:107], v22 offset:8192
ds_read_b128 v[108:111], v22 offset:12288
s_waitcnt lgkmcnt(5)
v_mfma_f32_32x32x16_bf16 v[64:79], v[152:155], v[120:123], v[64:79]
buffer_load_dwordx4 v245, s[48:51], s62 offen offset:1024 lds
s_waitcnt lgkmcnt(4)
v_mfma_f32_32x32x16_bf16 v[80:95], v[152:155], v[124:127], v[80:95]
s_waitcnt lgkmcnt(3)
v_mfma_f32_32x32x16_bf16 v[32:47], v[156:159], v[96:99], v[32:47]
ds_read_b128 v[112:115], v23 offset:0
ds_read_b128 v[116:119], v23 offset:4096
s_waitcnt lgkmcnt(4)
v_mfma_f32_32x32x16_bf16 v[48:63], v[156:159], v[100:103], v[48:63]
ds_read_b128 v[120:123], v23 offset:8192
ds_read_b128 v[124:127], v23 offset:12288
s_waitcnt lgkmcnt(5)
v_mfma_f32_32x32x16_bf16 v[64:79], v[156:159], v[104:107], v[64:79]
buffer_load_dwordx4 v246, s[48:51], s62 offen offset:2048 lds
s_waitcnt lgkmcnt(4)
v_mfma_f32_32x32x16_bf16 v[80:95], v[156:159], v[108:111], v[80:95]
s_waitcnt lgkmcnt(3)
v_mfma_f32_32x32x16_bf16 v[32:47], v[160:163], v[112:115], v[32:47]
ds_read_b128 v[96:99], v20 offset:16384
ds_read_b128 v[100:103], v20 offset:20480
s_waitcnt lgkmcnt(4)
v_mfma_f32_32x32x16_bf16 v[48:63], v[160:163], v[116:119], v[48:63]
ds_read_b128 v[104:107], v20 offset:24576
ds_read_b128 v[108:111], v20 offset:28672
s_waitcnt lgkmcnt(5)
v_mfma_f32_32x32x16_bf16 v[64:79], v[160:163], v[120:123], v[64:79]
buffer_load_dwordx4 v247, s[48:51], s62 offen offset:3072 lds
s_waitcnt lgkmcnt(4)
v_mfma_f32_32x32x16_bf16 v[80:95], v[160:163], v[124:127], v[80:95]
s_waitcnt lgkmcnt(3)
v_mfma_f32_32x32x16_bf16 v[32:47], v[164:167], v[96:99], v[32:47]
ds_read_b128 v[112:115], v21 offset:16384
ds_read_b128 v[116:119], v21 offset:20480
s_waitcnt lgkmcnt(4)
v_mfma_f32_32x32x16_bf16 v[48:63], v[164:167], v[100:103], v[48:63]
ds_read_b128 v[120:123], v21 offset:24576
ds_read_b128 v[124:127], v21 offset:28672
s_waitcnt lgkmcnt(5)
v_mfma_f32_32x32x16_bf16 v[64:79], v[164:167], v[104:107], v[64:79]
s_add_u32 m0, s67, 49152
s_nop 0
buffer_load_dwordx4 v244, s[52:55], s62 offen offset:0 lds
s_waitcnt lgkmcnt(4)
v_mfma_f32_32x32x16_bf16 v[80:95], v[164:167], v[108:111], v[80:95]
s_waitcnt lgkmcnt(3)
v_mfma_f32_32x32x16_bf16 v[32:47], v[168:171], v[112:115], v[32:47]
ds_read_b128 v[96:99], v22 offset:16384
ds_read_b128 v[100:103], v22 offset:20480
s_waitcnt lgkmcnt(4)
v_mfma_f32_32x32x16_bf16 v[48:63], v[168:171], v[116:119], v[48:63]
ds_read_b128 v[104:107], v22 offset:24576
ds_read_b128 v[108:111], v22 offset:28672
s_waitcnt lgkmcnt(5)
v_mfma_f32_32x32x16_bf16 v[64:79], v[168:171], v[120:123], v[64:79]
buffer_load_dwordx4 v245, s[52:55], s62 offen offset:1024 lds
s_waitcnt lgkmcnt(4)
v_mfma_f32_32x32x16_bf16 v[80:95], v[168:171], v[124:127], v[80:95]
s_waitcnt lgkmcnt(3)
v_mfma_f32_32x32x16_bf16 v[32:47], v[172:175], v[96:99], v[32:47]
ds_read_b128 v[112:115], v23 offset:16384
ds_read_b128 v[116:119], v23 offset:20480
s_waitcnt lgkmcnt(4)
v_mfma_f32_32x32x16_bf16 v[48:63], v[172:175], v[100:103], v[48:63]
ds_read_b128 v[120:123], v23 offset:24576
ds_read_b128 v[124:127], v23 offset:28672
s_waitcnt lgkmcnt(5)
v_mfma_f32_32x32x16_bf16 v[64:79], v[172:175], v[104:107], v[64:79]
buffer_load_dwordx4 v246, s[52:55], s62 offen offset:2048 lds
s_waitcnt lgkmcnt(4)
v_mfma_f32_32x32x16_bf16 v[80:95], v[172:175], v[108:111], v[80:95]
s_waitcnt lgkmcnt(0)
v_mfma_f32_32x32x16_bf16 v[32:47], v[176:179], v[112:115], v[32:47]
v_mfma_f32_32x32x16_bf16 v[48:63], v[176:179], v[116:119], v[48:63]
v_mfma_f32_32x32x16_bf16 v[64:79], v[176:179], v[120:123], v[64:79]
buffer_load_dwordx4 v247, s[52:55], s62 offen offset:3072 lds
v_mfma_f32_32x32x16_bf16 v[80:95], v[176:179], v[124:127], v[80:95]
s_lshl_b32 s60, s66, 3
v_lshl_add_u32 v17, v5, 2, s60
v_lshlrev_b32 v28, 11, v17
v_lshl_add_u32 v28, v6, 2, v28
v_lshlrev_b32 v29, 13, v17
v_lshl_add_u32 v29, v6, 3, v29
v_lshlrev_b32 v30, 2, v6
v_mov_b32 v15, s37
s_waitcnt vmcnt(9)
s_mov_b64 exec, 1
s_cmp_eq_u32 s100, 0
s_cbranch_scc1 L_rs49
global_store_dword v19, v15, s[32:33]
s_branch L_rd50
L_rs49:
global_store_dword v19, v15, s[32:33] sc1
L_rd50:
s_mov_b64 exec, -1
ds_read_b128 v[8:11], v12 offset:0
s_waitcnt lgkmcnt(0)
L_ck51:
v_min3_u32 v15, v8, v9, v10
v_min_u32 v15, v15, v11
s_nop 0
v_readfirstlane_b32 s60, v15
s_nop 0
s_cmp_ge_u32 s60, 3
s_cbranch_scc1 L_ckd52
ds_read_b128 v[8:11], v12 offset:0
s_waitcnt lgkmcnt(0)
s_branch L_ck51
L_ckd52:
ds_read_b128 v[8:11], v12 offset:16
s_waitcnt lgkmcnt(0)
L_ck53:
v_min3_u32 v15, v8, v9, v10
v_min_u32 v15, v15, v11
s_nop 0
v_readfirstlane_b32 s60, v15
s_nop 0
s_cmp_ge_u32 s60, 2
s_cbranch_scc1 L_ckd54
ds_read_b128 v[8:11], v12 offset:16
s_waitcnt lgkmcnt(0)
s_branch L_ck53
L_ckd54:
s_add_u32 m0, s67, 65536
s_add_u32 s62, s64, 256
s_and_b32 s62, s62, 0x3ff
buffer_load_dwordx4 v244, s[48:51], s62 offen offset:0 lds
buffer_load_dwordx4 v245, s[48:51], s62 offen offset:1024 lds
buffer_load_dwordx4 v246, s[48:51], s62 offen offset:2048 lds
buffer_load_dwordx4 v247, s[48:51], s62 offen offset:3072 lds
s_add_u32 m0, s67, 81920
s_nop 0
buffer_load_dwordx4 v244, s[52:55], s62 offen offset:0 lds
buffer_load_dwordx4 v245, s[52:55], s62 offen offset:1024 lds
buffer_load_dwordx4 v246, s[52:55], s62 offen offset:2048 lds
buffer_load_dwordx4 v247, s[52:55], s62 offen offset:3072 lds
s_mov_b32 s92, 0
L_w55:
global_load_dword v8, v18, s[32:33] sc1
s_waitcnt vmcnt(0)
v_cmp_ne_u32 vcc, s37, v8
s_nop 0
s_cbranch_vccz L_wd56
s_sleep 4
s_add_u32 s92, s92, 1
s_cmp_lt_u32 s92, 200000
s_cbranch_scc1 L_w55
L_wd56:
v_mov_b32 v14, 4
s_mov_b64 exec, 1
ds_write_b32 v13, v14
s_mov_b64 exec, -1
s_add_u32 s63, s65, 8192
s_and_b32 s63, s63, 0xffff
buffer_load_dwordx4 v[180:183], v2, s[40:43], s63 offen offset:0 sc1
buffer_load_dwordx4 v[184:187], v2, s[40:43], s63 offen offset:1024 sc1
buffer_load_dwordx4 v[188:191], v2, s[40:43], s63 offen offset:2048 sc1
buffer_load_dwordx4 v[192:195], v2, s[40:43], s63 offen offset:3072 sc1
s_add_u32 m0, s67, 98304
s_add_u32 s62, s64, 384
s_and_b32 s62, s62, 0x3ff
buffer_load_dwordx4 v244, s[48:51], s62 offen offset:0 lds
buffer_load_dwordx4 v245, s[48:51], s62 offen offset:1024 lds
buffer_load_dwordx4 v246, s[48:51], s62 offen offset:2048 lds
buffer_load_dwordx4 v247, s[48:51], s62 offen offset:3072 lds
s_add_u32 s63, s65, 12288
s_and_b32 s63, s63, 0xffff
buffer_load_dwordx4 v[196:199], v2, s[40:43], s63 offen offset:0 sc1
buffer_load_dwordx4 v[200:203], v2, s[40:43], s63 offen offset:1024 sc1
buffer_load_dwordx4 v[204:207], v2, s[40:43], s63 offen offset:2048 sc1
buffer_load_dwordx4 v[208:211], v2, s[40:43], s63 offen offset:3072 sc1
ds_read_b128 v[8:11], v12 offset:0
s_waitcnt lgkmcnt(0)
L_ck57:
v_min3_u32 v15, v8, v9, v10
v_min_u32 v15, v15, v11
s_nop 0
v_readfirstlane_b32 s60, v15
s_nop 0
s_cmp_ge_u32 s60, 4
s_cbranch_scc1 L_ckd58
ds_read_b128 v[8:11], v12 offset:0
s_waitcnt lgkmcnt(0)
s_branch L_ck57
L_ckd58:
ds_read_b128 v[96:99], v20 offset:32768
ds_read_b128 v[100:103], v20 offset:36864
ds_read_b128 v[104:107], v20 offset:40960
ds_read_b128 v[108:111], v20 offset:45056
s_waitcnt vmcnt(11) lgkmcnt(3)
v_mfma_f32_32x32x16_bf16 v[32:47], v[180:183], v[96:99], v[32:47]
ds_read_b128 v[112:115], v21 offset:32768
ds_read_b128 v[116:119], v21 offset:36864
s_waitcnt lgkmcnt(4)
v_mfma_f32_32x32x16_bf16 v[48:63], v[180:183], v[100:103], v[48:63]
ds_read_b128 v[120:123], v21 offset:40960
ds_read_b128 v[124:127], v21 offset:45056
s_waitcnt lgkmcnt(5)
v_mfma_f32_32x32x16_bf16 v[64:79], v[180:183], v[104:107], v[64:79]
s_waitcnt lgkmcnt(4)
v_mfma_f32_32x32x16_bf16 v[80:95], v[180:183], v[108:111], v[80:95]
s_add_u32 s63, s65, 16384
s_and_b32 s63, s63, 0xffff
buffer_load_dwordx4 v[212:215], v2, s[40:43], s63 offen offset:0 sc1
buffer_load_dwordx4 v[216:219], v2, s[40:43], s63 offen offset:1024 sc1
s_waitcnt vmcnt(12) lgkmcnt(3)
v_mfma_f32_32x32x16_bf16 v[32:47], v[184:187], v[112:115], v[32:47]
ds_read_b128 v[96:99], v22 offset:32768
ds_read_b128 v[100:103], v22 offset:36864
s_waitcnt lgkmcnt(4)
v_mfma_f32_32x32x16_bf16 v[48:63], v[184:187], v[116:119], v[48:63]
ds_read_b128 v[104:107], v22 offset:40960
ds_read_b128 v[108:111], v22 offset:45056
s_waitcnt lgkmcnt(5)
v_mfma_f32_32x32x16_bf16 v[64:79], v[184:187], v[120:123], v[64:79]
s_waitcnt lgkmcnt(4)
v_mfma_f32_32x32x16_bf16 v[80:95], v[184:187], v[124:127], v[80:95]
buffer_load_dwordx4 v[220:223], v2, s[40:43], s63 offen offset:2048 sc1
buffer_load_dwordx4 v[224:227], v2, s[40:43], s63 offen offset:3072 sc1
s_waitcnt vmcnt(13) lgkmcnt(3)
v_mfma_f32_32x32x16_bf16 v[32:47], v[188:191], v[96:99], v[32:47]
ds_read_b128 v[112:115], v23 offset:32768
ds_read_b128 v[116:119], v23 offset:36864
s_waitcnt lgkmcnt(4)
v_mfma_f32_32x32x16_bf16 v[48:63], v[188:191], v[100:103], v[48:63]
ds_read_b128 v[120:123], v23 offset:40960
ds_read_b128 v[124:127], v23 offset:45056
s_waitcnt lgkmcnt(5)
v_mfma_f32_32x32x16_bf16 v[64:79], v[188:191], v[104:107], v[64:79]
s_waitcnt lgkmcnt(4)
v_mfma_f32_32x32x16_bf16 v[80:95], v[188:191], v[108:111], v[80:95]
s_add_u32 s63, s65, 20480
s_and_b32 s63, s63, 0xffff
buffer_load_dwordx4 v[228:231], v2, s[40:43], s63 offen offset:0 sc1
buffer_load_dwordx4 v[232:235], v2, s[40:43], s63 offen offset:1024 sc1
s_waitcnt vmcnt(14) lgkmcnt(3)
v_mfma_f32_32x32x16_bf16 v[32:47], v[192:195], v[112:115], v[32:47]
ds_read_b128 v[96:99], v20 offset:49152
ds_read_b128 v[100:103], v20 offset:53248
s_waitcnt lgkmcnt(4)
v_mfma_f32_32x32x16_bf16 v[48:63], v[192:195], v[116:119], v[48:63]
ds_read_b128 v[104:107], v20 offset:57344
ds_read_b128 v[108:111], v20 offset:61440
s_waitcnt lgkmcnt(5)
v_mfma_f32_32x32x16_bf16 v[64:79], v[192:195], v[120:123], v[64:79]
s_waitcnt lgkmcnt(4)
v_mfma_f32_32x32x16_bf16 v[80:95], v[192:195], v[124:127], v[80:95]
buffer_load_dwordx4 v[236:239], v2, s[40:43], s63 offen offset:2048 sc1
buffer_load_dwordx4 v[240:243], v2, s[40:43], s63 offen offset:3072 sc1
s_waitcnt vmcnt(11) lgkmcnt(3)
v_mov_b32 v14, 5
s_mov_b64 exec, 1
ds_write_b32 v13, v14
s_mov_b64 exec, -1
v_mfma_f32_32x32x16_bf16 v[32:47], v[196:199], v[96:99], v[32:47]
ds_read_b128 v[112:115], v21 offset:49152
ds_read_b128 v[116:119], v21 offset:53248
s_waitcnt lgkmcnt(5)
v_mfma_f32_32x32x16_bf16 v[48:63], v[196:199], v[100:103], v[48:63]
ds_read_b128 v[120:123], v21 offset:57344
ds_read_b128 v[124:127], v21 offset:61440
s_waitcnt lgkmcnt(6)
v_mfma_f32_32x32x16_bf16 v[64:79], v[196:199], v[104:107], v[64:79]
s_add_u32 m0, s67, 0
s_nop 0
buffer_load_dwordx4 v244, s[52:55], s62 offen offset:0 lds
s_waitcnt lgkmcnt(5)
v_mfma_f32_32x32x16_bf16 v[80:95], v[196:199], v[108:111], v[80:95]
s_add_u32 s63, s65, 24576
s_and_b32 s63, s63, 0xffff
buffer_load_dwordx4 v[148:151], v2, s[40:43], s63 offen offset:0 sc1
buffer_load_dwordx4 v[152:155], v2, s[40:43], s63 offen offset:1024 sc1
s_waitcnt vmcnt(13) lgkmcnt(3)
v_mfma_f32_32x32x16_bf16 v[32:47], v[200:203], v[112:115], v[32:47]
ds_read_b128 v[96:99], v22 offset:49152
ds_read_b128 v[100:103], v22 offset:53248
s_waitcnt lgkmcnt(4)
v_mfma_f32_32x32x16_bf16 v[48:63], v[200:203], v[116:119], v[48:63]
ds_read_b128 v[104:107], v22 offset:57344
ds_read_b128 v[108:111], v22 offset:61440
s_waitcnt lgkmcnt(5)
v_mfma_f32_32x32x16_bf16 v[64:79], v[200:203], v[120:123], v[64:79]
buffer_load_dwordx4 v245, s[52:55], s62 offen offset:1024 lds
s_waitcnt lgkmcnt(4)
v_mfma_f32_32x32x16_bf16 v[80:95], v[200:203], v[124:127], v[80:95]
buffer_load_dwordx4 v[156:159], v2, s[40:43], s63 offen offset:2048 sc1
buffer_load_dwordx4 v[160:163], v2, s[40:43], s63 offen offset:3072 sc1
s_waitcnt vmcnt(15) lgkmcnt(3)
v_mfma_f32_32x32x16_bf16 v[32:47], v[204:207], v[96:99], v[32:47]
ds_read_b128 v[112:115], v23 offset:49152
ds_read_b128 v[116:119], v23 offset:53248
s_waitcnt lgkmcnt(4)
v_mfma_f32_32x32x16_bf16 v[48:63], v[204:207], v[100:103], v[48:63]
ds_read_b128 v[120:123], v23 offset:57344
ds_read_b128 v[124:127], v23 offset:61440
s_waitcnt lgkmcnt(5)
v_mfma_f32_32x32x16_bf16 v[64:79], v[204:207], v[104:107], v[64:79]
buffer_load_dwordx4 v246, s[52:55], s62 offen offset:2048 lds
s_waitcnt lgkmcnt(4)
v_mfma_f32_32x32x16_bf16 v[80:95], v[204:207], v[108:111], v[80:95]
s_add_u32 s63, s65, 28672
s_and_b32 s63, s63, 0xffff
buffer_load_dwordx4 v[164:167], v2, s[40:43], s63 offen offset:0 sc1
buffer_load_dwordx4 v[168:171], v2, s[40:43], s63 offen offset:1024 sc1
ds_read_b128 v[8:11], v12
s_waitcnt vmcnt(17) lgkmcnt(0)
L_ck59:
v_min3_u32 v15, v8, v9, v10
v_min_u32 v15, v15, v11
s_nop 0
v_readfirstlane_b32 s60, v15
s_nop 0
s_cmp_ge_u32 s60, 5
s_cbranch_scc1 L_ckd60
ds_read_b128 v[8:11], v12 offset:0
s_waitcnt lgkmcnt(0)
s_branch L_ck59
L_ckd60:
v_mfma_f32_32x32x16_bf16 v[32:47], v[208:211], v[112:115], v[32:47]
ds_read_b128 v[96:99], v24 offset:0
ds_read_b128 v[100:103], v24 offset:4096
v_mfma_f32_32x32x16_bf16 v[48:63], v[208:211], v[116:119], v[48:63]
ds_read_b128 v[104:107], v24 offset:8192
ds_read_b128 v[108:111], v24 offset:12288
v_mfma_f32_32x32x16_bf16 v[64:79], v[208:211], v[120:123], v[64:79]
buffer_load_dwordx4 v247, s[52:55], s62 offen offset:3072 lds
v_mfma_f32_32x32x16_bf16 v[80:95], v[208:211], v[124:127], v[80:95]
buffer_load_dwordx4 v[172:175], v2, s[40:43], s63 offen offset:2048 sc1
buffer_load_dwordx4 v[176:179], v2, s[40:43], s63 offen offset:3072 sc1
s_waitcnt vmcnt(19) lgkmcnt(3)
v_mfma_f32_32x32x16_bf16 v[32:47], v[212:215], v[96:99], v[32:47]
ds_read_b128 v[112:115], v25 offset:0
ds_read_b128 v[116:119], v25 offset:4096
s_waitcnt lgkmcnt(4)
v_mfma_f32_32x32x16_bf16 v[48:63], v[212:215], v[100:103], v[48:63]
ds_read_b128 v[120:123], v25 offset:8192
ds_read_b128 v[124:127], v25 offset:12288
s_waitcnt lgkmcnt(5)
v_mfma_f32_32x32x16_bf16 v[64:79], v[212:215], v[104:107], v[64:79]
s_add_u32 m0, s67, 16384
s_add_u32 s62, s64, 512
s_and_b32 s62, s62, 0x3ff
buffer_load_dwordx4 v244, s[48:51], s62 offen offset:0 lds
s_waitcnt lgkmcnt(4)
v_mfma_f32_32x32x16_bf16 v[80:95], v[212:215], v[108:111], v[80:95]
s_add_u32 s63, s65, 32768
s_and_b32 s63, s63, 0xffff
buffer_load_dwordx4 v[180:183], v2, s[40:43], s63 offen offset:0 sc1
buffer_load_dwordx4 v[184:187], v2, s[40:43], s63 offen offset:1024 sc1
s_waitcnt vmcnt(21) lgkmcnt(3)
v_mfma_f32_32x32x16_bf16 v[32:47], v[216:219], v[112:115], v[32:47]
ds_read_b128 v[96:99], v26 offset:0
ds_read_b128 v[100:103], v26 offset:4096
s_waitcnt lgkmcnt(4)
v_mfma_f32_32x32x16_bf16 v[48:63], v[216:219], v[116:119], v[48:63]
ds_read_b128 v[104:107], v26 offset:8192
ds_read_b128 v[108:111], v26 offset:12288
s_waitcnt lgkmcnt(5)
v_mfma_f32_32x32x16_bf16 v[64:79], v[216:219], v[120:123], v[64:79]
buffer_load_dwordx4 v245, s[48:51], s62 offen offset:1024 lds
s_waitcnt lgkmcnt(4)
v_mfma_f32_32x32x16_bf16 v[80:95], v[216:219], v[124:127], v[80:95]
buffer_load_dwordx4 v[188:191], v2, s[40:43], s63 offen offset:2048 sc1
buffer_load_dwordx4 v[192:195], v2, s[40:43], s63 offen offset:3072 sc1
s_waitcnt vmcnt(23) lgkmcnt(3)
v_mfma_f32_32x32x16_bf16 v[32:47], v[220:223], v[96:99], v[32:47]
ds_read_b128 v[112:115], v27 offset:0
ds_read_b128 v[116:119], v27 offset:4096
s_waitcnt lgkmcnt(4)
v_mfma_f32_32x32x16_bf16 v[48:63], v[220:223], v[100:103], v[48:63]
ds_read_b128 v[120:123], v27 offset:8192
ds_read_b128 v[124:127], v27 offset:12288
s_waitcnt lgkmcnt(5)
v_mfma_f32_32x32x16_bf16 v[64:79], v[220:223], v[104:107], v[64:79]
buffer_load_dwordx4 v246, s[48:51], s62 offen offset:2048 lds
s_waitcnt lgkmcnt(4)
v_mfma_f32_32x32x16_bf16 v[80:95], v[220:223], v[108:111], v[80:95]
s_add_u32 s63, s65, 36864
s_and_b32 s63, s63, 0xffff
buffer_load_dwordx4 v[196:199], v2, s[40:43], s63 offen offset:0 sc1
buffer_load_dwordx4 v[200:203], v2, s[40:43], s63 offen offset:1024 sc1
s_waitcnt vmcnt(25) lgkmcnt(3)
v_mfma_f32_32x32x16_bf16 v[32:47], v[224:227], v[112:115], v[32:47]
ds_read_b128 v[96:99], v24 offset:16384
ds_read_b128 v[100:103], v24 offset:20480
s_waitcnt lgkmcnt(4)
v_mfma_f32_32x32x16_bf16 v[48:63], v[224:227], v[116:119], v[48:63]
ds_read_b128 v[104:107], v24 offset:24576
ds_read_b128 v[108:111], v24 offset:28672
s_waitcnt lgkmcnt(5)
v_mfma_f32_32x32x16_bf16 v[64:79], v[224:227], v[120:123], v[64:79]
buffer_load_dwordx4 v247, s[48:51], s62 offen offset:3072 lds
s_waitcnt lgkmcnt(4)
v_mfma_f32_32x32x16_bf16 v[80:95], v[224:227], v[124:127], v[80:95]
buffer_load_dwordx4 v[204:207], v2, s[40:43], s63 offen offset:2048 sc1
buffer_load_dwordx4 v[208:211], v2, s[40:43], s63 offen offset:3072 sc1
s_waitcnt vmcnt(14) lgkmcnt(3)
v_mov_b32 v14, 6
s_mov_b64 exec, 1
ds_write_b32 v13, v14
s_mov_b64 exec, -1
v_mfma_f32_32x32x16_bf16 v[32:47], v[228:231], v[96:99], v[32:47]
ds_read_b128 v[112:115], v25 offset:16384
ds_read_b128 v[116:119], v25 offset:20480
s_waitcnt lgkmcnt(5)
v_mfma_f32_32x32x16_bf16 v[48:63], v[228:231], v[100:103], v[48:63]
ds_read_b128 v[120:123], v25 offset:24576
ds_read_b128 v[124:127], v25 offset:28672
s_waitcnt lgkmcnt(6)
v_mfma_f32_32x32x16_bf16 v[64:79], v[228:231], v[104:107], v[64:79]
s_add_u32 m0, s67, 32768
s_nop 0
buffer_load_dwordx4 v244, s[52:55], s62 offen offset:0 lds
s_waitcnt lgkmcnt(5)
v_mfma_f32_32x32x16_bf16 v[80:95], v[228:231], v[108:111], v[80:95]
s_add_u32 s63, s65, 40960
s_and_b32 s63, s63, 0xffff
buffer_load_dwordx4 v[212:215], v2, s[40:43], s63 offen offset:0 sc1
buffer_load_dwordx4 v[216:219], v2, s[40:43], s63 offen offset:1024 sc1
s_waitcnt vmcnt(29) lgkmcnt(3)
v_mfma_f32_32x32x16_bf16 v[32:47], v[232:235], v[112:115], v[32:47]
ds_read_b128 v[96:99], v26 offset:16384
ds_read_b128 v[100:103], v26 offset:20480
s_waitcnt lgkmcnt(4)
v_mfma_f32_32x32x16_bf16 v[48:63], v[232:235], v[116:119], v[48:63]
ds_read_b128 v[104:107], v26 offset:24576
ds_read_b128 v[108:111], v26 offset:28672
s_waitcnt lgkmcnt(5)
v_mfma_f32_32x32x16_bf16 v[64:79], v[232:235], v[120:123], v[64:79]
buffer_load_dwordx4 v245, s[52:55], s62 offen offset:1024 lds
s_waitcnt lgkmcnt(4)
v_mfma_f32_32x32x16_bf16 v[80:95], v[232:235], v[124:127], v[80:95]
buffer_load_dwordx4 v[220:223], v2, s[40:43], s63 offen offset:2048 sc1
buffer_load_dwordx4 v[224:227], v2, s[40:43], s63 offen offset:3072 sc1
s_waitcnt vmcnt(31) lgkmcnt(3)
v_mfma_f32_32x32x16_bf16 v[32:47], v[236:239], v[96:99], v[32:47]
ds_read_b128 v[112:115], v27 offset:16384
ds_read_b128 v[116:119], v27 offset:20480
s_waitcnt lgkmcnt(4)
v_mfma_f32_32x32x16_bf16 v[48:63], v[236:239], v[100:103], v[48:63]
ds_read_b128 v[120:123], v27 offset:24576
ds_read_b128 v[124:127], v27 offset:28672
s_waitcnt lgkmcnt(5)
v_mfma_f32_32x32x16_bf16 v[64:79], v[236:239], v[104:107], v[64:79]
buffer_load_dwordx4 v246, s[52:55], s62 offen offset:2048 lds
s_waitcnt lgkmcnt(4)
v_mfma_f32_32x32x16_bf16 v[80:95], v[236:239], v[108:111], v[80:95]
s_add_u32 s63, s65, 45056
s_and_b32 s63, s63, 0xffff
buffer_load_dwordx4 v[228:231], v2, s[40:43], s63 offen offset:0 sc1
buffer_load_dwordx4 v[232:235], v2, s[40:43], s63 offen offset:1024 sc1
ds_read_b128 v[8:11], v12
s_waitcnt vmcnt(33) lgkmcnt(0)
L_ck61:
v_min3_u32 v15, v8, v9, v10
v_min_u32 v15, v15, v11
s_nop 0
v_readfirstlane_b32 s60, v15
s_nop 0
s_cmp_ge_u32 s60, 6
s_cbranch_scc1 L_ckd62
ds_read_b128 v[8:11], v12 offset:0
s_waitcnt lgkmcnt(0)
s_branch L_ck61
L_ckd62:
v_mfma_f32_32x32x16_bf16 v[32:47], v[240:243], v[112:115], v[32:47]
ds_read_b128 v[96:99], v24 offset:32768
ds_read_b128 v[100:103], v24 offset:36864
v_mfma_f32_32x32x16_bf16 v[48:63], v[240:243], v[116:119], v[48:63]
ds_read_b128 v[104:107], v24 offset:40960
ds_read_b128 v[108:111], v24 offset:45056
v_mfma_f32_32x32x16_bf16 v[64:79], v[240:243], v[120:123], v[64:79]
buffer_load_dwordx4 v247, s[52:55], s62 offen offset:3072 lds
v_mfma_f32_32x32x16_bf16 v[80:95], v[240:243], v[124:127], v[80:95]
buffer_load_dwordx4 v[236:239], v2, s[40:43], s63 offen offset:2048 sc1
buffer_load_dwordx4 v[240:243], v2, s[40:43], s63 offen offset:3072 sc1
s_waitcnt vmcnt(34) lgkmcnt(3)
v_mfma_f32_32x32x16_bf16 v[32:47], v[148:151], v[96:99], v[32:47]
ds_read_b128 v[112:115], v25 offset:32768
ds_read_b128 v[116:119], v25 offset:36864
s_waitcnt lgkmcnt(4)
v_mfma_f32_32x32x16_bf16 v[48:63], v[148:151], v[100:103], v[48:63]
ds_read_b128 v[120:123], v25 offset:40960
ds_read_b128 v[124:127], v25 offset:45056
s_waitcnt lgkmcnt(5)
v_mfma_f32_32x32x16_bf16 v[64:79], v[148:151], v[104:107], v[64:79]
s_add_u32 m0, s67, 49152
s_add_u32 s62, s64, 640
s_and_b32 s62, s62, 0x3ff
buffer_load_dwordx4 v244, s[48:51], s62 offen offset:0 lds
s_waitcnt lgkmcnt(4)
v_mfma_f32_32x32x16_bf16 v[80:95], v[148:151], v[108:111], v[80:95]
s_add_u32 s63, s65, 49152
s_and_b32 s63, s63, 0xffff
buffer_load_dwordx4 v[148:151], v2, s[40:43], s63 offen offset:0 sc1
s_waitcnt vmcnt(35) lgkmcnt(3)
v_mfma_f32_32x32x16_bf16 v[32:47], v[152:155], v[112:115], v[32:47]
ds_read_b128 v[96:99], v26 offset:32768
ds_read_b128 v[100:103], v26 offset:36864
s_waitcnt lgkmcnt(4)
v_mfma_f32_32x32x16_bf16 v[48:63], v[152:155], v[116:119], v[48:63]
ds_read_b128 v[104:107], v26 offset:40960
ds_read_b128 v[108:111], v26 offset:45056
s_waitcnt lgkmcnt(5)
v_mfma_f32_32x32x16_bf16 v[64:79], v[152:155], v[120:123], v[64:79]
buffer_load_dwordx4 v245, s[48:51], s62 offen offset:1024 lds
s_waitcnt lgkmcnt(4)
v_mfma_f32_32x32x16_bf16 v[80:95], v[152:155], v[124:127], v[80:95]
buffer_load_dwordx4 v[152:155], v2, s[40:43], s63 offen offset:1024 sc1
s_waitcnt vmcnt(35) lgkmcnt(3)
v_mfma_f32_32x32x16_bf16 v[32:47], v[156:159], v[96:99], v[32:47]
ds_read_b128 v[112:115], v27 offset:32768
ds_read_b128 v[116:119], v27 offset:36864
s_waitcnt lgkmcnt(4)
v_mfma_f32_32x32x16_bf16 v[48:63], v[156:159], v[100:103], v[48:63]
ds_read_b128 v[120:123], v27 offset:40960
ds_read_b128 v[124:127], v27 offset:45056
s_waitcnt lgkmcnt(5)
v_mfma_f32_32x32x16_bf16 v[64:79], v[156:159], v[104:107], v[64:79]
buffer_load_dwordx4 v246, s[48:51], s62 offen offset:2048 lds
s_waitcnt lgkmcnt(4)
v_mfma_f32_32x32x16_bf16 v[80:95], v[156:159], v[108:111], v[80:95]
buffer_load_dwordx4 v[156:159], v2, s[40:43], s63 offen offset:2048 sc1
s_waitcnt vmcnt(36) lgkmcnt(3)
v_mfma_f32_32x32x16_bf16 v[32:47], v[160:163], v[112:115], v[32:47]
ds_read_b128 v[96:99], v20 offset:0
ds_read_b128 v[100:103], v20 offset:4096
s_waitcnt lgkmcnt(4)
v_mfma_f32_32x32x16_bf16 v[48:63], v[160:163], v[116:119], v[48:63]
ds_read_b128 v[104:107], v20 offset:8192
ds_read_b128 v[108:111], v20 offset:12288
s_waitcnt lgkmcnt(5)
v_mfma_f32_32x32x16_bf16 v[64:79], v[160:163], v[120:123], v[64:79]
buffer_load_dwordx4 v247, s[48:51], s62 offen offset:3072 lds
s_waitcnt lgkmcnt(4)
v_mfma_f32_32x32x16_bf16 v[80:95], v[160:163], v[124:127], v[80:95]
buffer_load_dwordx4 v[160:163], v2, s[40:43], s63 offen offset:3072 sc1
s_waitcnt vmcnt(10) lgkmcnt(3)
v_mov_b32 v14, 7
s_mov_b64 exec, 1
ds_write_b32 v13, v14
s_mov_b64 exec, -1
v_mfma_f32_32x32x16_bf16 v[32:47], v[164:167], v[96:99], v[32:47]
ds_read_b128 v[112:115], v21 offset:0
ds_read_b128 v[116:119], v21 offset:4096
s_waitcnt lgkmcnt(5)
v_mfma_f32_32x32x16_bf16 v[48:63], v[164:167], v[100:103], v[48:63]
ds_read_b128 v[120:123], v21 offset:8192
ds_read_b128 v[124:127], v21 offset:12288
s_waitcnt lgkmcnt(6)
v_mfma_f32_32x32x16_bf16 v[64:79], v[164:167], v[104:107], v[64:79]
s_add_u32 m0, s67, 65536
s_nop 0
buffer_load_dwordx4 v244, s[52:55], s62 offen offset:0 lds
s_waitcnt lgkmcnt(5)
v_mfma_f32_32x32x16_bf16 v[80:95], v[164:167], v[108:111], v[80:95]
s_add_u32 s63, s65, 53248
s_and_b32 s63, s63, 0xffff
buffer_load_dwordx4 v[164:167], v2, s[40:43], s63 offen offset:0 sc1
s_waitcnt vmcnt(37) lgkmcnt(3)
v_mfma_f32_32x32x16_bf16 v[32:47], v[168:171], v[112:115], v[32:47]
ds_read_b128 v[96:99], v22 offset:0
ds_read_b128 v[100:103], v22 offset:4096
s_waitcnt lgkmcnt(4)
v_mfma_f32_32x32x16_bf16 v[48:63], v[168:171], v[116:119], v[48:63]
ds_read_b128 v[104:107], v22 offset:8192
ds_read_b128 v[108:111], v22 offset:12288
s_waitcnt lgkmcnt(5)
v_mfma_f32_32x32x16_bf16 v[64:79], v[168:171], v[120:123], v[64:79]
buffer_load_dwordx4 v245, s[52:55], s62 offen offset:1024 lds
s_waitcnt lgkmcnt(4)
v_mfma_f32_32x32x16_bf16 v[80:95], v[168:171], v[124:127], v[80:95]
buffer_load_dwordx4 v[168:171], v2, s[40:43], s63 offen offset:1024 sc1
s_waitcnt vmcnt(37) lgkmcnt(3)
v_mfma_f32_32x32x16_bf16 v[32:47], v[172:175], v[96:99], v[32:47]
ds_read_b128 v[112:115], v23 offset:0
ds_read_b128 v[116:119], v23 offset:4096
s_waitcnt lgkmcnt(4)
v_mfma_f32_32x32x16_bf16 v[48:63], v[172:175], v[100:103], v[48:63]
ds_read_b128 v[120:123], v23 offset:8192
ds_read_b128 v[124:127], v23 offset:12288
s_waitcnt lgkmcnt(5)
v_mfma_f32_32x32x16_bf16 v[64:79], v[172:175], v[104:107], v[64:79]
buffer_load_dwordx4 v246, s[52:55], s62 offen offset:2048 lds
s_waitcnt lgkmcnt(4)
v_mfma_f32_32x32x16_bf16 v[80:95], v[172:175], v[108:111], v[80:95]
buffer_load_dwordx4 v[172:175], v2, s[40:43], s63 offen offset:2048 sc1
ds_read_b128 v[8:11], v12
s_waitcnt vmcnt(38) lgkmcnt(0)
L_ck63:
v_min3_u32 v15, v8, v9, v10
v_min_u32 v15, v15, v11
s_nop 0
v_readfirstlane_b32 s60, v15
s_nop 0
s_cmp_ge_u32 s60, 7
s_cbranch_scc1 L_ckd64
ds_read_b128 v[8:11], v12 offset:0
s_waitcnt lgkmcnt(0)
s_branch L_ck63
L_ckd64:
v_mfma_f32_32x32x16_bf16 v[32:47], v[176:179], v[112:115], v[32:47]
ds_read_b128 v[96:99], v20 offset:16384
ds_read_b128 v[100:103], v20 offset:20480
v_mfma_f32_32x32x16_bf16 v[48:63], v[176:179], v[116:119], v[48:63]
ds_read_b128 v[104:107], v20 offset:24576
ds_read_b128 v[108:111], v20 offset:28672
v_mfma_f32_32x32x16_bf16 v[64:79], v[176:179], v[120:123], v[64:79]
buffer_load_dwordx4 v247, s[52:55], s62 offen offset:3072 lds
v_mfma_f32_32x32x16_bf16 v[80:95], v[176:179], v[124:127], v[80:95]
buffer_load_dwordx4 v[176:179], v2, s[40:43], s63 offen offset:3072 sc1
s_waitcnt vmcnt(38) lgkmcnt(3)
v_mfma_f32_32x32x16_bf16 v[32:47], v[180:183], v[96:99], v[32:47]
ds_read_b128 v[112:115], v21 offset:16384
ds_read_b128 v[116:119], v21 offset:20480
s_waitcnt lgkmcnt(4)
v_mfma_f32_32x32x16_bf16 v[48:63], v[180:183], v[100:103], v[48:63]
ds_read_b128 v[120:123], v21 offset:24576
ds_read_b128 v[124:127], v21 offset:28672
s_waitcnt lgkmcnt(5)
v_mfma_f32_32x32x16_bf16 v[64:79], v[180:183], v[104:107], v[64:79]
s_add_u32 m0, s67, 81920
s_add_u32 s62, s64, 768
s_and_b32 s62, s62, 0x3ff
buffer_load_dwordx4 v244, s[48:51], s62 offen offset:0 lds
s_waitcnt lgkmcnt(4)
v_mfma_f32_32x32x16_bf16 v[80:95], v[180:183], v[108:111], v[80:95]
s_add_u32 s63, s65, 57344
s_and_b32 s63, s63, 0xffff
buffer_load_dwordx4 v[180:183], v2, s[40:43], s63 offen offset:0 sc1
s_waitcnt vmcnt(39) lgkmcnt(3)
v_mfma_f32_32x32x16_bf16 v[32:47], v[184:187], v[112:115], v[32:47]
ds_read_b128 v[96:99], v22 offset:16384
ds_read_b128 v[100:103], v22 offset:20480
s_waitcnt lgkmcnt(4)
v_mfma_f32_32x32x16_bf16 v[48:63], v[184:187], v[116:119], v[48:63]
ds_read_b128 v[104:107], v22 offset:24576
ds_read_b128 v[108:111], v22 offset:28672
s_waitcnt lgkmcnt(5)
v_mfma_f32_32x32x16_bf16 v[64:79], v[184:187], v[120:123], v[64:79]
buffer_load_dwordx4 v245, s[48:51], s62 offen offset:1024 lds
s_waitcnt lgkmcnt(4)
v_mfma_f32_32x32x16_bf16 v[80:95], v[184:187], v[124:127], v[80:95]
buffer_load_dwordx4 v[184:187], v2, s[40:43], s63 offen offset:1024 sc1
s_waitcnt vmcnt(39) lgkmcnt(3)
v_mfma_f32_32x32x16_bf16 v[32:47], v[188:191], v[96:99], v[32:47]
ds_read_b128 v[112:115], v23 offset:16384
ds_read_b128 v[116:119], v23 offset:20480
s_waitcnt lgkmcnt(4)
v_mfma_f32_32x32x16_bf16 v[48:63], v[188:191], v[100:103], v[48:63]
ds_read_b128 v[120:123], v23 offset:24576
ds_read_b128 v[124:127], v23 offset:28672
s_waitcnt lgkmcnt(5)
v_mfma_f32_32x32x16_bf16 v[64:79], v[188:191], v[104:107], v[64:79]
buffer_load_dwordx4 v246, s[48:51], s62 offen offset:2048 lds
s_waitcnt lgkmcnt(4)
v_mfma_f32_32x32x16_bf16 v[80:95], v[188:191], v[108:111], v[80:95]
buffer_load_dwordx4 v[188:191], v2, s[40:43], s63 offen offset:2048 sc1
s_waitcnt vmcnt(40) lgkmcnt(3)
v_mfma_f32_32x32x16_bf16 v[32:47], v[192:195], v[112:115], v[32:47]
ds_read_b128 v[96:99], v20 offset:32768
ds_read_b128 v[100:103], v20 offset:36864
s_waitcnt lgkmcnt(4)
v_mfma_f32_32x32x16_bf16 v[48:63], v[192:195], v[116:119], v[48:63]
ds_read_b128 v[104:107], v20 offset:40960
ds_read_b128 v[108:111], v20 offset:45056
s_waitcnt lgkmcnt(5)
v_mfma_f32_32x32x16_bf16 v[64:79], v[192:195], v[120:123], v[64:79]
buffer_load_dwordx4 v247, s[48:51], s62 offen offset:3072 lds
s_waitcnt lgkmcnt(4)
v_mfma_f32_32x32x16_bf16 v[80:95], v[192:195], v[124:127], v[80:95]
buffer_load_dwordx4 v[192:195], v2, s[40:43], s63 offen offset:3072 sc1
s_waitcnt vmcnt(9) lgkmcnt(3)
v_mov_b32 v14, 8
s_mov_b64 exec, 1
ds_write_b32 v13, v14
s_mov_b64 exec, -1
v_mfma_f32_32x32x16_bf16 v[32:47], v[196:199], v[96:99], v[32:47]
ds_read_b128 v[112:115], v21 offset:32768
ds_read_b128 v[116:119], v21 offset:36864
s_waitcnt lgkmcnt(5)
v_mfma_f32_32x32x16_bf16 v[48:63], v[196:199], v[100:103], v[48:63]
ds_read_b128 v[120:123], v21 offset:40960
ds_read_b128 v[124:127], v21 offset:45056
s_waitcnt lgkmcnt(6)
v_mfma_f32_32x32x16_bf16 v[64:79], v[196:199], v[104:107], v[64:79]
s_add_u32 m0, s67, 98304
s_nop 0
buffer_load_dwordx4 v244, s[52:55], s62 offen offset:0 lds
s_waitcnt lgkmcnt(5)
v_mfma_f32_32x32x16_bf16 v[80:95], v[196:199], v[108:111], v[80:95]
s_add_u32 s63, s65, 61440
s_and_b32 s63, s63, 0xffff
buffer_load_dwordx4 v[196:199], v2, s[40:43], s63 offen offset:0 sc1
s_waitcnt vmcnt(41) lgkmcnt(3)
v_mfma_f32_32x32x16_bf16 v[32:47], v[200:203], v[112:115], v[32:47]
ds_read_b128 v[96:99], v22 offset:32768
ds_read_b128 v[100:103], v22 offset:36864
s_waitcnt lgkmcnt(4)
v_mfma_f32_32x32x16_bf16 v[48:63], v[200:203], v[116:119], v[48:63]
ds_read_b128 v[104:107], v22 offset:40960
ds_read_b128 v[108:111], v22 offset:45056
s_waitcnt lgkmcnt(5)
v_mfma_f32_32x32x16_bf16 v[64:79], v[200:203], v[120:123], v[64:79]
buffer_load_dwordx4 v245, s[52:55], s62 offen offset:1024 lds
s_waitcnt lgkmcnt(4)
v_mfma_f32_32x32x16_bf16 v[80:95], v[200:203], v[124:127], v[80:95]
buffer_load_dwordx4 v[200:203], v2, s[40:43], s63 offen offset:1024 sc1
s_waitcnt vmcnt(41) lgkmcnt(3)
v_mfma_f32_32x32x16_bf16 v[32:47], v[204:207], v[96:99], v[32:47]
ds_read_b128 v[112:115], v23 offset:32768
ds_read_b128 v[116:119], v23 offset:36864
s_waitcnt lgkmcnt(4)
v_mfma_f32_32x32x16_bf16 v[48:63], v[204:207], v[100:103], v[48:63]
ds_read_b128 v[120:123], v23 offset:40960
ds_read_b128 v[124:127], v23 offset:45056
s_waitcnt lgkmcnt(5)
v_mfma_f32_32x32x16_bf16 v[64:79], v[204:207], v[104:107], v[64:79]
buffer_load_dwordx4 v246, s[52:55], s62 offen offset:2048 lds
s_waitcnt lgkmcnt(4)
v_mfma_f32_32x32x16_bf16 v[80:95], v[204:207], v[108:111], v[80:95]
buffer_load_dwordx4 v[204:207], v2, s[40:43], s63 offen offset:2048 sc1
ds_read_b128 v[8:11], v12
s_waitcnt vmcnt(42) lgkmcnt(0)
L_ck65:
v_min3_u32 v15, v8, v9, v10
v_min_u32 v15, v15, v11
s_nop 0
v_readfirstlane_b32 s60, v15
s_nop 0
s_cmp_ge_u32 s60, 8
s_cbranch_scc1 L_ckd66
ds_read_b128 v[8:11], v12 offset:0
s_waitcnt lgkmcnt(0)
s_branch L_ck65
L_ckd66:
v_mfma_f32_32x32x16_bf16 v[32:47], v[208:211], v[112:115], v[32:47]
ds_read_b128 v[96:99], v20 offset:49152
ds_read_b128 v[100:103], v20 offset:53248
v_mfma_f32_32x32x16_bf16 v[48:63], v[208:211], v[116:119], v[48:63]
ds_read_b128 v[104:107], v20 offset:57344
ds_read_b128 v[108:111], v20 offset:61440
v_mfma_f32_32x32x16_bf16 v[64:79], v[208:211], v[120:123], v[64:79]
buffer_load_dwordx4 v247, s[52:55], s62 offen offset:3072 lds
v_mfma_f32_32x32x16_bf16 v[80:95], v[208:211], v[124:127], v[80:95]
buffer_load_dwordx4 v[208:211], v2, s[40:43], s63 offen offset:3072 sc1
s_waitcnt vmcnt(42) lgkmcnt(3)
v_mfma_f32_32x32x16_bf16 v[32:47], v[212:215], v[96:99], v[32:47]
ds_read_b128 v[112:115], v21 offset:49152
ds_read_b128 v[116:119], v21 offset:53248
s_waitcnt lgkmcnt(4)
v_mfma_f32_32x32x16_bf16 v[48:63], v[212:215], v[100:103], v[48:63]
ds_read_b128 v[120:123], v21 offset:57344
ds_read_b128 v[124:127], v21 offset:61440
s_waitcnt lgkmcnt(5)
v_mfma_f32_32x32x16_bf16 v[64:79], v[212:215], v[104:107], v[64:79]
s_add_u32 m0, s67, 0
s_add_u32 s62, s64, 896
s_and_b32 s62, s62, 0x3ff
buffer_load_dwordx4 v244, s[48:51], s62 offen offset:0 lds
s_waitcnt lgkmcnt(4)
v_mfma_f32_32x32x16_bf16 v[80:95], v[212:215], v[108:111], v[80:95]
s_waitcnt vmcnt(42) lgkmcnt(3)
v_mfma_f32_32x32x16_bf16 v[32:47], v[216:219], v[112:115], v[32:47]
ds_read_b128 v[96:99], v22 offset:49152
ds_read_b128 v[100:103], v22 offset:53248
s_waitcnt lgkmcnt(4)
v_mfma_f32_32x32x16_bf16 v[48:63], v[216:219], v[116:119], v[48:63]
ds_read_b128 v[104:107], v22 offset:57344
ds_read_b128 v[108:111], v22 offset:61440
s_waitcnt lgkmcnt(5)
v_mfma_f32_32x32x16_bf16 v[64:79], v[216:219], v[120:123], v[64:79]
buffer_load_dwordx4 v245, s[48:51], s62 offen offset:1024 lds
s_waitcnt lgkmcnt(4)
v_mfma_f32_32x32x16_bf16 v[80:95], v[216:219], v[124:127], v[80:95]
s_waitcnt vmcnt(41) lgkmcnt(3)
v_mfma_f32_32x32x16_bf16 v[32:47], v[220:223], v[96:99], v[32:47]
ds_read_b128 v[112:115], v23 offset:49152
ds_read_b128 v[116:119], v23 offset:53248
s_waitcnt lgkmcnt(4)
v_mfma_f32_32x32x16_bf16 v[48:63], v[220:223], v[100:103], v[48:63]
ds_read_b128 v[120:123], v23 offset:57344
ds_read_b128 v[124:127], v23 offset:61440
s_waitcnt lgkmcnt(5)
v_mfma_f32_32x32x16_bf16 v[64:79], v[220:223], v[104:107], v[64:79]
buffer_load_dwordx4 v246, s[48:51], s62 offen offset:2048 lds
s_waitcnt lgkmcnt(4)
v_mfma_f32_32x32x16_bf16 v[80:95], v[220:223], v[108:111], v[80:95]
s_waitcnt vmcnt(41) lgkmcnt(3)
v_mfma_f32_32x32x16_bf16 v[32:47], v[224:227], v[112:115], v[32:47]
ds_read_b128 v[96:99], v24 offset:0
ds_read_b128 v[100:103], v24 offset:4096
s_waitcnt lgkmcnt(4)
v_mfma_f32_32x32x16_bf16 v[48:63], v[224:227], v[116:119], v[48:63]
ds_read_b128 v[104:107], v24 offset:8192
ds_read_b128 v[108:111], v24 offset:12288
s_waitcnt lgkmcnt(5)
v_mfma_f32_32x32x16_bf16 v[64:79], v[224:227], v[120:123], v[64:79]
buffer_load_dwordx4 v247, s[48:51], s62 offen offset:3072 lds
s_waitcnt lgkmcnt(4)
v_mfma_f32_32x32x16_bf16 v[80:95], v[224:227], v[124:127], v[80:95]
s_waitcnt vmcnt(5) lgkmcnt(3)
v_mov_b32 v14, 9
s_mov_b64 exec, 1
ds_write_b32 v13, v14
s_mov_b64 exec, -1
v_mfma_f32_32x32x16_bf16 v[32:47], v[228:231], v[96:99], v[32:47]
ds_read_b128 v[112:115], v25 offset:0
ds_read_b128 v[116:119], v25 offset:4096
s_waitcnt lgkmcnt(5)
v_mfma_f32_32x32x16_bf16 v[48:63], v[228:231], v[100:103], v[48:63]
ds_read_b128 v[120:123], v25 offset:8192
ds_read_b128 v[124:127], v25 offset:12288
s_waitcnt lgkmcnt(6)
v_mfma_f32_32x32x16_bf16 v[64:79], v[228:231], v[104:107], v[64:79]
s_add_u32 m0, s67, 16384
s_nop 0
buffer_load_dwordx4 v244, s[52:55], s62 offen offset:0 lds
s_waitcnt lgkmcnt(5)
v_mfma_f32_32x32x16_bf16 v[80:95], v[228:231], v[108:111], v[80:95]
s_waitcnt vmcnt(40) lgkmcnt(3)
v_mfma_f32_32x32x16_bf16 v[32:47], v[232:235], v[112:115], v[32:47]
ds_read_b128 v[96:99], v26 offset:0
ds_read_b128 v[100:103], v26 offset:4096
s_waitcnt lgkmcnt(4)
v_mfma_f32_32x32x16_bf16 v[48:63], v[232:235], v[116:119], v[48:63]
ds_read_b128 v[104:107], v26 offset:8192
ds_read_b128 v[108:111], v26 offset:12288
s_waitcnt lgkmcnt(5)
v_mfma_f32_32x32x16_bf16 v[64:79], v[232:235], v[120:123], v[64:79]
buffer_load_dwordx4 v245, s[52:55], s62 offen offset:1024 lds
s_waitcnt lgkmcnt(4)
v_mfma_f32_32x32x16_bf16 v[80:95], v[232:235], v[124:127], v[80:95]
s_waitcnt vmcnt(39) lgkmcnt(3)
v_mfma_f32_32x32x16_bf16 v[32:47], v[236:239], v[96:99], v[32:47]
ds_read_b128 v[112:115], v27 offset:0
ds_read_b128 v[116:119], v27 offset:4096
s_waitcnt lgkmcnt(4)
v_mfma_f32_32x32x16_bf16 v[48:63], v[236:239], v[100:103], v[48:63]
ds_read_b128 v[120:123], v27 offset:8192
ds_read_b128 v[124:127], v27 offset:12288
s_waitcnt lgkmcnt(5)
v_mfma_f32_32x32x16_bf16 v[64:79], v[236:239], v[104:107], v[64:79]
buffer_load_dwordx4 v246, s[52:55], s62 offen offset:2048 lds
s_waitcnt lgkmcnt(4)
v_mfma_f32_32x32x16_bf16 v[80:95], v[236:239], v[108:111], v[80:95]
ds_read_b128 v[8:11], v12
global_load_dword v31, v30, s[26:27]
s_waitcnt vmcnt(40) lgkmcnt(0)
L_ck67:
v_min3_u32 v15, v8, v9, v10
v_min_u32 v15, v15, v11
s_nop 0
v_readfirstlane_b32 s60, v15
s_nop 0
s_cmp_ge_u32 s60, 9
s_cbranch_scc1 L_ckd68
ds_read_b128 v[8:11], v12 offset:0
s_waitcnt lgkmcnt(0)
s_branch L_ck67
L_ckd68:
v_mfma_f32_32x32x16_bf16 v[32:47], v[240:243], v[112:115], v[32:47]
ds_read_b128 v[96:99], v24 offset:16384
ds_read_b128 v[100:103], v24 offset:20480
v_mfma_f32_32x32x16_bf16 v[48:63], v[240:243], v[116:119], v[48:63]
ds_read_b128 v[104:107], v24 offset:24576
ds_read_b128 v[108:111], v24 offset:28672
v_mfma_f32_32x32x16_bf16 v[64:79], v[240:243], v[120:123], v[64:79]
buffer_load_dwordx4 v247, s[52:55], s62 offen offset:3072 lds
v_mfma_f32_32x32x16_bf16 v[80:95], v[240:243], v[124:127], v[80:95]
s_mov_b32 s60, 0
buffer_load_dword v128, v28, s[56:59], s60 offen offset:0
s_waitcnt vmcnt(40) lgkmcnt(3)
v_mfma_f32_32x32x16_bf16 v[32:47], v[148:151], v[96:99], v[32:47]
ds_read_b128 v[112:115], v25 offset:16384
ds_read_b128 v[116:119], v25 offset:20480
s_waitcnt lgkmcnt(4)
v_mfma_f32_32x32x16_bf16 v[48:63], v[148:151], v[100:103], v[48:63]
ds_read_b128 v[120:123], v25 offset:24576
ds_read_b128 v[124:127], v25 offset:28672
s_waitcnt lgkmcnt(5)
v_mfma_f32_32x32x16_bf16 v[64:79], v[148:151], v[104:107], v[64:79]
s_waitcnt lgkmcnt(4)
v_mfma_f32_32x32x16_bf16 v[80:95], v[148:151], v[108:111], v[80:95]
s_mov_b32 s60, 0
buffer_load_dword v129, v28, s[56:59], s60 offen offset:2048
s_waitcnt vmcnt(39) lgkmcnt(3)
v_mfma_f32_32x32x16_bf16 v[32:47], v[152:155], v[112:115], v[32:47]
ds_read_b128 v[96:99], v26 offset:16384
ds_read_b128 v[100:103], v26 offset:20480
s_waitcnt lgkmcnt(4)
v_mfma_f32_32x32x16_bf16 v[48:63], v[152:155], v[116:119], v[48:63]
ds_read_b128 v[104:107], v26 offset:24576
ds_read_b128 v[108:111], v26 offset:28672
s_waitcnt lgkmcnt(5)
v_mfma_f32_32x32x16_bf16 v[64:79], v[152:155], v[120:123], v[64:79]
s_waitcnt lgkmcnt(4)
v_mfma_f32_32x32x16_bf16 v[80:95], v[152:155], v[124:127], v[80:95]
s_mov_b32 s60, 4096
buffer_load_dword v130, v28, s[56:59], s60 offen offset:0
s_waitcnt vmcnt(38) lgkmcnt(3)
v_mfma_f32_32x32x16_bf16 v[32:47], v[156:159], v[96:99], v[32:47]
ds_read_b128 v[112:115], v27 offset:16384
ds_read_b128 v[116:119], v27 offset:20480
s_waitcnt lgkmcnt(4)
v_mfma_f32_32x32x16_bf16 v[48:63], v[156:159], v[100:103], v[48:63]
ds_read_b128 v[120:123], v27 offset:24576
ds_read_b128 v[124:127], v27 offset:28672
s_waitcnt lgkmcnt(5)
v_mfma_f32_32x32x16_bf16 v[64:79], v[156:159], v[104:107], v[64:79]
s_waitcnt lgkmcnt(4)
v_mfma_f32_32x32x16_bf16 v[80:95], v[156:159], v[108:111], v[80:95]
s_mov_b32 s60, 4096
buffer_load_dword v131, v28, s[56:59], s60 offen offset:2048
s_waitcnt vmcnt(37) lgkmcnt(3)
v_mfma_f32_32x32x16_bf16 v[32:47], v[160:163], v[112:115], v[32:47]
ds_read_b128 v[96:99], v24 offset:32768
ds_read_b128 v[100:103], v24 offset:36864
s_waitcnt lgkmcnt(4)
v_mfma_f32_32x32x16_bf16 v[48:63], v[160:163], v[116:119], v[48:63]
ds_read_b128 v[104:107], v24 offset:40960
ds_read_b128 v[108:111], v24 offset:45056
s_waitcnt lgkmcnt(5)
v_mfma_f32_32x32x16_bf16 v[64:79], v[160:163], v[120:123], v[64:79]
s_waitcnt lgkmcnt(4)
v_mfma_f32_32x32x16_bf16 v[80:95], v[160:163], v[124:127], v[80:95]
s_mov_b32 s60, 32768
buffer_load_dword v132, v28, s[56:59], s60 offen offset:0
s_waitcnt vmcnt(5) lgkmcnt(3)
v_mov_b32 v14, 10
s_mov_b64 exec, 1
ds_write_b32 v13, v14
s_mov_b64 exec, -1
v_mfma_f32_32x32x16_bf16 v[32:47], v[164:167], v[96:99], v[32:47]
ds_read_b128 v[112:115], v25 offset:32768
ds_read_b128 v[116:119], v25 offset:36864
s_waitcnt lgkmcnt(5)
v_mfma_f32_32x32x16_bf16 v[48:63], v[164:167], v[100:103], v[48:63]
ds_read_b128 v[120:123], v25 offset:40960
ds_read_b128 v[124:127], v25 offset:45056
s_waitcnt lgkmcnt(6)
v_mfma_f32_32x32x16_bf16 v[64:79], v[164:167], v[104:107], v[64:79]
s_waitcnt lgkmcnt(5)
v_mfma_f32_32x32x16_bf16 v[80:95], v[164:167], v[108:111], v[80:95]
s_mov_b32 s60, 32768
buffer_load_dword v133, v28, s[56:59], s60 offen offset:2048
s_waitcnt vmcnt(35) lgkmcnt(3)
v_mfma_f32_32x32x16_bf16 v[32:47], v[168:171], v[112:115], v[32:47]
ds_read_b128 v[96:99], v26 offset:32768
ds_read_b128 v[100:103], v26 offset:36864
s_waitcnt lgkmcnt(4)
v_mfma_f32_32x32x16_bf16 v[48:63], v[168:171], v[116:119], v[48:63]
ds_read_b128 v[104:107], v26 offset:40960
ds_read_b128 v[108:111], v26 offset:45056
s_waitcnt lgkmcnt(5)
v_mfma_f32_32x32x16_bf16 v[64:79], v[168:171], v[120:123], v[64:79]
s_waitcnt lgkmcnt(4)
v_mfma_f32_32x32x16_bf16 v[80:95], v[168:171], v[124:127], v[80:95]
s_mov_b32 s60, 36864
buffer_load_dword v134, v28, s[56:59], s60 offen offset:0
s_waitcnt vmcnt(34) lgkmcnt(3)
v_mfma_f32_32x32x16_bf16 v[32:47], v[172:175], v[96:99], v[32:47]
ds_read_b128 v[112:115], v27 offset:32768
ds_read_b128 v[116:119], v27 offset:36864
s_waitcnt lgkmcnt(4)
v_mfma_f32_32x32x16_bf16 v[48:63], v[172:175], v[100:103], v[48:63]
ds_read_b128 v[120:123], v27 offset:40960
ds_read_b128 v[124:127], v27 offset:45056
s_waitcnt lgkmcnt(5)
v_mfma_f32_32x32x16_bf16 v[64:79], v[172:175], v[104:107], v[64:79]
s_waitcnt lgkmcnt(4)
v_mfma_f32_32x32x16_bf16 v[80:95], v[172:175], v[108:111], v[80:95]
ds_read_b128 v[8:11], v12
s_mov_b32 s60, 36864
buffer_load_dword v135, v28, s[56:59], s60 offen offset:2048
s_waitcnt vmcnt(33) lgkmcnt(0)
L_ck69:
v_min3_u32 v15, v8, v9, v10
v_min_u32 v15, v15, v11
s_nop 0
v_readfirstlane_b32 s60, v15
s_nop 0
s_cmp_ge_u32 s60, 10
s_cbranch_scc1 L_ckd70
ds_read_b128 v[8:11], v12 offset:0
s_waitcnt lgkmcnt(0)
s_branch L_ck69
L_ckd70:
v_mfma_f32_32x32x16_bf16 v[32:47], v[176:179], v[112:115], v[32:47]
ds_read_b128 v[96:99], v20 offset:0
ds_read_b128 v[100:103], v20 offset:4096
v_mfma_f32_32x32x16_bf16 v[48:63], v[176:179], v[116:119], v[48:63]
ds_read_b128 v[104:107], v20 offset:8192
ds_read_b128 v[108:111], v20 offset:12288
v_mfma_f32_32x32x16_bf16 v[64:79], v[176:179], v[120:123], v[64:79]
v_mfma_f32_32x32x16_bf16 v[80:95], v[176:179], v[124:127], v[80:95]
s_mov_b32 s60, 65536
buffer_load_dword v136, v28, s[56:59], s60 offen offset:0
s_waitcnt vmcnt(32) lgkmcnt(3)
v_mfma_f32_32x32x16_bf16 v[32:47], v[180:183], v[96:99], v[32:47]
ds_read_b128 v[112:115], v21 offset:0
ds_read_b128 v[116:119], v21 offset:4096
s_waitcnt lgkmcnt(4)
v_mfma_f32_32x32x16_bf16 v[48:63], v[180:183], v[100:103], v[48:63]
ds_read_b128 v[120:123], v21 offset:8192
ds_read_b128 v[124:127], v21 offset:12288
s_waitcnt lgkmcnt(5)
v_mfma_f32_32x32x16_bf16 v[64:79], v[180:183], v[104:107], v[64:79]
s_waitcnt lgkmcnt(4)
v_mfma_f32_32x32x16_bf16 v[80:95], v[180:183], v[108:111], v[80:95]
s_mov_b32 s60, 65536
buffer_load_dword v137, v28, s[56:59], s60 offen offset:2048
s_waitcnt vmcnt(31) lgkmcnt(3)
v_mfma_f32_32x32x16_bf16 v[32:47], v[184:187], v[112:115], v[32:47]
ds_read_b128 v[96:99], v22 offset:0
ds_read_b128 v[100:103], v22 offset:4096
s_waitcnt lgkmcnt(4)
v_mfma_f32_32x32x16_bf16 v[48:63], v[184:187], v[116:119], v[48:63]
ds_read_b128 v[104:107], v22 offset:8192
ds_read_b128 v[108:111], v22 offset:12288
s_waitcnt lgkmcnt(5)
v_mfma_f32_32x32x16_bf16 v[64:79], v[184:187], v[120:123], v[64:79]
s_waitcnt lgkmcnt(4)
v_mfma_f32_32x32x16_bf16 v[80:95], v[184:187], v[124:127], v[80:95]
s_mov_b32 s60, 69632
buffer_load_dword v138, v28, s[56:59], s60 offen offset:0
s_waitcnt vmcnt(30) lgkmcnt(3)
v_mfma_f32_32x32x16_bf16 v[32:47], v[188:191], v[96:99], v[32:47]
ds_read_b128 v[112:115], v23 offset:0
ds_read_b128 v[116:119], v23 offset:4096
s_waitcnt lgkmcnt(4)
v_mfma_f32_32x32x16_bf16 v[48:63], v[188:191], v[100:103], v[48:63]
ds_read_b128 v[120:123], v23 offset:8192
ds_read_b128 v[124:127], v23 offset:12288
s_waitcnt lgkmcnt(5)
v_mfma_f32_32x32x16_bf16 v[64:79], v[188:191], v[104:107], v[64:79]
s_waitcnt lgkmcnt(4)
v_mfma_f32_32x32x16_bf16 v[80:95], v[188:191], v[108:111], v[80:95]
s_mov_b32 s60, 69632
buffer_load_dword v139, v28, s[56:59], s60 offen offset:2048
s_waitcnt vmcnt(29) lgkmcnt(3)
v_mfma_f32_32x32x16_bf16 v[32:47], v[192:195], v[112:115], v[32:47]
ds_read_b128 v[96:99], v20 offset:16384
ds_read_b128 v[100:103], v20 offset:20480
s_waitcnt lgkmcnt(4)
v_mfma_f32_32x32x16_bf16 v[48:63], v[192:195], v[116:119], v[48:63]
ds_read_b128 v[104:107], v20 offset:24576
ds_read_b128 v[108:111], v20 offset:28672
s_waitcnt lgkmcnt(5)
v_mfma_f32_32x32x16_bf16 v[64:79], v[192:195], v[120:123], v[64:79]
s_waitcnt lgkmcnt(4)
v_mfma_f32_32x32x16_bf16 v[80:95], v[192:195], v[124:127], v[80:95]
s_mov_b32 s60, 98304
buffer_load_dword v140, v28, s[56:59], s60 offen offset:0
s_waitcnt vmcnt(28) lgkmcnt(3)
v_mfma_f32_32x32x16_bf16 v[32:47], v[196:199], v[96:99], v[32:47]
ds_read_b128 v[112:115], v21 offset:16384
ds_read_b128 v[116:119], v21 offset:20480
s_waitcnt lgkmcnt(4)
v_mfma_f32_32x32x16_bf16 v[48:63], v[196:199], v[100:103], v[48:63]
ds_read_b128 v[120:123], v21 offset:24576
ds_read_b128 v[124:127], v21 offset:28672
s_waitcnt lgkmcnt(5)
v_mfma_f32_32x32x16_bf16 v[64:79], v[196:199], v[104:107], v[64:79]
s_waitcnt lgkmcnt(4)
v_mfma_f32_32x32x16_bf16 v[80:95], v[196:199], v[108:111], v[80:95]
s_mov_b32 s60, 98304
buffer_load_dword v141, v28, s[56:59], s60 offen offset:2048
s_waitcnt vmcnt(27) lgkmcnt(3)
v_mfma_f32_32x32x16_bf16 v[32:47], v[200:203], v[112:115], v[32:47]
ds_read_b128 v[96:99], v22 offset:16384
ds_read_b128 v[100:103], v22 offset:20480
s_waitcnt lgkmcnt(4)
v_mfma_f32_32x32x16_bf16 v[48:63], v[200:203], v[116:119], v[48:63]
ds_read_b128 v[104:107], v22 offset:24576
ds_read_b128 v[108:111], v22 offset:28672
s_waitcnt lgkmcnt(5)
v_mfma_f32_32x32x16_bf16 v[64:79], v[200:203], v[120:123], v[64:79]
s_waitcnt lgkmcnt(4)
v_mfma_f32_32x32x16_bf16 v[80:95], v[200:203], v[124:127], v[80:95]
s_mov_b32 s60, 102400
buffer_load_dword v142, v28, s[56:59], s60 offen offset:0
s_waitcnt vmcnt(26) lgkmcnt(3)
v_mfma_f32_32x32x16_bf16 v[32:47], v[204:207], v[96:99], v[32:47]
ds_read_b128 v[112:115], v23 offset:16384
ds_read_b128 v[116:119], v23 offset:20480
s_waitcnt lgkmcnt(4)
v_mfma_f32_32x32x16_bf16 v[48:63], v[204:207], v[100:103], v[48:63]
ds_read_b128 v[120:123], v23 offset:24576
ds_read_b128 v[124:127], v23 offset:28672
s_waitcnt lgkmcnt(5)
v_mfma_f32_32x32x16_bf16 v[64:79], v[204:207], v[104:107], v[64:79]
s_waitcnt lgkmcnt(4)
v_mfma_f32_32x32x16_bf16 v[80:95], v[204:207], v[108:111], v[80:95]
s_mov_b32 s60, 102400
buffer_load_dword v143, v28, s[56:59], s60 offen offset:2048
s_waitcnt vmcnt(25) lgkmcnt(0)
v_mfma_f32_32x32x16_bf16 v[32:47], v[208:211], v[112:115], v[32:47]
v_mfma_f32_32x32x16_bf16 v[48:63], v[208:211], v[116:119], v[48:63]
v_mfma_f32_32x32x16_bf16 v[64:79], v[208:211], v[120:123], v[64:79]
v_mfma_f32_32x32x16_bf16 v[80:95], v[208:211], v[124:127], v[80:95]
s_mul_i32 s60, s37, 0x9e3779b1
s_and_b32 s60, s60, 0xbfff0000
s_or_b32 s60, s60, 0x20000000
s_lshl_b32 s64, s35, 4
s_add_u32 s64, s64, s36
s_lshl_b32 s64, s64, 2
s_add_u32 s64, s64, s34
s_lshl_b32 s64, s64, 13
s_add_u32 s50, s64, 33554432
s_add_u32 s48, s32, s50
s_addc_u32 s49, s33, 0
s_mov_b32 s50, 8192
s_mov_b32 s51, 0x20000
s_xor_b32 s64, s64, 262144
s_add_u32 s54, s64, 33554432
s_add_u32 s52, s32, s54
s_addc_u32 s53, s33, 0
s_mov_b32 s54, 8192
s_mov_b32 s55, 0x20000
s_movk_i32 s64, 0x1000
v_cvt_pk_bf16_f32 v96, v32, v48
v_cvt_pk_bf16_f32 v97, v33, v49
v_cvt_pk_bf16_f32 v98, v34, v50
v_cvt_pk_bf16_f32 v99, v35, s60
buffer_store_dwordx4 v[96:99], v2, s[48:51], 0 offen offset:0 sc1
v_cvt_pk_bf16_f32 v100, v51, v36
v_cvt_pk_bf16_f32 v101, v52, v37
v_cvt_pk_bf16_f32 v102, v53, v38
v_cvt_pk_bf16_f32 v103, v54, s60
buffer_store_dwordx4 v[100:103], v2, s[48:51], 0 offen offset:1024 sc1
v_cvt_pk_bf16_f32 v104, v39, v55
v_cvt_pk_bf16_f32 v105, v40, v56
v_cvt_pk_bf16_f32 v106, v41, v57
v_cvt_pk_bf16_f32 v107, v42, s60
buffer_store_dwordx4 v[104:107], v2, s[48:51], 0 offen offset:2048 sc1
v_cvt_pk_bf16_f32 v108, v58, v43
v_cvt_pk_bf16_f32 v109, v59, v44
v_cvt_pk_bf16_f32 v110, v60, v45
v_cvt_pk_bf16_f32 v111, v61, s60
buffer_store_dwordx4 v[108:111], v2, s[48:51], 0 offen offset:3072 sc1
v_cvt_pk_bf16_f32 v112, v46, v62
v_cvt_pk_bf16_f32 v113, v47, v63
v_cvt_pk_bf16_f32 v114, v63, v63
v_cvt_pk_bf16_f32 v115, v63, s60
buffer_store_dwordx4 v[112:115], v2, s[48:51], s64 offen offset:0 sc1
s_waitcnt vmcnt(5)
v_lshlrev_b32 v8, 16, v31
v_and_b32 v9, 0xffff0000, v31
v_lshlrev_b32 v148, 16, v128
v_and_b32 v149, 0xffff0000, v128
v_pk_mul_f32 v[148:149], v[148:149], v[8:9]
v_cvt_pk_bf16_f32 v10, v148, v149
v_lshlrev_b32 v148, 16, v10
v_and_b32 v149, 0xffff0000, v10
v_add_f32 v148, v148, v64
v_add_f32 v149, v149, v80
v_lshlrev_b32 v150, 16, v129
v_and_b32 v151, 0xffff0000, v129
v_pk_mul_f32 v[150:151], v[150:151], v[8:9]
v_cvt_pk_bf16_f32 v10, v150, v151
v_lshlrev_b32 v150, 16, v10
v_and_b32 v151, 0xffff0000, v10
v_add_f32 v150, v150, v65
v_add_f32 v151, v151, v81
v_lshlrev_b32 v152, 16, v130
v_and_b32 v153, 0xffff0000, v130
v_pk_mul_f32 v[152:153], v[152:153], v[8:9]
v_cvt_pk_bf16_f32 v10, v152, v153
v_lshlrev_b32 v152, 16, v10
v_and_b32 v153, 0xffff0000, v10
v_add_f32 v152, v152, v66
v_add_f32 v153, v153, v82
v_lshlrev_b32 v154, 16, v131
v_and_b32 v155, 0xffff0000, v131
v_pk_mul_f32 v[154:155], v[154:155], v[8:9]
v_cvt_pk_bf16_f32 v10, v154, v155
v_lshlrev_b32 v154, 16, v10
v_and_b32 v155, 0xffff0000, v10
v_add_f32 v154, v154, v67
v_add_f32 v155, v155, v83
v_lshlrev_b32 v156, 16, v132
v_and_b32 v157, 0xffff0000, v132
v_pk_mul_f32 v[156:157], v[156:157], v[8:9]
v_cvt_pk_bf16_f32 v10, v156, v157
v_lshlrev_b32 v156, 16, v10
v_and_b32 v157, 0xffff0000, v10
v_add_f32 v156, v156, v68
v_add_f32 v157, v157, v84
v_lshlrev_b32 v158, 16, v133
v_and_b32 v159, 0xffff0000, v133
v_pk_mul_f32 v[158:159], v[158:159], v[8:9]
v_cvt_pk_bf16_f32 v10, v158, v159
v_lshlrev_b32 v158, 16, v10
v_and_b32 v159, 0xffff0000, v10
v_add_f32 v158, v158, v69
v_add_f32 v159, v159, v85
v_lshlrev_b32 v160, 16, v134
v_and_b32 v161, 0xffff0000, v134
v_pk_mul_f32 v[160:161], v[160:161], v[8:9]
v_cvt_pk_bf16_f32 v10, v160, v161
v_lshlrev_b32 v160, 16, v10
v_and_b32 v161, 0xffff0000, v10
v_add_f32 v160, v160, v70
v_add_f32 v161, v161, v86
v_lshlrev_b32 v162, 16, v135
v_and_b32 v163, 0xffff0000, v135
v_pk_mul_f32 v[162:163], v[162:163], v[8:9]
v_cvt_pk_bf16_f32 v10, v162, v163
v_lshlrev_b32 v162, 16, v10
v_and_b32 v163, 0xffff0000, v10
v_add_f32 v162, v162, v71
v_add_f32 v163, v163, v87
v_lshlrev_b32 v164, 16, v136
v_and_b32 v165, 0xffff0000, v136
v_pk_mul_f32 v[164:165], v[164:165], v[8:9]
v_cvt_pk_bf16_f32 v10, v164, v165
v_lshlrev_b32 v164, 16, v10
v_and_b32 v165, 0xffff0000, v10
v_add_f32 v164, v164, v72
v_add_f32 v165, v165, v88
v_lshlrev_b32 v166, 16, v137
v_and_b32 v167, 0xffff0000, v137
v_pk_mul_f32 v[166:167], v[166:167], v[8:9]
v_cvt_pk_bf16_f32 v10, v166, v167
v_lshlrev_b32 v166, 16, v10
v_and_b32 v167, 0xffff0000, v10
v_add_f32 v166, v166, v73
v_add_f32 v167, v167, v89
v_lshlrev_b32 v168, 16, v138
v_and_b32 v169, 0xffff0000, v138
v_pk_mul_f32 v[168:169], v[168:169], v[8:9]
v_cvt_pk_bf16_f32 v10, v168, v169
v_lshlrev_b32 v168, 16, v10
v_and_b32 v169, 0xffff0000, v10
v_add_f32 v168, v168, v74
v_add_f32 v169, v169, v90
v_lshlrev_b32 v170, 16, v139
v_and_b32 v171, 0xffff0000, v139
v_pk_mul_f32 v[170:171], v[170:171], v[8:9]
v_cvt_pk_bf16_f32 v10, v170, v171
v_lshlrev_b32 v170, 16, v10
v_and_b32 v171, 0xffff0000, v10
v_add_f32 v170, v170, v75
v_add_f32 v171, v171, v91
v_lshlrev_b32 v172, 16, v140
v_and_b32 v173, 0xffff0000, v140
v_pk_mul_f32 v[172:173], v[172:173], v[8:9]
v_cvt_pk_bf16_f32 v10, v172, v173
v_lshlrev_b32 v172, 16, v10
v_and_b32 v173, 0xffff0000, v10
v_add_f32 v172, v172, v76
v_add_f32 v173, v173, v92
v_lshlrev_b32 v174, 16, v141
v_and_b32 v175, 0xffff0000, v141
v_pk_mul_f32 v[174:175], v[174:175], v[8:9]
v_cvt_pk_bf16_f32 v10, v174, v175
v_lshlrev_b32 v174, 16, v10
v_and_b32 v175, 0xffff0000, v10
v_add_f32 v174, v174, v77
v_add_f32 v175, v175, v93
v_lshlrev_b32 v176, 16, v142
v_and_b32 v177, 0xffff0000, v142
v_pk_mul_f32 v[176:177], v[176:177], v[8:9]
v_cvt_pk_bf16_f32 v10, v176, v177
v_lshlrev_b32 v176, 16, v10
v_and_b32 v177, 0xffff0000, v10
v_add_f32 v176, v176, v78
v_add_f32 v177, v177, v94
v_lshlrev_b32 v178, 16, v143
v_and_b32 v179, 0xffff0000, v143
v_pk_mul_f32 v[178:179], v[178:179], v[8:9]
v_cvt_pk_bf16_f32 v10, v178, v179
v_lshlrev_b32 v178, 16, v10
v_and_b32 v179, 0xffff0000, v10
v_add_f32 v178, v178, v79
v_add_f32 v179, v179, v95
s_mov_b32 s44, s28
s_mov_b32 s45, s29
s_mov_b32 s46, s24
s_mov_b32 s47, 0x20000
s_mov_b32 s92, 0
s_waitcnt vmcnt(0)
buffer_load_dwordx4 v[180:183], v2, s[52:55], 0 offen offset:0 sc1
buffer_load_dwordx4 v[184:187], v2, s[52:55], 0 offen offset:1024 sc1
buffer_load_dwordx4 v[188:191], v2, s[52:55], 0 offen offset:2048 sc1
buffer_load_dwordx4 v[192:195], v2, s[52:55], 0 offen offset:3072 sc1
buffer_load_dwordx4 v[196:199], v2, s[52:55], s64 offen offset:0 sc1
L_xl71:
v_mov_b32 v10, 0
s_waitcnt vmcnt(4)
v_bitop3_b32 v10, v10, v183, s60 bitop3:0xf6
s_waitcnt vmcnt(3)
v_bitop3_b32 v10, v10, v187, s60 bitop3:0xf6
s_waitcnt vmcnt(2)
v_bitop3_b32 v10, v10, v191, s60 bitop3:0xf6
s_waitcnt vmcnt(1)
v_bitop3_b32 v10, v10, v195, s60 bitop3:0xf6
s_waitcnt vmcnt(0)
v_bitop3_b32 v10, v10, v199, s60 bitop3:0xf6
v_cmp_lt_u32 vcc, 0xffff, v10
s_nop 0
s_cbranch_vccz L_xd72
s_add_u32 s92, s92, 1
s_cmp_ge_u32 s92, 200000
s_cbranch_scc1 L_xd72
buffer_load_dwordx4 v[180:183], v2, s[52:55], 0 offen offset:0 sc1
buffer_load_dwordx4 v[184:187], v2, s[52:55], 0 offen offset:1024 sc1
buffer_load_dwordx4 v[188:191], v2, s[52:55], 0 offen offset:2048 sc1
buffer_load_dwordx4 v[192:195], v2, s[52:55], 0 offen offset:3072 sc1
buffer_load_dwordx4 v[196:199], v2, s[52:55], s64 offen offset:0 sc1
s_branch L_xl71
L_xd72:
v_lshlrev_b32 v10, 16, v180
v_and_b32 v11, 0xffff0000, v180
v_pk_add_f32 v[148:149], v[148:149], v[10:11]
s_mov_b32 s64, 0
buffer_store_dwordx2 v[148:149], v29, s[44:47], s64 offen nt
v_lshlrev_b32 v10, 16, v181
v_and_b32 v11, 0xffff0000, v181
v_pk_add_f32 v[150:151], v[150:151], v[10:11]
s_mov_b32 s64, 8192
buffer_store_dwordx2 v[150:151], v29, s[44:47], s64 offen nt
v_lshlrev_b32 v10, 16, v182
v_and_b32 v11, 0xffff0000, v182
v_pk_add_f32 v[152:153], v[152:153], v[10:11]
s_mov_b32 s64, 16384
buffer_store_dwordx2 v[152:153], v29, s[44:47], s64 offen nt
v_lshlrev_b32 v10, 16, v183
v_lshlrev_b32 v11, 16, v184
v_pk_add_f32 v[154:155], v[154:155], v[10:11]
s_mov_b32 s64, 24576
buffer_store_dwordx2 v[154:155], v29, s[44:47], s64 offen nt
v_and_b32 v10, 0xffff0000, v184
v_lshlrev_b32 v11, 16, v185
v_pk_add_f32 v[156:157], v[156:157], v[10:11]
s_mov_b32 s64, 131072
buffer_store_dwordx2 v[156:157], v29, s[44:47], s64 offen nt
v_and_b32 v10, 0xffff0000, v185
v_lshlrev_b32 v11, 16, v186
v_pk_add_f32 v[158:159], v[158:159], v[10:11]
s_mov_b32 s64, 139264
buffer_store_dwordx2 v[158:159], v29, s[44:47], s64 offen nt
v_and_b32 v10, 0xffff0000, v186
v_lshlrev_b32 v11, 16, v187
v_pk_add_f32 v[160:161], v[160:161], v[10:11]
s_mov_b32 s64, 147456
buffer_store_dwordx2 v[160:161], v29, s[44:47], s64 offen nt
v_lshlrev_b32 v10, 16, v188
v_and_b32 v11, 0xffff0000, v188
v_pk_add_f32 v[162:163], v[162:163], v[10:11]
s_mov_b32 s64, 155648
buffer_store_dwordx2 v[162:163], v29, s[44:47], s64 offen nt
v_lshlrev_b32 v10, 16, v189
v_and_b32 v11, 0xffff0000, v189
v_pk_add_f32 v[164:165], v[164:165], v[10:11]
s_mov_b32 s64, 262144
buffer_store_dwordx2 v[164:165], v29, s[44:47], s64 offen nt
v_lshlrev_b32 v10, 16, v190
v_and_b32 v11, 0xffff0000, v190
v_pk_add_f32 v[166:167], v[166:167], v[10:11]
s_mov_b32 s64, 270336
buffer_store_dwordx2 v[166:167], v29, s[44:47], s64 offen nt
v_lshlrev_b32 v10, 16, v191
v_lshlrev_b32 v11, 16, v192
v_pk_add_f32 v[168:169], v[168:169], v[10:11]
s_mov_b32 s64, 278528
buffer_store_dwordx2 v[168:169], v29, s[44:47], s64 offen nt
v_and_b32 v10, 0xffff0000, v192
v_lshlrev_b32 v11, 16, v193
v_pk_add_f32 v[170:171], v[170:171], v[10:11]
s_mov_b32 s64, 286720
buffer_store_dwordx2 v[170:171], v29, s[44:47], s64 offen nt
v_and_b32 v10, 0xffff0000, v193
v_lshlrev_b32 v11, 16, v194
v_pk_add_f32 v[172:173], v[172:173], v[10:11]
s_mov_b32 s64, 393216
buffer_store_dwordx2 v[172:173], v29, s[44:47], s64 offen nt
v_and_b32 v10, 0xffff0000, v194
v_lshlrev_b32 v11, 16, v195
v_pk_add_f32 v[174:175], v[174:175], v[10:11]
s_mov_b32 s64, 401408
buffer_store_dwordx2 v[174:175], v29, s[44:47], s64 offen nt
v_lshlrev_b32 v10, 16, v196
v_and_b32 v11, 0xffff0000, v196
v_pk_add_f32 v[176:177], v[176:177], v[10:11]
s_mov_b32 s64, 409600
buffer_store_dwordx2 v[176:177], v29, s[44:47], s64 offen nt
v_lshlrev_b32 v10, 16, v197
v_and_b32 v11, 0xffff0000, v197
v_pk_add_f32 v[178:179], v[178:179], v[10:11]
s_mov_b32 s64, 417792
buffer_store_dwordx2 v[178:179], v29, s[44:47], s64 offen nt
L_concat_heads__spectral_gfnet__ssm_conv_s5__prompt_kernel_end:
s_endpgm

.section .rodata,"a"
.p2align 6
.amdhsa_kernel concat_heads__spectral_gfnet__ssm_conv_s5__prompt_kernel
  .amdhsa_next_free_vgpr 256
  .amdhsa_next_free_sgpr 102
  .amdhsa_accum_offset 256
  .amdhsa_group_segment_fixed_size 0
  .amdhsa_kernarg_size 120
  .amdhsa_user_sgpr_count 2
  .amdhsa_user_sgpr_kernarg_segment_ptr 1
  .amdhsa_system_sgpr_workgroup_id_x 1
.end_amdhsa_kernel
.text
```

```asm
; @launch grid=(256,1,1) block=(512,1,1) lds=163840
.amdgcn_target "amdgcn-amd-amdhsa--gfx950"
.text
.globl concat_heads__spectral_gfnet__ssm_conv_s5__prompt_kernel
.p2align 8
.type concat_heads__spectral_gfnet__ssm_conv_s5__prompt_kernel,@function
concat_heads__spectral_gfnet__ssm_conv_s5__prompt_kernel:
s_cmp_ge_u32 s2, 256
s_cbranch_scc1 L_concat_heads__spectral_gfnet__ssm_conv_s5__prompt_kernel_end
s_load_dwordx16 s[4:19], s[0:1], 0
s_load_dwordx8 s[20:27], s[0:1], 64
s_load_dwordx4 s[28:31], s[0:1], 96
s_load_dwordx2 s[32:33], s[0:1], 112
v_lshrrev_b32 v2, 6, v0
v_and_b32 v1, 63, v0
v_readfirstlane_b32 s34, v2
s_and_b32 s60, s2, 7
s_lshr_b32 s61, s2, 3
s_lshr_b32 s35, s60, 1
s_lshl_b32 s35, s35, 2
s_lshr_b32 s62, s61, 3
s_add_u32 s35, s35, s62
s_and_b32 s36, s60, 1
s_lshl_b32 s36, s36, 3
s_and_b32 s62, s61, 7
s_add_u32 s36, s36, s62
s_cmp_ge_u32 s34, 4
s_cbranch_scc0 L_concat_heads__spectral_gfnet__ssm_conv_s5__prompt_kernel_gemm
s_sub_u32 s66, s34, 4
v_lshrrev_b32 v2, 5, v1
v_bfe_u32 v3, v1, 3, 2
v_and_b32 v4, 1, v3
v_lshrrev_b32 v5, 1, v3
v_lshlrev_b32 v6, 5, v2
v_lshl_add_u32 v6, v4, 4, v6
v_add_u32 v6, v6, v5
s_lshr_b32 s60, s66, 1
s_lshl_b32 s61, s60, 6
s_and_b32 s62, s66, 1
s_lshl_b32 s62, s62, 3
s_add_u32 s61, s61, s62
v_add_u32 v6, s61, v6
v_lshlrev_b32 v6, 11, v6
s_lshl_b32 s61, s60, 5
v_lshl_add_u32 v7, v2, 3, v3
v_add_u32 v7, s61, v7
v_lshlrev_b32 v7, 11, v7
v_and_b32 v4, 7, v1
v_lshrrev_b32 v5, 4, v1
v_xor_b32 v4, v4, v5
v_lshlrev_b32 v4, 4, v4
v_xor_b32 v5, 64, v4
v_add_u32 v176, v6, v4
v_add_u32 v180, v7, v4
v_add_u32 v177, v6, v5
v_add_u32 v177, 3072, v177
v_add_u32 v181, v7, v5
v_add_u32 v181, 7168, v181
v_add_u32 v178, v6, v4
v_add_u32 v178, 6144, v178
v_add_u32 v182, v7, v4
v_add_u32 v182, 30720, v182
v_add_u32 v179, v6, v5
v_add_u32 v179, 9216, v179
v_add_u32 v183, v7, v5
v_add_u32 v183, 37888, v183
s_and_b32 s64, s2, 7
s_mul_i32 s64, s64, 0
s_add_u32 s60, s35, s36
s_and_b32 s60, s60, 0
s_mul_i32 s60, s60, 2048
s_add_u32 s64, s64, s60
s_mul_i32 s60, s35, 128
s_add_u32 s64, s64, s60
s_mul_i32 s60, s36, 128
s_add_u32 s64, s64, s60
s_lshl_b32 s60, s35, 18
s_lshl_b32 s61, s36, 17
s_waitcnt lgkmcnt(0)
s_lshl_b32 s25, s66, 12
s_mov_b32 s24, s64
s_add_u32 s12, s10, s60
s_addc_u32 s13, s11, 0
s_mov_b32 s14, 262144
s_mov_b32 s15, 0x20000
s_bitcmp1_b32 s66, 0
s_cselect_b32 s62, s18, s16
s_cselect_b32 s63, s19, s17
s_add_u32 s20, s62, s61
s_addc_u32 s21, s63, 0
s_mov_b32 s22, 131072
s_mov_b32 s23, 0x20000
s_add_u32 m0, s25, 0
s_add_u32 s26, s24, 0
s_and_b32 s26, s26, 0x7ff
buffer_load_dwordx4 v176, s[12:15], s26 offen offset:0 lds
buffer_load_dwordx4 v177, s[12:15], s26 offen offset:1024 lds
buffer_load_dwordx4 v178, s[12:15], s26 offen offset:2048 lds
buffer_load_dwordx4 v179, s[12:15], s26 offen offset:3072 lds
s_add_u32 m0, s25, 16384
s_nop 0
buffer_load_dwordx4 v180, s[20:23], s26 offen offset:0 lds
buffer_load_dwordx4 v181, s[20:23], s26 offen offset:1024 lds
buffer_load_dwordx4 v182, s[20:23], s26 offen offset:2048 lds
buffer_load_dwordx4 v183, s[20:23], s26 offen offset:3072 lds
s_mov_b32 s48, s6
s_mov_b32 s49, s7
s_mov_b32 s50, 2101248
s_mov_b32 s51, 0x20000
s_mov_b32 s52, s8
s_mov_b32 s53, s9
s_mov_b32 s54, 2101248
s_mov_b32 s55, 0x20000
s_and_b32 s60, s2, 31
s_lshr_b32 s61, s2, 5
s_lshl_b32 s61, s61, 7
s_add_u32 s60, s60, s61
s_lshl_b32 s61, s66, 5
s_add_u32 s67, s60, s61
s_lshl_b32 s60, s67, 12
s_add_u32 s4, s4, s60
s_addc_u32 s5, s5, 0
s_mov_b32 s6, 4096
s_mov_b32 s7, 0x20000
v_lshlrev_b32 v2, 4, v1
v_xor_b32 v3, 128, v2
s_lshl_b32 s68, s66, 12
s_add_u32 s68, s68, 131072
s_and_b32 s60, s2, 7
s_bfe_u32 s61, s2, 0x10003
s_bfe_u32 s62, s2, 0x20004
s_lshr_b32 s63, s2, 6
s_lshr_b32 s64, s60, 1
s_lshl_b32 s64, s64, 3
s_lshl_b32 s65, s61, 2
s_add_u32 s64, s64, s65
s_and_b32 s65, s60, 1
s_lshl_b32 s65, s65, 1
s_add_u32 s64, s64, s65
s_lshl_b32 s64, s64, 5
s_lshl_b32 s65, s62, 3
s_add_u32 s64, s64, s65
s_lshl_b32 s65, s66, 1
s_add_u32 s64, s64, s65
s_mul_i32 s64, s64, 1026
s_lshl_b32 s65, s63, 8
s_add_u32 s69, s64, s65
v_bfe_u32 v8, v1, 4, 1
v_mul_u32_u24 v8, 32832, v8
v_lshrrev_b32 v9, 5, v1
s_mov_b32 s65, 1050624
v_mul_lo_u32 v9, s65, v9
v_add_u32 v8, v8, v9
v_and_b32 v9, 15, v1
s_lshl_b32 s65, s66, 1
v_xor_b32 v9, s65, v9
v_lshl_add_u32 v18, v9, 4, v8
v_xor_b32 v9, 1, v9
v_lshl_add_u32 v19, v9, 4, v8
v_add_u32 v19, 1026, v19
s_bfe_u32 s64, s2, 0x20005
s_lshl_b32 s64, s64, 8
s_bfe_u32 s65, s2, 0x10004
s_lshl_b32 s65, s65, 6
s_add_u32 s64, s64, s65
s_bfe_u32 s65, s2, 0x10003
s_lshl_b32 s65, s65, 7
s_add_u32 s64, s64, s65
s_and_b32 s65, s2, 7
s_lshl_b32 s65, s65, 2
s_add_u32 s64, s64, s65
v_bfe_u32 v8, v1, 3, 2
v_add_u32 v8, s64, v8
v_bfe_u32 v9, v1, 2, 1
v_lshl_add_u32 v8, v9, 5, v8
v_bfe_u32 v9, v1, 1, 1
v_lshl_add_u32 v8, v9, 10, v8
v_sub_u32 v9, 2048, v8
v_and_b32 v9, 2047, v9
v_and_b32 v10, 1, v1
v_cmp_eq_u32 vcc, 1, v10
s_nop 1
v_cndmask_b32 v8, v8, v9, vcc
v_mul_u32_u24 v17, 1026, v8
s_lshr_b32 s64, s2, 7
s_lshl_b32 s64, s64, 10
v_add_u32 v17, s64, v17
v_mov_b32 v184, 126992
s_lshl_b32 s64, s66, 2
v_add_u32 v185, s64, v184
v_and_b32 v8, 31, v1
v_lshrrev_b32 v9, 5, v1
v_and_b32 v10, 1, v1
v_lshrrev_b32 v11, 1, v8
v_lshlrev_b32 v4, 6, v11
v_lshl_add_u32 v4, v10, 4, v4
v_lshl_add_u32 v4, v9, 12, v4
v_add_u32 v11, v11, v10
v_lshlrev_b32 v11, 6, v11
v_lshl_add_u32 v11, v10, 4, v11
v_lshl_add_u32 v11, v9, 12, v11
v_sub_u32 v5, 5168, v11
v_bfe_u32 v11, v4, 7, 1
v_lshlrev_b32 v11, 5, v11
v_xor_b32 v4, v4, v11
v_bfe_u32 v11, v5, 7, 1
v_lshlrev_b32 v11, 5, v11
v_xor_b32 v5, v5, v11
v_add_u32 v6, 11264, v5
v_and_b32 v6, 0x3fff, v6
s_add_u32 s64, s64, 98304
v_add_u32 v4, s64, v4
v_add_u32 v5, s64, v5
v_add_u32 v6, s64, v6
v_bfe_u32 v11, v1, 3, 1
v_lshlrev_b32 v11, 5, v11
v_xor_b32 v7, v2, v11
v_bfe_u32 v12, v1, 2, 1
v_mul_u32_u24 v12, 2176, v12
v_bfe_u32 v13, v1, 3, 1
v_lshl_add_u32 v12, v13, 6, v12
v_lshl_add_u32 v12, v9, 8, v12
v_bfe_u32 v13, v1, 4, 1
v_lshl_add_u32 v12, v13, 5, v12
v_and_b32 v13, 3, v1
v_lshl_add_u32 v12, v13, 3, v12
v_add_u32 v12, s68, v12
v_xor_b32 v13, 128, v12
s_lshl_b32 s64, s2, 14
s_lshl_b32 s65, s66, 12
s_add_u32 s64, s64, s65
s_add_u32 s42, s64, 16777216
s_add_u32 s40, s32, s42
s_addc_u32 s41, s33, 0
s_mov_b32 s42, 4096
s_mov_b32 s43, 0x20000
s_add_u32 s46, s64, 16777216
s_add_u32 s44, s32, s46
s_addc_u32 s45, s33, 0
s_mov_b32 s46, 4096
s_mov_b32 s47, 0x20000
v_and_b32 v14, 7, v1
v_lshrrev_b32 v15, 3, v1
v_xor_b32 v16, v14, v15
v_lshlrev_b32 v16, 4, v16
v_lshl_add_u32 v16, v14, 11, v16
s_lshr_b32 s64, s66, 1
s_lshl_b32 s64, s64, 7
s_and_b32 s65, s66, 1
s_lshl_b32 s65, s65, 3
s_add_u32 s64, s64, s65
s_add_u32 s64, s64, 147456
v_add_u32 v16, s64, v16
v_lshlrev_b32 v15, 16, v15
v_lshl_add_u32 v15, v14, 4, v15
s_lshl_b32 s64, s63, 7
s_lshr_b32 s65, s66, 1
s_lshl_b32 s65, s65, 6
s_add_u32 s64, s64, s65
s_and_b32 s65, s66, 1
s_lshl_b32 s65, s65, 2
s_add_u32 s64, s64, s65
s_mul_i32 s64, s64, 8192
s_lshr_b32 s65, s60, 2
s_mul_i32 s65, s65, 0
s_add_u32 s64, s64, s65
s_lshl_b32 s65, s60, 10
s_add_u32 s64, s64, s65
s_lshl_b32 s65, s61, 9
s_add_u32 s64, s64, s65
s_lshl_b32 s65, s62, 7
s_add_u32 s64, s64, s65
s_add_u32 s58, s64, 25182208
s_add_u32 s56, s32, s58
s_addc_u32 s57, s33, 0
s_sub_u32 s58, 4194304, s64
s_mov_b32 s59, 0x20000
v_and_b32 v104, 31, v1
v_cvt_f32_u32 v104, v104
v_lshrrev_b32 v105, 5, v1
v_lshlrev_b32 v105, 2, v105
v_cvt_f32_u32 v105, v105
v_mul_f32 v105, v104, v105
v_mul_f32 v105, 0x3d000000, v105
v_fmamk_f32 v106, v104, 0x0, v105
v_fract_f32 v106, v106
v_cos_f32 v107, v106
v_sin_f32 v108, v106
s_nop 0
v_cvt_pk_bf16_f32 v192, v107, v108
v_cvt_pk_bf16_f32 v208, -v108, v107
v_fmamk_f32 v109, v104, 0x3d000000, v105
v_fract_f32 v109, v109
v_cos_f32 v110, v109
v_sin_f32 v111, v109
s_nop 0
v_cvt_pk_bf16_f32 v193, v110, v111
v_cvt_pk_bf16_f32 v209, -v111, v110
v_fmamk_f32 v106, v104, 0x3d800000, v105
v_fract_f32 v106, v106
v_cos_f32 v107, v106
v_sin_f32 v108, v106
s_nop 0
v_cvt_pk_bf16_f32 v194, v107, v108
v_cvt_pk_bf16_f32 v210, -v108, v107
v_fmamk_f32 v109, v104, 0x3dc00000, v105
v_fract_f32 v109, v109
v_cos_f32 v110, v109
v_sin_f32 v111, v109
s_nop 0
v_cvt_pk_bf16_f32 v195, v110, v111
v_cvt_pk_bf16_f32 v211, -v111, v110
v_fmamk_f32 v106, v104, 0x3e800000, v105
v_fract_f32 v106, v106
v_cos_f32 v107, v106
v_sin_f32 v108, v106
s_nop 0
v_cvt_pk_bf16_f32 v196, v107, v108
v_cvt_pk_bf16_f32 v212, -v108, v107
v_fmamk_f32 v109, v104, 0x3e900000, v105
v_fract_f32 v109, v109
v_cos_f32 v110, v109
v_sin_f32 v111, v109
s_nop 0
v_cvt_pk_bf16_f32 v197, v110, v111
v_cvt_pk_bf16_f32 v213, -v111, v110
v_fmamk_f32 v106, v104, 0x3ea00000, v105
v_fract_f32 v106, v106
v_cos_f32 v107, v106
v_sin_f32 v108, v106
s_nop 0
v_cvt_pk_bf16_f32 v198, v107, v108
v_cvt_pk_bf16_f32 v214, -v108, v107
v_fmamk_f32 v109, v104, 0x3eb00000, v105
v_fract_f32 v109, v109
v_cos_f32 v110, v109
v_sin_f32 v111, v109
s_nop 0
v_cvt_pk_bf16_f32 v199, v110, v111
v_cvt_pk_bf16_f32 v215, -v111, v110
v_fmamk_f32 v106, v104, 0x3f000000, v105
v_fract_f32 v106, v106
v_cos_f32 v107, v106
v_sin_f32 v108, v106
s_nop 0
v_cvt_pk_bf16_f32 v200, v107, v108
v_cvt_pk_bf16_f32 v216, -v108, v107
v_fmamk_f32 v109, v104, 0x3f080000, v105
v_fract_f32 v109, v109
v_cos_f32 v110, v109
v_sin_f32 v111, v109
s_nop 0
v_cvt_pk_bf16_f32 v201, v110, v111
v_cvt_pk_bf16_f32 v217, -v111, v110
v_fmamk_f32 v106, v104, 0x3f100000, v105
v_fract_f32 v106, v106
v_cos_f32 v107, v106
v_sin_f32 v108, v106
s_nop 0
v_cvt_pk_bf16_f32 v202, v107, v108
v_cvt_pk_bf16_f32 v218, -v108, v107
v_fmamk_f32 v109, v104, 0x3f180000, v105
v_fract_f32 v109, v109
v_cos_f32 v110, v109
v_sin_f32 v111, v109
s_nop 0
v_cvt_pk_bf16_f32 v203, v110, v111
v_cvt_pk_bf16_f32 v219, -v111, v110
v_fmamk_f32 v106, v104, 0x3f400000, v105
v_fract_f32 v106, v106
v_cos_f32 v107, v106
v_sin_f32 v108, v106
s_nop 0
v_cvt_pk_bf16_f32 v204, v107, v108
v_cvt_pk_bf16_f32 v220, -v108, v107
v_fmamk_f32 v109, v104, 0x3f480000, v105
v_fract_f32 v109, v109
v_cos_f32 v110, v109
v_sin_f32 v111, v109
s_nop 0
v_cvt_pk_bf16_f32 v205, v110, v111
v_cvt_pk_bf16_f32 v221, -v111, v110
v_fmamk_f32 v106, v104, 0x3f500000, v105
v_fract_f32 v106, v106
v_cos_f32 v107, v106
v_sin_f32 v108, v106
s_nop 0
v_cvt_pk_bf16_f32 v206, v107, v108
v_cvt_pk_bf16_f32 v222, -v108, v107
v_fmamk_f32 v109, v104, 0x3f580000, v105
v_fract_f32 v109, v109
v_cos_f32 v110, v109
v_sin_f32 v111, v109
s_nop 0
v_cvt_pk_bf16_f32 v207, v110, v111
v_cvt_pk_bf16_f32 v223, -v111, v110
v_and_b32 v104, 31, v1
v_cvt_f32_u32 v104, v104
v_lshrrev_b32 v105, 5, v1
v_lshlrev_b32 v105, 2, v105
v_cvt_f32_u32 v105, v105
v_mul_f32 v105, v104, v105
v_mul_f32 v105, 0x3a800000, v105
v_fmamk_f32 v106, v104, 0x0, v105
v_cos_f32 v224, v106
v_sin_f32 v240, -v106
v_fmamk_f32 v107, v104, 0x3a800000, v105
v_cos_f32 v225, v107
v_sin_f32 v241, -v107
v_fmamk_f32 v106, v104, 0x3b000000, v105
v_cos_f32 v226, v106
v_sin_f32 v242, -v106
v_fmamk_f32 v107, v104, 0x3b400000, v105
v_cos_f32 v227, v107
v_sin_f32 v243, -v107
v_fmamk_f32 v106, v104, 0x3c000000, v105
v_cos_f32 v228, v106
v_sin_f32 v244, -v106
v_fmamk_f32 v107, v104, 0x3c100000, v105
v_cos_f32 v229, v107
v_sin_f32 v245, -v107
v_fmamk_f32 v106, v104, 0x3c200000, v105
v_cos_f32 v230, v106
v_sin_f32 v246, -v106
v_fmamk_f32 v107, v104, 0x3c300000, v105
v_cos_f32 v231, v107
v_sin_f32 v247, -v107
v_fmamk_f32 v106, v104, 0x3c800000, v105
v_cos_f32 v232, v106
v_sin_f32 v248, -v106
v_fmamk_f32 v107, v104, 0x3c880000, v105
v_cos_f32 v233, v107
v_sin_f32 v249, -v107
v_fmamk_f32 v106, v104, 0x3c900000, v105
v_cos_f32 v234, v106
v_sin_f32 v250, -v106
v_fmamk_f32 v107, v104, 0x3c980000, v105
v_cos_f32 v235, v107
v_sin_f32 v251, -v107
v_fmamk_f32 v106, v104, 0x3cc00000, v105
v_cos_f32 v236, v106
v_sin_f32 v252, -v106
v_fmamk_f32 v107, v104, 0x3cc80000, v105
v_cos_f32 v237, v107
v_sin_f32 v253, -v107
v_fmamk_f32 v106, v104, 0x3cd00000, v105
v_cos_f32 v238, v106
v_sin_f32 v254, -v106
v_fmamk_f32 v107, v104, 0x3cd80000, v105
v_cos_f32 v239, v107
v_sin_f32 v255, -v107
s_add_u32 m0, s25, 32768
s_add_u32 s26, s24, 128
s_and_b32 s26, s26, 0x7ff
buffer_load_dwordx4 v176, s[12:15], s26 offen offset:0 lds
buffer_load_dwordx4 v177, s[12:15], s26 offen offset:1024 lds
buffer_load_dwordx4 v178, s[12:15], s26 offen offset:2048 lds
buffer_load_dwordx4 v179, s[12:15], s26 offen offset:3072 lds
s_add_u32 m0, s25, 49152
s_nop 0
buffer_load_dwordx4 v180, s[20:23], s26 offen offset:0 lds
buffer_load_dwordx4 v181, s[20:23], s26 offen offset:1024 lds
buffer_load_dwordx4 v182, s[20:23], s26 offen offset:2048 lds
buffer_load_dwordx4 v183, s[20:23], s26 offen offset:3072 lds
s_waitcnt vmcnt(8)
s_barrier
s_add_u32 m0, s25, 65536
s_add_u32 s26, s24, 256
s_and_b32 s26, s26, 0x7ff
buffer_load_dwordx4 v176, s[12:15], s26 offen offset:0 lds
buffer_load_dwordx4 v177, s[12:15], s26 offen offset:1024 lds
buffer_load_dwordx4 v178, s[12:15], s26 offen offset:2048 lds
buffer_load_dwordx4 v179, s[12:15], s26 offen offset:3072 lds
s_add_u32 m0, s25, 81920
s_nop 0
buffer_load_dwordx4 v180, s[20:23], s26 offen offset:0 lds
buffer_load_dwordx4 v181, s[20:23], s26 offen offset:1024 lds
buffer_load_dwordx4 v182, s[20:23], s26 offen offset:2048 lds
buffer_load_dwordx4 v183, s[20:23], s26 offen offset:3072 lds
s_waitcnt vmcnt(8)
s_barrier
s_add_u32 m0, s25, 0
s_add_u32 s26, s24, 384
s_and_b32 s26, s26, 0x7ff
buffer_load_dwordx4 v176, s[12:15], s26 offen offset:0 lds
buffer_load_dwordx4 v177, s[12:15], s26 offen offset:1024 lds
buffer_load_dwordx4 v178, s[12:15], s26 offen offset:2048 lds
buffer_load_dwordx4 v179, s[12:15], s26 offen offset:3072 lds
s_add_u32 m0, s25, 16384
s_nop 0
buffer_load_dwordx4 v180, s[20:23], s26 offen offset:0 lds
buffer_load_dwordx4 v181, s[20:23], s26 offen offset:1024 lds
buffer_load_dwordx4 v182, s[20:23], s26 offen offset:2048 lds
buffer_load_dwordx4 v183, s[20:23], s26 offen offset:3072 lds
s_waitcnt vmcnt(8)
s_barrier
s_add_u32 m0, s25, 32768
s_add_u32 s26, s24, 512
s_and_b32 s26, s26, 0x7ff
buffer_load_dwordx4 v176, s[12:15], s26 offen offset:0 lds
buffer_load_dwordx4 v177, s[12:15], s26 offen offset:1024 lds
buffer_load_dwordx4 v178, s[12:15], s26 offen offset:2048 lds
buffer_load_dwordx4 v179, s[12:15], s26 offen offset:3072 lds
s_add_u32 m0, s25, 49152
s_nop 0
buffer_load_dwordx4 v180, s[20:23], s26 offen offset:0 lds
buffer_load_dwordx4 v181, s[20:23], s26 offen offset:1024 lds
buffer_load_dwordx4 v182, s[20:23], s26 offen offset:2048 lds
buffer_load_dwordx4 v183, s[20:23], s26 offen offset:3072 lds
s_waitcnt vmcnt(8)
s_barrier
s_add_u32 m0, s25, 65536
s_add_u32 s26, s24, 640
s_and_b32 s26, s26, 0x7ff
buffer_load_dwordx4 v176, s[12:15], s26 offen offset:0 lds
buffer_load_dwordx4 v177, s[12:15], s26 offen offset:1024 lds
buffer_load_dwordx4 v178, s[12:15], s26 offen offset:2048 lds
buffer_load_dwordx4 v179, s[12:15], s26 offen offset:3072 lds
s_add_u32 m0, s25, 81920
s_nop 0
buffer_load_dwordx4 v180, s[20:23], s26 offen offset:0 lds
buffer_load_dwordx4 v181, s[20:23], s26 offen offset:1024 lds
buffer_load_dwordx4 v182, s[20:23], s26 offen offset:2048 lds
buffer_load_dwordx4 v183, s[20:23], s26 offen offset:3072 lds
s_waitcnt vmcnt(8)
s_barrier
s_add_u32 m0, s25, 0
s_add_u32 s26, s24, 768
s_and_b32 s26, s26, 0x7ff
buffer_load_dwordx4 v176, s[12:15], s26 offen offset:0 lds
buffer_load_dwordx4 v177, s[12:15], s26 offen offset:1024 lds
buffer_load_dwordx4 v178, s[12:15], s26 offen offset:2048 lds
buffer_load_dwordx4 v179, s[12:15], s26 offen offset:3072 lds
s_add_u32 m0, s25, 16384
s_nop 0
buffer_load_dwordx4 v180, s[20:23], s26 offen offset:0 lds
buffer_load_dwordx4 v181, s[20:23], s26 offen offset:1024 lds
buffer_load_dwordx4 v182, s[20:23], s26 offen offset:2048 lds
buffer_load_dwordx4 v183, s[20:23], s26 offen offset:3072 lds
s_waitcnt vmcnt(8)
s_barrier
s_add_u32 m0, s25, 32768
s_add_u32 s26, s24, 896
s_and_b32 s26, s26, 0x7ff
buffer_load_dwordx4 v176, s[12:15], s26 offen offset:0 lds
buffer_load_dwordx4 v177, s[12:15], s26 offen offset:1024 lds
buffer_load_dwordx4 v178, s[12:15], s26 offen offset:2048 lds
buffer_load_dwordx4 v179, s[12:15], s26 offen offset:3072 lds
s_add_u32 m0, s25, 49152
s_nop 0
buffer_load_dwordx4 v180, s[20:23], s26 offen offset:0 lds
buffer_load_dwordx4 v181, s[20:23], s26 offen offset:1024 lds
buffer_load_dwordx4 v182, s[20:23], s26 offen offset:2048 lds
buffer_load_dwordx4 v183, s[20:23], s26 offen offset:3072 lds
v_and_b32 v104, 31, v1
v_cvt_f32_u32 v104, v104
v_lshrrev_b32 v105, 5, v1
v_lshlrev_b32 v105, 2, v105
v_cvt_f32_u32 v105, v105
v_mul_f32 v104, 0x3a000000, v104
v_fmamk_f32 v105, v105, 0x3c800000, v104
v_add_f32 v106, 0x0, v105
v_cos_f32 v136, v106
v_sin_f32 v152, -v106
v_add_f32 v107, 0x3c800000, v105
v_cos_f32 v137, v107
v_sin_f32 v153, -v107
v_add_f32 v106, 0x3d000000, v105
v_cos_f32 v138, v106
v_sin_f32 v154, -v106
v_add_f32 v107, 0x3d400000, v105
v_cos_f32 v139, v107
v_sin_f32 v155, -v107
v_add_f32 v106, 0x3e000000, v105
v_cos_f32 v140, v106
v_sin_f32 v156, -v106
v_add_f32 v107, 0x3e100000, v105
v_cos_f32 v141, v107
v_sin_f32 v157, -v107
v_add_f32 v106, 0x3e200000, v105
v_cos_f32 v142, v106
v_sin_f32 v158, -v106
v_add_f32 v107, 0x3e300000, v105
v_cos_f32 v143, v107
v_sin_f32 v159, -v107
v_add_f32 v106, 0x3e800000, v105
v_cos_f32 v144, v106
v_sin_f32 v160, -v106
v_add_f32 v107, 0x3e880000, v105
v_cos_f32 v145, v107
v_sin_f32 v161, -v107
v_add_f32 v106, 0x3e900000, v105
v_cos_f32 v146, v106
v_sin_f32 v162, -v106
v_add_f32 v107, 0x3e980000, v105
v_cos_f32 v147, v107
v_sin_f32 v163, -v107
v_add_f32 v106, 0x3ec00000, v105
v_cos_f32 v148, v106
v_sin_f32 v164, -v106
v_add_f32 v107, 0x3ec80000, v105
v_cos_f32 v149, v107
v_sin_f32 v165, -v107
v_add_f32 v106, 0x3ed00000, v105
v_cos_f32 v150, v106
v_sin_f32 v166, -v106
v_add_f32 v107, 0x3ed80000, v105
v_cos_f32 v151, v107
v_sin_f32 v167, -v107
s_add_u32 m0, s68, 16384
s_nop 0
buffer_load_dwordx4 v18, s[48:51], s69 offen nt lds
s_add_u32 m0, s68, 17408
s_nop 0
buffer_load_dwordx4 v18, s[52:55], s69 offen nt lds
s_add_u32 m0, s68, 18432
s_nop 0
buffer_load_dwordx4 v19, s[48:51], s69 offen nt lds
s_add_u32 m0, s68, 19456
s_nop 0
buffer_load_dwordx4 v19, s[52:55], s69 offen nt lds
s_cmp_lg_u32 s66, 3
s_cbranch_scc1 L_nw1
s_mov_b32 exec_hi, 0
buffer_load_ushort v88, v17, s[48:51], 0 offen nt
buffer_load_ushort v89, v17, s[52:55], 0 offen nt
s_mov_b64 exec, -1
L_nw1:
s_waitcnt vmcnt(12)
s_barrier
s_add_u32 m0, s25, 65536
s_add_u32 s26, s24, 1024
s_and_b32 s26, s26, 0x7ff
buffer_load_dwordx4 v176, s[12:15], s26 offen offset:0 lds
buffer_load_dwordx4 v177, s[12:15], s26 offen offset:1024 lds
buffer_load_dwordx4 v178, s[12:15], s26 offen offset:2048 lds
buffer_load_dwordx4 v179, s[12:15], s26 offen offset:3072 lds
s_add_u32 m0, s25, 81920
s_nop 0
buffer_load_dwordx4 v180, s[20:23], s26 offen offset:0 lds
buffer_load_dwordx4 v181, s[20:23], s26 offen offset:1024 lds
buffer_load_dwordx4 v182, s[20:23], s26 offen offset:2048 lds
buffer_load_dwordx4 v183, s[20:23], s26 offen offset:3072 lds
s_waitcnt vmcnt(12)
s_barrier
s_add_u32 m0, s25, 0
s_add_u32 s26, s24, 1152
s_and_b32 s26, s26, 0x7ff
buffer_load_dwordx4 v176, s[12:15], s26 offen offset:0 lds
buffer_load_dwordx4 v177, s[12:15], s26 offen offset:1024 lds
buffer_load_dwordx4 v178, s[12:15], s26 offen offset:2048 lds
buffer_load_dwordx4 v179, s[12:15], s26 offen offset:3072 lds
s_add_u32 m0, s25, 16384
s_nop 0
buffer_load_dwordx4 v180, s[20:23], s26 offen offset:0 lds
buffer_load_dwordx4 v181, s[20:23], s26 offen offset:1024 lds
buffer_load_dwordx4 v182, s[20:23], s26 offen offset:2048 lds
buffer_load_dwordx4 v183, s[20:23], s26 offen offset:3072 lds
v_mov_b32 v20, 0
global_load_dword v21, v20, s[30:31] sc1
s_waitcnt vmcnt(9)
s_barrier
s_add_u32 m0, s25, 32768
s_add_u32 s26, s24, 1280
s_and_b32 s26, s26, 0x7ff
buffer_load_dwordx4 v176, s[12:15], s26 offen offset:0 lds
buffer_load_dwordx4 v177, s[12:15], s26 offen offset:1024 lds
buffer_load_dwordx4 v178, s[12:15], s26 offen offset:2048 lds
buffer_load_dwordx4 v179, s[12:15], s26 offen offset:3072 lds
s_add_u32 m0, s25, 49152
s_nop 0
buffer_load_dwordx4 v180, s[20:23], s26 offen offset:0 lds
buffer_load_dwordx4 v181, s[20:23], s26 offen offset:1024 lds
buffer_load_dwordx4 v182, s[20:23], s26 offen offset:2048 lds
buffer_load_dwordx4 v183, s[20:23], s26 offen offset:3072 lds
ds_read_b64 v[104:105], v16 offset:0
ds_read_b64 v[106:107], v16 offset:256
ds_read_b64 v[108:109], v16 offset:512
ds_read_b64 v[110:111], v16 offset:768
ds_read_b64 v[112:113], v16 offset:1024
ds_read_b64 v[114:115], v16 offset:1280
ds_read_b64 v[116:117], v16 offset:1536
ds_read_b64 v[118:119], v16 offset:1792
s_mov_b32 s64, 0x05040100
s_mov_b32 s65, 0x07060302
v_lshlrev_b32 v88, 16, v88
v_lshlrev_b32 v89, 16, v89
v_lshlrev_b32 v9, 1, v1
v_add_f32_dpp v90, v88, v88 quad_perm:[1,0,3,2] row_mask:0xf bank_mask:0xf
v_subrev_f32_dpp v91, v89, v89 quad_perm:[1,0,3,2] row_mask:0xf bank_mask:0xf
v_mul_f32 v90, 0.5, v90
v_mul_f32 v91, 0.5, v91
v_cvt_pk_bf16_f32 v88, v90, v91
s_waitcnt lgkmcnt(0)
v_perm_b32 v120, v112, v104, s64
v_perm_b32 v121, v116, v108, s64
v_perm_b32 v122, v114, v106, s64
v_perm_b32 v123, v118, v110, s64
v_perm_b32 v124, v112, v104, s65
v_perm_b32 v125, v116, v108, s65
v_perm_b32 v126, v114, v106, s65
v_perm_b32 v127, v118, v110, s65
v_perm_b32 v128, v113, v105, s64
v_perm_b32 v129, v117, v109, s64
v_perm_b32 v130, v115, v107, s64
v_perm_b32 v131, v119, v111, s64
v_perm_b32 v132, v113, v105, s65
v_perm_b32 v133, v117, v109, s65
v_perm_b32 v134, v115, v107, s65
v_perm_b32 v135, v119, v111, s65
s_cmp_lg_u32 s66, 3
s_cbranch_scc1 L_nw2
s_lshr_b32 s64, s2, 7
s_mul_i32 s64, s64, 8192
s_bfe_u32 s65, s2, 0x10006
s_mul_i32 s65, s65, 4096
s_add_u32 s64, s64, s65
s_and_b32 s65, s2, 63
s_lshl_b32 s65, s65, 6
s_add_u32 s64, s64, s65
s_add_u32 s54, s64, 25165824
s_add_u32 s52, s32, s54
s_addc_u32 s53, s33, 0
s_mov_b32 s54, 64
s_mov_b32 s55, 0x20000
s_mov_b32 exec_lo, 0x55555555
s_mov_b32 exec_hi, 0
buffer_store_dword v88, v9, s[52:55], 0 offen sc1
s_mov_b64 exec, -1
L_nw2:
s_mov_b32 s92, 0
buffer_store_dwordx4 v[120:123], v15, s[56:59], s92 offen sc1
s_mov_b32 s92, 8192
buffer_store_dwordx4 v[124:127], v15, s[56:59], s92 offen sc1
s_mov_b32 s92, 16384
buffer_store_dwordx4 v[128:131], v15, s[56:59], s92 offen sc1
s_mov_b32 s92, 24576
buffer_store_dwordx4 v[132:135], v15, s[56:59], s92 offen sc1
s_waitcnt vmcnt(13)
s_barrier
s_add_u32 m0, s25, 65536
s_add_u32 s26, s24, 1408
s_and_b32 s26, s26, 0x7ff
buffer_load_dwordx4 v176, s[12:15], s26 offen offset:0 lds
buffer_load_dwordx4 v177, s[12:15], s26 offen offset:1024 lds
buffer_load_dwordx4 v178, s[12:15], s26 offen offset:2048 lds
buffer_load_dwordx4 v179, s[12:15], s26 offen offset:3072 lds
s_add_u32 m0, s25, 81920
s_nop 0
buffer_load_dwordx4 v180, s[20:23], s26 offen offset:0 lds
buffer_load_dwordx4 v181, s[20:23], s26 offen offset:1024 lds
buffer_load_dwordx4 v182, s[20:23], s26 offen offset:2048 lds
buffer_load_dwordx4 v183, s[20:23], s26 offen offset:3072 lds
s_waitcnt vmcnt(12)
s_barrier
s_add_u32 m0, s25, 0
s_add_u32 s26, s24, 1536
s_and_b32 s26, s26, 0x7ff
buffer_load_dwordx4 v176, s[12:15], s26 offen offset:0 lds
buffer_load_dwordx4 v177, s[12:15], s26 offen offset:1024 lds
buffer_load_dwordx4 v178, s[12:15], s26 offen offset:2048 lds
buffer_load_dwordx4 v179, s[12:15], s26 offen offset:3072 lds
s_add_u32 m0, s25, 16384
s_nop 0
buffer_load_dwordx4 v180, s[20:23], s26 offen offset:0 lds
buffer_load_dwordx4 v181, s[20:23], s26 offen offset:1024 lds
buffer_load_dwordx4 v182, s[20:23], s26 offen offset:2048 lds
buffer_load_dwordx4 v183, s[20:23], s26 offen offset:3072 lds
s_waitcnt vmcnt(8)
s_barrier
s_add_u32 m0, s25, 32768
s_add_u32 s26, s24, 1664
s_and_b32 s26, s26, 0x7ff
buffer_load_dwordx4 v176, s[12:15], s26 offen offset:0 lds
buffer_load_dwordx4 v177, s[12:15], s26 offen offset:1024 lds
buffer_load_dwordx4 v178, s[12:15], s26 offen offset:2048 lds
buffer_load_dwordx4 v179, s[12:15], s26 offen offset:3072 lds
s_add_u32 m0, s25, 49152
s_nop 0
buffer_load_dwordx4 v180, s[20:23], s26 offen offset:0 lds
buffer_load_dwordx4 v181, s[20:23], s26 offen offset:1024 lds
buffer_load_dwordx4 v182, s[20:23], s26 offen offset:2048 lds
buffer_load_dwordx4 v183, s[20:23], s26 offen offset:3072 lds
s_waitcnt vmcnt(8)
s_barrier
s_add_u32 m0, s25, 65536
s_add_u32 s26, s24, 1792
s_and_b32 s26, s26, 0x7ff
buffer_load_dwordx4 v176, s[12:15], s26 offen offset:0 lds
buffer_load_dwordx4 v177, s[12:15], s26 offen offset:1024 lds
buffer_load_dwordx4 v178, s[12:15], s26 offen offset:2048 lds
buffer_load_dwordx4 v179, s[12:15], s26 offen offset:3072 lds
s_add_u32 m0, s25, 81920
s_nop 0
buffer_load_dwordx4 v180, s[20:23], s26 offen offset:0 lds
buffer_load_dwordx4 v181, s[20:23], s26 offen offset:1024 lds
buffer_load_dwordx4 v182, s[20:23], s26 offen offset:2048 lds
buffer_load_dwordx4 v183, s[20:23], s26 offen offset:3072 lds
s_waitcnt vmcnt(8)
s_barrier
s_add_u32 m0, s25, 0
s_add_u32 s26, s24, 1920
s_and_b32 s26, s26, 0x7ff
buffer_load_dwordx4 v176, s[12:15], s26 offen offset:0 lds
buffer_load_dwordx4 v177, s[12:15], s26 offen offset:1024 lds
buffer_load_dwordx4 v178, s[12:15], s26 offen offset:2048 lds
buffer_load_dwordx4 v179, s[12:15], s26 offen offset:3072 lds
s_add_u32 m0, s25, 16384
s_nop 0
buffer_load_dwordx4 v180, s[20:23], s26 offen offset:0 lds
buffer_load_dwordx4 v181, s[20:23], s26 offen offset:1024 lds
buffer_load_dwordx4 v182, s[20:23], s26 offen offset:2048 lds
buffer_load_dwordx4 v183, s[20:23], s26 offen offset:3072 lds
s_load_dwordx4 s[8:11], s[0:1], 64
s_and_b32 s26, s2, 1
s_lshl_b32 s26, s26, 10
s_bfe_u32 s92, s2, 0x20001
s_lshl_b32 s92, s92, 19
s_add_u32 s26, s26, s92
s_lshr_b32 s92, s2, 3
s_lshl_b32 s92, s92, 14
s_add_u32 s26, s26, s92
s_lshr_b32 s92, s66, 1
s_lshl_b32 s92, s92, 13
s_add_u32 s26, s26, s92
v_bfe_u32 v22, v1, 3, 2
v_lshlrev_b32 v22, 11, v22
v_and_b32 v23, 7, v1
v_lshl_add_u32 v22, v23, 7, v22
v_add_u32 v22, s26, v22
s_waitcnt lgkmcnt(0)
s_bitcmp0_b32 s66, 0
s_cselect_b32 s8, s8, s10
s_cselect_b32 s9, s9, s11
s_mov_b32 exec_hi, 0
global_load_dword v23, v22, s[8:9]
s_mov_b64 exec, -1
s_waitcnt vmcnt(9)
s_barrier
s_add_u32 m0, s68, 0
s_mov_b32 s92, 0
buffer_load_dwordx4 v2, s[4:7], s92 offen offset:0 nt lds
buffer_load_dwordx4 v2, s[4:7], s92 offen offset:1024 nt lds
s_add_u32 m0, s68, 2048
s_mov_b32 s92, 2048
buffer_load_dwordx4 v3, s[4:7], s92 offen offset:0 nt lds
buffer_load_dwordx4 v3, s[4:7], s92 offen offset:1024 nt lds
s_waitcnt vmcnt(5)
s_barrier
s_barrier
s_barrier
s_setprio 3
v_readfirstlane_b32 s37, v21
s_nop 0
s_cmp_lg_u32 s37, 0
s_cbranch_scc1 L_sg3
v_mov_b32 v20, 0
L_n4:
global_load_dword v21, v20, s[30:31] sc1
s_waitcnt vmcnt(0)
v_readfirstlane_b32 s37, v21
s_nop 0
s_cmp_eq_u32 s37, 0
s_cbranch_scc1 L_n4
L_sg3:
s_waitcnt vmcnt(0)
ds_read_b64_tr_b16 v[24:25], v12 offset:0
ds_read_b64_tr_b16 v[26:27], v13 offset:0
ds_read_b64_tr_b16 v[28:29], v12 offset:512
ds_read_b64_tr_b16 v[30:31], v13 offset:512
ds_read_b64_tr_b16 v[32:33], v12 offset:1024
ds_read_b64_tr_b16 v[34:35], v13 offset:1024
ds_read_b64_tr_b16 v[36:37], v12 offset:1536
ds_read_b64_tr_b16 v[38:39], v13 offset:1536
s_waitcnt lgkmcnt(0)
v_mfma_f32_32x32x16_bf16 v[40:55], v[24:27], v[192:195], 0
v_mfma_f32_32x32x16_bf16 v[40:55], v[28:31], v[196:199], v[40:55]
v_mfma_f32_32x32x16_bf16 v[40:55], v[32:35], v[200:203], v[40:55]
v_mfma_f32_32x32x16_bf16 v[40:55], v[36:39], v[204:207], v[40:55]
v_mfma_f32_32x32x16_bf16 v[56:71], v[24:27], v[208:211], 0
v_mfma_f32_32x32x16_bf16 v[56:71], v[28:31], v[212:215], v[56:71]
v_mfma_f32_32x32x16_bf16 v[56:71], v[32:35], v[216:219], v[56:71]
v_mfma_f32_32x32x16_bf16 v[56:71], v[36:39], v[220:223], v[56:71]
s_nop 7
v_mul_f32 v168, v40, v224
v_mul_f32 v169, v40, v240
s_nop 1
v_fma_f32 v168, -v56, v240, v168
v_fmac_f32 v169, v56, v224
v_cvt_pk_bf16_f32 v72, v168, v169
v_mul_f32 v170, v41, v225
v_mul_f32 v171, v41, v241
v_fma_f32 v170, -v57, v241, v170
v_fmac_f32 v171, v57, v225
v_cvt_pk_bf16_f32 v73, v170, v171
v_mul_f32 v172, v42, v226
v_mul_f32 v173, v42, v242
v_fma_f32 v172, -v58, v242, v172
v_fmac_f32 v173, v58, v226
v_cvt_pk_bf16_f32 v74, v172, v173
v_mul_f32 v174, v43, v227
v_mul_f32 v175, v43, v243
v_fma_f32 v174, -v59, v243, v174
v_fmac_f32 v175, v59, v227
v_cvt_pk_bf16_f32 v75, v174, v175
v_mul_f32 v168, v44, v228
v_mul_f32 v169, v44, v244
v_fma_f32 v168, -v60, v244, v168
v_fmac_f32 v169, v60, v228
v_cvt_pk_bf16_f32 v76, v168, v169
v_mul_f32 v170, v45, v229
v_mul_f32 v171, v45, v245
v_fma_f32 v170, -v61, v245, v170
v_fmac_f32 v171, v61, v229
v_cvt_pk_bf16_f32 v77, v170, v171
v_mul_f32 v172, v46, v230
v_mul_f32 v173, v46, v246
v_fma_f32 v172, -v62, v246, v172
v_fmac_f32 v173, v62, v230
v_cvt_pk_bf16_f32 v78, v172, v173
v_mul_f32 v174, v47, v231
v_mul_f32 v175, v47, v247
v_fma_f32 v174, -v63, v247, v174
v_fmac_f32 v175, v63, v231
v_cvt_pk_bf16_f32 v79, v174, v175
v_mul_f32 v168, v48, v232
v_mul_f32 v169, v48, v248
v_fma_f32 v168, -v64, v248, v168
v_fmac_f32 v169, v64, v232
v_cvt_pk_bf16_f32 v80, v168, v169
v_mul_f32 v170, v49, v233
v_mul_f32 v171, v49, v249
v_fma_f32 v170, -v65, v249, v170
v_fmac_f32 v171, v65, v233
v_cvt_pk_bf16_f32 v81, v170, v171
v_mul_f32 v172, v50, v234
v_mul_f32 v173, v50, v250
v_fma_f32 v172, -v66, v250, v172
v_fmac_f32 v173, v66, v234
v_cvt_pk_bf16_f32 v82, v172, v173
v_mul_f32 v174, v51, v235
v_mul_f32 v175, v51, v251
v_fma_f32 v174, -v67, v251, v174
v_fmac_f32 v175, v67, v235
v_cvt_pk_bf16_f32 v83, v174, v175
v_mul_f32 v168, v52, v236
v_mul_f32 v169, v52, v252
v_fma_f32 v168, -v68, v252, v168
v_fmac_f32 v169, v68, v236
v_cvt_pk_bf16_f32 v84, v168, v169
v_mul_f32 v170, v53, v237
v_mul_f32 v171, v53, v253
v_fma_f32 v170, -v69, v253, v170
v_fmac_f32 v171, v69, v237
v_cvt_pk_bf16_f32 v85, v170, v171
v_mul_f32 v172, v54, v238
v_mul_f32 v173, v54, v254
v_fma_f32 v172, -v70, v254, v172
v_fmac_f32 v173, v70, v238
v_cvt_pk_bf16_f32 v86, v172, v173
v_mul_f32 v174, v55, v239
v_mul_f32 v175, v55, v255
v_fma_f32 v174, -v71, v255, v174
v_fmac_f32 v175, v71, v239
v_cvt_pk_bf16_f32 v87, v174, v175
v_mfma_f32_32x32x16_bf16 v[40:55], v[192:195], v[72:75], 0
v_mfma_f32_32x32x16_bf16 v[40:55], v[196:199], v[76:79], v[40:55]
v_mfma_f32_32x32x16_bf16 v[40:55], v[200:203], v[80:83], v[40:55]
v_mfma_f32_32x32x16_bf16 v[40:55], v[204:207], v[84:87], v[40:55]
v_mfma_f32_32x32x16_bf16 v[56:71], v[208:211], v[72:75], 0
v_mfma_f32_32x32x16_bf16 v[56:71], v[212:215], v[76:79], v[56:71]
v_mfma_f32_32x32x16_bf16 v[56:71], v[216:219], v[80:83], v[56:71]
v_mfma_f32_32x32x16_bf16 v[56:71], v[220:223], v[84:87], v[56:71]
s_lshl_b32 s92, s66, 12
s_add_u32 s92, s92, 98304
v_add_u32 v8, s92, v7
s_nop 8
v_cvt_pk_bf16_f32 v72, v40, v56
ds_write_b32 v4, v72 offset:0
v_cvt_pk_bf16_f32 v73, v41, v57
ds_write_b32 v4, v73 offset:1024
v_cvt_pk_bf16_f32 v74, v42, v58
ds_write_b32 v4, v74 offset:2048
v_cvt_pk_bf16_f32 v75, v43, v59
ds_write_b32 v4, v75 offset:3072
v_cvt_pk_bf16_f32 v76, v44, v60
ds_write_b32 v4, v76 offset:8192
v_cvt_pk_bf16_f32 v77, v45, v61
ds_write_b32 v4, v77 offset:9216
v_cvt_pk_bf16_f32 v78, v46, v62
ds_write_b32 v4, v78 offset:10240
v_cvt_pk_bf16_f32 v79, v47, v63
ds_write_b32 v4, v79 offset:11264
v_cvt_pk_bf16_f32 v80, v48, v64
ds_write_b32 v6, v80 offset:0
v_cvt_pk_bf16_f32 v81, v49, v65
ds_write_b32 v5, v81 offset:10240
v_cvt_pk_bf16_f32 v82, v50, v66
ds_write_b32 v5, v82 offset:9216
v_cvt_pk_bf16_f32 v83, v51, v67
ds_write_b32 v5, v83 offset:8192
v_cvt_pk_bf16_f32 v84, v52, v68
ds_write_b32 v5, v84 offset:3072
v_cvt_pk_bf16_f32 v85, v53, v69
ds_write_b32 v5, v85 offset:2048
v_cvt_pk_bf16_f32 v86, v54, v70
ds_write_b32 v5, v86 offset:1024
v_cvt_pk_bf16_f32 v87, v55, v71
ds_write_b32 v5, v87 offset:0
s_waitcnt lgkmcnt(0)
v_mov_b32 v190, 1
s_mov_b64 exec, 1
ds_write_b32 v185, v190
s_mov_b64 exec, -1
L_lc6:
ds_read_b128 v[186:189], v184
s_waitcnt lgkmcnt(0)
v_min3_u32 v186, v186, v187, v188
v_min_u32 v186, v186, v189
s_nop 0
v_readfirstlane_b32 s92, v186
s_nop 0
s_cmp_ge_u32 s92, 1
s_cbranch_scc1 L_lcd7
s_sleep 1
s_branch L_lc6
L_lcd7:
ds_read_b128 v[72:75], v8 offset:0
ds_read_b128 v[76:79], v8 offset:1024
ds_read_b128 v[80:83], v8 offset:2048
ds_read_b128 v[84:87], v8 offset:3072
v_add_u32 v4, 32768, v4
v_add_u32 v5, 32768, v5
v_add_u32 v6, 32768, v6
s_waitcnt lgkmcnt(0)
v_mov_b32 v190, 2
s_mov_b64 exec, 1
ds_write_b32 v185, v190
s_mov_b64 exec, -1
buffer_store_dwordx4 v[72:75], v2, s[40:43], 0 offen offset:0 sc1
buffer_store_dwordx4 v[76:79], v2, s[40:43], 0 offen offset:1024 sc1
buffer_store_dwordx4 v[80:83], v2, s[40:43], 0 offen offset:2048 sc1
buffer_store_dwordx4 v[84:87], v2, s[40:43], 0 offen offset:3072 sc1
s_and_b32 s60, s2, 7
s_lshl_b32 s60, s60, 5
s_lshr_b32 s64, s2, 3
s_add_u32 s60, s60, s64
s_lshr_b32 s64, s66, 1
s_xor_b32 s64, s64, s66
s_and_b32 s64, s64, 1
s_or_b32 s65, s64, s60
s_cmp_eq_u32 s65, 0
s_cselect_b32 s61, 1, 0
s_lshl_b32 s65, s60, 1
s_add_u32 s64, s64, s65
s_mul_i32 s64, s64, 8192
s_add_u32 s64, s64, 25182208
s_lshr_b32 s65, s66, 1
s_mul_i32 s69, s65, 8192
s_add_u32 s69, s69, 25165824
s_cmp_eq_u32 s61, 1
s_cselect_b32 s64, s69, s64
s_cselect_b32 s65, 0, s65
s_cselect_b32 s90, s32, s32
s_cselect_b32 s91, s33, s33
s_lshl_b32 s62, s65, 31
s_or_b32 s63, s62, 0x3f800000
s_add_u32 s48, s90, s64
s_addc_u32 s49, s91, 0
s_mov_b32 s50, 8192
s_mov_b32 s51, 0x20000
s_lshl_b32 s64, s66, 20
s_lshl_b32 s65, s60, 6
s_add_u32 s64, s64, s65
s_add_u32 s54, s64, 16777216
s_add_u32 s52, s32, s54
s_addc_u32 s53, s33, 0
s_sub_u32 s54, 1048576, s65
s_mov_b32 s55, 0x20000
s_add_u32 s58, s64, 16777216
s_add_u32 s56, s32, s58
s_addc_u32 s57, s33, 0
s_sub_u32 s58, 1048576, s65
s_mov_b32 s59, 0x20000
v_lshrrev_b32 v8, 2, v1
v_lshlrev_b32 v8, 14, v8
v_and_b32 v9, 3, v1
v_lshrrev_b32 v10, 4, v1
v_xor_b32 v9, v9, v10
v_lshl_add_u32 v14, v9, 4, v8
v_and_b32 v8, 31, v1
v_bfe_u32 v9, v1, 2, 2
v_xor_b32 v9, s66, v9
v_lshlrev_b32 v9, 4, v9
v_lshl_add_u32 v9, v8, 6, v9
v_lshrrev_b32 v8, 5, v1
v_lshl_add_u32 v9, v8, 11, v9
v_add_u32 v15, 131072, v9
s_lshl_b32 s64, s66, 13
s_add_u32 s64, s64, 131072
v_add_u32 v16, s64, v2
s_xor_b32 s65, s64, 24576
s_cmp_eq_u32 s61, 1
s_cselect_b32 s65, s64, s65
v_add_u32 v17, s65, v2
v_add_u32 v18, s68, v2
v_pk_mul_f32 v[136:137], s[62:63], v[136:137] op_sel:[1,0]
v_pk_mul_f32 v[138:139], s[62:63], v[138:139] op_sel:[1,0]
v_pk_mul_f32 v[140:141], s[62:63], v[140:141] op_sel:[1,0]
v_pk_mul_f32 v[142:143], s[62:63], v[142:143] op_sel:[1,0]
v_pk_mul_f32 v[144:145], s[62:63], v[144:145] op_sel:[1,0]
v_pk_mul_f32 v[146:147], s[62:63], v[146:147] op_sel:[1,0]
v_pk_mul_f32 v[148:149], s[62:63], v[148:149] op_sel:[1,0]
v_pk_mul_f32 v[150:151], s[62:63], v[150:151] op_sel:[1,0]
v_pk_mul_f32 v[152:153], s[62:63], v[152:153] op_sel:[1,0]
v_pk_mul_f32 v[154:155], s[62:63], v[154:155] op_sel:[1,0]
v_pk_mul_f32 v[156:157], s[62:63], v[156:157] op_sel:[1,0]
v_pk_mul_f32 v[158:159], s[62:63], v[158:159] op_sel:[1,0]
v_pk_mul_f32 v[160:161], s[62:63], v[160:161] op_sel:[1,0]
v_pk_mul_f32 v[162:163], s[62:63], v[162:163] op_sel:[1,0]
v_pk_mul_f32 v[164:165], s[62:63], v[164:165] op_sel:[1,0]
v_pk_mul_f32 v[166:167], s[62:63], v[166:167] op_sel:[1,0]
s_waitcnt vmcnt(0)
v_mov_b32 v190, 3
s_mov_b64 exec, 1
ds_write_b32 v185, v190
s_mov_b64 exec, -1
s_cmp_lg_u32 s66, 0
s_cbranch_scc1 L_ph8
L_lc9:
ds_read_b128 v[186:189], v184
s_waitcnt lgkmcnt(0)
v_min3_u32 v186, v186, v187, v188
v_min_u32 v186, v186, v189
s_nop 0
v_readfirstlane_b32 s92, v186
s_nop 0
s_cmp_ge_u32 s92, 3
s_cbranch_scc1 L_lcd10
s_sleep 1
s_branch L_lc9
L_lcd10:
s_and_b32 s64, s2, 15
s_lshl_b32 s65, s64, 7
s_add_u32 s65, s65, 4096
s_add_u32 s90, s32, s65
s_addc_u32 s91, s33, 0
s_mov_b32 s65, 1
s_atomic_add s65, s[90:91], 0x0 glc
s_lshl_b32 s64, s64, 2
s_add_u32 s64, s64, 540672
v_lshl_add_u32 v20, v1, 7, s64
v_mov_b32 v21, s37
s_add_u32 s4, s32, s64
s_addc_u32 s5, s33, 0
s_and_b32 s64, s2, 31
s_lshl_b32 s64, s64, 7
s_add_u32 s64, s64, 540672
s_waitcnt lgkmcnt(0)
s_cmp_lg_u32 s65, 15
s_cbranch_scc1 L_sg11
s_atomic_swap s37, s[4:5], 0x0
s_atomic_swap s37, s[4:5], 0x80
s_atomic_swap s37, s[4:5], 0x100
s_atomic_swap s37, s[4:5], 0x180
s_atomic_swap s37, s[4:5], 0x200
s_atomic_swap s37, s[4:5], 0x280
s_atomic_swap s37, s[4:5], 0x300
s_atomic_swap s37, s[4:5], 0x380
s_atomic_swap s37, s[4:5], 0x400
s_atomic_swap s37, s[4:5], 0x480
s_atomic_swap s37, s[4:5], 0x500
s_atomic_swap s37, s[4:5], 0x580
s_atomic_swap s37, s[4:5], 0x600
s_atomic_swap s37, s[4:5], 0x680
s_atomic_swap s37, s[4:5], 0x700
s_atomic_swap s37, s[4:5], 0x780
s_atomic_swap s37, s[4:5], 0x800
s_atomic_swap s37, s[4:5], 0x880
s_atomic_swap s37, s[4:5], 0x900
s_atomic_swap s37, s[4:5], 0x980
s_atomic_swap s37, s[4:5], 0xa00
s_atomic_swap s37, s[4:5], 0xa80
s_atomic_swap s37, s[4:5], 0xb00
s_atomic_swap s37, s[4:5], 0xb80
s_atomic_swap s37, s[4:5], 0xc00
s_atomic_swap s37, s[4:5], 0xc80
s_atomic_swap s37, s[4:5], 0xd00
s_atomic_swap s37, s[4:5], 0xd80
s_atomic_swap s37, s[4:5], 0xe00
s_atomic_swap s37, s[4:5], 0xe80
s_atomic_swap s37, s[4:5], 0xf00
s_atomic_swap s37, s[4:5], 0xf80
s_waitcnt lgkmcnt(0)
L_sg11:
s_add_u32 s90, s32, s64
s_addc_u32 s91, s33, 0
s_mov_b32 s64, s37
s_mov_b32 s65, s37
s_mov_b32 s92, 0
s_branch L_sp12
L_nok13:
s_add_u32 s92, s92, 1
s_cmp_ge_u32 s92, 200000
s_cbranch_scc1 L_ph8
s_sleep 2
L_sp12:
s_load_dwordx16 s[4:19], s[90:91], 0x0 glc
s_waitcnt lgkmcnt(0)
s_cmp_eq_u64 s[4:5], s[64:65]
s_cbranch_scc0 L_nok13
s_cmp_eq_u64 s[6:7], s[64:65]
s_cbranch_scc0 L_nok13
s_cmp_eq_u64 s[8:9], s[64:65]
s_cbranch_scc0 L_nok13
s_cmp_eq_u64 s[10:11], s[64:65]
s_cbranch_scc0 L_nok13
s_cmp_eq_u64 s[12:13], s[64:65]
s_cbranch_scc0 L_nok13
s_cmp_eq_u64 s[14:15], s[64:65]
s_cbranch_scc0 L_nok13
s_cmp_eq_u64 s[16:17], s[64:65]
s_cbranch_scc0 L_nok13
s_cmp_eq_u64 s[18:19], s[64:65]
s_cbranch_scc0 L_nok13
L_ph8:
v_mov_b32 v190, 4
s_mov_b64 exec, 1
ds_write_b32 v185, v190
s_mov_b64 exec, -1
L_lc14:
ds_read_b128 v[186:189], v184
s_waitcnt lgkmcnt(0)
v_min3_u32 v186, v186, v187, v188
v_min_u32 v186, v186, v189
s_nop 0
v_readfirstlane_b32 s92, v186
s_nop 0
s_cmp_ge_u32 s92, 4
s_cbranch_scc1 L_lcd15
s_sleep 1
s_branch L_lc14
L_lcd15:
s_setprio 3
s_add_u32 m0, s68, 0
s_mov_b32 s64, 0
buffer_load_dwordx4 v14, s[52:55], s64 offen sc1 lds
s_add_u32 m0, s68, 1024
s_mov_b32 s64, 262144
buffer_load_dwordx4 v14, s[52:55], s64 offen sc1 lds
s_add_u32 m0, s68, 2048
s_mov_b32 s64, 524288
buffer_load_dwordx4 v14, s[52:55], s64 offen sc1 lds
s_add_u32 m0, s68, 3072
s_mov_b32 s64, 786432
buffer_load_dwordx4 v14, s[52:55], s64 offen sc1 lds
s_movk_i32 s64, 4096
buffer_load_dwordx4 v[104:107], v2, s[48:51], 0 offen offset:0 sc1
buffer_load_dwordx4 v[108:111], v2, s[48:51], 0 offen offset:1024 sc1
buffer_load_dwordx4 v[112:115], v2, s[48:51], 0 offen offset:2048 sc1
buffer_load_dwordx4 v[116:119], v2, s[48:51], 0 offen offset:3072 sc1
buffer_load_dwordx4 v[120:123], v2, s[48:51], s64 offen offset:0 sc1
buffer_load_dwordx4 v[124:127], v2, s[48:51], s64 offen offset:1024 sc1
buffer_load_dwordx4 v[128:131], v2, s[48:51], s64 offen offset:2048 sc1
buffer_load_dwordx4 v[132:135], v2, s[48:51], s64 offen offset:3072 sc1
s_waitcnt vmcnt(8)
v_mov_b32 v190, 5
s_mov_b64 exec, 1
ds_write_b32 v185, v190
s_mov_b64 exec, -1
L_lc16:
ds_read_b128 v[186:189], v184
s_waitcnt lgkmcnt(0)
v_min3_u32 v186, v186, v187, v188
v_min_u32 v186, v186, v189
s_nop 0
v_readfirstlane_b32 s92, v186
s_nop 0
s_cmp_ge_u32 s92, 5
s_cbranch_scc1 L_lcd17
s_sleep 1
s_branch L_lc16
L_lcd17:
ds_read_b128 v[72:75], v15 offset:0
ds_read_b128 v[76:79], v15 offset:4096
ds_read_b128 v[80:83], v15 offset:8192
ds_read_b128 v[84:87], v15 offset:12288
s_waitcnt lgkmcnt(0)
v_mov_b32 v190, 6
s_mov_b64 exec, 1
ds_write_b32 v185, v190
s_mov_b64 exec, -1
s_lshl_b32 s64, s61, 31
s_or_b32 s64, s64, s62
L_fft18:
v_xor_b32 v24, s64, v72
v_xor_b32 v25, s64, v73
v_xor_b32 v26, s64, v74
v_xor_b32 v27, s64, v75
v_xor_b32 v28, s64, v76
v_xor_b32 v29, s64, v77
v_xor_b32 v30, s64, v78
v_xor_b32 v31, s64, v79
v_xor_b32 v32, s64, v80
v_xor_b32 v33, s64, v81
v_xor_b32 v34, s64, v82
v_xor_b32 v35, s64, v83
v_xor_b32 v36, s64, v84
v_xor_b32 v37, s64, v85
v_xor_b32 v38, s64, v86
v_xor_b32 v39, s64, v87
v_mfma_f32_32x32x16_bf16 v[40:55], v[24:27], v[192:195], 0
v_mfma_f32_32x32x16_bf16 v[40:55], v[28:31], v[196:199], v[40:55]
v_mfma_f32_32x32x16_bf16 v[40:55], v[32:35], v[200:203], v[40:55]
v_mfma_f32_32x32x16_bf16 v[40:55], v[36:39], v[204:207], v[40:55]
v_mfma_f32_32x32x16_bf16 v[56:71], v[24:27], v[208:211], 0
v_mfma_f32_32x32x16_bf16 v[56:71], v[28:31], v[212:215], v[56:71]
v_mfma_f32_32x32x16_bf16 v[56:71], v[32:35], v[216:219], v[56:71]
v_mfma_f32_32x32x16_bf16 v[56:71], v[36:39], v[220:223], v[56:71]
s_nop 7
v_mul_f32 v168, v40, v224
v_mul_f32 v169, v40, v240
s_nop 1
v_fma_f32 v168, -v56, v240, v168
v_fmac_f32 v169, v56, v224
v_cvt_pk_bf16_f32 v24, v168, v169
v_mul_f32 v170, v41, v225
v_mul_f32 v171, v41, v241
v_fma_f32 v170, -v57, v241, v170
v_fmac_f32 v171, v57, v225
v_cvt_pk_bf16_f32 v25, v170, v171
v_mul_f32 v172, v42, v226
v_mul_f32 v173, v42, v242
v_fma_f32 v172, -v58, v242, v172
v_fmac_f32 v173, v58, v226
v_cvt_pk_bf16_f32 v26, v172, v173
v_mul_f32 v174, v43, v227
v_mul_f32 v175, v43, v243
v_fma_f32 v174, -v59, v243, v174
v_fmac_f32 v175, v59, v227
v_cvt_pk_bf16_f32 v27, v174, v175
v_mul_f32 v168, v44, v228
v_mul_f32 v169, v44, v244
v_fma_f32 v168, -v60, v244, v168
v_fmac_f32 v169, v60, v228
v_cvt_pk_bf16_f32 v28, v168, v169
v_mul_f32 v170, v45, v229
v_mul_f32 v171, v45, v245
v_fma_f32 v170, -v61, v245, v170
v_fmac_f32 v171, v61, v229
v_cvt_pk_bf16_f32 v29, v170, v171
v_mul_f32 v172, v46, v230
v_mul_f32 v173, v46, v246
v_fma_f32 v172, -v62, v246, v172
v_fmac_f32 v173, v62, v230
v_cvt_pk_bf16_f32 v30, v172, v173
v_mul_f32 v174, v47, v231
v_mul_f32 v175, v47, v247
v_fma_f32 v174, -v63, v247, v174
v_fmac_f32 v175, v63, v231
v_cvt_pk_bf16_f32 v31, v174, v175
v_mul_f32 v168, v48, v232
v_mul_f32 v169, v48, v248
v_fma_f32 v168, -v64, v248, v168
v_fmac_f32 v169, v64, v232
v_cvt_pk_bf16_f32 v32, v168, v169
v_mul_f32 v170, v49, v233
v_mul_f32 v171, v49, v249
v_fma_f32 v170, -v65, v249, v170
v_fmac_f32 v171, v65, v233
v_cvt_pk_bf16_f32 v33, v170, v171
v_mul_f32 v172, v50, v234
v_mul_f32 v173, v50, v250
v_fma_f32 v172, -v66, v250, v172
v_fmac_f32 v173, v66, v234
v_cvt_pk_bf16_f32 v34, v172, v173
v_mul_f32 v174, v51, v235
v_mul_f32 v175, v51, v251
v_fma_f32 v174, -v67, v251, v174
v_fmac_f32 v175, v67, v235
v_cvt_pk_bf16_f32 v35, v174, v175
v_mul_f32 v168, v52, v236
v_mul_f32 v169, v52, v252
v_fma_f32 v168, -v68, v252, v168
v_fmac_f32 v169, v68, v236
v_cvt_pk_bf16_f32 v36, v168, v169
v_mul_f32 v170, v53, v237
v_mul_f32 v171, v53, v253
v_fma_f32 v170, -v69, v253, v170
v_fmac_f32 v171, v69, v237
v_cvt_pk_bf16_f32 v37, v170, v171
v_mul_f32 v172, v54, v238
v_mul_f32 v173, v54, v254
v_fma_f32 v172, -v70, v254, v172
v_fmac_f32 v173, v70, v238
v_cvt_pk_bf16_f32 v38, v172, v173
v_mul_f32 v174, v55, v239
v_mul_f32 v175, v55, v255
v_fma_f32 v174, -v71, v255, v174
v_fmac_f32 v175, v71, v239
v_cvt_pk_bf16_f32 v39, v174, v175
v_mfma_f32_32x32x16_bf16 v[40:55], v[192:195], v[24:27], 0
v_mfma_f32_32x32x16_bf16 v[40:55], v[196:199], v[28:31], v[40:55]
v_mfma_f32_32x32x16_bf16 v[40:55], v[200:203], v[32:35], v[40:55]
v_mfma_f32_32x32x16_bf16 v[40:55], v[204:207], v[36:39], v[40:55]
v_mfma_f32_32x32x16_bf16 v[56:71], v[208:211], v[24:27], 0
v_mfma_f32_32x32x16_bf16 v[56:71], v[212:215], v[28:31], v[56:71]
v_mfma_f32_32x32x16_bf16 v[56:71], v[216:219], v[32:35], v[56:71]
v_mfma_f32_32x32x16_bf16 v[56:71], v[220:223], v[36:39], v[56:71]
L_lc20:
ds_read_b128 v[186:189], v184
s_waitcnt lgkmcnt(0)
v_min3_u32 v186, v186, v187, v188
v_min_u32 v186, v186, v189
s_nop 0
v_readfirstlane_b32 s92, v186
s_nop 0
s_cmp_ge_u32 s92, 6
s_cbranch_scc1 L_lcd21
s_sleep 1
s_branch L_lc20
L_lcd21:
s_cmp_eq_u32 s61, 2
s_cbranch_scc1 L_nwr19
ds_write_b128 v16, v[40:43] offset:0
ds_write_b128 v16, v[44:47] offset:1024
ds_write_b128 v16, v[48:51] offset:2048
ds_write_b128 v16, v[52:55] offset:3072
ds_write_b128 v16, v[56:59] offset:4096
ds_write_b128 v16, v[60:63] offset:5120
ds_write_b128 v16, v[64:67] offset:6144
ds_write_b128 v16, v[68:71] offset:7168
s_cmp_eq_u32 s61, 0
s_cbranch_scc1 L_nwr19
s_mov_b32 s61, 2
s_mov_b32 s64, 0
s_branch L_fft18
L_nwr19:
s_waitcnt lgkmcnt(0)
v_mov_b32 v190, 7
s_mov_b64 exec, 1
ds_write_b32 v185, v190
s_mov_b64 exec, -1
L_lc22:
ds_read_b128 v[186:189], v184
s_waitcnt lgkmcnt(0)
v_min3_u32 v186, v186, v187, v188
v_min_u32 v186, v186, v189
s_nop 0
v_readfirstlane_b32 s92, v186
s_nop 0
s_cmp_ge_u32 s92, 7
s_cbranch_scc1 L_lcd23
s_sleep 1
s_branch L_lc22
L_lcd23:
ds_read_b128 v[72:75], v17 offset:0
ds_read_b128 v[76:79], v17 offset:1024
ds_read_b128 v[80:83], v17 offset:2048
ds_read_b128 v[84:87], v17 offset:3072
ds_read_b128 v[88:91], v17 offset:4096
ds_read_b128 v[92:95], v17 offset:5120
ds_read_b128 v[96:99], v17 offset:6144
ds_read_b128 v[100:103], v17 offset:7168
s_waitcnt vmcnt(0) lgkmcnt(0)
v_mov_b32 v190, 8
s_mov_b64 exec, 1
ds_write_b32 v185, v190
s_mov_b64 exec, -1
v_lshlrev_b32 v168, 16, v104
v_and_b32 v169, 0xffff0000, v104
v_lshlrev_b32 v170, 16, v105
v_and_b32 v171, 0xffff0000, v105
v_add_f32 v172, v168, v170
v_add_f32 v173, v169, v171
v_sub_f32 v168, v168, v170
v_sub_f32 v169, v169, v171
v_mul_f32 v170, v152, v40
v_mul_f32 v171, v152, v56
v_mul_f32 v174, v172, v40
v_mul_f32 v175, v172, v56
v_fma_f32 v170, -v136, v88, v170
v_fmac_f32 v171, v136, v72
v_fma_f32 v174, -v173, v56, v174
v_fmac_f32 v175, v173, v40
v_fmac_f32 v174, v168, v170
v_fmac_f32 v175, v168, v171
v_fma_f32 v174, -v169, v171, v174
v_fmac_f32 v175, v169, v170
v_cvt_pk_bf16_f32 v24, v175, v174
v_lshlrev_b32 v176, 16, v106
v_and_b32 v177, 0xffff0000, v106
v_lshlrev_b32 v178, 16, v107
v_and_b32 v179, 0xffff0000, v107
v_add_f32 v180, v176, v178
v_add_f32 v181, v177, v179
v_sub_f32 v176, v176, v178
v_sub_f32 v177, v177, v179
v_mul_f32 v178, v153, v41
v_mul_f32 v179, v153, v57
v_mul_f32 v182, v180, v41
v_mul_f32 v183, v180, v57
v_fma_f32 v178, -v137, v89, v178
v_fmac_f32 v179, v137, v73
v_fma_f32 v182, -v181, v57, v182
v_fmac_f32 v183, v181, v41
v_fmac_f32 v182, v176, v178
v_fmac_f32 v183, v176, v179
v_fma_f32 v182, -v177, v179, v182
v_fmac_f32 v183, v177, v178
v_cvt_pk_bf16_f32 v25, v183, v182
v_lshlrev_b32 v168, 16, v108
v_and_b32 v169, 0xffff0000, v108
v_lshlrev_b32 v170, 16, v109
v_and_b32 v171, 0xffff0000, v109
v_add_f32 v172, v168, v170
v_add_f32 v173, v169, v171
v_sub_f32 v168, v168, v170
v_sub_f32 v169, v169, v171
v_mul_f32 v170, v154, v42
v_mul_f32 v171, v154, v58
v_mul_f32 v174, v172, v42
v_mul_f32 v175, v172, v58
v_fma_f32 v170, -v138, v90, v170
v_fmac_f32 v171, v138, v74
v_fma_f32 v174, -v173, v58, v174
v_fmac_f32 v175, v173, v42
v_fmac_f32 v174, v168, v170
v_fmac_f32 v175, v168, v171
v_fma_f32 v174, -v169, v171, v174
v_fmac_f32 v175, v169, v170
v_cvt_pk_bf16_f32 v26, v175, v174
v_lshlrev_b32 v176, 16, v110
v_and_b32 v177, 0xffff0000, v110
v_lshlrev_b32 v178, 16, v111
v_and_b32 v179, 0xffff0000, v111
v_add_f32 v180, v176, v178
v_add_f32 v181, v177, v179
v_sub_f32 v176, v176, v178
v_sub_f32 v177, v177, v179
v_mul_f32 v178, v155, v43
v_mul_f32 v179, v155, v59
v_mul_f32 v182, v180, v43
v_mul_f32 v183, v180, v59
v_fma_f32 v178, -v139, v91, v178
v_fmac_f32 v179, v139, v75
v_fma_f32 v182, -v181, v59, v182
v_fmac_f32 v183, v181, v43
v_fmac_f32 v182, v176, v178
v_fmac_f32 v183, v176, v179
v_fma_f32 v182, -v177, v179, v182
v_fmac_f32 v183, v177, v178
v_cvt_pk_bf16_f32 v27, v183, v182
v_lshlrev_b32 v168, 16, v112
v_and_b32 v169, 0xffff0000, v112
v_lshlrev_b32 v170, 16, v113
v_and_b32 v171, 0xffff0000, v113
v_add_f32 v172, v168, v170
v_add_f32 v173, v169, v171
v_sub_f32 v168, v168, v170
v_sub_f32 v169, v169, v171
v_mul_f32 v170, v156, v44
v_mul_f32 v171, v156, v60
v_mul_f32 v174, v172, v44
v_mul_f32 v175, v172, v60
v_fma_f32 v170, -v140, v92, v170
v_fmac_f32 v171, v140, v76
v_fma_f32 v174, -v173, v60, v174
v_fmac_f32 v175, v173, v44
v_fmac_f32 v174, v168, v170
v_fmac_f32 v175, v168, v171
v_fma_f32 v174, -v169, v171, v174
v_fmac_f32 v175, v169, v170
v_cvt_pk_bf16_f32 v28, v175, v174
v_lshlrev_b32 v176, 16, v114
v_and_b32 v177, 0xffff0000, v114
v_lshlrev_b32 v178, 16, v115
v_and_b32 v179, 0xffff0000, v115
v_add_f32 v180, v176, v178
v_add_f32 v181, v177, v179
v_sub_f32 v176, v176, v178
v_sub_f32 v177, v177, v179
v_mul_f32 v178, v157, v45
v_mul_f32 v179, v157, v61
v_mul_f32 v182, v180, v45
v_mul_f32 v183, v180, v61
v_fma_f32 v178, -v141, v93, v178
v_fmac_f32 v179, v141, v77
v_fma_f32 v182, -v181, v61, v182
v_fmac_f32 v183, v181, v45
v_fmac_f32 v182, v176, v178
v_fmac_f32 v183, v176, v179
v_fma_f32 v182, -v177, v179, v182
v_fmac_f32 v183, v177, v178
v_cvt_pk_bf16_f32 v29, v183, v182
v_lshlrev_b32 v168, 16, v116
v_and_b32 v169, 0xffff0000, v116
v_lshlrev_b32 v170, 16, v117
v_and_b32 v171, 0xffff0000, v117
v_add_f32 v172, v168, v170
v_add_f32 v173, v169, v171
v_sub_f32 v168, v168, v170
v_sub_f32 v169, v169, v171
v_mul_f32 v170, v158, v46
v_mul_f32 v171, v158, v62
v_mul_f32 v174, v172, v46
v_mul_f32 v175, v172, v62
v_fma_f32 v170, -v142, v94, v170
v_fmac_f32 v171, v142, v78
v_fma_f32 v174, -v173, v62, v174
v_fmac_f32 v175, v173, v46
v_fmac_f32 v174, v168, v170
v_fmac_f32 v175, v168, v171
v_fma_f32 v174, -v169, v171, v174
v_fmac_f32 v175, v169, v170
v_cvt_pk_bf16_f32 v30, v175, v174
v_lshlrev_b32 v176, 16, v118
v_and_b32 v177, 0xffff0000, v118
v_lshlrev_b32 v178, 16, v119
v_and_b32 v179, 0xffff0000, v119
v_add_f32 v180, v176, v178
v_add_f32 v181, v177, v179
v_sub_f32 v176, v176, v178
v_sub_f32 v177, v177, v179
v_mul_f32 v178, v159, v47
v_mul_f32 v179, v159, v63
v_mul_f32 v182, v180, v47
v_mul_f32 v183, v180, v63
v_fma_f32 v178, -v143, v95, v178
v_fmac_f32 v179, v143, v79
v_fma_f32 v182, -v181, v63, v182
v_fmac_f32 v183, v181, v47
v_fmac_f32 v182, v176, v178
v_fmac_f32 v183, v176, v179
v_fma_f32 v182, -v177, v179, v182
v_fmac_f32 v183, v177, v178
v_cvt_pk_bf16_f32 v31, v183, v182
v_lshlrev_b32 v168, 16, v120
v_and_b32 v169, 0xffff0000, v120
v_lshlrev_b32 v170, 16, v121
v_and_b32 v171, 0xffff0000, v121
v_add_f32 v172, v168, v170
v_add_f32 v173, v169, v171
v_sub_f32 v168, v168, v170
v_sub_f32 v169, v169, v171
v_mul_f32 v170, v160, v48
v_mul_f32 v171, v160, v64
v_mul_f32 v174, v172, v48
v_mul_f32 v175, v172, v64
v_fma_f32 v170, -v144, v96, v170
v_fmac_f32 v171, v144, v80
v_fma_f32 v174, -v173, v64, v174
v_fmac_f32 v175, v173, v48
v_fmac_f32 v174, v168, v170
v_fmac_f32 v175, v168, v171
v_fma_f32 v174, -v169, v171, v174
v_fmac_f32 v175, v169, v170
v_cvt_pk_bf16_f32 v32, v175, v174
v_lshlrev_b32 v176, 16, v122
v_and_b32 v177, 0xffff0000, v122
v_lshlrev_b32 v178, 16, v123
v_and_b32 v179, 0xffff0000, v123
v_add_f32 v180, v176, v178
v_add_f32 v181, v177, v179
v_sub_f32 v176, v176, v178
v_sub_f32 v177, v177, v179
v_mul_f32 v178, v161, v49
v_mul_f32 v179, v161, v65
v_mul_f32 v182, v180, v49
v_mul_f32 v183, v180, v65
v_fma_f32 v178, -v145, v97, v178
v_fmac_f32 v179, v145, v81
v_fma_f32 v182, -v181, v65, v182
v_fmac_f32 v183, v181, v49
v_fmac_f32 v182, v176, v178
v_fmac_f32 v183, v176, v179
v_fma_f32 v182, -v177, v179, v182
v_fmac_f32 v183, v177, v178
v_cvt_pk_bf16_f32 v33, v183, v182
v_lshlrev_b32 v168, 16, v124
v_and_b32 v169, 0xffff0000, v124
v_lshlrev_b32 v170, 16, v125
v_and_b32 v171, 0xffff0000, v125
v_add_f32 v172, v168, v170
v_add_f32 v173, v169, v171
v_sub_f32 v168, v168, v170
v_sub_f32 v169, v169, v171
v_mul_f32 v170, v162, v50
v_mul_f32 v171, v162, v66
v_mul_f32 v174, v172, v50
v_mul_f32 v175, v172, v66
v_fma_f32 v170, -v146, v98, v170
v_fmac_f32 v171, v146, v82
v_fma_f32 v174, -v173, v66, v174
v_fmac_f32 v175, v173, v50
v_fmac_f32 v174, v168, v170
v_fmac_f32 v175, v168, v171
v_fma_f32 v174, -v169, v171, v174
v_fmac_f32 v175, v169, v170
v_cvt_pk_bf16_f32 v34, v175, v174
v_lshlrev_b32 v176, 16, v126
v_and_b32 v177, 0xffff0000, v126
v_lshlrev_b32 v178, 16, v127
v_and_b32 v179, 0xffff0000, v127
v_add_f32 v180, v176, v178
v_add_f32 v181, v177, v179
v_sub_f32 v176, v176, v178
v_sub_f32 v177, v177, v179
v_mul_f32 v178, v163, v51
v_mul_f32 v179, v163, v67
v_mul_f32 v182, v180, v51
v_mul_f32 v183, v180, v67
v_fma_f32 v178, -v147, v99, v178
v_fmac_f32 v179, v147, v83
v_fma_f32 v182, -v181, v67, v182
v_fmac_f32 v183, v181, v51
v_fmac_f32 v182, v176, v178
v_fmac_f32 v183, v176, v179
v_fma_f32 v182, -v177, v179, v182
v_fmac_f32 v183, v177, v178
v_cvt_pk_bf16_f32 v35, v183, v182
v_lshlrev_b32 v168, 16, v128
v_and_b32 v169, 0xffff0000, v128
v_lshlrev_b32 v170, 16, v129
v_and_b32 v171, 0xffff0000, v129
v_add_f32 v172, v168, v170
v_add_f32 v173, v169, v171
v_sub_f32 v168, v168, v170
v_sub_f32 v169, v169, v171
v_mul_f32 v170, v164, v52
v_mul_f32 v171, v164, v68
v_mul_f32 v174, v172, v52
v_mul_f32 v175, v172, v68
v_fma_f32 v170, -v148, v100, v170
v_fmac_f32 v171, v148, v84
v_fma_f32 v174, -v173, v68, v174
v_fmac_f32 v175, v173, v52
v_fmac_f32 v174, v168, v170
v_fmac_f32 v175, v168, v171
v_fma_f32 v174, -v169, v171, v174
v_fmac_f32 v175, v169, v170
v_cvt_pk_bf16_f32 v36, v175, v174
v_lshlrev_b32 v176, 16, v130
v_and_b32 v177, 0xffff0000, v130
v_lshlrev_b32 v178, 16, v131
v_and_b32 v179, 0xffff0000, v131
v_add_f32 v180, v176, v178
v_add_f32 v181, v177, v179
v_sub_f32 v176, v176, v178
v_sub_f32 v177, v177, v179
v_mul_f32 v178, v165, v53
v_mul_f32 v179, v165, v69
v_mul_f32 v182, v180, v53
v_mul_f32 v183, v180, v69
v_fma_f32 v178, -v149, v101, v178
v_fmac_f32 v179, v149, v85
v_fma_f32 v182, -v181, v69, v182
v_fmac_f32 v183, v181, v53
v_fmac_f32 v182, v176, v178
v_fmac_f32 v183, v176, v179
v_fma_f32 v182, -v177, v179, v182
v_fmac_f32 v183, v177, v178
v_cvt_pk_bf16_f32 v37, v183, v182
v_lshlrev_b32 v168, 16, v132
v_and_b32 v169, 0xffff0000, v132
v_lshlrev_b32 v170, 16, v133
v_and_b32 v171, 0xffff0000, v133
v_add_f32 v172, v168, v170
v_add_f32 v173, v169, v171
v_sub_f32 v168, v168, v170
v_sub_f32 v169, v169, v171
v_mul_f32 v170, v166, v54
v_mul_f32 v171, v166, v70
v_mul_f32 v174, v172, v54
v_mul_f32 v175, v172, v70
v_fma_f32 v170, -v150, v102, v170
v_fmac_f32 v171, v150, v86
v_fma_f32 v174, -v173, v70, v174
v_fmac_f32 v175, v173, v54
v_fmac_f32 v174, v168, v170
v_fmac_f32 v175, v168, v171
v_fma_f32 v174, -v169, v171, v174
v_fmac_f32 v175, v169, v170
v_cvt_pk_bf16_f32 v38, v175, v174
v_lshlrev_b32 v176, 16, v134
v_and_b32 v177, 0xffff0000, v134
v_lshlrev_b32 v178, 16, v135
v_and_b32 v179, 0xffff0000, v135
v_add_f32 v180, v176, v178
v_add_f32 v181, v177, v179
v_sub_f32 v176, v176, v178
v_sub_f32 v177, v177, v179
v_mul_f32 v178, v167, v55
v_mul_f32 v179, v167, v71
v_mul_f32 v182, v180, v55
v_mul_f32 v183, v180, v71
v_fma_f32 v178, -v151, v103, v178
v_fmac_f32 v179, v151, v87
v_fma_f32 v182, -v181, v71, v182
v_fmac_f32 v183, v181, v55
v_fmac_f32 v182, v176, v178
v_fmac_f32 v183, v176, v179
v_fma_f32 v182, -v177, v179, v182
v_fmac_f32 v183, v177, v178
v_cvt_pk_bf16_f32 v39, v183, v182
v_mfma_f32_32x32x16_bf16 v[40:55], v[24:27], v[192:195], 0
v_mfma_f32_32x32x16_bf16 v[40:55], v[28:31], v[196:199], v[40:55]
v_mfma_f32_32x32x16_bf16 v[40:55], v[32:35], v[200:203], v[40:55]
v_mfma_f32_32x32x16_bf16 v[40:55], v[36:39], v[204:207], v[40:55]
v_mfma_f32_32x32x16_bf16 v[56:71], v[24:27], v[208:211], 0
v_mfma_f32_32x32x16_bf16 v[56:71], v[28:31], v[212:215], v[56:71]
v_mfma_f32_32x32x16_bf16 v[56:71], v[32:35], v[216:219], v[56:71]
v_mfma_f32_32x32x16_bf16 v[56:71], v[36:39], v[220:223], v[56:71]
s_nop 7
v_mul_f32 v168, v40, v224
v_mul_f32 v169, v40, v240
s_nop 1
v_fma_f32 v168, -v56, v240, v168
v_fmac_f32 v169, v56, v224
v_cvt_pk_bf16_f32 v24, v168, v169
v_mul_f32 v170, v41, v225
v_mul_f32 v171, v41, v241
v_fma_f32 v170, -v57, v241, v170
v_fmac_f32 v171, v57, v225
v_cvt_pk_bf16_f32 v25, v170, v171
v_mul_f32 v172, v42, v226
v_mul_f32 v173, v42, v242
v_fma_f32 v172, -v58, v242, v172
v_fmac_f32 v173, v58, v226
v_cvt_pk_bf16_f32 v26, v172, v173
v_mul_f32 v174, v43, v227
v_mul_f32 v175, v43, v243
v_fma_f32 v174, -v59, v243, v174
v_fmac_f32 v175, v59, v227
v_cvt_pk_bf16_f32 v27, v174, v175
v_mul_f32 v168, v44, v228
v_mul_f32 v169, v44, v244
v_fma_f32 v168, -v60, v244, v168
v_fmac_f32 v169, v60, v228
v_cvt_pk_bf16_f32 v28, v168, v169
v_mul_f32 v170, v45, v229
v_mul_f32 v171, v45, v245
v_fma_f32 v170, -v61, v245, v170
v_fmac_f32 v171, v61, v229
v_cvt_pk_bf16_f32 v29, v170, v171
v_mul_f32 v172, v46, v230
v_mul_f32 v173, v46, v246
v_fma_f32 v172, -v62, v246, v172
v_fmac_f32 v173, v62, v230
v_cvt_pk_bf16_f32 v30, v172, v173
v_mul_f32 v174, v47, v231
v_mul_f32 v175, v47, v247
v_fma_f32 v174, -v63, v247, v174
v_fmac_f32 v175, v63, v231
v_cvt_pk_bf16_f32 v31, v174, v175
v_mul_f32 v168, v48, v232
v_mul_f32 v169, v48, v248
v_fma_f32 v168, -v64, v248, v168
v_fmac_f32 v169, v64, v232
v_cvt_pk_bf16_f32 v32, v168, v169
v_mul_f32 v170, v49, v233
v_mul_f32 v171, v49, v249
v_fma_f32 v170, -v65, v249, v170
v_fmac_f32 v171, v65, v233
v_cvt_pk_bf16_f32 v33, v170, v171
v_mul_f32 v172, v50, v234
v_mul_f32 v173, v50, v250
v_fma_f32 v172, -v66, v250, v172
v_fmac_f32 v173, v66, v234
v_cvt_pk_bf16_f32 v34, v172, v173
v_mul_f32 v174, v51, v235
v_mul_f32 v175, v51, v251
v_fma_f32 v174, -v67, v251, v174
v_fmac_f32 v175, v67, v235
v_cvt_pk_bf16_f32 v35, v174, v175
v_mul_f32 v168, v52, v236
v_mul_f32 v169, v52, v252
v_fma_f32 v168, -v68, v252, v168
v_fmac_f32 v169, v68, v236
v_cvt_pk_bf16_f32 v36, v168, v169
v_mul_f32 v170, v53, v237
v_mul_f32 v171, v53, v253
v_fma_f32 v170, -v69, v253, v170
v_fmac_f32 v171, v69, v237
v_cvt_pk_bf16_f32 v37, v170, v171
v_mul_f32 v172, v54, v238
v_mul_f32 v173, v54, v254
v_fma_f32 v172, -v70, v254, v172
v_fmac_f32 v173, v70, v238
v_cvt_pk_bf16_f32 v38, v172, v173
v_mul_f32 v174, v55, v239
v_mul_f32 v175, v55, v255
v_fma_f32 v174, -v71, v255, v174
v_fmac_f32 v175, v71, v239
v_cvt_pk_bf16_f32 v39, v174, v175
v_mfma_f32_32x32x16_bf16 v[40:55], v[192:195], v[24:27], 0
v_mfma_f32_32x32x16_bf16 v[40:55], v[196:199], v[28:31], v[40:55]
v_mfma_f32_32x32x16_bf16 v[40:55], v[200:203], v[32:35], v[40:55]
v_mfma_f32_32x32x16_bf16 v[40:55], v[204:207], v[36:39], v[40:55]
v_mfma_f32_32x32x16_bf16 v[56:71], v[208:211], v[24:27], 0
v_mfma_f32_32x32x16_bf16 v[56:71], v[212:215], v[28:31], v[56:71]
v_mfma_f32_32x32x16_bf16 v[56:71], v[216:219], v[32:35], v[56:71]
v_mfma_f32_32x32x16_bf16 v[56:71], v[220:223], v[36:39], v[56:71]
s_lshr_b32 s64, s62, 16
L_lc24:
ds_read_b128 v[186:189], v184
s_waitcnt lgkmcnt(0)
v_min3_u32 v186, v186, v187, v188
v_min_u32 v186, v186, v189
s_nop 0
v_readfirstlane_b32 s92, v186
s_nop 0
s_cmp_ge_u32 s92, 8
s_cbranch_scc1 L_lcd25
s_sleep 1
s_branch L_lc24
L_lcd25:
s_nop 1
v_cvt_pk_bf16_f32 v24, v40, v56
v_xor_b32 v24, s64, v24
v_cvt_pk_bf16_f32 v25, v41, v57
v_xor_b32 v25, s64, v25
v_cvt_pk_bf16_f32 v26, v42, v58
v_xor_b32 v26, s64, v26
v_cvt_pk_bf16_f32 v27, v43, v59
v_xor_b32 v27, s64, v27
ds_write_b128 v15, v[24:27] offset:0
v_cvt_pk_bf16_f32 v28, v44, v60
v_xor_b32 v28, s64, v28
v_cvt_pk_bf16_f32 v29, v45, v61
v_xor_b32 v29, s64, v29
v_cvt_pk_bf16_f32 v30, v46, v62
v_xor_b32 v30, s64, v30
v_cvt_pk_bf16_f32 v31, v47, v63
v_xor_b32 v31, s64, v31
ds_write_b128 v15, v[28:31] offset:4096
v_cvt_pk_bf16_f32 v32, v48, v64
v_xor_b32 v32, s64, v32
v_cvt_pk_bf16_f32 v33, v49, v65
v_xor_b32 v33, s64, v33
v_cvt_pk_bf16_f32 v34, v50, v66
v_xor_b32 v34, s64, v34
v_cvt_pk_bf16_f32 v35, v51, v67
v_xor_b32 v35, s64, v35
ds_write_b128 v15, v[32:35] offset:8192
v_cvt_pk_bf16_f32 v36, v52, v68
v_xor_b32 v36, s64, v36
v_cvt_pk_bf16_f32 v37, v53, v69
v_xor_b32 v37, s64, v37
v_cvt_pk_bf16_f32 v38, v54, v70
v_xor_b32 v38, s64, v38
v_cvt_pk_bf16_f32 v39, v55, v71
v_xor_b32 v39, s64, v39
ds_write_b128 v15, v[36:39] offset:12288
s_waitcnt lgkmcnt(0)
v_mov_b32 v190, 9
s_mov_b64 exec, 1
ds_write_b32 v185, v190
s_mov_b64 exec, -1
L_lc26:
ds_read_b128 v[186:189], v184
s_waitcnt lgkmcnt(0)
v_min3_u32 v186, v186, v187, v188
v_min_u32 v186, v186, v189
s_nop 0
v_readfirstlane_b32 s92, v186
s_nop 0
s_cmp_ge_u32 s92, 9
s_cbranch_scc1 L_lcd27
s_sleep 1
s_branch L_lc26
L_lcd27:
ds_read_b128 v[24:27], v18 offset:0
ds_read_b128 v[28:31], v18 offset:1024
ds_read_b128 v[32:35], v18 offset:2048
ds_read_b128 v[36:39], v18 offset:3072
s_mov_b32 s64, 0
s_waitcnt lgkmcnt(3)
buffer_store_dwordx4 v[24:27], v14, s[56:59], s64 offen sc1
s_mov_b32 s64, 262144
s_waitcnt lgkmcnt(2)
buffer_store_dwordx4 v[28:31], v14, s[56:59], s64 offen sc1
s_mov_b32 s64, 524288
s_waitcnt lgkmcnt(1)
buffer_store_dwordx4 v[32:35], v14, s[56:59], s64 offen sc1
s_mov_b32 s64, 786432
s_waitcnt lgkmcnt(0)
buffer_store_dwordx4 v[36:39], v14, s[56:59], s64 offen sc1
s_lshl_b32 s64, s67, 14
s_add_u32 s40, s28, s64
s_addc_u32 s41, s29, 0
s_mov_b32 s42, 16384
s_mov_b32 s43, 0x20000
v_and_b32 v8, 31, v1
v_lshrrev_b32 v9, 5, v1
v_lshlrev_b32 v14, 2, v8
v_lshl_add_u32 v14, v9, 9, v14
s_mov_b32 s64, 0x35000000
v_mul_f32 v224, s64, v224
v_mul_f32 v225, s64, v225
v_mul_f32 v226, s64, v226
v_mul_f32 v227, s64, v227
v_mul_f32 v228, s64, v228
v_mul_f32 v229, s64, v229
v_mul_f32 v230, s64, v230
v_mul_f32 v231, s64, v231
v_mul_f32 v232, s64, v232
v_mul_f32 v233, s64, v233
v_mul_f32 v234, s64, v234
v_mul_f32 v235, s64, v235
v_mul_f32 v236, s64, v236
v_mul_f32 v237, s64, v237
v_mul_f32 v238, s64, v238
v_mul_f32 v239, s64, v239
v_mul_f32 v240, s64, v240
v_mul_f32 v241, s64, v241
v_mul_f32 v242, s64, v242
v_mul_f32 v243, s64, v243
v_mul_f32 v244, s64, v244
v_mul_f32 v245, s64, v245
v_mul_f32 v246, s64, v246
v_mul_f32 v247, s64, v247
v_mul_f32 v248, s64, v248
v_mul_f32 v249, s64, v249
v_mul_f32 v250, s64, v250
v_mul_f32 v251, s64, v251
v_mul_f32 v252, s64, v252
v_mul_f32 v253, s64, v253
v_mul_f32 v254, s64, v254
v_mul_f32 v255, s64, v255
s_waitcnt vmcnt(0)
v_mov_b32 v190, 10
s_mov_b64 exec, 1
ds_write_b32 v185, v190
s_mov_b64 exec, -1
s_cmp_lg_u32 s66, 0
s_cbranch_scc1 L_ph28
L_lc29:
ds_read_b128 v[186:189], v184
s_waitcnt lgkmcnt(0)
v_min3_u32 v186, v186, v187, v188
v_min_u32 v186, v186, v189
s_nop 0
v_readfirstlane_b32 s92, v186
s_nop 0
s_cmp_ge_u32 s92, 10
s_cbranch_scc1 L_lcd30
s_sleep 1
s_branch L_lc29
L_lcd30:
s_and_b32 s64, s2, 15
s_lshl_b32 s65, s64, 7
s_add_u32 s65, s65, 6144
s_add_u32 s90, s32, s65
s_addc_u32 s91, s33, 0
s_mov_b32 s65, 1
s_atomic_add s65, s[90:91], 0x0 glc
s_lshl_b32 s64, s64, 2
s_add_u32 s64, s64, 548864
v_lshl_add_u32 v20, v1, 7, s64
v_mov_b32 v21, s37
s_add_u32 s4, s32, s64
s_addc_u32 s5, s33, 0
s_and_b32 s64, s2, 31
s_lshl_b32 s64, s64, 7
s_add_u32 s64, s64, 548864
s_waitcnt lgkmcnt(0)
s_cmp_lg_u32 s65, 15
s_cbranch_scc1 L_sg31
s_atomic_swap s37, s[4:5], 0x0
s_atomic_swap s37, s[4:5], 0x80
s_atomic_swap s37, s[4:5], 0x100
s_atomic_swap s37, s[4:5], 0x180
s_atomic_swap s37, s[4:5], 0x200
s_atomic_swap s37, s[4:5], 0x280
s_atomic_swap s37, s[4:5], 0x300
s_atomic_swap s37, s[4:5], 0x380
s_atomic_swap s37, s[4:5], 0x400
s_atomic_swap s37, s[4:5], 0x480
s_atomic_swap s37, s[4:5], 0x500
s_atomic_swap s37, s[4:5], 0x580
s_atomic_swap s37, s[4:5], 0x600
s_atomic_swap s37, s[4:5], 0x680
s_atomic_swap s37, s[4:5], 0x700
s_atomic_swap s37, s[4:5], 0x780
s_atomic_swap s37, s[4:5], 0x800
s_atomic_swap s37, s[4:5], 0x880
s_atomic_swap s37, s[4:5], 0x900
s_atomic_swap s37, s[4:5], 0x980
s_atomic_swap s37, s[4:5], 0xa00
s_atomic_swap s37, s[4:5], 0xa80
s_atomic_swap s37, s[4:5], 0xb00
s_atomic_swap s37, s[4:5], 0xb80
s_atomic_swap s37, s[4:5], 0xc00
s_atomic_swap s37, s[4:5], 0xc80
s_atomic_swap s37, s[4:5], 0xd00
s_atomic_swap s37, s[4:5], 0xd80
s_atomic_swap s37, s[4:5], 0xe00
s_atomic_swap s37, s[4:5], 0xe80
s_atomic_swap s37, s[4:5], 0xf00
s_atomic_swap s37, s[4:5], 0xf80
s_waitcnt lgkmcnt(0)
L_sg31:
s_add_u32 s90, s32, s64
s_addc_u32 s91, s33, 0
s_mov_b32 s64, s37
s_mov_b32 s65, s37
s_mov_b32 s92, 0
s_branch L_sp32
L_nok33:
s_add_u32 s92, s92, 1
s_cmp_ge_u32 s92, 200000
s_cbranch_scc1 L_ph28
s_sleep 2
L_sp32:
s_load_dwordx16 s[4:19], s[90:91], 0x0 glc
s_waitcnt lgkmcnt(0)
s_cmp_eq_u64 s[4:5], s[64:65]
s_cbranch_scc0 L_nok33
s_cmp_eq_u64 s[6:7], s[64:65]
s_cbranch_scc0 L_nok33
s_cmp_eq_u64 s[8:9], s[64:65]
s_cbranch_scc0 L_nok33
s_cmp_eq_u64 s[10:11], s[64:65]
s_cbranch_scc0 L_nok33
s_cmp_eq_u64 s[12:13], s[64:65]
s_cbranch_scc0 L_nok33
s_cmp_eq_u64 s[14:15], s[64:65]
s_cbranch_scc0 L_nok33
s_cmp_eq_u64 s[16:17], s[64:65]
s_cbranch_scc0 L_nok33
s_cmp_eq_u64 s[18:19], s[64:65]
s_cbranch_scc0 L_nok33
L_ph28:
v_mov_b32 v190, 11
s_mov_b64 exec, 1
ds_write_b32 v185, v190
s_mov_b64 exec, -1
L_lc34:
ds_read_b128 v[186:189], v184
s_waitcnt lgkmcnt(0)
v_min3_u32 v186, v186, v187, v188
v_min_u32 v186, v186, v189
s_nop 0
v_readfirstlane_b32 s92, v186
s_nop 0
s_cmp_ge_u32 s92, 11
s_cbranch_scc1 L_lcd35
s_sleep 1
s_branch L_lc34
L_lcd35:
s_mov_b32 m0, s68
s_nop 0
buffer_load_dwordx4 v7, s[44:47], 0 offen offset:0 sc1 lds
buffer_load_dwordx4 v7, s[44:47], 0 offen offset:1024 sc1 lds
buffer_load_dwordx4 v7, s[44:47], 0 offen offset:2048 sc1 lds
buffer_load_dwordx4 v7, s[44:47], 0 offen offset:3072 sc1 lds
s_waitcnt vmcnt(0)
v_mov_b32 v190, 12
s_mov_b64 exec, 1
ds_write_b32 v185, v190
s_mov_b64 exec, -1
L_lc36:
ds_read_b128 v[186:189], v184
s_waitcnt lgkmcnt(0)
v_min3_u32 v186, v186, v187, v188
v_min_u32 v186, v186, v189
s_nop 0
v_readfirstlane_b32 s92, v186
s_nop 0
s_cmp_ge_u32 s92, 12
s_cbranch_scc1 L_lcd37
s_sleep 1
s_branch L_lc36
L_lcd37:
ds_read_b32 v24, v4 offset:0
ds_read_b32 v25, v4 offset:1024
ds_read_b32 v26, v4 offset:2048
ds_read_b32 v27, v4 offset:3072
ds_read_b32 v28, v4 offset:8192
ds_read_b32 v29, v4 offset:9216
ds_read_b32 v30, v4 offset:10240
ds_read_b32 v31, v4 offset:11264
ds_read_b32 v32, v6 offset:0
ds_read_b32 v33, v5 offset:10240
ds_read_b32 v34, v5 offset:9216
ds_read_b32 v35, v5 offset:8192
ds_read_b32 v36, v5 offset:3072
ds_read_b32 v37, v5 offset:2048
ds_read_b32 v38, v5 offset:1024
ds_read_b32 v39, v5 offset:0
s_waitcnt lgkmcnt(0)
v_mfma_f32_32x32x16_bf16 v[40:55], v[24:27], v[192:195], 0
v_mfma_f32_32x32x16_bf16 v[40:55], v[28:31], v[196:199], v[40:55]
v_mfma_f32_32x32x16_bf16 v[40:55], v[32:35], v[200:203], v[40:55]
v_mfma_f32_32x32x16_bf16 v[40:55], v[36:39], v[204:207], v[40:55]
v_mfma_f32_32x32x16_bf16 v[56:71], v[24:27], v[208:211], 0
v_mfma_f32_32x32x16_bf16 v[56:71], v[28:31], v[212:215], v[56:71]
v_mfma_f32_32x32x16_bf16 v[56:71], v[32:35], v[216:219], v[56:71]
v_mfma_f32_32x32x16_bf16 v[56:71], v[36:39], v[220:223], v[56:71]
s_nop 7
v_mul_f32 v168, v40, v224
v_mul_f32 v169, v40, v240
s_nop 1
v_fma_f32 v168, -v56, v240, v168
v_fmac_f32 v169, v56, v224
v_cvt_pk_bf16_f32 v24, v168, v169
v_mul_f32 v170, v41, v225
v_mul_f32 v171, v41, v241
v_fma_f32 v170, -v57, v241, v170
v_fmac_f32 v171, v57, v225
v_cvt_pk_bf16_f32 v25, v170, v171
v_mul_f32 v172, v42, v226
v_mul_f32 v173, v42, v242
v_fma_f32 v172, -v58, v242, v172
v_fmac_f32 v173, v58, v226
v_cvt_pk_bf16_f32 v26, v172, v173
v_mul_f32 v174, v43, v227
v_mul_f32 v175, v43, v243
v_fma_f32 v174, -v59, v243, v174
v_fmac_f32 v175, v59, v227
v_cvt_pk_bf16_f32 v27, v174, v175
v_mul_f32 v168, v44, v228
v_mul_f32 v169, v44, v244
v_fma_f32 v168, -v60, v244, v168
v_fmac_f32 v169, v60, v228
v_cvt_pk_bf16_f32 v28, v168, v169
v_mul_f32 v170, v45, v229
v_mul_f32 v171, v45, v245
v_fma_f32 v170, -v61, v245, v170
v_fmac_f32 v171, v61, v229
v_cvt_pk_bf16_f32 v29, v170, v171
v_mul_f32 v172, v46, v230
v_mul_f32 v173, v46, v246
v_fma_f32 v172, -v62, v246, v172
v_fmac_f32 v173, v62, v230
v_cvt_pk_bf16_f32 v30, v172, v173
v_mul_f32 v174, v47, v231
v_mul_f32 v175, v47, v247
v_fma_f32 v174, -v63, v247, v174
v_fmac_f32 v175, v63, v231
v_cvt_pk_bf16_f32 v31, v174, v175
v_mul_f32 v168, v48, v232
v_mul_f32 v169, v48, v248
v_fma_f32 v168, -v64, v248, v168
v_fmac_f32 v169, v64, v232
v_cvt_pk_bf16_f32 v32, v168, v169
v_mul_f32 v170, v49, v233
v_mul_f32 v171, v49, v249
v_fma_f32 v170, -v65, v249, v170
v_fmac_f32 v171, v65, v233
v_cvt_pk_bf16_f32 v33, v170, v171
v_mul_f32 v172, v50, v234
v_mul_f32 v173, v50, v250
v_fma_f32 v172, -v66, v250, v172
v_fmac_f32 v173, v66, v234
v_cvt_pk_bf16_f32 v34, v172, v173
v_mul_f32 v174, v51, v235
v_mul_f32 v175, v51, v251
v_fma_f32 v174, -v67, v251, v174
v_fmac_f32 v175, v67, v235
v_cvt_pk_bf16_f32 v35, v174, v175
v_mul_f32 v168, v52, v236
v_mul_f32 v169, v52, v252
v_fma_f32 v168, -v68, v252, v168
v_fmac_f32 v169, v68, v236
v_cvt_pk_bf16_f32 v36, v168, v169
v_mul_f32 v170, v53, v237
v_mul_f32 v171, v53, v253
v_fma_f32 v170, -v69, v253, v170
v_fmac_f32 v171, v69, v237
v_cvt_pk_bf16_f32 v37, v170, v171
v_mul_f32 v172, v54, v238
v_mul_f32 v173, v54, v254
v_fma_f32 v172, -v70, v254, v172
v_fmac_f32 v173, v70, v238
v_cvt_pk_bf16_f32 v38, v172, v173
v_mul_f32 v174, v55, v239
v_mul_f32 v175, v55, v255
v_fma_f32 v174, -v71, v255, v174
v_fmac_f32 v175, v71, v239
v_cvt_pk_bf16_f32 v39, v174, v175
v_mfma_f32_32x32x16_bf16 v[40:55], v[192:195], v[24:27], 0
v_mfma_f32_32x32x16_bf16 v[40:55], v[196:199], v[28:31], v[40:55]
v_mfma_f32_32x32x16_bf16 v[40:55], v[200:203], v[32:35], v[40:55]
v_mfma_f32_32x32x16_bf16 v[40:55], v[204:207], v[36:39], v[40:55]
v_mfma_f32_32x32x16_bf16 v[56:71], v[208:211], v[24:27], 0
v_mfma_f32_32x32x16_bf16 v[56:71], v[212:215], v[28:31], v[56:71]
v_mfma_f32_32x32x16_bf16 v[56:71], v[216:219], v[32:35], v[56:71]
v_mfma_f32_32x32x16_bf16 v[56:71], v[220:223], v[36:39], v[56:71]
s_movk_i32 s64, 0x2000
s_nop 10
v_cvt_pk_bf16_f32 v73, v56, v40
v_lshlrev_b32 v72, 16, v73
v_and_b32 v73, 0xffff0000, v73
buffer_store_dword v72, v14, s[40:43], 0 offen offset:0 nt
buffer_store_dword v73, v14, s[40:43], s64 offen offset:0 nt
v_cvt_pk_bf16_f32 v75, v57, v41
v_lshlrev_b32 v74, 16, v75
v_and_b32 v75, 0xffff0000, v75
buffer_store_dword v74, v14, s[40:43], 0 offen offset:128 nt
buffer_store_dword v75, v14, s[40:43], s64 offen offset:128 nt
v_cvt_pk_bf16_f32 v77, v58, v42
v_lshlrev_b32 v76, 16, v77
v_and_b32 v77, 0xffff0000, v77
buffer_store_dword v76, v14, s[40:43], 0 offen offset:256 nt
buffer_store_dword v77, v14, s[40:43], s64 offen offset:256 nt
v_cvt_pk_bf16_f32 v79, v59, v43
v_lshlrev_b32 v78, 16, v79
v_and_b32 v79, 0xffff0000, v79
buffer_store_dword v78, v14, s[40:43], 0 offen offset:384 nt
buffer_store_dword v79, v14, s[40:43], s64 offen offset:384 nt
v_cvt_pk_bf16_f32 v81, v60, v44
v_lshlrev_b32 v80, 16, v81
v_and_b32 v81, 0xffff0000, v81
buffer_store_dword v80, v14, s[40:43], 0 offen offset:1024 nt
buffer_store_dword v81, v14, s[40:43], s64 offen offset:1024 nt
v_cvt_pk_bf16_f32 v83, v61, v45
v_lshlrev_b32 v82, 16, v83
v_and_b32 v83, 0xffff0000, v83
buffer_store_dword v82, v14, s[40:43], 0 offen offset:1152 nt
buffer_store_dword v83, v14, s[40:43], s64 offen offset:1152 nt
v_cvt_pk_bf16_f32 v85, v62, v46
v_lshlrev_b32 v84, 16, v85
v_and_b32 v85, 0xffff0000, v85
buffer_store_dword v84, v14, s[40:43], 0 offen offset:1280 nt
buffer_store_dword v85, v14, s[40:43], s64 offen offset:1280 nt
v_cvt_pk_bf16_f32 v87, v63, v47
v_lshlrev_b32 v86, 16, v87
v_and_b32 v87, 0xffff0000, v87
buffer_store_dword v86, v14, s[40:43], 0 offen offset:1408 nt
buffer_store_dword v87, v14, s[40:43], s64 offen offset:1408 nt
v_cvt_pk_bf16_f32 v89, v64, v48
v_lshlrev_b32 v88, 16, v89
v_and_b32 v89, 0xffff0000, v89
buffer_store_dword v88, v14, s[40:43], 0 offen offset:2048 nt
buffer_store_dword v89, v14, s[40:43], s64 offen offset:2048 nt
v_cvt_pk_bf16_f32 v91, v65, v49
v_lshlrev_b32 v90, 16, v91
v_and_b32 v91, 0xffff0000, v91
buffer_store_dword v90, v14, s[40:43], 0 offen offset:2176 nt
buffer_store_dword v91, v14, s[40:43], s64 offen offset:2176 nt
v_cvt_pk_bf16_f32 v93, v66, v50
v_lshlrev_b32 v92, 16, v93
v_and_b32 v93, 0xffff0000, v93
buffer_store_dword v92, v14, s[40:43], 0 offen offset:2304 nt
buffer_store_dword v93, v14, s[40:43], s64 offen offset:2304 nt
v_cvt_pk_bf16_f32 v95, v67, v51
v_lshlrev_b32 v94, 16, v95
v_and_b32 v95, 0xffff0000, v95
buffer_store_dword v94, v14, s[40:43], 0 offen offset:2432 nt
buffer_store_dword v95, v14, s[40:43], s64 offen offset:2432 nt
v_cvt_pk_bf16_f32 v97, v68, v52
v_lshlrev_b32 v96, 16, v97
v_and_b32 v97, 0xffff0000, v97
buffer_store_dword v96, v14, s[40:43], 0 offen offset:3072 nt
buffer_store_dword v97, v14, s[40:43], s64 offen offset:3072 nt
v_cvt_pk_bf16_f32 v99, v69, v53
v_lshlrev_b32 v98, 16, v99
v_and_b32 v99, 0xffff0000, v99
buffer_store_dword v98, v14, s[40:43], 0 offen offset:3200 nt
buffer_store_dword v99, v14, s[40:43], s64 offen offset:3200 nt
v_cvt_pk_bf16_f32 v101, v70, v54
v_lshlrev_b32 v100, 16, v101
v_and_b32 v101, 0xffff0000, v101
buffer_store_dword v100, v14, s[40:43], 0 offen offset:3328 nt
buffer_store_dword v101, v14, s[40:43], s64 offen offset:3328 nt
v_cvt_pk_bf16_f32 v103, v71, v55
v_lshlrev_b32 v102, 16, v103
v_and_b32 v103, 0xffff0000, v103
buffer_store_dword v102, v14, s[40:43], 0 offen offset:3456 nt
buffer_store_dword v103, v14, s[40:43], s64 offen offset:3456 nt
s_endpgm
L_concat_heads__spectral_gfnet__ssm_conv_s5__prompt_kernel_gemm:
s_lshr_b32 s68, s34, 1
s_and_b32 s66, s34, 1
v_and_b32 v6, 31, v1
v_lshrrev_b32 v5, 5, v1
v_and_b32 v4, 0x13, v6
v_bfe_u32 v7, v6, 2, 1
v_lshl_or_b32 v4, v7, 3, v4
v_bfe_u32 v7, v6, 3, 1
v_lshl_or_b32 v4, v7, 2, v4
s_lshl_b32 s60, s36, 6
s_lshl_b32 s61, s66, 5
s_add_u32 s60, s60, s61
v_add_u32 v4, s60, v4
v_lshlrev_b32 v7, 1, v4
v_lshlrev_b32 v11, 4, v1
s_waitcnt lgkmcnt(0)
global_load_ushort v8, v7, s[12:13]
global_load_ushort v9, v7, s[14:15]
global_load_ushort v10, v7, s[24:25]
s_lshl_b32 s60, s2, 3
s_add_u32 s60, s60, s34
s_cmp_lg_u32 s60, 1
s_cbranch_scc1 L_nn38
s_load_dword s60, s[32:33], 0
v_mov_b32 v16, 0
v_and_b32 v17, 31, v1
v_lshlrev_b32 v17, 7, v17
v_add_u32 v17, 4096, v17
global_store_dword v17, v16, s[32:33] sc1
s_waitcnt vmcnt(0) lgkmcnt(0)
s_add_u32 s60, s60, 1
s_cmp_eq_u32 s60, 0
s_cselect_b32 s60, 1, s60
v_mov_b32 v17, s60
s_mov_b64 exec, 1
global_store_dword v16, v17, s[30:31] sc1
global_store_dword v16, v17, s[32:33] offset:0
s_mov_b64 exec, -1
L_nn38:
s_cmp_lg_u32 s34, 0
s_cbranch_scc1 L_pf39
s_lshr_b32 s60, s2, 3
s_lshl_b32 s60, s60, 11
v_and_b32 v12, 15, v1
v_lshl_add_u32 v12, v12, 7, s60
v_min_u32 v12, L_concat_heads__spectral_gfnet__ssm_conv_s5__prompt_kernel_end-concat_heads__spectral_gfnet__ssm_conv_s5__prompt_kernel, v12
s_getpc_b64 s[60:61]
L_pc40:
s_sub_u32 s60, s60, L_pc40-concat_heads__spectral_gfnet__ssm_conv_s5__prompt_kernel
s_subb_u32 s61, s61, 0
global_load_dword v247, v12, s[60:61]
L_pf39:
v_bfe_u32 v7, v6, 1, 3
v_xor_b32 v7, v7, v5
v_lshlrev_b32 v7, 4, v7
v_lshl_add_u32 v7, v6, 7, v7
s_lshl_b32 s60, s68, 13
s_lshl_b32 s61, s66, 13
s_add_u32 s61, s61, 16384
v_xor_b32 v12, 0, v7
v_add_u32 v128, s60, v12
v_add_u32 v132, s61, v12
v_add_u32 v136, 0x10000, v128
v_add_u32 v140, 0x10000, v132
v_xor_b32 v12, 32, v7
v_add_u32 v129, s60, v12
v_add_u32 v133, s61, v12
v_add_u32 v137, 0x10000, v129
v_add_u32 v141, 0x10000, v133
v_xor_b32 v12, 64, v7
v_add_u32 v130, s60, v12
v_add_u32 v134, s61, v12
v_add_u32 v138, 0x10000, v130
v_add_u32 v142, 0x10000, v134
v_xor_b32 v12, 96, v7
v_add_u32 v131, s60, v12
v_add_u32 v135, s61, v12
v_add_u32 v139, 0x10000, v131
v_add_u32 v143, 0x10000, v135
v_mov_b64 v[64:65], 0
v_mov_b64 v[66:67], 0
v_mov_b64 v[68:69], 0
v_mov_b64 v[70:71], 0
v_mov_b64 v[72:73], 0
v_mov_b64 v[74:75], 0
v_mov_b64 v[76:77], 0
v_mov_b64 v[78:79], 0
v_mov_b64 v[80:81], 0
v_mov_b64 v[82:83], 0
v_mov_b64 v[84:85], 0
v_mov_b64 v[86:87], 0
v_mov_b64 v[88:89], 0
v_mov_b64 v[90:91], 0
v_mov_b64 v[92:93], 0
v_mov_b64 v[94:95], 0
v_mov_b64 v[96:97], 0
v_mov_b64 v[98:99], 0
v_mov_b64 v[100:101], 0
v_mov_b64 v[102:103], 0
v_mov_b64 v[104:105], 0
v_mov_b64 v[106:107], 0
v_mov_b64 v[108:109], 0
v_mov_b64 v[110:111], 0
v_mov_b64 v[112:113], 0
v_mov_b64 v[114:115], 0
v_mov_b64 v[116:117], 0
v_mov_b64 v[118:119], 0
v_mov_b64 v[120:121], 0
v_mov_b64 v[122:123], 0
v_mov_b64 v[124:125], 0
v_mov_b64 v[126:127], 0
v_mov_b32 v34, 126976
v_mov_b64 v[36:37], 0
v_mov_b64 v[38:39], 0
s_mov_b64 exec, 1
ds_write_b128 v34, v[36:39]
ds_write_b128 v34, v[36:39] offset:16
s_mov_b64 exec, -1
v_lshlrev_b32 v12, 4, v5
v_sub_u32 v12, v6, v12
v_mov_b32 v13, 0x3f80
v_mov_b32 v14, 1.0
v_cmp_eq_u32 vcc, 0, v12
v_cmp_eq_u32 s[60:61], 8, v12
s_nop 0
v_cndmask_b32 v248, 0, v13, vcc
v_cndmask_b32 v248, v248, v14, s[60:61]
v_cmp_eq_u32 vcc, 1, v12
v_cmp_eq_u32 s[60:61], 9, v12
s_nop 0
v_cndmask_b32 v249, 0, v13, vcc
v_cndmask_b32 v249, v249, v14, s[60:61]
v_cmp_eq_u32 vcc, 2, v12
v_cmp_eq_u32 s[60:61], 10, v12
s_nop 0
v_cndmask_b32 v250, 0, v13, vcc
v_cndmask_b32 v250, v250, v14, s[60:61]
v_cmp_eq_u32 vcc, 3, v12
v_cmp_eq_u32 s[60:61], 11, v12
s_nop 0
v_cndmask_b32 v251, 0, v13, vcc
v_cndmask_b32 v251, v251, v14, s[60:61]
v_cmp_eq_u32 vcc, 4, v12
v_cmp_eq_u32 s[60:61], 12, v12
s_nop 0
v_cndmask_b32 v252, 0, v13, vcc
v_cndmask_b32 v252, v252, v14, s[60:61]
v_cmp_eq_u32 vcc, 5, v12
v_cmp_eq_u32 s[60:61], 13, v12
s_nop 0
v_cndmask_b32 v253, 0, v13, vcc
v_cndmask_b32 v253, v253, v14, s[60:61]
v_cmp_eq_u32 vcc, 6, v12
v_cmp_eq_u32 s[60:61], 14, v12
s_nop 0
v_cndmask_b32 v254, 0, v13, vcc
v_cndmask_b32 v254, v254, v14, s[60:61]
v_cmp_eq_u32 vcc, 7, v12
v_cmp_eq_u32 s[60:61], 15, v12
s_nop 0
v_cndmask_b32 v255, 0, v13, vcc
v_cndmask_b32 v255, v255, v14, s[60:61]
s_add_u32 s40, s32, 65536
s_addc_u32 s41, s33, 0
s_mov_b32 s42, 262144
s_mov_b32 s43, 0x20000
s_add_u32 s44, s32, 1048576
s_addc_u32 s45, s33, 0
s_mov_b32 s46, 8388608
s_mov_b32 s47, 0x20000
s_waitcnt vmcnt(0)
v_lshlrev_b32 v8, 16, v8
v_lshlrev_b32 v9, 16, v9
v_lshlrev_b32 v10, 16, v10
v_mul_f32 v10, 0x3fb8aa3b, v10
v_exp_f32 v10, v10
s_nop 0
v_cvt_pk_bf16_f32 v10, v10, v10
v_lshlrev_b32 v10, 16, v10
v_mul_f32 v12, v10, v8
v_mul_f32 v13, v10, v9
v_mul_f32 v12, 0x3fb8aa3b, v12
v_exp_f32 v12, v12
v_mul_f32 v13, 0.15915494, v13
v_rndne_f32 v14, v13
v_sub_f32 v13, v13, v14
v_cos_f32 v14, v13
v_sin_f32 v15, v13
v_mul_f32 v24, v12, v14
v_mul_f32 v25, v12, v15
v_add_f32 v12, -1.0, v24
v_mul_f32 v13, v8, v8
v_fma_f32 v13, v9, v9, v13
v_rcp_f32 v13, v13
s_nop 0
v_add_f32 v13, v13, v13
v_mul_f32 v14, v12, v8
v_fma_f32 v14, v25, v9, v14
v_mul_f32 v26, v14, v13
v_mul_f32 v14, v25, v8
v_fma_f32 v14, -v12, v9, v14
v_mul_f32 v27, v14, v13
v_mul_f32 v12, v25, v25
v_mul_f32 v13, v24, v25
v_fma_f32 v28, v24, v24, -v12
v_add_f32 v29, v13, v13
v_mul_f32 v12, v29, v29
v_mul_f32 v13, v28, v29
v_fma_f32 v28, v28, v28, -v12
v_add_f32 v29, v13, v13
v_mul_f32 v12, v29, v29
v_mul_f32 v13, v28, v29
v_fma_f32 v28, v28, v28, -v12
v_add_f32 v29, v13, v13
v_mul_f32 v12, v29, v29
v_mul_f32 v13, v28, v29
v_fma_f32 v28, v28, v28, -v12
v_add_f32 v29, v13, v13
v_mul_f32 v12, v29, v29
v_mul_f32 v13, v28, v29
v_fma_f32 v20, v28, v28, -v12
v_add_f32 v21, v13, v13
v_mul_f32 v12, v21, v21
v_mul_f32 v13, v20, v21
v_fma_f32 v30, v20, v20, -v12
v_add_f32 v31, v13, v13
v_mul_f32 v12, v31, v31
v_mul_f32 v13, v30, v31
v_fma_f32 v30, v30, v30, -v12
v_add_f32 v31, v13, v13
v_mul_f32 v12, v31, v31
v_mul_f32 v13, v30, v31
v_fma_f32 v2, v30, v30, -v12
v_add_f32 v3, v13, v13
s_waitcnt lgkmcnt(0)
s_barrier
ds_read_b128 v[32:35], v128 offset:0
ds_read_b128 v[36:39], v132 offset:0
ds_read_b128 v[40:43], v132 offset:4096
ds_read_b128 v[44:47], v128 offset:4096
s_waitcnt lgkmcnt(2)
v_mfma_f32_32x32x16_bf16 v[64:79], v[32:35], v[36:39], v[64:79]
ds_read_b128 v[48:51], v129 offset:0
ds_read_b128 v[52:55], v133 offset:0
s_waitcnt lgkmcnt(3)
v_mfma_f32_32x32x16_bf16 v[80:95], v[32:35], v[40:43], v[80:95]
ds_read_b128 v[56:59], v133 offset:4096
ds_read_b128 v[60:63], v129 offset:4096
s_waitcnt lgkmcnt(4)
v_mfma_f32_32x32x16_bf16 v[96:111], v[44:47], v[36:39], v[96:111]
v_mfma_f32_32x32x16_bf16 v[112:127], v[44:47], v[40:43], v[112:127]
s_waitcnt lgkmcnt(2)
v_mfma_f32_32x32x16_bf16 v[64:79], v[48:51], v[52:55], v[64:79]
ds_read_b128 v[32:35], v130 offset:0
ds_read_b128 v[36:39], v134 offset:0
s_waitcnt lgkmcnt(3)
v_mfma_f32_32x32x16_bf16 v[80:95], v[48:51], v[56:59], v[80:95]
ds_read_b128 v[40:43], v134 offset:4096
ds_read_b128 v[44:47], v130 offset:4096
s_waitcnt lgkmcnt(4)
v_mfma_f32_32x32x16_bf16 v[96:111], v[60:63], v[52:55], v[96:111]
v_mfma_f32_32x32x16_bf16 v[112:127], v[60:63], v[56:59], v[112:127]
s_waitcnt lgkmcnt(2)
v_mfma_f32_32x32x16_bf16 v[64:79], v[32:35], v[36:39], v[64:79]
ds_read_b128 v[48:51], v131 offset:0
ds_read_b128 v[52:55], v135 offset:0
s_waitcnt lgkmcnt(3)
v_mfma_f32_32x32x16_bf16 v[80:95], v[32:35], v[40:43], v[80:95]
ds_read_b128 v[56:59], v135 offset:4096
ds_read_b128 v[60:63], v131 offset:4096
s_waitcnt lgkmcnt(4)
v_mfma_f32_32x32x16_bf16 v[96:111], v[44:47], v[36:39], v[96:111]
v_mfma_f32_32x32x16_bf16 v[112:127], v[44:47], v[40:43], v[112:127]
s_waitcnt lgkmcnt(0)
s_barrier
v_mfma_f32_32x32x16_bf16 v[64:79], v[48:51], v[52:55], v[64:79]
ds_read_b128 v[32:35], v128 offset:32768
ds_read_b128 v[36:39], v132 offset:32768
v_mfma_f32_32x32x16_bf16 v[80:95], v[48:51], v[56:59], v[80:95]
ds_read_b128 v[40:43], v132 offset:36864
ds_read_b128 v[44:47], v128 offset:36864
v_mfma_f32_32x32x16_bf16 v[96:111], v[60:63], v[52:55], v[96:111]
v_mfma_f32_32x32x16_bf16 v[112:127], v[60:63], v[56:59], v[112:127]
s_waitcnt lgkmcnt(2)
v_mfma_f32_32x32x16_bf16 v[64:79], v[32:35], v[36:39], v[64:79]
ds_read_b128 v[48:51], v129 offset:32768
ds_read_b128 v[52:55], v133 offset:32768
s_waitcnt lgkmcnt(3)
v_mfma_f32_32x32x16_bf16 v[80:95], v[32:35], v[40:43], v[80:95]
ds_read_b128 v[56:59], v133 offset:36864
ds_read_b128 v[60:63], v129 offset:36864
s_waitcnt lgkmcnt(4)
v_mfma_f32_32x32x16_bf16 v[96:111], v[44:47], v[36:39], v[96:111]
v_mfma_f32_32x32x16_bf16 v[112:127], v[44:47], v[40:43], v[112:127]
s_waitcnt lgkmcnt(2)
v_mfma_f32_32x32x16_bf16 v[64:79], v[48:51], v[52:55], v[64:79]
ds_read_b128 v[32:35], v130 offset:32768
ds_read_b128 v[36:39], v134 offset:32768
s_waitcnt lgkmcnt(3)
v_mfma_f32_32x32x16_bf16 v[80:95], v[48:51], v[56:59], v[80:95]
ds_read_b128 v[40:43], v134 offset:36864
ds_read_b128 v[44:47], v130 offset:36864
s_waitcnt lgkmcnt(4)
v_mfma_f32_32x32x16_bf16 v[96:111], v[60:63], v[52:55], v[96:111]
v_mfma_f32_32x32x16_bf16 v[112:127], v[60:63], v[56:59], v[112:127]
s_waitcnt lgkmcnt(2)
v_mfma_f32_32x32x16_bf16 v[64:79], v[32:35], v[36:39], v[64:79]
ds_read_b128 v[48:51], v131 offset:32768
ds_read_b128 v[52:55], v135 offset:32768
s_waitcnt lgkmcnt(3)
v_mfma_f32_32x32x16_bf16 v[80:95], v[32:35], v[40:43], v[80:95]
ds_read_b128 v[56:59], v135 offset:36864
ds_read_b128 v[60:63], v131 offset:36864
s_waitcnt lgkmcnt(4)
v_mfma_f32_32x32x16_bf16 v[96:111], v[44:47], v[36:39], v[96:111]
v_mfma_f32_32x32x16_bf16 v[112:127], v[44:47], v[40:43], v[112:127]
s_waitcnt lgkmcnt(0)
s_barrier
v_mfma_f32_32x32x16_bf16 v[64:79], v[48:51], v[52:55], v[64:79]
ds_read_b128 v[32:35], v136 offset:0
ds_read_b128 v[36:39], v140 offset:0
v_mfma_f32_32x32x16_bf16 v[80:95], v[48:51], v[56:59], v[80:95]
ds_read_b128 v[40:43], v140 offset:4096
ds_read_b128 v[44:47], v136 offset:4096
v_mfma_f32_32x32x16_bf16 v[96:111], v[60:63], v[52:55], v[96:111]
v_mfma_f32_32x32x16_bf16 v[112:127], v[60:63], v[56:59], v[112:127]
s_waitcnt lgkmcnt(2)
v_mfma_f32_32x32x16_bf16 v[64:79], v[32:35], v[36:39], v[64:79]
ds_read_b128 v[48:51], v137 offset:0
ds_read_b128 v[52:55], v141 offset:0
s_waitcnt lgkmcnt(3)
v_mfma_f32_32x32x16_bf16 v[80:95], v[32:35], v[40:43], v[80:95]
ds_read_b128 v[56:59], v141 offset:4096
ds_read_b128 v[60:63], v137 offset:4096
s_waitcnt lgkmcnt(4)
v_mfma_f32_32x32x16_bf16 v[96:111], v[44:47], v[36:39], v[96:111]
v_mfma_f32_32x32x16_bf16 v[112:127], v[44:47], v[40:43], v[112:127]
s_waitcnt lgkmcnt(2)
v_mfma_f32_32x32x16_bf16 v[64:79], v[48:51], v[52:55], v[64:79]
ds_read_b128 v[32:35], v138 offset:0
ds_read_b128 v[36:39], v142 offset:0
s_waitcnt lgkmcnt(3)
v_mfma_f32_32x32x16_bf16 v[80:95], v[48:51], v[56:59], v[80:95]
ds_read_b128 v[40:43], v142 offset:4096
ds_read_b128 v[44:47], v138 offset:4096
s_waitcnt lgkmcnt(4)
v_mfma_f32_32x32x16_bf16 v[96:111], v[60:63], v[52:55], v[96:111]
v_mfma_f32_32x32x16_bf16 v[112:127], v[60:63], v[56:59], v[112:127]
s_waitcnt lgkmcnt(2)
v_mfma_f32_32x32x16_bf16 v[64:79], v[32:35], v[36:39], v[64:79]
ds_read_b128 v[48:51], v139 offset:0
ds_read_b128 v[52:55], v143 offset:0
s_waitcnt lgkmcnt(3)
v_mfma_f32_32x32x16_bf16 v[80:95], v[32:35], v[40:43], v[80:95]
ds_read_b128 v[56:59], v143 offset:4096
ds_read_b128 v[60:63], v139 offset:4096
s_waitcnt lgkmcnt(4)
v_mfma_f32_32x32x16_bf16 v[96:111], v[44:47], v[36:39], v[96:111]
v_mfma_f32_32x32x16_bf16 v[112:127], v[44:47], v[40:43], v[112:127]
s_waitcnt lgkmcnt(0)
s_barrier
v_mfma_f32_32x32x16_bf16 v[64:79], v[48:51], v[52:55], v[64:79]
ds_read_b128 v[32:35], v128 offset:0
ds_read_b128 v[36:39], v132 offset:0
v_mfma_f32_32x32x16_bf16 v[80:95], v[48:51], v[56:59], v[80:95]
ds_read_b128 v[40:43], v132 offset:4096
ds_read_b128 v[44:47], v128 offset:4096
v_mfma_f32_32x32x16_bf16 v[96:111], v[60:63], v[52:55], v[96:111]
v_mfma_f32_32x32x16_bf16 v[112:127], v[60:63], v[56:59], v[112:127]
s_waitcnt lgkmcnt(2)
v_mfma_f32_32x32x16_bf16 v[64:79], v[32:35], v[36:39], v[64:79]
ds_read_b128 v[48:51], v129 offset:0
ds_read_b128 v[52:55], v133 offset:0
s_waitcnt lgkmcnt(3)
v_mfma_f32_32x32x16_bf16 v[80:95], v[32:35], v[40:43], v[80:95]
ds_read_b128 v[56:59], v133 offset:4096
ds_read_b128 v[60:63], v129 offset:4096
s_waitcnt lgkmcnt(4)
v_mfma_f32_32x32x16_bf16 v[96:111], v[44:47], v[36:39], v[96:111]
v_mfma_f32_32x32x16_bf16 v[112:127], v[44:47], v[40:43], v[112:127]
s_waitcnt lgkmcnt(2)
v_mfma_f32_32x32x16_bf16 v[64:79], v[48:51], v[52:55], v[64:79]
ds_read_b128 v[32:35], v130 offset:0
ds_read_b128 v[36:39], v134 offset:0
s_waitcnt lgkmcnt(3)
v_mfma_f32_32x32x16_bf16 v[80:95], v[48:51], v[56:59], v[80:95]
ds_read_b128 v[40:43], v134 offset:4096
ds_read_b128 v[44:47], v130 offset:4096
s_waitcnt lgkmcnt(4)
v_mfma_f32_32x32x16_bf16 v[96:111], v[60:63], v[52:55], v[96:111]
v_mfma_f32_32x32x16_bf16 v[112:127], v[60:63], v[56:59], v[112:127]
s_waitcnt lgkmcnt(2)
v_mfma_f32_32x32x16_bf16 v[64:79], v[32:35], v[36:39], v[64:79]
ds_read_b128 v[48:51], v131 offset:0
ds_read_b128 v[52:55], v135 offset:0
s_waitcnt lgkmcnt(3)
v_mfma_f32_32x32x16_bf16 v[80:95], v[32:35], v[40:43], v[80:95]
ds_read_b128 v[56:59], v135 offset:4096
ds_read_b128 v[60:63], v131 offset:4096
s_waitcnt lgkmcnt(4)
v_mfma_f32_32x32x16_bf16 v[96:111], v[44:47], v[36:39], v[96:111]
v_mfma_f32_32x32x16_bf16 v[112:127], v[44:47], v[40:43], v[112:127]
s_waitcnt lgkmcnt(0)
s_barrier
v_mfma_f32_32x32x16_bf16 v[64:79], v[48:51], v[52:55], v[64:79]
ds_read_b128 v[32:35], v128 offset:32768
ds_read_b128 v[36:39], v132 offset:32768
v_mfma_f32_32x32x16_bf16 v[80:95], v[48:51], v[56:59], v[80:95]
ds_read_b128 v[40:43], v132 offset:36864
ds_read_b128 v[44:47], v128 offset:36864
v_mfma_f32_32x32x16_bf16 v[96:111], v[60:63], v[52:55], v[96:111]
v_mfma_f32_32x32x16_bf16 v[112:127], v[60:63], v[56:59], v[112:127]
s_waitcnt lgkmcnt(2)
v_mfma_f32_32x32x16_bf16 v[64:79], v[32:35], v[36:39], v[64:79]
ds_read_b128 v[48:51], v129 offset:32768
ds_read_b128 v[52:55], v133 offset:32768
s_waitcnt lgkmcnt(3)
v_mfma_f32_32x32x16_bf16 v[80:95], v[32:35], v[40:43], v[80:95]
ds_read_b128 v[56:59], v133 offset:36864
ds_read_b128 v[60:63], v129 offset:36864
s_waitcnt lgkmcnt(4)
v_mfma_f32_32x32x16_bf16 v[96:111], v[44:47], v[36:39], v[96:111]
v_mfma_f32_32x32x16_bf16 v[112:127], v[44:47], v[40:43], v[112:127]
s_waitcnt lgkmcnt(2)
v_mfma_f32_32x32x16_bf16 v[64:79], v[48:51], v[52:55], v[64:79]
ds_read_b128 v[32:35], v130 offset:32768
ds_read_b128 v[36:39], v134 offset:32768
s_waitcnt lgkmcnt(3)
v_mfma_f32_32x32x16_bf16 v[80:95], v[48:51], v[56:59], v[80:95]
ds_read_b128 v[40:43], v134 offset:36864
ds_read_b128 v[44:47], v130 offset:36864
s_waitcnt lgkmcnt(4)
v_mfma_f32_32x32x16_bf16 v[96:111], v[60:63], v[52:55], v[96:111]
v_mfma_f32_32x32x16_bf16 v[112:127], v[60:63], v[56:59], v[112:127]
s_waitcnt lgkmcnt(2)
v_mfma_f32_32x32x16_bf16 v[64:79], v[32:35], v[36:39], v[64:79]
ds_read_b128 v[48:51], v131 offset:32768
ds_read_b128 v[52:55], v135 offset:32768
s_waitcnt lgkmcnt(3)
v_mfma_f32_32x32x16_bf16 v[80:95], v[32:35], v[40:43], v[80:95]
ds_read_b128 v[56:59], v135 offset:36864
ds_read_b128 v[60:63], v131 offset:36864
s_waitcnt lgkmcnt(4)
v_mfma_f32_32x32x16_bf16 v[96:111], v[44:47], v[36:39], v[96:111]
v_mfma_f32_32x32x16_bf16 v[112:127], v[44:47], v[40:43], v[112:127]
s_waitcnt lgkmcnt(0)
s_barrier
v_mfma_f32_32x32x16_bf16 v[64:79], v[48:51], v[52:55], v[64:79]
ds_read_b128 v[32:35], v136 offset:0
ds_read_b128 v[36:39], v140 offset:0
v_mfma_f32_32x32x16_bf16 v[80:95], v[48:51], v[56:59], v[80:95]
ds_read_b128 v[40:43], v140 offset:4096
ds_read_b128 v[44:47], v136 offset:4096
v_mfma_f32_32x32x16_bf16 v[96:111], v[60:63], v[52:55], v[96:111]
v_mfma_f32_32x32x16_bf16 v[112:127], v[60:63], v[56:59], v[112:127]
s_waitcnt lgkmcnt(2)
v_mfma_f32_32x32x16_bf16 v[64:79], v[32:35], v[36:39], v[64:79]
ds_read_b128 v[48:51], v137 offset:0
ds_read_b128 v[52:55], v141 offset:0
s_waitcnt lgkmcnt(3)
v_mfma_f32_32x32x16_bf16 v[80:95], v[32:35], v[40:43], v[80:95]
ds_read_b128 v[56:59], v141 offset:4096
ds_read_b128 v[60:63], v137 offset:4096
s_waitcnt lgkmcnt(4)
v_mfma_f32_32x32x16_bf16 v[96:111], v[44:47], v[36:39], v[96:111]
v_mfma_f32_32x32x16_bf16 v[112:127], v[44:47], v[40:43], v[112:127]
s_waitcnt lgkmcnt(2)
v_mfma_f32_32x32x16_bf16 v[64:79], v[48:51], v[52:55], v[64:79]
ds_read_b128 v[32:35], v138 offset:0
ds_read_b128 v[36:39], v142 offset:0
s_waitcnt lgkmcnt(3)
v_mfma_f32_32x32x16_bf16 v[80:95], v[48:51], v[56:59], v[80:95]
ds_read_b128 v[40:43], v142 offset:4096
ds_read_b128 v[44:47], v138 offset:4096
s_waitcnt lgkmcnt(4)
v_mfma_f32_32x32x16_bf16 v[96:111], v[60:63], v[52:55], v[96:111]
v_mfma_f32_32x32x16_bf16 v[112:127], v[60:63], v[56:59], v[112:127]
s_waitcnt lgkmcnt(2)
v_mfma_f32_32x32x16_bf16 v[64:79], v[32:35], v[36:39], v[64:79]
ds_read_b128 v[48:51], v139 offset:0
ds_read_b128 v[52:55], v143 offset:0
s_waitcnt lgkmcnt(3)
v_mfma_f32_32x32x16_bf16 v[80:95], v[32:35], v[40:43], v[80:95]
ds_read_b128 v[56:59], v143 offset:4096
ds_read_b128 v[60:63], v139 offset:4096
s_waitcnt lgkmcnt(4)
v_mfma_f32_32x32x16_bf16 v[96:111], v[44:47], v[36:39], v[96:111]
v_mfma_f32_32x32x16_bf16 v[112:127], v[44:47], v[40:43], v[112:127]
s_waitcnt lgkmcnt(0)
s_barrier
v_mfma_f32_32x32x16_bf16 v[64:79], v[48:51], v[52:55], v[64:79]
ds_read_b128 v[32:35], v128 offset:0
ds_read_b128 v[36:39], v132 offset:0
v_mfma_f32_32x32x16_bf16 v[80:95], v[48:51], v[56:59], v[80:95]
ds_read_b128 v[40:43], v132 offset:4096
ds_read_b128 v[44:47], v128 offset:4096
v_mfma_f32_32x32x16_bf16 v[96:111], v[60:63], v[52:55], v[96:111]
v_mfma_f32_32x32x16_bf16 v[112:127], v[60:63], v[56:59], v[112:127]
s_waitcnt lgkmcnt(2)
v_mfma_f32_32x32x16_bf16 v[64:79], v[32:35], v[36:39], v[64:79]
ds_read_b128 v[48:51], v129 offset:0
ds_read_b128 v[52:55], v133 offset:0
s_waitcnt lgkmcnt(3)
v_mfma_f32_32x32x16_bf16 v[80:95], v[32:35], v[40:43], v[80:95]
ds_read_b128 v[56:59], v133 offset:4096
ds_read_b128 v[60:63], v129 offset:4096
s_waitcnt lgkmcnt(4)
v_mfma_f32_32x32x16_bf16 v[96:111], v[44:47], v[36:39], v[96:111]
v_mfma_f32_32x32x16_bf16 v[112:127], v[44:47], v[40:43], v[112:127]
s_waitcnt lgkmcnt(2)
v_mfma_f32_32x32x16_bf16 v[64:79], v[48:51], v[52:55], v[64:79]
ds_read_b128 v[32:35], v130 offset:0
ds_read_b128 v[36:39], v134 offset:0
s_waitcnt lgkmcnt(3)
v_mfma_f32_32x32x16_bf16 v[80:95], v[48:51], v[56:59], v[80:95]
ds_read_b128 v[40:43], v134 offset:4096
ds_read_b128 v[44:47], v130 offset:4096
s_waitcnt lgkmcnt(4)
v_mfma_f32_32x32x16_bf16 v[96:111], v[60:63], v[52:55], v[96:111]
v_mfma_f32_32x32x16_bf16 v[112:127], v[60:63], v[56:59], v[112:127]
s_waitcnt lgkmcnt(2)
v_mfma_f32_32x32x16_bf16 v[64:79], v[32:35], v[36:39], v[64:79]
ds_read_b128 v[48:51], v131 offset:0
ds_read_b128 v[52:55], v135 offset:0
s_waitcnt lgkmcnt(3)
v_mfma_f32_32x32x16_bf16 v[80:95], v[32:35], v[40:43], v[80:95]
ds_read_b128 v[56:59], v135 offset:4096
ds_read_b128 v[60:63], v131 offset:4096
s_waitcnt lgkmcnt(4)
v_mfma_f32_32x32x16_bf16 v[96:111], v[44:47], v[36:39], v[96:111]
v_mfma_f32_32x32x16_bf16 v[112:127], v[44:47], v[40:43], v[112:127]
s_waitcnt lgkmcnt(0)
s_barrier
v_mfma_f32_32x32x16_bf16 v[64:79], v[48:51], v[52:55], v[64:79]
ds_read_b128 v[32:35], v128 offset:32768
ds_read_b128 v[36:39], v132 offset:32768
v_mfma_f32_32x32x16_bf16 v[80:95], v[48:51], v[56:59], v[80:95]
ds_read_b128 v[40:43], v132 offset:36864
ds_read_b128 v[44:47], v128 offset:36864
v_mfma_f32_32x32x16_bf16 v[96:111], v[60:63], v[52:55], v[96:111]
v_mfma_f32_32x32x16_bf16 v[112:127], v[60:63], v[56:59], v[112:127]
s_waitcnt lgkmcnt(2)
v_mfma_f32_32x32x16_bf16 v[64:79], v[32:35], v[36:39], v[64:79]
ds_read_b128 v[48:51], v129 offset:32768
ds_read_b128 v[52:55], v133 offset:32768
s_waitcnt lgkmcnt(3)
v_mfma_f32_32x32x16_bf16 v[80:95], v[32:35], v[40:43], v[80:95]
ds_read_b128 v[56:59], v133 offset:36864
ds_read_b128 v[60:63], v129 offset:36864
s_waitcnt lgkmcnt(4)
v_mfma_f32_32x32x16_bf16 v[96:111], v[44:47], v[36:39], v[96:111]
v_mfma_f32_32x32x16_bf16 v[112:127], v[44:47], v[40:43], v[112:127]
s_waitcnt lgkmcnt(2)
v_mfma_f32_32x32x16_bf16 v[64:79], v[48:51], v[52:55], v[64:79]
ds_read_b128 v[32:35], v130 offset:32768
ds_read_b128 v[36:39], v134 offset:32768
s_waitcnt lgkmcnt(3)
v_mfma_f32_32x32x16_bf16 v[80:95], v[48:51], v[56:59], v[80:95]
ds_read_b128 v[40:43], v134 offset:36864
ds_read_b128 v[44:47], v130 offset:36864
s_waitcnt lgkmcnt(4)
v_mfma_f32_32x32x16_bf16 v[96:111], v[60:63], v[52:55], v[96:111]
v_mfma_f32_32x32x16_bf16 v[112:127], v[60:63], v[56:59], v[112:127]
s_waitcnt lgkmcnt(2)
v_mfma_f32_32x32x16_bf16 v[64:79], v[32:35], v[36:39], v[64:79]
ds_read_b128 v[48:51], v131 offset:32768
ds_read_b128 v[52:55], v135 offset:32768
s_waitcnt lgkmcnt(3)
v_mfma_f32_32x32x16_bf16 v[80:95], v[32:35], v[40:43], v[80:95]
ds_read_b128 v[56:59], v135 offset:36864
ds_read_b128 v[60:63], v131 offset:36864
s_waitcnt lgkmcnt(4)
v_mfma_f32_32x32x16_bf16 v[96:111], v[44:47], v[36:39], v[96:111]
v_mfma_f32_32x32x16_bf16 v[112:127], v[44:47], v[40:43], v[112:127]
s_waitcnt lgkmcnt(0)
s_barrier
v_mfma_f32_32x32x16_bf16 v[64:79], v[48:51], v[52:55], v[64:79]
ds_read_b128 v[32:35], v136 offset:0
ds_read_b128 v[36:39], v140 offset:0
v_mfma_f32_32x32x16_bf16 v[80:95], v[48:51], v[56:59], v[80:95]
ds_read_b128 v[40:43], v140 offset:4096
ds_read_b128 v[44:47], v136 offset:4096
v_mfma_f32_32x32x16_bf16 v[96:111], v[60:63], v[52:55], v[96:111]
v_mfma_f32_32x32x16_bf16 v[112:127], v[60:63], v[56:59], v[112:127]
s_waitcnt lgkmcnt(2)
v_mfma_f32_32x32x16_bf16 v[64:79], v[32:35], v[36:39], v[64:79]
ds_read_b128 v[48:51], v137 offset:0
ds_read_b128 v[52:55], v141 offset:0
s_waitcnt lgkmcnt(3)
v_mfma_f32_32x32x16_bf16 v[80:95], v[32:35], v[40:43], v[80:95]
ds_read_b128 v[56:59], v141 offset:4096
ds_read_b128 v[60:63], v137 offset:4096
s_waitcnt lgkmcnt(4)
v_mfma_f32_32x32x16_bf16 v[96:111], v[44:47], v[36:39], v[96:111]
v_mfma_f32_32x32x16_bf16 v[112:127], v[44:47], v[40:43], v[112:127]
s_waitcnt lgkmcnt(2)
v_mfma_f32_32x32x16_bf16 v[64:79], v[48:51], v[52:55], v[64:79]
ds_read_b128 v[32:35], v138 offset:0
ds_read_b128 v[36:39], v142 offset:0
s_waitcnt lgkmcnt(3)
v_mfma_f32_32x32x16_bf16 v[80:95], v[48:51], v[56:59], v[80:95]
ds_read_b128 v[40:43], v142 offset:4096
ds_read_b128 v[44:47], v138 offset:4096
s_waitcnt lgkmcnt(4)
v_mfma_f32_32x32x16_bf16 v[96:111], v[60:63], v[52:55], v[96:111]
v_mfma_f32_32x32x16_bf16 v[112:127], v[60:63], v[56:59], v[112:127]
s_waitcnt lgkmcnt(2)
v_mfma_f32_32x32x16_bf16 v[64:79], v[32:35], v[36:39], v[64:79]
ds_read_b128 v[48:51], v139 offset:0
ds_read_b128 v[52:55], v143 offset:0
s_waitcnt lgkmcnt(3)
v_mfma_f32_32x32x16_bf16 v[80:95], v[32:35], v[40:43], v[80:95]
ds_read_b128 v[56:59], v143 offset:4096
ds_read_b128 v[60:63], v139 offset:4096
s_waitcnt lgkmcnt(4)
v_mfma_f32_32x32x16_bf16 v[96:111], v[44:47], v[36:39], v[96:111]
v_mfma_f32_32x32x16_bf16 v[112:127], v[44:47], v[40:43], v[112:127]
s_waitcnt lgkmcnt(0)
s_barrier
v_mfma_f32_32x32x16_bf16 v[64:79], v[48:51], v[52:55], v[64:79]
ds_read_b128 v[32:35], v128 offset:0
ds_read_b128 v[36:39], v132 offset:0
v_mfma_f32_32x32x16_bf16 v[80:95], v[48:51], v[56:59], v[80:95]
ds_read_b128 v[40:43], v132 offset:4096
ds_read_b128 v[44:47], v128 offset:4096
v_mfma_f32_32x32x16_bf16 v[96:111], v[60:63], v[52:55], v[96:111]
v_mfma_f32_32x32x16_bf16 v[112:127], v[60:63], v[56:59], v[112:127]
s_waitcnt lgkmcnt(2)
v_mfma_f32_32x32x16_bf16 v[64:79], v[32:35], v[36:39], v[64:79]
ds_read_b128 v[48:51], v129 offset:0
ds_read_b128 v[52:55], v133 offset:0
s_waitcnt lgkmcnt(3)
v_mfma_f32_32x32x16_bf16 v[80:95], v[32:35], v[40:43], v[80:95]
ds_read_b128 v[56:59], v133 offset:4096
ds_read_b128 v[60:63], v129 offset:4096
s_waitcnt lgkmcnt(4)
v_mfma_f32_32x32x16_bf16 v[96:111], v[44:47], v[36:39], v[96:111]
v_mfma_f32_32x32x16_bf16 v[112:127], v[44:47], v[40:43], v[112:127]
s_waitcnt lgkmcnt(2)
v_mfma_f32_32x32x16_bf16 v[64:79], v[48:51], v[52:55], v[64:79]
ds_read_b128 v[32:35], v130 offset:0
ds_read_b128 v[36:39], v134 offset:0
s_waitcnt lgkmcnt(3)
v_mfma_f32_32x32x16_bf16 v[80:95], v[48:51], v[56:59], v[80:95]
ds_read_b128 v[40:43], v134 offset:4096
ds_read_b128 v[44:47], v130 offset:4096
s_waitcnt lgkmcnt(4)
v_mfma_f32_32x32x16_bf16 v[96:111], v[60:63], v[52:55], v[96:111]
v_mfma_f32_32x32x16_bf16 v[112:127], v[60:63], v[56:59], v[112:127]
s_waitcnt lgkmcnt(2)
v_mfma_f32_32x32x16_bf16 v[64:79], v[32:35], v[36:39], v[64:79]
ds_read_b128 v[48:51], v131 offset:0
ds_read_b128 v[52:55], v135 offset:0
s_waitcnt lgkmcnt(3)
v_mfma_f32_32x32x16_bf16 v[80:95], v[32:35], v[40:43], v[80:95]
ds_read_b128 v[56:59], v135 offset:4096
ds_read_b128 v[60:63], v131 offset:4096
s_waitcnt lgkmcnt(4)
v_mfma_f32_32x32x16_bf16 v[96:111], v[44:47], v[36:39], v[96:111]
v_mfma_f32_32x32x16_bf16 v[112:127], v[44:47], v[40:43], v[112:127]
s_waitcnt lgkmcnt(0)
s_barrier
v_mfma_f32_32x32x16_bf16 v[64:79], v[48:51], v[52:55], v[64:79]
ds_read_b128 v[32:35], v128 offset:32768
ds_read_b128 v[36:39], v132 offset:32768
v_mfma_f32_32x32x16_bf16 v[80:95], v[48:51], v[56:59], v[80:95]
ds_read_b128 v[40:43], v132 offset:36864
ds_read_b128 v[44:47], v128 offset:36864
v_mfma_f32_32x32x16_bf16 v[96:111], v[60:63], v[52:55], v[96:111]
v_mfma_f32_32x32x16_bf16 v[112:127], v[60:63], v[56:59], v[112:127]
s_waitcnt lgkmcnt(2)
v_mfma_f32_32x32x16_bf16 v[64:79], v[32:35], v[36:39], v[64:79]
ds_read_b128 v[48:51], v129 offset:32768
ds_read_b128 v[52:55], v133 offset:32768
s_waitcnt lgkmcnt(3)
v_mfma_f32_32x32x16_bf16 v[80:95], v[32:35], v[40:43], v[80:95]
ds_read_b128 v[56:59], v133 offset:36864
ds_read_b128 v[60:63], v129 offset:36864
s_waitcnt lgkmcnt(4)
v_mfma_f32_32x32x16_bf16 v[96:111], v[44:47], v[36:39], v[96:111]
v_mfma_f32_32x32x16_bf16 v[112:127], v[44:47], v[40:43], v[112:127]
s_waitcnt lgkmcnt(2)
v_mfma_f32_32x32x16_bf16 v[64:79], v[48:51], v[52:55], v[64:79]
ds_read_b128 v[32:35], v130 offset:32768
ds_read_b128 v[36:39], v134 offset:32768
s_waitcnt lgkmcnt(3)
v_mfma_f32_32x32x16_bf16 v[80:95], v[48:51], v[56:59], v[80:95]
ds_read_b128 v[40:43], v134 offset:36864
ds_read_b128 v[44:47], v130 offset:36864
s_waitcnt lgkmcnt(4)
v_mfma_f32_32x32x16_bf16 v[96:111], v[60:63], v[52:55], v[96:111]
v_mfma_f32_32x32x16_bf16 v[112:127], v[60:63], v[56:59], v[112:127]
s_waitcnt lgkmcnt(2)
v_mfma_f32_32x32x16_bf16 v[64:79], v[32:35], v[36:39], v[64:79]
ds_read_b128 v[48:51], v131 offset:32768
ds_read_b128 v[52:55], v135 offset:32768
s_waitcnt lgkmcnt(3)
v_mfma_f32_32x32x16_bf16 v[80:95], v[32:35], v[40:43], v[80:95]
ds_read_b128 v[56:59], v135 offset:36864
ds_read_b128 v[60:63], v131 offset:36864
s_waitcnt lgkmcnt(4)
v_mfma_f32_32x32x16_bf16 v[96:111], v[44:47], v[36:39], v[96:111]
v_mfma_f32_32x32x16_bf16 v[112:127], v[44:47], v[40:43], v[112:127]
s_waitcnt lgkmcnt(0)
s_barrier
v_mfma_f32_32x32x16_bf16 v[64:79], v[48:51], v[52:55], v[64:79]
ds_read_b128 v[32:35], v136 offset:0
ds_read_b128 v[36:39], v140 offset:0
v_mfma_f32_32x32x16_bf16 v[80:95], v[48:51], v[56:59], v[80:95]
ds_read_b128 v[40:43], v140 offset:4096
ds_read_b128 v[44:47], v136 offset:4096
v_mfma_f32_32x32x16_bf16 v[96:111], v[60:63], v[52:55], v[96:111]
v_mfma_f32_32x32x16_bf16 v[112:127], v[60:63], v[56:59], v[112:127]
s_waitcnt lgkmcnt(2)
v_mfma_f32_32x32x16_bf16 v[64:79], v[32:35], v[36:39], v[64:79]
ds_read_b128 v[48:51], v137 offset:0
ds_read_b128 v[52:55], v141 offset:0
s_waitcnt lgkmcnt(3)
v_mfma_f32_32x32x16_bf16 v[80:95], v[32:35], v[40:43], v[80:95]
ds_read_b128 v[56:59], v141 offset:4096
ds_read_b128 v[60:63], v137 offset:4096
s_waitcnt lgkmcnt(4)
v_mfma_f32_32x32x16_bf16 v[96:111], v[44:47], v[36:39], v[96:111]
v_mfma_f32_32x32x16_bf16 v[112:127], v[44:47], v[40:43], v[112:127]
s_waitcnt lgkmcnt(2)
v_mfma_f32_32x32x16_bf16 v[64:79], v[48:51], v[52:55], v[64:79]
ds_read_b128 v[32:35], v138 offset:0
ds_read_b128 v[36:39], v142 offset:0
s_waitcnt lgkmcnt(3)
v_mfma_f32_32x32x16_bf16 v[80:95], v[48:51], v[56:59], v[80:95]
ds_read_b128 v[40:43], v142 offset:4096
ds_read_b128 v[44:47], v138 offset:4096
s_waitcnt lgkmcnt(4)
v_mfma_f32_32x32x16_bf16 v[96:111], v[60:63], v[52:55], v[96:111]
v_mfma_f32_32x32x16_bf16 v[112:127], v[60:63], v[56:59], v[112:127]
s_waitcnt lgkmcnt(2)
v_mfma_f32_32x32x16_bf16 v[64:79], v[32:35], v[36:39], v[64:79]
ds_read_b128 v[48:51], v139 offset:0
ds_read_b128 v[52:55], v143 offset:0
s_waitcnt lgkmcnt(3)
v_mfma_f32_32x32x16_bf16 v[80:95], v[32:35], v[40:43], v[80:95]
ds_read_b128 v[56:59], v143 offset:4096
ds_read_b128 v[60:63], v139 offset:4096
s_waitcnt lgkmcnt(4)
v_mfma_f32_32x32x16_bf16 v[96:111], v[44:47], v[36:39], v[96:111]
v_mfma_f32_32x32x16_bf16 v[112:127], v[44:47], v[40:43], v[112:127]
s_waitcnt lgkmcnt(0)
s_barrier
v_mfma_f32_32x32x16_bf16 v[64:79], v[48:51], v[52:55], v[64:79]
ds_read_b128 v[32:35], v128 offset:0
ds_read_b128 v[36:39], v132 offset:0
v_mfma_f32_32x32x16_bf16 v[80:95], v[48:51], v[56:59], v[80:95]
ds_read_b128 v[40:43], v132 offset:4096
ds_read_b128 v[44:47], v128 offset:4096
v_mfma_f32_32x32x16_bf16 v[96:111], v[60:63], v[52:55], v[96:111]
v_mfma_f32_32x32x16_bf16 v[112:127], v[60:63], v[56:59], v[112:127]
s_waitcnt lgkmcnt(2)
v_mov_b32 v12, 0
global_load_dword v13, v12, s[30:31] sc1
v_mfma_f32_32x32x16_bf16 v[64:79], v[32:35], v[36:39], v[64:79]
ds_read_b128 v[48:51], v129 offset:0
ds_read_b128 v[52:55], v133 offset:0
s_waitcnt lgkmcnt(3)
v_mfma_f32_32x32x16_bf16 v[80:95], v[32:35], v[40:43], v[80:95]
ds_read_b128 v[56:59], v133 offset:4096
ds_read_b128 v[60:63], v129 offset:4096
s_waitcnt lgkmcnt(4)
v_mfma_f32_32x32x16_bf16 v[96:111], v[44:47], v[36:39], v[96:111]
v_mfma_f32_32x32x16_bf16 v[112:127], v[44:47], v[40:43], v[112:127]
s_waitcnt lgkmcnt(2)
v_mfma_f32_32x32x16_bf16 v[64:79], v[48:51], v[52:55], v[64:79]
ds_read_b128 v[32:35], v130 offset:0
ds_read_b128 v[36:39], v134 offset:0
s_waitcnt lgkmcnt(3)
v_mfma_f32_32x32x16_bf16 v[80:95], v[48:51], v[56:59], v[80:95]
ds_read_b128 v[40:43], v134 offset:4096
ds_read_b128 v[44:47], v130 offset:4096
s_waitcnt lgkmcnt(4)
v_mfma_f32_32x32x16_bf16 v[96:111], v[60:63], v[52:55], v[96:111]
v_mfma_f32_32x32x16_bf16 v[112:127], v[60:63], v[56:59], v[112:127]
s_waitcnt lgkmcnt(2)
v_mfma_f32_32x32x16_bf16 v[64:79], v[32:35], v[36:39], v[64:79]
ds_read_b128 v[48:51], v131 offset:0
ds_read_b128 v[52:55], v135 offset:0
s_waitcnt lgkmcnt(3)
v_mfma_f32_32x32x16_bf16 v[80:95], v[32:35], v[40:43], v[80:95]
ds_read_b128 v[56:59], v135 offset:4096
ds_read_b128 v[60:63], v131 offset:4096
s_waitcnt lgkmcnt(4)
v_mfma_f32_32x32x16_bf16 v[96:111], v[44:47], v[36:39], v[96:111]
v_mfma_f32_32x32x16_bf16 v[112:127], v[44:47], v[40:43], v[112:127]
s_waitcnt lgkmcnt(0)
s_barrier
v_mfma_f32_32x32x16_bf16 v[64:79], v[48:51], v[52:55], v[64:79]
ds_read_b128 v[32:35], v128 offset:32768
ds_read_b128 v[36:39], v132 offset:32768
v_mfma_f32_32x32x16_bf16 v[80:95], v[48:51], v[56:59], v[80:95]
ds_read_b128 v[40:43], v132 offset:36864
ds_read_b128 v[44:47], v128 offset:36864
v_mfma_f32_32x32x16_bf16 v[96:111], v[60:63], v[52:55], v[96:111]
v_mfma_f32_32x32x16_bf16 v[112:127], v[60:63], v[56:59], v[112:127]
s_waitcnt lgkmcnt(2)
v_mfma_f32_32x32x16_bf16 v[64:79], v[32:35], v[36:39], v[64:79]
ds_read_b128 v[48:51], v129 offset:32768
ds_read_b128 v[52:55], v133 offset:32768
s_waitcnt lgkmcnt(3)
v_mfma_f32_32x32x16_bf16 v[80:95], v[32:35], v[40:43], v[80:95]
ds_read_b128 v[56:59], v133 offset:36864
ds_read_b128 v[60:63], v129 offset:36864
s_waitcnt lgkmcnt(4)
v_mfma_f32_32x32x16_bf16 v[96:111], v[44:47], v[36:39], v[96:111]
v_mfma_f32_32x32x16_bf16 v[112:127], v[44:47], v[40:43], v[112:127]
s_waitcnt lgkmcnt(2)
v_mfma_f32_32x32x16_bf16 v[64:79], v[48:51], v[52:55], v[64:79]
ds_read_b128 v[32:35], v130 offset:32768
ds_read_b128 v[36:39], v134 offset:32768
s_waitcnt lgkmcnt(3)
v_mfma_f32_32x32x16_bf16 v[80:95], v[48:51], v[56:59], v[80:95]
ds_read_b128 v[40:43], v134 offset:36864
ds_read_b128 v[44:47], v130 offset:36864
s_waitcnt lgkmcnt(4)
v_mfma_f32_32x32x16_bf16 v[96:111], v[60:63], v[52:55], v[96:111]
v_mfma_f32_32x32x16_bf16 v[112:127], v[60:63], v[56:59], v[112:127]
s_waitcnt lgkmcnt(2)
v_mfma_f32_32x32x16_bf16 v[64:79], v[32:35], v[36:39], v[64:79]
ds_read_b128 v[48:51], v131 offset:32768
ds_read_b128 v[52:55], v135 offset:32768
s_waitcnt lgkmcnt(3)
v_mfma_f32_32x32x16_bf16 v[80:95], v[32:35], v[40:43], v[80:95]
ds_read_b128 v[56:59], v135 offset:36864
ds_read_b128 v[60:63], v131 offset:36864
s_waitcnt lgkmcnt(4)
v_mfma_f32_32x32x16_bf16 v[96:111], v[44:47], v[36:39], v[96:111]
v_mfma_f32_32x32x16_bf16 v[112:127], v[44:47], v[40:43], v[112:127]
s_waitcnt lgkmcnt(0)
s_barrier
v_mfma_f32_32x32x16_bf16 v[64:79], v[48:51], v[52:55], v[64:79]
ds_read_b128 v[32:35], v136 offset:0
ds_read_b128 v[36:39], v140 offset:0
v_mfma_f32_32x32x16_bf16 v[80:95], v[48:51], v[56:59], v[80:95]
ds_read_b128 v[40:43], v140 offset:4096
ds_read_b128 v[44:47], v136 offset:4096
v_mfma_f32_32x32x16_bf16 v[96:111], v[60:63], v[52:55], v[96:111]
v_mfma_f32_32x32x16_bf16 v[112:127], v[60:63], v[56:59], v[112:127]
s_waitcnt lgkmcnt(2)
v_mfma_f32_32x32x16_bf16 v[64:79], v[32:35], v[36:39], v[64:79]
ds_read_b128 v[48:51], v137 offset:0
ds_read_b128 v[52:55], v141 offset:0
s_waitcnt lgkmcnt(3)
v_mfma_f32_32x32x16_bf16 v[80:95], v[32:35], v[40:43], v[80:95]
ds_read_b128 v[56:59], v141 offset:4096
ds_read_b128 v[60:63], v137 offset:4096
s_waitcnt lgkmcnt(4)
v_mfma_f32_32x32x16_bf16 v[96:111], v[44:47], v[36:39], v[96:111]
v_mfma_f32_32x32x16_bf16 v[112:127], v[44:47], v[40:43], v[112:127]
s_waitcnt lgkmcnt(2)
v_mfma_f32_32x32x16_bf16 v[64:79], v[48:51], v[52:55], v[64:79]
ds_read_b128 v[32:35], v138 offset:0
ds_read_b128 v[36:39], v142 offset:0
s_waitcnt lgkmcnt(3)
v_mfma_f32_32x32x16_bf16 v[80:95], v[48:51], v[56:59], v[80:95]
ds_read_b128 v[40:43], v142 offset:4096
ds_read_b128 v[44:47], v138 offset:4096
s_waitcnt lgkmcnt(4)
v_mfma_f32_32x32x16_bf16 v[96:111], v[60:63], v[52:55], v[96:111]
v_mfma_f32_32x32x16_bf16 v[112:127], v[60:63], v[56:59], v[112:127]
s_waitcnt lgkmcnt(2)
v_mfma_f32_32x32x16_bf16 v[64:79], v[32:35], v[36:39], v[64:79]
ds_read_b128 v[48:51], v139 offset:0
ds_read_b128 v[52:55], v143 offset:0
s_waitcnt lgkmcnt(3)
v_mfma_f32_32x32x16_bf16 v[80:95], v[32:35], v[40:43], v[80:95]
ds_read_b128 v[56:59], v143 offset:4096
ds_read_b128 v[60:63], v139 offset:4096
s_waitcnt lgkmcnt(4)
v_mfma_f32_32x32x16_bf16 v[96:111], v[44:47], v[36:39], v[96:111]
v_mfma_f32_32x32x16_bf16 v[112:127], v[44:47], v[40:43], v[112:127]
s_waitcnt lgkmcnt(0)
s_barrier
v_mfma_f32_32x32x16_bf16 v[64:79], v[48:51], v[52:55], v[64:79]
ds_read_b128 v[32:35], v128 offset:0
ds_read_b128 v[36:39], v132 offset:0
v_mfma_f32_32x32x16_bf16 v[80:95], v[48:51], v[56:59], v[80:95]
ds_read_b128 v[40:43], v132 offset:4096
ds_read_b128 v[44:47], v128 offset:4096
v_mfma_f32_32x32x16_bf16 v[96:111], v[60:63], v[52:55], v[96:111]
v_mfma_f32_32x32x16_bf16 v[112:127], v[60:63], v[56:59], v[112:127]
s_waitcnt lgkmcnt(2)
v_mfma_f32_32x32x16_bf16 v[64:79], v[32:35], v[36:39], v[64:79]
ds_read_b128 v[48:51], v129 offset:0
ds_read_b128 v[52:55], v133 offset:0
s_waitcnt lgkmcnt(3)
v_mfma_f32_32x32x16_bf16 v[80:95], v[32:35], v[40:43], v[80:95]
ds_read_b128 v[56:59], v133 offset:4096
ds_read_b128 v[60:63], v129 offset:4096
s_waitcnt lgkmcnt(4)
v_mfma_f32_32x32x16_bf16 v[96:111], v[44:47], v[36:39], v[96:111]
v_mfma_f32_32x32x16_bf16 v[112:127], v[44:47], v[40:43], v[112:127]
s_waitcnt lgkmcnt(2)
v_mfma_f32_32x32x16_bf16 v[64:79], v[48:51], v[52:55], v[64:79]
ds_read_b128 v[32:35], v130 offset:0
ds_read_b128 v[36:39], v134 offset:0
s_waitcnt lgkmcnt(3)
v_mfma_f32_32x32x16_bf16 v[80:95], v[48:51], v[56:59], v[80:95]
ds_read_b128 v[40:43], v134 offset:4096
ds_read_b128 v[44:47], v130 offset:4096
s_waitcnt lgkmcnt(4)
v_mfma_f32_32x32x16_bf16 v[96:111], v[60:63], v[52:55], v[96:111]
v_mfma_f32_32x32x16_bf16 v[112:127], v[60:63], v[56:59], v[112:127]
s_waitcnt lgkmcnt(2)
v_mfma_f32_32x32x16_bf16 v[64:79], v[32:35], v[36:39], v[64:79]
ds_read_b128 v[48:51], v131 offset:0
ds_read_b128 v[52:55], v135 offset:0
s_waitcnt lgkmcnt(3)
v_mfma_f32_32x32x16_bf16 v[80:95], v[32:35], v[40:43], v[80:95]
ds_read_b128 v[56:59], v135 offset:4096
ds_read_b128 v[60:63], v131 offset:4096
s_waitcnt lgkmcnt(4)
v_mfma_f32_32x32x16_bf16 v[96:111], v[44:47], v[36:39], v[96:111]
v_mfma_f32_32x32x16_bf16 v[112:127], v[44:47], v[40:43], v[112:127]
s_waitcnt lgkmcnt(0)
s_barrier
v_mfma_f32_32x32x16_bf16 v[64:79], v[48:51], v[52:55], v[64:79]
v_mfma_f32_32x32x16_bf16 v[80:95], v[48:51], v[56:59], v[80:95]
v_mfma_f32_32x32x16_bf16 v[96:111], v[60:63], v[52:55], v[96:111]
v_mfma_f32_32x32x16_bf16 v[112:127], v[60:63], v[56:59], v[112:127]
s_lshl_b32 s60, s66, 10
s_add_u32 s60, s60, 122880
s_lshl_b32 s61, s68, 4
v_lshl_add_u32 v14, v6, 5, s60
v_lshl_add_u32 v15, v5, 3, v14
v_add_u32 v15, s61, v15
s_nop 2
v_pk_fma_f32 v[40:41], v[24:25], v[64:65], v[66:67] op_sel_hi:[0,1,1]
v_pk_fma_f32 v[42:43], v[24:25], v[80:81], v[82:83] op_sel_hi:[0,1,1]
v_pk_fma_f32 v[66:67], v[24:25], v[80:81], v[40:41] op_sel:[1,0,0] neg_lo:[1,0,0] neg_hi:[1,0,0]
v_pk_fma_f32 v[82:83], v[24:25], v[64:65], v[42:43] op_sel:[1,0,0]
v_pk_fma_f32 v[40:41], v[24:25], v[66:67], v[68:69] op_sel_hi:[0,1,1]
v_pk_fma_f32 v[42:43], v[24:25], v[82:83], v[84:85] op_sel_hi:[0,1,1]
v_pk_fma_f32 v[68:69], v[24:25], v[82:83], v[40:41] op_sel:[1,0,0] neg_lo:[1,0,0] neg_hi:[1,0,0]
v_pk_fma_f32 v[84:85], v[24:25], v[66:67], v[42:43] op_sel:[1,0,0]
v_pk_fma_f32 v[40:41], v[24:25], v[68:69], v[70:71] op_sel_hi:[0,1,1]
v_pk_fma_f32 v[42:43], v[24:25], v[84:85], v[86:87] op_sel_hi:[0,1,1]
v_pk_fma_f32 v[70:71], v[24:25], v[84:85], v[40:41] op_sel:[1,0,0] neg_lo:[1,0,0] neg_hi:[1,0,0]
v_pk_fma_f32 v[86:87], v[24:25], v[68:69], v[42:43] op_sel:[1,0,0]
v_pk_fma_f32 v[40:41], v[24:25], v[70:71], v[72:73] op_sel_hi:[0,1,1]
v_pk_fma_f32 v[42:43], v[24:25], v[86:87], v[88:89] op_sel_hi:[0,1,1]
v_pk_fma_f32 v[72:73], v[24:25], v[86:87], v[40:41] op_sel:[1,0,0] neg_lo:[1,0,0] neg_hi:[1,0,0]
v_pk_fma_f32 v[88:89], v[24:25], v[70:71], v[42:43] op_sel:[1,0,0]
v_pk_fma_f32 v[40:41], v[24:25], v[72:73], v[74:75] op_sel_hi:[0,1,1]
v_pk_fma_f32 v[42:43], v[24:25], v[88:89], v[90:91] op_sel_hi:[0,1,1]
v_pk_fma_f32 v[74:75], v[24:25], v[88:89], v[40:41] op_sel:[1,0,0] neg_lo:[1,0,0] neg_hi:[1,0,0]
v_pk_fma_f32 v[90:91], v[24:25], v[72:73], v[42:43] op_sel:[1,0,0]
v_pk_fma_f32 v[40:41], v[24:25], v[74:75], v[76:77] op_sel_hi:[0,1,1]
v_pk_fma_f32 v[42:43], v[24:25], v[90:91], v[92:93] op_sel_hi:[0,1,1]
v_pk_fma_f32 v[76:77], v[24:25], v[90:91], v[40:41] op_sel:[1,0,0] neg_lo:[1,0,0] neg_hi:[1,0,0]
v_pk_fma_f32 v[92:93], v[24:25], v[74:75], v[42:43] op_sel:[1,0,0]
v_pk_fma_f32 v[40:41], v[24:25], v[76:77], v[78:79] op_sel_hi:[0,1,1]
v_pk_fma_f32 v[42:43], v[24:25], v[92:93], v[94:95] op_sel_hi:[0,1,1]
v_pk_fma_f32 v[78:79], v[24:25], v[92:93], v[40:41] op_sel:[1,0,0] neg_lo:[1,0,0] neg_hi:[1,0,0]
v_pk_fma_f32 v[94:95], v[24:25], v[76:77], v[42:43] op_sel:[1,0,0]
v_pk_fma_f32 v[40:41], v[24:25], v[78:79], v[96:97] op_sel_hi:[0,1,1]
v_pk_fma_f32 v[42:43], v[24:25], v[94:95], v[112:113] op_sel_hi:[0,1,1]
v_pk_fma_f32 v[96:97], v[24:25], v[94:95], v[40:41] op_sel:[1,0,0] neg_lo:[1,0,0] neg_hi:[1,0,0]
v_pk_fma_f32 v[112:113], v[24:25], v[78:79], v[42:43] op_sel:[1,0,0]
v_pk_fma_f32 v[40:41], v[24:25], v[96:97], v[98:99] op_sel_hi:[0,1,1]
v_pk_fma_f32 v[42:43], v[24:25], v[112:113], v[114:115] op_sel_hi:[0,1,1]
v_pk_fma_f32 v[98:99], v[24:25], v[112:113], v[40:41] op_sel:[1,0,0] neg_lo:[1,0,0] neg_hi:[1,0,0]
v_pk_fma_f32 v[114:115], v[24:25], v[96:97], v[42:43] op_sel:[1,0,0]
v_pk_fma_f32 v[40:41], v[24:25], v[98:99], v[100:101] op_sel_hi:[0,1,1]
v_pk_fma_f32 v[42:43], v[24:25], v[114:115], v[116:117] op_sel_hi:[0,1,1]
v_pk_fma_f32 v[100:101], v[24:25], v[114:115], v[40:41] op_sel:[1,0,0] neg_lo:[1,0,0] neg_hi:[1,0,0]
v_pk_fma_f32 v[116:117], v[24:25], v[98:99], v[42:43] op_sel:[1,0,0]
v_pk_fma_f32 v[40:41], v[24:25], v[100:101], v[102:103] op_sel_hi:[0,1,1]
v_pk_fma_f32 v[42:43], v[24:25], v[116:117], v[118:119] op_sel_hi:[0,1,1]
v_pk_fma_f32 v[102:103], v[24:25], v[116:117], v[40:41] op_sel:[1,0,0] neg_lo:[1,0,0] neg_hi:[1,0,0]
v_pk_fma_f32 v[118:119], v[24:25], v[100:101], v[42:43] op_sel:[1,0,0]
v_pk_fma_f32 v[40:41], v[24:25], v[102:103], v[104:105] op_sel_hi:[0,1,1]
v_pk_fma_f32 v[42:43], v[24:25], v[118:119], v[120:121] op_sel_hi:[0,1,1]
v_pk_fma_f32 v[104:105], v[24:25], v[118:119], v[40:41] op_sel:[1,0,0] neg_lo:[1,0,0] neg_hi:[1,0,0]
v_pk_fma_f32 v[120:121], v[24:25], v[102:103], v[42:43] op_sel:[1,0,0]
v_pk_fma_f32 v[40:41], v[24:25], v[104:105], v[106:107] op_sel_hi:[0,1,1]
v_pk_fma_f32 v[42:43], v[24:25], v[120:121], v[122:123] op_sel_hi:[0,1,1]
v_pk_fma_f32 v[106:107], v[24:25], v[120:121], v[40:41] op_sel:[1,0,0] neg_lo:[1,0,0] neg_hi:[1,0,0]
v_pk_fma_f32 v[122:123], v[24:25], v[104:105], v[42:43] op_sel:[1,0,0]
v_pk_fma_f32 v[40:41], v[24:25], v[106:107], v[108:109] op_sel_hi:[0,1,1]
v_pk_fma_f32 v[42:43], v[24:25], v[122:123], v[124:125] op_sel_hi:[0,1,1]
v_pk_fma_f32 v[108:109], v[24:25], v[122:123], v[40:41] op_sel:[1,0,0] neg_lo:[1,0,0] neg_hi:[1,0,0]
v_pk_fma_f32 v[124:125], v[24:25], v[106:107], v[42:43] op_sel:[1,0,0]
v_pk_fma_f32 v[40:41], v[24:25], v[108:109], v[110:111] op_sel_hi:[0,1,1]
v_pk_fma_f32 v[42:43], v[24:25], v[124:125], v[126:127] op_sel_hi:[0,1,1]
v_pk_fma_f32 v[110:111], v[24:25], v[124:125], v[40:41] op_sel:[1,0,0] neg_lo:[1,0,0] neg_hi:[1,0,0]
v_pk_fma_f32 v[126:127], v[24:25], v[108:109], v[42:43] op_sel:[1,0,0]
v_fma_f32 v40, v28, v110, v111
v_fma_f32 v41, v28, v126, v127
v_fma_f32 v32, -v29, v126, v40
v_fma_f32 v33, v29, v110, v41
ds_write_b64 v15, v[32:33]
s_sub_u32 s60, s35, 1
s_lshl_b32 s60, s60, 14
v_lshlrev_b32 v16, 4, v4
v_lshlrev_b32 v17, 14, v5
v_sub_u32 v17, v16, v17
v_add_u32 v128, s60, v17
s_lshl_b32 s60, s35, 14
v_add_u32 v16, s60, v16
v_lshlrev_b32 v17, 30, v5
v_or_b32 v16, v16, v17
s_waitcnt lgkmcnt(0)
s_barrier
ds_read_b128 v[144:147], v14
ds_read_b128 v[148:151], v14 offset:16
L_n41:
s_waitcnt vmcnt(0)
v_readfirstlane_b32 s37, v13
s_nop 0
s_cmp_lg_u32 s37, 0
s_cbranch_scc1 L_ng42
global_load_dword v13, v12, s[30:31] sc1
s_branch L_n41
L_ng42:
v_mov_b32 v46, s37
v_mov_b32 v47, s37
s_getreg_b32 s60, hwreg(HW_REG_XCC_ID, 0, 4)
s_lshl_b32 s61, s37, 4
s_or_b32 s100, s60, s61
v_mov_b32 v60, s100
s_lshr_b32 s101, s36, 3
s_lshl_b32 s60, s35, 11
s_add_u32 s60, s60, 32768
s_lshl_b32 s61, s36, 7
s_add_u32 s61, s61, s60
v_mov_b32 v61, s61
s_lshl_b32 s61, s101, 10
s_add_u32 s60, s60, s61
v_and_b32 v62, 7, v1
v_lshl_add_u32 v62, v62, 7, s60
s_waitcnt lgkmcnt(0)
v_fma_f32 v40, v20, v144, v146
v_fma_f32 v41, v20, v145, v147
v_fma_f32 v48, -v21, v145, v40
v_fma_f32 v49, v21, v144, v41
v_fma_f32 v40, v20, v48, v148
v_fma_f32 v41, v20, v49, v149
v_fma_f32 v50, -v21, v49, v40
v_fma_f32 v51, v21, v48, v41
v_fma_f32 v40, v20, v50, v150
v_fma_f32 v41, v20, v51, v151
v_fma_f32 v44, -v21, v51, v40
v_fma_f32 v45, v21, v50, v41
s_cmp_lg_u32 s68, 0
s_cbranch_scc1 L_np43
buffer_store_dwordx4 v[44:47], v16, s[40:43], 0 offen sc1
s_cmp_lg_u32 s66, 0
s_cbranch_scc1 L_np43
s_mov_b64 exec, 1
global_store_dword v61, v60, s[32:33] sc1
s_mov_b64 exec, -1
L_np43:
v_mov_b32 v17, 0x40000000
v_subrev_u32 v129, 32768, v128
v_subrev_u32 v130, 65536, v128
v_subrev_u32 v131, 98304, v128
v_subrev_u32 v132, 131072, v128
v_subrev_u32 v133, 163840, v128
v_subrev_u32 v134, 196608, v128
v_subrev_u32 v135, 229376, v128
v_cmp_le_i32 vcc, 0, v128
s_nop 1
v_cndmask_b32 v136, 0, v46, vcc
v_cndmask_b32 v128, v17, v128, vcc
v_cmp_le_i32 vcc, 0, v129
s_nop 1
v_cndmask_b32 v137, 0, v46, vcc
v_cndmask_b32 v129, v17, v129, vcc
v_cmp_le_i32 vcc, 0, v130
s_nop 1
v_cndmask_b32 v138, 0, v46, vcc
v_cndmask_b32 v130, v17, v130, vcc
v_cmp_le_i32 vcc, 0, v131
s_nop 1
v_cndmask_b32 v139, 0, v46, vcc
v_cndmask_b32 v131, v17, v131, vcc
v_cmp_le_i32 vcc, 0, v132
s_nop 1
v_cndmask_b32 v140, 0, v46, vcc
v_cndmask_b32 v132, v17, v132, vcc
v_cmp_le_i32 vcc, 0, v133
s_nop 1
v_cndmask_b32 v141, 0, v46, vcc
v_cndmask_b32 v133, v17, v133, vcc
v_cmp_le_i32 vcc, 0, v134
s_nop 1
v_cndmask_b32 v142, 0, v46, vcc
v_cndmask_b32 v134, v17, v134, vcc
v_cmp_le_i32 vcc, 0, v135
s_nop 1
v_cndmask_b32 v143, 0, v46, vcc
v_cndmask_b32 v135, v17, v135, vcc
s_lshl_b32 s60, s35, 1
s_add_u32 s60, s60, s68
s_lshl_b32 s60, s60, 12
s_add_u32 s60, s60, 393216
s_lshl_b32 s61, s101, 11
s_add_u32 s61, s61, s60
v_and_b32 v18, 15, v1
v_lshl_add_u32 v18, v18, 7, s61
s_lshl_b32 s61, s36, 8
s_add_u32 s60, s60, s61
s_lshl_b32 s61, s66, 7
s_add_u32 s60, s60, s61
v_mov_b32 v19, s60
global_load_dword v243, v18, s[32:33] sc1
v_mul_f32 v52, v27, v25
v_mul_f32 v53, v27, v24
v_fma_f32 v208, v26, v24, -v52
v_fma_f32 v209, v26, v25, v53
v_pk_mul_f32 v[52:53], v[26:27], v[64:65] op_sel_hi:[0,1]
v_pk_mul_f32 v[54:55], v[26:27], v[80:81] op_sel_hi:[0,1] neg_lo:[1,0] neg_hi:[1,0]
v_mul_f32 v58, v209, v25
v_mul_f32 v59, v209, v24
v_pk_fma_f32 v[54:55], v[26:27], v[64:65], v[54:55] op_sel:[1,0,0] neg_lo:[1,0,0] neg_hi:[1,0,0]
v_pk_fma_f32 v[64:65], v[26:27], v[80:81], v[52:53] op_sel:[1,0,0] neg_lo:[1,0,0] neg_hi:[1,0,0]
v_mov_b64 v[80:81], v[54:55]
v_fma_f32 v210, v208, v24, -v58
v_fma_f32 v211, v208, v25, v59
v_pk_mul_f32 v[52:53], v[26:27], v[66:67] op_sel_hi:[0,1]
v_pk_mul_f32 v[54:55], v[26:27], v[82:83] op_sel_hi:[0,1] neg_lo:[1,0] neg_hi:[1,0]
v_mul_f32 v58, v211, v25
v_mul_f32 v59, v211, v24
v_pk_fma_f32 v[54:55], v[26:27], v[66:67], v[54:55] op_sel:[1,0,0] neg_lo:[1,0,0] neg_hi:[1,0,0]
v_pk_fma_f32 v[66:67], v[26:27], v[82:83], v[52:53] op_sel:[1,0,0] neg_lo:[1,0,0] neg_hi:[1,0,0]
v_mov_b64 v[82:83], v[54:55]
v_fma_f32 v212, v210, v24, -v58
v_fma_f32 v213, v210, v25, v59
v_pk_mul_f32 v[52:53], v[26:27], v[68:69] op_sel_hi:[0,1]
v_pk_mul_f32 v[54:55], v[26:27], v[84:85] op_sel_hi:[0,1] neg_lo:[1,0] neg_hi:[1,0]
v_mul_f32 v58, v213, v25
v_mul_f32 v59, v213, v24
v_pk_fma_f32 v[54:55], v[26:27], v[68:69], v[54:55] op_sel:[1,0,0] neg_lo:[1,0,0] neg_hi:[1,0,0]
v_pk_fma_f32 v[68:69], v[26:27], v[84:85], v[52:53] op_sel:[1,0,0] neg_lo:[1,0,0] neg_hi:[1,0,0]
v_mov_b64 v[84:85], v[54:55]
v_fma_f32 v214, v212, v24, -v58
v_fma_f32 v215, v212, v25, v59
v_pk_mul_f32 v[52:53], v[26:27], v[70:71] op_sel_hi:[0,1]
v_pk_mul_f32 v[54:55], v[26:27], v[86:87] op_sel_hi:[0,1] neg_lo:[1,0] neg_hi:[1,0]
v_mul_f32 v58, v215, v25
v_mul_f32 v59, v215, v24
v_pk_fma_f32 v[54:55], v[26:27], v[70:71], v[54:55] op_sel:[1,0,0] neg_lo:[1,0,0] neg_hi:[1,0,0]
v_pk_fma_f32 v[70:71], v[26:27], v[86:87], v[52:53] op_sel:[1,0,0] neg_lo:[1,0,0] neg_hi:[1,0,0]
v_mov_b64 v[86:87], v[54:55]
v_fma_f32 v216, v214, v24, -v58
v_fma_f32 v217, v214, v25, v59
v_pk_mul_f32 v[52:53], v[26:27], v[72:73] op_sel_hi:[0,1]
v_pk_mul_f32 v[54:55], v[26:27], v[88:89] op_sel_hi:[0,1] neg_lo:[1,0] neg_hi:[1,0]
v_mul_f32 v58, v217, v25
v_mul_f32 v59, v217, v24
v_pk_fma_f32 v[54:55], v[26:27], v[72:73], v[54:55] op_sel:[1,0,0] neg_lo:[1,0,0] neg_hi:[1,0,0]
v_pk_fma_f32 v[72:73], v[26:27], v[88:89], v[52:53] op_sel:[1,0,0] neg_lo:[1,0,0] neg_hi:[1,0,0]
v_mov_b64 v[88:89], v[54:55]
v_fma_f32 v218, v216, v24, -v58
v_fma_f32 v219, v216, v25, v59
v_pk_mul_f32 v[52:53], v[26:27], v[74:75] op_sel_hi:[0,1]
v_pk_mul_f32 v[54:55], v[26:27], v[90:91] op_sel_hi:[0,1] neg_lo:[1,0] neg_hi:[1,0]
v_mul_f32 v58, v219, v25
v_mul_f32 v59, v219, v24
v_pk_fma_f32 v[54:55], v[26:27], v[74:75], v[54:55] op_sel:[1,0,0] neg_lo:[1,0,0] neg_hi:[1,0,0]
v_pk_fma_f32 v[74:75], v[26:27], v[90:91], v[52:53] op_sel:[1,0,0] neg_lo:[1,0,0] neg_hi:[1,0,0]
v_mov_b64 v[90:91], v[54:55]
v_fma_f32 v220, v218, v24, -v58
v_fma_f32 v221, v218, v25, v59
v_pk_mul_f32 v[52:53], v[26:27], v[76:77] op_sel_hi:[0,1]
v_pk_mul_f32 v[54:55], v[26:27], v[92:93] op_sel_hi:[0,1] neg_lo:[1,0] neg_hi:[1,0]
v_mul_f32 v58, v221, v25
v_mul_f32 v59, v221, v24
v_pk_fma_f32 v[54:55], v[26:27], v[76:77], v[54:55] op_sel:[1,0,0] neg_lo:[1,0,0] neg_hi:[1,0,0]
v_pk_fma_f32 v[76:77], v[26:27], v[92:93], v[52:53] op_sel:[1,0,0] neg_lo:[1,0,0] neg_hi:[1,0,0]
v_mov_b64 v[92:93], v[54:55]
v_fma_f32 v222, v220, v24, -v58
v_fma_f32 v223, v220, v25, v59
v_pk_mul_f32 v[52:53], v[26:27], v[78:79] op_sel_hi:[0,1]
v_pk_mul_f32 v[54:55], v[26:27], v[94:95] op_sel_hi:[0,1] neg_lo:[1,0] neg_hi:[1,0]
v_mul_f32 v58, v223, v25
v_mul_f32 v59, v223, v24
v_pk_fma_f32 v[54:55], v[26:27], v[78:79], v[54:55] op_sel:[1,0,0] neg_lo:[1,0,0] neg_hi:[1,0,0]
v_pk_fma_f32 v[78:79], v[26:27], v[94:95], v[52:53] op_sel:[1,0,0] neg_lo:[1,0,0] neg_hi:[1,0,0]
v_mov_b64 v[94:95], v[54:55]
v_fma_f32 v224, v222, v24, -v58
v_fma_f32 v225, v222, v25, v59
v_pk_mul_f32 v[52:53], v[26:27], v[96:97] op_sel_hi:[0,1]
v_pk_mul_f32 v[54:55], v[26:27], v[112:113] op_sel_hi:[0,1] neg_lo:[1,0] neg_hi:[1,0]
v_mul_f32 v58, v225, v25
v_mul_f32 v59, v225, v24
v_pk_fma_f32 v[54:55], v[26:27], v[96:97], v[54:55] op_sel:[1,0,0] neg_lo:[1,0,0] neg_hi:[1,0,0]
v_pk_fma_f32 v[96:97], v[26:27], v[112:113], v[52:53] op_sel:[1,0,0] neg_lo:[1,0,0] neg_hi:[1,0,0]
v_mov_b64 v[112:113], v[54:55]
v_fma_f32 v226, v224, v24, -v58
v_fma_f32 v227, v224, v25, v59
v_pk_mul_f32 v[52:53], v[26:27], v[98:99] op_sel_hi:[0,1]
v_pk_mul_f32 v[54:55], v[26:27], v[114:115] op_sel_hi:[0,1] neg_lo:[1,0] neg_hi:[1,0]
v_mul_f32 v58, v227, v25
v_mul_f32 v59, v227, v24
v_pk_fma_f32 v[54:55], v[26:27], v[98:99], v[54:55] op_sel:[1,0,0] neg_lo:[1,0,0] neg_hi:[1,0,0]
v_pk_fma_f32 v[98:99], v[26:27], v[114:115], v[52:53] op_sel:[1,0,0] neg_lo:[1,0,0] neg_hi:[1,0,0]
v_mov_b64 v[114:115], v[54:55]
v_fma_f32 v228, v226, v24, -v58
v_fma_f32 v229, v226, v25, v59
v_pk_mul_f32 v[52:53], v[26:27], v[100:101] op_sel_hi:[0,1]
v_pk_mul_f32 v[54:55], v[26:27], v[116:117] op_sel_hi:[0,1] neg_lo:[1,0] neg_hi:[1,0]
v_mul_f32 v58, v229, v25
v_mul_f32 v59, v229, v24
v_pk_fma_f32 v[54:55], v[26:27], v[100:101], v[54:55] op_sel:[1,0,0] neg_lo:[1,0,0] neg_hi:[1,0,0]
v_pk_fma_f32 v[100:101], v[26:27], v[116:117], v[52:53] op_sel:[1,0,0] neg_lo:[1,0,0] neg_hi:[1,0,0]
v_mov_b64 v[116:117], v[54:55]
v_fma_f32 v230, v228, v24, -v58
v_fma_f32 v231, v228, v25, v59
v_pk_mul_f32 v[52:53], v[26:27], v[102:103] op_sel_hi:[0,1]
v_pk_mul_f32 v[54:55], v[26:27], v[118:119] op_sel_hi:[0,1] neg_lo:[1,0] neg_hi:[1,0]
v_mul_f32 v58, v231, v25
v_mul_f32 v59, v231, v24
v_pk_fma_f32 v[54:55], v[26:27], v[102:103], v[54:55] op_sel:[1,0,0] neg_lo:[1,0,0] neg_hi:[1,0,0]
v_pk_fma_f32 v[102:103], v[26:27], v[118:119], v[52:53] op_sel:[1,0,0] neg_lo:[1,0,0] neg_hi:[1,0,0]
v_mov_b64 v[118:119], v[54:55]
v_fma_f32 v232, v230, v24, -v58
v_fma_f32 v233, v230, v25, v59
v_pk_mul_f32 v[52:53], v[26:27], v[104:105] op_sel_hi:[0,1]
v_pk_mul_f32 v[54:55], v[26:27], v[120:121] op_sel_hi:[0,1] neg_lo:[1,0] neg_hi:[1,0]
v_mul_f32 v58, v233, v25
v_mul_f32 v59, v233, v24
v_pk_fma_f32 v[54:55], v[26:27], v[104:105], v[54:55] op_sel:[1,0,0] neg_lo:[1,0,0] neg_hi:[1,0,0]
v_pk_fma_f32 v[104:105], v[26:27], v[120:121], v[52:53] op_sel:[1,0,0] neg_lo:[1,0,0] neg_hi:[1,0,0]
v_mov_b64 v[120:121], v[54:55]
v_fma_f32 v234, v232, v24, -v58
v_fma_f32 v235, v232, v25, v59
v_pk_mul_f32 v[52:53], v[26:27], v[106:107] op_sel_hi:[0,1]
v_pk_mul_f32 v[54:55], v[26:27], v[122:123] op_sel_hi:[0,1] neg_lo:[1,0] neg_hi:[1,0]
v_mul_f32 v58, v235, v25
v_mul_f32 v59, v235, v24
v_pk_fma_f32 v[54:55], v[26:27], v[106:107], v[54:55] op_sel:[1,0,0] neg_lo:[1,0,0] neg_hi:[1,0,0]
v_pk_fma_f32 v[106:107], v[26:27], v[122:123], v[52:53] op_sel:[1,0,0] neg_lo:[1,0,0] neg_hi:[1,0,0]
v_mov_b64 v[122:123], v[54:55]
v_fma_f32 v236, v234, v24, -v58
v_fma_f32 v237, v234, v25, v59
v_pk_mul_f32 v[52:53], v[26:27], v[108:109] op_sel_hi:[0,1]
v_pk_mul_f32 v[54:55], v[26:27], v[124:125] op_sel_hi:[0,1] neg_lo:[1,0] neg_hi:[1,0]
v_mul_f32 v58, v237, v25
v_mul_f32 v59, v237, v24
v_pk_fma_f32 v[54:55], v[26:27], v[108:109], v[54:55] op_sel:[1,0,0] neg_lo:[1,0,0] neg_hi:[1,0,0]
v_pk_fma_f32 v[108:109], v[26:27], v[124:125], v[52:53] op_sel:[1,0,0] neg_lo:[1,0,0] neg_hi:[1,0,0]
v_mov_b64 v[124:125], v[54:55]
v_fma_f32 v238, v236, v24, -v58
v_fma_f32 v239, v236, v25, v59
v_pk_mul_f32 v[52:53], v[26:27], v[110:111] op_sel_hi:[0,1]
v_pk_mul_f32 v[54:55], v[26:27], v[126:127] op_sel_hi:[0,1] neg_lo:[1,0] neg_hi:[1,0]
v_mov_b32 v56, v110
v_mov_b32 v57, v126
v_pk_fma_f32 v[54:55], v[26:27], v[110:111], v[54:55] op_sel:[1,0,0] neg_lo:[1,0,0] neg_hi:[1,0,0]
v_pk_fma_f32 v[110:111], v[26:27], v[126:127], v[52:53] op_sel:[1,0,0] neg_lo:[1,0,0] neg_hi:[1,0,0]
v_mov_b64 v[126:127], v[54:55]
buffer_load_dwordx4 v[160:163], v128, s[40:43], 0 offen sc1
buffer_load_dwordx4 v[164:167], v129, s[40:43], 0 offen sc1
buffer_load_dwordx4 v[168:171], v130, s[40:43], 0 offen sc1
buffer_load_dwordx4 v[172:175], v131, s[40:43], 0 offen sc1
buffer_load_dwordx4 v[176:179], v132, s[40:43], 0 offen sc1
buffer_load_dwordx4 v[180:183], v133, s[40:43], 0 offen sc1
buffer_load_dwordx4 v[184:187], v134, s[40:43], 0 offen sc1
buffer_load_dwordx4 v[188:191], v135, s[40:43], 0 offen sc1
global_load_dword v63, v62, s[32:33] sc1
s_xor_b32 s60, s68, s101
s_xor_b32 s60, s60, 1
s_lshl_b32 s60, s60, 6
s_add_u32 s60, s60, s66
v_lshrrev_b32 v8, 3, v1
v_lshl_add_u32 v8, v8, 1, s60
v_lshlrev_b32 v8, 11, v8
v_and_b32 v9, 7, v1
v_lshrrev_b32 v10, 4, v1
v_xor_b32 v9, v9, v10
v_lshlrev_b32 v9, 4, v9
v_xor_b32 v10, 64, v9
v_add_u32 v244, v8, v9
v_add_u32 v245, v8, v10
v_add_u32 v245, 31744, v245
v_add_u32 v246, v8, v9
v_add_u32 v246, 63488, v246
v_add_u32 v247, v8, v10
v_add_u32 v247, 95232, v247
s_and_b32 s64, s36, 7
s_lshl_b32 s60, s64, 18
s_lshl_b32 s61, s101, 10
s_add_u32 s60, s60, s61
s_add_u32 s48, s20, s60
s_addc_u32 s49, s21, 0
s_sub_u32 s50, 262144, s61
s_mov_b32 s51, 0x20000
s_add_u32 s52, s22, s60
s_addc_u32 s53, s23, 0
s_sub_u32 s54, 262144, s61
s_mov_b32 s55, 0x20000
s_lshl_b32 s61, s64, 1
s_add_u32 s61, s61, s101
s_lshl_b32 s61, s61, 7
s_lshl_b32 s63, s35, 1
s_add_u32 s63, s63, s68
s_lshl_b32 s60, s63, 17
s_add_u32 s60, s60, s61
s_add_u32 s56, s10, s60
s_addc_u32 s57, s11, 0
s_sub_u32 s58, 131072, s61
s_mov_b32 s59, 0x20000
s_add_u32 s26, s26, s61
s_addc_u32 s27, s27, 0
s_lshl_b32 s61, s61, 1
s_add_u32 s61, s61, 4096
s_lshl_b32 s60, s63, 19
s_add_u32 s60, s60, s61
s_add_u32 s28, s28, s60
s_addc_u32 s29, s29, 0
s_sub_u32 s24, 0x80000, s61
s_lshl_b32 s67, s34, 12
s_lshl_b32 s65, s64, 13
s_lshl_b32 s64, s64, 7
s_lshl_b32 s60, s68, 14
s_lshl_b32 s61, s66, 11
s_add_u32 s60, s60, s61
s_add_u32 s60, s60, 65536
v_add_u32 v16, s60, v11
s_lshl_b32 s60, s34, 13
s_add_u32 s60, s60, 65536
v_add_u32 v17, s60, v11
s_mov_b32 s69, 0
L_poll44:
s_mov_b64 s[60:61], 0
s_waitcnt vmcnt(8)
v_cmp_ne_u32 vcc, v162, v136
s_nop 0
s_or_b64 s[60:61], s[60:61], vcc
v_cmp_ne_u32 vcc, v163, v136
s_nop 0
s_or_b64 s[60:61], s[60:61], vcc
s_waitcnt vmcnt(7)
v_cmp_ne_u32 vcc, v166, v137
s_nop 0
s_or_b64 s[60:61], s[60:61], vcc
v_cmp_ne_u32 vcc, v167, v137
s_nop 0
s_or_b64 s[60:61], s[60:61], vcc
s_waitcnt vmcnt(6)
v_cmp_ne_u32 vcc, v170, v138
s_nop 0
s_or_b64 s[60:61], s[60:61], vcc
v_cmp_ne_u32 vcc, v171, v138
s_nop 0
s_or_b64 s[60:61], s[60:61], vcc
s_waitcnt vmcnt(5)
v_cmp_ne_u32 vcc, v174, v139
s_nop 0
s_or_b64 s[60:61], s[60:61], vcc
v_cmp_ne_u32 vcc, v175, v139
s_nop 0
s_or_b64 s[60:61], s[60:61], vcc
s_waitcnt vmcnt(4)
v_cmp_ne_u32 vcc, v178, v140
s_nop 0
s_or_b64 s[60:61], s[60:61], vcc
v_cmp_ne_u32 vcc, v179, v140
s_nop 0
s_or_b64 s[60:61], s[60:61], vcc
s_waitcnt vmcnt(3)
v_cmp_ne_u32 vcc, v182, v141
s_nop 0
s_or_b64 s[60:61], s[60:61], vcc
v_cmp_ne_u32 vcc, v183, v141
s_nop 0
s_or_b64 s[60:61], s[60:61], vcc
s_waitcnt vmcnt(2)
v_cmp_ne_u32 vcc, v186, v142
s_nop 0
s_or_b64 s[60:61], s[60:61], vcc
v_cmp_ne_u32 vcc, v187, v142
s_nop 0
s_or_b64 s[60:61], s[60:61], vcc
s_waitcnt vmcnt(1)
v_cmp_ne_u32 vcc, v190, v143
s_nop 0
s_or_b64 s[60:61], s[60:61], vcc
v_cmp_ne_u32 vcc, v191, v143
s_nop 0
s_or_b64 s[60:61], s[60:61], vcc
s_waitcnt vmcnt(0)
v_xor_b32 v63, v60, v63
v_cmp_lt_u32 vcc, 15, v63
s_nop 0
s_or_b64 s[60:61], s[60:61], vcc
s_add_u32 s69, s69, 1
s_cmp_eq_u64 s[60:61], 0
s_cbranch_scc1 L_polled45
s_cmp_ge_u32 s69, 200000
s_cbranch_scc1 L_polled45
buffer_load_dwordx4 v[160:163], v128, s[40:43], 0 offen sc1
buffer_load_dwordx4 v[164:167], v129, s[40:43], 0 offen sc1
buffer_load_dwordx4 v[168:171], v130, s[40:43], 0 offen sc1
buffer_load_dwordx4 v[172:175], v131, s[40:43], 0 offen sc1
buffer_load_dwordx4 v[176:179], v132, s[40:43], 0 offen sc1
buffer_load_dwordx4 v[180:183], v133, s[40:43], 0 offen sc1
buffer_load_dwordx4 v[184:187], v134, s[40:43], 0 offen sc1
buffer_load_dwordx4 v[188:191], v135, s[40:43], 0 offen sc1
global_load_dword v63, v62, s[32:33] sc1
s_branch L_poll44
L_polled45:
v_cmp_ne_u32 vcc, 0, v63
s_nop 0
s_cmp_eq_u64 vcc, 0
s_cselect_b32 s100, 1, 0
v_mov_b32 v12, 126976
s_lshl_b32 s60, s34, 2
v_add_u32 v13, s60, v12
v_mov_b32 v14, 1
s_mov_b64 exec, 1
ds_write_b32 v13, v14
s_mov_b64 exec, -1
s_add_u32 m0, s67, 0
s_add_u32 s62, s64, 0
s_and_b32 s62, s62, 0x3ff
buffer_load_dwordx4 v244, s[48:51], s62 offen offset:0 lds
buffer_load_dwordx4 v245, s[48:51], s62 offen offset:1024 lds
buffer_load_dwordx4 v246, s[48:51], s62 offen offset:2048 lds
buffer_load_dwordx4 v247, s[48:51], s62 offen offset:3072 lds
s_add_u32 m0, s67, 16384
s_nop 0
buffer_load_dwordx4 v244, s[52:55], s62 offen offset:0 lds
buffer_load_dwordx4 v245, s[52:55], s62 offen offset:1024 lds
buffer_load_dwordx4 v246, s[52:55], s62 offen offset:2048 lds
buffer_load_dwordx4 v247, s[52:55], s62 offen offset:3072 lds
v_fma_f32 v40, v2, v188, v184
v_fma_f32 v41, v2, v189, v185
v_fma_f32 v48, -v3, v189, v40
v_fma_f32 v49, v3, v188, v41
v_fma_f32 v40, v2, v48, v180
v_fma_f32 v41, v2, v49, v181
v_fma_f32 v188, -v3, v49, v40
v_fma_f32 v189, v3, v48, v41
v_fma_f32 v40, v2, v188, v176
v_fma_f32 v41, v2, v189, v177
v_fma_f32 v48, -v3, v189, v40
v_fma_f32 v49, v3, v188, v41
v_fma_f32 v40, v2, v48, v172
v_fma_f32 v41, v2, v49, v173
v_fma_f32 v188, -v3, v49, v40
v_fma_f32 v189, v3, v48, v41
v_fma_f32 v40, v2, v188, v168
v_fma_f32 v41, v2, v189, v169
v_fma_f32 v48, -v3, v189, v40
v_fma_f32 v49, v3, v188, v41
v_fma_f32 v40, v2, v48, v164
v_fma_f32 v41, v2, v49, v165
v_fma_f32 v188, -v3, v49, v40
v_fma_f32 v189, v3, v48, v41
v_fma_f32 v40, v2, v188, v160
v_fma_f32 v41, v2, v189, v161
v_fma_f32 v48, -v3, v189, v40
v_fma_f32 v49, v3, v188, v41
v_mov_b32 v50, v48
v_mov_b32 v51, v49
s_nop 0
v_permlane32_swap_b32 v48, v50
v_permlane32_swap_b32 v49, v51
v_fma_f32 v40, v30, v50, v48
v_fma_f32 v41, v30, v51, v49
v_fma_f32 v192, -v31, v51, v40
v_fma_f32 v193, v31, v50, v41
v_fma_f32 v40, v20, v192, v144
v_fma_f32 v41, v20, v193, v145
v_fma_f32 v194, -v21, v193, v40
v_fma_f32 v195, v21, v192, v41
v_fma_f32 v40, v20, v194, v146
v_fma_f32 v41, v20, v195, v147
v_fma_f32 v196, -v21, v195, v40
v_fma_f32 v197, v21, v194, v41
v_fma_f32 v40, v20, v196, v148
v_fma_f32 v41, v20, v197, v149
v_fma_f32 v198, -v21, v197, v40
v_fma_f32 v199, v21, v196, v41
s_cmp_eq_u32 s68, 0
s_cbranch_scc1 L_wt046
v_mov_b64 v[192:193], v[196:197]
v_mov_b64 v[194:195], v[198:199]
L_wt046:
v_cmp_eq_u32 vcc, 1, v5
s_nop 1
v_cndmask_b32 v48, v192, v194, vcc
v_cndmask_b32 v50, v193, v195, vcc
v_fma_f32 v40, v28, v48, v56
v_fma_f32 v41, v28, v50, v57
v_fma_f32 v49, -v29, v50, v40
v_fma_f32 v51, v29, v48, v41
s_lshl_b32 s60, s35, 1
s_add_u32 s69, s60, s68
s_mul_i32 s60, s69, 262144
s_lshl_b32 s61, s36, 13
s_add_u32 s60, s60, s61
s_lshl_b32 s61, s66, 11
s_add_u32 s60, s60, s61
v_xor_b32 v20, 0, v7
v_add_u32 v24, 0x10000, v20
v_xor_b32 v21, 32, v7
v_add_u32 v25, 0x10000, v21
v_xor_b32 v22, 64, v7
v_add_u32 v26, 0x10000, v22
v_xor_b32 v23, 96, v7
v_add_u32 v27, 0x10000, v23
v_pk_fma_f32 v[64:65], v[208:209], v[48:49], v[64:65] op_sel_hi:[0,1,1]
v_pk_fma_f32 v[80:81], v[208:209], v[50:51], v[80:81] op_sel_hi:[0,1,1] neg_lo:[1,0,0] neg_hi:[1,0,0]
v_pk_fma_f32 v[64:65], v[208:209], v[50:51], v[64:65] op_sel:[1,0,0] neg_lo:[1,0,0] neg_hi:[1,0,0]
v_pk_fma_f32 v[80:81], v[208:209], v[48:49], v[80:81] op_sel:[1,0,0] neg_lo:[1,0,0] neg_hi:[1,0,0]
v_cvt_pk_bf16_f32 v128, v64, v65
v_cvt_pk_bf16_f32 v144, v80, v81
v_pk_fma_f32 v[66:67], v[210:211], v[48:49], v[66:67] op_sel_hi:[0,1,1]
v_pk_fma_f32 v[82:83], v[210:211], v[50:51], v[82:83] op_sel_hi:[0,1,1] neg_lo:[1,0,0] neg_hi:[1,0,0]
v_pk_fma_f32 v[66:67], v[210:211], v[50:51], v[66:67] op_sel:[1,0,0] neg_lo:[1,0,0] neg_hi:[1,0,0]
v_pk_fma_f32 v[82:83], v[210:211], v[48:49], v[82:83] op_sel:[1,0,0] neg_lo:[1,0,0] neg_hi:[1,0,0]
v_cvt_pk_bf16_f32 v129, v66, v67
v_cvt_pk_bf16_f32 v145, v82, v83
v_pk_fma_f32 v[68:69], v[212:213], v[48:49], v[68:69] op_sel_hi:[0,1,1]
v_pk_fma_f32 v[84:85], v[212:213], v[50:51], v[84:85] op_sel_hi:[0,1,1] neg_lo:[1,0,0] neg_hi:[1,0,0]
v_pk_fma_f32 v[68:69], v[212:213], v[50:51], v[68:69] op_sel:[1,0,0] neg_lo:[1,0,0] neg_hi:[1,0,0]
v_pk_fma_f32 v[84:85], v[212:213], v[48:49], v[84:85] op_sel:[1,0,0] neg_lo:[1,0,0] neg_hi:[1,0,0]
v_cvt_pk_bf16_f32 v130, v68, v69
v_cvt_pk_bf16_f32 v146, v84, v85
v_pk_fma_f32 v[70:71], v[214:215], v[48:49], v[70:71] op_sel_hi:[0,1,1]
v_pk_fma_f32 v[86:87], v[214:215], v[50:51], v[86:87] op_sel_hi:[0,1,1] neg_lo:[1,0,0] neg_hi:[1,0,0]
v_pk_fma_f32 v[70:71], v[214:215], v[50:51], v[70:71] op_sel:[1,0,0] neg_lo:[1,0,0] neg_hi:[1,0,0]
v_pk_fma_f32 v[86:87], v[214:215], v[48:49], v[86:87] op_sel:[1,0,0] neg_lo:[1,0,0] neg_hi:[1,0,0]
v_cvt_pk_bf16_f32 v131, v70, v71
v_cvt_pk_bf16_f32 v147, v86, v87
v_pk_fma_f32 v[72:73], v[216:217], v[48:49], v[72:73] op_sel_hi:[0,1,1]
v_pk_fma_f32 v[88:89], v[216:217], v[50:51], v[88:89] op_sel_hi:[0,1,1] neg_lo:[1,0,0] neg_hi:[1,0,0]
v_pk_fma_f32 v[72:73], v[216:217], v[50:51], v[72:73] op_sel:[1,0,0] neg_lo:[1,0,0] neg_hi:[1,0,0]
v_pk_fma_f32 v[88:89], v[216:217], v[48:49], v[88:89] op_sel:[1,0,0] neg_lo:[1,0,0] neg_hi:[1,0,0]
v_cvt_pk_bf16_f32 v132, v72, v73
v_cvt_pk_bf16_f32 v148, v88, v89
v_pk_fma_f32 v[74:75], v[218:219], v[48:49], v[74:75] op_sel_hi:[0,1,1]
v_pk_fma_f32 v[90:91], v[218:219], v[50:51], v[90:91] op_sel_hi:[0,1,1] neg_lo:[1,0,0] neg_hi:[1,0,0]
v_pk_fma_f32 v[74:75], v[218:219], v[50:51], v[74:75] op_sel:[1,0,0] neg_lo:[1,0,0] neg_hi:[1,0,0]
v_pk_fma_f32 v[90:91], v[218:219], v[48:49], v[90:91] op_sel:[1,0,0] neg_lo:[1,0,0] neg_hi:[1,0,0]
v_cvt_pk_bf16_f32 v133, v74, v75
v_cvt_pk_bf16_f32 v149, v90, v91
v_pk_fma_f32 v[76:77], v[220:221], v[48:49], v[76:77] op_sel_hi:[0,1,1]
v_pk_fma_f32 v[92:93], v[220:221], v[50:51], v[92:93] op_sel_hi:[0,1,1] neg_lo:[1,0,0] neg_hi:[1,0,0]
v_pk_fma_f32 v[76:77], v[220:221], v[50:51], v[76:77] op_sel:[1,0,0] neg_lo:[1,0,0] neg_hi:[1,0,0]
v_pk_fma_f32 v[92:93], v[220:221], v[48:49], v[92:93] op_sel:[1,0,0] neg_lo:[1,0,0] neg_hi:[1,0,0]
v_cvt_pk_bf16_f32 v134, v76, v77
v_cvt_pk_bf16_f32 v150, v92, v93
v_pk_fma_f32 v[78:79], v[222:223], v[48:49], v[78:79] op_sel_hi:[0,1,1]
v_pk_fma_f32 v[94:95], v[222:223], v[50:51], v[94:95] op_sel_hi:[0,1,1] neg_lo:[1,0,0] neg_hi:[1,0,0]
v_pk_fma_f32 v[78:79], v[222:223], v[50:51], v[78:79] op_sel:[1,0,0] neg_lo:[1,0,0] neg_hi:[1,0,0]
v_pk_fma_f32 v[94:95], v[222:223], v[48:49], v[94:95] op_sel:[1,0,0] neg_lo:[1,0,0] neg_hi:[1,0,0]
v_cvt_pk_bf16_f32 v135, v78, v79
v_cvt_pk_bf16_f32 v151, v94, v95
v_mfma_f32_32x32x16_bf16 v[160:175], v[128:131], v[248:251], 0
v_mfma_f32_32x32x16_bf16 v[160:175], v[132:135], v[252:255], v[160:175]
v_mfma_f32_32x32x16_bf16 v[176:191], v[144:147], v[248:251], 0
v_mfma_f32_32x32x16_bf16 v[176:191], v[148:151], v[252:255], v[176:191]
v_pk_fma_f32 v[96:97], v[224:225], v[48:49], v[96:97] op_sel_hi:[0,1,1]
v_pk_fma_f32 v[112:113], v[224:225], v[50:51], v[112:113] op_sel_hi:[0,1,1] neg_lo:[1,0,0] neg_hi:[1,0,0]
v_pk_fma_f32 v[96:97], v[224:225], v[50:51], v[96:97] op_sel:[1,0,0] neg_lo:[1,0,0] neg_hi:[1,0,0]
v_pk_fma_f32 v[112:113], v[224:225], v[48:49], v[112:113] op_sel:[1,0,0] neg_lo:[1,0,0] neg_hi:[1,0,0]
v_cvt_pk_bf16_f32 v136, v96, v97
v_cvt_pk_bf16_f32 v152, v112, v113
v_pk_fma_f32 v[98:99], v[226:227], v[48:49], v[98:99] op_sel_hi:[0,1,1]
v_pk_fma_f32 v[114:115], v[226:227], v[50:51], v[114:115] op_sel_hi:[0,1,1] neg_lo:[1,0,0] neg_hi:[1,0,0]
v_pk_fma_f32 v[98:99], v[226:227], v[50:51], v[98:99] op_sel:[1,0,0] neg_lo:[1,0,0] neg_hi:[1,0,0]
v_pk_fma_f32 v[114:115], v[226:227], v[48:49], v[114:115] op_sel:[1,0,0] neg_lo:[1,0,0] neg_hi:[1,0,0]
v_cvt_pk_bf16_f32 v137, v98, v99
v_cvt_pk_bf16_f32 v153, v114, v115
v_pk_fma_f32 v[100:101], v[228:229], v[48:49], v[100:101] op_sel_hi:[0,1,1]
v_pk_fma_f32 v[116:117], v[228:229], v[50:51], v[116:117] op_sel_hi:[0,1,1] neg_lo:[1,0,0] neg_hi:[1,0,0]
v_pk_fma_f32 v[100:101], v[228:229], v[50:51], v[100:101] op_sel:[1,0,0] neg_lo:[1,0,0] neg_hi:[1,0,0]
v_pk_fma_f32 v[116:117], v[228:229], v[48:49], v[116:117] op_sel:[1,0,0] neg_lo:[1,0,0] neg_hi:[1,0,0]
v_cvt_pk_bf16_f32 v138, v100, v101
v_cvt_pk_bf16_f32 v154, v116, v117
v_pk_fma_f32 v[102:103], v[230:231], v[48:49], v[102:103] op_sel_hi:[0,1,1]
v_pk_fma_f32 v[118:119], v[230:231], v[50:51], v[118:119] op_sel_hi:[0,1,1] neg_lo:[1,0,0] neg_hi:[1,0,0]
v_pk_fma_f32 v[102:103], v[230:231], v[50:51], v[102:103] op_sel:[1,0,0] neg_lo:[1,0,0] neg_hi:[1,0,0]
v_pk_fma_f32 v[118:119], v[230:231], v[48:49], v[118:119] op_sel:[1,0,0] neg_lo:[1,0,0] neg_hi:[1,0,0]
v_cvt_pk_bf16_f32 v139, v102, v103
v_cvt_pk_bf16_f32 v155, v118, v119
s_add_u32 s61, s60, 0
v_cvt_pk_bf16_f32 v64, v160, v161
v_cvt_pk_bf16_f32 v65, v162, v163
v_cvt_pk_bf16_f32 v66, v164, v165
v_cvt_pk_bf16_f32 v67, v166, v167
v_cvt_pk_bf16_f32 v68, v168, v169
v_cvt_pk_bf16_f32 v69, v170, v171
v_cvt_pk_bf16_f32 v70, v172, v173
v_cvt_pk_bf16_f32 v71, v174, v175
buffer_store_dwordx4 v[64:67], v11, s[44:47], s61 offen sc1
buffer_store_dwordx4 v[68:71], v11, s[44:47], s61 offen offset:1024 sc1
ds_write_b128 v16, v[64:67] offset:0
ds_write_b128 v16, v[68:71] offset:1024
s_add_u32 s61, s60, 4096
v_cvt_pk_bf16_f32 v72, v176, v177
v_cvt_pk_bf16_f32 v73, v178, v179
v_cvt_pk_bf16_f32 v74, v180, v181
v_cvt_pk_bf16_f32 v75, v182, v183
v_cvt_pk_bf16_f32 v76, v184, v185
v_cvt_pk_bf16_f32 v77, v186, v187
v_cvt_pk_bf16_f32 v78, v188, v189
v_cvt_pk_bf16_f32 v79, v190, v191
buffer_store_dwordx4 v[72:75], v11, s[44:47], s61 offen sc1
buffer_store_dwordx4 v[76:79], v11, s[44:47], s61 offen offset:1024 sc1
ds_write_b128 v16, v[72:75] offset:4096
ds_write_b128 v16, v[76:79] offset:5120
v_pk_fma_f32 v[104:105], v[232:233], v[48:49], v[104:105] op_sel_hi:[0,1,1]
v_pk_fma_f32 v[120:121], v[232:233], v[50:51], v[120:121] op_sel_hi:[0,1,1] neg_lo:[1,0,0] neg_hi:[1,0,0]
v_pk_fma_f32 v[104:105], v[232:233], v[50:51], v[104:105] op_sel:[1,0,0] neg_lo:[1,0,0] neg_hi:[1,0,0]
v_pk_fma_f32 v[120:121], v[232:233], v[48:49], v[120:121] op_sel:[1,0,0] neg_lo:[1,0,0] neg_hi:[1,0,0]
v_cvt_pk_bf16_f32 v140, v104, v105
v_cvt_pk_bf16_f32 v156, v120, v121
v_pk_fma_f32 v[106:107], v[234:235], v[48:49], v[106:107] op_sel_hi:[0,1,1]
v_pk_fma_f32 v[122:123], v[234:235], v[50:51], v[122:123] op_sel_hi:[0,1,1] neg_lo:[1,0,0] neg_hi:[1,0,0]
v_pk_fma_f32 v[106:107], v[234:235], v[50:51], v[106:107] op_sel:[1,0,0] neg_lo:[1,0,0] neg_hi:[1,0,0]
v_pk_fma_f32 v[122:123], v[234:235], v[48:49], v[122:123] op_sel:[1,0,0] neg_lo:[1,0,0] neg_hi:[1,0,0]
v_cvt_pk_bf16_f32 v141, v106, v107
v_cvt_pk_bf16_f32 v157, v122, v123
v_pk_fma_f32 v[108:109], v[236:237], v[48:49], v[108:109] op_sel_hi:[0,1,1]
v_pk_fma_f32 v[124:125], v[236:237], v[50:51], v[124:125] op_sel_hi:[0,1,1] neg_lo:[1,0,0] neg_hi:[1,0,0]
v_pk_fma_f32 v[108:109], v[236:237], v[50:51], v[108:109] op_sel:[1,0,0] neg_lo:[1,0,0] neg_hi:[1,0,0]
v_pk_fma_f32 v[124:125], v[236:237], v[48:49], v[124:125] op_sel:[1,0,0] neg_lo:[1,0,0] neg_hi:[1,0,0]
v_cvt_pk_bf16_f32 v142, v108, v109
v_cvt_pk_bf16_f32 v158, v124, v125
v_pk_fma_f32 v[110:111], v[238:239], v[48:49], v[110:111] op_sel_hi:[0,1,1]
v_pk_fma_f32 v[126:127], v[238:239], v[50:51], v[126:127] op_sel_hi:[0,1,1] neg_lo:[1,0,0] neg_hi:[1,0,0]
v_pk_fma_f32 v[110:111], v[238:239], v[50:51], v[110:111] op_sel:[1,0,0] neg_lo:[1,0,0] neg_hi:[1,0,0]
v_pk_fma_f32 v[126:127], v[238:239], v[48:49], v[126:127] op_sel:[1,0,0] neg_lo:[1,0,0] neg_hi:[1,0,0]
v_cvt_pk_bf16_f32 v143, v110, v111
v_cvt_pk_bf16_f32 v159, v126, v127
v_mfma_f32_32x32x16_bf16 v[192:207], v[136:139], v[248:251], 0
v_mfma_f32_32x32x16_bf16 v[192:207], v[140:143], v[252:255], v[192:207]
v_mfma_f32_32x32x16_bf16 v[32:47], v[152:155], v[248:251], 0
v_mfma_f32_32x32x16_bf16 v[32:47], v[156:159], v[252:255], v[32:47]
s_add_u32 s61, s60, 131072
s_nop 8
v_cvt_pk_bf16_f32 v80, v192, v193
v_cvt_pk_bf16_f32 v81, v194, v195
v_cvt_pk_bf16_f32 v82, v196, v197
v_cvt_pk_bf16_f32 v83, v198, v199
v_cvt_pk_bf16_f32 v84, v200, v201
v_cvt_pk_bf16_f32 v85, v202, v203
v_cvt_pk_bf16_f32 v86, v204, v205
v_cvt_pk_bf16_f32 v87, v206, v207
buffer_store_dwordx4 v[80:83], v11, s[44:47], s61 offen sc1
buffer_store_dwordx4 v[84:87], v11, s[44:47], s61 offen offset:1024 sc1
ds_write_b128 v16, v[80:83] offset:8192
ds_write_b128 v16, v[84:87] offset:9216
s_add_u32 s61, s60, 135168
v_cvt_pk_bf16_f32 v88, v32, v33
v_cvt_pk_bf16_f32 v89, v34, v35
v_cvt_pk_bf16_f32 v90, v36, v37
v_cvt_pk_bf16_f32 v91, v38, v39
v_cvt_pk_bf16_f32 v92, v40, v41
v_cvt_pk_bf16_f32 v93, v42, v43
v_cvt_pk_bf16_f32 v94, v44, v45
v_cvt_pk_bf16_f32 v95, v46, v47
buffer_store_dwordx4 v[88:91], v11, s[44:47], s61 offen sc1
buffer_store_dwordx4 v[92:95], v11, s[44:47], s61 offen offset:1024 sc1
ds_write_b128 v16, v[88:91] offset:12288
ds_write_b128 v16, v[92:95] offset:13312
v_mov_b32 v2, v11
s_lshl_b32 s60, s35, 2
s_add_u32 s60, s60, s34
s_mul_i32 s60, s60, 131072
s_lshl_b32 s61, s101, 16
s_add_u32 s60, s60, s61
s_add_u32 s42, s60, 1048576
s_add_u32 s40, s32, s42
s_addc_u32 s41, s33, 0
s_mov_b32 s42, 65536
s_mov_b32 s43, 0x20000
s_waitcnt vmcnt(8) lgkmcnt(0)
v_mov_b32 v14, 2
s_mov_b64 exec, 1
ds_write_b32 v13, v14
s_mov_b64 exec, -1
ds_read_b128 v[8:11], v12 offset:0
s_waitcnt lgkmcnt(0)
L_ck47:
v_min3_u32 v15, v8, v9, v10
v_min_u32 v15, v15, v11
s_nop 0
v_readfirstlane_b32 s60, v15
s_nop 0
s_cmp_ge_u32 s60, 2
s_cbranch_scc1 L_ckd48
ds_read_b128 v[8:11], v12 offset:0
s_waitcnt lgkmcnt(0)
s_branch L_ck47
L_ckd48:
ds_read_b128 v[148:151], v17 offset:0
ds_read_b128 v[152:155], v17 offset:1024
ds_read_b128 v[156:159], v17 offset:2048
ds_read_b128 v[160:163], v17 offset:3072
ds_read_b128 v[164:167], v17 offset:4096
ds_read_b128 v[168:171], v17 offset:5120
ds_read_b128 v[172:175], v17 offset:6144
ds_read_b128 v[176:179], v17 offset:7168
ds_read_b128 v[96:99], v20 offset:0
ds_read_b128 v[100:103], v20 offset:4096
ds_read_b128 v[104:107], v20 offset:8192
ds_read_b128 v[108:111], v20 offset:12288
s_waitcnt lgkmcnt(4)
v_mov_b32 v14, 3
s_mov_b64 exec, 1
ds_write_b32 v13, v14
s_mov_b64 exec, -1
s_waitcnt lgkmcnt(0)
v_mfma_f32_32x32x16_bf16 v[32:47], v[148:151], v[96:99], 0
ds_read_b128 v[112:115], v21 offset:0
ds_read_b128 v[116:119], v21 offset:4096
v_mfma_f32_32x32x16_bf16 v[48:63], v[148:151], v[100:103], 0
ds_read_b128 v[120:123], v21 offset:8192
ds_read_b128 v[124:127], v21 offset:12288
v_mfma_f32_32x32x16_bf16 v[64:79], v[148:151], v[104:107], 0
s_add_u32 m0, s67, 32768
s_add_u32 s62, s64, 128
s_and_b32 s62, s62, 0x3ff
buffer_load_dwordx4 v244, s[48:51], s62 offen offset:0 lds
v_mfma_f32_32x32x16_bf16 v[80:95], v[148:151], v[108:111], 0
s_waitcnt lgkmcnt(3)
v_mfma_f32_32x32x16_bf16 v[32:47], v[152:155], v[112:115], v[32:47]
ds_read_b128 v[96:99], v22 offset:0
ds_read_b128 v[100:103], v22 offset:4096
s_waitcnt lgkmcnt(4)
v_mfma_f32_32x32x16_bf16 v[48:63], v[152:155], v[116:119], v[48:63]
ds_read_b128 v[104:107], v22 offset:8192
ds_read_b128 v[108:111], v22 offset:12288
s_waitcnt lgkmcnt(5)
v_mfma_f32_32x32x16_bf16 v[64:79], v[152:155], v[120:123], v[64:79]
buffer_load_dwordx4 v245, s[48:51], s62 offen offset:1024 lds
s_waitcnt lgkmcnt(4)
v_mfma_f32_32x32x16_bf16 v[80:95], v[152:155], v[124:127], v[80:95]
s_waitcnt lgkmcnt(3)
v_mfma_f32_32x32x16_bf16 v[32:47], v[156:159], v[96:99], v[32:47]
ds_read_b128 v[112:115], v23 offset:0
ds_read_b128 v[116:119], v23 offset:4096
s_waitcnt lgkmcnt(4)
v_mfma_f32_32x32x16_bf16 v[48:63], v[156:159], v[100:103], v[48:63]
ds_read_b128 v[120:123], v23 offset:8192
ds_read_b128 v[124:127], v23 offset:12288
s_waitcnt lgkmcnt(5)
v_mfma_f32_32x32x16_bf16 v[64:79], v[156:159], v[104:107], v[64:79]
buffer_load_dwordx4 v246, s[48:51], s62 offen offset:2048 lds
s_waitcnt lgkmcnt(4)
v_mfma_f32_32x32x16_bf16 v[80:95], v[156:159], v[108:111], v[80:95]
s_waitcnt lgkmcnt(3)
v_mfma_f32_32x32x16_bf16 v[32:47], v[160:163], v[112:115], v[32:47]
ds_read_b128 v[96:99], v20 offset:16384
ds_read_b128 v[100:103], v20 offset:20480
s_waitcnt lgkmcnt(4)
v_mfma_f32_32x32x16_bf16 v[48:63], v[160:163], v[116:119], v[48:63]
ds_read_b128 v[104:107], v20 offset:24576
ds_read_b128 v[108:111], v20 offset:28672
s_waitcnt lgkmcnt(5)
v_mfma_f32_32x32x16_bf16 v[64:79], v[160:163], v[120:123], v[64:79]
buffer_load_dwordx4 v247, s[48:51], s62 offen offset:3072 lds
s_waitcnt lgkmcnt(4)
v_mfma_f32_32x32x16_bf16 v[80:95], v[160:163], v[124:127], v[80:95]
s_waitcnt lgkmcnt(3)
v_mfma_f32_32x32x16_bf16 v[32:47], v[164:167], v[96:99], v[32:47]
ds_read_b128 v[112:115], v21 offset:16384
ds_read_b128 v[116:119], v21 offset:20480
s_waitcnt lgkmcnt(4)
v_mfma_f32_32x32x16_bf16 v[48:63], v[164:167], v[100:103], v[48:63]
ds_read_b128 v[120:123], v21 offset:24576
ds_read_b128 v[124:127], v21 offset:28672
s_waitcnt lgkmcnt(5)
v_mfma_f32_32x32x16_bf16 v[64:79], v[164:167], v[104:107], v[64:79]
s_add_u32 m0, s67, 49152
s_nop 0
buffer_load_dwordx4 v244, s[52:55], s62 offen offset:0 lds
s_waitcnt lgkmcnt(4)
v_mfma_f32_32x32x16_bf16 v[80:95], v[164:167], v[108:111], v[80:95]
s_waitcnt lgkmcnt(3)
v_mfma_f32_32x32x16_bf16 v[32:47], v[168:171], v[112:115], v[32:47]
ds_read_b128 v[96:99], v22 offset:16384
ds_read_b128 v[100:103], v22 offset:20480
s_waitcnt lgkmcnt(4)
v_mfma_f32_32x32x16_bf16 v[48:63], v[168:171], v[116:119], v[48:63]
ds_read_b128 v[104:107], v22 offset:24576
ds_read_b128 v[108:111], v22 offset:28672
s_waitcnt lgkmcnt(5)
v_mfma_f32_32x32x16_bf16 v[64:79], v[168:171], v[120:123], v[64:79]
buffer_load_dwordx4 v245, s[52:55], s62 offen offset:1024 lds
s_waitcnt lgkmcnt(4)
v_mfma_f32_32x32x16_bf16 v[80:95], v[168:171], v[124:127], v[80:95]
s_waitcnt lgkmcnt(3)
v_mfma_f32_32x32x16_bf16 v[32:47], v[172:175], v[96:99], v[32:47]
ds_read_b128 v[112:115], v23 offset:16384
ds_read_b128 v[116:119], v23 offset:20480
s_waitcnt lgkmcnt(4)
v_mfma_f32_32x32x16_bf16 v[48:63], v[172:175], v[100:103], v[48:63]
ds_read_b128 v[120:123], v23 offset:24576
ds_read_b128 v[124:127], v23 offset:28672
s_waitcnt lgkmcnt(5)
v_mfma_f32_32x32x16_bf16 v[64:79], v[172:175], v[104:107], v[64:79]
buffer_load_dwordx4 v246, s[52:55], s62 offen offset:2048 lds
s_waitcnt lgkmcnt(4)
v_mfma_f32_32x32x16_bf16 v[80:95], v[172:175], v[108:111], v[80:95]
s_waitcnt lgkmcnt(0)
v_mfma_f32_32x32x16_bf16 v[32:47], v[176:179], v[112:115], v[32:47]
v_mfma_f32_32x32x16_bf16 v[48:63], v[176:179], v[116:119], v[48:63]
v_mfma_f32_32x32x16_bf16 v[64:79], v[176:179], v[120:123], v[64:79]
buffer_load_dwordx4 v247, s[52:55], s62 offen offset:3072 lds
v_mfma_f32_32x32x16_bf16 v[80:95], v[176:179], v[124:127], v[80:95]
s_lshl_b32 s60, s66, 3
v_lshl_add_u32 v17, v5, 2, s60
v_lshlrev_b32 v28, 11, v17
v_lshl_add_u32 v28, v6, 2, v28
v_lshlrev_b32 v29, 13, v17
v_lshl_add_u32 v29, v6, 3, v29
v_lshlrev_b32 v30, 2, v6
v_mov_b32 v15, s37
s_waitcnt vmcnt(8)
s_mov_b64 exec, 1
s_cmp_eq_u32 s100, 0
s_cbranch_scc1 L_rs49
global_store_dword v19, v15, s[32:33]
s_branch L_rd50
L_rs49:
global_store_dword v19, v15, s[32:33] sc1
L_rd50:
s_mov_b64 exec, -1
ds_read_b128 v[8:11], v12 offset:0
s_waitcnt lgkmcnt(0)
L_ck51:
v_min3_u32 v15, v8, v9, v10
v_min_u32 v15, v15, v11
s_nop 0
v_readfirstlane_b32 s60, v15
s_nop 0
s_cmp_ge_u32 s60, 3
s_cbranch_scc1 L_ckd52
ds_read_b128 v[8:11], v12 offset:0
s_waitcnt lgkmcnt(0)
s_branch L_ck51
L_ckd52:
ds_read_b128 v[8:11], v12 offset:16
s_waitcnt lgkmcnt(0)
L_ck53:
v_min3_u32 v15, v8, v9, v10
v_min_u32 v15, v15, v11
s_nop 0
v_readfirstlane_b32 s60, v15
s_nop 0
s_cmp_ge_u32 s60, 2
s_cbranch_scc1 L_ckd54
ds_read_b128 v[8:11], v12 offset:16
s_waitcnt lgkmcnt(0)
s_branch L_ck53
L_ckd54:
s_add_u32 m0, s67, 65536
s_add_u32 s62, s64, 256
s_and_b32 s62, s62, 0x3ff
buffer_load_dwordx4 v244, s[48:51], s62 offen offset:0 lds
buffer_load_dwordx4 v245, s[48:51], s62 offen offset:1024 lds
buffer_load_dwordx4 v246, s[48:51], s62 offen offset:2048 lds
buffer_load_dwordx4 v247, s[48:51], s62 offen offset:3072 lds
s_add_u32 m0, s67, 81920
s_nop 0
buffer_load_dwordx4 v244, s[52:55], s62 offen offset:0 lds
buffer_load_dwordx4 v245, s[52:55], s62 offen offset:1024 lds
buffer_load_dwordx4 v246, s[52:55], s62 offen offset:2048 lds
buffer_load_dwordx4 v247, s[52:55], s62 offen offset:3072 lds
s_mov_b32 s92, 0
L_w55:
global_load_dword v8, v18, s[32:33] sc1
s_waitcnt vmcnt(0)
v_cmp_ne_u32 vcc, s37, v8
s_nop 0
s_cbranch_vccz L_wd56
s_sleep 4
s_add_u32 s92, s92, 1
s_cmp_lt_u32 s92, 200000
s_cbranch_scc1 L_w55
L_wd56:
v_mov_b32 v14, 4
s_mov_b64 exec, 1
ds_write_b32 v13, v14
s_mov_b64 exec, -1
s_add_u32 s63, s65, 8192
s_and_b32 s63, s63, 0xffff
buffer_load_dwordx4 v[180:183], v2, s[40:43], s63 offen offset:0 sc1
buffer_load_dwordx4 v[184:187], v2, s[40:43], s63 offen offset:1024 sc1
buffer_load_dwordx4 v[188:191], v2, s[40:43], s63 offen offset:2048 sc1
buffer_load_dwordx4 v[192:195], v2, s[40:43], s63 offen offset:3072 sc1
s_add_u32 m0, s67, 98304
s_add_u32 s62, s64, 384
s_and_b32 s62, s62, 0x3ff
buffer_load_dwordx4 v244, s[48:51], s62 offen offset:0 lds
buffer_load_dwordx4 v245, s[48:51], s62 offen offset:1024 lds
buffer_load_dwordx4 v246, s[48:51], s62 offen offset:2048 lds
buffer_load_dwordx4 v247, s[48:51], s62 offen offset:3072 lds
s_add_u32 s63, s65, 12288
s_and_b32 s63, s63, 0xffff
buffer_load_dwordx4 v[196:199], v2, s[40:43], s63 offen offset:0 sc1
buffer_load_dwordx4 v[200:203], v2, s[40:43], s63 offen offset:1024 sc1
buffer_load_dwordx4 v[204:207], v2, s[40:43], s63 offen offset:2048 sc1
buffer_load_dwordx4 v[208:211], v2, s[40:43], s63 offen offset:3072 sc1
ds_read_b128 v[8:11], v12 offset:0
s_waitcnt lgkmcnt(0)
L_ck57:
v_min3_u32 v15, v8, v9, v10
v_min_u32 v15, v15, v11
s_nop 0
v_readfirstlane_b32 s60, v15
s_nop 0
s_cmp_ge_u32 s60, 4
s_cbranch_scc1 L_ckd58
ds_read_b128 v[8:11], v12 offset:0
s_waitcnt lgkmcnt(0)
s_branch L_ck57
L_ckd58:
ds_read_b128 v[96:99], v20 offset:32768
ds_read_b128 v[100:103], v20 offset:36864
ds_read_b128 v[104:107], v20 offset:40960
ds_read_b128 v[108:111], v20 offset:45056
s_waitcnt vmcnt(11) lgkmcnt(3)
v_mfma_f32_32x32x16_bf16 v[32:47], v[180:183], v[96:99], v[32:47]
ds_read_b128 v[112:115], v21 offset:32768
ds_read_b128 v[116:119], v21 offset:36864
s_waitcnt lgkmcnt(4)
v_mfma_f32_32x32x16_bf16 v[48:63], v[180:183], v[100:103], v[48:63]
ds_read_b128 v[120:123], v21 offset:40960
ds_read_b128 v[124:127], v21 offset:45056
s_waitcnt lgkmcnt(5)
v_mfma_f32_32x32x16_bf16 v[64:79], v[180:183], v[104:107], v[64:79]
s_waitcnt lgkmcnt(4)
v_mfma_f32_32x32x16_bf16 v[80:95], v[180:183], v[108:111], v[80:95]
s_add_u32 s63, s65, 16384
s_and_b32 s63, s63, 0xffff
buffer_load_dwordx4 v[212:215], v2, s[40:43], s63 offen offset:0 sc1
buffer_load_dwordx4 v[216:219], v2, s[40:43], s63 offen offset:1024 sc1
s_waitcnt vmcnt(12) lgkmcnt(3)
v_mfma_f32_32x32x16_bf16 v[32:47], v[184:187], v[112:115], v[32:47]
ds_read_b128 v[96:99], v22 offset:32768
ds_read_b128 v[100:103], v22 offset:36864
s_waitcnt lgkmcnt(4)
v_mfma_f32_32x32x16_bf16 v[48:63], v[184:187], v[116:119], v[48:63]
ds_read_b128 v[104:107], v22 offset:40960
ds_read_b128 v[108:111], v22 offset:45056
s_waitcnt lgkmcnt(5)
v_mfma_f32_32x32x16_bf16 v[64:79], v[184:187], v[120:123], v[64:79]
s_waitcnt lgkmcnt(4)
v_mfma_f32_32x32x16_bf16 v[80:95], v[184:187], v[124:127], v[80:95]
buffer_load_dwordx4 v[220:223], v2, s[40:43], s63 offen offset:2048 sc1
buffer_load_dwordx4 v[224:227], v2, s[40:43], s63 offen offset:3072 sc1
s_waitcnt vmcnt(13) lgkmcnt(3)
v_mfma_f32_32x32x16_bf16 v[32:47], v[188:191], v[96:99], v[32:47]
ds_read_b128 v[112:115], v23 offset:32768
ds_read_b128 v[116:119], v23 offset:36864
s_waitcnt lgkmcnt(4)
v_mfma_f32_32x32x16_bf16 v[48:63], v[188:191], v[100:103], v[48:63]
ds_read_b128 v[120:123], v23 offset:40960
ds_read_b128 v[124:127], v23 offset:45056
s_waitcnt lgkmcnt(5)
v_mfma_f32_32x32x16_bf16 v[64:79], v[188:191], v[104:107], v[64:79]
s_waitcnt lgkmcnt(4)
v_mfma_f32_32x32x16_bf16 v[80:95], v[188:191], v[108:111], v[80:95]
s_add_u32 s63, s65, 20480
s_and_b32 s63, s63, 0xffff
buffer_load_dwordx4 v[228:231], v2, s[40:43], s63 offen offset:0 sc1
buffer_load_dwordx4 v[232:235], v2, s[40:43], s63 offen offset:1024 sc1
s_waitcnt vmcnt(14) lgkmcnt(3)
v_mfma_f32_32x32x16_bf16 v[32:47], v[192:195], v[112:115], v[32:47]
ds_read_b128 v[96:99], v20 offset:49152
ds_read_b128 v[100:103], v20 offset:53248
s_waitcnt lgkmcnt(4)
v_mfma_f32_32x32x16_bf16 v[48:63], v[192:195], v[116:119], v[48:63]
ds_read_b128 v[104:107], v20 offset:57344
ds_read_b128 v[108:111], v20 offset:61440
s_waitcnt lgkmcnt(5)
v_mfma_f32_32x32x16_bf16 v[64:79], v[192:195], v[120:123], v[64:79]
s_waitcnt lgkmcnt(4)
v_mfma_f32_32x32x16_bf16 v[80:95], v[192:195], v[124:127], v[80:95]
buffer_load_dwordx4 v[236:239], v2, s[40:43], s63 offen offset:2048 sc1
buffer_load_dwordx4 v[240:243], v2, s[40:43], s63 offen offset:3072 sc1
s_waitcnt vmcnt(11) lgkmcnt(3)
v_mov_b32 v14, 5
s_mov_b64 exec, 1
ds_write_b32 v13, v14
s_mov_b64 exec, -1
v_mfma_f32_32x32x16_bf16 v[32:47], v[196:199], v[96:99], v[32:47]
ds_read_b128 v[112:115], v21 offset:49152
ds_read_b128 v[116:119], v21 offset:53248
s_waitcnt lgkmcnt(5)
v_mfma_f32_32x32x16_bf16 v[48:63], v[196:199], v[100:103], v[48:63]
ds_read_b128 v[120:123], v21 offset:57344
ds_read_b128 v[124:127], v21 offset:61440
s_waitcnt lgkmcnt(6)
v_mfma_f32_32x32x16_bf16 v[64:79], v[196:199], v[104:107], v[64:79]
s_add_u32 m0, s67, 0
s_nop 0
buffer_load_dwordx4 v244, s[52:55], s62 offen offset:0 lds
s_waitcnt lgkmcnt(5)
v_mfma_f32_32x32x16_bf16 v[80:95], v[196:199], v[108:111], v[80:95]
s_add_u32 s63, s65, 24576
s_and_b32 s63, s63, 0xffff
buffer_load_dwordx4 v[148:151], v2, s[40:43], s63 offen offset:0 sc1
buffer_load_dwordx4 v[152:155], v2, s[40:43], s63 offen offset:1024 sc1
s_waitcnt vmcnt(13) lgkmcnt(3)
v_mfma_f32_32x32x16_bf16 v[32:47], v[200:203], v[112:115], v[32:47]
ds_read_b128 v[96:99], v22 offset:49152
ds_read_b128 v[100:103], v22 offset:53248
s_waitcnt lgkmcnt(4)
v_mfma_f32_32x32x16_bf16 v[48:63], v[200:203], v[116:119], v[48:63]
ds_read_b128 v[104:107], v22 offset:57344
ds_read_b128 v[108:111], v22 offset:61440
s_waitcnt lgkmcnt(5)
v_mfma_f32_32x32x16_bf16 v[64:79], v[200:203], v[120:123], v[64:79]
buffer_load_dwordx4 v245, s[52:55], s62 offen offset:1024 lds
s_waitcnt lgkmcnt(4)
v_mfma_f32_32x32x16_bf16 v[80:95], v[200:203], v[124:127], v[80:95]
buffer_load_dwordx4 v[156:159], v2, s[40:43], s63 offen offset:2048 sc1
buffer_load_dwordx4 v[160:163], v2, s[40:43], s63 offen offset:3072 sc1
s_waitcnt vmcnt(15) lgkmcnt(3)
v_mfma_f32_32x32x16_bf16 v[32:47], v[204:207], v[96:99], v[32:47]
ds_read_b128 v[112:115], v23 offset:49152
ds_read_b128 v[116:119], v23 offset:53248
s_waitcnt lgkmcnt(4)
v_mfma_f32_32x32x16_bf16 v[48:63], v[204:207], v[100:103], v[48:63]
ds_read_b128 v[120:123], v23 offset:57344
ds_read_b128 v[124:127], v23 offset:61440
s_waitcnt lgkmcnt(5)
v_mfma_f32_32x32x16_bf16 v[64:79], v[204:207], v[104:107], v[64:79]
buffer_load_dwordx4 v246, s[52:55], s62 offen offset:2048 lds
s_waitcnt lgkmcnt(4)
v_mfma_f32_32x32x16_bf16 v[80:95], v[204:207], v[108:111], v[80:95]
s_add_u32 s63, s65, 28672
s_and_b32 s63, s63, 0xffff
buffer_load_dwordx4 v[164:167], v2, s[40:43], s63 offen offset:0 sc1
buffer_load_dwordx4 v[168:171], v2, s[40:43], s63 offen offset:1024 sc1
ds_read_b128 v[8:11], v12
s_waitcnt vmcnt(17) lgkmcnt(0)
L_ck59:
v_min3_u32 v15, v8, v9, v10
v_min_u32 v15, v15, v11
s_nop 0
v_readfirstlane_b32 s60, v15
s_nop 0
s_cmp_ge_u32 s60, 5
s_cbranch_scc1 L_ckd60
ds_read_b128 v[8:11], v12 offset:0
s_waitcnt lgkmcnt(0)
s_branch L_ck59
L_ckd60:
v_mfma_f32_32x32x16_bf16 v[32:47], v[208:211], v[112:115], v[32:47]
ds_read_b128 v[96:99], v24 offset:0
ds_read_b128 v[100:103], v24 offset:4096
v_mfma_f32_32x32x16_bf16 v[48:63], v[208:211], v[116:119], v[48:63]
ds_read_b128 v[104:107], v24 offset:8192
ds_read_b128 v[108:111], v24 offset:12288
v_mfma_f32_32x32x16_bf16 v[64:79], v[208:211], v[120:123], v[64:79]
buffer_load_dwordx4 v247, s[52:55], s62 offen offset:3072 lds
v_mfma_f32_32x32x16_bf16 v[80:95], v[208:211], v[124:127], v[80:95]
buffer_load_dwordx4 v[172:175], v2, s[40:43], s63 offen offset:2048 sc1
buffer_load_dwordx4 v[176:179], v2, s[40:43], s63 offen offset:3072 sc1
s_waitcnt vmcnt(19) lgkmcnt(3)
v_mfma_f32_32x32x16_bf16 v[32:47], v[212:215], v[96:99], v[32:47]
ds_read_b128 v[112:115], v25 offset:0
ds_read_b128 v[116:119], v25 offset:4096
s_waitcnt lgkmcnt(4)
v_mfma_f32_32x32x16_bf16 v[48:63], v[212:215], v[100:103], v[48:63]
ds_read_b128 v[120:123], v25 offset:8192
ds_read_b128 v[124:127], v25 offset:12288
s_waitcnt lgkmcnt(5)
v_mfma_f32_32x32x16_bf16 v[64:79], v[212:215], v[104:107], v[64:79]
s_add_u32 m0, s67, 16384
s_add_u32 s62, s64, 512
s_and_b32 s62, s62, 0x3ff
buffer_load_dwordx4 v244, s[48:51], s62 offen offset:0 lds
s_waitcnt lgkmcnt(4)
v_mfma_f32_32x32x16_bf16 v[80:95], v[212:215], v[108:111], v[80:95]
s_add_u32 s63, s65, 32768
s_and_b32 s63, s63, 0xffff
buffer_load_dwordx4 v[180:183], v2, s[40:43], s63 offen offset:0 sc1
buffer_load_dwordx4 v[184:187], v2, s[40:43], s63 offen offset:1024 sc1
s_waitcnt vmcnt(21) lgkmcnt(3)
v_mfma_f32_32x32x16_bf16 v[32:47], v[216:219], v[112:115], v[32:47]
ds_read_b128 v[96:99], v26 offset:0
ds_read_b128 v[100:103], v26 offset:4096
s_waitcnt lgkmcnt(4)
v_mfma_f32_32x32x16_bf16 v[48:63], v[216:219], v[116:119], v[48:63]
ds_read_b128 v[104:107], v26 offset:8192
ds_read_b128 v[108:111], v26 offset:12288
s_waitcnt lgkmcnt(5)
v_mfma_f32_32x32x16_bf16 v[64:79], v[216:219], v[120:123], v[64:79]
buffer_load_dwordx4 v245, s[48:51], s62 offen offset:1024 lds
s_waitcnt lgkmcnt(4)
v_mfma_f32_32x32x16_bf16 v[80:95], v[216:219], v[124:127], v[80:95]
buffer_load_dwordx4 v[188:191], v2, s[40:43], s63 offen offset:2048 sc1
buffer_load_dwordx4 v[192:195], v2, s[40:43], s63 offen offset:3072 sc1
s_waitcnt vmcnt(23) lgkmcnt(3)
v_mfma_f32_32x32x16_bf16 v[32:47], v[220:223], v[96:99], v[32:47]
ds_read_b128 v[112:115], v27 offset:0
ds_read_b128 v[116:119], v27 offset:4096
s_waitcnt lgkmcnt(4)
v_mfma_f32_32x32x16_bf16 v[48:63], v[220:223], v[100:103], v[48:63]
ds_read_b128 v[120:123], v27 offset:8192
ds_read_b128 v[124:127], v27 offset:12288
s_waitcnt lgkmcnt(5)
v_mfma_f32_32x32x16_bf16 v[64:79], v[220:223], v[104:107], v[64:79]
buffer_load_dwordx4 v246, s[48:51], s62 offen offset:2048 lds
s_waitcnt lgkmcnt(4)
v_mfma_f32_32x32x16_bf16 v[80:95], v[220:223], v[108:111], v[80:95]
s_add_u32 s63, s65, 36864
s_and_b32 s63, s63, 0xffff
buffer_load_dwordx4 v[196:199], v2, s[40:43], s63 offen offset:0 sc1
buffer_load_dwordx4 v[200:203], v2, s[40:43], s63 offen offset:1024 sc1
s_waitcnt vmcnt(25) lgkmcnt(3)
v_mfma_f32_32x32x16_bf16 v[32:47], v[224:227], v[112:115], v[32:47]
ds_read_b128 v[96:99], v24 offset:16384
ds_read_b128 v[100:103], v24 offset:20480
s_waitcnt lgkmcnt(4)
v_mfma_f32_32x32x16_bf16 v[48:63], v[224:227], v[116:119], v[48:63]
ds_read_b128 v[104:107], v24 offset:24576
ds_read_b128 v[108:111], v24 offset:28672
s_waitcnt lgkmcnt(5)
v_mfma_f32_32x32x16_bf16 v[64:79], v[224:227], v[120:123], v[64:79]
buffer_load_dwordx4 v247, s[48:51], s62 offen offset:3072 lds
s_waitcnt lgkmcnt(4)
v_mfma_f32_32x32x16_bf16 v[80:95], v[224:227], v[124:127], v[80:95]
buffer_load_dwordx4 v[204:207], v2, s[40:43], s63 offen offset:2048 sc1
buffer_load_dwordx4 v[208:211], v2, s[40:43], s63 offen offset:3072 sc1
s_waitcnt vmcnt(14) lgkmcnt(3)
v_mov_b32 v14, 6
s_mov_b64 exec, 1
ds_write_b32 v13, v14
s_mov_b64 exec, -1
v_mfma_f32_32x32x16_bf16 v[32:47], v[228:231], v[96:99], v[32:47]
ds_read_b128 v[112:115], v25 offset:16384
ds_read_b128 v[116:119], v25 offset:20480
s_waitcnt lgkmcnt(5)
v_mfma_f32_32x32x16_bf16 v[48:63], v[228:231], v[100:103], v[48:63]
ds_read_b128 v[120:123], v25 offset:24576
ds_read_b128 v[124:127], v25 offset:28672
s_waitcnt lgkmcnt(6)
v_mfma_f32_32x32x16_bf16 v[64:79], v[228:231], v[104:107], v[64:79]
s_add_u32 m0, s67, 32768
s_nop 0
buffer_load_dwordx4 v244, s[52:55], s62 offen offset:0 lds
s_waitcnt lgkmcnt(5)
v_mfma_f32_32x32x16_bf16 v[80:95], v[228:231], v[108:111], v[80:95]
s_add_u32 s63, s65, 40960
s_and_b32 s63, s63, 0xffff
buffer_load_dwordx4 v[212:215], v2, s[40:43], s63 offen offset:0 sc1
buffer_load_dwordx4 v[216:219], v2, s[40:43], s63 offen offset:1024 sc1
s_waitcnt vmcnt(29) lgkmcnt(3)
v_mfma_f32_32x32x16_bf16 v[32:47], v[232:235], v[112:115], v[32:47]
ds_read_b128 v[96:99], v26 offset:16384
ds_read_b128 v[100:103], v26 offset:20480
s_waitcnt lgkmcnt(4)
v_mfma_f32_32x32x16_bf16 v[48:63], v[232:235], v[116:119], v[48:63]
ds_read_b128 v[104:107], v26 offset:24576
ds_read_b128 v[108:111], v26 offset:28672
s_waitcnt lgkmcnt(5)
v_mfma_f32_32x32x16_bf16 v[64:79], v[232:235], v[120:123], v[64:79]
buffer_load_dwordx4 v245, s[52:55], s62 offen offset:1024 lds
s_waitcnt lgkmcnt(4)
v_mfma_f32_32x32x16_bf16 v[80:95], v[232:235], v[124:127], v[80:95]
buffer_load_dwordx4 v[220:223], v2, s[40:43], s63 offen offset:2048 sc1
buffer_load_dwordx4 v[224:227], v2, s[40:43], s63 offen offset:3072 sc1
s_waitcnt vmcnt(31) lgkmcnt(3)
v_mfma_f32_32x32x16_bf16 v[32:47], v[236:239], v[96:99], v[32:47]
ds_read_b128 v[112:115], v27 offset:16384
ds_read_b128 v[116:119], v27 offset:20480
s_waitcnt lgkmcnt(4)
v_mfma_f32_32x32x16_bf16 v[48:63], v[236:239], v[100:103], v[48:63]
ds_read_b128 v[120:123], v27 offset:24576
ds_read_b128 v[124:127], v27 offset:28672
s_waitcnt lgkmcnt(5)
v_mfma_f32_32x32x16_bf16 v[64:79], v[236:239], v[104:107], v[64:79]
buffer_load_dwordx4 v246, s[52:55], s62 offen offset:2048 lds
s_waitcnt lgkmcnt(4)
v_mfma_f32_32x32x16_bf16 v[80:95], v[236:239], v[108:111], v[80:95]
s_add_u32 s63, s65, 45056
s_and_b32 s63, s63, 0xffff
buffer_load_dwordx4 v[228:231], v2, s[40:43], s63 offen offset:0 sc1
buffer_load_dwordx4 v[232:235], v2, s[40:43], s63 offen offset:1024 sc1
ds_read_b128 v[8:11], v12
s_waitcnt vmcnt(33) lgkmcnt(0)
L_ck61:
v_min3_u32 v15, v8, v9, v10
v_min_u32 v15, v15, v11
s_nop 0
v_readfirstlane_b32 s60, v15
s_nop 0
s_cmp_ge_u32 s60, 6
s_cbranch_scc1 L_ckd62
ds_read_b128 v[8:11], v12 offset:0
s_waitcnt lgkmcnt(0)
s_branch L_ck61
L_ckd62:
v_mfma_f32_32x32x16_bf16 v[32:47], v[240:243], v[112:115], v[32:47]
ds_read_b128 v[96:99], v24 offset:32768
ds_read_b128 v[100:103], v24 offset:36864
v_mfma_f32_32x32x16_bf16 v[48:63], v[240:243], v[116:119], v[48:63]
ds_read_b128 v[104:107], v24 offset:40960
ds_read_b128 v[108:111], v24 offset:45056
v_mfma_f32_32x32x16_bf16 v[64:79], v[240:243], v[120:123], v[64:79]
buffer_load_dwordx4 v247, s[52:55], s62 offen offset:3072 lds
v_mfma_f32_32x32x16_bf16 v[80:95], v[240:243], v[124:127], v[80:95]
buffer_load_dwordx4 v[236:239], v2, s[40:43], s63 offen offset:2048 sc1
buffer_load_dwordx4 v[240:243], v2, s[40:43], s63 offen offset:3072 sc1
s_waitcnt vmcnt(34) lgkmcnt(3)
v_mfma_f32_32x32x16_bf16 v[32:47], v[148:151], v[96:99], v[32:47]
ds_read_b128 v[112:115], v25 offset:32768
ds_read_b128 v[116:119], v25 offset:36864
s_waitcnt lgkmcnt(4)
v_mfma_f32_32x32x16_bf16 v[48:63], v[148:151], v[100:103], v[48:63]
ds_read_b128 v[120:123], v25 offset:40960
ds_read_b128 v[124:127], v25 offset:45056
s_waitcnt lgkmcnt(5)
v_mfma_f32_32x32x16_bf16 v[64:79], v[148:151], v[104:107], v[64:79]
s_add_u32 m0, s67, 49152
s_add_u32 s62, s64, 640
s_and_b32 s62, s62, 0x3ff
buffer_load_dwordx4 v244, s[48:51], s62 offen offset:0 lds
s_waitcnt lgkmcnt(4)
v_mfma_f32_32x32x16_bf16 v[80:95], v[148:151], v[108:111], v[80:95]
s_add_u32 s63, s65, 49152
s_and_b32 s63, s63, 0xffff
buffer_load_dwordx4 v[148:151], v2, s[40:43], s63 offen offset:0 sc1
s_waitcnt vmcnt(35) lgkmcnt(3)
v_mfma_f32_32x32x16_bf16 v[32:47], v[152:155], v[112:115], v[32:47]
ds_read_b128 v[96:99], v26 offset:32768
ds_read_b128 v[100:103], v26 offset:36864
s_waitcnt lgkmcnt(4)
v_mfma_f32_32x32x16_bf16 v[48:63], v[152:155], v[116:119], v[48:63]
ds_read_b128 v[104:107], v26 offset:40960
ds_read_b128 v[108:111], v26 offset:45056
s_waitcnt lgkmcnt(5)
v_mfma_f32_32x32x16_bf16 v[64:79], v[152:155], v[120:123], v[64:79]
buffer_load_dwordx4 v245, s[48:51], s62 offen offset:1024 lds
s_waitcnt lgkmcnt(4)
v_mfma_f32_32x32x16_bf16 v[80:95], v[152:155], v[124:127], v[80:95]
buffer_load_dwordx4 v[152:155], v2, s[40:43], s63 offen offset:1024 sc1
s_waitcnt vmcnt(35) lgkmcnt(3)
v_mfma_f32_32x32x16_bf16 v[32:47], v[156:159], v[96:99], v[32:47]
ds_read_b128 v[112:115], v27 offset:32768
ds_read_b128 v[116:119], v27 offset:36864
s_waitcnt lgkmcnt(4)
v_mfma_f32_32x32x16_bf16 v[48:63], v[156:159], v[100:103], v[48:63]
ds_read_b128 v[120:123], v27 offset:40960
ds_read_b128 v[124:127], v27 offset:45056
s_waitcnt lgkmcnt(5)
v_mfma_f32_32x32x16_bf16 v[64:79], v[156:159], v[104:107], v[64:79]
buffer_load_dwordx4 v246, s[48:51], s62 offen offset:2048 lds
s_waitcnt lgkmcnt(4)
v_mfma_f32_32x32x16_bf16 v[80:95], v[156:159], v[108:111], v[80:95]
buffer_load_dwordx4 v[156:159], v2, s[40:43], s63 offen offset:2048 sc1
s_waitcnt vmcnt(36) lgkmcnt(3)
v_mfma_f32_32x32x16_bf16 v[32:47], v[160:163], v[112:115], v[32:47]
ds_read_b128 v[96:99], v20 offset:0
ds_read_b128 v[100:103], v20 offset:4096
s_waitcnt lgkmcnt(4)
v_mfma_f32_32x32x16_bf16 v[48:63], v[160:163], v[116:119], v[48:63]
ds_read_b128 v[104:107], v20 offset:8192
ds_read_b128 v[108:111], v20 offset:12288
s_waitcnt lgkmcnt(5)
v_mfma_f32_32x32x16_bf16 v[64:79], v[160:163], v[120:123], v[64:79]
buffer_load_dwordx4 v247, s[48:51], s62 offen offset:3072 lds
s_waitcnt lgkmcnt(4)
v_mfma_f32_32x32x16_bf16 v[80:95], v[160:163], v[124:127], v[80:95]
buffer_load_dwordx4 v[160:163], v2, s[40:43], s63 offen offset:3072 sc1
s_waitcnt vmcnt(10) lgkmcnt(3)
v_mov_b32 v14, 7
s_mov_b64 exec, 1
ds_write_b32 v13, v14
s_mov_b64 exec, -1
v_mfma_f32_32x32x16_bf16 v[32:47], v[164:167], v[96:99], v[32:47]
ds_read_b128 v[112:115], v21 offset:0
ds_read_b128 v[116:119], v21 offset:4096
s_waitcnt lgkmcnt(5)
v_mfma_f32_32x32x16_bf16 v[48:63], v[164:167], v[100:103], v[48:63]
ds_read_b128 v[120:123], v21 offset:8192
ds_read_b128 v[124:127], v21 offset:12288
s_waitcnt lgkmcnt(6)
v_mfma_f32_32x32x16_bf16 v[64:79], v[164:167], v[104:107], v[64:79]
s_add_u32 m0, s67, 65536
s_nop 0
buffer_load_dwordx4 v244, s[52:55], s62 offen offset:0 lds
s_waitcnt lgkmcnt(5)
v_mfma_f32_32x32x16_bf16 v[80:95], v[164:167], v[108:111], v[80:95]
s_add_u32 s63, s65, 53248
s_and_b32 s63, s63, 0xffff
buffer_load_dwordx4 v[164:167], v2, s[40:43], s63 offen offset:0 sc1
s_waitcnt vmcnt(37) lgkmcnt(3)
v_mfma_f32_32x32x16_bf16 v[32:47], v[168:171], v[112:115], v[32:47]
ds_read_b128 v[96:99], v22 offset:0
ds_read_b128 v[100:103], v22 offset:4096
s_waitcnt lgkmcnt(4)
v_mfma_f32_32x32x16_bf16 v[48:63], v[168:171], v[116:119], v[48:63]
ds_read_b128 v[104:107], v22 offset:8192
ds_read_b128 v[108:111], v22 offset:12288
s_waitcnt lgkmcnt(5)
v_mfma_f32_32x32x16_bf16 v[64:79], v[168:171], v[120:123], v[64:79]
buffer_load_dwordx4 v245, s[52:55], s62 offen offset:1024 lds
s_waitcnt lgkmcnt(4)
v_mfma_f32_32x32x16_bf16 v[80:95], v[168:171], v[124:127], v[80:95]
buffer_load_dwordx4 v[168:171], v2, s[40:43], s63 offen offset:1024 sc1
s_waitcnt vmcnt(37) lgkmcnt(3)
v_mfma_f32_32x32x16_bf16 v[32:47], v[172:175], v[96:99], v[32:47]
ds_read_b128 v[112:115], v23 offset:0
ds_read_b128 v[116:119], v23 offset:4096
s_waitcnt lgkmcnt(4)
v_mfma_f32_32x32x16_bf16 v[48:63], v[172:175], v[100:103], v[48:63]
ds_read_b128 v[120:123], v23 offset:8192
ds_read_b128 v[124:127], v23 offset:12288
s_waitcnt lgkmcnt(5)
v_mfma_f32_32x32x16_bf16 v[64:79], v[172:175], v[104:107], v[64:79]
buffer_load_dwordx4 v246, s[52:55], s62 offen offset:2048 lds
s_waitcnt lgkmcnt(4)
v_mfma_f32_32x32x16_bf16 v[80:95], v[172:175], v[108:111], v[80:95]
buffer_load_dwordx4 v[172:175], v2, s[40:43], s63 offen offset:2048 sc1
ds_read_b128 v[8:11], v12
s_waitcnt vmcnt(38) lgkmcnt(0)
L_ck63:
v_min3_u32 v15, v8, v9, v10
v_min_u32 v15, v15, v11
s_nop 0
v_readfirstlane_b32 s60, v15
s_nop 0
s_cmp_ge_u32 s60, 7
s_cbranch_scc1 L_ckd64
ds_read_b128 v[8:11], v12 offset:0
s_waitcnt lgkmcnt(0)
s_branch L_ck63
L_ckd64:
v_mfma_f32_32x32x16_bf16 v[32:47], v[176:179], v[112:115], v[32:47]
ds_read_b128 v[96:99], v20 offset:16384
ds_read_b128 v[100:103], v20 offset:20480
v_mfma_f32_32x32x16_bf16 v[48:63], v[176:179], v[116:119], v[48:63]
ds_read_b128 v[104:107], v20 offset:24576
ds_read_b128 v[108:111], v20 offset:28672
v_mfma_f32_32x32x16_bf16 v[64:79], v[176:179], v[120:123], v[64:79]
buffer_load_dwordx4 v247, s[52:55], s62 offen offset:3072 lds
v_mfma_f32_32x32x16_bf16 v[80:95], v[176:179], v[124:127], v[80:95]
buffer_load_dwordx4 v[176:179], v2, s[40:43], s63 offen offset:3072 sc1
s_waitcnt vmcnt(38) lgkmcnt(3)
v_mfma_f32_32x32x16_bf16 v[32:47], v[180:183], v[96:99], v[32:47]
ds_read_b128 v[112:115], v21 offset:16384
ds_read_b128 v[116:119], v21 offset:20480
s_waitcnt lgkmcnt(4)
v_mfma_f32_32x32x16_bf16 v[48:63], v[180:183], v[100:103], v[48:63]
ds_read_b128 v[120:123], v21 offset:24576
ds_read_b128 v[124:127], v21 offset:28672
s_waitcnt lgkmcnt(5)
v_mfma_f32_32x32x16_bf16 v[64:79], v[180:183], v[104:107], v[64:79]
s_add_u32 m0, s67, 81920
s_add_u32 s62, s64, 768
s_and_b32 s62, s62, 0x3ff
buffer_load_dwordx4 v244, s[48:51], s62 offen offset:0 lds
s_waitcnt lgkmcnt(4)
v_mfma_f32_32x32x16_bf16 v[80:95], v[180:183], v[108:111], v[80:95]
s_add_u32 s63, s65, 57344
s_and_b32 s63, s63, 0xffff
buffer_load_dwordx4 v[180:183], v2, s[40:43], s63 offen offset:0 sc1
s_waitcnt vmcnt(39) lgkmcnt(3)
v_mfma_f32_32x32x16_bf16 v[32:47], v[184:187], v[112:115], v[32:47]
ds_read_b128 v[96:99], v22 offset:16384
ds_read_b128 v[100:103], v22 offset:20480
s_waitcnt lgkmcnt(4)
v_mfma_f32_32x32x16_bf16 v[48:63], v[184:187], v[116:119], v[48:63]
ds_read_b128 v[104:107], v22 offset:24576
ds_read_b128 v[108:111], v22 offset:28672
s_waitcnt lgkmcnt(5)
v_mfma_f32_32x32x16_bf16 v[64:79], v[184:187], v[120:123], v[64:79]
buffer_load_dwordx4 v245, s[48:51], s62 offen offset:1024 lds
s_waitcnt lgkmcnt(4)
v_mfma_f32_32x32x16_bf16 v[80:95], v[184:187], v[124:127], v[80:95]
buffer_load_dwordx4 v[184:187], v2, s[40:43], s63 offen offset:1024 sc1
s_waitcnt vmcnt(39) lgkmcnt(3)
v_mfma_f32_32x32x16_bf16 v[32:47], v[188:191], v[96:99], v[32:47]
ds_read_b128 v[112:115], v23 offset:16384
ds_read_b128 v[116:119], v23 offset:20480
s_waitcnt lgkmcnt(4)
v_mfma_f32_32x32x16_bf16 v[48:63], v[188:191], v[100:103], v[48:63]
ds_read_b128 v[120:123], v23 offset:24576
ds_read_b128 v[124:127], v23 offset:28672
s_waitcnt lgkmcnt(5)
v_mfma_f32_32x32x16_bf16 v[64:79], v[188:191], v[104:107], v[64:79]
buffer_load_dwordx4 v246, s[48:51], s62 offen offset:2048 lds
s_waitcnt lgkmcnt(4)
v_mfma_f32_32x32x16_bf16 v[80:95], v[188:191], v[108:111], v[80:95]
buffer_load_dwordx4 v[188:191], v2, s[40:43], s63 offen offset:2048 sc1
s_waitcnt vmcnt(40) lgkmcnt(3)
v_mfma_f32_32x32x16_bf16 v[32:47], v[192:195], v[112:115], v[32:47]
ds_read_b128 v[96:99], v20 offset:32768
ds_read_b128 v[100:103], v20 offset:36864
s_waitcnt lgkmcnt(4)
v_mfma_f32_32x32x16_bf16 v[48:63], v[192:195], v[116:119], v[48:63]
ds_read_b128 v[104:107], v20 offset:40960
ds_read_b128 v[108:111], v20 offset:45056
s_waitcnt lgkmcnt(5)
v_mfma_f32_32x32x16_bf16 v[64:79], v[192:195], v[120:123], v[64:79]
buffer_load_dwordx4 v247, s[48:51], s62 offen offset:3072 lds
s_waitcnt lgkmcnt(4)
v_mfma_f32_32x32x16_bf16 v[80:95], v[192:195], v[124:127], v[80:95]
buffer_load_dwordx4 v[192:195], v2, s[40:43], s63 offen offset:3072 sc1
s_waitcnt vmcnt(9) lgkmcnt(3)
v_mov_b32 v14, 8
s_mov_b64 exec, 1
ds_write_b32 v13, v14
s_mov_b64 exec, -1
v_mfma_f32_32x32x16_bf16 v[32:47], v[196:199], v[96:99], v[32:47]
ds_read_b128 v[112:115], v21 offset:32768
ds_read_b128 v[116:119], v21 offset:36864
s_waitcnt lgkmcnt(5)
v_mfma_f32_32x32x16_bf16 v[48:63], v[196:199], v[100:103], v[48:63]
ds_read_b128 v[120:123], v21 offset:40960
ds_read_b128 v[124:127], v21 offset:45056
s_waitcnt lgkmcnt(6)
v_mfma_f32_32x32x16_bf16 v[64:79], v[196:199], v[104:107], v[64:79]
s_add_u32 m0, s67, 98304
s_nop 0
buffer_load_dwordx4 v244, s[52:55], s62 offen offset:0 lds
s_waitcnt lgkmcnt(5)
v_mfma_f32_32x32x16_bf16 v[80:95], v[196:199], v[108:111], v[80:95]
s_add_u32 s63, s65, 61440
s_and_b32 s63, s63, 0xffff
buffer_load_dwordx4 v[196:199], v2, s[40:43], s63 offen offset:0 sc1
s_waitcnt vmcnt(41) lgkmcnt(3)
v_mfma_f32_32x32x16_bf16 v[32:47], v[200:203], v[112:115], v[32:47]
ds_read_b128 v[96:99], v22 offset:32768
ds_read_b128 v[100:103], v22 offset:36864
s_waitcnt lgkmcnt(4)
v_mfma_f32_32x32x16_bf16 v[48:63], v[200:203], v[116:119], v[48:63]
ds_read_b128 v[104:107], v22 offset:40960
ds_read_b128 v[108:111], v22 offset:45056
s_waitcnt lgkmcnt(5)
v_mfma_f32_32x32x16_bf16 v[64:79], v[200:203], v[120:123], v[64:79]
buffer_load_dwordx4 v245, s[52:55], s62 offen offset:1024 lds
s_waitcnt lgkmcnt(4)
v_mfma_f32_32x32x16_bf16 v[80:95], v[200:203], v[124:127], v[80:95]
buffer_load_dwordx4 v[200:203], v2, s[40:43], s63 offen offset:1024 sc1
s_waitcnt vmcnt(41) lgkmcnt(3)
v_mfma_f32_32x32x16_bf16 v[32:47], v[204:207], v[96:99], v[32:47]
ds_read_b128 v[112:115], v23 offset:32768
ds_read_b128 v[116:119], v23 offset:36864
s_waitcnt lgkmcnt(4)
v_mfma_f32_32x32x16_bf16 v[48:63], v[204:207], v[100:103], v[48:63]
ds_read_b128 v[120:123], v23 offset:40960
ds_read_b128 v[124:127], v23 offset:45056
s_waitcnt lgkmcnt(5)
v_mfma_f32_32x32x16_bf16 v[64:79], v[204:207], v[104:107], v[64:79]
buffer_load_dwordx4 v246, s[52:55], s62 offen offset:2048 lds
s_waitcnt lgkmcnt(4)
v_mfma_f32_32x32x16_bf16 v[80:95], v[204:207], v[108:111], v[80:95]
buffer_load_dwordx4 v[204:207], v2, s[40:43], s63 offen offset:2048 sc1
ds_read_b128 v[8:11], v12
s_waitcnt vmcnt(42) lgkmcnt(0)
L_ck65:
v_min3_u32 v15, v8, v9, v10
v_min_u32 v15, v15, v11
s_nop 0
v_readfirstlane_b32 s60, v15
s_nop 0
s_cmp_ge_u32 s60, 8
s_cbranch_scc1 L_ckd66
ds_read_b128 v[8:11], v12 offset:0
s_waitcnt lgkmcnt(0)
s_branch L_ck65
L_ckd66:
v_mfma_f32_32x32x16_bf16 v[32:47], v[208:211], v[112:115], v[32:47]
ds_read_b128 v[96:99], v20 offset:49152
ds_read_b128 v[100:103], v20 offset:53248
v_mfma_f32_32x32x16_bf16 v[48:63], v[208:211], v[116:119], v[48:63]
ds_read_b128 v[104:107], v20 offset:57344
ds_read_b128 v[108:111], v20 offset:61440
v_mfma_f32_32x32x16_bf16 v[64:79], v[208:211], v[120:123], v[64:79]
buffer_load_dwordx4 v247, s[52:55], s62 offen offset:3072 lds
v_mfma_f32_32x32x16_bf16 v[80:95], v[208:211], v[124:127], v[80:95]
buffer_load_dwordx4 v[208:211], v2, s[40:43], s63 offen offset:3072 sc1
s_waitcnt vmcnt(42) lgkmcnt(3)
v_mfma_f32_32x32x16_bf16 v[32:47], v[212:215], v[96:99], v[32:47]
ds_read_b128 v[112:115], v21 offset:49152
ds_read_b128 v[116:119], v21 offset:53248
s_waitcnt lgkmcnt(4)
v_mfma_f32_32x32x16_bf16 v[48:63], v[212:215], v[100:103], v[48:63]
ds_read_b128 v[120:123], v21 offset:57344
ds_read_b128 v[124:127], v21 offset:61440
s_waitcnt lgkmcnt(5)
v_mfma_f32_32x32x16_bf16 v[64:79], v[212:215], v[104:107], v[64:79]
s_add_u32 m0, s67, 0
s_add_u32 s62, s64, 896
s_and_b32 s62, s62, 0x3ff
buffer_load_dwordx4 v244, s[48:51], s62 offen offset:0 lds
s_waitcnt lgkmcnt(4)
v_mfma_f32_32x32x16_bf16 v[80:95], v[212:215], v[108:111], v[80:95]
s_waitcnt vmcnt(42) lgkmcnt(3)
v_mfma_f32_32x32x16_bf16 v[32:47], v[216:219], v[112:115], v[32:47]
ds_read_b128 v[96:99], v22 offset:49152
ds_read_b128 v[100:103], v22 offset:53248
s_waitcnt lgkmcnt(4)
v_mfma_f32_32x32x16_bf16 v[48:63], v[216:219], v[116:119], v[48:63]
ds_read_b128 v[104:107], v22 offset:57344
ds_read_b128 v[108:111], v22 offset:61440
s_waitcnt lgkmcnt(5)
v_mfma_f32_32x32x16_bf16 v[64:79], v[216:219], v[120:123], v[64:79]
buffer_load_dwordx4 v245, s[48:51], s62 offen offset:1024 lds
s_waitcnt lgkmcnt(4)
v_mfma_f32_32x32x16_bf16 v[80:95], v[216:219], v[124:127], v[80:95]
s_waitcnt vmcnt(41) lgkmcnt(3)
v_mfma_f32_32x32x16_bf16 v[32:47], v[220:223], v[96:99], v[32:47]
ds_read_b128 v[112:115], v23 offset:49152
ds_read_b128 v[116:119], v23 offset:53248
s_waitcnt lgkmcnt(4)
v_mfma_f32_32x32x16_bf16 v[48:63], v[220:223], v[100:103], v[48:63]
ds_read_b128 v[120:123], v23 offset:57344
ds_read_b128 v[124:127], v23 offset:61440
s_waitcnt lgkmcnt(5)
v_mfma_f32_32x32x16_bf16 v[64:79], v[220:223], v[104:107], v[64:79]
buffer_load_dwordx4 v246, s[48:51], s62 offen offset:2048 lds
s_waitcnt lgkmcnt(4)
v_mfma_f32_32x32x16_bf16 v[80:95], v[220:223], v[108:111], v[80:95]
s_waitcnt vmcnt(41) lgkmcnt(3)
v_mfma_f32_32x32x16_bf16 v[32:47], v[224:227], v[112:115], v[32:47]
ds_read_b128 v[96:99], v24 offset:0
ds_read_b128 v[100:103], v24 offset:4096
s_waitcnt lgkmcnt(4)
v_mfma_f32_32x32x16_bf16 v[48:63], v[224:227], v[116:119], v[48:63]
ds_read_b128 v[104:107], v24 offset:8192
ds_read_b128 v[108:111], v24 offset:12288
s_waitcnt lgkmcnt(5)
v_mfma_f32_32x32x16_bf16 v[64:79], v[224:227], v[120:123], v[64:79]
buffer_load_dwordx4 v247, s[48:51], s62 offen offset:3072 lds
s_waitcnt lgkmcnt(4)
v_mfma_f32_32x32x16_bf16 v[80:95], v[224:227], v[124:127], v[80:95]
s_waitcnt vmcnt(5) lgkmcnt(3)
v_mov_b32 v14, 9
s_mov_b64 exec, 1
ds_write_b32 v13, v14
s_mov_b64 exec, -1
v_mfma_f32_32x32x16_bf16 v[32:47], v[228:231], v[96:99], v[32:47]
ds_read_b128 v[112:115], v25 offset:0
ds_read_b128 v[116:119], v25 offset:4096
s_waitcnt lgkmcnt(5)
v_mfma_f32_32x32x16_bf16 v[48:63], v[228:231], v[100:103], v[48:63]
ds_read_b128 v[120:123], v25 offset:8192
ds_read_b128 v[124:127], v25 offset:12288
s_waitcnt lgkmcnt(6)
v_mfma_f32_32x32x16_bf16 v[64:79], v[228:231], v[104:107], v[64:79]
s_add_u32 m0, s67, 16384
s_nop 0
buffer_load_dwordx4 v244, s[52:55], s62 offen offset:0 lds
s_waitcnt lgkmcnt(5)
v_mfma_f32_32x32x16_bf16 v[80:95], v[228:231], v[108:111], v[80:95]
s_waitcnt vmcnt(40) lgkmcnt(3)
v_mfma_f32_32x32x16_bf16 v[32:47], v[232:235], v[112:115], v[32:47]
ds_read_b128 v[96:99], v26 offset:0
ds_read_b128 v[100:103], v26 offset:4096
s_waitcnt lgkmcnt(4)
v_mfma_f32_32x32x16_bf16 v[48:63], v[232:235], v[116:119], v[48:63]
ds_read_b128 v[104:107], v26 offset:8192
ds_read_b128 v[108:111], v26 offset:12288
s_waitcnt lgkmcnt(5)
v_mfma_f32_32x32x16_bf16 v[64:79], v[232:235], v[120:123], v[64:79]
buffer_load_dwordx4 v245, s[52:55], s62 offen offset:1024 lds
s_waitcnt lgkmcnt(4)
v_mfma_f32_32x32x16_bf16 v[80:95], v[232:235], v[124:127], v[80:95]
s_waitcnt vmcnt(39) lgkmcnt(3)
v_mfma_f32_32x32x16_bf16 v[32:47], v[236:239], v[96:99], v[32:47]
ds_read_b128 v[112:115], v27 offset:0
ds_read_b128 v[116:119], v27 offset:4096
s_waitcnt lgkmcnt(4)
v_mfma_f32_32x32x16_bf16 v[48:63], v[236:239], v[100:103], v[48:63]
ds_read_b128 v[120:123], v27 offset:8192
ds_read_b128 v[124:127], v27 offset:12288
s_waitcnt lgkmcnt(5)
v_mfma_f32_32x32x16_bf16 v[64:79], v[236:239], v[104:107], v[64:79]
buffer_load_dwordx4 v246, s[52:55], s62 offen offset:2048 lds
s_waitcnt lgkmcnt(4)
v_mfma_f32_32x32x16_bf16 v[80:95], v[236:239], v[108:111], v[80:95]
ds_read_b128 v[8:11], v12
global_load_dword v31, v30, s[26:27]
s_waitcnt vmcnt(40) lgkmcnt(0)
L_ck67:
v_min3_u32 v15, v8, v9, v10
v_min_u32 v15, v15, v11
s_nop 0
v_readfirstlane_b32 s60, v15
s_nop 0
s_cmp_ge_u32 s60, 9
s_cbranch_scc1 L_ckd68
ds_read_b128 v[8:11], v12 offset:0
s_waitcnt lgkmcnt(0)
s_branch L_ck67
L_ckd68:
v_mfma_f32_32x32x16_bf16 v[32:47], v[240:243], v[112:115], v[32:47]
ds_read_b128 v[96:99], v24 offset:16384
ds_read_b128 v[100:103], v24 offset:20480
v_mfma_f32_32x32x16_bf16 v[48:63], v[240:243], v[116:119], v[48:63]
ds_read_b128 v[104:107], v24 offset:24576
ds_read_b128 v[108:111], v24 offset:28672
v_mfma_f32_32x32x16_bf16 v[64:79], v[240:243], v[120:123], v[64:79]
buffer_load_dwordx4 v247, s[52:55], s62 offen offset:3072 lds
v_mfma_f32_32x32x16_bf16 v[80:95], v[240:243], v[124:127], v[80:95]
s_mov_b32 s60, 0
buffer_load_dword v128, v28, s[56:59], s60 offen offset:0
s_waitcnt vmcnt(40) lgkmcnt(3)
v_mfma_f32_32x32x16_bf16 v[32:47], v[148:151], v[96:99], v[32:47]
ds_read_b128 v[112:115], v25 offset:16384
ds_read_b128 v[116:119], v25 offset:20480
s_waitcnt lgkmcnt(4)
v_mfma_f32_32x32x16_bf16 v[48:63], v[148:151], v[100:103], v[48:63]
ds_read_b128 v[120:123], v25 offset:24576
ds_read_b128 v[124:127], v25 offset:28672
s_waitcnt lgkmcnt(5)
v_mfma_f32_32x32x16_bf16 v[64:79], v[148:151], v[104:107], v[64:79]
s_waitcnt lgkmcnt(4)
v_mfma_f32_32x32x16_bf16 v[80:95], v[148:151], v[108:111], v[80:95]
s_mov_b32 s60, 0
buffer_load_dword v129, v28, s[56:59], s60 offen offset:2048
s_waitcnt vmcnt(39) lgkmcnt(3)
v_mfma_f32_32x32x16_bf16 v[32:47], v[152:155], v[112:115], v[32:47]
ds_read_b128 v[96:99], v26 offset:16384
ds_read_b128 v[100:103], v26 offset:20480
s_waitcnt lgkmcnt(4)
v_mfma_f32_32x32x16_bf16 v[48:63], v[152:155], v[116:119], v[48:63]
ds_read_b128 v[104:107], v26 offset:24576
ds_read_b128 v[108:111], v26 offset:28672
s_waitcnt lgkmcnt(5)
v_mfma_f32_32x32x16_bf16 v[64:79], v[152:155], v[120:123], v[64:79]
s_waitcnt lgkmcnt(4)
v_mfma_f32_32x32x16_bf16 v[80:95], v[152:155], v[124:127], v[80:95]
s_mov_b32 s60, 4096
buffer_load_dword v130, v28, s[56:59], s60 offen offset:0
s_waitcnt vmcnt(38) lgkmcnt(3)
v_mfma_f32_32x32x16_bf16 v[32:47], v[156:159], v[96:99], v[32:47]
ds_read_b128 v[112:115], v27 offset:16384
ds_read_b128 v[116:119], v27 offset:20480
s_waitcnt lgkmcnt(4)
v_mfma_f32_32x32x16_bf16 v[48:63], v[156:159], v[100:103], v[48:63]
ds_read_b128 v[120:123], v27 offset:24576
ds_read_b128 v[124:127], v27 offset:28672
s_waitcnt lgkmcnt(5)
v_mfma_f32_32x32x16_bf16 v[64:79], v[156:159], v[104:107], v[64:79]
s_waitcnt lgkmcnt(4)
v_mfma_f32_32x32x16_bf16 v[80:95], v[156:159], v[108:111], v[80:95]
s_mov_b32 s60, 4096
buffer_load_dword v131, v28, s[56:59], s60 offen offset:2048
s_waitcnt vmcnt(37) lgkmcnt(3)
v_mfma_f32_32x32x16_bf16 v[32:47], v[160:163], v[112:115], v[32:47]
ds_read_b128 v[96:99], v24 offset:32768
ds_read_b128 v[100:103], v24 offset:36864
s_waitcnt lgkmcnt(4)
v_mfma_f32_32x32x16_bf16 v[48:63], v[160:163], v[116:119], v[48:63]
s_waitcnt lgkmcnt(3)
v_mfma_f32_32x32x16_bf16 v[64:79], v[160:163], v[120:123], v[64:79]
s_waitcnt lgkmcnt(2)
v_mfma_f32_32x32x16_bf16 v[80:95], v[160:163], v[124:127], v[80:95]
s_mov_b32 s60, 32768
buffer_load_dword v132, v28, s[56:59], s60 offen offset:0
s_waitcnt vmcnt(5) lgkmcnt(1)
v_mov_b32 v14, 10
s_mov_b64 exec, 1
ds_write_b32 v13, v14
s_mov_b64 exec, -1
v_mfma_f32_32x32x16_bf16 v[32:47], v[164:167], v[96:99], v[32:47]
ds_read_b128 v[112:115], v25 offset:32768
ds_read_b128 v[116:119], v25 offset:36864
s_waitcnt lgkmcnt(3)
v_mfma_f32_32x32x16_bf16 v[48:63], v[164:167], v[100:103], v[48:63]
s_mov_b32 s60, 32768
buffer_load_dword v133, v28, s[56:59], s60 offen offset:2048
s_waitcnt vmcnt(35) lgkmcnt(1)
v_mfma_f32_32x32x16_bf16 v[32:47], v[168:171], v[112:115], v[32:47]
ds_read_b128 v[96:99], v26 offset:32768
ds_read_b128 v[100:103], v26 offset:36864
s_waitcnt lgkmcnt(2)
v_mfma_f32_32x32x16_bf16 v[48:63], v[168:171], v[116:119], v[48:63]
s_mov_b32 s60, 36864
buffer_load_dword v134, v28, s[56:59], s60 offen offset:0
s_waitcnt vmcnt(34) lgkmcnt(1)
v_mfma_f32_32x32x16_bf16 v[32:47], v[172:175], v[96:99], v[32:47]
ds_read_b128 v[112:115], v27 offset:32768
ds_read_b128 v[116:119], v27 offset:36864
s_waitcnt lgkmcnt(2)
v_mfma_f32_32x32x16_bf16 v[48:63], v[172:175], v[100:103], v[48:63]
ds_read_b128 v[8:11], v12
s_mov_b32 s60, 36864
buffer_load_dword v135, v28, s[56:59], s60 offen offset:2048
s_waitcnt vmcnt(33) lgkmcnt(0)
L_ck69:
v_min3_u32 v15, v8, v9, v10
v_min_u32 v15, v15, v11
s_nop 0
v_readfirstlane_b32 s60, v15
s_nop 0
s_cmp_ge_u32 s60, 10
s_cbranch_scc1 L_ckd70
ds_read_b128 v[8:11], v12 offset:0
s_waitcnt lgkmcnt(0)
s_branch L_ck69
L_ckd70:
v_mfma_f32_32x32x16_bf16 v[32:47], v[176:179], v[112:115], v[32:47]
ds_read_b128 v[96:99], v20 offset:0
ds_read_b128 v[100:103], v20 offset:4096
v_mfma_f32_32x32x16_bf16 v[48:63], v[176:179], v[116:119], v[48:63]
s_mov_b32 s60, 65536
buffer_load_dword v136, v28, s[56:59], s60 offen offset:0
s_waitcnt vmcnt(32) lgkmcnt(1)
v_mfma_f32_32x32x16_bf16 v[32:47], v[180:183], v[96:99], v[32:47]
ds_read_b128 v[112:115], v21 offset:0
ds_read_b128 v[116:119], v21 offset:4096
s_waitcnt lgkmcnt(2)
v_mfma_f32_32x32x16_bf16 v[48:63], v[180:183], v[100:103], v[48:63]
s_mov_b32 s60, 65536
buffer_load_dword v137, v28, s[56:59], s60 offen offset:2048
s_waitcnt vmcnt(31) lgkmcnt(1)
v_mfma_f32_32x32x16_bf16 v[32:47], v[184:187], v[112:115], v[32:47]
ds_read_b128 v[96:99], v22 offset:0
ds_read_b128 v[100:103], v22 offset:4096
s_waitcnt lgkmcnt(2)
v_mfma_f32_32x32x16_bf16 v[48:63], v[184:187], v[116:119], v[48:63]
s_mov_b32 s60, 69632
buffer_load_dword v138, v28, s[56:59], s60 offen offset:0
s_waitcnt vmcnt(30) lgkmcnt(1)
v_mfma_f32_32x32x16_bf16 v[32:47], v[188:191], v[96:99], v[32:47]
ds_read_b128 v[112:115], v23 offset:0
ds_read_b128 v[116:119], v23 offset:4096
s_waitcnt lgkmcnt(2)
v_mfma_f32_32x32x16_bf16 v[48:63], v[188:191], v[100:103], v[48:63]
s_mov_b32 s60, 69632
buffer_load_dword v139, v28, s[56:59], s60 offen offset:2048
s_waitcnt vmcnt(29) lgkmcnt(1)
v_mfma_f32_32x32x16_bf16 v[32:47], v[192:195], v[112:115], v[32:47]
ds_read_b128 v[96:99], v20 offset:16384
ds_read_b128 v[100:103], v20 offset:20480
s_waitcnt lgkmcnt(2)
v_mfma_f32_32x32x16_bf16 v[48:63], v[192:195], v[116:119], v[48:63]
s_mov_b32 s60, 98304
buffer_load_dword v140, v28, s[56:59], s60 offen offset:0
s_waitcnt vmcnt(28) lgkmcnt(1)
v_mfma_f32_32x32x16_bf16 v[32:47], v[196:199], v[96:99], v[32:47]
ds_read_b128 v[112:115], v21 offset:16384
ds_read_b128 v[116:119], v21 offset:20480
s_waitcnt lgkmcnt(2)
v_mfma_f32_32x32x16_bf16 v[48:63], v[196:199], v[100:103], v[48:63]
s_mov_b32 s60, 98304
buffer_load_dword v141, v28, s[56:59], s60 offen offset:2048
s_waitcnt vmcnt(27) lgkmcnt(1)
v_mfma_f32_32x32x16_bf16 v[32:47], v[200:203], v[112:115], v[32:47]
ds_read_b128 v[96:99], v22 offset:16384
ds_read_b128 v[100:103], v22 offset:20480
s_waitcnt lgkmcnt(2)
v_mfma_f32_32x32x16_bf16 v[48:63], v[200:203], v[116:119], v[48:63]
s_mov_b32 s60, 102400
buffer_load_dword v142, v28, s[56:59], s60 offen offset:0
s_waitcnt vmcnt(26) lgkmcnt(1)
v_mfma_f32_32x32x16_bf16 v[32:47], v[204:207], v[96:99], v[32:47]
ds_read_b128 v[112:115], v23 offset:16384
ds_read_b128 v[116:119], v23 offset:20480
s_waitcnt lgkmcnt(2)
v_mfma_f32_32x32x16_bf16 v[48:63], v[204:207], v[100:103], v[48:63]
s_mov_b32 s60, 102400
buffer_load_dword v143, v28, s[56:59], s60 offen offset:2048
s_waitcnt vmcnt(25) lgkmcnt(0)
v_mfma_f32_32x32x16_bf16 v[32:47], v[208:211], v[112:115], v[32:47]
v_mfma_f32_32x32x16_bf16 v[48:63], v[208:211], v[116:119], v[48:63]
s_mul_i32 s60, s37, 0x9e3779b1
s_and_b32 s60, s60, 0xbfff0000
s_or_b32 s60, s60, 0x20000000
s_lshl_b32 s64, s35, 4
s_add_u32 s64, s64, s36
s_lshl_b32 s64, s64, 2
s_add_u32 s64, s64, s34
s_lshl_b32 s64, s64, 13
s_add_u32 s50, s64, 33554432
s_add_u32 s48, s32, s50
s_addc_u32 s49, s33, 0
s_mov_b32 s50, 8192
s_mov_b32 s51, 0x20000
s_xor_b32 s64, s64, 262144
s_add_u32 s54, s64, 33554432
s_add_u32 s52, s32, s54
s_addc_u32 s53, s33, 0
s_mov_b32 s54, 8192
s_mov_b32 s55, 0x20000
s_movk_i32 s64, 0x1000
v_cvt_pk_bf16_f32 v96, v32, v48
v_cvt_pk_bf16_f32 v97, v33, v49
v_cvt_pk_bf16_f32 v98, v34, v50
v_cvt_pk_bf16_f32 v99, v35, s60
buffer_store_dwordx4 v[96:99], v2, s[48:51], 0 offen offset:0 sc1
v_cvt_pk_bf16_f32 v100, v51, v36
v_cvt_pk_bf16_f32 v101, v52, v37
v_cvt_pk_bf16_f32 v102, v53, v38
v_cvt_pk_bf16_f32 v103, v54, s60
buffer_store_dwordx4 v[100:103], v2, s[48:51], 0 offen offset:1024 sc1
v_cvt_pk_bf16_f32 v244, v39, v55
v_cvt_pk_bf16_f32 v245, v40, v56
v_cvt_pk_bf16_f32 v246, v41, v57
v_cvt_pk_bf16_f32 v247, v42, s60
buffer_store_dwordx4 v[244:247], v2, s[48:51], 0 offen offset:2048 sc1
v_cvt_pk_bf16_f32 v248, v58, v43
v_cvt_pk_bf16_f32 v249, v59, v44
v_cvt_pk_bf16_f32 v250, v60, v45
v_cvt_pk_bf16_f32 v251, v61, s60
buffer_store_dwordx4 v[248:251], v2, s[48:51], 0 offen offset:3072 sc1
v_cvt_pk_bf16_f32 v252, v46, v62
v_cvt_pk_bf16_f32 v253, v47, v63
v_cvt_pk_bf16_f32 v254, v63, v63
v_cvt_pk_bf16_f32 v255, v63, s60
buffer_store_dwordx4 v[252:255], v2, s[48:51], s64 offen offset:0 sc1
ds_read_b128 v[104:107], v24 offset:40960
ds_read_b128 v[108:111], v24 offset:45056
ds_read_b128 v[120:123], v25 offset:40960
ds_read_b128 v[124:127], v25 offset:45056
s_waitcnt lgkmcnt(2)
v_mfma_f32_32x32x16_bf16 v[64:79], v[164:167], v[104:107], v[64:79]
v_mfma_f32_32x32x16_bf16 v[80:95], v[164:167], v[108:111], v[80:95]
ds_read_b128 v[104:107], v26 offset:40960
ds_read_b128 v[108:111], v26 offset:45056
s_waitcnt lgkmcnt(2)
v_mfma_f32_32x32x16_bf16 v[64:79], v[168:171], v[120:123], v[64:79]
v_mfma_f32_32x32x16_bf16 v[80:95], v[168:171], v[124:127], v[80:95]
ds_read_b128 v[120:123], v27 offset:40960
ds_read_b128 v[124:127], v27 offset:45056
s_waitcnt lgkmcnt(2)
v_mfma_f32_32x32x16_bf16 v[64:79], v[172:175], v[104:107], v[64:79]
v_mfma_f32_32x32x16_bf16 v[80:95], v[172:175], v[108:111], v[80:95]
ds_read_b128 v[104:107], v20 offset:8192
ds_read_b128 v[108:111], v20 offset:12288
s_waitcnt lgkmcnt(2)
v_mfma_f32_32x32x16_bf16 v[64:79], v[176:179], v[120:123], v[64:79]
v_mfma_f32_32x32x16_bf16 v[80:95], v[176:179], v[124:127], v[80:95]
ds_read_b128 v[120:123], v21 offset:8192
ds_read_b128 v[124:127], v21 offset:12288
s_waitcnt lgkmcnt(2)
v_mfma_f32_32x32x16_bf16 v[64:79], v[180:183], v[104:107], v[64:79]
v_mfma_f32_32x32x16_bf16 v[80:95], v[180:183], v[108:111], v[80:95]
ds_read_b128 v[104:107], v22 offset:8192
ds_read_b128 v[108:111], v22 offset:12288
s_waitcnt lgkmcnt(2)
v_mfma_f32_32x32x16_bf16 v[64:79], v[184:187], v[120:123], v[64:79]
v_mfma_f32_32x32x16_bf16 v[80:95], v[184:187], v[124:127], v[80:95]
ds_read_b128 v[120:123], v23 offset:8192
ds_read_b128 v[124:127], v23 offset:12288
s_waitcnt lgkmcnt(2)
v_mfma_f32_32x32x16_bf16 v[64:79], v[188:191], v[104:107], v[64:79]
v_mfma_f32_32x32x16_bf16 v[80:95], v[188:191], v[108:111], v[80:95]
ds_read_b128 v[104:107], v20 offset:24576
ds_read_b128 v[108:111], v20 offset:28672
s_waitcnt lgkmcnt(2)
v_mfma_f32_32x32x16_bf16 v[64:79], v[192:195], v[120:123], v[64:79]
v_mfma_f32_32x32x16_bf16 v[80:95], v[192:195], v[124:127], v[80:95]
ds_read_b128 v[120:123], v21 offset:24576
ds_read_b128 v[124:127], v21 offset:28672
s_waitcnt lgkmcnt(2)
v_mfma_f32_32x32x16_bf16 v[64:79], v[196:199], v[104:107], v[64:79]
v_mfma_f32_32x32x16_bf16 v[80:95], v[196:199], v[108:111], v[80:95]
ds_read_b128 v[104:107], v22 offset:24576
ds_read_b128 v[108:111], v22 offset:28672
s_waitcnt lgkmcnt(2)
v_mfma_f32_32x32x16_bf16 v[64:79], v[200:203], v[120:123], v[64:79]
v_mfma_f32_32x32x16_bf16 v[80:95], v[200:203], v[124:127], v[80:95]
ds_read_b128 v[120:123], v23 offset:24576
ds_read_b128 v[124:127], v23 offset:28672
s_waitcnt lgkmcnt(2)
v_mfma_f32_32x32x16_bf16 v[64:79], v[204:207], v[104:107], v[64:79]
v_mfma_f32_32x32x16_bf16 v[80:95], v[204:207], v[108:111], v[80:95]
s_waitcnt lgkmcnt(0)
v_mfma_f32_32x32x16_bf16 v[64:79], v[208:211], v[120:123], v[64:79]
v_mfma_f32_32x32x16_bf16 v[80:95], v[208:211], v[124:127], v[80:95]
s_waitcnt vmcnt(5)
v_lshlrev_b32 v8, 16, v31
v_and_b32 v9, 0xffff0000, v31
v_lshlrev_b32 v148, 16, v128
v_and_b32 v149, 0xffff0000, v128
v_pk_mul_f32 v[148:149], v[148:149], v[8:9]
v_cvt_pk_bf16_f32 v10, v148, v149
v_lshlrev_b32 v148, 16, v10
v_and_b32 v149, 0xffff0000, v10
s_nop 1
v_add_f32 v148, v148, v64
v_add_f32 v149, v149, v80
v_lshlrev_b32 v150, 16, v129
v_and_b32 v151, 0xffff0000, v129
v_pk_mul_f32 v[150:151], v[150:151], v[8:9]
v_cvt_pk_bf16_f32 v10, v150, v151
v_lshlrev_b32 v150, 16, v10
v_and_b32 v151, 0xffff0000, v10
v_add_f32 v150, v150, v65
v_add_f32 v151, v151, v81
v_lshlrev_b32 v152, 16, v130
v_and_b32 v153, 0xffff0000, v130
v_pk_mul_f32 v[152:153], v[152:153], v[8:9]
v_cvt_pk_bf16_f32 v10, v152, v153
v_lshlrev_b32 v152, 16, v10
v_and_b32 v153, 0xffff0000, v10
v_add_f32 v152, v152, v66
v_add_f32 v153, v153, v82
v_lshlrev_b32 v154, 16, v131
v_and_b32 v155, 0xffff0000, v131
v_pk_mul_f32 v[154:155], v[154:155], v[8:9]
v_cvt_pk_bf16_f32 v10, v154, v155
v_lshlrev_b32 v154, 16, v10
v_and_b32 v155, 0xffff0000, v10
v_add_f32 v154, v154, v67
v_add_f32 v155, v155, v83
v_lshlrev_b32 v156, 16, v132
v_and_b32 v157, 0xffff0000, v132
v_pk_mul_f32 v[156:157], v[156:157], v[8:9]
v_cvt_pk_bf16_f32 v10, v156, v157
v_lshlrev_b32 v156, 16, v10
v_and_b32 v157, 0xffff0000, v10
v_add_f32 v156, v156, v68
v_add_f32 v157, v157, v84
v_lshlrev_b32 v158, 16, v133
v_and_b32 v159, 0xffff0000, v133
v_pk_mul_f32 v[158:159], v[158:159], v[8:9]
v_cvt_pk_bf16_f32 v10, v158, v159
v_lshlrev_b32 v158, 16, v10
v_and_b32 v159, 0xffff0000, v10
v_add_f32 v158, v158, v69
v_add_f32 v159, v159, v85
v_lshlrev_b32 v160, 16, v134
v_and_b32 v161, 0xffff0000, v134
v_pk_mul_f32 v[160:161], v[160:161], v[8:9]
v_cvt_pk_bf16_f32 v10, v160, v161
v_lshlrev_b32 v160, 16, v10
v_and_b32 v161, 0xffff0000, v10
v_add_f32 v160, v160, v70
v_add_f32 v161, v161, v86
v_lshlrev_b32 v162, 16, v135
v_and_b32 v163, 0xffff0000, v135
v_pk_mul_f32 v[162:163], v[162:163], v[8:9]
v_cvt_pk_bf16_f32 v10, v162, v163
v_lshlrev_b32 v162, 16, v10
v_and_b32 v163, 0xffff0000, v10
v_add_f32 v162, v162, v71
v_add_f32 v163, v163, v87
v_lshlrev_b32 v164, 16, v136
v_and_b32 v165, 0xffff0000, v136
v_pk_mul_f32 v[164:165], v[164:165], v[8:9]
v_cvt_pk_bf16_f32 v10, v164, v165
v_lshlrev_b32 v164, 16, v10
v_and_b32 v165, 0xffff0000, v10
v_add_f32 v164, v164, v72
v_add_f32 v165, v165, v88
v_lshlrev_b32 v166, 16, v137
v_and_b32 v167, 0xffff0000, v137
v_pk_mul_f32 v[166:167], v[166:167], v[8:9]
v_cvt_pk_bf16_f32 v10, v166, v167
v_lshlrev_b32 v166, 16, v10
v_and_b32 v167, 0xffff0000, v10
v_add_f32 v166, v166, v73
v_add_f32 v167, v167, v89
v_lshlrev_b32 v168, 16, v138
v_and_b32 v169, 0xffff0000, v138
v_pk_mul_f32 v[168:169], v[168:169], v[8:9]
v_cvt_pk_bf16_f32 v10, v168, v169
v_lshlrev_b32 v168, 16, v10
v_and_b32 v169, 0xffff0000, v10
v_add_f32 v168, v168, v74
v_add_f32 v169, v169, v90
v_lshlrev_b32 v170, 16, v139
v_and_b32 v171, 0xffff0000, v139
v_pk_mul_f32 v[170:171], v[170:171], v[8:9]
v_cvt_pk_bf16_f32 v10, v170, v171
v_lshlrev_b32 v170, 16, v10
v_and_b32 v171, 0xffff0000, v10
v_add_f32 v170, v170, v75
v_add_f32 v171, v171, v91
v_lshlrev_b32 v172, 16, v140
v_and_b32 v173, 0xffff0000, v140
v_pk_mul_f32 v[172:173], v[172:173], v[8:9]
v_cvt_pk_bf16_f32 v10, v172, v173
v_lshlrev_b32 v172, 16, v10
v_and_b32 v173, 0xffff0000, v10
v_add_f32 v172, v172, v76
v_add_f32 v173, v173, v92
v_lshlrev_b32 v174, 16, v141
v_and_b32 v175, 0xffff0000, v141
v_pk_mul_f32 v[174:175], v[174:175], v[8:9]
v_cvt_pk_bf16_f32 v10, v174, v175
v_lshlrev_b32 v174, 16, v10
v_and_b32 v175, 0xffff0000, v10
v_add_f32 v174, v174, v77
v_add_f32 v175, v175, v93
v_lshlrev_b32 v176, 16, v142
v_and_b32 v177, 0xffff0000, v142
v_pk_mul_f32 v[176:177], v[176:177], v[8:9]
v_cvt_pk_bf16_f32 v10, v176, v177
v_lshlrev_b32 v176, 16, v10
v_and_b32 v177, 0xffff0000, v10
v_add_f32 v176, v176, v78
v_add_f32 v177, v177, v94
v_lshlrev_b32 v178, 16, v143
v_and_b32 v179, 0xffff0000, v143
v_pk_mul_f32 v[178:179], v[178:179], v[8:9]
v_cvt_pk_bf16_f32 v10, v178, v179
v_lshlrev_b32 v178, 16, v10
v_and_b32 v179, 0xffff0000, v10
v_add_f32 v178, v178, v79
v_add_f32 v179, v179, v95
s_mov_b32 s44, s28
s_mov_b32 s45, s29
s_mov_b32 s46, s24
s_mov_b32 s47, 0x20000
s_mov_b32 s92, 0
s_waitcnt vmcnt(0)
buffer_load_dwordx4 v[180:183], v2, s[52:55], 0 offen offset:0 sc1
buffer_load_dwordx4 v[184:187], v2, s[52:55], 0 offen offset:1024 sc1
buffer_load_dwordx4 v[188:191], v2, s[52:55], 0 offen offset:2048 sc1
buffer_load_dwordx4 v[192:195], v2, s[52:55], 0 offen offset:3072 sc1
buffer_load_dwordx4 v[196:199], v2, s[52:55], s64 offen offset:0 sc1
L_xl71:
v_mov_b32 v10, 0
s_waitcnt vmcnt(4)
v_bitop3_b32 v10, v10, v183, s60 bitop3:0xf6
s_waitcnt vmcnt(3)
v_bitop3_b32 v10, v10, v187, s60 bitop3:0xf6
s_waitcnt vmcnt(2)
v_bitop3_b32 v10, v10, v191, s60 bitop3:0xf6
s_waitcnt vmcnt(1)
v_bitop3_b32 v10, v10, v195, s60 bitop3:0xf6
s_waitcnt vmcnt(0)
v_bitop3_b32 v10, v10, v199, s60 bitop3:0xf6
v_cmp_lt_u32 vcc, 0xffff, v10
s_nop 0
s_cbranch_vccz L_xd72
s_add_u32 s92, s92, 1
s_cmp_ge_u32 s92, 200000
s_cbranch_scc1 L_xd72
buffer_load_dwordx4 v[180:183], v2, s[52:55], 0 offen offset:0 sc1
buffer_load_dwordx4 v[184:187], v2, s[52:55], 0 offen offset:1024 sc1
buffer_load_dwordx4 v[188:191], v2, s[52:55], 0 offen offset:2048 sc1
buffer_load_dwordx4 v[192:195], v2, s[52:55], 0 offen offset:3072 sc1
buffer_load_dwordx4 v[196:199], v2, s[52:55], s64 offen offset:0 sc1
s_branch L_xl71
L_xd72:
v_lshlrev_b32 v10, 16, v180
v_and_b32 v11, 0xffff0000, v180
v_pk_add_f32 v[148:149], v[148:149], v[10:11]
s_mov_b32 s64, 0
buffer_store_dwordx2 v[148:149], v29, s[44:47], s64 offen nt
v_lshlrev_b32 v10, 16, v181
v_and_b32 v11, 0xffff0000, v181
v_pk_add_f32 v[150:151], v[150:151], v[10:11]
s_mov_b32 s64, 8192
buffer_store_dwordx2 v[150:151], v29, s[44:47], s64 offen nt
v_lshlrev_b32 v10, 16, v182
v_and_b32 v11, 0xffff0000, v182
v_pk_add_f32 v[152:153], v[152:153], v[10:11]
s_mov_b32 s64, 16384
buffer_store_dwordx2 v[152:153], v29, s[44:47], s64 offen nt
v_lshlrev_b32 v10, 16, v183
v_lshlrev_b32 v11, 16, v184
v_pk_add_f32 v[154:155], v[154:155], v[10:11]
s_mov_b32 s64, 24576
buffer_store_dwordx2 v[154:155], v29, s[44:47], s64 offen nt
v_and_b32 v10, 0xffff0000, v184
v_lshlrev_b32 v11, 16, v185
v_pk_add_f32 v[156:157], v[156:157], v[10:11]
s_mov_b32 s64, 131072
buffer_store_dwordx2 v[156:157], v29, s[44:47], s64 offen nt
v_and_b32 v10, 0xffff0000, v185
v_lshlrev_b32 v11, 16, v186
v_pk_add_f32 v[158:159], v[158:159], v[10:11]
s_mov_b32 s64, 139264
buffer_store_dwordx2 v[158:159], v29, s[44:47], s64 offen nt
v_and_b32 v10, 0xffff0000, v186
v_lshlrev_b32 v11, 16, v187
v_pk_add_f32 v[160:161], v[160:161], v[10:11]
s_mov_b32 s64, 147456
buffer_store_dwordx2 v[160:161], v29, s[44:47], s64 offen nt
v_lshlrev_b32 v10, 16, v188
v_and_b32 v11, 0xffff0000, v188
v_pk_add_f32 v[162:163], v[162:163], v[10:11]
s_mov_b32 s64, 155648
buffer_store_dwordx2 v[162:163], v29, s[44:47], s64 offen nt
v_lshlrev_b32 v10, 16, v189
v_and_b32 v11, 0xffff0000, v189
v_pk_add_f32 v[164:165], v[164:165], v[10:11]
s_mov_b32 s64, 262144
buffer_store_dwordx2 v[164:165], v29, s[44:47], s64 offen nt
v_lshlrev_b32 v10, 16, v190
v_and_b32 v11, 0xffff0000, v190
v_pk_add_f32 v[166:167], v[166:167], v[10:11]
s_mov_b32 s64, 270336
buffer_store_dwordx2 v[166:167], v29, s[44:47], s64 offen nt
v_lshlrev_b32 v10, 16, v191
v_lshlrev_b32 v11, 16, v192
v_pk_add_f32 v[168:169], v[168:169], v[10:11]
s_mov_b32 s64, 278528
buffer_store_dwordx2 v[168:169], v29, s[44:47], s64 offen nt
v_and_b32 v10, 0xffff0000, v192
v_lshlrev_b32 v11, 16, v193
v_pk_add_f32 v[170:171], v[170:171], v[10:11]
s_mov_b32 s64, 286720
buffer_store_dwordx2 v[170:171], v29, s[44:47], s64 offen nt
v_and_b32 v10, 0xffff0000, v193
v_lshlrev_b32 v11, 16, v194
v_pk_add_f32 v[172:173], v[172:173], v[10:11]
s_mov_b32 s64, 393216
buffer_store_dwordx2 v[172:173], v29, s[44:47], s64 offen nt
v_and_b32 v10, 0xffff0000, v194
v_lshlrev_b32 v11, 16, v195
v_pk_add_f32 v[174:175], v[174:175], v[10:11]
s_mov_b32 s64, 401408
buffer_store_dwordx2 v[174:175], v29, s[44:47], s64 offen nt
v_lshlrev_b32 v10, 16, v196
v_and_b32 v11, 0xffff0000, v196
v_pk_add_f32 v[176:177], v[176:177], v[10:11]
s_mov_b32 s64, 409600
buffer_store_dwordx2 v[176:177], v29, s[44:47], s64 offen nt
v_lshlrev_b32 v10, 16, v197
v_and_b32 v11, 0xffff0000, v197
v_pk_add_f32 v[178:179], v[178:179], v[10:11]
s_mov_b32 s64, 417792
buffer_store_dwordx2 v[178:179], v29, s[44:47], s64 offen nt
L_concat_heads__spectral_gfnet__ssm_conv_s5__prompt_kernel_end:
s_endpgm

.section .rodata,"a"
.p2align 6
.amdhsa_kernel concat_heads__spectral_gfnet__ssm_conv_s5__prompt_kernel
  .amdhsa_next_free_vgpr 256
  .amdhsa_next_free_sgpr 102
  .amdhsa_accum_offset 256
  .amdhsa_group_segment_fixed_size 0
  .amdhsa_kernarg_size 120
  .amdhsa_user_sgpr_count 2
  .amdhsa_user_sgpr_kernarg_segment_ptr 1
  .amdhsa_system_sgpr_workgroup_id_x 1
.end_amdhsa_kernel
.text
```

```asm
; @launch grid=(256,1,1) block=(512,1,1) lds=163840
.amdgcn_target "amdgcn-amd-amdhsa--gfx950"
.text
.globl concat_heads__spectral_gfnet__ssm_conv_s5__prompt_kernel
.p2align 8
.type concat_heads__spectral_gfnet__ssm_conv_s5__prompt_kernel,@function
concat_heads__spectral_gfnet__ssm_conv_s5__prompt_kernel:
s_cmp_ge_u32 s2, 256
s_cbranch_scc1 L_concat_heads__spectral_gfnet__ssm_conv_s5__prompt_kernel_end
s_load_dwordx16 s[4:19], s[0:1], 0
s_load_dwordx8 s[20:27], s[0:1], 64
s_load_dwordx4 s[28:31], s[0:1], 96
s_load_dwordx2 s[32:33], s[0:1], 112
v_lshrrev_b32 v2, 6, v0
v_and_b32 v1, 63, v0
v_readfirstlane_b32 s34, v2
s_and_b32 s60, s2, 7
s_lshr_b32 s61, s2, 3
s_lshr_b32 s35, s60, 1
s_lshl_b32 s35, s35, 2
s_lshr_b32 s62, s61, 3
s_add_u32 s35, s35, s62
s_and_b32 s36, s60, 1
s_lshl_b32 s36, s36, 3
s_and_b32 s62, s61, 7
s_add_u32 s36, s36, s62
s_cmp_ge_u32 s34, 4
s_cbranch_scc0 L_concat_heads__spectral_gfnet__ssm_conv_s5__prompt_kernel_gemm
s_sub_u32 s66, s34, 4
v_lshrrev_b32 v2, 5, v1
v_bfe_u32 v3, v1, 3, 2
v_and_b32 v4, 1, v3
v_lshrrev_b32 v5, 1, v3
v_lshlrev_b32 v6, 5, v2
v_lshl_add_u32 v6, v4, 4, v6
v_add_u32 v6, v6, v5
s_lshr_b32 s60, s66, 1
s_lshl_b32 s61, s60, 6
s_and_b32 s62, s66, 1
s_lshl_b32 s62, s62, 3
s_add_u32 s61, s61, s62
v_add_u32 v6, s61, v6
v_lshlrev_b32 v6, 11, v6
s_lshl_b32 s61, s60, 5
v_lshl_add_u32 v7, v2, 3, v3
v_add_u32 v7, s61, v7
v_lshlrev_b32 v7, 11, v7
v_and_b32 v4, 7, v1
v_lshrrev_b32 v5, 4, v1
v_xor_b32 v4, v4, v5
v_lshlrev_b32 v4, 4, v4
v_xor_b32 v5, 64, v4
v_add_u32 v176, v6, v4
v_add_u32 v180, v7, v4
v_add_u32 v177, v6, v5
v_add_u32 v177, 3072, v177
v_add_u32 v181, v7, v5
v_add_u32 v181, 7168, v181
v_add_u32 v178, v6, v4
v_add_u32 v178, 6144, v178
v_add_u32 v182, v7, v4
v_add_u32 v182, 30720, v182
v_add_u32 v179, v6, v5
v_add_u32 v179, 9216, v179
v_add_u32 v183, v7, v5
v_add_u32 v183, 37888, v183
s_and_b32 s64, s2, 7
s_mul_i32 s64, s64, 0
s_add_u32 s60, s35, s36
s_and_b32 s60, s60, 0
s_mul_i32 s60, s60, 2048
s_add_u32 s64, s64, s60
s_mul_i32 s60, s35, 128
s_add_u32 s64, s64, s60
s_mul_i32 s60, s36, 128
s_add_u32 s64, s64, s60
s_lshl_b32 s60, s35, 18
s_lshl_b32 s61, s36, 17
s_waitcnt lgkmcnt(0)
s_lshl_b32 s25, s66, 12
s_mov_b32 s24, s64
s_add_u32 s12, s10, s60
s_addc_u32 s13, s11, 0
s_mov_b32 s14, 262144
s_mov_b32 s15, 0x20000
s_bitcmp1_b32 s66, 0
s_cselect_b32 s62, s18, s16
s_cselect_b32 s63, s19, s17
s_cselect_b32 s100, s22, s20
s_cselect_b32 s101, s23, s21
s_add_u32 s20, s62, s61
s_addc_u32 s21, s63, 0
s_mov_b32 s22, 131072
s_mov_b32 s23, 0x20000
s_add_u32 m0, s25, 0
s_add_u32 s26, s24, 0
s_and_b32 s26, s26, 0x7ff
buffer_load_dwordx4 v176, s[12:15], s26 offen offset:0 lds
buffer_load_dwordx4 v177, s[12:15], s26 offen offset:1024 lds
buffer_load_dwordx4 v178, s[12:15], s26 offen offset:2048 lds
buffer_load_dwordx4 v179, s[12:15], s26 offen offset:3072 lds
s_add_u32 m0, s25, 16384
s_nop 0
buffer_load_dwordx4 v180, s[20:23], s26 offen offset:0 lds
buffer_load_dwordx4 v181, s[20:23], s26 offen offset:1024 lds
buffer_load_dwordx4 v182, s[20:23], s26 offen offset:2048 lds
buffer_load_dwordx4 v183, s[20:23], s26 offen offset:3072 lds
s_setprio 3
s_mov_b32 s48, s6
s_mov_b32 s49, s7
s_mov_b32 s50, 2101248
s_mov_b32 s51, 0x20000
s_mov_b32 s52, s8
s_mov_b32 s53, s9
s_mov_b32 s54, 2101248
s_mov_b32 s55, 0x20000
s_and_b32 s60, s2, 31
s_lshr_b32 s61, s2, 5
s_lshl_b32 s61, s61, 7
s_add_u32 s60, s60, s61
s_lshl_b32 s61, s66, 5
s_add_u32 s67, s60, s61
s_lshl_b32 s60, s67, 12
s_add_u32 s4, s4, s60
s_addc_u32 s5, s5, 0
s_mov_b32 s6, 4096
s_mov_b32 s7, 0x20000
v_lshlrev_b32 v2, 4, v1
v_xor_b32 v3, 128, v2
s_lshl_b32 s68, s66, 12
s_add_u32 s68, s68, 131072
s_and_b32 s60, s2, 7
s_bfe_u32 s61, s2, 0x10003
s_bfe_u32 s62, s2, 0x20004
s_lshr_b32 s63, s2, 6
s_lshr_b32 s64, s60, 1
s_lshl_b32 s64, s64, 3
s_lshl_b32 s65, s61, 2
s_add_u32 s64, s64, s65
s_and_b32 s65, s60, 1
s_lshl_b32 s65, s65, 1
s_add_u32 s64, s64, s65
s_lshl_b32 s64, s64, 5
s_lshl_b32 s65, s62, 3
s_add_u32 s64, s64, s65
s_lshl_b32 s65, s66, 1
s_add_u32 s64, s64, s65
s_mul_i32 s64, s64, 1026
s_lshl_b32 s65, s63, 8
s_add_u32 s69, s64, s65
v_bfe_u32 v8, v1, 4, 1
v_mul_u32_u24 v8, 32832, v8
v_lshrrev_b32 v9, 5, v1
s_mov_b32 s65, 1050624
v_mul_lo_u32 v9, s65, v9
v_add_u32 v8, v8, v9
v_and_b32 v9, 15, v1
s_lshl_b32 s65, s66, 1
v_xor_b32 v9, s65, v9
v_lshl_add_u32 v18, v9, 4, v8
v_xor_b32 v9, 1, v9
v_lshl_add_u32 v19, v9, 4, v8
v_add_u32 v19, 1026, v19
s_bfe_u32 s64, s2, 0x20005
s_lshl_b32 s64, s64, 8
s_bfe_u32 s65, s2, 0x10004
s_lshl_b32 s65, s65, 6
s_add_u32 s64, s64, s65
s_bfe_u32 s65, s2, 0x10003
s_lshl_b32 s65, s65, 7
s_add_u32 s64, s64, s65
s_and_b32 s65, s2, 7
s_lshl_b32 s65, s65, 2
s_add_u32 s64, s64, s65
v_bfe_u32 v8, v1, 3, 2
v_add_u32 v8, s64, v8
v_bfe_u32 v9, v1, 2, 1
v_lshl_add_u32 v8, v9, 5, v8
v_bfe_u32 v9, v1, 1, 1
v_lshl_add_u32 v8, v9, 10, v8
v_sub_u32 v9, 2048, v8
v_and_b32 v9, 2047, v9
v_and_b32 v10, 1, v1
v_cmp_eq_u32 vcc, 1, v10
s_nop 1
v_cndmask_b32 v8, v8, v9, vcc
v_mul_u32_u24 v17, 1026, v8
s_lshr_b32 s64, s2, 7
s_lshl_b32 s64, s64, 10
v_add_u32 v17, s64, v17
v_mov_b32 v184, 126992
s_lshl_b32 s64, s66, 2
v_add_u32 v185, s64, v184
v_and_b32 v8, 31, v1
v_lshrrev_b32 v9, 5, v1
v_and_b32 v10, 1, v1
v_lshrrev_b32 v11, 1, v8
v_lshlrev_b32 v4, 6, v11
v_lshl_add_u32 v4, v10, 4, v4
v_lshl_add_u32 v4, v9, 12, v4
v_add_u32 v11, v11, v10
v_lshlrev_b32 v11, 6, v11
v_lshl_add_u32 v11, v10, 4, v11
v_lshl_add_u32 v11, v9, 12, v11
v_sub_u32 v5, 5168, v11
v_bfe_u32 v11, v4, 7, 1
v_lshlrev_b32 v11, 5, v11
v_xor_b32 v4, v4, v11
v_bfe_u32 v11, v5, 7, 1
v_lshlrev_b32 v11, 5, v11
v_xor_b32 v5, v5, v11
v_add_u32 v6, 11264, v5
v_and_b32 v6, 0x3fff, v6
s_add_u32 s64, s64, 98304
v_add_u32 v4, s64, v4
v_add_u32 v5, s64, v5
v_add_u32 v6, s64, v6
v_bfe_u32 v11, v1, 3, 1
v_lshlrev_b32 v11, 5, v11
v_xor_b32 v7, v2, v11
v_bfe_u32 v12, v1, 2, 1
v_mul_u32_u24 v12, 2176, v12
v_bfe_u32 v13, v1, 3, 1
v_lshl_add_u32 v12, v13, 6, v12
v_lshl_add_u32 v12, v9, 8, v12
v_bfe_u32 v13, v1, 4, 1
v_lshl_add_u32 v12, v13, 5, v12
v_and_b32 v13, 3, v1
v_lshl_add_u32 v12, v13, 3, v12
v_add_u32 v12, s68, v12
v_xor_b32 v13, 128, v12
s_lshl_b32 s64, s2, 14
s_lshl_b32 s65, s66, 12
s_add_u32 s64, s64, s65
s_add_u32 s42, s64, 16777216
s_add_u32 s40, s32, s42
s_addc_u32 s41, s33, 0
s_mov_b32 s42, 4096
s_mov_b32 s43, 0x20000
s_add_u32 s46, s64, 16777216
s_add_u32 s44, s32, s46
s_addc_u32 s45, s33, 0
s_mov_b32 s46, 4096
s_mov_b32 s47, 0x20000
v_and_b32 v14, 7, v1
v_lshrrev_b32 v15, 3, v1
v_xor_b32 v16, v14, v15
v_lshlrev_b32 v16, 4, v16
v_lshl_add_u32 v16, v14, 11, v16
s_lshr_b32 s64, s66, 1
s_lshl_b32 s64, s64, 7
s_and_b32 s65, s66, 1
s_lshl_b32 s65, s65, 3
s_add_u32 s64, s64, s65
s_add_u32 s64, s64, 147456
v_add_u32 v16, s64, v16
v_lshlrev_b32 v15, 16, v15
v_lshl_add_u32 v15, v14, 4, v15
s_lshl_b32 s64, s63, 7
s_lshr_b32 s65, s66, 1
s_lshl_b32 s65, s65, 6
s_add_u32 s64, s64, s65
s_and_b32 s65, s66, 1
s_lshl_b32 s65, s65, 2
s_add_u32 s64, s64, s65
s_mul_i32 s64, s64, 8192
s_lshr_b32 s65, s60, 2
s_mul_i32 s65, s65, 0
s_add_u32 s64, s64, s65
s_lshl_b32 s65, s60, 10
s_add_u32 s64, s64, s65
s_lshl_b32 s65, s61, 9
s_add_u32 s64, s64, s65
s_lshl_b32 s65, s62, 7
s_add_u32 s64, s64, s65
s_add_u32 s58, s64, 25182208
s_add_u32 s56, s32, s58
s_addc_u32 s57, s33, 0
s_sub_u32 s58, 4194304, s64
s_mov_b32 s59, 0x20000
v_and_b32 v104, 31, v1
v_cvt_f32_u32 v104, v104
v_lshrrev_b32 v105, 5, v1
v_lshlrev_b32 v105, 2, v105
v_cvt_f32_u32 v105, v105
v_mul_f32 v105, v104, v105
v_mul_f32 v105, 0x3d000000, v105
v_fmamk_f32 v106, v104, 0x0, v105
v_fract_f32 v106, v106
v_cos_f32 v107, v106
v_sin_f32 v108, v106
s_nop 0
v_cvt_pk_bf16_f32 v192, v107, v108
v_cvt_pk_bf16_f32 v208, -v108, v107
v_fmamk_f32 v109, v104, 0x3d000000, v105
v_fract_f32 v109, v109
v_cos_f32 v110, v109
v_sin_f32 v111, v109
s_nop 0
v_cvt_pk_bf16_f32 v193, v110, v111
v_cvt_pk_bf16_f32 v209, -v111, v110
v_fmamk_f32 v106, v104, 0x3d800000, v105
v_fract_f32 v106, v106
v_cos_f32 v107, v106
v_sin_f32 v108, v106
s_nop 0
v_cvt_pk_bf16_f32 v194, v107, v108
v_cvt_pk_bf16_f32 v210, -v108, v107
v_fmamk_f32 v109, v104, 0x3dc00000, v105
v_fract_f32 v109, v109
v_cos_f32 v110, v109
v_sin_f32 v111, v109
s_nop 0
v_cvt_pk_bf16_f32 v195, v110, v111
v_cvt_pk_bf16_f32 v211, -v111, v110
v_fmamk_f32 v106, v104, 0x3e800000, v105
v_fract_f32 v106, v106
v_cos_f32 v107, v106
v_sin_f32 v108, v106
s_nop 0
v_cvt_pk_bf16_f32 v196, v107, v108
v_cvt_pk_bf16_f32 v212, -v108, v107
v_fmamk_f32 v109, v104, 0x3e900000, v105
v_fract_f32 v109, v109
v_cos_f32 v110, v109
v_sin_f32 v111, v109
s_nop 0
v_cvt_pk_bf16_f32 v197, v110, v111
v_cvt_pk_bf16_f32 v213, -v111, v110
v_fmamk_f32 v106, v104, 0x3ea00000, v105
v_fract_f32 v106, v106
v_cos_f32 v107, v106
v_sin_f32 v108, v106
s_nop 0
v_cvt_pk_bf16_f32 v198, v107, v108
v_cvt_pk_bf16_f32 v214, -v108, v107
v_fmamk_f32 v109, v104, 0x3eb00000, v105
v_fract_f32 v109, v109
v_cos_f32 v110, v109
v_sin_f32 v111, v109
s_nop 0
v_cvt_pk_bf16_f32 v199, v110, v111
v_cvt_pk_bf16_f32 v215, -v111, v110
v_fmamk_f32 v106, v104, 0x3f000000, v105
v_fract_f32 v106, v106
v_cos_f32 v107, v106
v_sin_f32 v108, v106
s_nop 0
v_cvt_pk_bf16_f32 v200, v107, v108
v_cvt_pk_bf16_f32 v216, -v108, v107
v_fmamk_f32 v109, v104, 0x3f080000, v105
v_fract_f32 v109, v109
v_cos_f32 v110, v109
v_sin_f32 v111, v109
s_nop 0
v_cvt_pk_bf16_f32 v201, v110, v111
v_cvt_pk_bf16_f32 v217, -v111, v110
v_fmamk_f32 v106, v104, 0x3f100000, v105
v_fract_f32 v106, v106
v_cos_f32 v107, v106
v_sin_f32 v108, v106
s_nop 0
v_cvt_pk_bf16_f32 v202, v107, v108
v_cvt_pk_bf16_f32 v218, -v108, v107
v_fmamk_f32 v109, v104, 0x3f180000, v105
v_fract_f32 v109, v109
v_cos_f32 v110, v109
v_sin_f32 v111, v109
s_nop 0
v_cvt_pk_bf16_f32 v203, v110, v111
v_cvt_pk_bf16_f32 v219, -v111, v110
v_fmamk_f32 v106, v104, 0x3f400000, v105
v_fract_f32 v106, v106
v_cos_f32 v107, v106
v_sin_f32 v108, v106
s_nop 0
v_cvt_pk_bf16_f32 v204, v107, v108
v_cvt_pk_bf16_f32 v220, -v108, v107
v_fmamk_f32 v109, v104, 0x3f480000, v105
v_fract_f32 v109, v109
v_cos_f32 v110, v109
v_sin_f32 v111, v109
s_nop 0
v_cvt_pk_bf16_f32 v205, v110, v111
v_cvt_pk_bf16_f32 v221, -v111, v110
v_fmamk_f32 v106, v104, 0x3f500000, v105
v_fract_f32 v106, v106
v_cos_f32 v107, v106
v_sin_f32 v108, v106
s_nop 0
v_cvt_pk_bf16_f32 v206, v107, v108
v_cvt_pk_bf16_f32 v222, -v108, v107
v_fmamk_f32 v109, v104, 0x3f580000, v105
v_fract_f32 v109, v109
v_cos_f32 v110, v109
v_sin_f32 v111, v109
s_nop 0
v_cvt_pk_bf16_f32 v207, v110, v111
v_cvt_pk_bf16_f32 v223, -v111, v110
v_and_b32 v104, 31, v1
v_cvt_f32_u32 v104, v104
v_lshrrev_b32 v105, 5, v1
v_lshlrev_b32 v105, 2, v105
v_cvt_f32_u32 v105, v105
v_mul_f32 v105, v104, v105
v_mul_f32 v105, 0x3a800000, v105
v_fmamk_f32 v106, v104, 0x0, v105
v_cos_f32 v224, v106
v_sin_f32 v240, -v106
v_fmamk_f32 v107, v104, 0x3a800000, v105
v_cos_f32 v225, v107
v_sin_f32 v241, -v107
v_fmamk_f32 v106, v104, 0x3b000000, v105
v_cos_f32 v226, v106
v_sin_f32 v242, -v106
v_fmamk_f32 v107, v104, 0x3b400000, v105
v_cos_f32 v227, v107
v_sin_f32 v243, -v107
v_fmamk_f32 v106, v104, 0x3c000000, v105
v_cos_f32 v228, v106
v_sin_f32 v244, -v106
v_fmamk_f32 v107, v104, 0x3c100000, v105
v_cos_f32 v229, v107
v_sin_f32 v245, -v107
v_fmamk_f32 v106, v104, 0x3c200000, v105
v_cos_f32 v230, v106
v_sin_f32 v246, -v106
v_fmamk_f32 v107, v104, 0x3c300000, v105
v_cos_f32 v231, v107
v_sin_f32 v247, -v107
v_fmamk_f32 v106, v104, 0x3c800000, v105
v_cos_f32 v232, v106
v_sin_f32 v248, -v106
v_fmamk_f32 v107, v104, 0x3c880000, v105
v_cos_f32 v233, v107
v_sin_f32 v249, -v107
v_fmamk_f32 v106, v104, 0x3c900000, v105
v_cos_f32 v234, v106
v_sin_f32 v250, -v106
v_fmamk_f32 v107, v104, 0x3c980000, v105
v_cos_f32 v235, v107
v_sin_f32 v251, -v107
v_fmamk_f32 v106, v104, 0x3cc00000, v105
v_cos_f32 v236, v106
v_sin_f32 v252, -v106
v_fmamk_f32 v107, v104, 0x3cc80000, v105
v_cos_f32 v237, v107
v_sin_f32 v253, -v107
v_fmamk_f32 v106, v104, 0x3cd00000, v105
v_cos_f32 v238, v106
v_sin_f32 v254, -v106
v_fmamk_f32 v107, v104, 0x3cd80000, v105
v_cos_f32 v239, v107
v_sin_f32 v255, -v107
v_and_b32 v104, 31, v1
v_cvt_f32_u32 v104, v104
v_lshrrev_b32 v105, 5, v1
v_lshlrev_b32 v105, 2, v105
v_cvt_f32_u32 v105, v105
v_mul_f32 v104, 0x3a000000, v104
v_fmamk_f32 v105, v105, 0x3c800000, v104
v_add_f32 v106, 0x0, v105
v_cos_f32 v136, v106
v_sin_f32 v152, -v106
v_add_f32 v107, 0x3c800000, v105
v_cos_f32 v137, v107
v_sin_f32 v153, -v107
v_add_f32 v106, 0x3d000000, v105
v_cos_f32 v138, v106
v_sin_f32 v154, -v106
v_add_f32 v107, 0x3d400000, v105
v_cos_f32 v139, v107
v_sin_f32 v155, -v107
v_add_f32 v106, 0x3e000000, v105
v_cos_f32 v140, v106
v_sin_f32 v156, -v106
v_add_f32 v107, 0x3e100000, v105
v_cos_f32 v141, v107
v_sin_f32 v157, -v107
v_add_f32 v106, 0x3e200000, v105
v_cos_f32 v142, v106
v_sin_f32 v158, -v106
v_add_f32 v107, 0x3e300000, v105
v_cos_f32 v143, v107
v_sin_f32 v159, -v107
v_add_f32 v106, 0x3e800000, v105
v_cos_f32 v144, v106
v_sin_f32 v160, -v106
v_add_f32 v107, 0x3e880000, v105
v_cos_f32 v145, v107
v_sin_f32 v161, -v107
v_add_f32 v106, 0x3e900000, v105
v_cos_f32 v146, v106
v_sin_f32 v162, -v106
v_add_f32 v107, 0x3e980000, v105
v_cos_f32 v147, v107
v_sin_f32 v163, -v107
v_add_f32 v106, 0x3ec00000, v105
v_cos_f32 v148, v106
v_sin_f32 v164, -v106
v_add_f32 v107, 0x3ec80000, v105
v_cos_f32 v149, v107
v_sin_f32 v165, -v107
v_add_f32 v106, 0x3ed00000, v105
v_cos_f32 v150, v106
v_sin_f32 v166, -v106
v_add_f32 v107, 0x3ed80000, v105
v_cos_f32 v151, v107
v_sin_f32 v167, -v107
s_add_u32 m0, s25, 32768
s_add_u32 s26, s24, 128
s_and_b32 s26, s26, 0x7ff
buffer_load_dwordx4 v176, s[12:15], s26 offen offset:0 lds
buffer_load_dwordx4 v177, s[12:15], s26 offen offset:1024 lds
buffer_load_dwordx4 v178, s[12:15], s26 offen offset:2048 lds
buffer_load_dwordx4 v179, s[12:15], s26 offen offset:3072 lds
s_add_u32 m0, s25, 49152
s_nop 0
buffer_load_dwordx4 v180, s[20:23], s26 offen offset:0 lds
buffer_load_dwordx4 v181, s[20:23], s26 offen offset:1024 lds
buffer_load_dwordx4 v182, s[20:23], s26 offen offset:2048 lds
buffer_load_dwordx4 v183, s[20:23], s26 offen offset:3072 lds
s_waitcnt vmcnt(8)
s_barrier
s_add_u32 m0, s25, 65536
s_add_u32 s26, s24, 256
s_and_b32 s26, s26, 0x7ff
buffer_load_dwordx4 v176, s[12:15], s26 offen offset:0 lds
buffer_load_dwordx4 v177, s[12:15], s26 offen offset:1024 lds
buffer_load_dwordx4 v178, s[12:15], s26 offen offset:2048 lds
buffer_load_dwordx4 v179, s[12:15], s26 offen offset:3072 lds
s_add_u32 m0, s25, 81920
s_nop 0
buffer_load_dwordx4 v180, s[20:23], s26 offen offset:0 lds
buffer_load_dwordx4 v181, s[20:23], s26 offen offset:1024 lds
buffer_load_dwordx4 v182, s[20:23], s26 offen offset:2048 lds
buffer_load_dwordx4 v183, s[20:23], s26 offen offset:3072 lds
s_waitcnt vmcnt(8)
s_barrier
s_add_u32 m0, s25, 0
s_add_u32 s26, s24, 384
s_and_b32 s26, s26, 0x7ff
buffer_load_dwordx4 v176, s[12:15], s26 offen offset:0 lds
buffer_load_dwordx4 v177, s[12:15], s26 offen offset:1024 lds
buffer_load_dwordx4 v178, s[12:15], s26 offen offset:2048 lds
buffer_load_dwordx4 v179, s[12:15], s26 offen offset:3072 lds
s_add_u32 m0, s25, 16384
s_nop 0
buffer_load_dwordx4 v180, s[20:23], s26 offen offset:0 lds
buffer_load_dwordx4 v181, s[20:23], s26 offen offset:1024 lds
buffer_load_dwordx4 v182, s[20:23], s26 offen offset:2048 lds
buffer_load_dwordx4 v183, s[20:23], s26 offen offset:3072 lds
s_add_u32 m0, s68, 16384
s_nop 0
buffer_load_dwordx4 v18, s[48:51], s69 offen nt lds
s_add_u32 m0, s68, 17408
s_nop 0
buffer_load_dwordx4 v18, s[52:55], s69 offen nt lds
s_add_u32 m0, s68, 18432
s_nop 0
buffer_load_dwordx4 v19, s[48:51], s69 offen nt lds
s_add_u32 m0, s68, 19456
s_nop 0
buffer_load_dwordx4 v19, s[52:55], s69 offen nt lds
s_cmp_lg_u32 s66, 3
s_cbranch_scc1 L_nw1
s_mov_b32 exec_hi, 0
buffer_load_ushort v88, v17, s[48:51], 0 offen nt
buffer_load_ushort v89, v17, s[52:55], 0 offen nt
s_mov_b64 exec, -1
L_nw1:
s_waitcnt vmcnt(12)
s_barrier
s_add_u32 m0, s25, 32768
s_add_u32 s26, s24, 512
s_and_b32 s26, s26, 0x7ff
buffer_load_dwordx4 v176, s[12:15], s26 offen offset:0 lds
buffer_load_dwordx4 v177, s[12:15], s26 offen offset:1024 lds
buffer_load_dwordx4 v178, s[12:15], s26 offen offset:2048 lds
buffer_load_dwordx4 v179, s[12:15], s26 offen offset:3072 lds
s_add_u32 m0, s25, 49152
s_nop 0
buffer_load_dwordx4 v180, s[20:23], s26 offen offset:0 lds
buffer_load_dwordx4 v181, s[20:23], s26 offen offset:1024 lds
buffer_load_dwordx4 v182, s[20:23], s26 offen offset:2048 lds
buffer_load_dwordx4 v183, s[20:23], s26 offen offset:3072 lds
s_waitcnt vmcnt(12)
s_barrier
s_add_u32 m0, s25, 65536
s_add_u32 s26, s24, 640
s_and_b32 s26, s26, 0x7ff
buffer_load_dwordx4 v176, s[12:15], s26 offen offset:0 lds
buffer_load_dwordx4 v177, s[12:15], s26 offen offset:1024 lds
buffer_load_dwordx4 v178, s[12:15], s26 offen offset:2048 lds
buffer_load_dwordx4 v179, s[12:15], s26 offen offset:3072 lds
s_add_u32 m0, s25, 81920
s_nop 0
buffer_load_dwordx4 v180, s[20:23], s26 offen offset:0 lds
buffer_load_dwordx4 v181, s[20:23], s26 offen offset:1024 lds
buffer_load_dwordx4 v182, s[20:23], s26 offen offset:2048 lds
buffer_load_dwordx4 v183, s[20:23], s26 offen offset:3072 lds
s_waitcnt vmcnt(8)
s_barrier
s_add_u32 m0, s25, 0
s_add_u32 s26, s24, 768
s_and_b32 s26, s26, 0x7ff
buffer_load_dwordx4 v176, s[12:15], s26 offen offset:0 lds
buffer_load_dwordx4 v177, s[12:15], s26 offen offset:1024 lds
buffer_load_dwordx4 v178, s[12:15], s26 offen offset:2048 lds
buffer_load_dwordx4 v179, s[12:15], s26 offen offset:3072 lds
s_add_u32 m0, s25, 16384
s_nop 0
buffer_load_dwordx4 v180, s[20:23], s26 offen offset:0 lds
buffer_load_dwordx4 v181, s[20:23], s26 offen offset:1024 lds
buffer_load_dwordx4 v182, s[20:23], s26 offen offset:2048 lds
buffer_load_dwordx4 v183, s[20:23], s26 offen offset:3072 lds
ds_read_b64 v[104:105], v16 offset:0
ds_read_b64 v[106:107], v16 offset:256
ds_read_b64 v[108:109], v16 offset:512
ds_read_b64 v[110:111], v16 offset:768
ds_read_b64 v[112:113], v16 offset:1024
ds_read_b64 v[114:115], v16 offset:1280
ds_read_b64 v[116:117], v16 offset:1536
ds_read_b64 v[118:119], v16 offset:1792
s_mov_b32 s64, 0x05040100
s_mov_b32 s65, 0x07060302
v_lshlrev_b32 v88, 16, v88
v_lshlrev_b32 v89, 16, v89
v_lshlrev_b32 v9, 1, v1
v_add_f32_dpp v90, v88, v88 quad_perm:[1,0,3,2] row_mask:0xf bank_mask:0xf
v_subrev_f32_dpp v91, v89, v89 quad_perm:[1,0,3,2] row_mask:0xf bank_mask:0xf
v_mul_f32 v90, 0.5, v90
v_mul_f32 v91, 0.5, v91
v_cvt_pk_bf16_f32 v88, v90, v91
s_waitcnt lgkmcnt(0)
v_perm_b32 v120, v112, v104, s64
v_perm_b32 v121, v116, v108, s64
v_perm_b32 v122, v114, v106, s64
v_perm_b32 v123, v118, v110, s64
v_perm_b32 v124, v112, v104, s65
v_perm_b32 v125, v116, v108, s65
v_perm_b32 v126, v114, v106, s65
v_perm_b32 v127, v118, v110, s65
v_perm_b32 v128, v113, v105, s64
v_perm_b32 v129, v117, v109, s64
v_perm_b32 v130, v115, v107, s64
v_perm_b32 v131, v119, v111, s64
v_perm_b32 v132, v113, v105, s65
v_perm_b32 v133, v117, v109, s65
v_perm_b32 v134, v115, v107, s65
v_perm_b32 v135, v119, v111, s65
s_waitcnt vmcnt(8)
s_barrier
s_add_u32 m0, s25, 32768
s_add_u32 s26, s24, 896
s_and_b32 s26, s26, 0x7ff
buffer_load_dwordx4 v176, s[12:15], s26 offen offset:0 lds
buffer_load_dwordx4 v177, s[12:15], s26 offen offset:1024 lds
buffer_load_dwordx4 v178, s[12:15], s26 offen offset:2048 lds
buffer_load_dwordx4 v179, s[12:15], s26 offen offset:3072 lds
s_add_u32 m0, s25, 49152
s_nop 0
buffer_load_dwordx4 v180, s[20:23], s26 offen offset:0 lds
buffer_load_dwordx4 v181, s[20:23], s26 offen offset:1024 lds
buffer_load_dwordx4 v182, s[20:23], s26 offen offset:2048 lds
buffer_load_dwordx4 v183, s[20:23], s26 offen offset:3072 lds
s_waitcnt vmcnt(8)
s_barrier
s_add_u32 m0, s25, 65536
s_add_u32 s26, s24, 1024
s_and_b32 s26, s26, 0x7ff
buffer_load_dwordx4 v176, s[12:15], s26 offen offset:0 lds
buffer_load_dwordx4 v177, s[12:15], s26 offen offset:1024 lds
buffer_load_dwordx4 v178, s[12:15], s26 offen offset:2048 lds
buffer_load_dwordx4 v179, s[12:15], s26 offen offset:3072 lds
s_add_u32 m0, s25, 81920
s_nop 0
buffer_load_dwordx4 v180, s[20:23], s26 offen offset:0 lds
buffer_load_dwordx4 v181, s[20:23], s26 offen offset:1024 lds
buffer_load_dwordx4 v182, s[20:23], s26 offen offset:2048 lds
buffer_load_dwordx4 v183, s[20:23], s26 offen offset:3072 lds
s_cmp_lg_u32 s66, 3
s_cbranch_scc1 L_nw2
s_lshr_b32 s64, s2, 7
s_mul_i32 s64, s64, 8192
s_bfe_u32 s65, s2, 0x10006
s_mul_i32 s65, s65, 4096
s_add_u32 s64, s64, s65
s_and_b32 s65, s2, 63
s_lshl_b32 s65, s65, 6
s_add_u32 s64, s64, s65
s_add_u32 s54, s64, 25165824
s_add_u32 s52, s32, s54
s_addc_u32 s53, s33, 0
s_mov_b32 s54, 64
s_mov_b32 s55, 0x20000
s_mov_b32 exec_lo, 0x55555555
s_mov_b32 exec_hi, 0
buffer_store_dword v88, v9, s[52:55], 0 offen sc1
s_mov_b64 exec, -1
L_nw2:
s_mov_b32 s92, 0
buffer_store_dwordx4 v[120:123], v15, s[56:59], s92 offen sc1
s_mov_b32 s92, 8192
buffer_store_dwordx4 v[124:127], v15, s[56:59], s92 offen sc1
s_mov_b32 s92, 16384
buffer_store_dwordx4 v[128:131], v15, s[56:59], s92 offen sc1
s_mov_b32 s92, 24576
buffer_store_dwordx4 v[132:135], v15, s[56:59], s92 offen sc1
s_waitcnt vmcnt(12)
s_barrier
s_add_u32 m0, s25, 0
s_add_u32 s26, s24, 1152
s_and_b32 s26, s26, 0x7ff
buffer_load_dwordx4 v176, s[12:15], s26 offen offset:0 lds
buffer_load_dwordx4 v177, s[12:15], s26 offen offset:1024 lds
buffer_load_dwordx4 v178, s[12:15], s26 offen offset:2048 lds
buffer_load_dwordx4 v179, s[12:15], s26 offen offset:3072 lds
s_add_u32 m0, s25, 16384
s_nop 0
buffer_load_dwordx4 v180, s[20:23], s26 offen offset:0 lds
buffer_load_dwordx4 v181, s[20:23], s26 offen offset:1024 lds
buffer_load_dwordx4 v182, s[20:23], s26 offen offset:2048 lds
buffer_load_dwordx4 v183, s[20:23], s26 offen offset:3072 lds
v_mov_b32 v20, 0
global_load_dword v21, v20, s[30:31] sc1
s_waitcnt vmcnt(13)
s_barrier
s_add_u32 m0, s25, 32768
s_add_u32 s26, s24, 1280
s_and_b32 s26, s26, 0x7ff
buffer_load_dwordx4 v176, s[12:15], s26 offen offset:0 lds
buffer_load_dwordx4 v177, s[12:15], s26 offen offset:1024 lds
buffer_load_dwordx4 v178, s[12:15], s26 offen offset:2048 lds
buffer_load_dwordx4 v179, s[12:15], s26 offen offset:3072 lds
s_add_u32 m0, s25, 49152
s_nop 0
buffer_load_dwordx4 v180, s[20:23], s26 offen offset:0 lds
buffer_load_dwordx4 v181, s[20:23], s26 offen offset:1024 lds
buffer_load_dwordx4 v182, s[20:23], s26 offen offset:2048 lds
buffer_load_dwordx4 v183, s[20:23], s26 offen offset:3072 lds
s_waitcnt vmcnt(9)
s_barrier
s_add_u32 m0, s25, 65536
s_add_u32 s26, s24, 1408
s_and_b32 s26, s26, 0x7ff
buffer_load_dwordx4 v176, s[12:15], s26 offen offset:0 lds
buffer_load_dwordx4 v177, s[12:15], s26 offen offset:1024 lds
buffer_load_dwordx4 v178, s[12:15], s26 offen offset:2048 lds
buffer_load_dwordx4 v179, s[12:15], s26 offen offset:3072 lds
s_add_u32 m0, s25, 81920
s_nop 0
buffer_load_dwordx4 v180, s[20:23], s26 offen offset:0 lds
buffer_load_dwordx4 v181, s[20:23], s26 offen offset:1024 lds
buffer_load_dwordx4 v182, s[20:23], s26 offen offset:2048 lds
buffer_load_dwordx4 v183, s[20:23], s26 offen offset:3072 lds
s_waitcnt vmcnt(8)
s_barrier
s_add_u32 m0, s25, 0
s_add_u32 s26, s24, 1536
s_and_b32 s26, s26, 0x7ff
buffer_load_dwordx4 v176, s[12:15], s26 offen offset:0 lds
buffer_load_dwordx4 v177, s[12:15], s26 offen offset:1024 lds
buffer_load_dwordx4 v178, s[12:15], s26 offen offset:2048 lds
buffer_load_dwordx4 v179, s[12:15], s26 offen offset:3072 lds
s_add_u32 m0, s25, 16384
s_nop 0
buffer_load_dwordx4 v180, s[20:23], s26 offen offset:0 lds
buffer_load_dwordx4 v181, s[20:23], s26 offen offset:1024 lds
buffer_load_dwordx4 v182, s[20:23], s26 offen offset:2048 lds
buffer_load_dwordx4 v183, s[20:23], s26 offen offset:3072 lds
s_waitcnt vmcnt(8)
s_barrier
s_add_u32 m0, s25, 32768
s_add_u32 s26, s24, 1664
s_and_b32 s26, s26, 0x7ff
buffer_load_dwordx4 v176, s[12:15], s26 offen offset:0 lds
buffer_load_dwordx4 v177, s[12:15], s26 offen offset:1024 lds
buffer_load_dwordx4 v178, s[12:15], s26 offen offset:2048 lds
buffer_load_dwordx4 v179, s[12:15], s26 offen offset:3072 lds
s_add_u32 m0, s25, 49152
s_nop 0
buffer_load_dwordx4 v180, s[20:23], s26 offen offset:0 lds
buffer_load_dwordx4 v181, s[20:23], s26 offen offset:1024 lds
buffer_load_dwordx4 v182, s[20:23], s26 offen offset:2048 lds
buffer_load_dwordx4 v183, s[20:23], s26 offen offset:3072 lds
s_waitcnt vmcnt(8)
s_barrier
s_add_u32 m0, s25, 65536
s_add_u32 s26, s24, 1792
s_and_b32 s26, s26, 0x7ff
buffer_load_dwordx4 v176, s[12:15], s26 offen offset:0 lds
buffer_load_dwordx4 v177, s[12:15], s26 offen offset:1024 lds
buffer_load_dwordx4 v178, s[12:15], s26 offen offset:2048 lds
buffer_load_dwordx4 v179, s[12:15], s26 offen offset:3072 lds
s_add_u32 m0, s25, 81920
s_nop 0
buffer_load_dwordx4 v180, s[20:23], s26 offen offset:0 lds
buffer_load_dwordx4 v181, s[20:23], s26 offen offset:1024 lds
buffer_load_dwordx4 v182, s[20:23], s26 offen offset:2048 lds
buffer_load_dwordx4 v183, s[20:23], s26 offen offset:3072 lds
s_waitcnt vmcnt(8)
s_barrier
s_add_u32 m0, s25, 0
s_add_u32 s26, s24, 1920
s_and_b32 s26, s26, 0x7ff
buffer_load_dwordx4 v176, s[12:15], s26 offen offset:0 lds
buffer_load_dwordx4 v177, s[12:15], s26 offen offset:1024 lds
buffer_load_dwordx4 v178, s[12:15], s26 offen offset:2048 lds
buffer_load_dwordx4 v179, s[12:15], s26 offen offset:3072 lds
s_add_u32 m0, s25, 16384
s_nop 0
buffer_load_dwordx4 v180, s[20:23], s26 offen offset:0 lds
buffer_load_dwordx4 v181, s[20:23], s26 offen offset:1024 lds
buffer_load_dwordx4 v182, s[20:23], s26 offen offset:2048 lds
buffer_load_dwordx4 v183, s[20:23], s26 offen offset:3072 lds
s_and_b32 s26, s2, 1
s_lshl_b32 s26, s26, 10
s_bfe_u32 s92, s2, 0x20001
s_lshl_b32 s92, s92, 19
s_add_u32 s26, s26, s92
s_lshr_b32 s92, s2, 3
s_lshl_b32 s92, s92, 14
s_add_u32 s26, s26, s92
s_lshr_b32 s92, s66, 1
s_lshl_b32 s92, s92, 13
s_add_u32 s26, s26, s92
v_bfe_u32 v22, v1, 3, 2
v_lshlrev_b32 v22, 11, v22
v_and_b32 v23, 7, v1
v_lshl_add_u32 v22, v23, 7, v22
v_add_u32 v22, s26, v22
s_mov_b32 exec_hi, 0
global_load_dword v23, v22, s[100:101]
s_mov_b64 exec, -1
s_waitcnt vmcnt(9)
s_barrier
s_add_u32 m0, s68, 0
s_mov_b32 s92, 0
buffer_load_dwordx4 v2, s[4:7], s92 offen offset:0 nt lds
buffer_load_dwordx4 v2, s[4:7], s92 offen offset:1024 nt lds
s_add_u32 m0, s68, 2048
s_mov_b32 s92, 2048
buffer_load_dwordx4 v3, s[4:7], s92 offen offset:0 nt lds
buffer_load_dwordx4 v3, s[4:7], s92 offen offset:1024 nt lds
s_waitcnt vmcnt(5)
s_barrier
s_barrier
s_barrier
s_setprio 3
v_readfirstlane_b32 s37, v21
s_nop 0
s_cmp_lg_u32 s37, 0
s_cbranch_scc1 L_sg3
v_mov_b32 v20, 0
L_n4:
global_load_dword v21, v20, s[30:31] sc1
s_waitcnt vmcnt(0)
v_readfirstlane_b32 s37, v21
s_nop 0
s_cmp_eq_u32 s37, 0
s_cbranch_scc1 L_n4
L_sg3:
s_waitcnt vmcnt(0)
ds_read_b64_tr_b16 v[24:25], v12 offset:0
ds_read_b64_tr_b16 v[26:27], v13 offset:0
ds_read_b64_tr_b16 v[28:29], v12 offset:512
ds_read_b64_tr_b16 v[30:31], v13 offset:512
ds_read_b64_tr_b16 v[32:33], v12 offset:1024
ds_read_b64_tr_b16 v[34:35], v13 offset:1024
ds_read_b64_tr_b16 v[36:37], v12 offset:1536
ds_read_b64_tr_b16 v[38:39], v13 offset:1536
s_waitcnt lgkmcnt(0)
v_mfma_f32_32x32x16_bf16 v[40:55], v[24:27], v[192:195], 0
v_mfma_f32_32x32x16_bf16 v[40:55], v[28:31], v[196:199], v[40:55]
v_mfma_f32_32x32x16_bf16 v[40:55], v[32:35], v[200:203], v[40:55]
v_mfma_f32_32x32x16_bf16 v[40:55], v[36:39], v[204:207], v[40:55]
v_mfma_f32_32x32x16_bf16 v[56:71], v[24:27], v[208:211], 0
v_mfma_f32_32x32x16_bf16 v[56:71], v[28:31], v[212:215], v[56:71]
v_mfma_f32_32x32x16_bf16 v[56:71], v[32:35], v[216:219], v[56:71]
v_mfma_f32_32x32x16_bf16 v[56:71], v[36:39], v[220:223], v[56:71]
s_nop 7
v_mul_f32 v168, v40, v224
v_mul_f32 v169, v40, v240
s_nop 1
v_fma_f32 v168, -v56, v240, v168
v_fmac_f32 v169, v56, v224
v_cvt_pk_bf16_f32 v72, v168, v169
v_mul_f32 v170, v41, v225
v_mul_f32 v171, v41, v241
v_fma_f32 v170, -v57, v241, v170
v_fmac_f32 v171, v57, v225
v_cvt_pk_bf16_f32 v73, v170, v171
v_mul_f32 v172, v42, v226
v_mul_f32 v173, v42, v242
v_fma_f32 v172, -v58, v242, v172
v_fmac_f32 v173, v58, v226
v_cvt_pk_bf16_f32 v74, v172, v173
v_mul_f32 v174, v43, v227
v_mul_f32 v175, v43, v243
v_fma_f32 v174, -v59, v243, v174
v_fmac_f32 v175, v59, v227
v_cvt_pk_bf16_f32 v75, v174, v175
v_mul_f32 v168, v44, v228
v_mul_f32 v169, v44, v244
v_fma_f32 v168, -v60, v244, v168
v_fmac_f32 v169, v60, v228
v_cvt_pk_bf16_f32 v76, v168, v169
v_mul_f32 v170, v45, v229
v_mul_f32 v171, v45, v245
v_fma_f32 v170, -v61, v245, v170
v_fmac_f32 v171, v61, v229
v_cvt_pk_bf16_f32 v77, v170, v171
v_mul_f32 v172, v46, v230
v_mul_f32 v173, v46, v246
v_fma_f32 v172, -v62, v246, v172
v_fmac_f32 v173, v62, v230
v_cvt_pk_bf16_f32 v78, v172, v173
v_mul_f32 v174, v47, v231
v_mul_f32 v175, v47, v247
v_fma_f32 v174, -v63, v247, v174
v_fmac_f32 v175, v63, v231
v_cvt_pk_bf16_f32 v79, v174, v175
v_mul_f32 v168, v48, v232
v_mul_f32 v169, v48, v248
v_fma_f32 v168, -v64, v248, v168
v_fmac_f32 v169, v64, v232
v_cvt_pk_bf16_f32 v80, v168, v169
v_mul_f32 v170, v49, v233
v_mul_f32 v171, v49, v249
v_fma_f32 v170, -v65, v249, v170
v_fmac_f32 v171, v65, v233
v_cvt_pk_bf16_f32 v81, v170, v171
v_mul_f32 v172, v50, v234
v_mul_f32 v173, v50, v250
v_fma_f32 v172, -v66, v250, v172
v_fmac_f32 v173, v66, v234
v_cvt_pk_bf16_f32 v82, v172, v173
v_mul_f32 v174, v51, v235
v_mul_f32 v175, v51, v251
v_fma_f32 v174, -v67, v251, v174
v_fmac_f32 v175, v67, v235
v_cvt_pk_bf16_f32 v83, v174, v175
v_mul_f32 v168, v52, v236
v_mul_f32 v169, v52, v252
v_fma_f32 v168, -v68, v252, v168
v_fmac_f32 v169, v68, v236
v_cvt_pk_bf16_f32 v84, v168, v169
v_mul_f32 v170, v53, v237
v_mul_f32 v171, v53, v253
v_fma_f32 v170, -v69, v253, v170
v_fmac_f32 v171, v69, v237
v_cvt_pk_bf16_f32 v85, v170, v171
v_mul_f32 v172, v54, v238
v_mul_f32 v173, v54, v254
v_fma_f32 v172, -v70, v254, v172
v_fmac_f32 v173, v70, v238
v_cvt_pk_bf16_f32 v86, v172, v173
v_mul_f32 v174, v55, v239
v_mul_f32 v175, v55, v255
v_fma_f32 v174, -v71, v255, v174
v_fmac_f32 v175, v71, v239
v_cvt_pk_bf16_f32 v87, v174, v175
v_mfma_f32_32x32x16_bf16 v[40:55], v[192:195], v[72:75], 0
v_mfma_f32_32x32x16_bf16 v[40:55], v[196:199], v[76:79], v[40:55]
v_mfma_f32_32x32x16_bf16 v[40:55], v[200:203], v[80:83], v[40:55]
v_mfma_f32_32x32x16_bf16 v[40:55], v[204:207], v[84:87], v[40:55]
v_mfma_f32_32x32x16_bf16 v[56:71], v[208:211], v[72:75], 0
v_mfma_f32_32x32x16_bf16 v[56:71], v[212:215], v[76:79], v[56:71]
v_mfma_f32_32x32x16_bf16 v[56:71], v[216:219], v[80:83], v[56:71]
v_mfma_f32_32x32x16_bf16 v[56:71], v[220:223], v[84:87], v[56:71]
s_lshl_b32 s92, s66, 12
s_add_u32 s92, s92, 98304
v_add_u32 v8, s92, v7
s_nop 8
v_cvt_pk_bf16_f32 v72, v40, v56
ds_write_b32 v4, v72 offset:0
v_cvt_pk_bf16_f32 v73, v41, v57
ds_write_b32 v4, v73 offset:1024
v_cvt_pk_bf16_f32 v74, v42, v58
ds_write_b32 v4, v74 offset:2048
v_cvt_pk_bf16_f32 v75, v43, v59
ds_write_b32 v4, v75 offset:3072
v_cvt_pk_bf16_f32 v76, v44, v60
ds_write_b32 v4, v76 offset:8192
v_cvt_pk_bf16_f32 v77, v45, v61
ds_write_b32 v4, v77 offset:9216
v_cvt_pk_bf16_f32 v78, v46, v62
ds_write_b32 v4, v78 offset:10240
v_cvt_pk_bf16_f32 v79, v47, v63
ds_write_b32 v4, v79 offset:11264
v_cvt_pk_bf16_f32 v80, v48, v64
ds_write_b32 v6, v80 offset:0
v_cvt_pk_bf16_f32 v81, v49, v65
ds_write_b32 v5, v81 offset:10240
v_cvt_pk_bf16_f32 v82, v50, v66
ds_write_b32 v5, v82 offset:9216
v_cvt_pk_bf16_f32 v83, v51, v67
ds_write_b32 v5, v83 offset:8192
v_cvt_pk_bf16_f32 v84, v52, v68
ds_write_b32 v5, v84 offset:3072
v_cvt_pk_bf16_f32 v85, v53, v69
ds_write_b32 v5, v85 offset:2048
v_cvt_pk_bf16_f32 v86, v54, v70
ds_write_b32 v5, v86 offset:1024
v_cvt_pk_bf16_f32 v87, v55, v71
ds_write_b32 v5, v87 offset:0
s_waitcnt lgkmcnt(0)
v_mov_b32 v190, 1
s_mov_b64 exec, 1
ds_write_b32 v185, v190
s_mov_b64 exec, -1
L_lc6:
ds_read_b128 v[186:189], v184
s_waitcnt lgkmcnt(0)
v_min3_u32 v186, v186, v187, v188
v_min_u32 v186, v186, v189
s_nop 0
v_readfirstlane_b32 s92, v186
s_nop 0
s_cmp_ge_u32 s92, 1
s_cbranch_scc1 L_lcd7
s_sleep 1
s_branch L_lc6
L_lcd7:
ds_read_b128 v[72:75], v8 offset:0
ds_read_b128 v[76:79], v8 offset:1024
ds_read_b128 v[80:83], v8 offset:2048
ds_read_b128 v[84:87], v8 offset:3072
v_add_u32 v4, 32768, v4
v_add_u32 v5, 32768, v5
v_add_u32 v6, 32768, v6
s_waitcnt lgkmcnt(0)
v_mov_b32 v190, 2
s_mov_b64 exec, 1
ds_write_b32 v185, v190
s_mov_b64 exec, -1
buffer_store_dwordx4 v[72:75], v2, s[40:43], 0 offen offset:0 sc1
buffer_store_dwordx4 v[76:79], v2, s[40:43], 0 offen offset:1024 sc1
buffer_store_dwordx4 v[80:83], v2, s[40:43], 0 offen offset:2048 sc1
buffer_store_dwordx4 v[84:87], v2, s[40:43], 0 offen offset:3072 sc1
s_and_b32 s60, s2, 7
s_lshl_b32 s60, s60, 5
s_lshr_b32 s64, s2, 3
s_add_u32 s60, s60, s64
s_lshr_b32 s64, s66, 1
s_xor_b32 s64, s64, s66
s_and_b32 s64, s64, 1
s_or_b32 s65, s64, s60
s_cmp_eq_u32 s65, 0
s_cselect_b32 s61, 1, 0
s_lshl_b32 s65, s60, 1
s_add_u32 s64, s64, s65
s_mul_i32 s64, s64, 8192
s_add_u32 s64, s64, 25182208
s_lshr_b32 s65, s66, 1
s_mul_i32 s69, s65, 8192
s_add_u32 s69, s69, 25165824
s_cmp_eq_u32 s61, 1
s_cselect_b32 s64, s69, s64
s_cselect_b32 s65, 0, s65
s_cselect_b32 s90, s32, s32
s_cselect_b32 s91, s33, s33
s_lshl_b32 s62, s65, 31
s_or_b32 s63, s62, 0x3f800000
s_add_u32 s48, s90, s64
s_addc_u32 s49, s91, 0
s_mov_b32 s50, 8192
s_mov_b32 s51, 0x20000
s_lshl_b32 s64, s66, 20
s_lshl_b32 s65, s60, 6
s_add_u32 s64, s64, s65
s_add_u32 s54, s64, 16777216
s_add_u32 s52, s32, s54
s_addc_u32 s53, s33, 0
s_sub_u32 s54, 1048576, s65
s_mov_b32 s55, 0x20000
s_add_u32 s58, s64, 16777216
s_add_u32 s56, s32, s58
s_addc_u32 s57, s33, 0
s_sub_u32 s58, 1048576, s65
s_mov_b32 s59, 0x20000
v_lshrrev_b32 v8, 2, v1
v_lshlrev_b32 v8, 14, v8
v_and_b32 v9, 3, v1
v_lshrrev_b32 v10, 4, v1
v_xor_b32 v9, v9, v10
v_lshl_add_u32 v14, v9, 4, v8
v_and_b32 v8, 31, v1
v_bfe_u32 v9, v1, 2, 2
v_xor_b32 v9, s66, v9
v_lshlrev_b32 v9, 4, v9
v_lshl_add_u32 v9, v8, 6, v9
v_lshrrev_b32 v8, 5, v1
v_lshl_add_u32 v9, v8, 11, v9
v_add_u32 v15, 131072, v9
s_lshl_b32 s64, s66, 13
s_add_u32 s64, s64, 131072
v_add_u32 v16, s64, v2
s_xor_b32 s65, s64, 24576
s_cmp_eq_u32 s61, 1
s_cselect_b32 s65, s64, s65
v_add_u32 v17, s65, v2
v_add_u32 v18, s68, v2
v_mul_f32 v136, s63, v136
v_mul_f32 v137, s63, v137
v_mul_f32 v138, s63, v138
v_mul_f32 v139, s63, v139
v_mul_f32 v140, s63, v140
v_mul_f32 v141, s63, v141
v_mul_f32 v142, s63, v142
v_mul_f32 v143, s63, v143
v_mul_f32 v144, s63, v144
v_mul_f32 v145, s63, v145
v_mul_f32 v146, s63, v146
v_mul_f32 v147, s63, v147
v_mul_f32 v148, s63, v148
v_mul_f32 v149, s63, v149
v_mul_f32 v150, s63, v150
v_mul_f32 v151, s63, v151
v_mul_f32 v152, s63, v152
v_mul_f32 v153, s63, v153
v_mul_f32 v154, s63, v154
v_mul_f32 v155, s63, v155
v_mul_f32 v156, s63, v156
v_mul_f32 v157, s63, v157
v_mul_f32 v158, s63, v158
v_mul_f32 v159, s63, v159
v_mul_f32 v160, s63, v160
v_mul_f32 v161, s63, v161
v_mul_f32 v162, s63, v162
v_mul_f32 v163, s63, v163
v_mul_f32 v164, s63, v164
v_mul_f32 v165, s63, v165
v_mul_f32 v166, s63, v166
v_mul_f32 v167, s63, v167
s_waitcnt vmcnt(0)
v_mov_b32 v190, 3
s_mov_b64 exec, 1
ds_write_b32 v185, v190
s_mov_b64 exec, -1
s_cmp_lg_u32 s66, 0
s_cbranch_scc1 L_ph8
L_lc9:
ds_read_b128 v[186:189], v184
s_waitcnt lgkmcnt(0)
v_min3_u32 v186, v186, v187, v188
v_min_u32 v186, v186, v189
s_nop 0
v_readfirstlane_b32 s92, v186
s_nop 0
s_cmp_ge_u32 s92, 3
s_cbranch_scc1 L_lcd10
s_sleep 1
s_branch L_lc9
L_lcd10:
s_and_b32 s64, s2, 15
s_lshl_b32 s65, s64, 7
s_add_u32 s65, s65, 4096
s_add_u32 s90, s32, s65
s_addc_u32 s91, s33, 0
s_mov_b32 s65, 1
s_atomic_add s65, s[90:91], 0x0 glc
s_lshl_b32 s64, s64, 2
s_add_u32 s64, s64, 540672
v_lshl_add_u32 v20, v1, 7, s64
v_mov_b32 v21, s37
s_add_u32 s4, s32, s64
s_addc_u32 s5, s33, 0
s_and_b32 s64, s2, 31
s_lshl_b32 s64, s64, 7
s_add_u32 s64, s64, 540672
s_waitcnt lgkmcnt(0)
s_cmp_lg_u32 s65, 15
s_cbranch_scc1 L_sg11
s_atomic_swap s37, s[4:5], 0x0
s_atomic_swap s37, s[4:5], 0x80
s_atomic_swap s37, s[4:5], 0x100
s_atomic_swap s37, s[4:5], 0x180
s_atomic_swap s37, s[4:5], 0x200
s_atomic_swap s37, s[4:5], 0x280
s_atomic_swap s37, s[4:5], 0x300
s_atomic_swap s37, s[4:5], 0x380
s_atomic_swap s37, s[4:5], 0x400
s_atomic_swap s37, s[4:5], 0x480
s_atomic_swap s37, s[4:5], 0x500
s_atomic_swap s37, s[4:5], 0x580
s_atomic_swap s37, s[4:5], 0x600
s_atomic_swap s37, s[4:5], 0x680
s_atomic_swap s37, s[4:5], 0x700
s_atomic_swap s37, s[4:5], 0x780
s_atomic_swap s37, s[4:5], 0x800
s_atomic_swap s37, s[4:5], 0x880
s_atomic_swap s37, s[4:5], 0x900
s_atomic_swap s37, s[4:5], 0x980
s_atomic_swap s37, s[4:5], 0xa00
s_atomic_swap s37, s[4:5], 0xa80
s_atomic_swap s37, s[4:5], 0xb00
s_atomic_swap s37, s[4:5], 0xb80
s_atomic_swap s37, s[4:5], 0xc00
s_atomic_swap s37, s[4:5], 0xc80
s_atomic_swap s37, s[4:5], 0xd00
s_atomic_swap s37, s[4:5], 0xd80
s_atomic_swap s37, s[4:5], 0xe00
s_atomic_swap s37, s[4:5], 0xe80
s_atomic_swap s37, s[4:5], 0xf00
s_atomic_swap s37, s[4:5], 0xf80
s_waitcnt lgkmcnt(0)
L_sg11:
s_add_u32 s90, s32, s64
s_addc_u32 s91, s33, 0
s_mov_b32 s64, s37
s_mov_b32 s65, s37
s_mov_b32 s92, 0
s_branch L_sp12
L_nok13:
s_add_u32 s92, s92, 1
s_cmp_ge_u32 s92, 200000
s_cbranch_scc1 L_ph8
s_sleep 2
L_sp12:
s_load_dwordx16 s[4:19], s[90:91], 0x0 glc
s_waitcnt lgkmcnt(0)
s_cmp_eq_u64 s[4:5], s[64:65]
s_cbranch_scc0 L_nok13
s_cmp_eq_u64 s[6:7], s[64:65]
s_cbranch_scc0 L_nok13
s_cmp_eq_u64 s[8:9], s[64:65]
s_cbranch_scc0 L_nok13
s_cmp_eq_u64 s[10:11], s[64:65]
s_cbranch_scc0 L_nok13
s_cmp_eq_u64 s[12:13], s[64:65]
s_cbranch_scc0 L_nok13
s_cmp_eq_u64 s[14:15], s[64:65]
s_cbranch_scc0 L_nok13
s_cmp_eq_u64 s[16:17], s[64:65]
s_cbranch_scc0 L_nok13
s_cmp_eq_u64 s[18:19], s[64:65]
s_cbranch_scc0 L_nok13
L_ph8:
v_mov_b32 v190, 4
s_mov_b64 exec, 1
ds_write_b32 v185, v190
s_mov_b64 exec, -1
L_lc14:
ds_read_b128 v[186:189], v184
s_waitcnt lgkmcnt(0)
v_min3_u32 v186, v186, v187, v188
v_min_u32 v186, v186, v189
s_nop 0
v_readfirstlane_b32 s92, v186
s_nop 0
s_cmp_ge_u32 s92, 4
s_cbranch_scc1 L_lcd15
s_sleep 1
s_branch L_lc14
L_lcd15:
s_setprio 3
s_add_u32 m0, s68, 0
s_mov_b32 s64, 0
buffer_load_dwordx4 v14, s[52:55], s64 offen sc1 lds
s_add_u32 m0, s68, 1024
s_mov_b32 s64, 262144
buffer_load_dwordx4 v14, s[52:55], s64 offen sc1 lds
s_add_u32 m0, s68, 2048
s_mov_b32 s64, 524288
buffer_load_dwordx4 v14, s[52:55], s64 offen sc1 lds
s_add_u32 m0, s68, 3072
s_mov_b32 s64, 786432
buffer_load_dwordx4 v14, s[52:55], s64 offen sc1 lds
s_movk_i32 s64, 4096
buffer_load_dwordx4 v[104:107], v2, s[48:51], 0 offen offset:0 sc1
buffer_load_dwordx4 v[108:111], v2, s[48:51], 0 offen offset:1024 sc1
buffer_load_dwordx4 v[112:115], v2, s[48:51], 0 offen offset:2048 sc1
buffer_load_dwordx4 v[116:119], v2, s[48:51], 0 offen offset:3072 sc1
buffer_load_dwordx4 v[120:123], v2, s[48:51], s64 offen offset:0 sc1
buffer_load_dwordx4 v[124:127], v2, s[48:51], s64 offen offset:1024 sc1
buffer_load_dwordx4 v[128:131], v2, s[48:51], s64 offen offset:2048 sc1
buffer_load_dwordx4 v[132:135], v2, s[48:51], s64 offen offset:3072 sc1
s_waitcnt vmcnt(8)
v_mov_b32 v190, 5
s_mov_b64 exec, 1
ds_write_b32 v185, v190
s_mov_b64 exec, -1
L_lc16:
ds_read_b128 v[186:189], v184
s_waitcnt lgkmcnt(0)
v_min3_u32 v186, v186, v187, v188
v_min_u32 v186, v186, v189
s_nop 0
v_readfirstlane_b32 s92, v186
s_nop 0
s_cmp_ge_u32 s92, 5
s_cbranch_scc1 L_lcd17
s_sleep 1
s_branch L_lc16
L_lcd17:
ds_read_b128 v[72:75], v15 offset:0
ds_read_b128 v[76:79], v15 offset:4096
ds_read_b128 v[80:83], v15 offset:8192
ds_read_b128 v[84:87], v15 offset:12288
s_waitcnt lgkmcnt(0)
v_mov_b32 v190, 6
s_mov_b64 exec, 1
ds_write_b32 v185, v190
s_mov_b64 exec, -1
s_lshl_b32 s64, s61, 31
s_or_b32 s64, s64, s62
L_fft18:
v_xor_b32 v24, s64, v72
v_xor_b32 v25, s64, v73
v_xor_b32 v26, s64, v74
v_xor_b32 v27, s64, v75
v_xor_b32 v28, s64, v76
v_xor_b32 v29, s64, v77
v_xor_b32 v30, s64, v78
v_xor_b32 v31, s64, v79
v_xor_b32 v32, s64, v80
v_xor_b32 v33, s64, v81
v_xor_b32 v34, s64, v82
v_xor_b32 v35, s64, v83
v_xor_b32 v36, s64, v84
v_xor_b32 v37, s64, v85
v_xor_b32 v38, s64, v86
v_xor_b32 v39, s64, v87
v_mfma_f32_32x32x16_bf16 v[40:55], v[24:27], v[192:195], 0
v_mfma_f32_32x32x16_bf16 v[40:55], v[28:31], v[196:199], v[40:55]
v_mfma_f32_32x32x16_bf16 v[40:55], v[32:35], v[200:203], v[40:55]
v_mfma_f32_32x32x16_bf16 v[40:55], v[36:39], v[204:207], v[40:55]
v_mfma_f32_32x32x16_bf16 v[56:71], v[24:27], v[208:211], 0
v_mfma_f32_32x32x16_bf16 v[56:71], v[28:31], v[212:215], v[56:71]
v_mfma_f32_32x32x16_bf16 v[56:71], v[32:35], v[216:219], v[56:71]
v_mfma_f32_32x32x16_bf16 v[56:71], v[36:39], v[220:223], v[56:71]
s_nop 7
v_mul_f32 v168, v40, v224
v_mul_f32 v169, v40, v240
s_nop 1
v_fma_f32 v168, -v56, v240, v168
v_fmac_f32 v169, v56, v224
v_cvt_pk_bf16_f32 v24, v168, v169
v_mul_f32 v170, v41, v225
v_mul_f32 v171, v41, v241
v_fma_f32 v170, -v57, v241, v170
v_fmac_f32 v171, v57, v225
v_cvt_pk_bf16_f32 v25, v170, v171
v_mul_f32 v172, v42, v226
v_mul_f32 v173, v42, v242
v_fma_f32 v172, -v58, v242, v172
v_fmac_f32 v173, v58, v226
v_cvt_pk_bf16_f32 v26, v172, v173
v_mul_f32 v174, v43, v227
v_mul_f32 v175, v43, v243
v_fma_f32 v174, -v59, v243, v174
v_fmac_f32 v175, v59, v227
v_cvt_pk_bf16_f32 v27, v174, v175
v_mul_f32 v168, v44, v228
v_mul_f32 v169, v44, v244
v_fma_f32 v168, -v60, v244, v168
v_fmac_f32 v169, v60, v228
v_cvt_pk_bf16_f32 v28, v168, v169
v_mul_f32 v170, v45, v229
v_mul_f32 v171, v45, v245
v_fma_f32 v170, -v61, v245, v170
v_fmac_f32 v171, v61, v229
v_cvt_pk_bf16_f32 v29, v170, v171
v_mul_f32 v172, v46, v230
v_mul_f32 v173, v46, v246
v_fma_f32 v172, -v62, v246, v172
v_fmac_f32 v173, v62, v230
v_cvt_pk_bf16_f32 v30, v172, v173
v_mul_f32 v174, v47, v231
v_mul_f32 v175, v47, v247
v_fma_f32 v174, -v63, v247, v174
v_fmac_f32 v175, v63, v231
v_cvt_pk_bf16_f32 v31, v174, v175
v_mul_f32 v168, v48, v232
v_mul_f32 v169, v48, v248
v_fma_f32 v168, -v64, v248, v168
v_fmac_f32 v169, v64, v232
v_cvt_pk_bf16_f32 v32, v168, v169
v_mul_f32 v170, v49, v233
v_mul_f32 v171, v49, v249
v_fma_f32 v170, -v65, v249, v170
v_fmac_f32 v171, v65, v233
v_cvt_pk_bf16_f32 v33, v170, v171
v_mul_f32 v172, v50, v234
v_mul_f32 v173, v50, v250
v_fma_f32 v172, -v66, v250, v172
v_fmac_f32 v173, v66, v234
v_cvt_pk_bf16_f32 v34, v172, v173
v_mul_f32 v174, v51, v235
v_mul_f32 v175, v51, v251
v_fma_f32 v174, -v67, v251, v174
v_fmac_f32 v175, v67, v235
v_cvt_pk_bf16_f32 v35, v174, v175
v_mul_f32 v168, v52, v236
v_mul_f32 v169, v52, v252
v_fma_f32 v168, -v68, v252, v168
v_fmac_f32 v169, v68, v236
v_cvt_pk_bf16_f32 v36, v168, v169
v_mul_f32 v170, v53, v237
v_mul_f32 v171, v53, v253
v_fma_f32 v170, -v69, v253, v170
v_fmac_f32 v171, v69, v237
v_cvt_pk_bf16_f32 v37, v170, v171
v_mul_f32 v172, v54, v238
v_mul_f32 v173, v54, v254
v_fma_f32 v172, -v70, v254, v172
v_fmac_f32 v173, v70, v238
v_cvt_pk_bf16_f32 v38, v172, v173
v_mul_f32 v174, v55, v239
v_mul_f32 v175, v55, v255
v_fma_f32 v174, -v71, v255, v174
v_fmac_f32 v175, v71, v239
v_cvt_pk_bf16_f32 v39, v174, v175
v_mfma_f32_32x32x16_bf16 v[40:55], v[192:195], v[24:27], 0
v_mfma_f32_32x32x16_bf16 v[40:55], v[196:199], v[28:31], v[40:55]
v_mfma_f32_32x32x16_bf16 v[40:55], v[200:203], v[32:35], v[40:55]
v_mfma_f32_32x32x16_bf16 v[40:55], v[204:207], v[36:39], v[40:55]
v_mfma_f32_32x32x16_bf16 v[56:71], v[208:211], v[24:27], 0
v_mfma_f32_32x32x16_bf16 v[56:71], v[212:215], v[28:31], v[56:71]
v_mfma_f32_32x32x16_bf16 v[56:71], v[216:219], v[32:35], v[56:71]
v_mfma_f32_32x32x16_bf16 v[56:71], v[220:223], v[36:39], v[56:71]
L_lc20:
ds_read_b128 v[186:189], v184
s_waitcnt lgkmcnt(0)
v_min3_u32 v186, v186, v187, v188
v_min_u32 v186, v186, v189
s_nop 0
v_readfirstlane_b32 s92, v186
s_nop 0
s_cmp_ge_u32 s92, 6
s_cbranch_scc1 L_lcd21
s_sleep 1
s_branch L_lc20
L_lcd21:
s_cmp_eq_u32 s61, 2
s_cbranch_scc1 L_nwr19
ds_write_b128 v16, v[40:43] offset:0
ds_write_b128 v16, v[44:47] offset:1024
ds_write_b128 v16, v[48:51] offset:2048
ds_write_b128 v16, v[52:55] offset:3072
ds_write_b128 v16, v[56:59] offset:4096
ds_write_b128 v16, v[60:63] offset:5120
ds_write_b128 v16, v[64:67] offset:6144
ds_write_b128 v16, v[68:71] offset:7168
s_cmp_eq_u32 s61, 0
s_cbranch_scc1 L_nwr19
s_mov_b32 s61, 2
s_mov_b32 s64, 0
s_branch L_fft18
L_nwr19:
s_waitcnt lgkmcnt(0)
v_mov_b32 v190, 7
s_mov_b64 exec, 1
ds_write_b32 v185, v190
s_mov_b64 exec, -1
L_lc22:
ds_read_b128 v[186:189], v184
s_waitcnt lgkmcnt(0)
v_min3_u32 v186, v186, v187, v188
v_min_u32 v186, v186, v189
s_nop 0
v_readfirstlane_b32 s92, v186
s_nop 0
s_cmp_ge_u32 s92, 7
s_cbranch_scc1 L_lcd23
s_sleep 1
s_branch L_lc22
L_lcd23:
ds_read_b128 v[72:75], v17 offset:0
ds_read_b128 v[76:79], v17 offset:1024
ds_read_b128 v[80:83], v17 offset:2048
ds_read_b128 v[84:87], v17 offset:3072
ds_read_b128 v[88:91], v17 offset:4096
ds_read_b128 v[92:95], v17 offset:5120
ds_read_b128 v[96:99], v17 offset:6144
ds_read_b128 v[100:103], v17 offset:7168
s_waitcnt vmcnt(0) lgkmcnt(0)
v_mov_b32 v190, 8
s_mov_b64 exec, 1
ds_write_b32 v185, v190
s_mov_b64 exec, -1
v_lshlrev_b32 v168, 16, v104
v_and_b32 v169, 0xffff0000, v104
v_lshlrev_b32 v170, 16, v105
v_and_b32 v171, 0xffff0000, v105
v_add_f32 v172, v168, v170
v_add_f32 v173, v169, v171
v_sub_f32 v168, v168, v170
v_sub_f32 v169, v169, v171
v_mul_f32 v170, v152, v40
v_mul_f32 v171, v152, v56
v_mul_f32 v174, v172, v40
v_mul_f32 v175, v172, v56
v_fma_f32 v170, -v136, v88, v170
v_fmac_f32 v171, v136, v72
v_fma_f32 v174, -v173, v56, v174
v_fmac_f32 v175, v173, v40
v_fmac_f32 v174, v168, v170
v_fmac_f32 v175, v168, v171
v_fma_f32 v174, -v169, v171, v174
v_fmac_f32 v175, v169, v170
v_cvt_pk_bf16_f32 v24, v175, v174
v_lshlrev_b32 v176, 16, v106
v_and_b32 v177, 0xffff0000, v106
v_lshlrev_b32 v178, 16, v107
v_and_b32 v179, 0xffff0000, v107
v_add_f32 v180, v176, v178
v_add_f32 v181, v177, v179
v_sub_f32 v176, v176, v178
v_sub_f32 v177, v177, v179
v_mul_f32 v178, v153, v41
v_mul_f32 v179, v153, v57
v_mul_f32 v182, v180, v41
v_mul_f32 v183, v180, v57
v_fma_f32 v178, -v137, v89, v178
v_fmac_f32 v179, v137, v73
v_fma_f32 v182, -v181, v57, v182
v_fmac_f32 v183, v181, v41
v_fmac_f32 v182, v176, v178
v_fmac_f32 v183, v176, v179
v_fma_f32 v182, -v177, v179, v182
v_fmac_f32 v183, v177, v178
v_cvt_pk_bf16_f32 v25, v183, v182
v_lshlrev_b32 v168, 16, v108
v_and_b32 v169, 0xffff0000, v108
v_lshlrev_b32 v170, 16, v109
v_and_b32 v171, 0xffff0000, v109
v_add_f32 v172, v168, v170
v_add_f32 v173, v169, v171
v_sub_f32 v168, v168, v170
v_sub_f32 v169, v169, v171
v_mul_f32 v170, v154, v42
v_mul_f32 v171, v154, v58
v_mul_f32 v174, v172, v42
v_mul_f32 v175, v172, v58
v_fma_f32 v170, -v138, v90, v170
v_fmac_f32 v171, v138, v74
v_fma_f32 v174, -v173, v58, v174
v_fmac_f32 v175, v173, v42
v_fmac_f32 v174, v168, v170
v_fmac_f32 v175, v168, v171
v_fma_f32 v174, -v169, v171, v174
v_fmac_f32 v175, v169, v170
v_cvt_pk_bf16_f32 v26, v175, v174
v_lshlrev_b32 v176, 16, v110
v_and_b32 v177, 0xffff0000, v110
v_lshlrev_b32 v178, 16, v111
v_and_b32 v179, 0xffff0000, v111
v_add_f32 v180, v176, v178
v_add_f32 v181, v177, v179
v_sub_f32 v176, v176, v178
v_sub_f32 v177, v177, v179
v_mul_f32 v178, v155, v43
v_mul_f32 v179, v155, v59
v_mul_f32 v182, v180, v43
v_mul_f32 v183, v180, v59
v_fma_f32 v178, -v139, v91, v178
v_fmac_f32 v179, v139, v75
v_fma_f32 v182, -v181, v59, v182
v_fmac_f32 v183, v181, v43
v_fmac_f32 v182, v176, v178
v_fmac_f32 v183, v176, v179
v_fma_f32 v182, -v177, v179, v182
v_fmac_f32 v183, v177, v178
v_cvt_pk_bf16_f32 v27, v183, v182
v_lshlrev_b32 v168, 16, v112
v_and_b32 v169, 0xffff0000, v112
v_lshlrev_b32 v170, 16, v113
v_and_b32 v171, 0xffff0000, v113
v_add_f32 v172, v168, v170
v_add_f32 v173, v169, v171
v_sub_f32 v168, v168, v170
v_sub_f32 v169, v169, v171
v_mul_f32 v170, v156, v44
v_mul_f32 v171, v156, v60
v_mul_f32 v174, v172, v44
v_mul_f32 v175, v172, v60
v_fma_f32 v170, -v140, v92, v170
v_fmac_f32 v171, v140, v76
v_fma_f32 v174, -v173, v60, v174
v_fmac_f32 v175, v173, v44
v_fmac_f32 v174, v168, v170
v_fmac_f32 v175, v168, v171
v_fma_f32 v174, -v169, v171, v174
v_fmac_f32 v175, v169, v170
v_cvt_pk_bf16_f32 v28, v175, v174
v_lshlrev_b32 v176, 16, v114
v_and_b32 v177, 0xffff0000, v114
v_lshlrev_b32 v178, 16, v115
v_and_b32 v179, 0xffff0000, v115
v_add_f32 v180, v176, v178
v_add_f32 v181, v177, v179
v_sub_f32 v176, v176, v178
v_sub_f32 v177, v177, v179
v_mul_f32 v178, v157, v45
v_mul_f32 v179, v157, v61
v_mul_f32 v182, v180, v45
v_mul_f32 v183, v180, v61
v_fma_f32 v178, -v141, v93, v178
v_fmac_f32 v179, v141, v77
v_fma_f32 v182, -v181, v61, v182
v_fmac_f32 v183, v181, v45
v_fmac_f32 v182, v176, v178
v_fmac_f32 v183, v176, v179
v_fma_f32 v182, -v177, v179, v182
v_fmac_f32 v183, v177, v178
v_cvt_pk_bf16_f32 v29, v183, v182
v_lshlrev_b32 v168, 16, v116
v_and_b32 v169, 0xffff0000, v116
v_lshlrev_b32 v170, 16, v117
v_and_b32 v171, 0xffff0000, v117
v_add_f32 v172, v168, v170
v_add_f32 v173, v169, v171
v_sub_f32 v168, v168, v170
v_sub_f32 v169, v169, v171
v_mul_f32 v170, v158, v46
v_mul_f32 v171, v158, v62
v_mul_f32 v174, v172, v46
v_mul_f32 v175, v172, v62
v_fma_f32 v170, -v142, v94, v170
v_fmac_f32 v171, v142, v78
v_fma_f32 v174, -v173, v62, v174
v_fmac_f32 v175, v173, v46
v_fmac_f32 v174, v168, v170
v_fmac_f32 v175, v168, v171
v_fma_f32 v174, -v169, v171, v174
v_fmac_f32 v175, v169, v170
v_cvt_pk_bf16_f32 v30, v175, v174
v_lshlrev_b32 v176, 16, v118
v_and_b32 v177, 0xffff0000, v118
v_lshlrev_b32 v178, 16, v119
v_and_b32 v179, 0xffff0000, v119
v_add_f32 v180, v176, v178
v_add_f32 v181, v177, v179
v_sub_f32 v176, v176, v178
v_sub_f32 v177, v177, v179
v_mul_f32 v178, v159, v47
v_mul_f32 v179, v159, v63
v_mul_f32 v182, v180, v47
v_mul_f32 v183, v180, v63
v_fma_f32 v178, -v143, v95, v178
v_fmac_f32 v179, v143, v79
v_fma_f32 v182, -v181, v63, v182
v_fmac_f32 v183, v181, v47
v_fmac_f32 v182, v176, v178
v_fmac_f32 v183, v176, v179
v_fma_f32 v182, -v177, v179, v182
v_fmac_f32 v183, v177, v178
v_cvt_pk_bf16_f32 v31, v183, v182
v_lshlrev_b32 v168, 16, v120
v_and_b32 v169, 0xffff0000, v120
v_lshlrev_b32 v170, 16, v121
v_and_b32 v171, 0xffff0000, v121
v_add_f32 v172, v168, v170
v_add_f32 v173, v169, v171
v_sub_f32 v168, v168, v170
v_sub_f32 v169, v169, v171
v_mul_f32 v170, v160, v48
v_mul_f32 v171, v160, v64
v_mul_f32 v174, v172, v48
v_mul_f32 v175, v172, v64
v_fma_f32 v170, -v144, v96, v170
v_fmac_f32 v171, v144, v80
v_fma_f32 v174, -v173, v64, v174
v_fmac_f32 v175, v173, v48
v_fmac_f32 v174, v168, v170
v_fmac_f32 v175, v168, v171
v_fma_f32 v174, -v169, v171, v174
v_fmac_f32 v175, v169, v170
v_cvt_pk_bf16_f32 v32, v175, v174
v_lshlrev_b32 v176, 16, v122
v_and_b32 v177, 0xffff0000, v122
v_lshlrev_b32 v178, 16, v123
v_and_b32 v179, 0xffff0000, v123
v_add_f32 v180, v176, v178
v_add_f32 v181, v177, v179
v_sub_f32 v176, v176, v178
v_sub_f32 v177, v177, v179
v_mul_f32 v178, v161, v49
v_mul_f32 v179, v161, v65
v_mul_f32 v182, v180, v49
v_mul_f32 v183, v180, v65
v_fma_f32 v178, -v145, v97, v178
v_fmac_f32 v179, v145, v81
v_fma_f32 v182, -v181, v65, v182
v_fmac_f32 v183, v181, v49
v_fmac_f32 v182, v176, v178
v_fmac_f32 v183, v176, v179
v_fma_f32 v182, -v177, v179, v182
v_fmac_f32 v183, v177, v178
v_cvt_pk_bf16_f32 v33, v183, v182
v_lshlrev_b32 v168, 16, v124
v_and_b32 v169, 0xffff0000, v124
v_lshlrev_b32 v170, 16, v125
v_and_b32 v171, 0xffff0000, v125
v_add_f32 v172, v168, v170
v_add_f32 v173, v169, v171
v_sub_f32 v168, v168, v170
v_sub_f32 v169, v169, v171
v_mul_f32 v170, v162, v50
v_mul_f32 v171, v162, v66
v_mul_f32 v174, v172, v50
v_mul_f32 v175, v172, v66
v_fma_f32 v170, -v146, v98, v170
v_fmac_f32 v171, v146, v82
v_fma_f32 v174, -v173, v66, v174
v_fmac_f32 v175, v173, v50
v_fmac_f32 v174, v168, v170
v_fmac_f32 v175, v168, v171
v_fma_f32 v174, -v169, v171, v174
v_fmac_f32 v175, v169, v170
v_cvt_pk_bf16_f32 v34, v175, v174
v_lshlrev_b32 v176, 16, v126
v_and_b32 v177, 0xffff0000, v126
v_lshlrev_b32 v178, 16, v127
v_and_b32 v179, 0xffff0000, v127
v_add_f32 v180, v176, v178
v_add_f32 v181, v177, v179
v_sub_f32 v176, v176, v178
v_sub_f32 v177, v177, v179
v_mul_f32 v178, v163, v51
v_mul_f32 v179, v163, v67
v_mul_f32 v182, v180, v51
v_mul_f32 v183, v180, v67
v_fma_f32 v178, -v147, v99, v178
v_fmac_f32 v179, v147, v83
v_fma_f32 v182, -v181, v67, v182
v_fmac_f32 v183, v181, v51
v_fmac_f32 v182, v176, v178
v_fmac_f32 v183, v176, v179
v_fma_f32 v182, -v177, v179, v182
v_fmac_f32 v183, v177, v178
v_cvt_pk_bf16_f32 v35, v183, v182
v_lshlrev_b32 v168, 16, v128
v_and_b32 v169, 0xffff0000, v128
v_lshlrev_b32 v170, 16, v129
v_and_b32 v171, 0xffff0000, v129
v_add_f32 v172, v168, v170
v_add_f32 v173, v169, v171
v_sub_f32 v168, v168, v170
v_sub_f32 v169, v169, v171
v_mul_f32 v170, v164, v52
v_mul_f32 v171, v164, v68
v_mul_f32 v174, v172, v52
v_mul_f32 v175, v172, v68
v_fma_f32 v170, -v148, v100, v170
v_fmac_f32 v171, v148, v84
v_fma_f32 v174, -v173, v68, v174
v_fmac_f32 v175, v173, v52
v_fmac_f32 v174, v168, v170
v_fmac_f32 v175, v168, v171
v_fma_f32 v174, -v169, v171, v174
v_fmac_f32 v175, v169, v170
v_cvt_pk_bf16_f32 v36, v175, v174
v_lshlrev_b32 v176, 16, v130
v_and_b32 v177, 0xffff0000, v130
v_lshlrev_b32 v178, 16, v131
v_and_b32 v179, 0xffff0000, v131
v_add_f32 v180, v176, v178
v_add_f32 v181, v177, v179
v_sub_f32 v176, v176, v178
v_sub_f32 v177, v177, v179
v_mul_f32 v178, v165, v53
v_mul_f32 v179, v165, v69
v_mul_f32 v182, v180, v53
v_mul_f32 v183, v180, v69
v_fma_f32 v178, -v149, v101, v178
v_fmac_f32 v179, v149, v85
v_fma_f32 v182, -v181, v69, v182
v_fmac_f32 v183, v181, v53
v_fmac_f32 v182, v176, v178
v_fmac_f32 v183, v176, v179
v_fma_f32 v182, -v177, v179, v182
v_fmac_f32 v183, v177, v178
v_cvt_pk_bf16_f32 v37, v183, v182
v_lshlrev_b32 v168, 16, v132
v_and_b32 v169, 0xffff0000, v132
v_lshlrev_b32 v170, 16, v133
v_and_b32 v171, 0xffff0000, v133
v_add_f32 v172, v168, v170
v_add_f32 v173, v169, v171
v_sub_f32 v168, v168, v170
v_sub_f32 v169, v169, v171
v_mul_f32 v170, v166, v54
v_mul_f32 v171, v166, v70
v_mul_f32 v174, v172, v54
v_mul_f32 v175, v172, v70
v_fma_f32 v170, -v150, v102, v170
v_fmac_f32 v171, v150, v86
v_fma_f32 v174, -v173, v70, v174
v_fmac_f32 v175, v173, v54
v_fmac_f32 v174, v168, v170
v_fmac_f32 v175, v168, v171
v_fma_f32 v174, -v169, v171, v174
v_fmac_f32 v175, v169, v170
v_cvt_pk_bf16_f32 v38, v175, v174
v_lshlrev_b32 v176, 16, v134
v_and_b32 v177, 0xffff0000, v134
v_lshlrev_b32 v178, 16, v135
v_and_b32 v179, 0xffff0000, v135
v_add_f32 v180, v176, v178
v_add_f32 v181, v177, v179
v_sub_f32 v176, v176, v178
v_sub_f32 v177, v177, v179
v_mul_f32 v178, v167, v55
v_mul_f32 v179, v167, v71
v_mul_f32 v182, v180, v55
v_mul_f32 v183, v180, v71
v_fma_f32 v178, -v151, v103, v178
v_fmac_f32 v179, v151, v87
v_fma_f32 v182, -v181, v71, v182
v_fmac_f32 v183, v181, v55
v_fmac_f32 v182, v176, v178
v_fmac_f32 v183, v176, v179
v_fma_f32 v182, -v177, v179, v182
v_fmac_f32 v183, v177, v178
v_cvt_pk_bf16_f32 v39, v183, v182
v_mfma_f32_32x32x16_bf16 v[40:55], v[24:27], v[192:195], 0
v_mfma_f32_32x32x16_bf16 v[40:55], v[28:31], v[196:199], v[40:55]
v_mfma_f32_32x32x16_bf16 v[40:55], v[32:35], v[200:203], v[40:55]
v_mfma_f32_32x32x16_bf16 v[40:55], v[36:39], v[204:207], v[40:55]
v_mfma_f32_32x32x16_bf16 v[56:71], v[24:27], v[208:211], 0
v_mfma_f32_32x32x16_bf16 v[56:71], v[28:31], v[212:215], v[56:71]
v_mfma_f32_32x32x16_bf16 v[56:71], v[32:35], v[216:219], v[56:71]
v_mfma_f32_32x32x16_bf16 v[56:71], v[36:39], v[220:223], v[56:71]
s_nop 7
v_mul_f32 v168, v40, v224
v_mul_f32 v169, v40, v240
s_nop 1
v_fma_f32 v168, -v56, v240, v168
v_fmac_f32 v169, v56, v224
v_cvt_pk_bf16_f32 v24, v168, v169
v_mul_f32 v170, v41, v225
v_mul_f32 v171, v41, v241
v_fma_f32 v170, -v57, v241, v170
v_fmac_f32 v171, v57, v225
v_cvt_pk_bf16_f32 v25, v170, v171
v_mul_f32 v172, v42, v226
v_mul_f32 v173, v42, v242
v_fma_f32 v172, -v58, v242, v172
v_fmac_f32 v173, v58, v226
v_cvt_pk_bf16_f32 v26, v172, v173
v_mul_f32 v174, v43, v227
v_mul_f32 v175, v43, v243
v_fma_f32 v174, -v59, v243, v174
v_fmac_f32 v175, v59, v227
v_cvt_pk_bf16_f32 v27, v174, v175
v_mul_f32 v168, v44, v228
v_mul_f32 v169, v44, v244
v_fma_f32 v168, -v60, v244, v168
v_fmac_f32 v169, v60, v228
v_cvt_pk_bf16_f32 v28, v168, v169
v_mul_f32 v170, v45, v229
v_mul_f32 v171, v45, v245
v_fma_f32 v170, -v61, v245, v170
v_fmac_f32 v171, v61, v229
v_cvt_pk_bf16_f32 v29, v170, v171
v_mul_f32 v172, v46, v230
v_mul_f32 v173, v46, v246
v_fma_f32 v172, -v62, v246, v172
v_fmac_f32 v173, v62, v230
v_cvt_pk_bf16_f32 v30, v172, v173
v_mul_f32 v174, v47, v231
v_mul_f32 v175, v47, v247
v_fma_f32 v174, -v63, v247, v174
v_fmac_f32 v175, v63, v231
v_cvt_pk_bf16_f32 v31, v174, v175
v_mul_f32 v168, v48, v232
v_mul_f32 v169, v48, v248
v_fma_f32 v168, -v64, v248, v168
v_fmac_f32 v169, v64, v232
v_cvt_pk_bf16_f32 v32, v168, v169
v_mul_f32 v170, v49, v233
v_mul_f32 v171, v49, v249
v_fma_f32 v170, -v65, v249, v170
v_fmac_f32 v171, v65, v233
v_cvt_pk_bf16_f32 v33, v170, v171
v_mul_f32 v172, v50, v234
v_mul_f32 v173, v50, v250
v_fma_f32 v172, -v66, v250, v172
v_fmac_f32 v173, v66, v234
v_cvt_pk_bf16_f32 v34, v172, v173
v_mul_f32 v174, v51, v235
v_mul_f32 v175, v51, v251
v_fma_f32 v174, -v67, v251, v174
v_fmac_f32 v175, v67, v235
v_cvt_pk_bf16_f32 v35, v174, v175
v_mul_f32 v168, v52, v236
v_mul_f32 v169, v52, v252
v_fma_f32 v168, -v68, v252, v168
v_fmac_f32 v169, v68, v236
v_cvt_pk_bf16_f32 v36, v168, v169
v_mul_f32 v170, v53, v237
v_mul_f32 v171, v53, v253
v_fma_f32 v170, -v69, v253, v170
v_fmac_f32 v171, v69, v237
v_cvt_pk_bf16_f32 v37, v170, v171
v_mul_f32 v172, v54, v238
v_mul_f32 v173, v54, v254
v_fma_f32 v172, -v70, v254, v172
v_fmac_f32 v173, v70, v238
v_cvt_pk_bf16_f32 v38, v172, v173
v_mul_f32 v174, v55, v239
v_mul_f32 v175, v55, v255
v_fma_f32 v174, -v71, v255, v174
v_fmac_f32 v175, v71, v239
v_cvt_pk_bf16_f32 v39, v174, v175
v_mfma_f32_32x32x16_bf16 v[40:55], v[192:195], v[24:27], 0
v_mfma_f32_32x32x16_bf16 v[40:55], v[196:199], v[28:31], v[40:55]
v_mfma_f32_32x32x16_bf16 v[40:55], v[200:203], v[32:35], v[40:55]
v_mfma_f32_32x32x16_bf16 v[40:55], v[204:207], v[36:39], v[40:55]
v_mfma_f32_32x32x16_bf16 v[56:71], v[208:211], v[24:27], 0
v_mfma_f32_32x32x16_bf16 v[56:71], v[212:215], v[28:31], v[56:71]
v_mfma_f32_32x32x16_bf16 v[56:71], v[216:219], v[32:35], v[56:71]
v_mfma_f32_32x32x16_bf16 v[56:71], v[220:223], v[36:39], v[56:71]
s_lshr_b32 s64, s62, 16
L_lc24:
ds_read_b128 v[186:189], v184
s_waitcnt lgkmcnt(0)
v_min3_u32 v186, v186, v187, v188
v_min_u32 v186, v186, v189
s_nop 0
v_readfirstlane_b32 s92, v186
s_nop 0
s_cmp_ge_u32 s92, 8
s_cbranch_scc1 L_lcd25
s_sleep 1
s_branch L_lc24
L_lcd25:
s_nop 1
v_cvt_pk_bf16_f32 v24, v40, v56
v_xor_b32 v24, s64, v24
v_cvt_pk_bf16_f32 v25, v41, v57
v_xor_b32 v25, s64, v25
v_cvt_pk_bf16_f32 v26, v42, v58
v_xor_b32 v26, s64, v26
v_cvt_pk_bf16_f32 v27, v43, v59
v_xor_b32 v27, s64, v27
ds_write_b128 v15, v[24:27] offset:0
v_cvt_pk_bf16_f32 v28, v44, v60
v_xor_b32 v28, s64, v28
v_cvt_pk_bf16_f32 v29, v45, v61
v_xor_b32 v29, s64, v29
v_cvt_pk_bf16_f32 v30, v46, v62
v_xor_b32 v30, s64, v30
v_cvt_pk_bf16_f32 v31, v47, v63
v_xor_b32 v31, s64, v31
ds_write_b128 v15, v[28:31] offset:4096
v_cvt_pk_bf16_f32 v32, v48, v64
v_xor_b32 v32, s64, v32
v_cvt_pk_bf16_f32 v33, v49, v65
v_xor_b32 v33, s64, v33
v_cvt_pk_bf16_f32 v34, v50, v66
v_xor_b32 v34, s64, v34
v_cvt_pk_bf16_f32 v35, v51, v67
v_xor_b32 v35, s64, v35
ds_write_b128 v15, v[32:35] offset:8192
v_cvt_pk_bf16_f32 v36, v52, v68
v_xor_b32 v36, s64, v36
v_cvt_pk_bf16_f32 v37, v53, v69
v_xor_b32 v37, s64, v37
v_cvt_pk_bf16_f32 v38, v54, v70
v_xor_b32 v38, s64, v38
v_cvt_pk_bf16_f32 v39, v55, v71
v_xor_b32 v39, s64, v39
ds_write_b128 v15, v[36:39] offset:12288
s_waitcnt lgkmcnt(0)
v_mov_b32 v190, 9
s_mov_b64 exec, 1
ds_write_b32 v185, v190
s_mov_b64 exec, -1
L_lc26:
ds_read_b128 v[186:189], v184
s_waitcnt lgkmcnt(0)
v_min3_u32 v186, v186, v187, v188
v_min_u32 v186, v186, v189
s_nop 0
v_readfirstlane_b32 s92, v186
s_nop 0
s_cmp_ge_u32 s92, 9
s_cbranch_scc1 L_lcd27
s_sleep 1
s_branch L_lc26
L_lcd27:
ds_read_b128 v[24:27], v18 offset:0
ds_read_b128 v[28:31], v18 offset:1024
ds_read_b128 v[32:35], v18 offset:2048
ds_read_b128 v[36:39], v18 offset:3072
s_mov_b32 s64, 0
s_waitcnt lgkmcnt(3)
buffer_store_dwordx4 v[24:27], v14, s[56:59], s64 offen sc1
s_mov_b32 s64, 262144
s_waitcnt lgkmcnt(2)
buffer_store_dwordx4 v[28:31], v14, s[56:59], s64 offen sc1
s_mov_b32 s64, 524288
s_waitcnt lgkmcnt(1)
buffer_store_dwordx4 v[32:35], v14, s[56:59], s64 offen sc1
s_mov_b32 s64, 786432
s_waitcnt lgkmcnt(0)
buffer_store_dwordx4 v[36:39], v14, s[56:59], s64 offen sc1
s_lshl_b32 s64, s67, 14
s_add_u32 s40, s28, s64
s_addc_u32 s41, s29, 0
s_mov_b32 s42, 16384
s_mov_b32 s43, 0x20000
v_and_b32 v8, 31, v1
v_lshrrev_b32 v9, 5, v1
v_lshlrev_b32 v14, 2, v8
v_lshl_add_u32 v14, v9, 9, v14
s_mov_b32 s64, 0x35000000
v_mul_f32 v224, s64, v224
v_mul_f32 v225, s64, v225
v_mul_f32 v226, s64, v226
v_mul_f32 v227, s64, v227
v_mul_f32 v228, s64, v228
v_mul_f32 v229, s64, v229
v_mul_f32 v230, s64, v230
v_mul_f32 v231, s64, v231
v_mul_f32 v232, s64, v232
v_mul_f32 v233, s64, v233
v_mul_f32 v234, s64, v234
v_mul_f32 v235, s64, v235
v_mul_f32 v236, s64, v236
v_mul_f32 v237, s64, v237
v_mul_f32 v238, s64, v238
v_mul_f32 v239, s64, v239
v_mul_f32 v240, s64, v240
v_mul_f32 v241, s64, v241
v_mul_f32 v242, s64, v242
v_mul_f32 v243, s64, v243
v_mul_f32 v244, s64, v244
v_mul_f32 v245, s64, v245
v_mul_f32 v246, s64, v246
v_mul_f32 v247, s64, v247
v_mul_f32 v248, s64, v248
v_mul_f32 v249, s64, v249
v_mul_f32 v250, s64, v250
v_mul_f32 v251, s64, v251
v_mul_f32 v252, s64, v252
v_mul_f32 v253, s64, v253
v_mul_f32 v254, s64, v254
v_mul_f32 v255, s64, v255
s_waitcnt vmcnt(0)
v_mov_b32 v190, 10
s_mov_b64 exec, 1
ds_write_b32 v185, v190
s_mov_b64 exec, -1
s_cmp_lg_u32 s66, 0
s_cbranch_scc1 L_ph28
L_lc29:
ds_read_b128 v[186:189], v184
s_waitcnt lgkmcnt(0)
v_min3_u32 v186, v186, v187, v188
v_min_u32 v186, v186, v189
s_nop 0
v_readfirstlane_b32 s92, v186
s_nop 0
s_cmp_ge_u32 s92, 10
s_cbranch_scc1 L_lcd30
s_sleep 1
s_branch L_lc29
L_lcd30:
s_and_b32 s64, s2, 15
s_lshl_b32 s65, s64, 7
s_add_u32 s65, s65, 6144
s_add_u32 s90, s32, s65
s_addc_u32 s91, s33, 0
s_mov_b32 s65, 1
s_atomic_add s65, s[90:91], 0x0 glc
s_lshl_b32 s64, s64, 2
s_add_u32 s64, s64, 548864
v_lshl_add_u32 v20, v1, 7, s64
v_mov_b32 v21, s37
s_add_u32 s4, s32, s64
s_addc_u32 s5, s33, 0
s_and_b32 s64, s2, 31
s_lshl_b32 s64, s64, 7
s_add_u32 s64, s64, 548864
s_waitcnt lgkmcnt(0)
s_cmp_lg_u32 s65, 15
s_cbranch_scc1 L_sg31
s_atomic_swap s37, s[4:5], 0x0
s_atomic_swap s37, s[4:5], 0x80
s_atomic_swap s37, s[4:5], 0x100
s_atomic_swap s37, s[4:5], 0x180
s_atomic_swap s37, s[4:5], 0x200
s_atomic_swap s37, s[4:5], 0x280
s_atomic_swap s37, s[4:5], 0x300
s_atomic_swap s37, s[4:5], 0x380
s_atomic_swap s37, s[4:5], 0x400
s_atomic_swap s37, s[4:5], 0x480
s_atomic_swap s37, s[4:5], 0x500
s_atomic_swap s37, s[4:5], 0x580
s_atomic_swap s37, s[4:5], 0x600
s_atomic_swap s37, s[4:5], 0x680
s_atomic_swap s37, s[4:5], 0x700
s_atomic_swap s37, s[4:5], 0x780
s_atomic_swap s37, s[4:5], 0x800
s_atomic_swap s37, s[4:5], 0x880
s_atomic_swap s37, s[4:5], 0x900
s_atomic_swap s37, s[4:5], 0x980
s_atomic_swap s37, s[4:5], 0xa00
s_atomic_swap s37, s[4:5], 0xa80
s_atomic_swap s37, s[4:5], 0xb00
s_atomic_swap s37, s[4:5], 0xb80
s_atomic_swap s37, s[4:5], 0xc00
s_atomic_swap s37, s[4:5], 0xc80
s_atomic_swap s37, s[4:5], 0xd00
s_atomic_swap s37, s[4:5], 0xd80
s_atomic_swap s37, s[4:5], 0xe00
s_atomic_swap s37, s[4:5], 0xe80
s_atomic_swap s37, s[4:5], 0xf00
s_atomic_swap s37, s[4:5], 0xf80
s_waitcnt lgkmcnt(0)
L_sg31:
s_add_u32 s90, s32, s64
s_addc_u32 s91, s33, 0
s_mov_b32 s64, s37
s_mov_b32 s65, s37
s_mov_b32 s92, 0
s_branch L_sp32
L_nok33:
s_add_u32 s92, s92, 1
s_cmp_ge_u32 s92, 200000
s_cbranch_scc1 L_ph28
s_sleep 2
L_sp32:
s_load_dwordx16 s[4:19], s[90:91], 0x0 glc
s_waitcnt lgkmcnt(0)
s_cmp_eq_u64 s[4:5], s[64:65]
s_cbranch_scc0 L_nok33
s_cmp_eq_u64 s[6:7], s[64:65]
s_cbranch_scc0 L_nok33
s_cmp_eq_u64 s[8:9], s[64:65]
s_cbranch_scc0 L_nok33
s_cmp_eq_u64 s[10:11], s[64:65]
s_cbranch_scc0 L_nok33
s_cmp_eq_u64 s[12:13], s[64:65]
s_cbranch_scc0 L_nok33
s_cmp_eq_u64 s[14:15], s[64:65]
s_cbranch_scc0 L_nok33
s_cmp_eq_u64 s[16:17], s[64:65]
s_cbranch_scc0 L_nok33
s_cmp_eq_u64 s[18:19], s[64:65]
s_cbranch_scc0 L_nok33
L_ph28:
v_mov_b32 v190, 11
s_mov_b64 exec, 1
ds_write_b32 v185, v190
s_mov_b64 exec, -1
L_lc34:
ds_read_b128 v[186:189], v184
s_waitcnt lgkmcnt(0)
v_min3_u32 v186, v186, v187, v188
v_min_u32 v186, v186, v189
s_nop 0
v_readfirstlane_b32 s92, v186
s_nop 0
s_cmp_ge_u32 s92, 11
s_cbranch_scc1 L_lcd35
s_sleep 1
s_branch L_lc34
L_lcd35:
s_setprio 3
s_mov_b32 m0, s68
s_nop 0
buffer_load_dwordx4 v7, s[44:47], 0 offen offset:0 sc1 lds
buffer_load_dwordx4 v7, s[44:47], 0 offen offset:1024 sc1 lds
buffer_load_dwordx4 v7, s[44:47], 0 offen offset:2048 sc1 lds
buffer_load_dwordx4 v7, s[44:47], 0 offen offset:3072 sc1 lds
s_waitcnt vmcnt(0)
v_mov_b32 v190, 12
s_mov_b64 exec, 1
ds_write_b32 v185, v190
s_mov_b64 exec, -1
L_lc36:
ds_read_b128 v[186:189], v184
s_waitcnt lgkmcnt(0)
v_min3_u32 v186, v186, v187, v188
v_min_u32 v186, v186, v189
s_nop 0
v_readfirstlane_b32 s92, v186
s_nop 0
s_cmp_ge_u32 s92, 12
s_cbranch_scc1 L_lcd37
s_sleep 1
s_branch L_lc36
L_lcd37:
ds_read_b32 v24, v4 offset:0
ds_read_b32 v25, v4 offset:1024
ds_read_b32 v26, v4 offset:2048
ds_read_b32 v27, v4 offset:3072
ds_read_b32 v28, v4 offset:8192
ds_read_b32 v29, v4 offset:9216
ds_read_b32 v30, v4 offset:10240
ds_read_b32 v31, v4 offset:11264
ds_read_b32 v32, v6 offset:0
ds_read_b32 v33, v5 offset:10240
ds_read_b32 v34, v5 offset:9216
ds_read_b32 v35, v5 offset:8192
ds_read_b32 v36, v5 offset:3072
ds_read_b32 v37, v5 offset:2048
ds_read_b32 v38, v5 offset:1024
ds_read_b32 v39, v5 offset:0
s_waitcnt lgkmcnt(0)
v_mfma_f32_32x32x16_bf16 v[40:55], v[24:27], v[192:195], 0
v_mfma_f32_32x32x16_bf16 v[40:55], v[28:31], v[196:199], v[40:55]
v_mfma_f32_32x32x16_bf16 v[40:55], v[32:35], v[200:203], v[40:55]
v_mfma_f32_32x32x16_bf16 v[40:55], v[36:39], v[204:207], v[40:55]
v_mfma_f32_32x32x16_bf16 v[56:71], v[24:27], v[208:211], 0
v_mfma_f32_32x32x16_bf16 v[56:71], v[28:31], v[212:215], v[56:71]
v_mfma_f32_32x32x16_bf16 v[56:71], v[32:35], v[216:219], v[56:71]
v_mfma_f32_32x32x16_bf16 v[56:71], v[36:39], v[220:223], v[56:71]
s_nop 7
v_mul_f32 v168, v40, v224
v_mul_f32 v169, v40, v240
s_nop 1
v_fma_f32 v168, -v56, v240, v168
v_fmac_f32 v169, v56, v224
v_cvt_pk_bf16_f32 v24, v168, v169
v_mul_f32 v170, v41, v225
v_mul_f32 v171, v41, v241
v_fma_f32 v170, -v57, v241, v170
v_fmac_f32 v171, v57, v225
v_cvt_pk_bf16_f32 v25, v170, v171
v_mul_f32 v172, v42, v226
v_mul_f32 v173, v42, v242
v_fma_f32 v172, -v58, v242, v172
v_fmac_f32 v173, v58, v226
v_cvt_pk_bf16_f32 v26, v172, v173
v_mul_f32 v174, v43, v227
v_mul_f32 v175, v43, v243
v_fma_f32 v174, -v59, v243, v174
v_fmac_f32 v175, v59, v227
v_cvt_pk_bf16_f32 v27, v174, v175
v_mul_f32 v168, v44, v228
v_mul_f32 v169, v44, v244
v_fma_f32 v168, -v60, v244, v168
v_fmac_f32 v169, v60, v228
v_cvt_pk_bf16_f32 v28, v168, v169
v_mul_f32 v170, v45, v229
v_mul_f32 v171, v45, v245
v_fma_f32 v170, -v61, v245, v170
v_fmac_f32 v171, v61, v229
v_cvt_pk_bf16_f32 v29, v170, v171
v_mul_f32 v172, v46, v230
v_mul_f32 v173, v46, v246
v_fma_f32 v172, -v62, v246, v172
v_fmac_f32 v173, v62, v230
v_cvt_pk_bf16_f32 v30, v172, v173
v_mul_f32 v174, v47, v231
v_mul_f32 v175, v47, v247
v_fma_f32 v174, -v63, v247, v174
v_fmac_f32 v175, v63, v231
v_cvt_pk_bf16_f32 v31, v174, v175
v_mul_f32 v168, v48, v232
v_mul_f32 v169, v48, v248
v_fma_f32 v168, -v64, v248, v168
v_fmac_f32 v169, v64, v232
v_cvt_pk_bf16_f32 v32, v168, v169
v_mul_f32 v170, v49, v233
v_mul_f32 v171, v49, v249
v_fma_f32 v170, -v65, v249, v170
v_fmac_f32 v171, v65, v233
v_cvt_pk_bf16_f32 v33, v170, v171
v_mul_f32 v172, v50, v234
v_mul_f32 v173, v50, v250
v_fma_f32 v172, -v66, v250, v172
v_fmac_f32 v173, v66, v234
v_cvt_pk_bf16_f32 v34, v172, v173
v_mul_f32 v174, v51, v235
v_mul_f32 v175, v51, v251
v_fma_f32 v174, -v67, v251, v174
v_fmac_f32 v175, v67, v235
v_cvt_pk_bf16_f32 v35, v174, v175
v_mul_f32 v168, v52, v236
v_mul_f32 v169, v52, v252
v_fma_f32 v168, -v68, v252, v168
v_fmac_f32 v169, v68, v236
v_cvt_pk_bf16_f32 v36, v168, v169
v_mul_f32 v170, v53, v237
v_mul_f32 v171, v53, v253
v_fma_f32 v170, -v69, v253, v170
v_fmac_f32 v171, v69, v237
v_cvt_pk_bf16_f32 v37, v170, v171
v_mul_f32 v172, v54, v238
v_mul_f32 v173, v54, v254
v_fma_f32 v172, -v70, v254, v172
v_fmac_f32 v173, v70, v238
v_cvt_pk_bf16_f32 v38, v172, v173
v_mul_f32 v174, v55, v239
v_mul_f32 v175, v55, v255
v_fma_f32 v174, -v71, v255, v174
v_fmac_f32 v175, v71, v239
v_cvt_pk_bf16_f32 v39, v174, v175
v_mfma_f32_32x32x16_bf16 v[40:55], v[192:195], v[24:27], 0
v_mfma_f32_32x32x16_bf16 v[40:55], v[196:199], v[28:31], v[40:55]
v_mfma_f32_32x32x16_bf16 v[40:55], v[200:203], v[32:35], v[40:55]
v_mfma_f32_32x32x16_bf16 v[40:55], v[204:207], v[36:39], v[40:55]
v_mfma_f32_32x32x16_bf16 v[56:71], v[208:211], v[24:27], 0
v_mfma_f32_32x32x16_bf16 v[56:71], v[212:215], v[28:31], v[56:71]
v_mfma_f32_32x32x16_bf16 v[56:71], v[216:219], v[32:35], v[56:71]
v_mfma_f32_32x32x16_bf16 v[56:71], v[220:223], v[36:39], v[56:71]
s_movk_i32 s64, 0x2000
s_nop 10
v_cvt_pk_bf16_f32 v73, v56, v40
v_lshlrev_b32 v72, 16, v73
v_and_b32 v73, 0xffff0000, v73
buffer_store_dword v72, v14, s[40:43], 0 offen offset:0 nt
buffer_store_dword v73, v14, s[40:43], s64 offen offset:0 nt
v_cvt_pk_bf16_f32 v75, v57, v41
v_lshlrev_b32 v74, 16, v75
v_and_b32 v75, 0xffff0000, v75
buffer_store_dword v74, v14, s[40:43], 0 offen offset:128 nt
buffer_store_dword v75, v14, s[40:43], s64 offen offset:128 nt
v_cvt_pk_bf16_f32 v77, v58, v42
v_lshlrev_b32 v76, 16, v77
v_and_b32 v77, 0xffff0000, v77
buffer_store_dword v76, v14, s[40:43], 0 offen offset:256 nt
buffer_store_dword v77, v14, s[40:43], s64 offen offset:256 nt
v_cvt_pk_bf16_f32 v79, v59, v43
v_lshlrev_b32 v78, 16, v79
v_and_b32 v79, 0xffff0000, v79
buffer_store_dword v78, v14, s[40:43], 0 offen offset:384 nt
buffer_store_dword v79, v14, s[40:43], s64 offen offset:384 nt
v_cvt_pk_bf16_f32 v81, v60, v44
v_lshlrev_b32 v80, 16, v81
v_and_b32 v81, 0xffff0000, v81
buffer_store_dword v80, v14, s[40:43], 0 offen offset:1024 nt
buffer_store_dword v81, v14, s[40:43], s64 offen offset:1024 nt
v_cvt_pk_bf16_f32 v83, v61, v45
v_lshlrev_b32 v82, 16, v83
v_and_b32 v83, 0xffff0000, v83
buffer_store_dword v82, v14, s[40:43], 0 offen offset:1152 nt
buffer_store_dword v83, v14, s[40:43], s64 offen offset:1152 nt
v_cvt_pk_bf16_f32 v85, v62, v46
v_lshlrev_b32 v84, 16, v85
v_and_b32 v85, 0xffff0000, v85
buffer_store_dword v84, v14, s[40:43], 0 offen offset:1280 nt
buffer_store_dword v85, v14, s[40:43], s64 offen offset:1280 nt
v_cvt_pk_bf16_f32 v87, v63, v47
v_lshlrev_b32 v86, 16, v87
v_and_b32 v87, 0xffff0000, v87
buffer_store_dword v86, v14, s[40:43], 0 offen offset:1408 nt
buffer_store_dword v87, v14, s[40:43], s64 offen offset:1408 nt
v_cvt_pk_bf16_f32 v89, v64, v48
v_lshlrev_b32 v88, 16, v89
v_and_b32 v89, 0xffff0000, v89
buffer_store_dword v88, v14, s[40:43], 0 offen offset:2048 nt
buffer_store_dword v89, v14, s[40:43], s64 offen offset:2048 nt
v_cvt_pk_bf16_f32 v91, v65, v49
v_lshlrev_b32 v90, 16, v91
v_and_b32 v91, 0xffff0000, v91
buffer_store_dword v90, v14, s[40:43], 0 offen offset:2176 nt
buffer_store_dword v91, v14, s[40:43], s64 offen offset:2176 nt
v_cvt_pk_bf16_f32 v93, v66, v50
v_lshlrev_b32 v92, 16, v93
v_and_b32 v93, 0xffff0000, v93
buffer_store_dword v92, v14, s[40:43], 0 offen offset:2304 nt
buffer_store_dword v93, v14, s[40:43], s64 offen offset:2304 nt
v_cvt_pk_bf16_f32 v95, v67, v51
v_lshlrev_b32 v94, 16, v95
v_and_b32 v95, 0xffff0000, v95
buffer_store_dword v94, v14, s[40:43], 0 offen offset:2432 nt
buffer_store_dword v95, v14, s[40:43], s64 offen offset:2432 nt
v_cvt_pk_bf16_f32 v97, v68, v52
v_lshlrev_b32 v96, 16, v97
v_and_b32 v97, 0xffff0000, v97
buffer_store_dword v96, v14, s[40:43], 0 offen offset:3072 nt
buffer_store_dword v97, v14, s[40:43], s64 offen offset:3072 nt
v_cvt_pk_bf16_f32 v99, v69, v53
v_lshlrev_b32 v98, 16, v99
v_and_b32 v99, 0xffff0000, v99
buffer_store_dword v98, v14, s[40:43], 0 offen offset:3200 nt
buffer_store_dword v99, v14, s[40:43], s64 offen offset:3200 nt
v_cvt_pk_bf16_f32 v101, v70, v54
v_lshlrev_b32 v100, 16, v101
v_and_b32 v101, 0xffff0000, v101
buffer_store_dword v100, v14, s[40:43], 0 offen offset:3328 nt
buffer_store_dword v101, v14, s[40:43], s64 offen offset:3328 nt
v_cvt_pk_bf16_f32 v103, v71, v55
v_lshlrev_b32 v102, 16, v103
v_and_b32 v103, 0xffff0000, v103
buffer_store_dword v102, v14, s[40:43], 0 offen offset:3456 nt
buffer_store_dword v103, v14, s[40:43], s64 offen offset:3456 nt
s_endpgm
L_concat_heads__spectral_gfnet__ssm_conv_s5__prompt_kernel_gemm:
s_lshr_b32 s68, s34, 1
s_and_b32 s66, s34, 1
v_and_b32 v6, 31, v1
v_lshrrev_b32 v5, 5, v1
v_and_b32 v4, 0x13, v6
v_bfe_u32 v7, v6, 2, 1
v_lshl_or_b32 v4, v7, 3, v4
v_bfe_u32 v7, v6, 3, 1
v_lshl_or_b32 v4, v7, 2, v4
s_lshl_b32 s60, s36, 6
s_lshl_b32 s61, s66, 5
s_add_u32 s60, s60, s61
v_add_u32 v4, s60, v4
v_lshlrev_b32 v7, 1, v4
v_lshlrev_b32 v11, 4, v1
s_waitcnt lgkmcnt(0)
global_load_ushort v8, v7, s[12:13]
global_load_ushort v9, v7, s[14:15]
global_load_ushort v10, v7, s[24:25]
s_lshl_b32 s60, s2, 3
s_add_u32 s60, s60, s34
s_cmp_lg_u32 s60, 1
s_cbranch_scc1 L_nn38
s_load_dword s60, s[32:33], 0
v_mov_b32 v16, 0
v_and_b32 v17, 31, v1
v_lshlrev_b32 v17, 7, v17
v_add_u32 v17, 4096, v17
global_store_dword v17, v16, s[32:33] sc1
s_waitcnt vmcnt(0) lgkmcnt(0)
s_add_u32 s60, s60, 1
s_cmp_eq_u32 s60, 0
s_cselect_b32 s60, 1, s60
v_mov_b32 v17, s60
s_mov_b64 exec, 1
global_store_dword v16, v17, s[30:31] sc1
global_store_dword v16, v17, s[32:33] offset:0
s_mov_b64 exec, -1
L_nn38:
s_cmp_lg_u32 s34, 0
s_cbranch_scc1 L_pf39
s_lshr_b32 s60, s2, 3
s_lshl_b32 s60, s60, 11
v_and_b32 v12, 15, v1
v_lshl_add_u32 v12, v12, 7, s60
v_min_u32 v12, L_concat_heads__spectral_gfnet__ssm_conv_s5__prompt_kernel_end-concat_heads__spectral_gfnet__ssm_conv_s5__prompt_kernel, v12
s_getpc_b64 s[60:61]
L_pc40:
s_sub_u32 s60, s60, L_pc40-concat_heads__spectral_gfnet__ssm_conv_s5__prompt_kernel
s_subb_u32 s61, s61, 0
global_load_dword v247, v12, s[60:61]
L_pf39:
v_bfe_u32 v7, v6, 1, 3
v_xor_b32 v7, v7, v5
v_lshlrev_b32 v7, 4, v7
v_lshl_add_u32 v7, v6, 7, v7
s_lshl_b32 s60, s68, 13
s_lshl_b32 s61, s66, 13
s_add_u32 s61, s61, 16384
v_xor_b32 v12, 0, v7
v_add_u32 v128, s60, v12
v_add_u32 v132, s61, v12
v_add_u32 v136, 0x10000, v128
v_add_u32 v140, 0x10000, v132
v_xor_b32 v12, 32, v7
v_add_u32 v129, s60, v12
v_add_u32 v133, s61, v12
v_add_u32 v137, 0x10000, v129
v_add_u32 v141, 0x10000, v133
v_xor_b32 v12, 64, v7
v_add_u32 v130, s60, v12
v_add_u32 v134, s61, v12
v_add_u32 v138, 0x10000, v130
v_add_u32 v142, 0x10000, v134
v_xor_b32 v12, 96, v7
v_add_u32 v131, s60, v12
v_add_u32 v135, s61, v12
v_add_u32 v139, 0x10000, v131
v_add_u32 v143, 0x10000, v135
v_mov_b64 v[64:65], 0
v_mov_b64 v[66:67], 0
v_mov_b64 v[68:69], 0
v_mov_b64 v[70:71], 0
v_mov_b64 v[72:73], 0
v_mov_b64 v[74:75], 0
v_mov_b64 v[76:77], 0
v_mov_b64 v[78:79], 0
v_mov_b64 v[80:81], 0
v_mov_b64 v[82:83], 0
v_mov_b64 v[84:85], 0
v_mov_b64 v[86:87], 0
v_mov_b64 v[88:89], 0
v_mov_b64 v[90:91], 0
v_mov_b64 v[92:93], 0
v_mov_b64 v[94:95], 0
v_mov_b64 v[96:97], 0
v_mov_b64 v[98:99], 0
v_mov_b64 v[100:101], 0
v_mov_b64 v[102:103], 0
v_mov_b64 v[104:105], 0
v_mov_b64 v[106:107], 0
v_mov_b64 v[108:109], 0
v_mov_b64 v[110:111], 0
v_mov_b64 v[112:113], 0
v_mov_b64 v[114:115], 0
v_mov_b64 v[116:117], 0
v_mov_b64 v[118:119], 0
v_mov_b64 v[120:121], 0
v_mov_b64 v[122:123], 0
v_mov_b64 v[124:125], 0
v_mov_b64 v[126:127], 0
v_mov_b32 v34, 126976
v_mov_b64 v[36:37], 0
v_mov_b64 v[38:39], 0
s_mov_b64 exec, 1
ds_write_b128 v34, v[36:39]
ds_write_b128 v34, v[36:39] offset:16
s_mov_b64 exec, -1
v_lshlrev_b32 v12, 4, v5
v_sub_u32 v12, v6, v12
v_mov_b32 v13, 0x3f80
v_mov_b32 v14, 1.0
v_cmp_eq_u32 vcc, 0, v12
v_cmp_eq_u32 s[60:61], 8, v12
s_nop 0
v_cndmask_b32 v248, 0, v13, vcc
v_cndmask_b32 v248, v248, v14, s[60:61]
v_cmp_eq_u32 vcc, 1, v12
v_cmp_eq_u32 s[60:61], 9, v12
s_nop 0
v_cndmask_b32 v249, 0, v13, vcc
v_cndmask_b32 v249, v249, v14, s[60:61]
v_cmp_eq_u32 vcc, 2, v12
v_cmp_eq_u32 s[60:61], 10, v12
s_nop 0
v_cndmask_b32 v250, 0, v13, vcc
v_cndmask_b32 v250, v250, v14, s[60:61]
v_cmp_eq_u32 vcc, 3, v12
v_cmp_eq_u32 s[60:61], 11, v12
s_nop 0
v_cndmask_b32 v251, 0, v13, vcc
v_cndmask_b32 v251, v251, v14, s[60:61]
v_cmp_eq_u32 vcc, 4, v12
v_cmp_eq_u32 s[60:61], 12, v12
s_nop 0
v_cndmask_b32 v252, 0, v13, vcc
v_cndmask_b32 v252, v252, v14, s[60:61]
v_cmp_eq_u32 vcc, 5, v12
v_cmp_eq_u32 s[60:61], 13, v12
s_nop 0
v_cndmask_b32 v253, 0, v13, vcc
v_cndmask_b32 v253, v253, v14, s[60:61]
v_cmp_eq_u32 vcc, 6, v12
v_cmp_eq_u32 s[60:61], 14, v12
s_nop 0
v_cndmask_b32 v254, 0, v13, vcc
v_cndmask_b32 v254, v254, v14, s[60:61]
v_cmp_eq_u32 vcc, 7, v12
v_cmp_eq_u32 s[60:61], 15, v12
s_nop 0
v_cndmask_b32 v255, 0, v13, vcc
v_cndmask_b32 v255, v255, v14, s[60:61]
s_add_u32 s40, s32, 65536
s_addc_u32 s41, s33, 0
s_mov_b32 s42, 262144
s_mov_b32 s43, 0x20000
s_add_u32 s44, s32, 1048576
s_addc_u32 s45, s33, 0
s_mov_b32 s46, 8388608
s_mov_b32 s47, 0x20000
s_waitcnt vmcnt(0)
v_lshlrev_b32 v8, 16, v8
v_lshlrev_b32 v9, 16, v9
v_lshlrev_b32 v10, 16, v10
v_mul_f32 v10, 0x3fb8aa3b, v10
v_exp_f32 v10, v10
s_nop 0
v_cvt_pk_bf16_f32 v10, v10, v10
v_lshlrev_b32 v10, 16, v10
v_mul_f32 v12, v10, v8
v_mul_f32 v13, v10, v9
v_mul_f32 v12, 0x3fb8aa3b, v12
v_exp_f32 v12, v12
v_mul_f32 v13, 0.15915494, v13
v_rndne_f32 v14, v13
v_sub_f32 v13, v13, v14
v_cos_f32 v14, v13
v_sin_f32 v15, v13
v_mul_f32 v24, v12, v14
v_mul_f32 v25, v12, v15
v_add_f32 v12, -1.0, v24
v_mul_f32 v13, v8, v8
v_fma_f32 v13, v9, v9, v13
v_rcp_f32 v13, v13
s_nop 0
v_add_f32 v13, v13, v13
v_mul_f32 v14, v12, v8
v_fma_f32 v14, v25, v9, v14
v_mul_f32 v26, v14, v13
v_mul_f32 v14, v25, v8
v_fma_f32 v14, -v12, v9, v14
v_mul_f32 v27, v14, v13
v_mul_f32 v12, v25, v25
v_mul_f32 v13, v24, v25
v_fma_f32 v28, v24, v24, -v12
v_add_f32 v29, v13, v13
v_mul_f32 v12, v29, v29
v_mul_f32 v13, v28, v29
v_fma_f32 v28, v28, v28, -v12
v_add_f32 v29, v13, v13
v_mul_f32 v12, v29, v29
v_mul_f32 v13, v28, v29
v_fma_f32 v28, v28, v28, -v12
v_add_f32 v29, v13, v13
v_mul_f32 v12, v29, v29
v_mul_f32 v13, v28, v29
v_fma_f32 v28, v28, v28, -v12
v_add_f32 v29, v13, v13
v_mul_f32 v12, v29, v29
v_mul_f32 v13, v28, v29
v_fma_f32 v20, v28, v28, -v12
v_add_f32 v21, v13, v13
v_mul_f32 v12, v21, v21
v_mul_f32 v13, v20, v21
v_fma_f32 v30, v20, v20, -v12
v_add_f32 v31, v13, v13
v_mul_f32 v12, v31, v31
v_mul_f32 v13, v30, v31
v_fma_f32 v30, v30, v30, -v12
v_add_f32 v31, v13, v13
v_mul_f32 v12, v31, v31
v_mul_f32 v13, v30, v31
v_fma_f32 v2, v30, v30, -v12
v_add_f32 v3, v13, v13
s_waitcnt lgkmcnt(0)
s_barrier
ds_read_b128 v[32:35], v128 offset:0
ds_read_b128 v[36:39], v132 offset:0
ds_read_b128 v[40:43], v132 offset:4096
ds_read_b128 v[44:47], v128 offset:4096
s_waitcnt lgkmcnt(2)
v_mfma_f32_32x32x16_bf16 v[64:79], v[32:35], v[36:39], v[64:79]
ds_read_b128 v[48:51], v129 offset:0
ds_read_b128 v[52:55], v133 offset:0
s_waitcnt lgkmcnt(3)
v_mfma_f32_32x32x16_bf16 v[80:95], v[32:35], v[40:43], v[80:95]
ds_read_b128 v[56:59], v133 offset:4096
ds_read_b128 v[60:63], v129 offset:4096
s_waitcnt lgkmcnt(4)
v_mfma_f32_32x32x16_bf16 v[96:111], v[44:47], v[36:39], v[96:111]
v_mfma_f32_32x32x16_bf16 v[112:127], v[44:47], v[40:43], v[112:127]
s_waitcnt lgkmcnt(2)
v_mfma_f32_32x32x16_bf16 v[64:79], v[48:51], v[52:55], v[64:79]
ds_read_b128 v[32:35], v130 offset:0
ds_read_b128 v[36:39], v134 offset:0
s_waitcnt lgkmcnt(3)
v_mfma_f32_32x32x16_bf16 v[80:95], v[48:51], v[56:59], v[80:95]
ds_read_b128 v[40:43], v134 offset:4096
ds_read_b128 v[44:47], v130 offset:4096
s_waitcnt lgkmcnt(4)
v_mfma_f32_32x32x16_bf16 v[96:111], v[60:63], v[52:55], v[96:111]
v_mfma_f32_32x32x16_bf16 v[112:127], v[60:63], v[56:59], v[112:127]
s_waitcnt lgkmcnt(2)
v_mfma_f32_32x32x16_bf16 v[64:79], v[32:35], v[36:39], v[64:79]
ds_read_b128 v[48:51], v131 offset:0
ds_read_b128 v[52:55], v135 offset:0
s_waitcnt lgkmcnt(3)
v_mfma_f32_32x32x16_bf16 v[80:95], v[32:35], v[40:43], v[80:95]
ds_read_b128 v[56:59], v135 offset:4096
ds_read_b128 v[60:63], v131 offset:4096
s_waitcnt lgkmcnt(4)
v_mfma_f32_32x32x16_bf16 v[96:111], v[44:47], v[36:39], v[96:111]
v_mfma_f32_32x32x16_bf16 v[112:127], v[44:47], v[40:43], v[112:127]
s_waitcnt lgkmcnt(0)
s_barrier
v_mfma_f32_32x32x16_bf16 v[64:79], v[48:51], v[52:55], v[64:79]
ds_read_b128 v[32:35], v128 offset:32768
ds_read_b128 v[36:39], v132 offset:32768
v_mfma_f32_32x32x16_bf16 v[80:95], v[48:51], v[56:59], v[80:95]
ds_read_b128 v[40:43], v132 offset:36864
ds_read_b128 v[44:47], v128 offset:36864
v_mfma_f32_32x32x16_bf16 v[96:111], v[60:63], v[52:55], v[96:111]
v_mfma_f32_32x32x16_bf16 v[112:127], v[60:63], v[56:59], v[112:127]
s_waitcnt lgkmcnt(2)
v_mfma_f32_32x32x16_bf16 v[64:79], v[32:35], v[36:39], v[64:79]
ds_read_b128 v[48:51], v129 offset:32768
ds_read_b128 v[52:55], v133 offset:32768
s_waitcnt lgkmcnt(3)
v_mfma_f32_32x32x16_bf16 v[80:95], v[32:35], v[40:43], v[80:95]
ds_read_b128 v[56:59], v133 offset:36864
ds_read_b128 v[60:63], v129 offset:36864
s_waitcnt lgkmcnt(4)
v_mfma_f32_32x32x16_bf16 v[96:111], v[44:47], v[36:39], v[96:111]
v_mfma_f32_32x32x16_bf16 v[112:127], v[44:47], v[40:43], v[112:127]
s_waitcnt lgkmcnt(2)
v_mfma_f32_32x32x16_bf16 v[64:79], v[48:51], v[52:55], v[64:79]
ds_read_b128 v[32:35], v130 offset:32768
ds_read_b128 v[36:39], v134 offset:32768
s_waitcnt lgkmcnt(3)
v_mfma_f32_32x32x16_bf16 v[80:95], v[48:51], v[56:59], v[80:95]
ds_read_b128 v[40:43], v134 offset:36864
ds_read_b128 v[44:47], v130 offset:36864
s_waitcnt lgkmcnt(4)
v_mfma_f32_32x32x16_bf16 v[96:111], v[60:63], v[52:55], v[96:111]
v_mfma_f32_32x32x16_bf16 v[112:127], v[60:63], v[56:59], v[112:127]
s_waitcnt lgkmcnt(2)
v_mfma_f32_32x32x16_bf16 v[64:79], v[32:35], v[36:39], v[64:79]
ds_read_b128 v[48:51], v131 offset:32768
ds_read_b128 v[52:55], v135 offset:32768
s_waitcnt lgkmcnt(3)
v_mfma_f32_32x32x16_bf16 v[80:95], v[32:35], v[40:43], v[80:95]
ds_read_b128 v[56:59], v135 offset:36864
ds_read_b128 v[60:63], v131 offset:36864
s_waitcnt lgkmcnt(4)
v_mfma_f32_32x32x16_bf16 v[96:111], v[44:47], v[36:39], v[96:111]
v_mfma_f32_32x32x16_bf16 v[112:127], v[44:47], v[40:43], v[112:127]
s_waitcnt lgkmcnt(0)
s_barrier
v_mfma_f32_32x32x16_bf16 v[64:79], v[48:51], v[52:55], v[64:79]
ds_read_b128 v[32:35], v136 offset:0
ds_read_b128 v[36:39], v140 offset:0
v_mfma_f32_32x32x16_bf16 v[80:95], v[48:51], v[56:59], v[80:95]
ds_read_b128 v[40:43], v140 offset:4096
ds_read_b128 v[44:47], v136 offset:4096
v_mfma_f32_32x32x16_bf16 v[96:111], v[60:63], v[52:55], v[96:111]
v_mfma_f32_32x32x16_bf16 v[112:127], v[60:63], v[56:59], v[112:127]
s_waitcnt lgkmcnt(2)
v_mfma_f32_32x32x16_bf16 v[64:79], v[32:35], v[36:39], v[64:79]
ds_read_b128 v[48:51], v137 offset:0
ds_read_b128 v[52:55], v141 offset:0
s_waitcnt lgkmcnt(3)
v_mfma_f32_32x32x16_bf16 v[80:95], v[32:35], v[40:43], v[80:95]
ds_read_b128 v[56:59], v141 offset:4096
ds_read_b128 v[60:63], v137 offset:4096
s_waitcnt lgkmcnt(4)
v_mfma_f32_32x32x16_bf16 v[96:111], v[44:47], v[36:39], v[96:111]
v_mfma_f32_32x32x16_bf16 v[112:127], v[44:47], v[40:43], v[112:127]
s_waitcnt lgkmcnt(2)
v_mfma_f32_32x32x16_bf16 v[64:79], v[48:51], v[52:55], v[64:79]
ds_read_b128 v[32:35], v138 offset:0
ds_read_b128 v[36:39], v142 offset:0
s_waitcnt lgkmcnt(3)
v_mfma_f32_32x32x16_bf16 v[80:95], v[48:51], v[56:59], v[80:95]
ds_read_b128 v[40:43], v142 offset:4096
ds_read_b128 v[44:47], v138 offset:4096
s_waitcnt lgkmcnt(4)
v_mfma_f32_32x32x16_bf16 v[96:111], v[60:63], v[52:55], v[96:111]
v_mfma_f32_32x32x16_bf16 v[112:127], v[60:63], v[56:59], v[112:127]
s_waitcnt lgkmcnt(2)
v_mfma_f32_32x32x16_bf16 v[64:79], v[32:35], v[36:39], v[64:79]
ds_read_b128 v[48:51], v139 offset:0
ds_read_b128 v[52:55], v143 offset:0
s_waitcnt lgkmcnt(3)
v_mfma_f32_32x32x16_bf16 v[80:95], v[32:35], v[40:43], v[80:95]
ds_read_b128 v[56:59], v143 offset:4096
ds_read_b128 v[60:63], v139 offset:4096
s_waitcnt lgkmcnt(4)
v_mfma_f32_32x32x16_bf16 v[96:111], v[44:47], v[36:39], v[96:111]
v_mfma_f32_32x32x16_bf16 v[112:127], v[44:47], v[40:43], v[112:127]
s_waitcnt lgkmcnt(0)
s_barrier
v_mfma_f32_32x32x16_bf16 v[64:79], v[48:51], v[52:55], v[64:79]
ds_read_b128 v[32:35], v128 offset:0
ds_read_b128 v[36:39], v132 offset:0
v_mfma_f32_32x32x16_bf16 v[80:95], v[48:51], v[56:59], v[80:95]
ds_read_b128 v[40:43], v132 offset:4096
ds_read_b128 v[44:47], v128 offset:4096
v_mfma_f32_32x32x16_bf16 v[96:111], v[60:63], v[52:55], v[96:111]
v_mfma_f32_32x32x16_bf16 v[112:127], v[60:63], v[56:59], v[112:127]
s_waitcnt lgkmcnt(2)
v_mfma_f32_32x32x16_bf16 v[64:79], v[32:35], v[36:39], v[64:79]
ds_read_b128 v[48:51], v129 offset:0
ds_read_b128 v[52:55], v133 offset:0
s_waitcnt lgkmcnt(3)
v_mfma_f32_32x32x16_bf16 v[80:95], v[32:35], v[40:43], v[80:95]
ds_read_b128 v[56:59], v133 offset:4096
ds_read_b128 v[60:63], v129 offset:4096
s_waitcnt lgkmcnt(4)
v_mfma_f32_32x32x16_bf16 v[96:111], v[44:47], v[36:39], v[96:111]
v_mfma_f32_32x32x16_bf16 v[112:127], v[44:47], v[40:43], v[112:127]
s_waitcnt lgkmcnt(2)
v_mfma_f32_32x32x16_bf16 v[64:79], v[48:51], v[52:55], v[64:79]
ds_read_b128 v[32:35], v130 offset:0
ds_read_b128 v[36:39], v134 offset:0
s_waitcnt lgkmcnt(3)
v_mfma_f32_32x32x16_bf16 v[80:95], v[48:51], v[56:59], v[80:95]
ds_read_b128 v[40:43], v134 offset:4096
ds_read_b128 v[44:47], v130 offset:4096
s_waitcnt lgkmcnt(4)
v_mfma_f32_32x32x16_bf16 v[96:111], v[60:63], v[52:55], v[96:111]
v_mfma_f32_32x32x16_bf16 v[112:127], v[60:63], v[56:59], v[112:127]
s_waitcnt lgkmcnt(2)
v_mfma_f32_32x32x16_bf16 v[64:79], v[32:35], v[36:39], v[64:79]
ds_read_b128 v[48:51], v131 offset:0
ds_read_b128 v[52:55], v135 offset:0
s_waitcnt lgkmcnt(3)
v_mfma_f32_32x32x16_bf16 v[80:95], v[32:35], v[40:43], v[80:95]
ds_read_b128 v[56:59], v135 offset:4096
ds_read_b128 v[60:63], v131 offset:4096
s_waitcnt lgkmcnt(4)
v_mfma_f32_32x32x16_bf16 v[96:111], v[44:47], v[36:39], v[96:111]
v_mfma_f32_32x32x16_bf16 v[112:127], v[44:47], v[40:43], v[112:127]
s_waitcnt lgkmcnt(0)
s_barrier
v_mfma_f32_32x32x16_bf16 v[64:79], v[48:51], v[52:55], v[64:79]
ds_read_b128 v[32:35], v128 offset:32768
ds_read_b128 v[36:39], v132 offset:32768
v_mfma_f32_32x32x16_bf16 v[80:95], v[48:51], v[56:59], v[80:95]
ds_read_b128 v[40:43], v132 offset:36864
ds_read_b128 v[44:47], v128 offset:36864
v_mfma_f32_32x32x16_bf16 v[96:111], v[60:63], v[52:55], v[96:111]
v_mfma_f32_32x32x16_bf16 v[112:127], v[60:63], v[56:59], v[112:127]
s_waitcnt lgkmcnt(2)
v_mfma_f32_32x32x16_bf16 v[64:79], v[32:35], v[36:39], v[64:79]
ds_read_b128 v[48:51], v129 offset:32768
ds_read_b128 v[52:55], v133 offset:32768
s_waitcnt lgkmcnt(3)
v_mfma_f32_32x32x16_bf16 v[80:95], v[32:35], v[40:43], v[80:95]
ds_read_b128 v[56:59], v133 offset:36864
ds_read_b128 v[60:63], v129 offset:36864
s_waitcnt lgkmcnt(4)
v_mfma_f32_32x32x16_bf16 v[96:111], v[44:47], v[36:39], v[96:111]
v_mfma_f32_32x32x16_bf16 v[112:127], v[44:47], v[40:43], v[112:127]
s_waitcnt lgkmcnt(2)
v_mfma_f32_32x32x16_bf16 v[64:79], v[48:51], v[52:55], v[64:79]
ds_read_b128 v[32:35], v130 offset:32768
ds_read_b128 v[36:39], v134 offset:32768
s_waitcnt lgkmcnt(3)
v_mfma_f32_32x32x16_bf16 v[80:95], v[48:51], v[56:59], v[80:95]
ds_read_b128 v[40:43], v134 offset:36864
ds_read_b128 v[44:47], v130 offset:36864
s_waitcnt lgkmcnt(4)
v_mfma_f32_32x32x16_bf16 v[96:111], v[60:63], v[52:55], v[96:111]
v_mfma_f32_32x32x16_bf16 v[112:127], v[60:63], v[56:59], v[112:127]
s_waitcnt lgkmcnt(2)
v_mfma_f32_32x32x16_bf16 v[64:79], v[32:35], v[36:39], v[64:79]
ds_read_b128 v[48:51], v131 offset:32768
ds_read_b128 v[52:55], v135 offset:32768
s_waitcnt lgkmcnt(3)
v_mfma_f32_32x32x16_bf16 v[80:95], v[32:35], v[40:43], v[80:95]
ds_read_b128 v[56:59], v135 offset:36864
ds_read_b128 v[60:63], v131 offset:36864
s_waitcnt lgkmcnt(4)
v_mfma_f32_32x32x16_bf16 v[96:111], v[44:47], v[36:39], v[96:111]
v_mfma_f32_32x32x16_bf16 v[112:127], v[44:47], v[40:43], v[112:127]
s_waitcnt lgkmcnt(0)
s_barrier
v_mfma_f32_32x32x16_bf16 v[64:79], v[48:51], v[52:55], v[64:79]
ds_read_b128 v[32:35], v136 offset:0
ds_read_b128 v[36:39], v140 offset:0
v_mfma_f32_32x32x16_bf16 v[80:95], v[48:51], v[56:59], v[80:95]
ds_read_b128 v[40:43], v140 offset:4096
ds_read_b128 v[44:47], v136 offset:4096
v_mfma_f32_32x32x16_bf16 v[96:111], v[60:63], v[52:55], v[96:111]
v_mfma_f32_32x32x16_bf16 v[112:127], v[60:63], v[56:59], v[112:127]
s_waitcnt lgkmcnt(2)
v_mfma_f32_32x32x16_bf16 v[64:79], v[32:35], v[36:39], v[64:79]
ds_read_b128 v[48:51], v137 offset:0
ds_read_b128 v[52:55], v141 offset:0
s_waitcnt lgkmcnt(3)
v_mfma_f32_32x32x16_bf16 v[80:95], v[32:35], v[40:43], v[80:95]
ds_read_b128 v[56:59], v141 offset:4096
ds_read_b128 v[60:63], v137 offset:4096
s_waitcnt lgkmcnt(4)
v_mfma_f32_32x32x16_bf16 v[96:111], v[44:47], v[36:39], v[96:111]
v_mfma_f32_32x32x16_bf16 v[112:127], v[44:47], v[40:43], v[112:127]
s_waitcnt lgkmcnt(2)
v_mfma_f32_32x32x16_bf16 v[64:79], v[48:51], v[52:55], v[64:79]
ds_read_b128 v[32:35], v138 offset:0
ds_read_b128 v[36:39], v142 offset:0
s_waitcnt lgkmcnt(3)
v_mfma_f32_32x32x16_bf16 v[80:95], v[48:51], v[56:59], v[80:95]
ds_read_b128 v[40:43], v142 offset:4096
ds_read_b128 v[44:47], v138 offset:4096
s_waitcnt lgkmcnt(4)
v_mfma_f32_32x32x16_bf16 v[96:111], v[60:63], v[52:55], v[96:111]
v_mfma_f32_32x32x16_bf16 v[112:127], v[60:63], v[56:59], v[112:127]
s_waitcnt lgkmcnt(2)
v_mfma_f32_32x32x16_bf16 v[64:79], v[32:35], v[36:39], v[64:79]
ds_read_b128 v[48:51], v139 offset:0
ds_read_b128 v[52:55], v143 offset:0
s_waitcnt lgkmcnt(3)
v_mfma_f32_32x32x16_bf16 v[80:95], v[32:35], v[40:43], v[80:95]
ds_read_b128 v[56:59], v143 offset:4096
ds_read_b128 v[60:63], v139 offset:4096
s_waitcnt lgkmcnt(4)
v_mfma_f32_32x32x16_bf16 v[96:111], v[44:47], v[36:39], v[96:111]
v_mfma_f32_32x32x16_bf16 v[112:127], v[44:47], v[40:43], v[112:127]
s_waitcnt lgkmcnt(0)
s_barrier
v_mfma_f32_32x32x16_bf16 v[64:79], v[48:51], v[52:55], v[64:79]
ds_read_b128 v[32:35], v128 offset:0
ds_read_b128 v[36:39], v132 offset:0
v_mfma_f32_32x32x16_bf16 v[80:95], v[48:51], v[56:59], v[80:95]
ds_read_b128 v[40:43], v132 offset:4096
ds_read_b128 v[44:47], v128 offset:4096
v_mfma_f32_32x32x16_bf16 v[96:111], v[60:63], v[52:55], v[96:111]
v_mfma_f32_32x32x16_bf16 v[112:127], v[60:63], v[56:59], v[112:127]
s_waitcnt lgkmcnt(2)
v_mfma_f32_32x32x16_bf16 v[64:79], v[32:35], v[36:39], v[64:79]
ds_read_b128 v[48:51], v129 offset:0
ds_read_b128 v[52:55], v133 offset:0
s_waitcnt lgkmcnt(3)
v_mfma_f32_32x32x16_bf16 v[80:95], v[32:35], v[40:43], v[80:95]
ds_read_b128 v[56:59], v133 offset:4096
ds_read_b128 v[60:63], v129 offset:4096
s_waitcnt lgkmcnt(4)
v_mfma_f32_32x32x16_bf16 v[96:111], v[44:47], v[36:39], v[96:111]
v_mfma_f32_32x32x16_bf16 v[112:127], v[44:47], v[40:43], v[112:127]
s_waitcnt lgkmcnt(2)
v_mfma_f32_32x32x16_bf16 v[64:79], v[48:51], v[52:55], v[64:79]
ds_read_b128 v[32:35], v130 offset:0
ds_read_b128 v[36:39], v134 offset:0
s_waitcnt lgkmcnt(3)
v_mfma_f32_32x32x16_bf16 v[80:95], v[48:51], v[56:59], v[80:95]
ds_read_b128 v[40:43], v134 offset:4096
ds_read_b128 v[44:47], v130 offset:4096
s_waitcnt lgkmcnt(4)
v_mfma_f32_32x32x16_bf16 v[96:111], v[60:63], v[52:55], v[96:111]
v_mfma_f32_32x32x16_bf16 v[112:127], v[60:63], v[56:59], v[112:127]
s_waitcnt lgkmcnt(2)
v_mfma_f32_32x32x16_bf16 v[64:79], v[32:35], v[36:39], v[64:79]
ds_read_b128 v[48:51], v131 offset:0
ds_read_b128 v[52:55], v135 offset:0
s_waitcnt lgkmcnt(3)
v_mfma_f32_32x32x16_bf16 v[80:95], v[32:35], v[40:43], v[80:95]
ds_read_b128 v[56:59], v135 offset:4096
ds_read_b128 v[60:63], v131 offset:4096
s_waitcnt lgkmcnt(4)
v_mfma_f32_32x32x16_bf16 v[96:111], v[44:47], v[36:39], v[96:111]
v_mfma_f32_32x32x16_bf16 v[112:127], v[44:47], v[40:43], v[112:127]
s_waitcnt lgkmcnt(0)
s_barrier
v_mfma_f32_32x32x16_bf16 v[64:79], v[48:51], v[52:55], v[64:79]
ds_read_b128 v[32:35], v128 offset:32768
ds_read_b128 v[36:39], v132 offset:32768
v_mfma_f32_32x32x16_bf16 v[80:95], v[48:51], v[56:59], v[80:95]
ds_read_b128 v[40:43], v132 offset:36864
ds_read_b128 v[44:47], v128 offset:36864
v_mfma_f32_32x32x16_bf16 v[96:111], v[60:63], v[52:55], v[96:111]
v_mfma_f32_32x32x16_bf16 v[112:127], v[60:63], v[56:59], v[112:127]
s_waitcnt lgkmcnt(2)
v_mfma_f32_32x32x16_bf16 v[64:79], v[32:35], v[36:39], v[64:79]
ds_read_b128 v[48:51], v129 offset:32768
ds_read_b128 v[52:55], v133 offset:32768
s_waitcnt lgkmcnt(3)
v_mfma_f32_32x32x16_bf16 v[80:95], v[32:35], v[40:43], v[80:95]
ds_read_b128 v[56:59], v133 offset:36864
ds_read_b128 v[60:63], v129 offset:36864
s_waitcnt lgkmcnt(4)
v_mfma_f32_32x32x16_bf16 v[96:111], v[44:47], v[36:39], v[96:111]
v_mfma_f32_32x32x16_bf16 v[112:127], v[44:47], v[40:43], v[112:127]
s_waitcnt lgkmcnt(2)
v_mfma_f32_32x32x16_bf16 v[64:79], v[48:51], v[52:55], v[64:79]
ds_read_b128 v[32:35], v130 offset:32768
ds_read_b128 v[36:39], v134 offset:32768
s_waitcnt lgkmcnt(3)
v_mfma_f32_32x32x16_bf16 v[80:95], v[48:51], v[56:59], v[80:95]
ds_read_b128 v[40:43], v134 offset:36864
ds_read_b128 v[44:47], v130 offset:36864
s_waitcnt lgkmcnt(4)
v_mfma_f32_32x32x16_bf16 v[96:111], v[60:63], v[52:55], v[96:111]
v_mfma_f32_32x32x16_bf16 v[112:127], v[60:63], v[56:59], v[112:127]
s_waitcnt lgkmcnt(2)
v_mfma_f32_32x32x16_bf16 v[64:79], v[32:35], v[36:39], v[64:79]
ds_read_b128 v[48:51], v131 offset:32768
ds_read_b128 v[52:55], v135 offset:32768
s_waitcnt lgkmcnt(3)
v_mfma_f32_32x32x16_bf16 v[80:95], v[32:35], v[40:43], v[80:95]
ds_read_b128 v[56:59], v135 offset:36864
ds_read_b128 v[60:63], v131 offset:36864
s_waitcnt lgkmcnt(4)
v_mfma_f32_32x32x16_bf16 v[96:111], v[44:47], v[36:39], v[96:111]
v_mfma_f32_32x32x16_bf16 v[112:127], v[44:47], v[40:43], v[112:127]
s_waitcnt lgkmcnt(0)
s_barrier
v_mfma_f32_32x32x16_bf16 v[64:79], v[48:51], v[52:55], v[64:79]
ds_read_b128 v[32:35], v136 offset:0
ds_read_b128 v[36:39], v140 offset:0
v_mfma_f32_32x32x16_bf16 v[80:95], v[48:51], v[56:59], v[80:95]
ds_read_b128 v[40:43], v140 offset:4096
ds_read_b128 v[44:47], v136 offset:4096
v_mfma_f32_32x32x16_bf16 v[96:111], v[60:63], v[52:55], v[96:111]
v_mfma_f32_32x32x16_bf16 v[112:127], v[60:63], v[56:59], v[112:127]
s_waitcnt lgkmcnt(2)
v_mfma_f32_32x32x16_bf16 v[64:79], v[32:35], v[36:39], v[64:79]
ds_read_b128 v[48:51], v137 offset:0
ds_read_b128 v[52:55], v141 offset:0
s_waitcnt lgkmcnt(3)
v_mfma_f32_32x32x16_bf16 v[80:95], v[32:35], v[40:43], v[80:95]
ds_read_b128 v[56:59], v141 offset:4096
ds_read_b128 v[60:63], v137 offset:4096
s_waitcnt lgkmcnt(4)
v_mfma_f32_32x32x16_bf16 v[96:111], v[44:47], v[36:39], v[96:111]
v_mfma_f32_32x32x16_bf16 v[112:127], v[44:47], v[40:43], v[112:127]
s_waitcnt lgkmcnt(2)
v_mfma_f32_32x32x16_bf16 v[64:79], v[48:51], v[52:55], v[64:79]
ds_read_b128 v[32:35], v138 offset:0
ds_read_b128 v[36:39], v142 offset:0
s_waitcnt lgkmcnt(3)
v_mfma_f32_32x32x16_bf16 v[80:95], v[48:51], v[56:59], v[80:95]
ds_read_b128 v[40:43], v142 offset:4096
ds_read_b128 v[44:47], v138 offset:4096
s_waitcnt lgkmcnt(4)
v_mfma_f32_32x32x16_bf16 v[96:111], v[60:63], v[52:55], v[96:111]
v_mfma_f32_32x32x16_bf16 v[112:127], v[60:63], v[56:59], v[112:127]
s_waitcnt lgkmcnt(2)
v_mfma_f32_32x32x16_bf16 v[64:79], v[32:35], v[36:39], v[64:79]
ds_read_b128 v[48:51], v139 offset:0
ds_read_b128 v[52:55], v143 offset:0
s_waitcnt lgkmcnt(3)
v_mfma_f32_32x32x16_bf16 v[80:95], v[32:35], v[40:43], v[80:95]
ds_read_b128 v[56:59], v143 offset:4096
ds_read_b128 v[60:63], v139 offset:4096
s_waitcnt lgkmcnt(4)
v_mfma_f32_32x32x16_bf16 v[96:111], v[44:47], v[36:39], v[96:111]
v_mfma_f32_32x32x16_bf16 v[112:127], v[44:47], v[40:43], v[112:127]
s_waitcnt lgkmcnt(0)
s_barrier
v_mfma_f32_32x32x16_bf16 v[64:79], v[48:51], v[52:55], v[64:79]
ds_read_b128 v[32:35], v128 offset:0
ds_read_b128 v[36:39], v132 offset:0
v_mfma_f32_32x32x16_bf16 v[80:95], v[48:51], v[56:59], v[80:95]
ds_read_b128 v[40:43], v132 offset:4096
ds_read_b128 v[44:47], v128 offset:4096
v_mfma_f32_32x32x16_bf16 v[96:111], v[60:63], v[52:55], v[96:111]
v_mfma_f32_32x32x16_bf16 v[112:127], v[60:63], v[56:59], v[112:127]
s_waitcnt lgkmcnt(2)
v_mfma_f32_32x32x16_bf16 v[64:79], v[32:35], v[36:39], v[64:79]
ds_read_b128 v[48:51], v129 offset:0
ds_read_b128 v[52:55], v133 offset:0
s_waitcnt lgkmcnt(3)
v_mfma_f32_32x32x16_bf16 v[80:95], v[32:35], v[40:43], v[80:95]
ds_read_b128 v[56:59], v133 offset:4096
ds_read_b128 v[60:63], v129 offset:4096
s_waitcnt lgkmcnt(4)
v_mfma_f32_32x32x16_bf16 v[96:111], v[44:47], v[36:39], v[96:111]
v_mfma_f32_32x32x16_bf16 v[112:127], v[44:47], v[40:43], v[112:127]
s_waitcnt lgkmcnt(2)
v_mfma_f32_32x32x16_bf16 v[64:79], v[48:51], v[52:55], v[64:79]
ds_read_b128 v[32:35], v130 offset:0
ds_read_b128 v[36:39], v134 offset:0
s_waitcnt lgkmcnt(3)
v_mfma_f32_32x32x16_bf16 v[80:95], v[48:51], v[56:59], v[80:95]
ds_read_b128 v[40:43], v134 offset:4096
ds_read_b128 v[44:47], v130 offset:4096
s_waitcnt lgkmcnt(4)
v_mfma_f32_32x32x16_bf16 v[96:111], v[60:63], v[52:55], v[96:111]
v_mfma_f32_32x32x16_bf16 v[112:127], v[60:63], v[56:59], v[112:127]
s_waitcnt lgkmcnt(2)
v_mfma_f32_32x32x16_bf16 v[64:79], v[32:35], v[36:39], v[64:79]
ds_read_b128 v[48:51], v131 offset:0
ds_read_b128 v[52:55], v135 offset:0
s_waitcnt lgkmcnt(3)
v_mfma_f32_32x32x16_bf16 v[80:95], v[32:35], v[40:43], v[80:95]
ds_read_b128 v[56:59], v135 offset:4096
ds_read_b128 v[60:63], v131 offset:4096
s_waitcnt lgkmcnt(4)
v_mfma_f32_32x32x16_bf16 v[96:111], v[44:47], v[36:39], v[96:111]
v_mfma_f32_32x32x16_bf16 v[112:127], v[44:47], v[40:43], v[112:127]
s_waitcnt lgkmcnt(0)
s_barrier
v_mfma_f32_32x32x16_bf16 v[64:79], v[48:51], v[52:55], v[64:79]
ds_read_b128 v[32:35], v128 offset:32768
ds_read_b128 v[36:39], v132 offset:32768
v_mfma_f32_32x32x16_bf16 v[80:95], v[48:51], v[56:59], v[80:95]
ds_read_b128 v[40:43], v132 offset:36864
ds_read_b128 v[44:47], v128 offset:36864
v_mfma_f32_32x32x16_bf16 v[96:111], v[60:63], v[52:55], v[96:111]
v_mfma_f32_32x32x16_bf16 v[112:127], v[60:63], v[56:59], v[112:127]
s_waitcnt lgkmcnt(2)
v_mfma_f32_32x32x16_bf16 v[64:79], v[32:35], v[36:39], v[64:79]
ds_read_b128 v[48:51], v129 offset:32768
ds_read_b128 v[52:55], v133 offset:32768
s_waitcnt lgkmcnt(3)
v_mfma_f32_32x32x16_bf16 v[80:95], v[32:35], v[40:43], v[80:95]
ds_read_b128 v[56:59], v133 offset:36864
ds_read_b128 v[60:63], v129 offset:36864
s_waitcnt lgkmcnt(4)
v_mfma_f32_32x32x16_bf16 v[96:111], v[44:47], v[36:39], v[96:111]
v_mfma_f32_32x32x16_bf16 v[112:127], v[44:47], v[40:43], v[112:127]
s_waitcnt lgkmcnt(2)
v_mfma_f32_32x32x16_bf16 v[64:79], v[48:51], v[52:55], v[64:79]
ds_read_b128 v[32:35], v130 offset:32768
ds_read_b128 v[36:39], v134 offset:32768
s_waitcnt lgkmcnt(3)
v_mfma_f32_32x32x16_bf16 v[80:95], v[48:51], v[56:59], v[80:95]
ds_read_b128 v[40:43], v134 offset:36864
ds_read_b128 v[44:47], v130 offset:36864
s_waitcnt lgkmcnt(4)
v_mfma_f32_32x32x16_bf16 v[96:111], v[60:63], v[52:55], v[96:111]
v_mfma_f32_32x32x16_bf16 v[112:127], v[60:63], v[56:59], v[112:127]
s_waitcnt lgkmcnt(2)
v_mfma_f32_32x32x16_bf16 v[64:79], v[32:35], v[36:39], v[64:79]
ds_read_b128 v[48:51], v131 offset:32768
ds_read_b128 v[52:55], v135 offset:32768
s_waitcnt lgkmcnt(3)
v_mfma_f32_32x32x16_bf16 v[80:95], v[32:35], v[40:43], v[80:95]
ds_read_b128 v[56:59], v135 offset:36864
ds_read_b128 v[60:63], v131 offset:36864
s_waitcnt lgkmcnt(4)
v_mfma_f32_32x32x16_bf16 v[96:111], v[44:47], v[36:39], v[96:111]
v_mfma_f32_32x32x16_bf16 v[112:127], v[44:47], v[40:43], v[112:127]
s_waitcnt lgkmcnt(0)
s_barrier
v_mfma_f32_32x32x16_bf16 v[64:79], v[48:51], v[52:55], v[64:79]
ds_read_b128 v[32:35], v136 offset:0
ds_read_b128 v[36:39], v140 offset:0
v_mfma_f32_32x32x16_bf16 v[80:95], v[48:51], v[56:59], v[80:95]
ds_read_b128 v[40:43], v140 offset:4096
ds_read_b128 v[44:47], v136 offset:4096
v_mfma_f32_32x32x16_bf16 v[96:111], v[60:63], v[52:55], v[96:111]
v_mfma_f32_32x32x16_bf16 v[112:127], v[60:63], v[56:59], v[112:127]
s_waitcnt lgkmcnt(2)
v_mfma_f32_32x32x16_bf16 v[64:79], v[32:35], v[36:39], v[64:79]
ds_read_b128 v[48:51], v137 offset:0
ds_read_b128 v[52:55], v141 offset:0
s_waitcnt lgkmcnt(3)
v_mfma_f32_32x32x16_bf16 v[80:95], v[32:35], v[40:43], v[80:95]
ds_read_b128 v[56:59], v141 offset:4096
ds_read_b128 v[60:63], v137 offset:4096
s_waitcnt lgkmcnt(4)
v_mfma_f32_32x32x16_bf16 v[96:111], v[44:47], v[36:39], v[96:111]
v_mfma_f32_32x32x16_bf16 v[112:127], v[44:47], v[40:43], v[112:127]
s_waitcnt lgkmcnt(2)
v_mfma_f32_32x32x16_bf16 v[64:79], v[48:51], v[52:55], v[64:79]
ds_read_b128 v[32:35], v138 offset:0
ds_read_b128 v[36:39], v142 offset:0
s_waitcnt lgkmcnt(3)
v_mfma_f32_32x32x16_bf16 v[80:95], v[48:51], v[56:59], v[80:95]
ds_read_b128 v[40:43], v142 offset:4096
ds_read_b128 v[44:47], v138 offset:4096
s_waitcnt lgkmcnt(4)
v_mfma_f32_32x32x16_bf16 v[96:111], v[60:63], v[52:55], v[96:111]
v_mfma_f32_32x32x16_bf16 v[112:127], v[60:63], v[56:59], v[112:127]
s_waitcnt lgkmcnt(2)
v_mfma_f32_32x32x16_bf16 v[64:79], v[32:35], v[36:39], v[64:79]
ds_read_b128 v[48:51], v139 offset:0
ds_read_b128 v[52:55], v143 offset:0
s_waitcnt lgkmcnt(3)
v_mfma_f32_32x32x16_bf16 v[80:95], v[32:35], v[40:43], v[80:95]
ds_read_b128 v[56:59], v143 offset:4096
ds_read_b128 v[60:63], v139 offset:4096
s_waitcnt lgkmcnt(4)
v_mfma_f32_32x32x16_bf16 v[96:111], v[44:47], v[36:39], v[96:111]
v_mfma_f32_32x32x16_bf16 v[112:127], v[44:47], v[40:43], v[112:127]
s_waitcnt lgkmcnt(0)
s_barrier
v_mfma_f32_32x32x16_bf16 v[64:79], v[48:51], v[52:55], v[64:79]
ds_read_b128 v[32:35], v128 offset:0
ds_read_b128 v[36:39], v132 offset:0
v_mfma_f32_32x32x16_bf16 v[80:95], v[48:51], v[56:59], v[80:95]
ds_read_b128 v[40:43], v132 offset:4096
ds_read_b128 v[44:47], v128 offset:4096
v_mfma_f32_32x32x16_bf16 v[96:111], v[60:63], v[52:55], v[96:111]
v_mfma_f32_32x32x16_bf16 v[112:127], v[60:63], v[56:59], v[112:127]
s_waitcnt lgkmcnt(2)
v_mov_b32 v12, 0
global_load_dword v13, v12, s[30:31] sc1
v_mfma_f32_32x32x16_bf16 v[64:79], v[32:35], v[36:39], v[64:79]
ds_read_b128 v[48:51], v129 offset:0
ds_read_b128 v[52:55], v133 offset:0
s_waitcnt lgkmcnt(3)
v_mfma_f32_32x32x16_bf16 v[80:95], v[32:35], v[40:43], v[80:95]
ds_read_b128 v[56:59], v133 offset:4096
ds_read_b128 v[60:63], v129 offset:4096
s_waitcnt lgkmcnt(4)
v_mfma_f32_32x32x16_bf16 v[96:111], v[44:47], v[36:39], v[96:111]
v_mfma_f32_32x32x16_bf16 v[112:127], v[44:47], v[40:43], v[112:127]
s_waitcnt lgkmcnt(2)
v_mfma_f32_32x32x16_bf16 v[64:79], v[48:51], v[52:55], v[64:79]
ds_read_b128 v[32:35], v130 offset:0
ds_read_b128 v[36:39], v134 offset:0
s_waitcnt lgkmcnt(3)
v_mfma_f32_32x32x16_bf16 v[80:95], v[48:51], v[56:59], v[80:95]
ds_read_b128 v[40:43], v134 offset:4096
ds_read_b128 v[44:47], v130 offset:4096
s_waitcnt lgkmcnt(4)
v_mfma_f32_32x32x16_bf16 v[96:111], v[60:63], v[52:55], v[96:111]
v_mfma_f32_32x32x16_bf16 v[112:127], v[60:63], v[56:59], v[112:127]
s_waitcnt lgkmcnt(2)
v_mfma_f32_32x32x16_bf16 v[64:79], v[32:35], v[36:39], v[64:79]
ds_read_b128 v[48:51], v131 offset:0
ds_read_b128 v[52:55], v135 offset:0
s_waitcnt lgkmcnt(3)
v_mfma_f32_32x32x16_bf16 v[80:95], v[32:35], v[40:43], v[80:95]
ds_read_b128 v[56:59], v135 offset:4096
ds_read_b128 v[60:63], v131 offset:4096
s_waitcnt lgkmcnt(4)
v_mfma_f32_32x32x16_bf16 v[96:111], v[44:47], v[36:39], v[96:111]
v_mfma_f32_32x32x16_bf16 v[112:127], v[44:47], v[40:43], v[112:127]
s_waitcnt lgkmcnt(0)
s_barrier
v_mfma_f32_32x32x16_bf16 v[64:79], v[48:51], v[52:55], v[64:79]
ds_read_b128 v[32:35], v128 offset:32768
ds_read_b128 v[36:39], v132 offset:32768
v_mfma_f32_32x32x16_bf16 v[80:95], v[48:51], v[56:59], v[80:95]
ds_read_b128 v[40:43], v132 offset:36864
ds_read_b128 v[44:47], v128 offset:36864
v_mfma_f32_32x32x16_bf16 v[96:111], v[60:63], v[52:55], v[96:111]
v_mfma_f32_32x32x16_bf16 v[112:127], v[60:63], v[56:59], v[112:127]
s_waitcnt lgkmcnt(2)
v_mfma_f32_32x32x16_bf16 v[64:79], v[32:35], v[36:39], v[64:79]
ds_read_b128 v[48:51], v129 offset:32768
ds_read_b128 v[52:55], v133 offset:32768
s_waitcnt lgkmcnt(3)
v_mfma_f32_32x32x16_bf16 v[80:95], v[32:35], v[40:43], v[80:95]
ds_read_b128 v[56:59], v133 offset:36864
ds_read_b128 v[60:63], v129 offset:36864
s_waitcnt lgkmcnt(4)
v_mfma_f32_32x32x16_bf16 v[96:111], v[44:47], v[36:39], v[96:111]
v_mfma_f32_32x32x16_bf16 v[112:127], v[44:47], v[40:43], v[112:127]
s_waitcnt lgkmcnt(2)
v_mfma_f32_32x32x16_bf16 v[64:79], v[48:51], v[52:55], v[64:79]
ds_read_b128 v[32:35], v130 offset:32768
ds_read_b128 v[36:39], v134 offset:32768
s_waitcnt lgkmcnt(3)
v_mfma_f32_32x32x16_bf16 v[80:95], v[48:51], v[56:59], v[80:95]
ds_read_b128 v[40:43], v134 offset:36864
ds_read_b128 v[44:47], v130 offset:36864
s_waitcnt lgkmcnt(4)
v_mfma_f32_32x32x16_bf16 v[96:111], v[60:63], v[52:55], v[96:111]
v_mfma_f32_32x32x16_bf16 v[112:127], v[60:63], v[56:59], v[112:127]
s_waitcnt lgkmcnt(2)
v_mfma_f32_32x32x16_bf16 v[64:79], v[32:35], v[36:39], v[64:79]
ds_read_b128 v[48:51], v131 offset:32768
ds_read_b128 v[52:55], v135 offset:32768
s_waitcnt lgkmcnt(3)
v_mfma_f32_32x32x16_bf16 v[80:95], v[32:35], v[40:43], v[80:95]
ds_read_b128 v[56:59], v135 offset:36864
ds_read_b128 v[60:63], v131 offset:36864
s_waitcnt lgkmcnt(4)
v_mfma_f32_32x32x16_bf16 v[96:111], v[44:47], v[36:39], v[96:111]
v_mfma_f32_32x32x16_bf16 v[112:127], v[44:47], v[40:43], v[112:127]
s_waitcnt lgkmcnt(0)
s_barrier
v_mfma_f32_32x32x16_bf16 v[64:79], v[48:51], v[52:55], v[64:79]
ds_read_b128 v[32:35], v136 offset:0
ds_read_b128 v[36:39], v140 offset:0
v_mfma_f32_32x32x16_bf16 v[80:95], v[48:51], v[56:59], v[80:95]
ds_read_b128 v[40:43], v140 offset:4096
ds_read_b128 v[44:47], v136 offset:4096
v_mfma_f32_32x32x16_bf16 v[96:111], v[60:63], v[52:55], v[96:111]
v_mfma_f32_32x32x16_bf16 v[112:127], v[60:63], v[56:59], v[112:127]
s_waitcnt lgkmcnt(2)
v_mfma_f32_32x32x16_bf16 v[64:79], v[32:35], v[36:39], v[64:79]
ds_read_b128 v[48:51], v137 offset:0
ds_read_b128 v[52:55], v141 offset:0
s_waitcnt lgkmcnt(3)
v_mfma_f32_32x32x16_bf16 v[80:95], v[32:35], v[40:43], v[80:95]
ds_read_b128 v[56:59], v141 offset:4096
ds_read_b128 v[60:63], v137 offset:4096
s_waitcnt lgkmcnt(4)
v_mfma_f32_32x32x16_bf16 v[96:111], v[44:47], v[36:39], v[96:111]
v_mfma_f32_32x32x16_bf16 v[112:127], v[44:47], v[40:43], v[112:127]
s_waitcnt lgkmcnt(2)
v_mfma_f32_32x32x16_bf16 v[64:79], v[48:51], v[52:55], v[64:79]
ds_read_b128 v[32:35], v138 offset:0
ds_read_b128 v[36:39], v142 offset:0
s_waitcnt lgkmcnt(3)
v_mfma_f32_32x32x16_bf16 v[80:95], v[48:51], v[56:59], v[80:95]
ds_read_b128 v[40:43], v142 offset:4096
ds_read_b128 v[44:47], v138 offset:4096
s_waitcnt lgkmcnt(4)
v_mfma_f32_32x32x16_bf16 v[96:111], v[60:63], v[52:55], v[96:111]
v_mfma_f32_32x32x16_bf16 v[112:127], v[60:63], v[56:59], v[112:127]
s_waitcnt lgkmcnt(2)
v_mfma_f32_32x32x16_bf16 v[64:79], v[32:35], v[36:39], v[64:79]
ds_read_b128 v[48:51], v139 offset:0
ds_read_b128 v[52:55], v143 offset:0
s_waitcnt lgkmcnt(3)
v_mfma_f32_32x32x16_bf16 v[80:95], v[32:35], v[40:43], v[80:95]
ds_read_b128 v[56:59], v143 offset:4096
ds_read_b128 v[60:63], v139 offset:4096
s_waitcnt lgkmcnt(4)
v_mfma_f32_32x32x16_bf16 v[96:111], v[44:47], v[36:39], v[96:111]
v_mfma_f32_32x32x16_bf16 v[112:127], v[44:47], v[40:43], v[112:127]
s_waitcnt lgkmcnt(0)
s_barrier
v_mfma_f32_32x32x16_bf16 v[64:79], v[48:51], v[52:55], v[64:79]
ds_read_b128 v[32:35], v128 offset:0
ds_read_b128 v[36:39], v132 offset:0
v_mfma_f32_32x32x16_bf16 v[80:95], v[48:51], v[56:59], v[80:95]
ds_read_b128 v[40:43], v132 offset:4096
ds_read_b128 v[44:47], v128 offset:4096
v_mfma_f32_32x32x16_bf16 v[96:111], v[60:63], v[52:55], v[96:111]
v_mfma_f32_32x32x16_bf16 v[112:127], v[60:63], v[56:59], v[112:127]
s_waitcnt lgkmcnt(2)
v_mfma_f32_32x32x16_bf16 v[64:79], v[32:35], v[36:39], v[64:79]
ds_read_b128 v[48:51], v129 offset:0
ds_read_b128 v[52:55], v133 offset:0
s_waitcnt lgkmcnt(3)
v_mfma_f32_32x32x16_bf16 v[80:95], v[32:35], v[40:43], v[80:95]
ds_read_b128 v[56:59], v133 offset:4096
ds_read_b128 v[60:63], v129 offset:4096
s_waitcnt lgkmcnt(4)
v_mfma_f32_32x32x16_bf16 v[96:111], v[44:47], v[36:39], v[96:111]
v_mfma_f32_32x32x16_bf16 v[112:127], v[44:47], v[40:43], v[112:127]
s_waitcnt lgkmcnt(2)
v_mfma_f32_32x32x16_bf16 v[64:79], v[48:51], v[52:55], v[64:79]
ds_read_b128 v[32:35], v130 offset:0
ds_read_b128 v[36:39], v134 offset:0
s_waitcnt lgkmcnt(3)
v_mfma_f32_32x32x16_bf16 v[80:95], v[48:51], v[56:59], v[80:95]
ds_read_b128 v[40:43], v134 offset:4096
ds_read_b128 v[44:47], v130 offset:4096
s_waitcnt lgkmcnt(4)
v_mfma_f32_32x32x16_bf16 v[96:111], v[60:63], v[52:55], v[96:111]
v_mfma_f32_32x32x16_bf16 v[112:127], v[60:63], v[56:59], v[112:127]
s_waitcnt lgkmcnt(2)
v_mfma_f32_32x32x16_bf16 v[64:79], v[32:35], v[36:39], v[64:79]
ds_read_b128 v[48:51], v131 offset:0
ds_read_b128 v[52:55], v135 offset:0
s_waitcnt lgkmcnt(3)
v_mfma_f32_32x32x16_bf16 v[80:95], v[32:35], v[40:43], v[80:95]
ds_read_b128 v[56:59], v135 offset:4096
ds_read_b128 v[60:63], v131 offset:4096
s_waitcnt lgkmcnt(4)
v_mfma_f32_32x32x16_bf16 v[96:111], v[44:47], v[36:39], v[96:111]
v_mfma_f32_32x32x16_bf16 v[112:127], v[44:47], v[40:43], v[112:127]
s_waitcnt lgkmcnt(0)
s_barrier
v_mfma_f32_32x32x16_bf16 v[64:79], v[48:51], v[52:55], v[64:79]
v_mfma_f32_32x32x16_bf16 v[80:95], v[48:51], v[56:59], v[80:95]
v_mfma_f32_32x32x16_bf16 v[96:111], v[60:63], v[52:55], v[96:111]
v_mfma_f32_32x32x16_bf16 v[112:127], v[60:63], v[56:59], v[112:127]
s_lshl_b32 s60, s66, 10
s_add_u32 s60, s60, 122880
s_lshl_b32 s61, s68, 4
v_lshl_add_u32 v14, v6, 5, s60
v_lshl_add_u32 v15, v5, 3, v14
v_add_u32 v15, s61, v15
s_nop 2
v_pk_fma_f32 v[40:41], v[24:25], v[64:65], v[66:67] op_sel_hi:[0,1,1]
v_pk_fma_f32 v[42:43], v[24:25], v[80:81], v[82:83] op_sel_hi:[0,1,1]
v_pk_fma_f32 v[66:67], v[24:25], v[80:81], v[40:41] op_sel:[1,0,0] neg_lo:[1,0,0] neg_hi:[1,0,0]
v_pk_fma_f32 v[82:83], v[24:25], v[64:65], v[42:43] op_sel:[1,0,0]
v_pk_fma_f32 v[40:41], v[24:25], v[66:67], v[68:69] op_sel_hi:[0,1,1]
v_pk_fma_f32 v[42:43], v[24:25], v[82:83], v[84:85] op_sel_hi:[0,1,1]
v_pk_fma_f32 v[68:69], v[24:25], v[82:83], v[40:41] op_sel:[1,0,0] neg_lo:[1,0,0] neg_hi:[1,0,0]
v_pk_fma_f32 v[84:85], v[24:25], v[66:67], v[42:43] op_sel:[1,0,0]
v_pk_fma_f32 v[40:41], v[24:25], v[68:69], v[70:71] op_sel_hi:[0,1,1]
v_pk_fma_f32 v[42:43], v[24:25], v[84:85], v[86:87] op_sel_hi:[0,1,1]
v_pk_fma_f32 v[70:71], v[24:25], v[84:85], v[40:41] op_sel:[1,0,0] neg_lo:[1,0,0] neg_hi:[1,0,0]
v_pk_fma_f32 v[86:87], v[24:25], v[68:69], v[42:43] op_sel:[1,0,0]
v_pk_fma_f32 v[40:41], v[24:25], v[70:71], v[72:73] op_sel_hi:[0,1,1]
v_pk_fma_f32 v[42:43], v[24:25], v[86:87], v[88:89] op_sel_hi:[0,1,1]
v_pk_fma_f32 v[72:73], v[24:25], v[86:87], v[40:41] op_sel:[1,0,0] neg_lo:[1,0,0] neg_hi:[1,0,0]
v_pk_fma_f32 v[88:89], v[24:25], v[70:71], v[42:43] op_sel:[1,0,0]
v_pk_fma_f32 v[40:41], v[24:25], v[72:73], v[74:75] op_sel_hi:[0,1,1]
v_pk_fma_f32 v[42:43], v[24:25], v[88:89], v[90:91] op_sel_hi:[0,1,1]
v_pk_fma_f32 v[74:75], v[24:25], v[88:89], v[40:41] op_sel:[1,0,0] neg_lo:[1,0,0] neg_hi:[1,0,0]
v_pk_fma_f32 v[90:91], v[24:25], v[72:73], v[42:43] op_sel:[1,0,0]
v_pk_fma_f32 v[40:41], v[24:25], v[74:75], v[76:77] op_sel_hi:[0,1,1]
v_pk_fma_f32 v[42:43], v[24:25], v[90:91], v[92:93] op_sel_hi:[0,1,1]
v_pk_fma_f32 v[76:77], v[24:25], v[90:91], v[40:41] op_sel:[1,0,0] neg_lo:[1,0,0] neg_hi:[1,0,0]
v_pk_fma_f32 v[92:93], v[24:25], v[74:75], v[42:43] op_sel:[1,0,0]
v_pk_fma_f32 v[40:41], v[24:25], v[76:77], v[78:79] op_sel_hi:[0,1,1]
v_pk_fma_f32 v[42:43], v[24:25], v[92:93], v[94:95] op_sel_hi:[0,1,1]
v_pk_fma_f32 v[78:79], v[24:25], v[92:93], v[40:41] op_sel:[1,0,0] neg_lo:[1,0,0] neg_hi:[1,0,0]
v_pk_fma_f32 v[94:95], v[24:25], v[76:77], v[42:43] op_sel:[1,0,0]
v_pk_fma_f32 v[40:41], v[24:25], v[78:79], v[96:97] op_sel_hi:[0,1,1]
v_pk_fma_f32 v[42:43], v[24:25], v[94:95], v[112:113] op_sel_hi:[0,1,1]
v_pk_fma_f32 v[96:97], v[24:25], v[94:95], v[40:41] op_sel:[1,0,0] neg_lo:[1,0,0] neg_hi:[1,0,0]
v_pk_fma_f32 v[112:113], v[24:25], v[78:79], v[42:43] op_sel:[1,0,0]
v_pk_fma_f32 v[40:41], v[24:25], v[96:97], v[98:99] op_sel_hi:[0,1,1]
v_pk_fma_f32 v[42:43], v[24:25], v[112:113], v[114:115] op_sel_hi:[0,1,1]
v_pk_fma_f32 v[98:99], v[24:25], v[112:113], v[40:41] op_sel:[1,0,0] neg_lo:[1,0,0] neg_hi:[1,0,0]
v_pk_fma_f32 v[114:115], v[24:25], v[96:97], v[42:43] op_sel:[1,0,0]
v_pk_fma_f32 v[40:41], v[24:25], v[98:99], v[100:101] op_sel_hi:[0,1,1]
v_pk_fma_f32 v[42:43], v[24:25], v[114:115], v[116:117] op_sel_hi:[0,1,1]
v_pk_fma_f32 v[100:101], v[24:25], v[114:115], v[40:41] op_sel:[1,0,0] neg_lo:[1,0,0] neg_hi:[1,0,0]
v_pk_fma_f32 v[116:117], v[24:25], v[98:99], v[42:43] op_sel:[1,0,0]
v_pk_fma_f32 v[40:41], v[24:25], v[100:101], v[102:103] op_sel_hi:[0,1,1]
v_pk_fma_f32 v[42:43], v[24:25], v[116:117], v[118:119] op_sel_hi:[0,1,1]
v_pk_fma_f32 v[102:103], v[24:25], v[116:117], v[40:41] op_sel:[1,0,0] neg_lo:[1,0,0] neg_hi:[1,0,0]
v_pk_fma_f32 v[118:119], v[24:25], v[100:101], v[42:43] op_sel:[1,0,0]
v_pk_fma_f32 v[40:41], v[24:25], v[102:103], v[104:105] op_sel_hi:[0,1,1]
v_pk_fma_f32 v[42:43], v[24:25], v[118:119], v[120:121] op_sel_hi:[0,1,1]
v_pk_fma_f32 v[104:105], v[24:25], v[118:119], v[40:41] op_sel:[1,0,0] neg_lo:[1,0,0] neg_hi:[1,0,0]
v_pk_fma_f32 v[120:121], v[24:25], v[102:103], v[42:43] op_sel:[1,0,0]
v_pk_fma_f32 v[40:41], v[24:25], v[104:105], v[106:107] op_sel_hi:[0,1,1]
v_pk_fma_f32 v[42:43], v[24:25], v[120:121], v[122:123] op_sel_hi:[0,1,1]
v_pk_fma_f32 v[106:107], v[24:25], v[120:121], v[40:41] op_sel:[1,0,0] neg_lo:[1,0,0] neg_hi:[1,0,0]
v_pk_fma_f32 v[122:123], v[24:25], v[104:105], v[42:43] op_sel:[1,0,0]
v_pk_fma_f32 v[40:41], v[24:25], v[106:107], v[108:109] op_sel_hi:[0,1,1]
v_pk_fma_f32 v[42:43], v[24:25], v[122:123], v[124:125] op_sel_hi:[0,1,1]
v_pk_fma_f32 v[108:109], v[24:25], v[122:123], v[40:41] op_sel:[1,0,0] neg_lo:[1,0,0] neg_hi:[1,0,0]
v_pk_fma_f32 v[124:125], v[24:25], v[106:107], v[42:43] op_sel:[1,0,0]
v_pk_fma_f32 v[40:41], v[24:25], v[108:109], v[110:111] op_sel_hi:[0,1,1]
v_pk_fma_f32 v[42:43], v[24:25], v[124:125], v[126:127] op_sel_hi:[0,1,1]
v_pk_fma_f32 v[110:111], v[24:25], v[124:125], v[40:41] op_sel:[1,0,0] neg_lo:[1,0,0] neg_hi:[1,0,0]
v_pk_fma_f32 v[126:127], v[24:25], v[108:109], v[42:43] op_sel:[1,0,0]
v_fma_f32 v40, v28, v110, v111
v_fma_f32 v41, v28, v126, v127
v_fma_f32 v32, -v29, v126, v40
v_fma_f32 v33, v29, v110, v41
ds_write_b64 v15, v[32:33]
s_sub_u32 s60, s35, 1
s_lshl_b32 s60, s60, 14
v_lshlrev_b32 v16, 4, v4
v_lshlrev_b32 v17, 14, v5
v_sub_u32 v17, v16, v17
v_add_u32 v128, s60, v17
s_lshl_b32 s60, s35, 14
v_add_u32 v16, s60, v16
v_lshlrev_b32 v17, 30, v5
v_or_b32 v16, v16, v17
s_waitcnt lgkmcnt(0)
s_barrier
ds_read_b128 v[144:147], v14
ds_read_b128 v[148:151], v14 offset:16
L_n41:
s_waitcnt vmcnt(0)
v_readfirstlane_b32 s37, v13
s_nop 0
s_cmp_lg_u32 s37, 0
s_cbranch_scc1 L_ng42
global_load_dword v13, v12, s[30:31] sc1
s_branch L_n41
L_ng42:
v_mov_b32 v46, s37
v_mov_b32 v47, s37
s_getreg_b32 s60, hwreg(HW_REG_XCC_ID, 0, 4)
s_lshl_b32 s61, s37, 4
s_or_b32 s100, s60, s61
v_mov_b32 v60, s100
s_lshr_b32 s101, s36, 3
s_lshl_b32 s60, s35, 11
s_add_u32 s60, s60, 32768
s_lshl_b32 s61, s36, 7
s_add_u32 s61, s61, s60
v_mov_b32 v61, s61
s_lshl_b32 s61, s101, 10
s_add_u32 s60, s60, s61
v_and_b32 v62, 7, v1
v_lshl_add_u32 v62, v62, 7, s60
s_waitcnt lgkmcnt(0)
v_fma_f32 v40, v20, v144, v146
v_fma_f32 v41, v20, v145, v147
v_fma_f32 v48, -v21, v145, v40
v_fma_f32 v49, v21, v144, v41
v_fma_f32 v40, v20, v48, v148
v_fma_f32 v41, v20, v49, v149
v_fma_f32 v50, -v21, v49, v40
v_fma_f32 v51, v21, v48, v41
v_fma_f32 v40, v20, v50, v150
v_fma_f32 v41, v20, v51, v151
v_fma_f32 v44, -v21, v51, v40
v_fma_f32 v45, v21, v50, v41
s_cmp_lg_u32 s68, 0
s_cbranch_scc1 L_np43
buffer_store_dwordx4 v[44:47], v16, s[40:43], 0 offen sc1
s_cmp_lg_u32 s66, 0
s_cbranch_scc1 L_np43
s_mov_b64 exec, 1
global_store_dword v61, v60, s[32:33] sc1
s_mov_b64 exec, -1
L_np43:
v_mov_b32 v17, 0x40000000
v_subrev_u32 v129, 32768, v128
v_subrev_u32 v130, 65536, v128
v_subrev_u32 v131, 98304, v128
v_subrev_u32 v132, 131072, v128
v_subrev_u32 v133, 163840, v128
v_subrev_u32 v134, 196608, v128
v_subrev_u32 v135, 229376, v128
v_cmp_le_i32 vcc, 0, v128
s_nop 1
v_cndmask_b32 v136, 0, v46, vcc
v_cndmask_b32 v128, v17, v128, vcc
v_cmp_le_i32 vcc, 0, v129
s_nop 1
v_cndmask_b32 v137, 0, v46, vcc
v_cndmask_b32 v129, v17, v129, vcc
v_cmp_le_i32 vcc, 0, v130
s_nop 1
v_cndmask_b32 v138, 0, v46, vcc
v_cndmask_b32 v130, v17, v130, vcc
v_cmp_le_i32 vcc, 0, v131
s_nop 1
v_cndmask_b32 v139, 0, v46, vcc
v_cndmask_b32 v131, v17, v131, vcc
v_cmp_le_i32 vcc, 0, v132
s_nop 1
v_cndmask_b32 v140, 0, v46, vcc
v_cndmask_b32 v132, v17, v132, vcc
v_cmp_le_i32 vcc, 0, v133
s_nop 1
v_cndmask_b32 v141, 0, v46, vcc
v_cndmask_b32 v133, v17, v133, vcc
v_cmp_le_i32 vcc, 0, v134
s_nop 1
v_cndmask_b32 v142, 0, v46, vcc
v_cndmask_b32 v134, v17, v134, vcc
v_cmp_le_i32 vcc, 0, v135
s_nop 1
v_cndmask_b32 v143, 0, v46, vcc
v_cndmask_b32 v135, v17, v135, vcc
s_lshl_b32 s60, s35, 1
s_add_u32 s60, s60, s68
s_lshl_b32 s60, s60, 12
s_add_u32 s60, s60, 393216
s_lshl_b32 s61, s101, 11
s_add_u32 s61, s61, s60
v_and_b32 v18, 15, v1
v_lshl_add_u32 v18, v18, 7, s61
s_lshl_b32 s61, s36, 8
s_add_u32 s60, s60, s61
s_lshl_b32 s61, s66, 7
s_add_u32 s60, s60, s61
v_mov_b32 v19, s60
global_load_dword v243, v18, s[32:33] sc1
v_mul_f32 v52, v27, v25
v_mul_f32 v53, v27, v24
v_fma_f32 v208, v26, v24, -v52
v_fma_f32 v209, v26, v25, v53
v_pk_mul_f32 v[52:53], v[26:27], v[64:65] op_sel_hi:[0,1]
v_pk_mul_f32 v[54:55], v[26:27], v[80:81] op_sel_hi:[0,1] neg_lo:[1,0] neg_hi:[1,0]
v_mul_f32 v58, v209, v25
v_mul_f32 v59, v209, v24
v_pk_fma_f32 v[54:55], v[26:27], v[64:65], v[54:55] op_sel:[1,0,0] neg_lo:[1,0,0] neg_hi:[1,0,0]
v_pk_fma_f32 v[64:65], v[26:27], v[80:81], v[52:53] op_sel:[1,0,0] neg_lo:[1,0,0] neg_hi:[1,0,0]
v_mov_b64 v[80:81], v[54:55]
v_fma_f32 v210, v208, v24, -v58
v_fma_f32 v211, v208, v25, v59
v_pk_mul_f32 v[52:53], v[26:27], v[66:67] op_sel_hi:[0,1]
v_pk_mul_f32 v[54:55], v[26:27], v[82:83] op_sel_hi:[0,1] neg_lo:[1,0] neg_hi:[1,0]
v_mul_f32 v58, v211, v25
v_mul_f32 v59, v211, v24
v_pk_fma_f32 v[54:55], v[26:27], v[66:67], v[54:55] op_sel:[1,0,0] neg_lo:[1,0,0] neg_hi:[1,0,0]
v_pk_fma_f32 v[66:67], v[26:27], v[82:83], v[52:53] op_sel:[1,0,0] neg_lo:[1,0,0] neg_hi:[1,0,0]
v_mov_b64 v[82:83], v[54:55]
v_fma_f32 v212, v210, v24, -v58
v_fma_f32 v213, v210, v25, v59
v_pk_mul_f32 v[52:53], v[26:27], v[68:69] op_sel_hi:[0,1]
v_pk_mul_f32 v[54:55], v[26:27], v[84:85] op_sel_hi:[0,1] neg_lo:[1,0] neg_hi:[1,0]
v_mul_f32 v58, v213, v25
v_mul_f32 v59, v213, v24
v_pk_fma_f32 v[54:55], v[26:27], v[68:69], v[54:55] op_sel:[1,0,0] neg_lo:[1,0,0] neg_hi:[1,0,0]
v_pk_fma_f32 v[68:69], v[26:27], v[84:85], v[52:53] op_sel:[1,0,0] neg_lo:[1,0,0] neg_hi:[1,0,0]
v_mov_b64 v[84:85], v[54:55]
v_fma_f32 v214, v212, v24, -v58
v_fma_f32 v215, v212, v25, v59
v_pk_mul_f32 v[52:53], v[26:27], v[70:71] op_sel_hi:[0,1]
v_pk_mul_f32 v[54:55], v[26:27], v[86:87] op_sel_hi:[0,1] neg_lo:[1,0] neg_hi:[1,0]
v_mul_f32 v58, v215, v25
v_mul_f32 v59, v215, v24
v_pk_fma_f32 v[54:55], v[26:27], v[70:71], v[54:55] op_sel:[1,0,0] neg_lo:[1,0,0] neg_hi:[1,0,0]
v_pk_fma_f32 v[70:71], v[26:27], v[86:87], v[52:53] op_sel:[1,0,0] neg_lo:[1,0,0] neg_hi:[1,0,0]
v_mov_b64 v[86:87], v[54:55]
v_fma_f32 v216, v214, v24, -v58
v_fma_f32 v217, v214, v25, v59
v_pk_mul_f32 v[52:53], v[26:27], v[72:73] op_sel_hi:[0,1]
v_pk_mul_f32 v[54:55], v[26:27], v[88:89] op_sel_hi:[0,1] neg_lo:[1,0] neg_hi:[1,0]
v_mul_f32 v58, v217, v25
v_mul_f32 v59, v217, v24
v_pk_fma_f32 v[54:55], v[26:27], v[72:73], v[54:55] op_sel:[1,0,0] neg_lo:[1,0,0] neg_hi:[1,0,0]
v_pk_fma_f32 v[72:73], v[26:27], v[88:89], v[52:53] op_sel:[1,0,0] neg_lo:[1,0,0] neg_hi:[1,0,0]
v_mov_b64 v[88:89], v[54:55]
v_fma_f32 v218, v216, v24, -v58
v_fma_f32 v219, v216, v25, v59
v_pk_mul_f32 v[52:53], v[26:27], v[74:75] op_sel_hi:[0,1]
v_pk_mul_f32 v[54:55], v[26:27], v[90:91] op_sel_hi:[0,1] neg_lo:[1,0] neg_hi:[1,0]
v_mul_f32 v58, v219, v25
v_mul_f32 v59, v219, v24
v_pk_fma_f32 v[54:55], v[26:27], v[74:75], v[54:55] op_sel:[1,0,0] neg_lo:[1,0,0] neg_hi:[1,0,0]
v_pk_fma_f32 v[74:75], v[26:27], v[90:91], v[52:53] op_sel:[1,0,0] neg_lo:[1,0,0] neg_hi:[1,0,0]
v_mov_b64 v[90:91], v[54:55]
v_fma_f32 v220, v218, v24, -v58
v_fma_f32 v221, v218, v25, v59
v_pk_mul_f32 v[52:53], v[26:27], v[76:77] op_sel_hi:[0,1]
v_pk_mul_f32 v[54:55], v[26:27], v[92:93] op_sel_hi:[0,1] neg_lo:[1,0] neg_hi:[1,0]
v_mul_f32 v58, v221, v25
v_mul_f32 v59, v221, v24
v_pk_fma_f32 v[54:55], v[26:27], v[76:77], v[54:55] op_sel:[1,0,0] neg_lo:[1,0,0] neg_hi:[1,0,0]
v_pk_fma_f32 v[76:77], v[26:27], v[92:93], v[52:53] op_sel:[1,0,0] neg_lo:[1,0,0] neg_hi:[1,0,0]
v_mov_b64 v[92:93], v[54:55]
v_fma_f32 v222, v220, v24, -v58
v_fma_f32 v223, v220, v25, v59
v_pk_mul_f32 v[52:53], v[26:27], v[78:79] op_sel_hi:[0,1]
v_pk_mul_f32 v[54:55], v[26:27], v[94:95] op_sel_hi:[0,1] neg_lo:[1,0] neg_hi:[1,0]
v_mul_f32 v58, v223, v25
v_mul_f32 v59, v223, v24
v_pk_fma_f32 v[54:55], v[26:27], v[78:79], v[54:55] op_sel:[1,0,0] neg_lo:[1,0,0] neg_hi:[1,0,0]
v_pk_fma_f32 v[78:79], v[26:27], v[94:95], v[52:53] op_sel:[1,0,0] neg_lo:[1,0,0] neg_hi:[1,0,0]
v_mov_b64 v[94:95], v[54:55]
v_fma_f32 v224, v222, v24, -v58
v_fma_f32 v225, v222, v25, v59
v_pk_mul_f32 v[52:53], v[26:27], v[96:97] op_sel_hi:[0,1]
v_pk_mul_f32 v[54:55], v[26:27], v[112:113] op_sel_hi:[0,1] neg_lo:[1,0] neg_hi:[1,0]
v_mul_f32 v58, v225, v25
v_mul_f32 v59, v225, v24
v_pk_fma_f32 v[54:55], v[26:27], v[96:97], v[54:55] op_sel:[1,0,0] neg_lo:[1,0,0] neg_hi:[1,0,0]
v_pk_fma_f32 v[96:97], v[26:27], v[112:113], v[52:53] op_sel:[1,0,0] neg_lo:[1,0,0] neg_hi:[1,0,0]
v_mov_b64 v[112:113], v[54:55]
v_fma_f32 v226, v224, v24, -v58
v_fma_f32 v227, v224, v25, v59
v_pk_mul_f32 v[52:53], v[26:27], v[98:99] op_sel_hi:[0,1]
v_pk_mul_f32 v[54:55], v[26:27], v[114:115] op_sel_hi:[0,1] neg_lo:[1,0] neg_hi:[1,0]
v_mul_f32 v58, v227, v25
v_mul_f32 v59, v227, v24
v_pk_fma_f32 v[54:55], v[26:27], v[98:99], v[54:55] op_sel:[1,0,0] neg_lo:[1,0,0] neg_hi:[1,0,0]
v_pk_fma_f32 v[98:99], v[26:27], v[114:115], v[52:53] op_sel:[1,0,0] neg_lo:[1,0,0] neg_hi:[1,0,0]
v_mov_b64 v[114:115], v[54:55]
v_fma_f32 v228, v226, v24, -v58
v_fma_f32 v229, v226, v25, v59
v_pk_mul_f32 v[52:53], v[26:27], v[100:101] op_sel_hi:[0,1]
v_pk_mul_f32 v[54:55], v[26:27], v[116:117] op_sel_hi:[0,1] neg_lo:[1,0] neg_hi:[1,0]
v_mul_f32 v58, v229, v25
v_mul_f32 v59, v229, v24
v_pk_fma_f32 v[54:55], v[26:27], v[100:101], v[54:55] op_sel:[1,0,0] neg_lo:[1,0,0] neg_hi:[1,0,0]
v_pk_fma_f32 v[100:101], v[26:27], v[116:117], v[52:53] op_sel:[1,0,0] neg_lo:[1,0,0] neg_hi:[1,0,0]
v_mov_b64 v[116:117], v[54:55]
v_fma_f32 v230, v228, v24, -v58
v_fma_f32 v231, v228, v25, v59
v_pk_mul_f32 v[52:53], v[26:27], v[102:103] op_sel_hi:[0,1]
v_pk_mul_f32 v[54:55], v[26:27], v[118:119] op_sel_hi:[0,1] neg_lo:[1,0] neg_hi:[1,0]
v_mul_f32 v58, v231, v25
v_mul_f32 v59, v231, v24
v_pk_fma_f32 v[54:55], v[26:27], v[102:103], v[54:55] op_sel:[1,0,0] neg_lo:[1,0,0] neg_hi:[1,0,0]
v_pk_fma_f32 v[102:103], v[26:27], v[118:119], v[52:53] op_sel:[1,0,0] neg_lo:[1,0,0] neg_hi:[1,0,0]
v_mov_b64 v[118:119], v[54:55]
v_fma_f32 v232, v230, v24, -v58
v_fma_f32 v233, v230, v25, v59
v_pk_mul_f32 v[52:53], v[26:27], v[104:105] op_sel_hi:[0,1]
v_pk_mul_f32 v[54:55], v[26:27], v[120:121] op_sel_hi:[0,1] neg_lo:[1,0] neg_hi:[1,0]
v_mul_f32 v58, v233, v25
v_mul_f32 v59, v233, v24
v_pk_fma_f32 v[54:55], v[26:27], v[104:105], v[54:55] op_sel:[1,0,0] neg_lo:[1,0,0] neg_hi:[1,0,0]
v_pk_fma_f32 v[104:105], v[26:27], v[120:121], v[52:53] op_sel:[1,0,0] neg_lo:[1,0,0] neg_hi:[1,0,0]
v_mov_b64 v[120:121], v[54:55]
v_fma_f32 v234, v232, v24, -v58
v_fma_f32 v235, v232, v25, v59
v_pk_mul_f32 v[52:53], v[26:27], v[106:107] op_sel_hi:[0,1]
v_pk_mul_f32 v[54:55], v[26:27], v[122:123] op_sel_hi:[0,1] neg_lo:[1,0] neg_hi:[1,0]
v_mul_f32 v58, v235, v25
v_mul_f32 v59, v235, v24
v_pk_fma_f32 v[54:55], v[26:27], v[106:107], v[54:55] op_sel:[1,0,0] neg_lo:[1,0,0] neg_hi:[1,0,0]
v_pk_fma_f32 v[106:107], v[26:27], v[122:123], v[52:53] op_sel:[1,0,0] neg_lo:[1,0,0] neg_hi:[1,0,0]
v_mov_b64 v[122:123], v[54:55]
v_fma_f32 v236, v234, v24, -v58
v_fma_f32 v237, v234, v25, v59
v_pk_mul_f32 v[52:53], v[26:27], v[108:109] op_sel_hi:[0,1]
v_pk_mul_f32 v[54:55], v[26:27], v[124:125] op_sel_hi:[0,1] neg_lo:[1,0] neg_hi:[1,0]
v_mul_f32 v58, v237, v25
v_mul_f32 v59, v237, v24
v_pk_fma_f32 v[54:55], v[26:27], v[108:109], v[54:55] op_sel:[1,0,0] neg_lo:[1,0,0] neg_hi:[1,0,0]
v_pk_fma_f32 v[108:109], v[26:27], v[124:125], v[52:53] op_sel:[1,0,0] neg_lo:[1,0,0] neg_hi:[1,0,0]
v_mov_b64 v[124:125], v[54:55]
v_fma_f32 v238, v236, v24, -v58
v_fma_f32 v239, v236, v25, v59
v_pk_mul_f32 v[52:53], v[26:27], v[110:111] op_sel_hi:[0,1]
v_pk_mul_f32 v[54:55], v[26:27], v[126:127] op_sel_hi:[0,1] neg_lo:[1,0] neg_hi:[1,0]
v_mov_b32 v56, v110
v_mov_b32 v57, v126
v_pk_fma_f32 v[54:55], v[26:27], v[110:111], v[54:55] op_sel:[1,0,0] neg_lo:[1,0,0] neg_hi:[1,0,0]
v_pk_fma_f32 v[110:111], v[26:27], v[126:127], v[52:53] op_sel:[1,0,0] neg_lo:[1,0,0] neg_hi:[1,0,0]
v_mov_b64 v[126:127], v[54:55]
buffer_load_dwordx4 v[160:163], v128, s[40:43], 0 offen sc1
buffer_load_dwordx4 v[164:167], v129, s[40:43], 0 offen sc1
buffer_load_dwordx4 v[168:171], v130, s[40:43], 0 offen sc1
buffer_load_dwordx4 v[172:175], v131, s[40:43], 0 offen sc1
buffer_load_dwordx4 v[176:179], v132, s[40:43], 0 offen sc1
buffer_load_dwordx4 v[180:183], v133, s[40:43], 0 offen sc1
buffer_load_dwordx4 v[184:187], v134, s[40:43], 0 offen sc1
buffer_load_dwordx4 v[188:191], v135, s[40:43], 0 offen sc1
global_load_dword v63, v62, s[32:33] sc1
v_mov_b32 v12, 126976
s_lshl_b32 s60, s34, 2
v_add_u32 v13, s60, v12
v_mov_b32 v14, 1
s_mov_b64 exec, 1
ds_write_b32 v13, v14
s_mov_b64 exec, -1
s_xor_b32 s60, s68, s101
s_xor_b32 s60, s60, 1
s_lshl_b32 s60, s60, 6
s_add_u32 s60, s60, s66
v_lshrrev_b32 v8, 3, v1
v_lshl_add_u32 v8, v8, 1, s60
v_lshlrev_b32 v8, 11, v8
v_and_b32 v9, 7, v1
v_lshrrev_b32 v10, 4, v1
v_xor_b32 v9, v9, v10
v_lshlrev_b32 v9, 4, v9
v_xor_b32 v10, 64, v9
v_add_u32 v244, v8, v9
v_add_u32 v245, v8, v10
v_add_u32 v245, 31744, v245
v_add_u32 v246, v8, v9
v_add_u32 v246, 63488, v246
v_add_u32 v247, v8, v10
v_add_u32 v247, 95232, v247
s_and_b32 s64, s36, 7
s_lshl_b32 s60, s64, 18
s_lshl_b32 s61, s101, 10
s_add_u32 s60, s60, s61
s_add_u32 s48, s20, s60
s_addc_u32 s49, s21, 0
s_sub_u32 s50, 262144, s61
s_mov_b32 s51, 0x20000
s_add_u32 s52, s22, s60
s_addc_u32 s53, s23, 0
s_sub_u32 s54, 262144, s61
s_mov_b32 s55, 0x20000
s_lshl_b32 s61, s64, 1
s_add_u32 s61, s61, s101
s_lshl_b32 s61, s61, 7
s_lshl_b32 s63, s35, 1
s_add_u32 s63, s63, s68
s_lshl_b32 s60, s63, 17
s_add_u32 s60, s60, s61
s_add_u32 s56, s10, s60
s_addc_u32 s57, s11, 0
s_sub_u32 s58, 131072, s61
s_mov_b32 s59, 0x20000
s_add_u32 s26, s26, s61
s_addc_u32 s27, s27, 0
s_lshl_b32 s61, s61, 1
s_add_u32 s61, s61, 4096
s_lshl_b32 s60, s63, 19
s_add_u32 s60, s60, s61
s_add_u32 s28, s28, s60
s_addc_u32 s29, s29, 0
s_sub_u32 s24, 0x80000, s61
s_lshl_b32 s67, s34, 12
s_lshl_b32 s65, s64, 13
s_lshl_b32 s64, s64, 7
s_lshl_b32 s60, s68, 14
s_lshl_b32 s61, s66, 11
s_add_u32 s60, s60, s61
s_add_u32 s60, s60, 65536
v_add_u32 v16, s60, v11
s_lshl_b32 s60, s34, 13
s_add_u32 s60, s60, 65536
v_add_u32 v17, s60, v11
s_mov_b32 s69, 0
L_poll44:
s_mov_b64 s[60:61], 0
s_waitcnt vmcnt(8)
v_cmp_ne_u32 vcc, v162, v136
s_nop 0
s_or_b64 s[60:61], s[60:61], vcc
v_cmp_ne_u32 vcc, v163, v136
s_nop 0
s_or_b64 s[60:61], s[60:61], vcc
s_waitcnt vmcnt(7)
v_cmp_ne_u32 vcc, v166, v137
s_nop 0
s_or_b64 s[60:61], s[60:61], vcc
v_cmp_ne_u32 vcc, v167, v137
s_nop 0
s_or_b64 s[60:61], s[60:61], vcc
s_waitcnt vmcnt(6)
v_cmp_ne_u32 vcc, v170, v138
s_nop 0
s_or_b64 s[60:61], s[60:61], vcc
v_cmp_ne_u32 vcc, v171, v138
s_nop 0
s_or_b64 s[60:61], s[60:61], vcc
s_waitcnt vmcnt(5)
v_cmp_ne_u32 vcc, v174, v139
s_nop 0
s_or_b64 s[60:61], s[60:61], vcc
v_cmp_ne_u32 vcc, v175, v139
s_nop 0
s_or_b64 s[60:61], s[60:61], vcc
s_waitcnt vmcnt(4)
v_cmp_ne_u32 vcc, v178, v140
s_nop 0
s_or_b64 s[60:61], s[60:61], vcc
v_cmp_ne_u32 vcc, v179, v140
s_nop 0
s_or_b64 s[60:61], s[60:61], vcc
s_waitcnt vmcnt(3)
v_cmp_ne_u32 vcc, v182, v141
s_nop 0
s_or_b64 s[60:61], s[60:61], vcc
v_cmp_ne_u32 vcc, v183, v141
s_nop 0
s_or_b64 s[60:61], s[60:61], vcc
s_waitcnt vmcnt(2)
v_cmp_ne_u32 vcc, v186, v142
s_nop 0
s_or_b64 s[60:61], s[60:61], vcc
v_cmp_ne_u32 vcc, v187, v142
s_nop 0
s_or_b64 s[60:61], s[60:61], vcc
s_waitcnt vmcnt(1)
v_cmp_ne_u32 vcc, v190, v143
s_nop 0
s_or_b64 s[60:61], s[60:61], vcc
v_cmp_ne_u32 vcc, v191, v143
s_nop 0
s_or_b64 s[60:61], s[60:61], vcc
s_waitcnt vmcnt(0)
v_xor_b32 v63, v60, v63
v_cmp_lt_u32 vcc, 15, v63
s_nop 0
s_or_b64 s[60:61], s[60:61], vcc
s_add_u32 s69, s69, 1
s_cmp_eq_u64 s[60:61], 0
s_cbranch_scc1 L_polled45
s_cmp_ge_u32 s69, 200000
s_cbranch_scc1 L_polled45
buffer_load_dwordx4 v[160:163], v128, s[40:43], 0 offen sc1
buffer_load_dwordx4 v[164:167], v129, s[40:43], 0 offen sc1
buffer_load_dwordx4 v[168:171], v130, s[40:43], 0 offen sc1
buffer_load_dwordx4 v[172:175], v131, s[40:43], 0 offen sc1
buffer_load_dwordx4 v[176:179], v132, s[40:43], 0 offen sc1
buffer_load_dwordx4 v[180:183], v133, s[40:43], 0 offen sc1
buffer_load_dwordx4 v[184:187], v134, s[40:43], 0 offen sc1
buffer_load_dwordx4 v[188:191], v135, s[40:43], 0 offen sc1
global_load_dword v63, v62, s[32:33] sc1
s_branch L_poll44
L_polled45:
v_cmp_ne_u32 vcc, 0, v63
s_nop 0
s_cmp_eq_u64 vcc, 0
s_cselect_b32 s100, 1, 0
v_mov_b32 v14, 2
s_mov_b64 exec, 1
ds_write_b32 v13, v14
s_mov_b64 exec, -1
s_add_u32 m0, s67, 0
s_add_u32 s62, s64, 0
s_and_b32 s62, s62, 0x3ff
buffer_load_dwordx4 v244, s[48:51], s62 offen offset:0 lds
buffer_load_dwordx4 v245, s[48:51], s62 offen offset:1024 lds
buffer_load_dwordx4 v246, s[48:51], s62 offen offset:2048 lds
buffer_load_dwordx4 v247, s[48:51], s62 offen offset:3072 lds
s_add_u32 m0, s67, 16384
s_nop 0
buffer_load_dwordx4 v244, s[52:55], s62 offen offset:0 lds
buffer_load_dwordx4 v245, s[52:55], s62 offen offset:1024 lds
buffer_load_dwordx4 v246, s[52:55], s62 offen offset:2048 lds
buffer_load_dwordx4 v247, s[52:55], s62 offen offset:3072 lds
v_fma_f32 v40, v2, v188, v184
v_fma_f32 v41, v2, v189, v185
v_fma_f32 v48, -v3, v189, v40
v_fma_f32 v49, v3, v188, v41
v_fma_f32 v40, v2, v48, v180
v_fma_f32 v41, v2, v49, v181
v_fma_f32 v188, -v3, v49, v40
v_fma_f32 v189, v3, v48, v41
v_fma_f32 v40, v2, v188, v176
v_fma_f32 v41, v2, v189, v177
v_fma_f32 v48, -v3, v189, v40
v_fma_f32 v49, v3, v188, v41
v_fma_f32 v40, v2, v48, v172
v_fma_f32 v41, v2, v49, v173
v_fma_f32 v188, -v3, v49, v40
v_fma_f32 v189, v3, v48, v41
v_fma_f32 v40, v2, v188, v168
v_fma_f32 v41, v2, v189, v169
v_fma_f32 v48, -v3, v189, v40
v_fma_f32 v49, v3, v188, v41
v_fma_f32 v40, v2, v48, v164
v_fma_f32 v41, v2, v49, v165
v_fma_f32 v188, -v3, v49, v40
v_fma_f32 v189, v3, v48, v41
v_fma_f32 v40, v2, v188, v160
v_fma_f32 v41, v2, v189, v161
v_fma_f32 v48, -v3, v189, v40
v_fma_f32 v49, v3, v188, v41
v_mov_b32 v50, v48
v_mov_b32 v51, v49
s_nop 0
v_permlane32_swap_b32 v48, v50
v_permlane32_swap_b32 v49, v51
v_fma_f32 v40, v30, v50, v48
v_fma_f32 v41, v30, v51, v49
v_fma_f32 v192, -v31, v51, v40
v_fma_f32 v193, v31, v50, v41
v_fma_f32 v40, v20, v192, v144
v_fma_f32 v41, v20, v193, v145
v_fma_f32 v194, -v21, v193, v40
v_fma_f32 v195, v21, v192, v41
v_fma_f32 v40, v20, v194, v146
v_fma_f32 v41, v20, v195, v147
v_fma_f32 v196, -v21, v195, v40
v_fma_f32 v197, v21, v194, v41
v_fma_f32 v40, v20, v196, v148
v_fma_f32 v41, v20, v197, v149
v_fma_f32 v198, -v21, v197, v40
v_fma_f32 v199, v21, v196, v41
s_cmp_eq_u32 s68, 0
s_cbranch_scc1 L_wt046
v_mov_b64 v[192:193], v[196:197]
v_mov_b64 v[194:195], v[198:199]
L_wt046:
v_cmp_eq_u32 vcc, 1, v5
s_nop 1
v_cndmask_b32 v48, v192, v194, vcc
v_cndmask_b32 v50, v193, v195, vcc
v_fma_f32 v40, v28, v48, v56
v_fma_f32 v41, v28, v50, v57
v_fma_f32 v49, -v29, v50, v40
v_fma_f32 v51, v29, v48, v41
s_lshl_b32 s60, s35, 1
s_add_u32 s69, s60, s68
s_mul_i32 s60, s69, 262144
s_lshl_b32 s61, s36, 13
s_add_u32 s60, s60, s61
s_lshl_b32 s61, s66, 11
s_add_u32 s60, s60, s61
v_xor_b32 v20, 0, v7
v_add_u32 v24, 0x10000, v20
v_xor_b32 v21, 32, v7
v_add_u32 v25, 0x10000, v21
v_xor_b32 v22, 64, v7
v_add_u32 v26, 0x10000, v22
v_xor_b32 v23, 96, v7
v_add_u32 v27, 0x10000, v23
v_pk_fma_f32 v[64:65], v[208:209], v[48:49], v[64:65] op_sel_hi:[0,1,1]
v_pk_fma_f32 v[80:81], v[208:209], v[50:51], v[80:81] op_sel_hi:[0,1,1] neg_lo:[1,0,0] neg_hi:[1,0,0]
v_pk_fma_f32 v[64:65], v[208:209], v[50:51], v[64:65] op_sel:[1,0,0] neg_lo:[1,0,0] neg_hi:[1,0,0]
v_pk_fma_f32 v[80:81], v[208:209], v[48:49], v[80:81] op_sel:[1,0,0] neg_lo:[1,0,0] neg_hi:[1,0,0]
v_cvt_pk_bf16_f32 v128, v64, v65
v_cvt_pk_bf16_f32 v144, v80, v81
v_pk_fma_f32 v[66:67], v[210:211], v[48:49], v[66:67] op_sel_hi:[0,1,1]
v_pk_fma_f32 v[82:83], v[210:211], v[50:51], v[82:83] op_sel_hi:[0,1,1] neg_lo:[1,0,0] neg_hi:[1,0,0]
v_pk_fma_f32 v[66:67], v[210:211], v[50:51], v[66:67] op_sel:[1,0,0] neg_lo:[1,0,0] neg_hi:[1,0,0]
v_pk_fma_f32 v[82:83], v[210:211], v[48:49], v[82:83] op_sel:[1,0,0] neg_lo:[1,0,0] neg_hi:[1,0,0]
v_cvt_pk_bf16_f32 v129, v66, v67
v_cvt_pk_bf16_f32 v145, v82, v83
v_pk_fma_f32 v[68:69], v[212:213], v[48:49], v[68:69] op_sel_hi:[0,1,1]
v_pk_fma_f32 v[84:85], v[212:213], v[50:51], v[84:85] op_sel_hi:[0,1,1] neg_lo:[1,0,0] neg_hi:[1,0,0]
v_pk_fma_f32 v[68:69], v[212:213], v[50:51], v[68:69] op_sel:[1,0,0] neg_lo:[1,0,0] neg_hi:[1,0,0]
v_pk_fma_f32 v[84:85], v[212:213], v[48:49], v[84:85] op_sel:[1,0,0] neg_lo:[1,0,0] neg_hi:[1,0,0]
v_cvt_pk_bf16_f32 v130, v68, v69
v_cvt_pk_bf16_f32 v146, v84, v85
v_pk_fma_f32 v[70:71], v[214:215], v[48:49], v[70:71] op_sel_hi:[0,1,1]
v_pk_fma_f32 v[86:87], v[214:215], v[50:51], v[86:87] op_sel_hi:[0,1,1] neg_lo:[1,0,0] neg_hi:[1,0,0]
v_pk_fma_f32 v[70:71], v[214:215], v[50:51], v[70:71] op_sel:[1,0,0] neg_lo:[1,0,0] neg_hi:[1,0,0]
v_pk_fma_f32 v[86:87], v[214:215], v[48:49], v[86:87] op_sel:[1,0,0] neg_lo:[1,0,0] neg_hi:[1,0,0]
v_cvt_pk_bf16_f32 v131, v70, v71
v_cvt_pk_bf16_f32 v147, v86, v87
v_pk_fma_f32 v[72:73], v[216:217], v[48:49], v[72:73] op_sel_hi:[0,1,1]
v_pk_fma_f32 v[88:89], v[216:217], v[50:51], v[88:89] op_sel_hi:[0,1,1] neg_lo:[1,0,0] neg_hi:[1,0,0]
v_pk_fma_f32 v[72:73], v[216:217], v[50:51], v[72:73] op_sel:[1,0,0] neg_lo:[1,0,0] neg_hi:[1,0,0]
v_pk_fma_f32 v[88:89], v[216:217], v[48:49], v[88:89] op_sel:[1,0,0] neg_lo:[1,0,0] neg_hi:[1,0,0]
v_cvt_pk_bf16_f32 v132, v72, v73
v_cvt_pk_bf16_f32 v148, v88, v89
v_pk_fma_f32 v[74:75], v[218:219], v[48:49], v[74:75] op_sel_hi:[0,1,1]
v_pk_fma_f32 v[90:91], v[218:219], v[50:51], v[90:91] op_sel_hi:[0,1,1] neg_lo:[1,0,0] neg_hi:[1,0,0]
v_pk_fma_f32 v[74:75], v[218:219], v[50:51], v[74:75] op_sel:[1,0,0] neg_lo:[1,0,0] neg_hi:[1,0,0]
v_pk_fma_f32 v[90:91], v[218:219], v[48:49], v[90:91] op_sel:[1,0,0] neg_lo:[1,0,0] neg_hi:[1,0,0]
v_cvt_pk_bf16_f32 v133, v74, v75
v_cvt_pk_bf16_f32 v149, v90, v91
v_pk_fma_f32 v[76:77], v[220:221], v[48:49], v[76:77] op_sel_hi:[0,1,1]
v_pk_fma_f32 v[92:93], v[220:221], v[50:51], v[92:93] op_sel_hi:[0,1,1] neg_lo:[1,0,0] neg_hi:[1,0,0]
v_pk_fma_f32 v[76:77], v[220:221], v[50:51], v[76:77] op_sel:[1,0,0] neg_lo:[1,0,0] neg_hi:[1,0,0]
v_pk_fma_f32 v[92:93], v[220:221], v[48:49], v[92:93] op_sel:[1,0,0] neg_lo:[1,0,0] neg_hi:[1,0,0]
v_cvt_pk_bf16_f32 v134, v76, v77
v_cvt_pk_bf16_f32 v150, v92, v93
v_pk_fma_f32 v[78:79], v[222:223], v[48:49], v[78:79] op_sel_hi:[0,1,1]
v_pk_fma_f32 v[94:95], v[222:223], v[50:51], v[94:95] op_sel_hi:[0,1,1] neg_lo:[1,0,0] neg_hi:[1,0,0]
v_pk_fma_f32 v[78:79], v[222:223], v[50:51], v[78:79] op_sel:[1,0,0] neg_lo:[1,0,0] neg_hi:[1,0,0]
v_pk_fma_f32 v[94:95], v[222:223], v[48:49], v[94:95] op_sel:[1,0,0] neg_lo:[1,0,0] neg_hi:[1,0,0]
v_cvt_pk_bf16_f32 v135, v78, v79
v_cvt_pk_bf16_f32 v151, v94, v95
v_mfma_f32_32x32x16_bf16 v[160:175], v[128:131], v[248:251], 0
v_mfma_f32_32x32x16_bf16 v[160:175], v[132:135], v[252:255], v[160:175]
v_mfma_f32_32x32x16_bf16 v[176:191], v[144:147], v[248:251], 0
v_mfma_f32_32x32x16_bf16 v[176:191], v[148:151], v[252:255], v[176:191]
v_pk_fma_f32 v[96:97], v[224:225], v[48:49], v[96:97] op_sel_hi:[0,1,1]
v_pk_fma_f32 v[112:113], v[224:225], v[50:51], v[112:113] op_sel_hi:[0,1,1] neg_lo:[1,0,0] neg_hi:[1,0,0]
v_pk_fma_f32 v[96:97], v[224:225], v[50:51], v[96:97] op_sel:[1,0,0] neg_lo:[1,0,0] neg_hi:[1,0,0]
v_pk_fma_f32 v[112:113], v[224:225], v[48:49], v[112:113] op_sel:[1,0,0] neg_lo:[1,0,0] neg_hi:[1,0,0]
v_cvt_pk_bf16_f32 v136, v96, v97
v_cvt_pk_bf16_f32 v152, v112, v113
v_pk_fma_f32 v[98:99], v[226:227], v[48:49], v[98:99] op_sel_hi:[0,1,1]
v_pk_fma_f32 v[114:115], v[226:227], v[50:51], v[114:115] op_sel_hi:[0,1,1] neg_lo:[1,0,0] neg_hi:[1,0,0]
v_pk_fma_f32 v[98:99], v[226:227], v[50:51], v[98:99] op_sel:[1,0,0] neg_lo:[1,0,0] neg_hi:[1,0,0]
v_pk_fma_f32 v[114:115], v[226:227], v[48:49], v[114:115] op_sel:[1,0,0] neg_lo:[1,0,0] neg_hi:[1,0,0]
v_cvt_pk_bf16_f32 v137, v98, v99
v_cvt_pk_bf16_f32 v153, v114, v115
v_pk_fma_f32 v[100:101], v[228:229], v[48:49], v[100:101] op_sel_hi:[0,1,1]
v_pk_fma_f32 v[116:117], v[228:229], v[50:51], v[116:117] op_sel_hi:[0,1,1] neg_lo:[1,0,0] neg_hi:[1,0,0]
v_pk_fma_f32 v[100:101], v[228:229], v[50:51], v[100:101] op_sel:[1,0,0] neg_lo:[1,0,0] neg_hi:[1,0,0]
v_pk_fma_f32 v[116:117], v[228:229], v[48:49], v[116:117] op_sel:[1,0,0] neg_lo:[1,0,0] neg_hi:[1,0,0]
v_cvt_pk_bf16_f32 v138, v100, v101
v_cvt_pk_bf16_f32 v154, v116, v117
v_pk_fma_f32 v[102:103], v[230:231], v[48:49], v[102:103] op_sel_hi:[0,1,1]
v_pk_fma_f32 v[118:119], v[230:231], v[50:51], v[118:119] op_sel_hi:[0,1,1] neg_lo:[1,0,0] neg_hi:[1,0,0]
v_pk_fma_f32 v[102:103], v[230:231], v[50:51], v[102:103] op_sel:[1,0,0] neg_lo:[1,0,0] neg_hi:[1,0,0]
v_pk_fma_f32 v[118:119], v[230:231], v[48:49], v[118:119] op_sel:[1,0,0] neg_lo:[1,0,0] neg_hi:[1,0,0]
v_cvt_pk_bf16_f32 v139, v102, v103
v_cvt_pk_bf16_f32 v155, v118, v119
s_add_u32 s61, s60, 0
v_cvt_pk_bf16_f32 v64, v160, v161
v_cvt_pk_bf16_f32 v65, v162, v163
v_cvt_pk_bf16_f32 v66, v164, v165
v_cvt_pk_bf16_f32 v67, v166, v167
v_cvt_pk_bf16_f32 v68, v168, v169
v_cvt_pk_bf16_f32 v69, v170, v171
v_cvt_pk_bf16_f32 v70, v172, v173
v_cvt_pk_bf16_f32 v71, v174, v175
buffer_store_dwordx4 v[64:67], v11, s[44:47], s61 offen sc1
buffer_store_dwordx4 v[68:71], v11, s[44:47], s61 offen offset:1024 sc1
ds_write_b128 v16, v[64:67] offset:0
ds_write_b128 v16, v[68:71] offset:1024
s_add_u32 s61, s60, 4096
v_cvt_pk_bf16_f32 v72, v176, v177
v_cvt_pk_bf16_f32 v73, v178, v179
v_cvt_pk_bf16_f32 v74, v180, v181
v_cvt_pk_bf16_f32 v75, v182, v183
v_cvt_pk_bf16_f32 v76, v184, v185
v_cvt_pk_bf16_f32 v77, v186, v187
v_cvt_pk_bf16_f32 v78, v188, v189
v_cvt_pk_bf16_f32 v79, v190, v191
buffer_store_dwordx4 v[72:75], v11, s[44:47], s61 offen sc1
buffer_store_dwordx4 v[76:79], v11, s[44:47], s61 offen offset:1024 sc1
ds_write_b128 v16, v[72:75] offset:4096
ds_write_b128 v16, v[76:79] offset:5120
v_pk_fma_f32 v[104:105], v[232:233], v[48:49], v[104:105] op_sel_hi:[0,1,1]
v_pk_fma_f32 v[120:121], v[232:233], v[50:51], v[120:121] op_sel_hi:[0,1,1] neg_lo:[1,0,0] neg_hi:[1,0,0]
v_pk_fma_f32 v[104:105], v[232:233], v[50:51], v[104:105] op_sel:[1,0,0] neg_lo:[1,0,0] neg_hi:[1,0,0]
v_pk_fma_f32 v[120:121], v[232:233], v[48:49], v[120:121] op_sel:[1,0,0] neg_lo:[1,0,0] neg_hi:[1,0,0]
v_cvt_pk_bf16_f32 v140, v104, v105
v_cvt_pk_bf16_f32 v156, v120, v121
v_pk_fma_f32 v[106:107], v[234:235], v[48:49], v[106:107] op_sel_hi:[0,1,1]
v_pk_fma_f32 v[122:123], v[234:235], v[50:51], v[122:123] op_sel_hi:[0,1,1] neg_lo:[1,0,0] neg_hi:[1,0,0]
v_pk_fma_f32 v[106:107], v[234:235], v[50:51], v[106:107] op_sel:[1,0,0] neg_lo:[1,0,0] neg_hi:[1,0,0]
v_pk_fma_f32 v[122:123], v[234:235], v[48:49], v[122:123] op_sel:[1,0,0] neg_lo:[1,0,0] neg_hi:[1,0,0]
v_cvt_pk_bf16_f32 v141, v106, v107
v_cvt_pk_bf16_f32 v157, v122, v123
v_pk_fma_f32 v[108:109], v[236:237], v[48:49], v[108:109] op_sel_hi:[0,1,1]
v_pk_fma_f32 v[124:125], v[236:237], v[50:51], v[124:125] op_sel_hi:[0,1,1] neg_lo:[1,0,0] neg_hi:[1,0,0]
v_pk_fma_f32 v[108:109], v[236:237], v[50:51], v[108:109] op_sel:[1,0,0] neg_lo:[1,0,0] neg_hi:[1,0,0]
v_pk_fma_f32 v[124:125], v[236:237], v[48:49], v[124:125] op_sel:[1,0,0] neg_lo:[1,0,0] neg_hi:[1,0,0]
v_cvt_pk_bf16_f32 v142, v108, v109
v_cvt_pk_bf16_f32 v158, v124, v125
v_pk_fma_f32 v[110:111], v[238:239], v[48:49], v[110:111] op_sel_hi:[0,1,1]
v_pk_fma_f32 v[126:127], v[238:239], v[50:51], v[126:127] op_sel_hi:[0,1,1] neg_lo:[1,0,0] neg_hi:[1,0,0]
v_pk_fma_f32 v[110:111], v[238:239], v[50:51], v[110:111] op_sel:[1,0,0] neg_lo:[1,0,0] neg_hi:[1,0,0]
v_pk_fma_f32 v[126:127], v[238:239], v[48:49], v[126:127] op_sel:[1,0,0] neg_lo:[1,0,0] neg_hi:[1,0,0]
v_cvt_pk_bf16_f32 v143, v110, v111
v_cvt_pk_bf16_f32 v159, v126, v127
v_mfma_f32_32x32x16_bf16 v[192:207], v[136:139], v[248:251], 0
v_mfma_f32_32x32x16_bf16 v[192:207], v[140:143], v[252:255], v[192:207]
v_mfma_f32_32x32x16_bf16 v[32:47], v[152:155], v[248:251], 0
v_mfma_f32_32x32x16_bf16 v[32:47], v[156:159], v[252:255], v[32:47]
s_add_u32 s61, s60, 131072
s_nop 8
v_cvt_pk_bf16_f32 v80, v192, v193
v_cvt_pk_bf16_f32 v81, v194, v195
v_cvt_pk_bf16_f32 v82, v196, v197
v_cvt_pk_bf16_f32 v83, v198, v199
v_cvt_pk_bf16_f32 v84, v200, v201
v_cvt_pk_bf16_f32 v85, v202, v203
v_cvt_pk_bf16_f32 v86, v204, v205
v_cvt_pk_bf16_f32 v87, v206, v207
buffer_store_dwordx4 v[80:83], v11, s[44:47], s61 offen sc1
buffer_store_dwordx4 v[84:87], v11, s[44:47], s61 offen offset:1024 sc1
ds_write_b128 v16, v[80:83] offset:8192
ds_write_b128 v16, v[84:87] offset:9216
s_add_u32 s61, s60, 135168
v_cvt_pk_bf16_f32 v88, v32, v33
v_cvt_pk_bf16_f32 v89, v34, v35
v_cvt_pk_bf16_f32 v90, v36, v37
v_cvt_pk_bf16_f32 v91, v38, v39
v_cvt_pk_bf16_f32 v92, v40, v41
v_cvt_pk_bf16_f32 v93, v42, v43
v_cvt_pk_bf16_f32 v94, v44, v45
v_cvt_pk_bf16_f32 v95, v46, v47
buffer_store_dwordx4 v[88:91], v11, s[44:47], s61 offen sc1
buffer_store_dwordx4 v[92:95], v11, s[44:47], s61 offen offset:1024 sc1
ds_write_b128 v16, v[88:91] offset:12288
ds_write_b128 v16, v[92:95] offset:13312
v_mov_b32 v2, v11
s_lshl_b32 s60, s35, 2
s_add_u32 s60, s60, s34
s_mul_i32 s60, s60, 131072
s_lshl_b32 s61, s101, 16
s_add_u32 s60, s60, s61
s_add_u32 s42, s60, 1048576
s_add_u32 s40, s32, s42
s_addc_u32 s41, s33, 0
s_mov_b32 s42, 65536
s_mov_b32 s43, 0x20000
s_waitcnt vmcnt(8) lgkmcnt(0)
v_mov_b32 v14, 3
s_mov_b64 exec, 1
ds_write_b32 v13, v14
s_mov_b64 exec, -1
ds_read_b128 v[8:11], v12 offset:0
s_waitcnt lgkmcnt(0)
L_ck47:
v_min3_u32 v15, v8, v9, v10
v_min_u32 v15, v15, v11
s_nop 0
v_readfirstlane_b32 s60, v15
s_nop 0
s_cmp_ge_u32 s60, 3
s_cbranch_scc1 L_ckd48
ds_read_b128 v[8:11], v12 offset:0
s_waitcnt lgkmcnt(0)
s_branch L_ck47
L_ckd48:
ds_read_b128 v[148:151], v17 offset:0
ds_read_b128 v[152:155], v17 offset:1024
ds_read_b128 v[156:159], v17 offset:2048
ds_read_b128 v[160:163], v17 offset:3072
ds_read_b128 v[164:167], v17 offset:4096
ds_read_b128 v[168:171], v17 offset:5120
ds_read_b128 v[172:175], v17 offset:6144
ds_read_b128 v[176:179], v17 offset:7168
ds_read_b128 v[96:99], v20 offset:0
ds_read_b128 v[100:103], v20 offset:4096
ds_read_b128 v[104:107], v20 offset:8192
ds_read_b128 v[108:111], v20 offset:12288
s_waitcnt lgkmcnt(4)
v_mov_b32 v14, 4
s_mov_b64 exec, 1
ds_write_b32 v13, v14
s_mov_b64 exec, -1
s_waitcnt lgkmcnt(0)
v_mfma_f32_32x32x16_bf16 v[32:47], v[148:151], v[96:99], 0
ds_read_b128 v[112:115], v21 offset:0
ds_read_b128 v[116:119], v21 offset:4096
v_mfma_f32_32x32x16_bf16 v[48:63], v[148:151], v[100:103], 0
ds_read_b128 v[120:123], v21 offset:8192
ds_read_b128 v[124:127], v21 offset:12288
v_mfma_f32_32x32x16_bf16 v[64:79], v[148:151], v[104:107], 0
s_add_u32 m0, s67, 32768
s_add_u32 s62, s64, 128
s_and_b32 s62, s62, 0x3ff
buffer_load_dwordx4 v244, s[48:51], s62 offen offset:0 lds
v_mfma_f32_32x32x16_bf16 v[80:95], v[148:151], v[108:111], 0
s_waitcnt lgkmcnt(3)
v_mfma_f32_32x32x16_bf16 v[32:47], v[152:155], v[112:115], v[32:47]
ds_read_b128 v[96:99], v22 offset:0
ds_read_b128 v[100:103], v22 offset:4096
s_waitcnt lgkmcnt(4)
v_mfma_f32_32x32x16_bf16 v[48:63], v[152:155], v[116:119], v[48:63]
ds_read_b128 v[104:107], v22 offset:8192
ds_read_b128 v[108:111], v22 offset:12288
s_waitcnt lgkmcnt(5)
v_mfma_f32_32x32x16_bf16 v[64:79], v[152:155], v[120:123], v[64:79]
buffer_load_dwordx4 v245, s[48:51], s62 offen offset:1024 lds
s_waitcnt lgkmcnt(4)
v_mfma_f32_32x32x16_bf16 v[80:95], v[152:155], v[124:127], v[80:95]
s_waitcnt lgkmcnt(3)
v_mfma_f32_32x32x16_bf16 v[32:47], v[156:159], v[96:99], v[32:47]
ds_read_b128 v[112:115], v23 offset:0
ds_read_b128 v[116:119], v23 offset:4096
s_waitcnt lgkmcnt(4)
v_mfma_f32_32x32x16_bf16 v[48:63], v[156:159], v[100:103], v[48:63]
ds_read_b128 v[120:123], v23 offset:8192
ds_read_b128 v[124:127], v23 offset:12288
s_waitcnt lgkmcnt(5)
v_mfma_f32_32x32x16_bf16 v[64:79], v[156:159], v[104:107], v[64:79]
buffer_load_dwordx4 v246, s[48:51], s62 offen offset:2048 lds
s_waitcnt lgkmcnt(4)
v_mfma_f32_32x32x16_bf16 v[80:95], v[156:159], v[108:111], v[80:95]
s_waitcnt lgkmcnt(3)
v_mfma_f32_32x32x16_bf16 v[32:47], v[160:163], v[112:115], v[32:47]
ds_read_b128 v[96:99], v20 offset:16384
ds_read_b128 v[100:103], v20 offset:20480
s_waitcnt lgkmcnt(4)
v_mfma_f32_32x32x16_bf16 v[48:63], v[160:163], v[116:119], v[48:63]
ds_read_b128 v[104:107], v20 offset:24576
ds_read_b128 v[108:111], v20 offset:28672
s_waitcnt lgkmcnt(5)
v_mfma_f32_32x32x16_bf16 v[64:79], v[160:163], v[120:123], v[64:79]
buffer_load_dwordx4 v247, s[48:51], s62 offen offset:3072 lds
s_waitcnt lgkmcnt(4)
v_mfma_f32_32x32x16_bf16 v[80:95], v[160:163], v[124:127], v[80:95]
s_waitcnt lgkmcnt(3)
v_mfma_f32_32x32x16_bf16 v[32:47], v[164:167], v[96:99], v[32:47]
ds_read_b128 v[112:115], v21 offset:16384
ds_read_b128 v[116:119], v21 offset:20480
s_waitcnt lgkmcnt(4)
v_mfma_f32_32x32x16_bf16 v[48:63], v[164:167], v[100:103], v[48:63]
ds_read_b128 v[120:123], v21 offset:24576
ds_read_b128 v[124:127], v21 offset:28672
s_waitcnt lgkmcnt(5)
v_mfma_f32_32x32x16_bf16 v[64:79], v[164:167], v[104:107], v[64:79]
s_add_u32 m0, s67, 49152
s_nop 0
buffer_load_dwordx4 v244, s[52:55], s62 offen offset:0 lds
s_waitcnt lgkmcnt(4)
v_mfma_f32_32x32x16_bf16 v[80:95], v[164:167], v[108:111], v[80:95]
s_waitcnt lgkmcnt(3)
v_mfma_f32_32x32x16_bf16 v[32:47], v[168:171], v[112:115], v[32:47]
ds_read_b128 v[96:99], v22 offset:16384
ds_read_b128 v[100:103], v22 offset:20480
s_waitcnt lgkmcnt(4)
v_mfma_f32_32x32x16_bf16 v[48:63], v[168:171], v[116:119], v[48:63]
ds_read_b128 v[104:107], v22 offset:24576
ds_read_b128 v[108:111], v22 offset:28672
s_waitcnt lgkmcnt(5)
v_mfma_f32_32x32x16_bf16 v[64:79], v[168:171], v[120:123], v[64:79]
buffer_load_dwordx4 v245, s[52:55], s62 offen offset:1024 lds
s_waitcnt lgkmcnt(4)
v_mfma_f32_32x32x16_bf16 v[80:95], v[168:171], v[124:127], v[80:95]
s_waitcnt lgkmcnt(3)
v_mfma_f32_32x32x16_bf16 v[32:47], v[172:175], v[96:99], v[32:47]
ds_read_b128 v[112:115], v23 offset:16384
ds_read_b128 v[116:119], v23 offset:20480
s_waitcnt lgkmcnt(4)
v_mfma_f32_32x32x16_bf16 v[48:63], v[172:175], v[100:103], v[48:63]
ds_read_b128 v[120:123], v23 offset:24576
ds_read_b128 v[124:127], v23 offset:28672
s_waitcnt lgkmcnt(5)
v_mfma_f32_32x32x16_bf16 v[64:79], v[172:175], v[104:107], v[64:79]
buffer_load_dwordx4 v246, s[52:55], s62 offen offset:2048 lds
s_waitcnt lgkmcnt(4)
v_mfma_f32_32x32x16_bf16 v[80:95], v[172:175], v[108:111], v[80:95]
s_waitcnt lgkmcnt(0)
v_mfma_f32_32x32x16_bf16 v[32:47], v[176:179], v[112:115], v[32:47]
v_mfma_f32_32x32x16_bf16 v[48:63], v[176:179], v[116:119], v[48:63]
v_mfma_f32_32x32x16_bf16 v[64:79], v[176:179], v[120:123], v[64:79]
buffer_load_dwordx4 v247, s[52:55], s62 offen offset:3072 lds
v_mfma_f32_32x32x16_bf16 v[80:95], v[176:179], v[124:127], v[80:95]
s_lshl_b32 s60, s66, 3
v_lshl_add_u32 v17, v5, 2, s60
v_lshlrev_b32 v28, 11, v17
v_lshl_add_u32 v28, v6, 2, v28
v_lshlrev_b32 v29, 13, v17
v_lshl_add_u32 v29, v6, 3, v29
v_lshlrev_b32 v30, 2, v6
v_mov_b32 v15, s37
s_waitcnt vmcnt(8)
s_mov_b64 exec, 1
s_cmp_eq_u32 s100, 0
s_cbranch_scc1 L_rs49
global_store_dword v19, v15, s[32:33]
s_branch L_rd50
L_rs49:
global_store_dword v19, v15, s[32:33] sc1
L_rd50:
s_mov_b64 exec, -1
ds_read_b128 v[8:11], v12 offset:0
s_waitcnt lgkmcnt(0)
L_ck51:
v_min3_u32 v15, v8, v9, v10
v_min_u32 v15, v15, v11
s_nop 0
v_readfirstlane_b32 s60, v15
s_nop 0
s_cmp_ge_u32 s60, 4
s_cbranch_scc1 L_ckd52
ds_read_b128 v[8:11], v12 offset:0
s_waitcnt lgkmcnt(0)
s_branch L_ck51
L_ckd52:
ds_read_b128 v[8:11], v12 offset:16
s_waitcnt lgkmcnt(0)
L_ck53:
v_min3_u32 v15, v8, v9, v10
v_min_u32 v15, v15, v11
s_nop 0
v_readfirstlane_b32 s60, v15
s_nop 0
s_cmp_ge_u32 s60, 2
s_cbranch_scc1 L_ckd54
ds_read_b128 v[8:11], v12 offset:16
s_waitcnt lgkmcnt(0)
s_branch L_ck53
L_ckd54:
s_add_u32 m0, s67, 65536
s_add_u32 s62, s64, 256
s_and_b32 s62, s62, 0x3ff
buffer_load_dwordx4 v244, s[48:51], s62 offen offset:0 lds
buffer_load_dwordx4 v245, s[48:51], s62 offen offset:1024 lds
buffer_load_dwordx4 v246, s[48:51], s62 offen offset:2048 lds
buffer_load_dwordx4 v247, s[48:51], s62 offen offset:3072 lds
s_add_u32 m0, s67, 81920
s_nop 0
buffer_load_dwordx4 v244, s[52:55], s62 offen offset:0 lds
buffer_load_dwordx4 v245, s[52:55], s62 offen offset:1024 lds
buffer_load_dwordx4 v246, s[52:55], s62 offen offset:2048 lds
buffer_load_dwordx4 v247, s[52:55], s62 offen offset:3072 lds
s_mov_b32 s92, 0
L_w55:
global_load_dword v8, v18, s[32:33] sc1
s_waitcnt vmcnt(0)
v_cmp_ne_u32 vcc, s37, v8
s_nop 0
s_cbranch_vccz L_wd56
s_sleep 4
s_add_u32 s92, s92, 1
s_cmp_lt_u32 s92, 200000
s_cbranch_scc1 L_w55
L_wd56:
v_mov_b32 v14, 5
s_mov_b64 exec, 1
ds_write_b32 v13, v14
s_mov_b64 exec, -1
s_add_u32 s63, s65, 8192
s_and_b32 s63, s63, 0xffff
buffer_load_dwordx4 v[180:183], v2, s[40:43], s63 offen offset:0 sc1
buffer_load_dwordx4 v[184:187], v2, s[40:43], s63 offen offset:1024 sc1
buffer_load_dwordx4 v[188:191], v2, s[40:43], s63 offen offset:2048 sc1
buffer_load_dwordx4 v[192:195], v2, s[40:43], s63 offen offset:3072 sc1
s_add_u32 m0, s67, 98304
s_add_u32 s62, s64, 384
s_and_b32 s62, s62, 0x3ff
buffer_load_dwordx4 v244, s[48:51], s62 offen offset:0 lds
buffer_load_dwordx4 v245, s[48:51], s62 offen offset:1024 lds
buffer_load_dwordx4 v246, s[48:51], s62 offen offset:2048 lds
buffer_load_dwordx4 v247, s[48:51], s62 offen offset:3072 lds
s_add_u32 s63, s65, 12288
s_and_b32 s63, s63, 0xffff
buffer_load_dwordx4 v[196:199], v2, s[40:43], s63 offen offset:0 sc1
buffer_load_dwordx4 v[200:203], v2, s[40:43], s63 offen offset:1024 sc1
buffer_load_dwordx4 v[204:207], v2, s[40:43], s63 offen offset:2048 sc1
buffer_load_dwordx4 v[208:211], v2, s[40:43], s63 offen offset:3072 sc1
ds_read_b128 v[8:11], v12 offset:0
s_waitcnt lgkmcnt(0)
L_ck57:
v_min3_u32 v15, v8, v9, v10
v_min_u32 v15, v15, v11
s_nop 0
v_readfirstlane_b32 s60, v15
s_nop 0
s_cmp_ge_u32 s60, 5
s_cbranch_scc1 L_ckd58
ds_read_b128 v[8:11], v12 offset:0
s_waitcnt lgkmcnt(0)
s_branch L_ck57
L_ckd58:
ds_read_b128 v[96:99], v20 offset:32768
ds_read_b128 v[100:103], v20 offset:36864
ds_read_b128 v[104:107], v20 offset:40960
ds_read_b128 v[108:111], v20 offset:45056
s_waitcnt vmcnt(11) lgkmcnt(3)
v_mfma_f32_32x32x16_bf16 v[32:47], v[180:183], v[96:99], v[32:47]
ds_read_b128 v[112:115], v21 offset:32768
ds_read_b128 v[116:119], v21 offset:36864
s_waitcnt lgkmcnt(4)
v_mfma_f32_32x32x16_bf16 v[48:63], v[180:183], v[100:103], v[48:63]
ds_read_b128 v[120:123], v21 offset:40960
ds_read_b128 v[124:127], v21 offset:45056
s_waitcnt lgkmcnt(5)
v_mfma_f32_32x32x16_bf16 v[64:79], v[180:183], v[104:107], v[64:79]
s_waitcnt lgkmcnt(4)
v_mfma_f32_32x32x16_bf16 v[80:95], v[180:183], v[108:111], v[80:95]
s_add_u32 s63, s65, 16384
s_and_b32 s63, s63, 0xffff
buffer_load_dwordx4 v[212:215], v2, s[40:43], s63 offen offset:0 sc1
buffer_load_dwordx4 v[216:219], v2, s[40:43], s63 offen offset:1024 sc1
s_waitcnt vmcnt(12) lgkmcnt(3)
v_mfma_f32_32x32x16_bf16 v[32:47], v[184:187], v[112:115], v[32:47]
ds_read_b128 v[96:99], v22 offset:32768
ds_read_b128 v[100:103], v22 offset:36864
s_waitcnt lgkmcnt(4)
v_mfma_f32_32x32x16_bf16 v[48:63], v[184:187], v[116:119], v[48:63]
ds_read_b128 v[104:107], v22 offset:40960
ds_read_b128 v[108:111], v22 offset:45056
s_waitcnt lgkmcnt(5)
v_mfma_f32_32x32x16_bf16 v[64:79], v[184:187], v[120:123], v[64:79]
s_waitcnt lgkmcnt(4)
v_mfma_f32_32x32x16_bf16 v[80:95], v[184:187], v[124:127], v[80:95]
buffer_load_dwordx4 v[220:223], v2, s[40:43], s63 offen offset:2048 sc1
buffer_load_dwordx4 v[224:227], v2, s[40:43], s63 offen offset:3072 sc1
s_waitcnt vmcnt(13) lgkmcnt(3)
v_mfma_f32_32x32x16_bf16 v[32:47], v[188:191], v[96:99], v[32:47]
ds_read_b128 v[112:115], v23 offset:32768
ds_read_b128 v[116:119], v23 offset:36864
s_waitcnt lgkmcnt(4)
v_mfma_f32_32x32x16_bf16 v[48:63], v[188:191], v[100:103], v[48:63]
ds_read_b128 v[120:123], v23 offset:40960
ds_read_b128 v[124:127], v23 offset:45056
s_waitcnt lgkmcnt(5)
v_mfma_f32_32x32x16_bf16 v[64:79], v[188:191], v[104:107], v[64:79]
s_waitcnt lgkmcnt(4)
v_mfma_f32_32x32x16_bf16 v[80:95], v[188:191], v[108:111], v[80:95]
s_add_u32 s63, s65, 20480
s_and_b32 s63, s63, 0xffff
buffer_load_dwordx4 v[228:231], v2, s[40:43], s63 offen offset:0 sc1
buffer_load_dwordx4 v[232:235], v2, s[40:43], s63 offen offset:1024 sc1
s_waitcnt vmcnt(14) lgkmcnt(3)
v_mfma_f32_32x32x16_bf16 v[32:47], v[192:195], v[112:115], v[32:47]
ds_read_b128 v[96:99], v20 offset:49152
ds_read_b128 v[100:103], v20 offset:53248
s_waitcnt lgkmcnt(4)
v_mfma_f32_32x32x16_bf16 v[48:63], v[192:195], v[116:119], v[48:63]
ds_read_b128 v[104:107], v20 offset:57344
ds_read_b128 v[108:111], v20 offset:61440
s_waitcnt lgkmcnt(5)
v_mfma_f32_32x32x16_bf16 v[64:79], v[192:195], v[120:123], v[64:79]
s_waitcnt lgkmcnt(4)
v_mfma_f32_32x32x16_bf16 v[80:95], v[192:195], v[124:127], v[80:95]
buffer_load_dwordx4 v[236:239], v2, s[40:43], s63 offen offset:2048 sc1
buffer_load_dwordx4 v[240:243], v2, s[40:43], s63 offen offset:3072 sc1
s_waitcnt vmcnt(11) lgkmcnt(3)
v_mov_b32 v14, 6
s_mov_b64 exec, 1
ds_write_b32 v13, v14
s_mov_b64 exec, -1
v_mfma_f32_32x32x16_bf16 v[32:47], v[196:199], v[96:99], v[32:47]
ds_read_b128 v[112:115], v21 offset:49152
ds_read_b128 v[116:119], v21 offset:53248
s_waitcnt lgkmcnt(5)
v_mfma_f32_32x32x16_bf16 v[48:63], v[196:199], v[100:103], v[48:63]
ds_read_b128 v[120:123], v21 offset:57344
ds_read_b128 v[124:127], v21 offset:61440
s_waitcnt lgkmcnt(6)
v_mfma_f32_32x32x16_bf16 v[64:79], v[196:199], v[104:107], v[64:79]
s_add_u32 m0, s67, 0
s_nop 0
buffer_load_dwordx4 v244, s[52:55], s62 offen offset:0 lds
s_waitcnt lgkmcnt(5)
v_mfma_f32_32x32x16_bf16 v[80:95], v[196:199], v[108:111], v[80:95]
s_add_u32 s63, s65, 24576
s_and_b32 s63, s63, 0xffff
buffer_load_dwordx4 v[148:151], v2, s[40:43], s63 offen offset:0 sc1
buffer_load_dwordx4 v[152:155], v2, s[40:43], s63 offen offset:1024 sc1
s_waitcnt vmcnt(13) lgkmcnt(3)
v_mfma_f32_32x32x16_bf16 v[32:47], v[200:203], v[112:115], v[32:47]
ds_read_b128 v[96:99], v22 offset:49152
ds_read_b128 v[100:103], v22 offset:53248
s_waitcnt lgkmcnt(4)
v_mfma_f32_32x32x16_bf16 v[48:63], v[200:203], v[116:119], v[48:63]
ds_read_b128 v[104:107], v22 offset:57344
ds_read_b128 v[108:111], v22 offset:61440
s_waitcnt lgkmcnt(5)
v_mfma_f32_32x32x16_bf16 v[64:79], v[200:203], v[120:123], v[64:79]
buffer_load_dwordx4 v245, s[52:55], s62 offen offset:1024 lds
s_waitcnt lgkmcnt(4)
v_mfma_f32_32x32x16_bf16 v[80:95], v[200:203], v[124:127], v[80:95]
buffer_load_dwordx4 v[156:159], v2, s[40:43], s63 offen offset:2048 sc1
buffer_load_dwordx4 v[160:163], v2, s[40:43], s63 offen offset:3072 sc1
s_waitcnt vmcnt(15) lgkmcnt(3)
v_mfma_f32_32x32x16_bf16 v[32:47], v[204:207], v[96:99], v[32:47]
ds_read_b128 v[112:115], v23 offset:49152
ds_read_b128 v[116:119], v23 offset:53248
s_waitcnt lgkmcnt(4)
v_mfma_f32_32x32x16_bf16 v[48:63], v[204:207], v[100:103], v[48:63]
ds_read_b128 v[120:123], v23 offset:57344
ds_read_b128 v[124:127], v23 offset:61440
s_waitcnt lgkmcnt(5)
v_mfma_f32_32x32x16_bf16 v[64:79], v[204:207], v[104:107], v[64:79]
buffer_load_dwordx4 v246, s[52:55], s62 offen offset:2048 lds
s_waitcnt lgkmcnt(4)
v_mfma_f32_32x32x16_bf16 v[80:95], v[204:207], v[108:111], v[80:95]
s_add_u32 s63, s65, 28672
s_and_b32 s63, s63, 0xffff
buffer_load_dwordx4 v[164:167], v2, s[40:43], s63 offen offset:0 sc1
buffer_load_dwordx4 v[168:171], v2, s[40:43], s63 offen offset:1024 sc1
ds_read_b128 v[8:11], v12
s_waitcnt vmcnt(17) lgkmcnt(0)
L_ck59:
v_min3_u32 v15, v8, v9, v10
v_min_u32 v15, v15, v11
s_nop 0
v_readfirstlane_b32 s60, v15
s_nop 0
s_cmp_ge_u32 s60, 6
s_cbranch_scc1 L_ckd60
ds_read_b128 v[8:11], v12 offset:0
s_waitcnt lgkmcnt(0)
s_branch L_ck59
L_ckd60:
v_mfma_f32_32x32x16_bf16 v[32:47], v[208:211], v[112:115], v[32:47]
ds_read_b128 v[96:99], v24 offset:0
ds_read_b128 v[100:103], v24 offset:4096
v_mfma_f32_32x32x16_bf16 v[48:63], v[208:211], v[116:119], v[48:63]
ds_read_b128 v[104:107], v24 offset:8192
ds_read_b128 v[108:111], v24 offset:12288
v_mfma_f32_32x32x16_bf16 v[64:79], v[208:211], v[120:123], v[64:79]
buffer_load_dwordx4 v247, s[52:55], s62 offen offset:3072 lds
v_mfma_f32_32x32x16_bf16 v[80:95], v[208:211], v[124:127], v[80:95]
buffer_load_dwordx4 v[172:175], v2, s[40:43], s63 offen offset:2048 sc1
buffer_load_dwordx4 v[176:179], v2, s[40:43], s63 offen offset:3072 sc1
s_waitcnt vmcnt(19) lgkmcnt(3)
v_mfma_f32_32x32x16_bf16 v[32:47], v[212:215], v[96:99], v[32:47]
ds_read_b128 v[112:115], v25 offset:0
ds_read_b128 v[116:119], v25 offset:4096
s_waitcnt lgkmcnt(4)
v_mfma_f32_32x32x16_bf16 v[48:63], v[212:215], v[100:103], v[48:63]
ds_read_b128 v[120:123], v25 offset:8192
ds_read_b128 v[124:127], v25 offset:12288
s_waitcnt lgkmcnt(5)
v_mfma_f32_32x32x16_bf16 v[64:79], v[212:215], v[104:107], v[64:79]
s_add_u32 m0, s67, 16384
s_add_u32 s62, s64, 512
s_and_b32 s62, s62, 0x3ff
buffer_load_dwordx4 v244, s[48:51], s62 offen offset:0 lds
s_waitcnt lgkmcnt(4)
v_mfma_f32_32x32x16_bf16 v[80:95], v[212:215], v[108:111], v[80:95]
s_add_u32 s63, s65, 32768
s_and_b32 s63, s63, 0xffff
buffer_load_dwordx4 v[180:183], v2, s[40:43], s63 offen offset:0 sc1
buffer_load_dwordx4 v[184:187], v2, s[40:43], s63 offen offset:1024 sc1
s_waitcnt vmcnt(21) lgkmcnt(3)
v_mfma_f32_32x32x16_bf16 v[32:47], v[216:219], v[112:115], v[32:47]
ds_read_b128 v[96:99], v26 offset:0
ds_read_b128 v[100:103], v26 offset:4096
s_waitcnt lgkmcnt(4)
v_mfma_f32_32x32x16_bf16 v[48:63], v[216:219], v[116:119], v[48:63]
ds_read_b128 v[104:107], v26 offset:8192
ds_read_b128 v[108:111], v26 offset:12288
s_waitcnt lgkmcnt(5)
v_mfma_f32_32x32x16_bf16 v[64:79], v[216:219], v[120:123], v[64:79]
buffer_load_dwordx4 v245, s[48:51], s62 offen offset:1024 lds
s_waitcnt lgkmcnt(4)
v_mfma_f32_32x32x16_bf16 v[80:95], v[216:219], v[124:127], v[80:95]
buffer_load_dwordx4 v[188:191], v2, s[40:43], s63 offen offset:2048 sc1
buffer_load_dwordx4 v[192:195], v2, s[40:43], s63 offen offset:3072 sc1
s_waitcnt vmcnt(23) lgkmcnt(3)
v_mfma_f32_32x32x16_bf16 v[32:47], v[220:223], v[96:99], v[32:47]
ds_read_b128 v[112:115], v27 offset:0
ds_read_b128 v[116:119], v27 offset:4096
s_waitcnt lgkmcnt(4)
v_mfma_f32_32x32x16_bf16 v[48:63], v[220:223], v[100:103], v[48:63]
ds_read_b128 v[120:123], v27 offset:8192
ds_read_b128 v[124:127], v27 offset:12288
s_waitcnt lgkmcnt(5)
v_mfma_f32_32x32x16_bf16 v[64:79], v[220:223], v[104:107], v[64:79]
buffer_load_dwordx4 v246, s[48:51], s62 offen offset:2048 lds
s_waitcnt lgkmcnt(4)
v_mfma_f32_32x32x16_bf16 v[80:95], v[220:223], v[108:111], v[80:95]
s_add_u32 s63, s65, 36864
s_and_b32 s63, s63, 0xffff
buffer_load_dwordx4 v[196:199], v2, s[40:43], s63 offen offset:0 sc1
buffer_load_dwordx4 v[200:203], v2, s[40:43], s63 offen offset:1024 sc1
s_waitcnt vmcnt(25) lgkmcnt(3)
v_mfma_f32_32x32x16_bf16 v[32:47], v[224:227], v[112:115], v[32:47]
ds_read_b128 v[96:99], v24 offset:16384
ds_read_b128 v[100:103], v24 offset:20480
s_waitcnt lgkmcnt(4)
v_mfma_f32_32x32x16_bf16 v[48:63], v[224:227], v[116:119], v[48:63]
ds_read_b128 v[104:107], v24 offset:24576
ds_read_b128 v[108:111], v24 offset:28672
s_waitcnt lgkmcnt(5)
v_mfma_f32_32x32x16_bf16 v[64:79], v[224:227], v[120:123], v[64:79]
buffer_load_dwordx4 v247, s[48:51], s62 offen offset:3072 lds
s_waitcnt lgkmcnt(4)
v_mfma_f32_32x32x16_bf16 v[80:95], v[224:227], v[124:127], v[80:95]
buffer_load_dwordx4 v[204:207], v2, s[40:43], s63 offen offset:2048 sc1
buffer_load_dwordx4 v[208:211], v2, s[40:43], s63 offen offset:3072 sc1
s_waitcnt vmcnt(14) lgkmcnt(3)
v_mov_b32 v14, 7
s_mov_b64 exec, 1
ds_write_b32 v13, v14
s_mov_b64 exec, -1
v_mfma_f32_32x32x16_bf16 v[32:47], v[228:231], v[96:99], v[32:47]
ds_read_b128 v[112:115], v25 offset:16384
ds_read_b128 v[116:119], v25 offset:20480
s_waitcnt lgkmcnt(5)
v_mfma_f32_32x32x16_bf16 v[48:63], v[228:231], v[100:103], v[48:63]
ds_read_b128 v[120:123], v25 offset:24576
ds_read_b128 v[124:127], v25 offset:28672
s_waitcnt lgkmcnt(6)
v_mfma_f32_32x32x16_bf16 v[64:79], v[228:231], v[104:107], v[64:79]
s_add_u32 m0, s67, 32768
s_nop 0
buffer_load_dwordx4 v244, s[52:55], s62 offen offset:0 lds
s_waitcnt lgkmcnt(5)
v_mfma_f32_32x32x16_bf16 v[80:95], v[228:231], v[108:111], v[80:95]
s_add_u32 s63, s65, 40960
s_and_b32 s63, s63, 0xffff
buffer_load_dwordx4 v[212:215], v2, s[40:43], s63 offen offset:0 sc1
buffer_load_dwordx4 v[216:219], v2, s[40:43], s63 offen offset:1024 sc1
s_waitcnt vmcnt(29) lgkmcnt(3)
v_mfma_f32_32x32x16_bf16 v[32:47], v[232:235], v[112:115], v[32:47]
ds_read_b128 v[96:99], v26 offset:16384
ds_read_b128 v[100:103], v26 offset:20480
s_waitcnt lgkmcnt(4)
v_mfma_f32_32x32x16_bf16 v[48:63], v[232:235], v[116:119], v[48:63]
ds_read_b128 v[104:107], v26 offset:24576
ds_read_b128 v[108:111], v26 offset:28672
s_waitcnt lgkmcnt(5)
v_mfma_f32_32x32x16_bf16 v[64:79], v[232:235], v[120:123], v[64:79]
buffer_load_dwordx4 v245, s[52:55], s62 offen offset:1024 lds
s_waitcnt lgkmcnt(4)
v_mfma_f32_32x32x16_bf16 v[80:95], v[232:235], v[124:127], v[80:95]
buffer_load_dwordx4 v[220:223], v2, s[40:43], s63 offen offset:2048 sc1
buffer_load_dwordx4 v[224:227], v2, s[40:43], s63 offen offset:3072 sc1
s_waitcnt vmcnt(31) lgkmcnt(3)
v_mfma_f32_32x32x16_bf16 v[32:47], v[236:239], v[96:99], v[32:47]
ds_read_b128 v[112:115], v27 offset:16384
ds_read_b128 v[116:119], v27 offset:20480
s_waitcnt lgkmcnt(4)
v_mfma_f32_32x32x16_bf16 v[48:63], v[236:239], v[100:103], v[48:63]
ds_read_b128 v[120:123], v27 offset:24576
ds_read_b128 v[124:127], v27 offset:28672
s_waitcnt lgkmcnt(5)
v_mfma_f32_32x32x16_bf16 v[64:79], v[236:239], v[104:107], v[64:79]
buffer_load_dwordx4 v246, s[52:55], s62 offen offset:2048 lds
s_waitcnt lgkmcnt(4)
v_mfma_f32_32x32x16_bf16 v[80:95], v[236:239], v[108:111], v[80:95]
s_add_u32 s63, s65, 45056
s_and_b32 s63, s63, 0xffff
buffer_load_dwordx4 v[228:231], v2, s[40:43], s63 offen offset:0 sc1
buffer_load_dwordx4 v[232:235], v2, s[40:43], s63 offen offset:1024 sc1
ds_read_b128 v[8:11], v12
s_waitcnt vmcnt(33) lgkmcnt(0)
L_ck61:
v_min3_u32 v15, v8, v9, v10
v_min_u32 v15, v15, v11
s_nop 0
v_readfirstlane_b32 s60, v15
s_nop 0
s_cmp_ge_u32 s60, 7
s_cbranch_scc1 L_ckd62
ds_read_b128 v[8:11], v12 offset:0
s_waitcnt lgkmcnt(0)
s_branch L_ck61
L_ckd62:
v_mfma_f32_32x32x16_bf16 v[32:47], v[240:243], v[112:115], v[32:47]
ds_read_b128 v[96:99], v24 offset:32768
ds_read_b128 v[100:103], v24 offset:36864
v_mfma_f32_32x32x16_bf16 v[48:63], v[240:243], v[116:119], v[48:63]
ds_read_b128 v[104:107], v24 offset:40960
ds_read_b128 v[108:111], v24 offset:45056
v_mfma_f32_32x32x16_bf16 v[64:79], v[240:243], v[120:123], v[64:79]
buffer_load_dwordx4 v247, s[52:55], s62 offen offset:3072 lds
v_mfma_f32_32x32x16_bf16 v[80:95], v[240:243], v[124:127], v[80:95]
buffer_load_dwordx4 v[236:239], v2, s[40:43], s63 offen offset:2048 sc1
buffer_load_dwordx4 v[240:243], v2, s[40:43], s63 offen offset:3072 sc1
s_waitcnt vmcnt(34) lgkmcnt(3)
v_mfma_f32_32x32x16_bf16 v[32:47], v[148:151], v[96:99], v[32:47]
ds_read_b128 v[112:115], v25 offset:32768
ds_read_b128 v[116:119], v25 offset:36864
s_waitcnt lgkmcnt(4)
v_mfma_f32_32x32x16_bf16 v[48:63], v[148:151], v[100:103], v[48:63]
ds_read_b128 v[120:123], v25 offset:40960
ds_read_b128 v[124:127], v25 offset:45056
s_waitcnt lgkmcnt(5)
v_mfma_f32_32x32x16_bf16 v[64:79], v[148:151], v[104:107], v[64:79]
s_add_u32 m0, s67, 49152
s_add_u32 s62, s64, 640
s_and_b32 s62, s62, 0x3ff
buffer_load_dwordx4 v244, s[48:51], s62 offen offset:0 lds
s_waitcnt lgkmcnt(4)
v_mfma_f32_32x32x16_bf16 v[80:95], v[148:151], v[108:111], v[80:95]
s_add_u32 s63, s65, 49152
s_and_b32 s63, s63, 0xffff
buffer_load_dwordx4 v[148:151], v2, s[40:43], s63 offen offset:0 sc1
s_waitcnt vmcnt(35) lgkmcnt(3)
v_mfma_f32_32x32x16_bf16 v[32:47], v[152:155], v[112:115], v[32:47]
ds_read_b128 v[96:99], v26 offset:32768
ds_read_b128 v[100:103], v26 offset:36864
s_waitcnt lgkmcnt(4)
v_mfma_f32_32x32x16_bf16 v[48:63], v[152:155], v[116:119], v[48:63]
ds_read_b128 v[104:107], v26 offset:40960
ds_read_b128 v[108:111], v26 offset:45056
s_waitcnt lgkmcnt(5)
v_mfma_f32_32x32x16_bf16 v[64:79], v[152:155], v[120:123], v[64:79]
buffer_load_dwordx4 v245, s[48:51], s62 offen offset:1024 lds
s_waitcnt lgkmcnt(4)
v_mfma_f32_32x32x16_bf16 v[80:95], v[152:155], v[124:127], v[80:95]
buffer_load_dwordx4 v[152:155], v2, s[40:43], s63 offen offset:1024 sc1
s_waitcnt vmcnt(35) lgkmcnt(3)
v_mfma_f32_32x32x16_bf16 v[32:47], v[156:159], v[96:99], v[32:47]
ds_read_b128 v[112:115], v27 offset:32768
ds_read_b128 v[116:119], v27 offset:36864
s_waitcnt lgkmcnt(4)
v_mfma_f32_32x32x16_bf16 v[48:63], v[156:159], v[100:103], v[48:63]
ds_read_b128 v[120:123], v27 offset:40960
ds_read_b128 v[124:127], v27 offset:45056
s_waitcnt lgkmcnt(5)
v_mfma_f32_32x32x16_bf16 v[64:79], v[156:159], v[104:107], v[64:79]
buffer_load_dwordx4 v246, s[48:51], s62 offen offset:2048 lds
s_waitcnt lgkmcnt(4)
v_mfma_f32_32x32x16_bf16 v[80:95], v[156:159], v[108:111], v[80:95]
buffer_load_dwordx4 v[156:159], v2, s[40:43], s63 offen offset:2048 sc1
s_waitcnt vmcnt(36) lgkmcnt(3)
v_mfma_f32_32x32x16_bf16 v[32:47], v[160:163], v[112:115], v[32:47]
ds_read_b128 v[96:99], v20 offset:0
ds_read_b128 v[100:103], v20 offset:4096
s_waitcnt lgkmcnt(4)
v_mfma_f32_32x32x16_bf16 v[48:63], v[160:163], v[116:119], v[48:63]
ds_read_b128 v[104:107], v20 offset:8192
ds_read_b128 v[108:111], v20 offset:12288
s_waitcnt lgkmcnt(5)
v_mfma_f32_32x32x16_bf16 v[64:79], v[160:163], v[120:123], v[64:79]
buffer_load_dwordx4 v247, s[48:51], s62 offen offset:3072 lds
s_waitcnt lgkmcnt(4)
v_mfma_f32_32x32x16_bf16 v[80:95], v[160:163], v[124:127], v[80:95]
buffer_load_dwordx4 v[160:163], v2, s[40:43], s63 offen offset:3072 sc1
s_waitcnt vmcnt(10) lgkmcnt(3)
v_mov_b32 v14, 8
s_mov_b64 exec, 1
ds_write_b32 v13, v14
s_mov_b64 exec, -1
v_mfma_f32_32x32x16_bf16 v[32:47], v[164:167], v[96:99], v[32:47]
ds_read_b128 v[112:115], v21 offset:0
ds_read_b128 v[116:119], v21 offset:4096
s_waitcnt lgkmcnt(5)
v_mfma_f32_32x32x16_bf16 v[48:63], v[164:167], v[100:103], v[48:63]
ds_read_b128 v[120:123], v21 offset:8192
ds_read_b128 v[124:127], v21 offset:12288
s_waitcnt lgkmcnt(6)
v_mfma_f32_32x32x16_bf16 v[64:79], v[164:167], v[104:107], v[64:79]
s_add_u32 m0, s67, 65536
s_nop 0
buffer_load_dwordx4 v244, s[52:55], s62 offen offset:0 lds
s_waitcnt lgkmcnt(5)
v_mfma_f32_32x32x16_bf16 v[80:95], v[164:167], v[108:111], v[80:95]
s_add_u32 s63, s65, 53248
s_and_b32 s63, s63, 0xffff
buffer_load_dwordx4 v[164:167], v2, s[40:43], s63 offen offset:0 sc1
s_waitcnt vmcnt(37) lgkmcnt(3)
v_mfma_f32_32x32x16_bf16 v[32:47], v[168:171], v[112:115], v[32:47]
ds_read_b128 v[96:99], v22 offset:0
ds_read_b128 v[100:103], v22 offset:4096
s_waitcnt lgkmcnt(4)
v_mfma_f32_32x32x16_bf16 v[48:63], v[168:171], v[116:119], v[48:63]
ds_read_b128 v[104:107], v22 offset:8192
ds_read_b128 v[108:111], v22 offset:12288
s_waitcnt lgkmcnt(5)
v_mfma_f32_32x32x16_bf16 v[64:79], v[168:171], v[120:123], v[64:79]
buffer_load_dwordx4 v245, s[52:55], s62 offen offset:1024 lds
s_waitcnt lgkmcnt(4)
v_mfma_f32_32x32x16_bf16 v[80:95], v[168:171], v[124:127], v[80:95]
buffer_load_dwordx4 v[168:171], v2, s[40:43], s63 offen offset:1024 sc1
s_waitcnt vmcnt(37) lgkmcnt(3)
v_mfma_f32_32x32x16_bf16 v[32:47], v[172:175], v[96:99], v[32:47]
ds_read_b128 v[112:115], v23 offset:0
ds_read_b128 v[116:119], v23 offset:4096
s_waitcnt lgkmcnt(4)
v_mfma_f32_32x32x16_bf16 v[48:63], v[172:175], v[100:103], v[48:63]
ds_read_b128 v[120:123], v23 offset:8192
ds_read_b128 v[124:127], v23 offset:12288
s_waitcnt lgkmcnt(5)
v_mfma_f32_32x32x16_bf16 v[64:79], v[172:175], v[104:107], v[64:79]
buffer_load_dwordx4 v246, s[52:55], s62 offen offset:2048 lds
s_waitcnt lgkmcnt(4)
v_mfma_f32_32x32x16_bf16 v[80:95], v[172:175], v[108:111], v[80:95]
buffer_load_dwordx4 v[172:175], v2, s[40:43], s63 offen offset:2048 sc1
ds_read_b128 v[8:11], v12
s_waitcnt vmcnt(38) lgkmcnt(0)
L_ck63:
v_min3_u32 v15, v8, v9, v10
v_min_u32 v15, v15, v11
s_nop 0
v_readfirstlane_b32 s60, v15
s_nop 0
s_cmp_ge_u32 s60, 8
s_cbranch_scc1 L_ckd64
ds_read_b128 v[8:11], v12 offset:0
s_waitcnt lgkmcnt(0)
s_branch L_ck63
L_ckd64:
v_mfma_f32_32x32x16_bf16 v[32:47], v[176:179], v[112:115], v[32:47]
ds_read_b128 v[96:99], v20 offset:16384
ds_read_b128 v[100:103], v20 offset:20480
v_mfma_f32_32x32x16_bf16 v[48:63], v[176:179], v[116:119], v[48:63]
ds_read_b128 v[104:107], v20 offset:24576
ds_read_b128 v[108:111], v20 offset:28672
v_mfma_f32_32x32x16_bf16 v[64:79], v[176:179], v[120:123], v[64:79]
buffer_load_dwordx4 v247, s[52:55], s62 offen offset:3072 lds
v_mfma_f32_32x32x16_bf16 v[80:95], v[176:179], v[124:127], v[80:95]
buffer_load_dwordx4 v[176:179], v2, s[40:43], s63 offen offset:3072 sc1
s_waitcnt vmcnt(38) lgkmcnt(3)
v_mfma_f32_32x32x16_bf16 v[32:47], v[180:183], v[96:99], v[32:47]
ds_read_b128 v[112:115], v21 offset:16384
ds_read_b128 v[116:119], v21 offset:20480
s_waitcnt lgkmcnt(4)
v_mfma_f32_32x32x16_bf16 v[48:63], v[180:183], v[100:103], v[48:63]
ds_read_b128 v[120:123], v21 offset:24576
ds_read_b128 v[124:127], v21 offset:28672
s_waitcnt lgkmcnt(5)
v_mfma_f32_32x32x16_bf16 v[64:79], v[180:183], v[104:107], v[64:79]
s_add_u32 m0, s67, 81920
s_add_u32 s62, s64, 768
s_and_b32 s62, s62, 0x3ff
buffer_load_dwordx4 v244, s[48:51], s62 offen offset:0 lds
s_waitcnt lgkmcnt(4)
v_mfma_f32_32x32x16_bf16 v[80:95], v[180:183], v[108:111], v[80:95]
s_add_u32 s63, s65, 57344
s_and_b32 s63, s63, 0xffff
buffer_load_dwordx4 v[180:183], v2, s[40:43], s63 offen offset:0 sc1
s_waitcnt vmcnt(39) lgkmcnt(3)
v_mfma_f32_32x32x16_bf16 v[32:47], v[184:187], v[112:115], v[32:47]
ds_read_b128 v[96:99], v22 offset:16384
ds_read_b128 v[100:103], v22 offset:20480
s_waitcnt lgkmcnt(4)
v_mfma_f32_32x32x16_bf16 v[48:63], v[184:187], v[116:119], v[48:63]
ds_read_b128 v[104:107], v22 offset:24576
ds_read_b128 v[108:111], v22 offset:28672
s_waitcnt lgkmcnt(5)
v_mfma_f32_32x32x16_bf16 v[64:79], v[184:187], v[120:123], v[64:79]
buffer_load_dwordx4 v245, s[48:51], s62 offen offset:1024 lds
s_waitcnt lgkmcnt(4)
v_mfma_f32_32x32x16_bf16 v[80:95], v[184:187], v[124:127], v[80:95]
buffer_load_dwordx4 v[184:187], v2, s[40:43], s63 offen offset:1024 sc1
s_waitcnt vmcnt(39) lgkmcnt(3)
v_mfma_f32_32x32x16_bf16 v[32:47], v[188:191], v[96:99], v[32:47]
ds_read_b128 v[112:115], v23 offset:16384
ds_read_b128 v[116:119], v23 offset:20480
s_waitcnt lgkmcnt(4)
v_mfma_f32_32x32x16_bf16 v[48:63], v[188:191], v[100:103], v[48:63]
ds_read_b128 v[120:123], v23 offset:24576
ds_read_b128 v[124:127], v23 offset:28672
s_waitcnt lgkmcnt(5)
v_mfma_f32_32x32x16_bf16 v[64:79], v[188:191], v[104:107], v[64:79]
buffer_load_dwordx4 v246, s[48:51], s62 offen offset:2048 lds
s_waitcnt lgkmcnt(4)
v_mfma_f32_32x32x16_bf16 v[80:95], v[188:191], v[108:111], v[80:95]
buffer_load_dwordx4 v[188:191], v2, s[40:43], s63 offen offset:2048 sc1
s_waitcnt vmcnt(40) lgkmcnt(3)
v_mfma_f32_32x32x16_bf16 v[32:47], v[192:195], v[112:115], v[32:47]
ds_read_b128 v[96:99], v20 offset:32768
ds_read_b128 v[100:103], v20 offset:36864
s_waitcnt lgkmcnt(4)
v_mfma_f32_32x32x16_bf16 v[48:63], v[192:195], v[116:119], v[48:63]
ds_read_b128 v[104:107], v20 offset:40960
ds_read_b128 v[108:111], v20 offset:45056
s_waitcnt lgkmcnt(5)
v_mfma_f32_32x32x16_bf16 v[64:79], v[192:195], v[120:123], v[64:79]
buffer_load_dwordx4 v247, s[48:51], s62 offen offset:3072 lds
s_waitcnt lgkmcnt(4)
v_mfma_f32_32x32x16_bf16 v[80:95], v[192:195], v[124:127], v[80:95]
buffer_load_dwordx4 v[192:195], v2, s[40:43], s63 offen offset:3072 sc1
s_waitcnt vmcnt(9) lgkmcnt(3)
v_mov_b32 v14, 9
s_mov_b64 exec, 1
ds_write_b32 v13, v14
s_mov_b64 exec, -1
v_mfma_f32_32x32x16_bf16 v[32:47], v[196:199], v[96:99], v[32:47]
ds_read_b128 v[112:115], v21 offset:32768
ds_read_b128 v[116:119], v21 offset:36864
s_waitcnt lgkmcnt(5)
v_mfma_f32_32x32x16_bf16 v[48:63], v[196:199], v[100:103], v[48:63]
ds_read_b128 v[120:123], v21 offset:40960
ds_read_b128 v[124:127], v21 offset:45056
s_waitcnt lgkmcnt(6)
v_mfma_f32_32x32x16_bf16 v[64:79], v[196:199], v[104:107], v[64:79]
s_add_u32 m0, s67, 98304
s_nop 0
buffer_load_dwordx4 v244, s[52:55], s62 offen offset:0 lds
s_waitcnt lgkmcnt(5)
v_mfma_f32_32x32x16_bf16 v[80:95], v[196:199], v[108:111], v[80:95]
s_add_u32 s63, s65, 61440
s_and_b32 s63, s63, 0xffff
buffer_load_dwordx4 v[196:199], v2, s[40:43], s63 offen offset:0 sc1
s_waitcnt vmcnt(41) lgkmcnt(3)
v_mfma_f32_32x32x16_bf16 v[32:47], v[200:203], v[112:115], v[32:47]
ds_read_b128 v[96:99], v22 offset:32768
ds_read_b128 v[100:103], v22 offset:36864
s_waitcnt lgkmcnt(4)
v_mfma_f32_32x32x16_bf16 v[48:63], v[200:203], v[116:119], v[48:63]
ds_read_b128 v[104:107], v22 offset:40960
ds_read_b128 v[108:111], v22 offset:45056
s_waitcnt lgkmcnt(5)
v_mfma_f32_32x32x16_bf16 v[64:79], v[200:203], v[120:123], v[64:79]
buffer_load_dwordx4 v245, s[52:55], s62 offen offset:1024 lds
s_waitcnt lgkmcnt(4)
v_mfma_f32_32x32x16_bf16 v[80:95], v[200:203], v[124:127], v[80:95]
buffer_load_dwordx4 v[200:203], v2, s[40:43], s63 offen offset:1024 sc1
s_waitcnt vmcnt(41) lgkmcnt(3)
v_mfma_f32_32x32x16_bf16 v[32:47], v[204:207], v[96:99], v[32:47]
ds_read_b128 v[112:115], v23 offset:32768
ds_read_b128 v[116:119], v23 offset:36864
s_waitcnt lgkmcnt(4)
v_mfma_f32_32x32x16_bf16 v[48:63], v[204:207], v[100:103], v[48:63]
ds_read_b128 v[120:123], v23 offset:40960
ds_read_b128 v[124:127], v23 offset:45056
s_waitcnt lgkmcnt(5)
v_mfma_f32_32x32x16_bf16 v[64:79], v[204:207], v[104:107], v[64:79]
buffer_load_dwordx4 v246, s[52:55], s62 offen offset:2048 lds
s_waitcnt lgkmcnt(4)
v_mfma_f32_32x32x16_bf16 v[80:95], v[204:207], v[108:111], v[80:95]
buffer_load_dwordx4 v[204:207], v2, s[40:43], s63 offen offset:2048 sc1
ds_read_b128 v[8:11], v12
s_waitcnt vmcnt(42) lgkmcnt(0)
L_ck65:
v_min3_u32 v15, v8, v9, v10
v_min_u32 v15, v15, v11
s_nop 0
v_readfirstlane_b32 s60, v15
s_nop 0
s_cmp_ge_u32 s60, 9
s_cbranch_scc1 L_ckd66
ds_read_b128 v[8:11], v12 offset:0
s_waitcnt lgkmcnt(0)
s_branch L_ck65
L_ckd66:
v_mfma_f32_32x32x16_bf16 v[32:47], v[208:211], v[112:115], v[32:47]
ds_read_b128 v[96:99], v20 offset:49152
ds_read_b128 v[100:103], v20 offset:53248
v_mfma_f32_32x32x16_bf16 v[48:63], v[208:211], v[116:119], v[48:63]
ds_read_b128 v[104:107], v20 offset:57344
ds_read_b128 v[108:111], v20 offset:61440
v_mfma_f32_32x32x16_bf16 v[64:79], v[208:211], v[120:123], v[64:79]
buffer_load_dwordx4 v247, s[52:55], s62 offen offset:3072 lds
v_mfma_f32_32x32x16_bf16 v[80:95], v[208:211], v[124:127], v[80:95]
buffer_load_dwordx4 v[208:211], v2, s[40:43], s63 offen offset:3072 sc1
s_waitcnt vmcnt(42) lgkmcnt(3)
v_mfma_f32_32x32x16_bf16 v[32:47], v[212:215], v[96:99], v[32:47]
ds_read_b128 v[112:115], v21 offset:49152
ds_read_b128 v[116:119], v21 offset:53248
s_waitcnt lgkmcnt(4)
v_mfma_f32_32x32x16_bf16 v[48:63], v[212:215], v[100:103], v[48:63]
ds_read_b128 v[120:123], v21 offset:57344
ds_read_b128 v[124:127], v21 offset:61440
s_waitcnt lgkmcnt(5)
v_mfma_f32_32x32x16_bf16 v[64:79], v[212:215], v[104:107], v[64:79]
s_add_u32 m0, s67, 0
s_add_u32 s62, s64, 896
s_and_b32 s62, s62, 0x3ff
buffer_load_dwordx4 v244, s[48:51], s62 offen offset:0 lds
s_waitcnt lgkmcnt(4)
v_mfma_f32_32x32x16_bf16 v[80:95], v[212:215], v[108:111], v[80:95]
s_waitcnt vmcnt(42) lgkmcnt(3)
v_mfma_f32_32x32x16_bf16 v[32:47], v[216:219], v[112:115], v[32:47]
ds_read_b128 v[96:99], v22 offset:49152
ds_read_b128 v[100:103], v22 offset:53248
s_waitcnt lgkmcnt(4)
v_mfma_f32_32x32x16_bf16 v[48:63], v[216:219], v[116:119], v[48:63]
ds_read_b128 v[104:107], v22 offset:57344
ds_read_b128 v[108:111], v22 offset:61440
s_waitcnt lgkmcnt(5)
v_mfma_f32_32x32x16_bf16 v[64:79], v[216:219], v[120:123], v[64:79]
buffer_load_dwordx4 v245, s[48:51], s62 offen offset:1024 lds
s_waitcnt lgkmcnt(4)
v_mfma_f32_32x32x16_bf16 v[80:95], v[216:219], v[124:127], v[80:95]
s_waitcnt vmcnt(41) lgkmcnt(3)
v_mfma_f32_32x32x16_bf16 v[32:47], v[220:223], v[96:99], v[32:47]
ds_read_b128 v[112:115], v23 offset:49152
ds_read_b128 v[116:119], v23 offset:53248
s_waitcnt lgkmcnt(4)
v_mfma_f32_32x32x16_bf16 v[48:63], v[220:223], v[100:103], v[48:63]
ds_read_b128 v[120:123], v23 offset:57344
ds_read_b128 v[124:127], v23 offset:61440
s_waitcnt lgkmcnt(5)
v_mfma_f32_32x32x16_bf16 v[64:79], v[220:223], v[104:107], v[64:79]
buffer_load_dwordx4 v246, s[48:51], s62 offen offset:2048 lds
s_waitcnt lgkmcnt(4)
v_mfma_f32_32x32x16_bf16 v[80:95], v[220:223], v[108:111], v[80:95]
s_waitcnt vmcnt(41) lgkmcnt(3)
v_mfma_f32_32x32x16_bf16 v[32:47], v[224:227], v[112:115], v[32:47]
ds_read_b128 v[96:99], v24 offset:0
ds_read_b128 v[100:103], v24 offset:4096
s_waitcnt lgkmcnt(4)
v_mfma_f32_32x32x16_bf16 v[48:63], v[224:227], v[116:119], v[48:63]
ds_read_b128 v[104:107], v24 offset:8192
ds_read_b128 v[108:111], v24 offset:12288
s_waitcnt lgkmcnt(5)
v_mfma_f32_32x32x16_bf16 v[64:79], v[224:227], v[120:123], v[64:79]
buffer_load_dwordx4 v247, s[48:51], s62 offen offset:3072 lds
s_waitcnt lgkmcnt(4)
v_mfma_f32_32x32x16_bf16 v[80:95], v[224:227], v[124:127], v[80:95]
s_waitcnt vmcnt(5) lgkmcnt(3)
v_mov_b32 v14, 10
s_mov_b64 exec, 1
ds_write_b32 v13, v14
s_mov_b64 exec, -1
v_mfma_f32_32x32x16_bf16 v[32:47], v[228:231], v[96:99], v[32:47]
ds_read_b128 v[112:115], v25 offset:0
ds_read_b128 v[116:119], v25 offset:4096
s_waitcnt lgkmcnt(5)
v_mfma_f32_32x32x16_bf16 v[48:63], v[228:231], v[100:103], v[48:63]
ds_read_b128 v[120:123], v25 offset:8192
ds_read_b128 v[124:127], v25 offset:12288
s_waitcnt lgkmcnt(6)
v_mfma_f32_32x32x16_bf16 v[64:79], v[228:231], v[104:107], v[64:79]
s_add_u32 m0, s67, 16384
s_nop 0
buffer_load_dwordx4 v244, s[52:55], s62 offen offset:0 lds
s_waitcnt lgkmcnt(5)
v_mfma_f32_32x32x16_bf16 v[80:95], v[228:231], v[108:111], v[80:95]
s_waitcnt vmcnt(40) lgkmcnt(3)
v_mfma_f32_32x32x16_bf16 v[32:47], v[232:235], v[112:115], v[32:47]
ds_read_b128 v[96:99], v26 offset:0
ds_read_b128 v[100:103], v26 offset:4096
s_waitcnt lgkmcnt(4)
v_mfma_f32_32x32x16_bf16 v[48:63], v[232:235], v[116:119], v[48:63]
ds_read_b128 v[104:107], v26 offset:8192
ds_read_b128 v[108:111], v26 offset:12288
s_waitcnt lgkmcnt(5)
v_mfma_f32_32x32x16_bf16 v[64:79], v[232:235], v[120:123], v[64:79]
buffer_load_dwordx4 v245, s[52:55], s62 offen offset:1024 lds
s_waitcnt lgkmcnt(4)
v_mfma_f32_32x32x16_bf16 v[80:95], v[232:235], v[124:127], v[80:95]
s_waitcnt vmcnt(39) lgkmcnt(3)
v_mfma_f32_32x32x16_bf16 v[32:47], v[236:239], v[96:99], v[32:47]
ds_read_b128 v[112:115], v27 offset:0
ds_read_b128 v[116:119], v27 offset:4096
s_waitcnt lgkmcnt(4)
v_mfma_f32_32x32x16_bf16 v[48:63], v[236:239], v[100:103], v[48:63]
ds_read_b128 v[120:123], v27 offset:8192
ds_read_b128 v[124:127], v27 offset:12288
s_waitcnt lgkmcnt(5)
v_mfma_f32_32x32x16_bf16 v[64:79], v[236:239], v[104:107], v[64:79]
buffer_load_dwordx4 v246, s[52:55], s62 offen offset:2048 lds
s_waitcnt lgkmcnt(4)
v_mfma_f32_32x32x16_bf16 v[80:95], v[236:239], v[108:111], v[80:95]
ds_read_b128 v[8:11], v12
global_load_dword v31, v30, s[26:27]
s_waitcnt vmcnt(40) lgkmcnt(0)
L_ck67:
v_min3_u32 v15, v8, v9, v10
v_min_u32 v15, v15, v11
s_nop 0
v_readfirstlane_b32 s60, v15
s_nop 0
s_cmp_ge_u32 s60, 10
s_cbranch_scc1 L_ckd68
ds_read_b128 v[8:11], v12 offset:0
s_waitcnt lgkmcnt(0)
s_branch L_ck67
L_ckd68:
v_mfma_f32_32x32x16_bf16 v[32:47], v[240:243], v[112:115], v[32:47]
ds_read_b128 v[96:99], v24 offset:16384
ds_read_b128 v[100:103], v24 offset:20480
v_mfma_f32_32x32x16_bf16 v[48:63], v[240:243], v[116:119], v[48:63]
ds_read_b128 v[104:107], v24 offset:24576
ds_read_b128 v[108:111], v24 offset:28672
v_mfma_f32_32x32x16_bf16 v[64:79], v[240:243], v[120:123], v[64:79]
buffer_load_dwordx4 v247, s[52:55], s62 offen offset:3072 lds
v_mfma_f32_32x32x16_bf16 v[80:95], v[240:243], v[124:127], v[80:95]
s_mov_b32 s60, 0
buffer_load_dword v128, v28, s[56:59], s60 offen offset:0
s_waitcnt vmcnt(40) lgkmcnt(3)
v_mfma_f32_32x32x16_bf16 v[32:47], v[148:151], v[96:99], v[32:47]
ds_read_b128 v[112:115], v25 offset:16384
ds_read_b128 v[116:119], v25 offset:20480
s_waitcnt lgkmcnt(4)
v_mfma_f32_32x32x16_bf16 v[48:63], v[148:151], v[100:103], v[48:63]
ds_read_b128 v[120:123], v25 offset:24576
ds_read_b128 v[124:127], v25 offset:28672
s_waitcnt lgkmcnt(5)
v_mfma_f32_32x32x16_bf16 v[64:79], v[148:151], v[104:107], v[64:79]
s_waitcnt lgkmcnt(4)
v_mfma_f32_32x32x16_bf16 v[80:95], v[148:151], v[108:111], v[80:95]
s_mov_b32 s60, 0
buffer_load_dword v129, v28, s[56:59], s60 offen offset:2048
s_waitcnt vmcnt(39) lgkmcnt(3)
v_mfma_f32_32x32x16_bf16 v[32:47], v[152:155], v[112:115], v[32:47]
ds_read_b128 v[96:99], v26 offset:16384
ds_read_b128 v[100:103], v26 offset:20480
s_waitcnt lgkmcnt(4)
v_mfma_f32_32x32x16_bf16 v[48:63], v[152:155], v[116:119], v[48:63]
ds_read_b128 v[104:107], v26 offset:24576
ds_read_b128 v[108:111], v26 offset:28672
s_waitcnt lgkmcnt(5)
v_mfma_f32_32x32x16_bf16 v[64:79], v[152:155], v[120:123], v[64:79]
s_waitcnt lgkmcnt(4)
v_mfma_f32_32x32x16_bf16 v[80:95], v[152:155], v[124:127], v[80:95]
s_mov_b32 s60, 4096
buffer_load_dword v130, v28, s[56:59], s60 offen offset:0
s_waitcnt vmcnt(38) lgkmcnt(3)
v_mfma_f32_32x32x16_bf16 v[32:47], v[156:159], v[96:99], v[32:47]
ds_read_b128 v[112:115], v27 offset:16384
ds_read_b128 v[116:119], v27 offset:20480
s_waitcnt lgkmcnt(4)
v_mfma_f32_32x32x16_bf16 v[48:63], v[156:159], v[100:103], v[48:63]
ds_read_b128 v[120:123], v27 offset:24576
ds_read_b128 v[124:127], v27 offset:28672
s_waitcnt lgkmcnt(5)
v_mfma_f32_32x32x16_bf16 v[64:79], v[156:159], v[104:107], v[64:79]
s_waitcnt lgkmcnt(4)
v_mfma_f32_32x32x16_bf16 v[80:95], v[156:159], v[108:111], v[80:95]
s_mov_b32 s60, 4096
buffer_load_dword v131, v28, s[56:59], s60 offen offset:2048
s_waitcnt vmcnt(37) lgkmcnt(3)
v_mfma_f32_32x32x16_bf16 v[32:47], v[160:163], v[112:115], v[32:47]
ds_read_b128 v[96:99], v24 offset:32768
ds_read_b128 v[100:103], v24 offset:36864
s_waitcnt lgkmcnt(4)
v_mfma_f32_32x32x16_bf16 v[48:63], v[160:163], v[116:119], v[48:63]
s_waitcnt lgkmcnt(3)
v_mfma_f32_32x32x16_bf16 v[64:79], v[160:163], v[120:123], v[64:79]
s_waitcnt lgkmcnt(2)
v_mfma_f32_32x32x16_bf16 v[80:95], v[160:163], v[124:127], v[80:95]
s_mov_b32 s60, 32768
buffer_load_dword v132, v28, s[56:59], s60 offen offset:0
s_waitcnt vmcnt(5) lgkmcnt(1)
v_mov_b32 v14, 11
s_mov_b64 exec, 1
ds_write_b32 v13, v14
s_mov_b64 exec, -1
v_mfma_f32_32x32x16_bf16 v[32:47], v[164:167], v[96:99], v[32:47]
ds_read_b128 v[112:115], v25 offset:32768
ds_read_b128 v[116:119], v25 offset:36864
s_waitcnt lgkmcnt(3)
v_mfma_f32_32x32x16_bf16 v[48:63], v[164:167], v[100:103], v[48:63]
s_mov_b32 s60, 32768
buffer_load_dword v133, v28, s[56:59], s60 offen offset:2048
s_waitcnt vmcnt(35) lgkmcnt(1)
v_mfma_f32_32x32x16_bf16 v[32:47], v[168:171], v[112:115], v[32:47]
ds_read_b128 v[96:99], v26 offset:32768
ds_read_b128 v[100:103], v26 offset:36864
s_waitcnt lgkmcnt(2)
v_mfma_f32_32x32x16_bf16 v[48:63], v[168:171], v[116:119], v[48:63]
s_mov_b32 s60, 36864
buffer_load_dword v134, v28, s[56:59], s60 offen offset:0
s_waitcnt vmcnt(34) lgkmcnt(1)
v_mfma_f32_32x32x16_bf16 v[32:47], v[172:175], v[96:99], v[32:47]
ds_read_b128 v[112:115], v27 offset:32768
ds_read_b128 v[116:119], v27 offset:36864
s_waitcnt lgkmcnt(2)
v_mfma_f32_32x32x16_bf16 v[48:63], v[172:175], v[100:103], v[48:63]
ds_read_b128 v[8:11], v12
s_mov_b32 s60, 36864
buffer_load_dword v135, v28, s[56:59], s60 offen offset:2048
s_waitcnt vmcnt(33) lgkmcnt(0)
L_ck69:
v_min3_u32 v15, v8, v9, v10
v_min_u32 v15, v15, v11
s_nop 0
v_readfirstlane_b32 s60, v15
s_nop 0
s_cmp_ge_u32 s60, 11
s_cbranch_scc1 L_ckd70
ds_read_b128 v[8:11], v12 offset:0
s_waitcnt lgkmcnt(0)
s_branch L_ck69
L_ckd70:
v_mfma_f32_32x32x16_bf16 v[32:47], v[176:179], v[112:115], v[32:47]
ds_read_b128 v[96:99], v20 offset:0
ds_read_b128 v[100:103], v20 offset:4096
v_mfma_f32_32x32x16_bf16 v[48:63], v[176:179], v[116:119], v[48:63]
s_mov_b32 s60, 65536
buffer_load_dword v136, v28, s[56:59], s60 offen offset:0
s_waitcnt vmcnt(32) lgkmcnt(1)
v_mfma_f32_32x32x16_bf16 v[32:47], v[180:183], v[96:99], v[32:47]
ds_read_b128 v[112:115], v21 offset:0
ds_read_b128 v[116:119], v21 offset:4096
s_waitcnt lgkmcnt(2)
v_mfma_f32_32x32x16_bf16 v[48:63], v[180:183], v[100:103], v[48:63]
s_mov_b32 s60, 65536
buffer_load_dword v137, v28, s[56:59], s60 offen offset:2048
s_waitcnt vmcnt(31) lgkmcnt(1)
v_mfma_f32_32x32x16_bf16 v[32:47], v[184:187], v[112:115], v[32:47]
ds_read_b128 v[96:99], v22 offset:0
ds_read_b128 v[100:103], v22 offset:4096
s_waitcnt lgkmcnt(2)
v_mfma_f32_32x32x16_bf16 v[48:63], v[184:187], v[116:119], v[48:63]
s_mov_b32 s60, 69632
buffer_load_dword v138, v28, s[56:59], s60 offen offset:0
s_waitcnt vmcnt(30) lgkmcnt(1)
v_mfma_f32_32x32x16_bf16 v[32:47], v[188:191], v[96:99], v[32:47]
ds_read_b128 v[112:115], v23 offset:0
ds_read_b128 v[116:119], v23 offset:4096
s_waitcnt lgkmcnt(2)
v_mfma_f32_32x32x16_bf16 v[48:63], v[188:191], v[100:103], v[48:63]
s_mov_b32 s60, 69632
buffer_load_dword v139, v28, s[56:59], s60 offen offset:2048
s_waitcnt vmcnt(29) lgkmcnt(1)
v_mfma_f32_32x32x16_bf16 v[32:47], v[192:195], v[112:115], v[32:47]
ds_read_b128 v[96:99], v20 offset:16384
ds_read_b128 v[100:103], v20 offset:20480
s_waitcnt lgkmcnt(2)
v_mfma_f32_32x32x16_bf16 v[48:63], v[192:195], v[116:119], v[48:63]
s_mov_b32 s60, 98304
buffer_load_dword v140, v28, s[56:59], s60 offen offset:0
s_waitcnt vmcnt(28) lgkmcnt(1)
v_mfma_f32_32x32x16_bf16 v[32:47], v[196:199], v[96:99], v[32:47]
ds_read_b128 v[112:115], v21 offset:16384
ds_read_b128 v[116:119], v21 offset:20480
s_waitcnt lgkmcnt(2)
v_mfma_f32_32x32x16_bf16 v[48:63], v[196:199], v[100:103], v[48:63]
s_mov_b32 s60, 98304
buffer_load_dword v141, v28, s[56:59], s60 offen offset:2048
s_waitcnt vmcnt(27) lgkmcnt(1)
v_mfma_f32_32x32x16_bf16 v[32:47], v[200:203], v[112:115], v[32:47]
ds_read_b128 v[96:99], v22 offset:16384
ds_read_b128 v[100:103], v22 offset:20480
s_waitcnt lgkmcnt(2)
v_mfma_f32_32x32x16_bf16 v[48:63], v[200:203], v[116:119], v[48:63]
s_mov_b32 s60, 102400
buffer_load_dword v142, v28, s[56:59], s60 offen offset:0
s_waitcnt vmcnt(26) lgkmcnt(1)
v_mfma_f32_32x32x16_bf16 v[32:47], v[204:207], v[96:99], v[32:47]
ds_read_b128 v[112:115], v23 offset:16384
ds_read_b128 v[116:119], v23 offset:20480
s_waitcnt lgkmcnt(2)
v_mfma_f32_32x32x16_bf16 v[48:63], v[204:207], v[100:103], v[48:63]
s_mov_b32 s60, 102400
buffer_load_dword v143, v28, s[56:59], s60 offen offset:2048
s_waitcnt vmcnt(25) lgkmcnt(0)
v_mfma_f32_32x32x16_bf16 v[32:47], v[208:211], v[112:115], v[32:47]
v_mfma_f32_32x32x16_bf16 v[48:63], v[208:211], v[116:119], v[48:63]
s_mul_i32 s60, s37, 0x9e3779b1
s_and_b32 s60, s60, 0xbfff0000
s_or_b32 s60, s60, 0x20000000
s_lshl_b32 s64, s35, 4
s_add_u32 s64, s64, s36
s_lshl_b32 s64, s64, 2
s_add_u32 s64, s64, s34
s_lshl_b32 s64, s64, 13
s_add_u32 s50, s64, 33554432
s_add_u32 s48, s32, s50
s_addc_u32 s49, s33, 0
s_mov_b32 s50, 8192
s_mov_b32 s51, 0x20000
s_xor_b32 s64, s64, 262144
s_add_u32 s54, s64, 33554432
s_add_u32 s52, s32, s54
s_addc_u32 s53, s33, 0
s_mov_b32 s54, 8192
s_mov_b32 s55, 0x20000
s_movk_i32 s64, 0x1000
v_cvt_pk_bf16_f32 v96, v32, v48
v_cvt_pk_bf16_f32 v97, v33, v49
v_cvt_pk_bf16_f32 v98, v34, v50
v_cvt_pk_bf16_f32 v99, v35, s60
buffer_store_dwordx4 v[96:99], v2, s[48:51], 0 offen offset:0 sc1
v_cvt_pk_bf16_f32 v100, v51, v36
v_cvt_pk_bf16_f32 v101, v52, v37
v_cvt_pk_bf16_f32 v102, v53, v38
v_cvt_pk_bf16_f32 v103, v54, s60
buffer_store_dwordx4 v[100:103], v2, s[48:51], 0 offen offset:1024 sc1
v_cvt_pk_bf16_f32 v244, v39, v55
v_cvt_pk_bf16_f32 v245, v40, v56
v_cvt_pk_bf16_f32 v246, v41, v57
v_cvt_pk_bf16_f32 v247, v42, s60
buffer_store_dwordx4 v[244:247], v2, s[48:51], 0 offen offset:2048 sc1
v_cvt_pk_bf16_f32 v248, v58, v43
v_cvt_pk_bf16_f32 v249, v59, v44
v_cvt_pk_bf16_f32 v250, v60, v45
v_cvt_pk_bf16_f32 v251, v61, s60
buffer_store_dwordx4 v[248:251], v2, s[48:51], 0 offen offset:3072 sc1
v_cvt_pk_bf16_f32 v252, v46, v62
v_cvt_pk_bf16_f32 v253, v47, v63
v_cvt_pk_bf16_f32 v254, v63, v63
v_cvt_pk_bf16_f32 v255, v63, s60
buffer_store_dwordx4 v[252:255], v2, s[48:51], s64 offen offset:0 sc1
ds_read_b128 v[104:107], v24 offset:40960
ds_read_b128 v[108:111], v24 offset:45056
ds_read_b128 v[120:123], v25 offset:40960
ds_read_b128 v[124:127], v25 offset:45056
s_waitcnt lgkmcnt(2)
v_mfma_f32_32x32x16_bf16 v[64:79], v[164:167], v[104:107], v[64:79]
v_mfma_f32_32x32x16_bf16 v[80:95], v[164:167], v[108:111], v[80:95]
ds_read_b128 v[104:107], v26 offset:40960
ds_read_b128 v[108:111], v26 offset:45056
s_waitcnt lgkmcnt(2)
v_mfma_f32_32x32x16_bf16 v[64:79], v[168:171], v[120:123], v[64:79]
v_mfma_f32_32x32x16_bf16 v[80:95], v[168:171], v[124:127], v[80:95]
ds_read_b128 v[120:123], v27 offset:40960
ds_read_b128 v[124:127], v27 offset:45056
s_waitcnt lgkmcnt(2)
v_mfma_f32_32x32x16_bf16 v[64:79], v[172:175], v[104:107], v[64:79]
v_mfma_f32_32x32x16_bf16 v[80:95], v[172:175], v[108:111], v[80:95]
ds_read_b128 v[104:107], v20 offset:8192
ds_read_b128 v[108:111], v20 offset:12288
s_waitcnt lgkmcnt(2)
v_mfma_f32_32x32x16_bf16 v[64:79], v[176:179], v[120:123], v[64:79]
v_mfma_f32_32x32x16_bf16 v[80:95], v[176:179], v[124:127], v[80:95]
ds_read_b128 v[120:123], v21 offset:8192
ds_read_b128 v[124:127], v21 offset:12288
s_waitcnt lgkmcnt(2)
v_mfma_f32_32x32x16_bf16 v[64:79], v[180:183], v[104:107], v[64:79]
v_mfma_f32_32x32x16_bf16 v[80:95], v[180:183], v[108:111], v[80:95]
ds_read_b128 v[104:107], v22 offset:8192
ds_read_b128 v[108:111], v22 offset:12288
s_waitcnt lgkmcnt(2)
v_mfma_f32_32x32x16_bf16 v[64:79], v[184:187], v[120:123], v[64:79]
v_mfma_f32_32x32x16_bf16 v[80:95], v[184:187], v[124:127], v[80:95]
ds_read_b128 v[120:123], v23 offset:8192
ds_read_b128 v[124:127], v23 offset:12288
s_waitcnt lgkmcnt(2)
v_mfma_f32_32x32x16_bf16 v[64:79], v[188:191], v[104:107], v[64:79]
v_mfma_f32_32x32x16_bf16 v[80:95], v[188:191], v[108:111], v[80:95]
ds_read_b128 v[104:107], v20 offset:24576
ds_read_b128 v[108:111], v20 offset:28672
s_waitcnt lgkmcnt(2)
v_mfma_f32_32x32x16_bf16 v[64:79], v[192:195], v[120:123], v[64:79]
v_mfma_f32_32x32x16_bf16 v[80:95], v[192:195], v[124:127], v[80:95]
ds_read_b128 v[120:123], v21 offset:24576
ds_read_b128 v[124:127], v21 offset:28672
s_waitcnt lgkmcnt(2)
v_mfma_f32_32x32x16_bf16 v[64:79], v[196:199], v[104:107], v[64:79]
v_mfma_f32_32x32x16_bf16 v[80:95], v[196:199], v[108:111], v[80:95]
ds_read_b128 v[104:107], v22 offset:24576
ds_read_b128 v[108:111], v22 offset:28672
s_waitcnt lgkmcnt(2)
v_mfma_f32_32x32x16_bf16 v[64:79], v[200:203], v[120:123], v[64:79]
v_mfma_f32_32x32x16_bf16 v[80:95], v[200:203], v[124:127], v[80:95]
ds_read_b128 v[120:123], v23 offset:24576
ds_read_b128 v[124:127], v23 offset:28672
s_waitcnt lgkmcnt(2)
v_mfma_f32_32x32x16_bf16 v[64:79], v[204:207], v[104:107], v[64:79]
v_mfma_f32_32x32x16_bf16 v[80:95], v[204:207], v[108:111], v[80:95]
s_waitcnt lgkmcnt(0)
v_mfma_f32_32x32x16_bf16 v[64:79], v[208:211], v[120:123], v[64:79]
v_mfma_f32_32x32x16_bf16 v[80:95], v[208:211], v[124:127], v[80:95]
s_waitcnt vmcnt(5)
v_lshlrev_b32 v8, 16, v31
v_and_b32 v9, 0xffff0000, v31
v_lshlrev_b32 v148, 16, v128
v_and_b32 v149, 0xffff0000, v128
v_pk_mul_f32 v[148:149], v[148:149], v[8:9]
v_cvt_pk_bf16_f32 v10, v148, v149
v_lshlrev_b32 v148, 16, v10
v_and_b32 v149, 0xffff0000, v10
s_nop 1
v_add_f32 v148, v148, v64
v_add_f32 v149, v149, v80
v_lshlrev_b32 v150, 16, v129
v_and_b32 v151, 0xffff0000, v129
v_pk_mul_f32 v[150:151], v[150:151], v[8:9]
v_cvt_pk_bf16_f32 v10, v150, v151
v_lshlrev_b32 v150, 16, v10
v_and_b32 v151, 0xffff0000, v10
v_add_f32 v150, v150, v65
v_add_f32 v151, v151, v81
v_lshlrev_b32 v152, 16, v130
v_and_b32 v153, 0xffff0000, v130
v_pk_mul_f32 v[152:153], v[152:153], v[8:9]
v_cvt_pk_bf16_f32 v10, v152, v153
v_lshlrev_b32 v152, 16, v10
v_and_b32 v153, 0xffff0000, v10
v_add_f32 v152, v152, v66
v_add_f32 v153, v153, v82
v_lshlrev_b32 v154, 16, v131
v_and_b32 v155, 0xffff0000, v131
v_pk_mul_f32 v[154:155], v[154:155], v[8:9]
v_cvt_pk_bf16_f32 v10, v154, v155
v_lshlrev_b32 v154, 16, v10
v_and_b32 v155, 0xffff0000, v10
v_add_f32 v154, v154, v67
v_add_f32 v155, v155, v83
v_lshlrev_b32 v156, 16, v132
v_and_b32 v157, 0xffff0000, v132
v_pk_mul_f32 v[156:157], v[156:157], v[8:9]
v_cvt_pk_bf16_f32 v10, v156, v157
v_lshlrev_b32 v156, 16, v10
v_and_b32 v157, 0xffff0000, v10
v_add_f32 v156, v156, v68
v_add_f32 v157, v157, v84
v_lshlrev_b32 v158, 16, v133
v_and_b32 v159, 0xffff0000, v133
v_pk_mul_f32 v[158:159], v[158:159], v[8:9]
v_cvt_pk_bf16_f32 v10, v158, v159
v_lshlrev_b32 v158, 16, v10
v_and_b32 v159, 0xffff0000, v10
v_add_f32 v158, v158, v69
v_add_f32 v159, v159, v85
v_lshlrev_b32 v160, 16, v134
v_and_b32 v161, 0xffff0000, v134
v_pk_mul_f32 v[160:161], v[160:161], v[8:9]
v_cvt_pk_bf16_f32 v10, v160, v161
v_lshlrev_b32 v160, 16, v10
v_and_b32 v161, 0xffff0000, v10
v_add_f32 v160, v160, v70
v_add_f32 v161, v161, v86
v_lshlrev_b32 v162, 16, v135
v_and_b32 v163, 0xffff0000, v135
v_pk_mul_f32 v[162:163], v[162:163], v[8:9]
v_cvt_pk_bf16_f32 v10, v162, v163
v_lshlrev_b32 v162, 16, v10
v_and_b32 v163, 0xffff0000, v10
v_add_f32 v162, v162, v71
v_add_f32 v163, v163, v87
v_lshlrev_b32 v164, 16, v136
v_and_b32 v165, 0xffff0000, v136
v_pk_mul_f32 v[164:165], v[164:165], v[8:9]
v_cvt_pk_bf16_f32 v10, v164, v165
v_lshlrev_b32 v164, 16, v10
v_and_b32 v165, 0xffff0000, v10
v_add_f32 v164, v164, v72
v_add_f32 v165, v165, v88
v_lshlrev_b32 v166, 16, v137
v_and_b32 v167, 0xffff0000, v137
v_pk_mul_f32 v[166:167], v[166:167], v[8:9]
v_cvt_pk_bf16_f32 v10, v166, v167
v_lshlrev_b32 v166, 16, v10
v_and_b32 v167, 0xffff0000, v10
v_add_f32 v166, v166, v73
v_add_f32 v167, v167, v89
v_lshlrev_b32 v168, 16, v138
v_and_b32 v169, 0xffff0000, v138
v_pk_mul_f32 v[168:169], v[168:169], v[8:9]
v_cvt_pk_bf16_f32 v10, v168, v169
v_lshlrev_b32 v168, 16, v10
v_and_b32 v169, 0xffff0000, v10
v_add_f32 v168, v168, v74
v_add_f32 v169, v169, v90
v_lshlrev_b32 v170, 16, v139
v_and_b32 v171, 0xffff0000, v139
v_pk_mul_f32 v[170:171], v[170:171], v[8:9]
v_cvt_pk_bf16_f32 v10, v170, v171
v_lshlrev_b32 v170, 16, v10
v_and_b32 v171, 0xffff0000, v10
v_add_f32 v170, v170, v75
v_add_f32 v171, v171, v91
v_lshlrev_b32 v172, 16, v140
v_and_b32 v173, 0xffff0000, v140
v_pk_mul_f32 v[172:173], v[172:173], v[8:9]
v_cvt_pk_bf16_f32 v10, v172, v173
v_lshlrev_b32 v172, 16, v10
v_and_b32 v173, 0xffff0000, v10
v_add_f32 v172, v172, v76
v_add_f32 v173, v173, v92
v_lshlrev_b32 v174, 16, v141
v_and_b32 v175, 0xffff0000, v141
v_pk_mul_f32 v[174:175], v[174:175], v[8:9]
v_cvt_pk_bf16_f32 v10, v174, v175
v_lshlrev_b32 v174, 16, v10
v_and_b32 v175, 0xffff0000, v10
v_add_f32 v174, v174, v77
v_add_f32 v175, v175, v93
v_lshlrev_b32 v176, 16, v142
v_and_b32 v177, 0xffff0000, v142
v_pk_mul_f32 v[176:177], v[176:177], v[8:9]
v_cvt_pk_bf16_f32 v10, v176, v177
v_lshlrev_b32 v176, 16, v10
v_and_b32 v177, 0xffff0000, v10
v_add_f32 v176, v176, v78
v_add_f32 v177, v177, v94
v_lshlrev_b32 v178, 16, v143
v_and_b32 v179, 0xffff0000, v143
v_pk_mul_f32 v[178:179], v[178:179], v[8:9]
v_cvt_pk_bf16_f32 v10, v178, v179
v_lshlrev_b32 v178, 16, v10
v_and_b32 v179, 0xffff0000, v10
v_add_f32 v178, v178, v79
v_add_f32 v179, v179, v95
s_mov_b32 s44, s28
s_mov_b32 s45, s29
s_mov_b32 s46, s24
s_mov_b32 s47, 0x20000
s_mov_b32 s92, 0
L_xw73:
s_load_dword s61, s[52:53], 5116 glc
s_add_u32 s92, s92, 1
s_waitcnt lgkmcnt(0)
s_xor_b32 s61, s61, s60
s_cmp_lt_u32 s61, 0x10000
s_cbranch_scc1 L_xwd74
s_cmp_lt_u32 s92, 200000
s_cbranch_scc1 L_xw73
L_xwd74:
s_mov_b32 s92, 0
buffer_load_dwordx4 v[180:183], v2, s[52:55], 0 offen offset:0 sc1
buffer_load_dwordx4 v[184:187], v2, s[52:55], 0 offen offset:1024 sc1
buffer_load_dwordx4 v[188:191], v2, s[52:55], 0 offen offset:2048 sc1
buffer_load_dwordx4 v[192:195], v2, s[52:55], 0 offen offset:3072 sc1
buffer_load_dwordx4 v[196:199], v2, s[52:55], s64 offen offset:0 sc1
L_xl71:
v_mov_b32 v10, 0
s_waitcnt vmcnt(4)
v_bitop3_b32 v10, v10, v183, s60 bitop3:0xf6
s_waitcnt vmcnt(3)
v_bitop3_b32 v10, v10, v187, s60 bitop3:0xf6
s_waitcnt vmcnt(2)
v_bitop3_b32 v10, v10, v191, s60 bitop3:0xf6
s_waitcnt vmcnt(1)
v_bitop3_b32 v10, v10, v195, s60 bitop3:0xf6
s_waitcnt vmcnt(0)
v_bitop3_b32 v10, v10, v199, s60 bitop3:0xf6
v_cmp_lt_u32 vcc, 0xffff, v10
s_nop 0
s_cbranch_vccz L_xd72
s_add_u32 s92, s92, 1
s_cmp_ge_u32 s92, 200000
s_cbranch_scc1 L_xd72
buffer_load_dwordx4 v[180:183], v2, s[52:55], 0 offen offset:0 sc1
buffer_load_dwordx4 v[184:187], v2, s[52:55], 0 offen offset:1024 sc1
buffer_load_dwordx4 v[188:191], v2, s[52:55], 0 offen offset:2048 sc1
buffer_load_dwordx4 v[192:195], v2, s[52:55], 0 offen offset:3072 sc1
buffer_load_dwordx4 v[196:199], v2, s[52:55], s64 offen offset:0 sc1
s_branch L_xl71
L_xd72:
v_lshlrev_b32 v10, 16, v180
v_and_b32 v11, 0xffff0000, v180
v_pk_add_f32 v[148:149], v[148:149], v[10:11]
s_mov_b32 s64, 0
buffer_store_dwordx2 v[148:149], v29, s[44:47], s64 offen nt
v_lshlrev_b32 v10, 16, v181
v_and_b32 v11, 0xffff0000, v181
v_pk_add_f32 v[150:151], v[150:151], v[10:11]
s_mov_b32 s64, 8192
buffer_store_dwordx2 v[150:151], v29, s[44:47], s64 offen nt
v_lshlrev_b32 v10, 16, v182
v_and_b32 v11, 0xffff0000, v182
v_pk_add_f32 v[152:153], v[152:153], v[10:11]
s_mov_b32 s64, 16384
buffer_store_dwordx2 v[152:153], v29, s[44:47], s64 offen nt
v_lshlrev_b32 v10, 16, v183
v_lshlrev_b32 v11, 16, v184
v_pk_add_f32 v[154:155], v[154:155], v[10:11]
s_mov_b32 s64, 24576
buffer_store_dwordx2 v[154:155], v29, s[44:47], s64 offen nt
v_and_b32 v10, 0xffff0000, v184
v_lshlrev_b32 v11, 16, v185
v_pk_add_f32 v[156:157], v[156:157], v[10:11]
s_mov_b32 s64, 131072
buffer_store_dwordx2 v[156:157], v29, s[44:47], s64 offen nt
v_and_b32 v10, 0xffff0000, v185
v_lshlrev_b32 v11, 16, v186
v_pk_add_f32 v[158:159], v[158:159], v[10:11]
s_mov_b32 s64, 139264
buffer_store_dwordx2 v[158:159], v29, s[44:47], s64 offen nt
v_and_b32 v10, 0xffff0000, v186
v_lshlrev_b32 v11, 16, v187
v_pk_add_f32 v[160:161], v[160:161], v[10:11]
s_mov_b32 s64, 147456
buffer_store_dwordx2 v[160:161], v29, s[44:47], s64 offen nt
v_lshlrev_b32 v10, 16, v188
v_and_b32 v11, 0xffff0000, v188
v_pk_add_f32 v[162:163], v[162:163], v[10:11]
s_mov_b32 s64, 155648
buffer_store_dwordx2 v[162:163], v29, s[44:47], s64 offen nt
v_lshlrev_b32 v10, 16, v189
v_and_b32 v11, 0xffff0000, v189
v_pk_add_f32 v[164:165], v[164:165], v[10:11]
s_mov_b32 s64, 262144
buffer_store_dwordx2 v[164:165], v29, s[44:47], s64 offen nt
v_lshlrev_b32 v10, 16, v190
v_and_b32 v11, 0xffff0000, v190
v_pk_add_f32 v[166:167], v[166:167], v[10:11]
s_mov_b32 s64, 270336
buffer_store_dwordx2 v[166:167], v29, s[44:47], s64 offen nt
v_lshlrev_b32 v10, 16, v191
v_lshlrev_b32 v11, 16, v192
v_pk_add_f32 v[168:169], v[168:169], v[10:11]
s_mov_b32 s64, 278528
buffer_store_dwordx2 v[168:169], v29, s[44:47], s64 offen nt
v_and_b32 v10, 0xffff0000, v192
v_lshlrev_b32 v11, 16, v193
v_pk_add_f32 v[170:171], v[170:171], v[10:11]
s_mov_b32 s64, 286720
buffer_store_dwordx2 v[170:171], v29, s[44:47], s64 offen nt
v_and_b32 v10, 0xffff0000, v193
v_lshlrev_b32 v11, 16, v194
v_pk_add_f32 v[172:173], v[172:173], v[10:11]
s_mov_b32 s64, 393216
buffer_store_dwordx2 v[172:173], v29, s[44:47], s64 offen nt
v_and_b32 v10, 0xffff0000, v194
v_lshlrev_b32 v11, 16, v195
v_pk_add_f32 v[174:175], v[174:175], v[10:11]
s_mov_b32 s64, 401408
buffer_store_dwordx2 v[174:175], v29, s[44:47], s64 offen nt
v_lshlrev_b32 v10, 16, v196
v_and_b32 v11, 0xffff0000, v196
v_pk_add_f32 v[176:177], v[176:177], v[10:11]
s_mov_b32 s64, 409600
buffer_store_dwordx2 v[176:177], v29, s[44:47], s64 offen nt
v_lshlrev_b32 v10, 16, v197
v_and_b32 v11, 0xffff0000, v197
v_pk_add_f32 v[178:179], v[178:179], v[10:11]
s_mov_b32 s64, 417792
buffer_store_dwordx2 v[178:179], v29, s[44:47], s64 offen nt
L_concat_heads__spectral_gfnet__ssm_conv_s5__prompt_kernel_end:
s_endpgm

.section .rodata,"a"
.p2align 6
.amdhsa_kernel concat_heads__spectral_gfnet__ssm_conv_s5__prompt_kernel
  .amdhsa_next_free_vgpr 256
  .amdhsa_next_free_sgpr 102
  .amdhsa_accum_offset 256
  .amdhsa_group_segment_fixed_size 0
  .amdhsa_kernarg_size 120
  .amdhsa_user_sgpr_count 2
  .amdhsa_user_sgpr_kernarg_segment_ptr 1
  .amdhsa_system_sgpr_workgroup_id_x 1
.end_amdhsa_kernel
.text
```

```asm
; @launch grid=(256,1,1) block=(512,1,1) lds=163840
.amdgcn_target "amdgcn-amd-amdhsa--gfx950"
.text
.globl concat_heads__spectral_gfnet__ssm_conv_s5__prompt_kernel
.p2align 8
.type concat_heads__spectral_gfnet__ssm_conv_s5__prompt_kernel,@function
concat_heads__spectral_gfnet__ssm_conv_s5__prompt_kernel:
s_cmp_ge_u32 s2, 256
s_cbranch_scc1 L_concat_heads__spectral_gfnet__ssm_conv_s5__prompt_kernel_end
s_load_dwordx16 s[4:19], s[0:1], 0
s_load_dwordx8 s[20:27], s[0:1], 64
s_load_dwordx4 s[28:31], s[0:1], 96
s_load_dwordx2 s[32:33], s[0:1], 112
v_lshrrev_b32 v2, 6, v0
v_and_b32 v1, 63, v0
v_readfirstlane_b32 s34, v2
s_and_b32 s60, s2, 7
s_lshr_b32 s61, s2, 3
s_lshr_b32 s35, s60, 1
s_lshl_b32 s35, s35, 2
s_lshr_b32 s62, s61, 3
s_add_u32 s35, s35, s62
s_and_b32 s36, s60, 1
s_lshl_b32 s36, s36, 3
s_and_b32 s62, s61, 7
s_add_u32 s36, s36, s62
s_cmp_ge_u32 s34, 4
s_cbranch_scc0 L_concat_heads__spectral_gfnet__ssm_conv_s5__prompt_kernel_gemm
s_sub_u32 s66, s34, 4
v_lshrrev_b32 v2, 5, v1
v_bfe_u32 v3, v1, 3, 2
v_and_b32 v4, 1, v3
v_lshrrev_b32 v5, 1, v3
v_lshlrev_b32 v6, 5, v2
v_lshl_add_u32 v6, v4, 4, v6
v_add_u32 v6, v6, v5
s_lshr_b32 s60, s66, 1
s_lshl_b32 s61, s60, 6
s_and_b32 s62, s66, 1
s_lshl_b32 s62, s62, 3
s_add_u32 s61, s61, s62
v_add_u32 v6, s61, v6
v_lshlrev_b32 v6, 11, v6
s_lshl_b32 s61, s60, 5
v_lshl_add_u32 v7, v2, 3, v3
v_add_u32 v7, s61, v7
v_lshlrev_b32 v7, 11, v7
v_and_b32 v4, 7, v1
v_lshrrev_b32 v5, 4, v1
v_xor_b32 v4, v4, v5
v_lshlrev_b32 v4, 4, v4
v_xor_b32 v5, 64, v4
v_add_u32 v176, v6, v4
v_add_u32 v180, v7, v4
v_add_u32 v177, v6, v5
v_add_u32 v177, 3072, v177
v_add_u32 v181, v7, v5
v_add_u32 v181, 7168, v181
v_add_u32 v178, v6, v4
v_add_u32 v178, 6144, v178
v_add_u32 v182, v7, v4
v_add_u32 v182, 30720, v182
v_add_u32 v179, v6, v5
v_add_u32 v179, 9216, v179
v_add_u32 v183, v7, v5
v_add_u32 v183, 37888, v183
s_and_b32 s64, s2, 7
s_mul_i32 s64, s64, 0
s_add_u32 s60, s35, s36
s_and_b32 s60, s60, 0
s_mul_i32 s60, s60, 2048
s_add_u32 s64, s64, s60
s_mul_i32 s60, s35, 128
s_add_u32 s64, s64, s60
s_mul_i32 s60, s36, 128
s_add_u32 s64, s64, s60
s_lshl_b32 s60, s35, 18
s_lshl_b32 s61, s36, 17
s_waitcnt lgkmcnt(0)
s_lshl_b32 s25, s66, 12
s_mov_b32 s24, s64
s_add_u32 s12, s10, s60
s_addc_u32 s13, s11, 0
s_mov_b32 s14, 262144
s_mov_b32 s15, 0x20000
s_bitcmp1_b32 s66, 0
s_cselect_b32 s62, s18, s16
s_cselect_b32 s63, s19, s17
s_cselect_b32 s100, s22, s20
s_cselect_b32 s101, s23, s21
s_add_u32 s20, s62, s61
s_addc_u32 s21, s63, 0
s_mov_b32 s22, 131072
s_mov_b32 s23, 0x20000
s_add_u32 m0, s25, 0
s_add_u32 s26, s24, 0
s_and_b32 s26, s26, 0x7ff
buffer_load_dwordx4 v176, s[12:15], s26 offen offset:0 lds
buffer_load_dwordx4 v177, s[12:15], s26 offen offset:1024 lds
buffer_load_dwordx4 v178, s[12:15], s26 offen offset:2048 lds
buffer_load_dwordx4 v179, s[12:15], s26 offen offset:3072 lds
s_add_u32 m0, s25, 16384
s_nop 0
buffer_load_dwordx4 v180, s[20:23], s26 offen offset:0 lds
buffer_load_dwordx4 v181, s[20:23], s26 offen offset:1024 lds
buffer_load_dwordx4 v182, s[20:23], s26 offen offset:2048 lds
buffer_load_dwordx4 v183, s[20:23], s26 offen offset:3072 lds
s_setprio 3
s_mov_b32 s48, s6
s_mov_b32 s49, s7
s_mov_b32 s50, 2101248
s_mov_b32 s51, 0x20000
s_mov_b32 s52, s8
s_mov_b32 s53, s9
s_mov_b32 s54, 2101248
s_mov_b32 s55, 0x20000
s_and_b32 s60, s2, 31
s_lshr_b32 s61, s2, 5
s_lshl_b32 s61, s61, 7
s_add_u32 s60, s60, s61
s_lshl_b32 s61, s66, 5
s_add_u32 s67, s60, s61
s_lshl_b32 s60, s67, 12
s_add_u32 s4, s4, s60
s_addc_u32 s5, s5, 0
s_mov_b32 s6, 4096
s_mov_b32 s7, 0x20000
v_lshlrev_b32 v2, 4, v1
v_xor_b32 v3, 128, v2
s_lshl_b32 s68, s66, 12
s_add_u32 s68, s68, 131072
s_and_b32 s60, s2, 7
s_bfe_u32 s61, s2, 0x10003
s_bfe_u32 s62, s2, 0x20004
s_lshr_b32 s63, s2, 6
s_lshr_b32 s64, s60, 1
s_lshl_b32 s64, s64, 3
s_lshl_b32 s65, s61, 2
s_add_u32 s64, s64, s65
s_and_b32 s65, s60, 1
s_lshl_b32 s65, s65, 1
s_add_u32 s64, s64, s65
s_lshl_b32 s64, s64, 5
s_lshl_b32 s65, s62, 3
s_add_u32 s64, s64, s65
s_lshl_b32 s65, s66, 1
s_add_u32 s64, s64, s65
s_mul_i32 s64, s64, 1026
s_lshl_b32 s65, s63, 8
s_add_u32 s69, s64, s65
v_bfe_u32 v8, v1, 4, 1
v_mul_u32_u24 v8, 32832, v8
v_lshrrev_b32 v9, 5, v1
s_mov_b32 s65, 1050624
v_mul_lo_u32 v9, s65, v9
v_add_u32 v8, v8, v9
v_and_b32 v9, 15, v1
s_lshl_b32 s65, s66, 1
v_xor_b32 v9, s65, v9
v_lshl_add_u32 v18, v9, 4, v8
v_xor_b32 v9, 1, v9
v_lshl_add_u32 v19, v9, 4, v8
v_add_u32 v19, 1026, v19
s_bfe_u32 s64, s2, 0x20005
s_lshl_b32 s64, s64, 8
s_bfe_u32 s65, s2, 0x10004
s_lshl_b32 s65, s65, 6
s_add_u32 s64, s64, s65
s_bfe_u32 s65, s2, 0x10003
s_lshl_b32 s65, s65, 7
s_add_u32 s64, s64, s65
s_and_b32 s65, s2, 7
s_lshl_b32 s65, s65, 2
s_add_u32 s64, s64, s65
v_bfe_u32 v8, v1, 3, 2
v_add_u32 v8, s64, v8
v_bfe_u32 v9, v1, 2, 1
v_lshl_add_u32 v8, v9, 5, v8
v_bfe_u32 v9, v1, 1, 1
v_lshl_add_u32 v8, v9, 10, v8
v_sub_u32 v9, 2048, v8
v_and_b32 v9, 2047, v9
v_and_b32 v10, 1, v1
v_cmp_eq_u32 vcc, 1, v10
s_nop 1
v_cndmask_b32 v8, v8, v9, vcc
v_mul_u32_u24 v17, 1026, v8
s_lshr_b32 s64, s2, 7
s_lshl_b32 s64, s64, 10
v_add_u32 v17, s64, v17
v_mov_b32 v184, 126992
s_lshl_b32 s64, s66, 2
v_add_u32 v185, s64, v184
v_and_b32 v8, 31, v1
v_lshrrev_b32 v9, 5, v1
v_and_b32 v10, 1, v1
v_lshrrev_b32 v11, 1, v8
v_lshlrev_b32 v4, 6, v11
v_lshl_add_u32 v4, v10, 4, v4
v_lshl_add_u32 v4, v9, 12, v4
v_add_u32 v11, v11, v10
v_lshlrev_b32 v11, 6, v11
v_lshl_add_u32 v11, v10, 4, v11
v_lshl_add_u32 v11, v9, 12, v11
v_sub_u32 v5, 5168, v11
v_bfe_u32 v11, v4, 7, 1
v_lshlrev_b32 v11, 5, v11
v_xor_b32 v4, v4, v11
v_bfe_u32 v11, v5, 7, 1
v_lshlrev_b32 v11, 5, v11
v_xor_b32 v5, v5, v11
v_add_u32 v6, 11264, v5
v_and_b32 v6, 0x3fff, v6
s_add_u32 s64, s64, 98304
v_add_u32 v4, s64, v4
v_add_u32 v5, s64, v5
v_add_u32 v6, s64, v6
v_bfe_u32 v11, v1, 3, 1
v_lshlrev_b32 v11, 5, v11
v_xor_b32 v7, v2, v11
v_bfe_u32 v12, v1, 2, 1
v_mul_u32_u24 v12, 2176, v12
v_bfe_u32 v13, v1, 3, 1
v_lshl_add_u32 v12, v13, 6, v12
v_lshl_add_u32 v12, v9, 8, v12
v_bfe_u32 v13, v1, 4, 1
v_lshl_add_u32 v12, v13, 5, v12
v_and_b32 v13, 3, v1
v_lshl_add_u32 v12, v13, 3, v12
v_add_u32 v12, s68, v12
v_xor_b32 v13, 128, v12
s_lshl_b32 s64, s2, 14
s_lshl_b32 s65, s66, 12
s_add_u32 s64, s64, s65
s_add_u32 s42, s64, 16777216
s_add_u32 s40, s32, s42
s_addc_u32 s41, s33, 0
s_mov_b32 s42, 4096
s_mov_b32 s43, 0x20000
s_add_u32 s46, s64, 16777216
s_add_u32 s44, s32, s46
s_addc_u32 s45, s33, 0
s_mov_b32 s46, 4096
s_mov_b32 s47, 0x20000
v_and_b32 v14, 7, v1
v_lshrrev_b32 v15, 3, v1
v_xor_b32 v16, v14, v15
v_lshlrev_b32 v16, 4, v16
v_lshl_add_u32 v16, v14, 11, v16
s_lshr_b32 s64, s66, 1
s_lshl_b32 s64, s64, 7
s_and_b32 s65, s66, 1
s_lshl_b32 s65, s65, 3
s_add_u32 s64, s64, s65
s_add_u32 s64, s64, 147456
v_add_u32 v16, s64, v16
v_lshlrev_b32 v15, 16, v15
v_lshl_add_u32 v15, v14, 4, v15
s_lshl_b32 s64, s63, 7
s_lshr_b32 s65, s66, 1
s_lshl_b32 s65, s65, 6
s_add_u32 s64, s64, s65
s_and_b32 s65, s66, 1
s_lshl_b32 s65, s65, 2
s_add_u32 s64, s64, s65
s_mul_i32 s64, s64, 8192
s_lshr_b32 s65, s60, 2
s_mul_i32 s65, s65, 0
s_add_u32 s64, s64, s65
s_lshl_b32 s65, s60, 10
s_add_u32 s64, s64, s65
s_lshl_b32 s65, s61, 9
s_add_u32 s64, s64, s65
s_lshl_b32 s65, s62, 7
s_add_u32 s64, s64, s65
s_add_u32 s58, s64, 25182208
s_add_u32 s56, s32, s58
s_addc_u32 s57, s33, 0
s_sub_u32 s58, 4194304, s64
s_mov_b32 s59, 0x20000
v_and_b32 v104, 31, v1
v_cvt_f32_u32 v104, v104
v_lshrrev_b32 v105, 5, v1
v_lshlrev_b32 v105, 2, v105
v_cvt_f32_u32 v105, v105
v_mul_f32 v105, v104, v105
v_mul_f32 v105, 0x3d000000, v105
v_fmamk_f32 v106, v104, 0x0, v105
v_fract_f32 v106, v106
v_cos_f32 v107, v106
v_sin_f32 v108, v106
s_nop 0
v_cvt_pk_bf16_f32 v192, v107, v108
v_cvt_pk_bf16_f32 v208, -v108, v107
v_fmamk_f32 v109, v104, 0x3d000000, v105
v_fract_f32 v109, v109
v_cos_f32 v110, v109
v_sin_f32 v111, v109
s_nop 0
v_cvt_pk_bf16_f32 v193, v110, v111
v_cvt_pk_bf16_f32 v209, -v111, v110
v_fmamk_f32 v106, v104, 0x3d800000, v105
v_fract_f32 v106, v106
v_cos_f32 v107, v106
v_sin_f32 v108, v106
s_nop 0
v_cvt_pk_bf16_f32 v194, v107, v108
v_cvt_pk_bf16_f32 v210, -v108, v107
v_fmamk_f32 v109, v104, 0x3dc00000, v105
v_fract_f32 v109, v109
v_cos_f32 v110, v109
v_sin_f32 v111, v109
s_nop 0
v_cvt_pk_bf16_f32 v195, v110, v111
v_cvt_pk_bf16_f32 v211, -v111, v110
v_fmamk_f32 v106, v104, 0x3e800000, v105
v_fract_f32 v106, v106
v_cos_f32 v107, v106
v_sin_f32 v108, v106
s_nop 0
v_cvt_pk_bf16_f32 v196, v107, v108
v_cvt_pk_bf16_f32 v212, -v108, v107
v_fmamk_f32 v109, v104, 0x3e900000, v105
v_fract_f32 v109, v109
v_cos_f32 v110, v109
v_sin_f32 v111, v109
s_nop 0
v_cvt_pk_bf16_f32 v197, v110, v111
v_cvt_pk_bf16_f32 v213, -v111, v110
v_fmamk_f32 v106, v104, 0x3ea00000, v105
v_fract_f32 v106, v106
v_cos_f32 v107, v106
v_sin_f32 v108, v106
s_nop 0
v_cvt_pk_bf16_f32 v198, v107, v108
v_cvt_pk_bf16_f32 v214, -v108, v107
v_fmamk_f32 v109, v104, 0x3eb00000, v105
v_fract_f32 v109, v109
v_cos_f32 v110, v109
v_sin_f32 v111, v109
s_nop 0
v_cvt_pk_bf16_f32 v199, v110, v111
v_cvt_pk_bf16_f32 v215, -v111, v110
v_fmamk_f32 v106, v104, 0x3f000000, v105
v_fract_f32 v106, v106
v_cos_f32 v107, v106
v_sin_f32 v108, v106
s_nop 0
v_cvt_pk_bf16_f32 v200, v107, v108
v_cvt_pk_bf16_f32 v216, -v108, v107
v_fmamk_f32 v109, v104, 0x3f080000, v105
v_fract_f32 v109, v109
v_cos_f32 v110, v109
v_sin_f32 v111, v109
s_nop 0
v_cvt_pk_bf16_f32 v201, v110, v111
v_cvt_pk_bf16_f32 v217, -v111, v110
v_fmamk_f32 v106, v104, 0x3f100000, v105
v_fract_f32 v106, v106
v_cos_f32 v107, v106
v_sin_f32 v108, v106
s_nop 0
v_cvt_pk_bf16_f32 v202, v107, v108
v_cvt_pk_bf16_f32 v218, -v108, v107
v_fmamk_f32 v109, v104, 0x3f180000, v105
v_fract_f32 v109, v109
v_cos_f32 v110, v109
v_sin_f32 v111, v109
s_nop 0
v_cvt_pk_bf16_f32 v203, v110, v111
v_cvt_pk_bf16_f32 v219, -v111, v110
v_fmamk_f32 v106, v104, 0x3f400000, v105
v_fract_f32 v106, v106
v_cos_f32 v107, v106
v_sin_f32 v108, v106
s_nop 0
v_cvt_pk_bf16_f32 v204, v107, v108
v_cvt_pk_bf16_f32 v220, -v108, v107
v_fmamk_f32 v109, v104, 0x3f480000, v105
v_fract_f32 v109, v109
v_cos_f32 v110, v109
v_sin_f32 v111, v109
s_nop 0
v_cvt_pk_bf16_f32 v205, v110, v111
v_cvt_pk_bf16_f32 v221, -v111, v110
v_fmamk_f32 v106, v104, 0x3f500000, v105
v_fract_f32 v106, v106
v_cos_f32 v107, v106
v_sin_f32 v108, v106
s_nop 0
v_cvt_pk_bf16_f32 v206, v107, v108
v_cvt_pk_bf16_f32 v222, -v108, v107
v_fmamk_f32 v109, v104, 0x3f580000, v105
v_fract_f32 v109, v109
v_cos_f32 v110, v109
v_sin_f32 v111, v109
s_nop 0
v_cvt_pk_bf16_f32 v207, v110, v111
v_cvt_pk_bf16_f32 v223, -v111, v110
v_and_b32 v104, 31, v1
v_cvt_f32_u32 v104, v104
v_lshrrev_b32 v105, 5, v1
v_lshlrev_b32 v105, 2, v105
v_cvt_f32_u32 v105, v105
v_mul_f32 v105, v104, v105
v_mul_f32 v105, 0x3a800000, v105
v_fmamk_f32 v106, v104, 0x0, v105
v_cos_f32 v224, v106
v_sin_f32 v240, -v106
v_fmamk_f32 v107, v104, 0x3a800000, v105
v_cos_f32 v225, v107
v_sin_f32 v241, -v107
v_fmamk_f32 v106, v104, 0x3b000000, v105
v_cos_f32 v226, v106
v_sin_f32 v242, -v106
v_fmamk_f32 v107, v104, 0x3b400000, v105
v_cos_f32 v227, v107
v_sin_f32 v243, -v107
v_fmamk_f32 v106, v104, 0x3c000000, v105
v_cos_f32 v228, v106
v_sin_f32 v244, -v106
v_fmamk_f32 v107, v104, 0x3c100000, v105
v_cos_f32 v229, v107
v_sin_f32 v245, -v107
v_fmamk_f32 v106, v104, 0x3c200000, v105
v_cos_f32 v230, v106
v_sin_f32 v246, -v106
v_fmamk_f32 v107, v104, 0x3c300000, v105
v_cos_f32 v231, v107
v_sin_f32 v247, -v107
v_fmamk_f32 v106, v104, 0x3c800000, v105
v_cos_f32 v232, v106
v_sin_f32 v248, -v106
v_fmamk_f32 v107, v104, 0x3c880000, v105
v_cos_f32 v233, v107
v_sin_f32 v249, -v107
v_fmamk_f32 v106, v104, 0x3c900000, v105
v_cos_f32 v234, v106
v_sin_f32 v250, -v106
v_fmamk_f32 v107, v104, 0x3c980000, v105
v_cos_f32 v235, v107
v_sin_f32 v251, -v107
v_fmamk_f32 v106, v104, 0x3cc00000, v105
v_cos_f32 v236, v106
v_sin_f32 v252, -v106
v_fmamk_f32 v107, v104, 0x3cc80000, v105
v_cos_f32 v237, v107
v_sin_f32 v253, -v107
v_fmamk_f32 v106, v104, 0x3cd00000, v105
v_cos_f32 v238, v106
v_sin_f32 v254, -v106
v_fmamk_f32 v107, v104, 0x3cd80000, v105
v_cos_f32 v239, v107
v_sin_f32 v255, -v107
v_and_b32 v104, 31, v1
v_cvt_f32_u32 v104, v104
v_lshrrev_b32 v105, 5, v1
v_lshlrev_b32 v105, 2, v105
v_cvt_f32_u32 v105, v105
v_mul_f32 v104, 0x3a000000, v104
v_fmamk_f32 v105, v105, 0x3c800000, v104
v_add_f32 v106, 0x0, v105
v_cos_f32 v136, v106
v_sin_f32 v152, -v106
v_add_f32 v107, 0x3c800000, v105
v_cos_f32 v137, v107
v_sin_f32 v153, -v107
v_add_f32 v106, 0x3d000000, v105
v_cos_f32 v138, v106
v_sin_f32 v154, -v106
v_add_f32 v107, 0x3d400000, v105
v_cos_f32 v139, v107
v_sin_f32 v155, -v107
v_add_f32 v106, 0x3e000000, v105
v_cos_f32 v140, v106
v_sin_f32 v156, -v106
v_add_f32 v107, 0x3e100000, v105
v_cos_f32 v141, v107
v_sin_f32 v157, -v107
v_add_f32 v106, 0x3e200000, v105
v_cos_f32 v142, v106
v_sin_f32 v158, -v106
v_add_f32 v107, 0x3e300000, v105
v_cos_f32 v143, v107
v_sin_f32 v159, -v107
v_add_f32 v106, 0x3e800000, v105
v_cos_f32 v144, v106
v_sin_f32 v160, -v106
v_add_f32 v107, 0x3e880000, v105
v_cos_f32 v145, v107
v_sin_f32 v161, -v107
v_add_f32 v106, 0x3e900000, v105
v_cos_f32 v146, v106
v_sin_f32 v162, -v106
v_add_f32 v107, 0x3e980000, v105
v_cos_f32 v147, v107
v_sin_f32 v163, -v107
v_add_f32 v106, 0x3ec00000, v105
v_cos_f32 v148, v106
v_sin_f32 v164, -v106
v_add_f32 v107, 0x3ec80000, v105
v_cos_f32 v149, v107
v_sin_f32 v165, -v107
v_add_f32 v106, 0x3ed00000, v105
v_cos_f32 v150, v106
v_sin_f32 v166, -v106
v_add_f32 v107, 0x3ed80000, v105
v_cos_f32 v151, v107
v_sin_f32 v167, -v107
s_add_u32 m0, s25, 32768
s_add_u32 s26, s24, 128
s_and_b32 s26, s26, 0x7ff
buffer_load_dwordx4 v176, s[12:15], s26 offen offset:0 lds
buffer_load_dwordx4 v177, s[12:15], s26 offen offset:1024 lds
buffer_load_dwordx4 v178, s[12:15], s26 offen offset:2048 lds
buffer_load_dwordx4 v179, s[12:15], s26 offen offset:3072 lds
s_add_u32 m0, s25, 49152
s_nop 0
buffer_load_dwordx4 v180, s[20:23], s26 offen offset:0 lds
buffer_load_dwordx4 v181, s[20:23], s26 offen offset:1024 lds
buffer_load_dwordx4 v182, s[20:23], s26 offen offset:2048 lds
buffer_load_dwordx4 v183, s[20:23], s26 offen offset:3072 lds
s_waitcnt vmcnt(8)
s_barrier
s_add_u32 m0, s25, 65536
s_add_u32 s26, s24, 256
s_and_b32 s26, s26, 0x7ff
buffer_load_dwordx4 v176, s[12:15], s26 offen offset:0 lds
buffer_load_dwordx4 v177, s[12:15], s26 offen offset:1024 lds
buffer_load_dwordx4 v178, s[12:15], s26 offen offset:2048 lds
buffer_load_dwordx4 v179, s[12:15], s26 offen offset:3072 lds
s_add_u32 m0, s25, 81920
s_nop 0
buffer_load_dwordx4 v180, s[20:23], s26 offen offset:0 lds
buffer_load_dwordx4 v181, s[20:23], s26 offen offset:1024 lds
buffer_load_dwordx4 v182, s[20:23], s26 offen offset:2048 lds
buffer_load_dwordx4 v183, s[20:23], s26 offen offset:3072 lds
s_add_u32 m0, s68, 16384
s_nop 0
buffer_load_dwordx4 v18, s[48:51], s69 offen nt lds
s_add_u32 m0, s68, 17408
s_nop 0
buffer_load_dwordx4 v18, s[52:55], s69 offen nt lds
s_add_u32 m0, s68, 18432
s_nop 0
buffer_load_dwordx4 v19, s[48:51], s69 offen nt lds
s_add_u32 m0, s68, 19456
s_nop 0
buffer_load_dwordx4 v19, s[52:55], s69 offen nt lds
s_cmp_lg_u32 s66, 3
s_cbranch_scc1 L_nw1
s_mov_b32 exec_hi, 0
buffer_load_ushort v88, v17, s[48:51], 0 offen nt
buffer_load_ushort v89, v17, s[52:55], 0 offen nt
s_mov_b64 exec, -1
L_nw1:
s_waitcnt vmcnt(12)
s_barrier
s_add_u32 m0, s25, 0
s_add_u32 s26, s24, 384
s_and_b32 s26, s26, 0x7ff
buffer_load_dwordx4 v176, s[12:15], s26 offen offset:0 lds
buffer_load_dwordx4 v177, s[12:15], s26 offen offset:1024 lds
buffer_load_dwordx4 v178, s[12:15], s26 offen offset:2048 lds
buffer_load_dwordx4 v179, s[12:15], s26 offen offset:3072 lds
s_add_u32 m0, s25, 16384
s_nop 0
buffer_load_dwordx4 v180, s[20:23], s26 offen offset:0 lds
buffer_load_dwordx4 v181, s[20:23], s26 offen offset:1024 lds
buffer_load_dwordx4 v182, s[20:23], s26 offen offset:2048 lds
buffer_load_dwordx4 v183, s[20:23], s26 offen offset:3072 lds
s_waitcnt vmcnt(12)
s_barrier
s_add_u32 m0, s25, 32768
s_add_u32 s26, s24, 512
s_and_b32 s26, s26, 0x7ff
buffer_load_dwordx4 v176, s[12:15], s26 offen offset:0 lds
buffer_load_dwordx4 v177, s[12:15], s26 offen offset:1024 lds
buffer_load_dwordx4 v178, s[12:15], s26 offen offset:2048 lds
buffer_load_dwordx4 v179, s[12:15], s26 offen offset:3072 lds
s_add_u32 m0, s25, 49152
s_nop 0
buffer_load_dwordx4 v180, s[20:23], s26 offen offset:0 lds
buffer_load_dwordx4 v181, s[20:23], s26 offen offset:1024 lds
buffer_load_dwordx4 v182, s[20:23], s26 offen offset:2048 lds
buffer_load_dwordx4 v183, s[20:23], s26 offen offset:3072 lds
s_add_u32 m0, s68, 0
s_mov_b32 s92, 0
buffer_load_dwordx4 v2, s[4:7], s92 offen offset:0 nt lds
buffer_load_dwordx4 v2, s[4:7], s92 offen offset:1024 nt lds
s_add_u32 m0, s68, 2048
s_mov_b32 s92, 2048
buffer_load_dwordx4 v3, s[4:7], s92 offen offset:0 nt lds
buffer_load_dwordx4 v3, s[4:7], s92 offen offset:1024 nt lds
s_waitcnt vmcnt(12)
s_barrier
s_add_u32 m0, s25, 65536
s_add_u32 s26, s24, 640
s_and_b32 s26, s26, 0x7ff
buffer_load_dwordx4 v176, s[12:15], s26 offen offset:0 lds
buffer_load_dwordx4 v177, s[12:15], s26 offen offset:1024 lds
buffer_load_dwordx4 v178, s[12:15], s26 offen offset:2048 lds
buffer_load_dwordx4 v179, s[12:15], s26 offen offset:3072 lds
s_add_u32 m0, s25, 81920
s_nop 0
buffer_load_dwordx4 v180, s[20:23], s26 offen offset:0 lds
buffer_load_dwordx4 v181, s[20:23], s26 offen offset:1024 lds
buffer_load_dwordx4 v182, s[20:23], s26 offen offset:2048 lds
buffer_load_dwordx4 v183, s[20:23], s26 offen offset:3072 lds
ds_read_b64 v[104:105], v16 offset:0
ds_read_b64 v[106:107], v16 offset:256
ds_read_b64 v[108:109], v16 offset:512
ds_read_b64 v[110:111], v16 offset:768
ds_read_b64 v[112:113], v16 offset:1024
ds_read_b64 v[114:115], v16 offset:1280
ds_read_b64 v[116:117], v16 offset:1536
ds_read_b64 v[118:119], v16 offset:1792
s_mov_b32 s64, 0x05040100
s_mov_b32 s65, 0x07060302
v_lshlrev_b32 v88, 16, v88
v_lshlrev_b32 v89, 16, v89
v_lshlrev_b32 v9, 1, v1
v_add_f32_dpp v90, v88, v88 quad_perm:[1,0,3,2] row_mask:0xf bank_mask:0xf
v_subrev_f32_dpp v91, v89, v89 quad_perm:[1,0,3,2] row_mask:0xf bank_mask:0xf
v_mul_f32 v90, 0.5, v90
v_mul_f32 v91, 0.5, v91
v_cvt_pk_bf16_f32 v88, v90, v91
s_waitcnt lgkmcnt(0)
v_perm_b32 v120, v112, v104, s64
v_perm_b32 v121, v116, v108, s64
v_perm_b32 v122, v114, v106, s64
v_perm_b32 v123, v118, v110, s64
v_perm_b32 v124, v112, v104, s65
v_perm_b32 v125, v116, v108, s65
v_perm_b32 v126, v114, v106, s65
v_perm_b32 v127, v118, v110, s65
v_perm_b32 v128, v113, v105, s64
v_perm_b32 v129, v117, v109, s64
v_perm_b32 v130, v115, v107, s64
v_perm_b32 v131, v119, v111, s64
v_perm_b32 v132, v113, v105, s65
v_perm_b32 v133, v117, v109, s65
v_perm_b32 v134, v115, v107, s65
v_perm_b32 v135, v119, v111, s65
s_waitcnt vmcnt(12)
s_barrier
s_add_u32 m0, s25, 0
s_add_u32 s26, s24, 768
s_and_b32 s26, s26, 0x7ff
buffer_load_dwordx4 v176, s[12:15], s26 offen offset:0 lds
buffer_load_dwordx4 v177, s[12:15], s26 offen offset:1024 lds
buffer_load_dwordx4 v178, s[12:15], s26 offen offset:2048 lds
buffer_load_dwordx4 v179, s[12:15], s26 offen offset:3072 lds
s_add_u32 m0, s25, 16384
s_nop 0
buffer_load_dwordx4 v180, s[20:23], s26 offen offset:0 lds
buffer_load_dwordx4 v181, s[20:23], s26 offen offset:1024 lds
buffer_load_dwordx4 v182, s[20:23], s26 offen offset:2048 lds
buffer_load_dwordx4 v183, s[20:23], s26 offen offset:3072 lds
s_waitcnt vmcnt(8)
s_barrier
s_add_u32 m0, s25, 32768
s_add_u32 s26, s24, 896
s_and_b32 s26, s26, 0x7ff
buffer_load_dwordx4 v176, s[12:15], s26 offen offset:0 lds
buffer_load_dwordx4 v177, s[12:15], s26 offen offset:1024 lds
buffer_load_dwordx4 v178, s[12:15], s26 offen offset:2048 lds
buffer_load_dwordx4 v179, s[12:15], s26 offen offset:3072 lds
s_add_u32 m0, s25, 49152
s_nop 0
buffer_load_dwordx4 v180, s[20:23], s26 offen offset:0 lds
buffer_load_dwordx4 v181, s[20:23], s26 offen offset:1024 lds
buffer_load_dwordx4 v182, s[20:23], s26 offen offset:2048 lds
buffer_load_dwordx4 v183, s[20:23], s26 offen offset:3072 lds
s_waitcnt vmcnt(8)
s_barrier
s_add_u32 m0, s25, 65536
s_add_u32 s26, s24, 1024
s_and_b32 s26, s26, 0x7ff
buffer_load_dwordx4 v176, s[12:15], s26 offen offset:0 lds
buffer_load_dwordx4 v177, s[12:15], s26 offen offset:1024 lds
buffer_load_dwordx4 v178, s[12:15], s26 offen offset:2048 lds
buffer_load_dwordx4 v179, s[12:15], s26 offen offset:3072 lds
s_add_u32 m0, s25, 81920
s_nop 0
buffer_load_dwordx4 v180, s[20:23], s26 offen offset:0 lds
buffer_load_dwordx4 v181, s[20:23], s26 offen offset:1024 lds
buffer_load_dwordx4 v182, s[20:23], s26 offen offset:2048 lds
buffer_load_dwordx4 v183, s[20:23], s26 offen offset:3072 lds
s_waitcnt vmcnt(8)
s_barrier
s_add_u32 m0, s25, 0
s_add_u32 s26, s24, 1152
s_and_b32 s26, s26, 0x7ff
buffer_load_dwordx4 v176, s[12:15], s26 offen offset:0 lds
buffer_load_dwordx4 v177, s[12:15], s26 offen offset:1024 lds
buffer_load_dwordx4 v178, s[12:15], s26 offen offset:2048 lds
buffer_load_dwordx4 v179, s[12:15], s26 offen offset:3072 lds
s_add_u32 m0, s25, 16384
s_nop 0
buffer_load_dwordx4 v180, s[20:23], s26 offen offset:0 lds
buffer_load_dwordx4 v181, s[20:23], s26 offen offset:1024 lds
buffer_load_dwordx4 v182, s[20:23], s26 offen offset:2048 lds
buffer_load_dwordx4 v183, s[20:23], s26 offen offset:3072 lds
v_mov_b32 v20, 0
global_load_dword v21, v20, s[30:31] sc1
s_waitcnt vmcnt(9)
s_barrier
s_add_u32 m0, s25, 32768
s_add_u32 s26, s24, 1280
s_and_b32 s26, s26, 0x7ff
buffer_load_dwordx4 v176, s[12:15], s26 offen offset:0 lds
buffer_load_dwordx4 v177, s[12:15], s26 offen offset:1024 lds
buffer_load_dwordx4 v178, s[12:15], s26 offen offset:2048 lds
buffer_load_dwordx4 v179, s[12:15], s26 offen offset:3072 lds
s_add_u32 m0, s25, 49152
s_nop 0
buffer_load_dwordx4 v180, s[20:23], s26 offen offset:0 lds
buffer_load_dwordx4 v181, s[20:23], s26 offen offset:1024 lds
buffer_load_dwordx4 v182, s[20:23], s26 offen offset:2048 lds
buffer_load_dwordx4 v183, s[20:23], s26 offen offset:3072 lds
s_waitcnt vmcnt(9)
s_barrier
s_add_u32 m0, s25, 65536
s_add_u32 s26, s24, 1408
s_and_b32 s26, s26, 0x7ff
buffer_load_dwordx4 v176, s[12:15], s26 offen offset:0 lds
buffer_load_dwordx4 v177, s[12:15], s26 offen offset:1024 lds
buffer_load_dwordx4 v178, s[12:15], s26 offen offset:2048 lds
buffer_load_dwordx4 v179, s[12:15], s26 offen offset:3072 lds
s_add_u32 m0, s25, 81920
s_nop 0
buffer_load_dwordx4 v180, s[20:23], s26 offen offset:0 lds
buffer_load_dwordx4 v181, s[20:23], s26 offen offset:1024 lds
buffer_load_dwordx4 v182, s[20:23], s26 offen offset:2048 lds
buffer_load_dwordx4 v183, s[20:23], s26 offen offset:3072 lds
s_cmp_lg_u32 s66, 3
s_cbranch_scc1 L_nw2
s_lshr_b32 s64, s2, 7
s_mul_i32 s64, s64, 8192
s_bfe_u32 s65, s2, 0x10006
s_mul_i32 s65, s65, 4096
s_add_u32 s64, s64, s65
s_and_b32 s65, s2, 63
s_lshl_b32 s65, s65, 6
s_add_u32 s64, s64, s65
s_add_u32 s54, s64, 25165824
s_add_u32 s52, s32, s54
s_addc_u32 s53, s33, 0
s_mov_b32 s54, 64
s_mov_b32 s55, 0x20000
s_mov_b32 exec_lo, 0x55555555
s_mov_b32 exec_hi, 0
buffer_store_dword v88, v9, s[52:55], 0 offen sc1
s_mov_b64 exec, -1
L_nw2:
s_mov_b32 s92, 0
buffer_store_dwordx4 v[120:123], v15, s[56:59], s92 offen sc1
s_mov_b32 s92, 8192
buffer_store_dwordx4 v[124:127], v15, s[56:59], s92 offen sc1
s_mov_b32 s92, 16384
buffer_store_dwordx4 v[128:131], v15, s[56:59], s92 offen sc1
s_mov_b32 s92, 24576
buffer_store_dwordx4 v[132:135], v15, s[56:59], s92 offen sc1
s_waitcnt vmcnt(12)
s_barrier
s_add_u32 m0, s25, 0
s_add_u32 s26, s24, 1536
s_and_b32 s26, s26, 0x7ff
buffer_load_dwordx4 v176, s[12:15], s26 offen offset:0 lds
buffer_load_dwordx4 v177, s[12:15], s26 offen offset:1024 lds
buffer_load_dwordx4 v178, s[12:15], s26 offen offset:2048 lds
buffer_load_dwordx4 v179, s[12:15], s26 offen offset:3072 lds
s_add_u32 m0, s25, 16384
s_nop 0
buffer_load_dwordx4 v180, s[20:23], s26 offen offset:0 lds
buffer_load_dwordx4 v181, s[20:23], s26 offen offset:1024 lds
buffer_load_dwordx4 v182, s[20:23], s26 offen offset:2048 lds
buffer_load_dwordx4 v183, s[20:23], s26 offen offset:3072 lds
s_waitcnt vmcnt(12)
s_barrier
s_add_u32 m0, s25, 32768
s_add_u32 s26, s24, 1664
s_and_b32 s26, s26, 0x7ff
buffer_load_dwordx4 v176, s[12:15], s26 offen offset:0 lds
buffer_load_dwordx4 v177, s[12:15], s26 offen offset:1024 lds
buffer_load_dwordx4 v178, s[12:15], s26 offen offset:2048 lds
buffer_load_dwordx4 v179, s[12:15], s26 offen offset:3072 lds
s_add_u32 m0, s25, 49152
s_nop 0
buffer_load_dwordx4 v180, s[20:23], s26 offen offset:0 lds
buffer_load_dwordx4 v181, s[20:23], s26 offen offset:1024 lds
buffer_load_dwordx4 v182, s[20:23], s26 offen offset:2048 lds
buffer_load_dwordx4 v183, s[20:23], s26 offen offset:3072 lds
s_waitcnt vmcnt(8)
s_barrier
s_add_u32 m0, s25, 65536
s_add_u32 s26, s24, 1792
s_and_b32 s26, s26, 0x7ff
buffer_load_dwordx4 v176, s[12:15], s26 offen offset:0 lds
buffer_load_dwordx4 v177, s[12:15], s26 offen offset:1024 lds
buffer_load_dwordx4 v178, s[12:15], s26 offen offset:2048 lds
buffer_load_dwordx4 v179, s[12:15], s26 offen offset:3072 lds
s_add_u32 m0, s25, 81920
s_nop 0
buffer_load_dwordx4 v180, s[20:23], s26 offen offset:0 lds
buffer_load_dwordx4 v181, s[20:23], s26 offen offset:1024 lds
buffer_load_dwordx4 v182, s[20:23], s26 offen offset:2048 lds
buffer_load_dwordx4 v183, s[20:23], s26 offen offset:3072 lds
s_waitcnt vmcnt(8)
s_barrier
s_add_u32 m0, s25, 0
s_add_u32 s26, s24, 1920
s_and_b32 s26, s26, 0x7ff
buffer_load_dwordx4 v176, s[12:15], s26 offen offset:0 lds
buffer_load_dwordx4 v177, s[12:15], s26 offen offset:1024 lds
buffer_load_dwordx4 v178, s[12:15], s26 offen offset:2048 lds
buffer_load_dwordx4 v179, s[12:15], s26 offen offset:3072 lds
s_add_u32 m0, s25, 16384
s_nop 0
buffer_load_dwordx4 v180, s[20:23], s26 offen offset:0 lds
buffer_load_dwordx4 v181, s[20:23], s26 offen offset:1024 lds
buffer_load_dwordx4 v182, s[20:23], s26 offen offset:2048 lds
buffer_load_dwordx4 v183, s[20:23], s26 offen offset:3072 lds
s_and_b32 s26, s2, 1
s_lshl_b32 s26, s26, 10
s_bfe_u32 s92, s2, 0x20001
s_lshl_b32 s92, s92, 19
s_add_u32 s26, s26, s92
s_lshr_b32 s92, s2, 3
s_lshl_b32 s92, s92, 14
s_add_u32 s26, s26, s92
s_lshr_b32 s92, s66, 1
s_lshl_b32 s92, s92, 13
s_add_u32 s26, s26, s92
v_bfe_u32 v22, v1, 3, 2
v_lshlrev_b32 v22, 11, v22
v_and_b32 v23, 7, v1
v_lshl_add_u32 v22, v23, 7, v22
v_add_u32 v22, s26, v22
s_mov_b32 exec_hi, 0
global_load_dword v23, v22, s[100:101]
s_mov_b64 exec, -1
s_waitcnt vmcnt(9)
s_barrier
s_waitcnt vmcnt(1)
s_barrier
s_barrier
s_barrier
s_setprio 3
v_readfirstlane_b32 s37, v21
s_nop 0
s_cmp_lg_u32 s37, 0
s_cbranch_scc1 L_sg3
v_mov_b32 v20, 0
L_n4:
global_load_dword v21, v20, s[30:31] sc1
s_waitcnt vmcnt(0)
v_readfirstlane_b32 s37, v21
s_nop 0
s_cmp_eq_u32 s37, 0
s_cbranch_scc1 L_n4
L_sg3:
s_waitcnt vmcnt(63)
ds_read_b64_tr_b16 v[24:25], v12 offset:0
ds_read_b64_tr_b16 v[26:27], v13 offset:0
ds_read_b64_tr_b16 v[28:29], v12 offset:512
ds_read_b64_tr_b16 v[30:31], v13 offset:512
ds_read_b64_tr_b16 v[32:33], v12 offset:1024
ds_read_b64_tr_b16 v[34:35], v13 offset:1024
ds_read_b64_tr_b16 v[36:37], v12 offset:1536
ds_read_b64_tr_b16 v[38:39], v13 offset:1536
s_waitcnt lgkmcnt(0)
v_mfma_f32_32x32x16_bf16 v[40:55], v[24:27], v[192:195], 0
v_mfma_f32_32x32x16_bf16 v[40:55], v[28:31], v[196:199], v[40:55]
v_mfma_f32_32x32x16_bf16 v[40:55], v[32:35], v[200:203], v[40:55]
v_mfma_f32_32x32x16_bf16 v[40:55], v[36:39], v[204:207], v[40:55]
v_mfma_f32_32x32x16_bf16 v[56:71], v[24:27], v[208:211], 0
v_mfma_f32_32x32x16_bf16 v[56:71], v[28:31], v[212:215], v[56:71]
v_mfma_f32_32x32x16_bf16 v[56:71], v[32:35], v[216:219], v[56:71]
v_mfma_f32_32x32x16_bf16 v[56:71], v[36:39], v[220:223], v[56:71]
s_nop 7
v_mul_f32 v168, v40, v224
v_mul_f32 v169, v40, v240
s_nop 1
v_fma_f32 v168, -v56, v240, v168
v_fmac_f32 v169, v56, v224
v_cvt_pk_bf16_f32 v72, v168, v169
v_mul_f32 v170, v41, v225
v_mul_f32 v171, v41, v241
v_fma_f32 v170, -v57, v241, v170
v_fmac_f32 v171, v57, v225
v_cvt_pk_bf16_f32 v73, v170, v171
v_mul_f32 v172, v42, v226
v_mul_f32 v173, v42, v242
v_fma_f32 v172, -v58, v242, v172
v_fmac_f32 v173, v58, v226
v_cvt_pk_bf16_f32 v74, v172, v173
v_mul_f32 v174, v43, v227
v_mul_f32 v175, v43, v243
v_fma_f32 v174, -v59, v243, v174
v_fmac_f32 v175, v59, v227
v_cvt_pk_bf16_f32 v75, v174, v175
v_mul_f32 v168, v44, v228
v_mul_f32 v169, v44, v244
v_fma_f32 v168, -v60, v244, v168
v_fmac_f32 v169, v60, v228
v_cvt_pk_bf16_f32 v76, v168, v169
v_mul_f32 v170, v45, v229
v_mul_f32 v171, v45, v245
v_fma_f32 v170, -v61, v245, v170
v_fmac_f32 v171, v61, v229
v_cvt_pk_bf16_f32 v77, v170, v171
v_mul_f32 v172, v46, v230
v_mul_f32 v173, v46, v246
v_fma_f32 v172, -v62, v246, v172
v_fmac_f32 v173, v62, v230
v_cvt_pk_bf16_f32 v78, v172, v173
v_mul_f32 v174, v47, v231
v_mul_f32 v175, v47, v247
v_fma_f32 v174, -v63, v247, v174
v_fmac_f32 v175, v63, v231
v_cvt_pk_bf16_f32 v79, v174, v175
v_mul_f32 v168, v48, v232
v_mul_f32 v169, v48, v248
v_fma_f32 v168, -v64, v248, v168
v_fmac_f32 v169, v64, v232
v_cvt_pk_bf16_f32 v80, v168, v169
v_mul_f32 v170, v49, v233
v_mul_f32 v171, v49, v249
v_fma_f32 v170, -v65, v249, v170
v_fmac_f32 v171, v65, v233
v_cvt_pk_bf16_f32 v81, v170, v171
v_mul_f32 v172, v50, v234
v_mul_f32 v173, v50, v250
v_fma_f32 v172, -v66, v250, v172
v_fmac_f32 v173, v66, v234
v_cvt_pk_bf16_f32 v82, v172, v173
v_mul_f32 v174, v51, v235
v_mul_f32 v175, v51, v251
v_fma_f32 v174, -v67, v251, v174
v_fmac_f32 v175, v67, v235
v_cvt_pk_bf16_f32 v83, v174, v175
v_mul_f32 v168, v52, v236
v_mul_f32 v169, v52, v252
v_fma_f32 v168, -v68, v252, v168
v_fmac_f32 v169, v68, v236
v_cvt_pk_bf16_f32 v84, v168, v169
v_mul_f32 v170, v53, v237
v_mul_f32 v171, v53, v253
v_fma_f32 v170, -v69, v253, v170
v_fmac_f32 v171, v69, v237
v_cvt_pk_bf16_f32 v85, v170, v171
v_mul_f32 v172, v54, v238
v_mul_f32 v173, v54, v254
v_fma_f32 v172, -v70, v254, v172
v_fmac_f32 v173, v70, v238
v_cvt_pk_bf16_f32 v86, v172, v173
v_mul_f32 v174, v55, v239
v_mul_f32 v175, v55, v255
v_fma_f32 v174, -v71, v255, v174
v_fmac_f32 v175, v71, v239
v_cvt_pk_bf16_f32 v87, v174, v175
v_mfma_f32_32x32x16_bf16 v[40:55], v[192:195], v[72:75], 0
v_mfma_f32_32x32x16_bf16 v[40:55], v[196:199], v[76:79], v[40:55]
v_mfma_f32_32x32x16_bf16 v[40:55], v[200:203], v[80:83], v[40:55]
v_mfma_f32_32x32x16_bf16 v[40:55], v[204:207], v[84:87], v[40:55]
v_mfma_f32_32x32x16_bf16 v[56:71], v[208:211], v[72:75], 0
v_mfma_f32_32x32x16_bf16 v[56:71], v[212:215], v[76:79], v[56:71]
v_mfma_f32_32x32x16_bf16 v[56:71], v[216:219], v[80:83], v[56:71]
v_mfma_f32_32x32x16_bf16 v[56:71], v[220:223], v[84:87], v[56:71]
s_lshl_b32 s92, s66, 12
s_add_u32 s92, s92, 98304
v_add_u32 v8, s92, v7
s_nop 8
v_cvt_pk_bf16_f32 v72, v40, v56
ds_write_b32 v4, v72 offset:0
v_cvt_pk_bf16_f32 v73, v41, v57
ds_write_b32 v4, v73 offset:1024
v_cvt_pk_bf16_f32 v74, v42, v58
ds_write_b32 v4, v74 offset:2048
v_cvt_pk_bf16_f32 v75, v43, v59
ds_write_b32 v4, v75 offset:3072
v_cvt_pk_bf16_f32 v76, v44, v60
ds_write_b32 v4, v76 offset:8192
v_cvt_pk_bf16_f32 v77, v45, v61
ds_write_b32 v4, v77 offset:9216
v_cvt_pk_bf16_f32 v78, v46, v62
ds_write_b32 v4, v78 offset:10240
v_cvt_pk_bf16_f32 v79, v47, v63
ds_write_b32 v4, v79 offset:11264
v_cvt_pk_bf16_f32 v80, v48, v64
ds_write_b32 v6, v80 offset:0
v_cvt_pk_bf16_f32 v81, v49, v65
ds_write_b32 v5, v81 offset:10240
v_cvt_pk_bf16_f32 v82, v50, v66
ds_write_b32 v5, v82 offset:9216
v_cvt_pk_bf16_f32 v83, v51, v67
ds_write_b32 v5, v83 offset:8192
v_cvt_pk_bf16_f32 v84, v52, v68
ds_write_b32 v5, v84 offset:3072
v_cvt_pk_bf16_f32 v85, v53, v69
ds_write_b32 v5, v85 offset:2048
v_cvt_pk_bf16_f32 v86, v54, v70
ds_write_b32 v5, v86 offset:1024
v_cvt_pk_bf16_f32 v87, v55, v71
ds_write_b32 v5, v87 offset:0
s_waitcnt lgkmcnt(0)
v_mov_b32 v190, 1
s_mov_b64 exec, 1
ds_write_b32 v185, v190
s_mov_b64 exec, -1
L_lc6:
ds_read_b128 v[186:189], v184
s_waitcnt lgkmcnt(0)
v_min3_u32 v186, v186, v187, v188
v_min_u32 v186, v186, v189
s_nop 0
v_readfirstlane_b32 s92, v186
s_nop 0
s_cmp_ge_u32 s92, 1
s_cbranch_scc1 L_lcd7
s_sleep 1
s_branch L_lc6
L_lcd7:
ds_read_b128 v[72:75], v8 offset:0
ds_read_b128 v[76:79], v8 offset:1024
ds_read_b128 v[80:83], v8 offset:2048
ds_read_b128 v[84:87], v8 offset:3072
v_add_u32 v4, 32768, v4
v_add_u32 v5, 32768, v5
v_add_u32 v6, 32768, v6
s_waitcnt lgkmcnt(0)
v_mov_b32 v190, 2
s_mov_b64 exec, 1
ds_write_b32 v185, v190
s_mov_b64 exec, -1
buffer_store_dwordx4 v[72:75], v2, s[40:43], 0 offen offset:0 sc1
buffer_store_dwordx4 v[76:79], v2, s[40:43], 0 offen offset:1024 sc1
buffer_store_dwordx4 v[80:83], v2, s[40:43], 0 offen offset:2048 sc1
buffer_store_dwordx4 v[84:87], v2, s[40:43], 0 offen offset:3072 sc1
s_and_b32 s60, s2, 7
s_lshl_b32 s60, s60, 5
s_lshr_b32 s64, s2, 3
s_add_u32 s60, s60, s64
s_lshr_b32 s64, s66, 1
s_xor_b32 s64, s64, s66
s_and_b32 s64, s64, 1
s_or_b32 s65, s64, s60
s_cmp_eq_u32 s65, 0
s_cselect_b32 s61, 1, 0
s_lshl_b32 s65, s60, 1
s_add_u32 s64, s64, s65
s_mul_i32 s64, s64, 8192
s_add_u32 s64, s64, 25182208
s_lshr_b32 s65, s66, 1
s_mul_i32 s69, s65, 8192
s_add_u32 s69, s69, 25165824
s_cmp_eq_u32 s61, 1
s_cselect_b32 s64, s69, s64
s_cselect_b32 s65, 0, s65
s_cselect_b32 s90, s32, s32
s_cselect_b32 s91, s33, s33
s_lshl_b32 s62, s65, 31
s_or_b32 s63, s62, 0x3f800000
s_add_u32 s48, s90, s64
s_addc_u32 s49, s91, 0
s_mov_b32 s50, 8192
s_mov_b32 s51, 0x20000
s_lshl_b32 s64, s66, 20
s_lshl_b32 s65, s60, 6
s_add_u32 s64, s64, s65
s_add_u32 s54, s64, 16777216
s_add_u32 s52, s32, s54
s_addc_u32 s53, s33, 0
s_sub_u32 s54, 1048576, s65
s_mov_b32 s55, 0x20000
s_add_u32 s58, s64, 16777216
s_add_u32 s56, s32, s58
s_addc_u32 s57, s33, 0
s_sub_u32 s58, 1048576, s65
s_mov_b32 s59, 0x20000
v_lshrrev_b32 v8, 2, v1
v_lshlrev_b32 v8, 14, v8
v_and_b32 v9, 3, v1
v_lshrrev_b32 v10, 4, v1
v_xor_b32 v9, v9, v10
v_lshl_add_u32 v14, v9, 4, v8
v_and_b32 v8, 31, v1
v_bfe_u32 v9, v1, 2, 2
v_xor_b32 v9, s66, v9
v_lshlrev_b32 v9, 4, v9
v_lshl_add_u32 v9, v8, 6, v9
v_lshrrev_b32 v8, 5, v1
v_lshl_add_u32 v9, v8, 11, v9
v_add_u32 v15, 131072, v9
s_lshl_b32 s64, s66, 13
s_add_u32 s64, s64, 131072
v_add_u32 v16, s64, v2
s_xor_b32 s65, s64, 24576
s_cmp_eq_u32 s61, 1
s_cselect_b32 s65, s64, s65
v_add_u32 v17, s65, v2
v_add_u32 v18, s68, v2
v_mul_f32 v136, s63, v136
v_mul_f32 v137, s63, v137
v_mul_f32 v138, s63, v138
v_mul_f32 v139, s63, v139
v_mul_f32 v140, s63, v140
v_mul_f32 v141, s63, v141
v_mul_f32 v142, s63, v142
v_mul_f32 v143, s63, v143
v_mul_f32 v144, s63, v144
v_mul_f32 v145, s63, v145
v_mul_f32 v146, s63, v146
v_mul_f32 v147, s63, v147
v_mul_f32 v148, s63, v148
v_mul_f32 v149, s63, v149
v_mul_f32 v150, s63, v150
v_mul_f32 v151, s63, v151
v_mul_f32 v152, s63, v152
v_mul_f32 v153, s63, v153
v_mul_f32 v154, s63, v154
v_mul_f32 v155, s63, v155
v_mul_f32 v156, s63, v156
v_mul_f32 v157, s63, v157
v_mul_f32 v158, s63, v158
v_mul_f32 v159, s63, v159
v_mul_f32 v160, s63, v160
v_mul_f32 v161, s63, v161
v_mul_f32 v162, s63, v162
v_mul_f32 v163, s63, v163
v_mul_f32 v164, s63, v164
v_mul_f32 v165, s63, v165
v_mul_f32 v166, s63, v166
v_mul_f32 v167, s63, v167
s_waitcnt vmcnt(0)
v_mov_b32 v190, 3
s_mov_b64 exec, 1
ds_write_b32 v185, v190
s_mov_b64 exec, -1
s_cmp_lg_u32 s66, 0
s_cbranch_scc1 L_ph8
L_lc9:
ds_read_b128 v[186:189], v184
s_waitcnt lgkmcnt(0)
v_min3_u32 v186, v186, v187, v188
v_min_u32 v186, v186, v189
s_nop 0
v_readfirstlane_b32 s92, v186
s_nop 0
s_cmp_ge_u32 s92, 3
s_cbranch_scc1 L_lcd10
s_sleep 1
s_branch L_lc9
L_lcd10:
s_and_b32 s64, s2, 15
s_lshl_b32 s65, s64, 7
s_add_u32 s65, s65, 4096
s_add_u32 s90, s32, s65
s_addc_u32 s91, s33, 0
s_mov_b32 s65, 1
s_atomic_add s65, s[90:91], 0x0 glc
s_lshl_b32 s64, s64, 2
s_add_u32 s64, s64, 540672
v_lshl_add_u32 v20, v1, 7, s64
v_mov_b32 v21, s37
s_add_u32 s4, s32, s64
s_addc_u32 s5, s33, 0
s_and_b32 s64, s2, 31
s_lshl_b32 s64, s64, 7
s_add_u32 s64, s64, 540672
s_waitcnt lgkmcnt(0)
s_cmp_lg_u32 s65, 15
s_cbranch_scc1 L_sg11
s_atomic_swap s37, s[4:5], 0x0
s_atomic_swap s37, s[4:5], 0x80
s_atomic_swap s37, s[4:5], 0x100
s_atomic_swap s37, s[4:5], 0x180
s_atomic_swap s37, s[4:5], 0x200
s_atomic_swap s37, s[4:5], 0x280
s_atomic_swap s37, s[4:5], 0x300
s_atomic_swap s37, s[4:5], 0x380
s_atomic_swap s37, s[4:5], 0x400
s_atomic_swap s37, s[4:5], 0x480
s_atomic_swap s37, s[4:5], 0x500
s_atomic_swap s37, s[4:5], 0x580
s_atomic_swap s37, s[4:5], 0x600
s_atomic_swap s37, s[4:5], 0x680
s_atomic_swap s37, s[4:5], 0x700
s_atomic_swap s37, s[4:5], 0x780
s_atomic_swap s37, s[4:5], 0x800
s_atomic_swap s37, s[4:5], 0x880
s_atomic_swap s37, s[4:5], 0x900
s_atomic_swap s37, s[4:5], 0x980
s_atomic_swap s37, s[4:5], 0xa00
s_atomic_swap s37, s[4:5], 0xa80
s_atomic_swap s37, s[4:5], 0xb00
s_atomic_swap s37, s[4:5], 0xb80
s_atomic_swap s37, s[4:5], 0xc00
s_atomic_swap s37, s[4:5], 0xc80
s_atomic_swap s37, s[4:5], 0xd00
s_atomic_swap s37, s[4:5], 0xd80
s_atomic_swap s37, s[4:5], 0xe00
s_atomic_swap s37, s[4:5], 0xe80
s_atomic_swap s37, s[4:5], 0xf00
s_atomic_swap s37, s[4:5], 0xf80
s_waitcnt lgkmcnt(0)
L_sg11:
s_add_u32 s90, s32, s64
s_addc_u32 s91, s33, 0
s_mov_b32 s64, s37
s_mov_b32 s65, s37
s_mov_b32 s92, 0
s_branch L_sp12
L_nok13:
s_add_u32 s92, s92, 1
s_cmp_ge_u32 s92, 200000
s_cbranch_scc1 L_ph8
s_sleep 6
L_sp12:
s_load_dwordx16 s[4:19], s[90:91], 0x0 glc
s_waitcnt lgkmcnt(0)
s_cmp_eq_u64 s[4:5], s[64:65]
s_cbranch_scc0 L_nok13
s_cmp_eq_u64 s[6:7], s[64:65]
s_cbranch_scc0 L_nok13
s_cmp_eq_u64 s[8:9], s[64:65]
s_cbranch_scc0 L_nok13
s_cmp_eq_u64 s[10:11], s[64:65]
s_cbranch_scc0 L_nok13
s_cmp_eq_u64 s[12:13], s[64:65]
s_cbranch_scc0 L_nok13
s_cmp_eq_u64 s[14:15], s[64:65]
s_cbranch_scc0 L_nok13
s_cmp_eq_u64 s[16:17], s[64:65]
s_cbranch_scc0 L_nok13
s_cmp_eq_u64 s[18:19], s[64:65]
s_cbranch_scc0 L_nok13
L_ph8:
v_mov_b32 v190, 4
s_mov_b64 exec, 1
ds_write_b32 v185, v190
s_mov_b64 exec, -1
L_lc14:
ds_read_b128 v[186:189], v184
s_waitcnt lgkmcnt(0)
v_min3_u32 v186, v186, v187, v188
v_min_u32 v186, v186, v189
s_nop 0
v_readfirstlane_b32 s92, v186
s_nop 0
s_cmp_ge_u32 s92, 4
s_cbranch_scc1 L_lcd15
s_sleep 1
s_branch L_lc14
L_lcd15:
s_setprio 3
s_add_u32 m0, s68, 0
s_mov_b32 s64, 0
buffer_load_dwordx4 v14, s[52:55], s64 offen sc1 lds
s_add_u32 m0, s68, 1024
s_mov_b32 s64, 262144
buffer_load_dwordx4 v14, s[52:55], s64 offen sc1 lds
s_add_u32 m0, s68, 2048
s_mov_b32 s64, 524288
buffer_load_dwordx4 v14, s[52:55], s64 offen sc1 lds
s_add_u32 m0, s68, 3072
s_mov_b32 s64, 786432
buffer_load_dwordx4 v14, s[52:55], s64 offen sc1 lds
s_movk_i32 s64, 4096
buffer_load_dwordx4 v[104:107], v2, s[48:51], 0 offen offset:0 sc1
buffer_load_dwordx4 v[108:111], v2, s[48:51], 0 offen offset:1024 sc1
buffer_load_dwordx4 v[112:115], v2, s[48:51], 0 offen offset:2048 sc1
buffer_load_dwordx4 v[116:119], v2, s[48:51], 0 offen offset:3072 sc1
buffer_load_dwordx4 v[120:123], v2, s[48:51], s64 offen offset:0 sc1
buffer_load_dwordx4 v[124:127], v2, s[48:51], s64 offen offset:1024 sc1
buffer_load_dwordx4 v[128:131], v2, s[48:51], s64 offen offset:2048 sc1
buffer_load_dwordx4 v[132:135], v2, s[48:51], s64 offen offset:3072 sc1
s_waitcnt vmcnt(8)
v_mov_b32 v190, 5
s_mov_b64 exec, 1
ds_write_b32 v185, v190
s_mov_b64 exec, -1
L_lc16:
ds_read_b128 v[186:189], v184
s_waitcnt lgkmcnt(0)
v_min3_u32 v186, v186, v187, v188
v_min_u32 v186, v186, v189
s_nop 0
v_readfirstlane_b32 s92, v186
s_nop 0
s_cmp_ge_u32 s92, 5
s_cbranch_scc1 L_lcd17
s_sleep 1
s_branch L_lc16
L_lcd17:
ds_read_b128 v[72:75], v15 offset:0
ds_read_b128 v[76:79], v15 offset:4096
ds_read_b128 v[80:83], v15 offset:8192
ds_read_b128 v[84:87], v15 offset:12288
s_waitcnt lgkmcnt(0)
v_mov_b32 v190, 6
s_mov_b64 exec, 1
ds_write_b32 v185, v190
s_mov_b64 exec, -1
s_lshl_b32 s64, s61, 31
s_or_b32 s64, s64, s62
L_fft18:
v_xor_b32 v24, s64, v72
v_xor_b32 v25, s64, v73
v_xor_b32 v26, s64, v74
v_xor_b32 v27, s64, v75
v_xor_b32 v28, s64, v76
v_xor_b32 v29, s64, v77
v_xor_b32 v30, s64, v78
v_xor_b32 v31, s64, v79
v_xor_b32 v32, s64, v80
v_xor_b32 v33, s64, v81
v_xor_b32 v34, s64, v82
v_xor_b32 v35, s64, v83
v_xor_b32 v36, s64, v84
v_xor_b32 v37, s64, v85
v_xor_b32 v38, s64, v86
v_xor_b32 v39, s64, v87
v_mfma_f32_32x32x16_bf16 v[40:55], v[24:27], v[192:195], 0
v_mfma_f32_32x32x16_bf16 v[40:55], v[28:31], v[196:199], v[40:55]
v_mfma_f32_32x32x16_bf16 v[40:55], v[32:35], v[200:203], v[40:55]
v_mfma_f32_32x32x16_bf16 v[40:55], v[36:39], v[204:207], v[40:55]
v_mfma_f32_32x32x16_bf16 v[56:71], v[24:27], v[208:211], 0
v_mfma_f32_32x32x16_bf16 v[56:71], v[28:31], v[212:215], v[56:71]
v_mfma_f32_32x32x16_bf16 v[56:71], v[32:35], v[216:219], v[56:71]
v_mfma_f32_32x32x16_bf16 v[56:71], v[36:39], v[220:223], v[56:71]
s_nop 7
v_mul_f32 v168, v40, v224
v_mul_f32 v169, v40, v240
s_nop 1
v_fma_f32 v168, -v56, v240, v168
v_fmac_f32 v169, v56, v224
v_cvt_pk_bf16_f32 v24, v168, v169
v_mul_f32 v170, v41, v225
v_mul_f32 v171, v41, v241
v_fma_f32 v170, -v57, v241, v170
v_fmac_f32 v171, v57, v225
v_cvt_pk_bf16_f32 v25, v170, v171
v_mul_f32 v172, v42, v226
v_mul_f32 v173, v42, v242
v_fma_f32 v172, -v58, v242, v172
v_fmac_f32 v173, v58, v226
v_cvt_pk_bf16_f32 v26, v172, v173
v_mul_f32 v174, v43, v227
v_mul_f32 v175, v43, v243
v_fma_f32 v174, -v59, v243, v174
v_fmac_f32 v175, v59, v227
v_cvt_pk_bf16_f32 v27, v174, v175
v_mul_f32 v168, v44, v228
v_mul_f32 v169, v44, v244
v_fma_f32 v168, -v60, v244, v168
v_fmac_f32 v169, v60, v228
v_cvt_pk_bf16_f32 v28, v168, v169
v_mul_f32 v170, v45, v229
v_mul_f32 v171, v45, v245
v_fma_f32 v170, -v61, v245, v170
v_fmac_f32 v171, v61, v229
v_cvt_pk_bf16_f32 v29, v170, v171
v_mul_f32 v172, v46, v230
v_mul_f32 v173, v46, v246
v_fma_f32 v172, -v62, v246, v172
v_fmac_f32 v173, v62, v230
v_cvt_pk_bf16_f32 v30, v172, v173
v_mul_f32 v174, v47, v231
v_mul_f32 v175, v47, v247
v_fma_f32 v174, -v63, v247, v174
v_fmac_f32 v175, v63, v231
v_cvt_pk_bf16_f32 v31, v174, v175
v_mul_f32 v168, v48, v232
v_mul_f32 v169, v48, v248
v_fma_f32 v168, -v64, v248, v168
v_fmac_f32 v169, v64, v232
v_cvt_pk_bf16_f32 v32, v168, v169
v_mul_f32 v170, v49, v233
v_mul_f32 v171, v49, v249
v_fma_f32 v170, -v65, v249, v170
v_fmac_f32 v171, v65, v233
v_cvt_pk_bf16_f32 v33, v170, v171
v_mul_f32 v172, v50, v234
v_mul_f32 v173, v50, v250
v_fma_f32 v172, -v66, v250, v172
v_fmac_f32 v173, v66, v234
v_cvt_pk_bf16_f32 v34, v172, v173
v_mul_f32 v174, v51, v235
v_mul_f32 v175, v51, v251
v_fma_f32 v174, -v67, v251, v174
v_fmac_f32 v175, v67, v235
v_cvt_pk_bf16_f32 v35, v174, v175
v_mul_f32 v168, v52, v236
v_mul_f32 v169, v52, v252
v_fma_f32 v168, -v68, v252, v168
v_fmac_f32 v169, v68, v236
v_cvt_pk_bf16_f32 v36, v168, v169
v_mul_f32 v170, v53, v237
v_mul_f32 v171, v53, v253
v_fma_f32 v170, -v69, v253, v170
v_fmac_f32 v171, v69, v237
v_cvt_pk_bf16_f32 v37, v170, v171
v_mul_f32 v172, v54, v238
v_mul_f32 v173, v54, v254
v_fma_f32 v172, -v70, v254, v172
v_fmac_f32 v173, v70, v238
v_cvt_pk_bf16_f32 v38, v172, v173
v_mul_f32 v174, v55, v239
v_mul_f32 v175, v55, v255
v_fma_f32 v174, -v71, v255, v174
v_fmac_f32 v175, v71, v239
v_cvt_pk_bf16_f32 v39, v174, v175
v_mfma_f32_32x32x16_bf16 v[40:55], v[192:195], v[24:27], 0
v_mfma_f32_32x32x16_bf16 v[40:55], v[196:199], v[28:31], v[40:55]
v_mfma_f32_32x32x16_bf16 v[40:55], v[200:203], v[32:35], v[40:55]
v_mfma_f32_32x32x16_bf16 v[40:55], v[204:207], v[36:39], v[40:55]
v_mfma_f32_32x32x16_bf16 v[56:71], v[208:211], v[24:27], 0
v_mfma_f32_32x32x16_bf16 v[56:71], v[212:215], v[28:31], v[56:71]
v_mfma_f32_32x32x16_bf16 v[56:71], v[216:219], v[32:35], v[56:71]
v_mfma_f32_32x32x16_bf16 v[56:71], v[220:223], v[36:39], v[56:71]
L_lc20:
ds_read_b128 v[186:189], v184
s_waitcnt lgkmcnt(0)
v_min3_u32 v186, v186, v187, v188
v_min_u32 v186, v186, v189
s_nop 0
v_readfirstlane_b32 s92, v186
s_nop 0
s_cmp_ge_u32 s92, 6
s_cbranch_scc1 L_lcd21
s_sleep 1
s_branch L_lc20
L_lcd21:
s_cmp_eq_u32 s61, 2
s_cbranch_scc1 L_nwr19
ds_write_b128 v16, v[40:43] offset:0
ds_write_b128 v16, v[44:47] offset:1024
ds_write_b128 v16, v[48:51] offset:2048
ds_write_b128 v16, v[52:55] offset:3072
ds_write_b128 v16, v[56:59] offset:4096
ds_write_b128 v16, v[60:63] offset:5120
ds_write_b128 v16, v[64:67] offset:6144
ds_write_b128 v16, v[68:71] offset:7168
s_cmp_eq_u32 s61, 0
s_cbranch_scc1 L_nwr19
s_mov_b32 s61, 2
s_mov_b32 s64, 0
s_branch L_fft18
L_nwr19:
s_waitcnt lgkmcnt(0)
v_mov_b32 v190, 7
s_mov_b64 exec, 1
ds_write_b32 v185, v190
s_mov_b64 exec, -1
L_lc22:
ds_read_b128 v[186:189], v184
s_waitcnt lgkmcnt(0)
v_min3_u32 v186, v186, v187, v188
v_min_u32 v186, v186, v189
s_nop 0
v_readfirstlane_b32 s92, v186
s_nop 0
s_cmp_ge_u32 s92, 7
s_cbranch_scc1 L_lcd23
s_sleep 1
s_branch L_lc22
L_lcd23:
ds_read_b128 v[72:75], v17 offset:0
ds_read_b128 v[76:79], v17 offset:1024
ds_read_b128 v[80:83], v17 offset:2048
ds_read_b128 v[84:87], v17 offset:3072
ds_read_b128 v[88:91], v17 offset:4096
ds_read_b128 v[92:95], v17 offset:5120
ds_read_b128 v[96:99], v17 offset:6144
ds_read_b128 v[100:103], v17 offset:7168
s_waitcnt vmcnt(0) lgkmcnt(0)
v_mov_b32 v190, 8
s_mov_b64 exec, 1
ds_write_b32 v185, v190
s_mov_b64 exec, -1
v_lshlrev_b32 v168, 16, v104
v_and_b32 v169, 0xffff0000, v104
v_lshlrev_b32 v170, 16, v105
v_and_b32 v171, 0xffff0000, v105
v_add_f32 v172, v168, v170
v_add_f32 v173, v169, v171
v_sub_f32 v168, v168, v170
v_sub_f32 v169, v169, v171
v_mul_f32 v170, v152, v40
v_mul_f32 v171, v152, v56
v_mul_f32 v174, v172, v40
v_mul_f32 v175, v172, v56
v_fma_f32 v170, -v136, v88, v170
v_fmac_f32 v171, v136, v72
v_fma_f32 v174, -v173, v56, v174
v_fmac_f32 v175, v173, v40
v_fmac_f32 v174, v168, v170
v_fmac_f32 v175, v168, v171
v_fma_f32 v174, -v169, v171, v174
v_fmac_f32 v175, v169, v170
v_cvt_pk_bf16_f32 v24, v175, v174
v_lshlrev_b32 v176, 16, v106
v_and_b32 v177, 0xffff0000, v106
v_lshlrev_b32 v178, 16, v107
v_and_b32 v179, 0xffff0000, v107
v_add_f32 v180, v176, v178
v_add_f32 v181, v177, v179
v_sub_f32 v176, v176, v178
v_sub_f32 v177, v177, v179
v_mul_f32 v178, v153, v41
v_mul_f32 v179, v153, v57
v_mul_f32 v182, v180, v41
v_mul_f32 v183, v180, v57
v_fma_f32 v178, -v137, v89, v178
v_fmac_f32 v179, v137, v73
v_fma_f32 v182, -v181, v57, v182
v_fmac_f32 v183, v181, v41
v_fmac_f32 v182, v176, v178
v_fmac_f32 v183, v176, v179
v_fma_f32 v182, -v177, v179, v182
v_fmac_f32 v183, v177, v178
v_cvt_pk_bf16_f32 v25, v183, v182
v_lshlrev_b32 v168, 16, v108
v_and_b32 v169, 0xffff0000, v108
v_lshlrev_b32 v170, 16, v109
v_and_b32 v171, 0xffff0000, v109
v_add_f32 v172, v168, v170
v_add_f32 v173, v169, v171
v_sub_f32 v168, v168, v170
v_sub_f32 v169, v169, v171
v_mul_f32 v170, v154, v42
v_mul_f32 v171, v154, v58
v_mul_f32 v174, v172, v42
v_mul_f32 v175, v172, v58
v_fma_f32 v170, -v138, v90, v170
v_fmac_f32 v171, v138, v74
v_fma_f32 v174, -v173, v58, v174
v_fmac_f32 v175, v173, v42
v_fmac_f32 v174, v168, v170
v_fmac_f32 v175, v168, v171
v_fma_f32 v174, -v169, v171, v174
v_fmac_f32 v175, v169, v170
v_cvt_pk_bf16_f32 v26, v175, v174
v_lshlrev_b32 v176, 16, v110
v_and_b32 v177, 0xffff0000, v110
v_lshlrev_b32 v178, 16, v111
v_and_b32 v179, 0xffff0000, v111
v_add_f32 v180, v176, v178
v_add_f32 v181, v177, v179
v_sub_f32 v176, v176, v178
v_sub_f32 v177, v177, v179
v_mul_f32 v178, v155, v43
v_mul_f32 v179, v155, v59
v_mul_f32 v182, v180, v43
v_mul_f32 v183, v180, v59
v_fma_f32 v178, -v139, v91, v178
v_fmac_f32 v179, v139, v75
v_fma_f32 v182, -v181, v59, v182
v_fmac_f32 v183, v181, v43
v_fmac_f32 v182, v176, v178
v_fmac_f32 v183, v176, v179
v_fma_f32 v182, -v177, v179, v182
v_fmac_f32 v183, v177, v178
v_cvt_pk_bf16_f32 v27, v183, v182
v_lshlrev_b32 v168, 16, v112
v_and_b32 v169, 0xffff0000, v112
v_lshlrev_b32 v170, 16, v113
v_and_b32 v171, 0xffff0000, v113
v_add_f32 v172, v168, v170
v_add_f32 v173, v169, v171
v_sub_f32 v168, v168, v170
v_sub_f32 v169, v169, v171
v_mul_f32 v170, v156, v44
v_mul_f32 v171, v156, v60
v_mul_f32 v174, v172, v44
v_mul_f32 v175, v172, v60
v_fma_f32 v170, -v140, v92, v170
v_fmac_f32 v171, v140, v76
v_fma_f32 v174, -v173, v60, v174
v_fmac_f32 v175, v173, v44
v_fmac_f32 v174, v168, v170
v_fmac_f32 v175, v168, v171
v_fma_f32 v174, -v169, v171, v174
v_fmac_f32 v175, v169, v170
v_cvt_pk_bf16_f32 v28, v175, v174
v_lshlrev_b32 v176, 16, v114
v_and_b32 v177, 0xffff0000, v114
v_lshlrev_b32 v178, 16, v115
v_and_b32 v179, 0xffff0000, v115
v_add_f32 v180, v176, v178
v_add_f32 v181, v177, v179
v_sub_f32 v176, v176, v178
v_sub_f32 v177, v177, v179
v_mul_f32 v178, v157, v45
v_mul_f32 v179, v157, v61
v_mul_f32 v182, v180, v45
v_mul_f32 v183, v180, v61
v_fma_f32 v178, -v141, v93, v178
v_fmac_f32 v179, v141, v77
v_fma_f32 v182, -v181, v61, v182
v_fmac_f32 v183, v181, v45
v_fmac_f32 v182, v176, v178
v_fmac_f32 v183, v176, v179
v_fma_f32 v182, -v177, v179, v182
v_fmac_f32 v183, v177, v178
v_cvt_pk_bf16_f32 v29, v183, v182
v_lshlrev_b32 v168, 16, v116
v_and_b32 v169, 0xffff0000, v116
v_lshlrev_b32 v170, 16, v117
v_and_b32 v171, 0xffff0000, v117
v_add_f32 v172, v168, v170
v_add_f32 v173, v169, v171
v_sub_f32 v168, v168, v170
v_sub_f32 v169, v169, v171
v_mul_f32 v170, v158, v46
v_mul_f32 v171, v158, v62
v_mul_f32 v174, v172, v46
v_mul_f32 v175, v172, v62
v_fma_f32 v170, -v142, v94, v170
v_fmac_f32 v171, v142, v78
v_fma_f32 v174, -v173, v62, v174
v_fmac_f32 v175, v173, v46
v_fmac_f32 v174, v168, v170
v_fmac_f32 v175, v168, v171
v_fma_f32 v174, -v169, v171, v174
v_fmac_f32 v175, v169, v170
v_cvt_pk_bf16_f32 v30, v175, v174
v_lshlrev_b32 v176, 16, v118
v_and_b32 v177, 0xffff0000, v118
v_lshlrev_b32 v178, 16, v119
v_and_b32 v179, 0xffff0000, v119
v_add_f32 v180, v176, v178
v_add_f32 v181, v177, v179
v_sub_f32 v176, v176, v178
v_sub_f32 v177, v177, v179
v_mul_f32 v178, v159, v47
v_mul_f32 v179, v159, v63
v_mul_f32 v182, v180, v47
v_mul_f32 v183, v180, v63
v_fma_f32 v178, -v143, v95, v178
v_fmac_f32 v179, v143, v79
v_fma_f32 v182, -v181, v63, v182
v_fmac_f32 v183, v181, v47
v_fmac_f32 v182, v176, v178
v_fmac_f32 v183, v176, v179
v_fma_f32 v182, -v177, v179, v182
v_fmac_f32 v183, v177, v178
v_cvt_pk_bf16_f32 v31, v183, v182
v_lshlrev_b32 v168, 16, v120
v_and_b32 v169, 0xffff0000, v120
v_lshlrev_b32 v170, 16, v121
v_and_b32 v171, 0xffff0000, v121
v_add_f32 v172, v168, v170
v_add_f32 v173, v169, v171
v_sub_f32 v168, v168, v170
v_sub_f32 v169, v169, v171
v_mul_f32 v170, v160, v48
v_mul_f32 v171, v160, v64
v_mul_f32 v174, v172, v48
v_mul_f32 v175, v172, v64
v_fma_f32 v170, -v144, v96, v170
v_fmac_f32 v171, v144, v80
v_fma_f32 v174, -v173, v64, v174
v_fmac_f32 v175, v173, v48
v_fmac_f32 v174, v168, v170
v_fmac_f32 v175, v168, v171
v_fma_f32 v174, -v169, v171, v174
v_fmac_f32 v175, v169, v170
v_cvt_pk_bf16_f32 v32, v175, v174
v_lshlrev_b32 v176, 16, v122
v_and_b32 v177, 0xffff0000, v122
v_lshlrev_b32 v178, 16, v123
v_and_b32 v179, 0xffff0000, v123
v_add_f32 v180, v176, v178
v_add_f32 v181, v177, v179
v_sub_f32 v176, v176, v178
v_sub_f32 v177, v177, v179
v_mul_f32 v178, v161, v49
v_mul_f32 v179, v161, v65
v_mul_f32 v182, v180, v49
v_mul_f32 v183, v180, v65
v_fma_f32 v178, -v145, v97, v178
v_fmac_f32 v179, v145, v81
v_fma_f32 v182, -v181, v65, v182
v_fmac_f32 v183, v181, v49
v_fmac_f32 v182, v176, v178
v_fmac_f32 v183, v176, v179
v_fma_f32 v182, -v177, v179, v182
v_fmac_f32 v183, v177, v178
v_cvt_pk_bf16_f32 v33, v183, v182
v_lshlrev_b32 v168, 16, v124
v_and_b32 v169, 0xffff0000, v124
v_lshlrev_b32 v170, 16, v125
v_and_b32 v171, 0xffff0000, v125
v_add_f32 v172, v168, v170
v_add_f32 v173, v169, v171
v_sub_f32 v168, v168, v170
v_sub_f32 v169, v169, v171
v_mul_f32 v170, v162, v50
v_mul_f32 v171, v162, v66
v_mul_f32 v174, v172, v50
v_mul_f32 v175, v172, v66
v_fma_f32 v170, -v146, v98, v170
v_fmac_f32 v171, v146, v82
v_fma_f32 v174, -v173, v66, v174
v_fmac_f32 v175, v173, v50
v_fmac_f32 v174, v168, v170
v_fmac_f32 v175, v168, v171
v_fma_f32 v174, -v169, v171, v174
v_fmac_f32 v175, v169, v170
v_cvt_pk_bf16_f32 v34, v175, v174
v_lshlrev_b32 v176, 16, v126
v_and_b32 v177, 0xffff0000, v126
v_lshlrev_b32 v178, 16, v127
v_and_b32 v179, 0xffff0000, v127
v_add_f32 v180, v176, v178
v_add_f32 v181, v177, v179
v_sub_f32 v176, v176, v178
v_sub_f32 v177, v177, v179
v_mul_f32 v178, v163, v51
v_mul_f32 v179, v163, v67
v_mul_f32 v182, v180, v51
v_mul_f32 v183, v180, v67
v_fma_f32 v178, -v147, v99, v178
v_fmac_f32 v179, v147, v83
v_fma_f32 v182, -v181, v67, v182
v_fmac_f32 v183, v181, v51
v_fmac_f32 v182, v176, v178
v_fmac_f32 v183, v176, v179
v_fma_f32 v182, -v177, v179, v182
v_fmac_f32 v183, v177, v178
v_cvt_pk_bf16_f32 v35, v183, v182
v_lshlrev_b32 v168, 16, v128
v_and_b32 v169, 0xffff0000, v128
v_lshlrev_b32 v170, 16, v129
v_and_b32 v171, 0xffff0000, v129
v_add_f32 v172, v168, v170
v_add_f32 v173, v169, v171
v_sub_f32 v168, v168, v170
v_sub_f32 v169, v169, v171
v_mul_f32 v170, v164, v52
v_mul_f32 v171, v164, v68
v_mul_f32 v174, v172, v52
v_mul_f32 v175, v172, v68
v_fma_f32 v170, -v148, v100, v170
v_fmac_f32 v171, v148, v84
v_fma_f32 v174, -v173, v68, v174
v_fmac_f32 v175, v173, v52
v_fmac_f32 v174, v168, v170
v_fmac_f32 v175, v168, v171
v_fma_f32 v174, -v169, v171, v174
v_fmac_f32 v175, v169, v170
v_cvt_pk_bf16_f32 v36, v175, v174
v_lshlrev_b32 v176, 16, v130
v_and_b32 v177, 0xffff0000, v130
v_lshlrev_b32 v178, 16, v131
v_and_b32 v179, 0xffff0000, v131
v_add_f32 v180, v176, v178
v_add_f32 v181, v177, v179
v_sub_f32 v176, v176, v178
v_sub_f32 v177, v177, v179
v_mul_f32 v178, v165, v53
v_mul_f32 v179, v165, v69
v_mul_f32 v182, v180, v53
v_mul_f32 v183, v180, v69
v_fma_f32 v178, -v149, v101, v178
v_fmac_f32 v179, v149, v85
v_fma_f32 v182, -v181, v69, v182
v_fmac_f32 v183, v181, v53
v_fmac_f32 v182, v176, v178
v_fmac_f32 v183, v176, v179
v_fma_f32 v182, -v177, v179, v182
v_fmac_f32 v183, v177, v178
v_cvt_pk_bf16_f32 v37, v183, v182
v_lshlrev_b32 v168, 16, v132
v_and_b32 v169, 0xffff0000, v132
v_lshlrev_b32 v170, 16, v133
v_and_b32 v171, 0xffff0000, v133
v_add_f32 v172, v168, v170
v_add_f32 v173, v169, v171
v_sub_f32 v168, v168, v170
v_sub_f32 v169, v169, v171
v_mul_f32 v170, v166, v54
v_mul_f32 v171, v166, v70
v_mul_f32 v174, v172, v54
v_mul_f32 v175, v172, v70
v_fma_f32 v170, -v150, v102, v170
v_fmac_f32 v171, v150, v86
v_fma_f32 v174, -v173, v70, v174
v_fmac_f32 v175, v173, v54
v_fmac_f32 v174, v168, v170
v_fmac_f32 v175, v168, v171
v_fma_f32 v174, -v169, v171, v174
v_fmac_f32 v175, v169, v170
v_cvt_pk_bf16_f32 v38, v175, v174
v_lshlrev_b32 v176, 16, v134
v_and_b32 v177, 0xffff0000, v134
v_lshlrev_b32 v178, 16, v135
v_and_b32 v179, 0xffff0000, v135
v_add_f32 v180, v176, v178
v_add_f32 v181, v177, v179
v_sub_f32 v176, v176, v178
v_sub_f32 v177, v177, v179
v_mul_f32 v178, v167, v55
v_mul_f32 v179, v167, v71
v_mul_f32 v182, v180, v55
v_mul_f32 v183, v180, v71
v_fma_f32 v178, -v151, v103, v178
v_fmac_f32 v179, v151, v87
v_fma_f32 v182, -v181, v71, v182
v_fmac_f32 v183, v181, v55
v_fmac_f32 v182, v176, v178
v_fmac_f32 v183, v176, v179
v_fma_f32 v182, -v177, v179, v182
v_fmac_f32 v183, v177, v178
v_cvt_pk_bf16_f32 v39, v183, v182
v_mfma_f32_32x32x16_bf16 v[40:55], v[24:27], v[192:195], 0
v_mfma_f32_32x32x16_bf16 v[40:55], v[28:31], v[196:199], v[40:55]
v_mfma_f32_32x32x16_bf16 v[40:55], v[32:35], v[200:203], v[40:55]
v_mfma_f32_32x32x16_bf16 v[40:55], v[36:39], v[204:207], v[40:55]
v_mfma_f32_32x32x16_bf16 v[56:71], v[24:27], v[208:211], 0
v_mfma_f32_32x32x16_bf16 v[56:71], v[28:31], v[212:215], v[56:71]
v_mfma_f32_32x32x16_bf16 v[56:71], v[32:35], v[216:219], v[56:71]
v_mfma_f32_32x32x16_bf16 v[56:71], v[36:39], v[220:223], v[56:71]
s_nop 7
v_mul_f32 v168, v40, v224
v_mul_f32 v169, v40, v240
s_nop 1
v_fma_f32 v168, -v56, v240, v168
v_fmac_f32 v169, v56, v224
v_cvt_pk_bf16_f32 v24, v168, v169
v_mul_f32 v170, v41, v225
v_mul_f32 v171, v41, v241
v_fma_f32 v170, -v57, v241, v170
v_fmac_f32 v171, v57, v225
v_cvt_pk_bf16_f32 v25, v170, v171
v_mul_f32 v172, v42, v226
v_mul_f32 v173, v42, v242
v_fma_f32 v172, -v58, v242, v172
v_fmac_f32 v173, v58, v226
v_cvt_pk_bf16_f32 v26, v172, v173
v_mul_f32 v174, v43, v227
v_mul_f32 v175, v43, v243
v_fma_f32 v174, -v59, v243, v174
v_fmac_f32 v175, v59, v227
v_cvt_pk_bf16_f32 v27, v174, v175
v_mul_f32 v168, v44, v228
v_mul_f32 v169, v44, v244
v_fma_f32 v168, -v60, v244, v168
v_fmac_f32 v169, v60, v228
v_cvt_pk_bf16_f32 v28, v168, v169
v_mul_f32 v170, v45, v229
v_mul_f32 v171, v45, v245
v_fma_f32 v170, -v61, v245, v170
v_fmac_f32 v171, v61, v229
v_cvt_pk_bf16_f32 v29, v170, v171
v_mul_f32 v172, v46, v230
v_mul_f32 v173, v46, v246
v_fma_f32 v172, -v62, v246, v172
v_fmac_f32 v173, v62, v230
v_cvt_pk_bf16_f32 v30, v172, v173
v_mul_f32 v174, v47, v231
v_mul_f32 v175, v47, v247
v_fma_f32 v174, -v63, v247, v174
v_fmac_f32 v175, v63, v231
v_cvt_pk_bf16_f32 v31, v174, v175
v_mul_f32 v168, v48, v232
v_mul_f32 v169, v48, v248
v_fma_f32 v168, -v64, v248, v168
v_fmac_f32 v169, v64, v232
v_cvt_pk_bf16_f32 v32, v168, v169
v_mul_f32 v170, v49, v233
v_mul_f32 v171, v49, v249
v_fma_f32 v170, -v65, v249, v170
v_fmac_f32 v171, v65, v233
v_cvt_pk_bf16_f32 v33, v170, v171
v_mul_f32 v172, v50, v234
v_mul_f32 v173, v50, v250
v_fma_f32 v172, -v66, v250, v172
v_fmac_f32 v173, v66, v234
v_cvt_pk_bf16_f32 v34, v172, v173
v_mul_f32 v174, v51, v235
v_mul_f32 v175, v51, v251
v_fma_f32 v174, -v67, v251, v174
v_fmac_f32 v175, v67, v235
v_cvt_pk_bf16_f32 v35, v174, v175
v_mul_f32 v168, v52, v236
v_mul_f32 v169, v52, v252
v_fma_f32 v168, -v68, v252, v168
v_fmac_f32 v169, v68, v236
v_cvt_pk_bf16_f32 v36, v168, v169
v_mul_f32 v170, v53, v237
v_mul_f32 v171, v53, v253
v_fma_f32 v170, -v69, v253, v170
v_fmac_f32 v171, v69, v237
v_cvt_pk_bf16_f32 v37, v170, v171
v_mul_f32 v172, v54, v238
v_mul_f32 v173, v54, v254
v_fma_f32 v172, -v70, v254, v172
v_fmac_f32 v173, v70, v238
v_cvt_pk_bf16_f32 v38, v172, v173
v_mul_f32 v174, v55, v239
v_mul_f32 v175, v55, v255
v_fma_f32 v174, -v71, v255, v174
v_fmac_f32 v175, v71, v239
v_cvt_pk_bf16_f32 v39, v174, v175
v_mfma_f32_32x32x16_bf16 v[40:55], v[192:195], v[24:27], 0
v_mfma_f32_32x32x16_bf16 v[40:55], v[196:199], v[28:31], v[40:55]
v_mfma_f32_32x32x16_bf16 v[40:55], v[200:203], v[32:35], v[40:55]
v_mfma_f32_32x32x16_bf16 v[40:55], v[204:207], v[36:39], v[40:55]
v_mfma_f32_32x32x16_bf16 v[56:71], v[208:211], v[24:27], 0
v_mfma_f32_32x32x16_bf16 v[56:71], v[212:215], v[28:31], v[56:71]
v_mfma_f32_32x32x16_bf16 v[56:71], v[216:219], v[32:35], v[56:71]
v_mfma_f32_32x32x16_bf16 v[56:71], v[220:223], v[36:39], v[56:71]
s_lshr_b32 s64, s62, 16
L_lc24:
ds_read_b128 v[186:189], v184
s_waitcnt lgkmcnt(0)
v_min3_u32 v186, v186, v187, v188
v_min_u32 v186, v186, v189
s_nop 0
v_readfirstlane_b32 s92, v186
s_nop 0
s_cmp_ge_u32 s92, 8
s_cbranch_scc1 L_lcd25
s_sleep 1
s_branch L_lc24
L_lcd25:
s_nop 1
v_cvt_pk_bf16_f32 v24, v40, v56
v_xor_b32 v24, s64, v24
v_cvt_pk_bf16_f32 v25, v41, v57
v_xor_b32 v25, s64, v25
v_cvt_pk_bf16_f32 v26, v42, v58
v_xor_b32 v26, s64, v26
v_cvt_pk_bf16_f32 v27, v43, v59
v_xor_b32 v27, s64, v27
ds_write_b128 v15, v[24:27] offset:0
v_cvt_pk_bf16_f32 v28, v44, v60
v_xor_b32 v28, s64, v28
v_cvt_pk_bf16_f32 v29, v45, v61
v_xor_b32 v29, s64, v29
v_cvt_pk_bf16_f32 v30, v46, v62
v_xor_b32 v30, s64, v30
v_cvt_pk_bf16_f32 v31, v47, v63
v_xor_b32 v31, s64, v31
ds_write_b128 v15, v[28:31] offset:4096
v_cvt_pk_bf16_f32 v32, v48, v64
v_xor_b32 v32, s64, v32
v_cvt_pk_bf16_f32 v33, v49, v65
v_xor_b32 v33, s64, v33
v_cvt_pk_bf16_f32 v34, v50, v66
v_xor_b32 v34, s64, v34
v_cvt_pk_bf16_f32 v35, v51, v67
v_xor_b32 v35, s64, v35
ds_write_b128 v15, v[32:35] offset:8192
v_cvt_pk_bf16_f32 v36, v52, v68
v_xor_b32 v36, s64, v36
v_cvt_pk_bf16_f32 v37, v53, v69
v_xor_b32 v37, s64, v37
v_cvt_pk_bf16_f32 v38, v54, v70
v_xor_b32 v38, s64, v38
v_cvt_pk_bf16_f32 v39, v55, v71
v_xor_b32 v39, s64, v39
ds_write_b128 v15, v[36:39] offset:12288
s_waitcnt lgkmcnt(0)
v_mov_b32 v190, 9
s_mov_b64 exec, 1
ds_write_b32 v185, v190
s_mov_b64 exec, -1
L_lc26:
ds_read_b128 v[186:189], v184
s_waitcnt lgkmcnt(0)
v_min3_u32 v186, v186, v187, v188
v_min_u32 v186, v186, v189
s_nop 0
v_readfirstlane_b32 s92, v186
s_nop 0
s_cmp_ge_u32 s92, 9
s_cbranch_scc1 L_lcd27
s_sleep 1
s_branch L_lc26
L_lcd27:
ds_read_b128 v[24:27], v18 offset:0
ds_read_b128 v[28:31], v18 offset:1024
ds_read_b128 v[32:35], v18 offset:2048
ds_read_b128 v[36:39], v18 offset:3072
s_mov_b32 s64, 0
s_waitcnt lgkmcnt(3)
buffer_store_dwordx4 v[24:27], v14, s[56:59], s64 offen sc1
s_mov_b32 s64, 262144
s_waitcnt lgkmcnt(2)
buffer_store_dwordx4 v[28:31], v14, s[56:59], s64 offen sc1
s_mov_b32 s64, 524288
s_waitcnt lgkmcnt(1)
buffer_store_dwordx4 v[32:35], v14, s[56:59], s64 offen sc1
s_mov_b32 s64, 786432
s_waitcnt lgkmcnt(0)
buffer_store_dwordx4 v[36:39], v14, s[56:59], s64 offen sc1
s_lshl_b32 s64, s67, 14
s_add_u32 s40, s28, s64
s_addc_u32 s41, s29, 0
s_mov_b32 s42, 16384
s_mov_b32 s43, 0x20000
v_and_b32 v8, 31, v1
v_lshrrev_b32 v9, 5, v1
v_lshlrev_b32 v14, 2, v8
v_lshl_add_u32 v14, v9, 9, v14
s_mov_b32 s64, 0x35000000
v_mul_f32 v224, s64, v224
v_mul_f32 v225, s64, v225
v_mul_f32 v226, s64, v226
v_mul_f32 v227, s64, v227
v_mul_f32 v228, s64, v228
v_mul_f32 v229, s64, v229
v_mul_f32 v230, s64, v230
v_mul_f32 v231, s64, v231
v_mul_f32 v232, s64, v232
v_mul_f32 v233, s64, v233
v_mul_f32 v234, s64, v234
v_mul_f32 v235, s64, v235
v_mul_f32 v236, s64, v236
v_mul_f32 v237, s64, v237
v_mul_f32 v238, s64, v238
v_mul_f32 v239, s64, v239
v_mul_f32 v240, s64, v240
v_mul_f32 v241, s64, v241
v_mul_f32 v242, s64, v242
v_mul_f32 v243, s64, v243
v_mul_f32 v244, s64, v244
v_mul_f32 v245, s64, v245
v_mul_f32 v246, s64, v246
v_mul_f32 v247, s64, v247
v_mul_f32 v248, s64, v248
v_mul_f32 v249, s64, v249
v_mul_f32 v250, s64, v250
v_mul_f32 v251, s64, v251
v_mul_f32 v252, s64, v252
v_mul_f32 v253, s64, v253
v_mul_f32 v254, s64, v254
v_mul_f32 v255, s64, v255
s_waitcnt vmcnt(0)
v_mov_b32 v190, 10
s_mov_b64 exec, 1
ds_write_b32 v185, v190
s_mov_b64 exec, -1
s_cmp_lg_u32 s66, 0
s_cbranch_scc1 L_ph28
L_lc29:
ds_read_b128 v[186:189], v184
s_waitcnt lgkmcnt(0)
v_min3_u32 v186, v186, v187, v188
v_min_u32 v186, v186, v189
s_nop 0
v_readfirstlane_b32 s92, v186
s_nop 0
s_cmp_ge_u32 s92, 10
s_cbranch_scc1 L_lcd30
s_sleep 1
s_branch L_lc29
L_lcd30:
s_and_b32 s64, s2, 15
s_lshl_b32 s65, s64, 7
s_add_u32 s65, s65, 6144
s_add_u32 s90, s32, s65
s_addc_u32 s91, s33, 0
s_mov_b32 s65, 1
s_atomic_add s65, s[90:91], 0x0 glc
s_lshl_b32 s64, s64, 2
s_add_u32 s64, s64, 548864
v_lshl_add_u32 v20, v1, 7, s64
v_mov_b32 v21, s37
s_add_u32 s4, s32, s64
s_addc_u32 s5, s33, 0
s_and_b32 s64, s2, 31
s_lshl_b32 s64, s64, 7
s_add_u32 s64, s64, 548864
s_waitcnt lgkmcnt(0)
s_cmp_lg_u32 s65, 15
s_cbranch_scc1 L_sg31
s_atomic_swap s37, s[4:5], 0x0
s_atomic_swap s37, s[4:5], 0x80
s_atomic_swap s37, s[4:5], 0x100
s_atomic_swap s37, s[4:5], 0x180
s_atomic_swap s37, s[4:5], 0x200
s_atomic_swap s37, s[4:5], 0x280
s_atomic_swap s37, s[4:5], 0x300
s_atomic_swap s37, s[4:5], 0x380
s_atomic_swap s37, s[4:5], 0x400
s_atomic_swap s37, s[4:5], 0x480
s_atomic_swap s37, s[4:5], 0x500
s_atomic_swap s37, s[4:5], 0x580
s_atomic_swap s37, s[4:5], 0x600
s_atomic_swap s37, s[4:5], 0x680
s_atomic_swap s37, s[4:5], 0x700
s_atomic_swap s37, s[4:5], 0x780
s_atomic_swap s37, s[4:5], 0x800
s_atomic_swap s37, s[4:5], 0x880
s_atomic_swap s37, s[4:5], 0x900
s_atomic_swap s37, s[4:5], 0x980
s_atomic_swap s37, s[4:5], 0xa00
s_atomic_swap s37, s[4:5], 0xa80
s_atomic_swap s37, s[4:5], 0xb00
s_atomic_swap s37, s[4:5], 0xb80
s_atomic_swap s37, s[4:5], 0xc00
s_atomic_swap s37, s[4:5], 0xc80
s_atomic_swap s37, s[4:5], 0xd00
s_atomic_swap s37, s[4:5], 0xd80
s_atomic_swap s37, s[4:5], 0xe00
s_atomic_swap s37, s[4:5], 0xe80
s_atomic_swap s37, s[4:5], 0xf00
s_atomic_swap s37, s[4:5], 0xf80
s_waitcnt lgkmcnt(0)
L_sg31:
s_add_u32 s90, s32, s64
s_addc_u32 s91, s33, 0
s_mov_b32 s64, s37
s_mov_b32 s65, s37
s_mov_b32 s92, 0
s_branch L_sp32
L_nok33:
s_add_u32 s92, s92, 1
s_cmp_ge_u32 s92, 200000
s_cbranch_scc1 L_ph28
s_sleep 6
L_sp32:
s_load_dwordx16 s[4:19], s[90:91], 0x0 glc
s_waitcnt lgkmcnt(0)
s_cmp_eq_u64 s[4:5], s[64:65]
s_cbranch_scc0 L_nok33
s_cmp_eq_u64 s[6:7], s[64:65]
s_cbranch_scc0 L_nok33
s_cmp_eq_u64 s[8:9], s[64:65]
s_cbranch_scc0 L_nok33
s_cmp_eq_u64 s[10:11], s[64:65]
s_cbranch_scc0 L_nok33
s_cmp_eq_u64 s[12:13], s[64:65]
s_cbranch_scc0 L_nok33
s_cmp_eq_u64 s[14:15], s[64:65]
s_cbranch_scc0 L_nok33
s_cmp_eq_u64 s[16:17], s[64:65]
s_cbranch_scc0 L_nok33
s_cmp_eq_u64 s[18:19], s[64:65]
s_cbranch_scc0 L_nok33
L_ph28:
v_mov_b32 v190, 11
s_mov_b64 exec, 1
ds_write_b32 v185, v190
s_mov_b64 exec, -1
L_lc34:
ds_read_b128 v[186:189], v184
s_waitcnt lgkmcnt(0)
v_min3_u32 v186, v186, v187, v188
v_min_u32 v186, v186, v189
s_nop 0
v_readfirstlane_b32 s92, v186
s_nop 0
s_cmp_ge_u32 s92, 11
s_cbranch_scc1 L_lcd35
s_sleep 1
s_branch L_lc34
L_lcd35:
s_setprio 3
s_mov_b32 m0, s68
s_nop 0
buffer_load_dwordx4 v7, s[44:47], 0 offen offset:0 sc1 lds
buffer_load_dwordx4 v7, s[44:47], 0 offen offset:1024 sc1 lds
buffer_load_dwordx4 v7, s[44:47], 0 offen offset:2048 sc1 lds
buffer_load_dwordx4 v7, s[44:47], 0 offen offset:3072 sc1 lds
s_waitcnt vmcnt(0)
v_mov_b32 v190, 12
s_mov_b64 exec, 1
ds_write_b32 v185, v190
s_mov_b64 exec, -1
L_lc36:
ds_read_b128 v[186:189], v184
s_waitcnt lgkmcnt(0)
v_min3_u32 v186, v186, v187, v188
v_min_u32 v186, v186, v189
s_nop 0
v_readfirstlane_b32 s92, v186
s_nop 0
s_cmp_ge_u32 s92, 12
s_cbranch_scc1 L_lcd37
s_sleep 1
s_branch L_lc36
L_lcd37:
ds_read_b32 v24, v4 offset:0
ds_read_b32 v25, v4 offset:1024
ds_read_b32 v26, v4 offset:2048
ds_read_b32 v27, v4 offset:3072
ds_read_b32 v28, v4 offset:8192
ds_read_b32 v29, v4 offset:9216
ds_read_b32 v30, v4 offset:10240
ds_read_b32 v31, v4 offset:11264
ds_read_b32 v32, v6 offset:0
ds_read_b32 v33, v5 offset:10240
ds_read_b32 v34, v5 offset:9216
ds_read_b32 v35, v5 offset:8192
ds_read_b32 v36, v5 offset:3072
ds_read_b32 v37, v5 offset:2048
ds_read_b32 v38, v5 offset:1024
ds_read_b32 v39, v5 offset:0
s_waitcnt lgkmcnt(0)
v_mfma_f32_32x32x16_bf16 v[40:55], v[24:27], v[192:195], 0
v_mfma_f32_32x32x16_bf16 v[40:55], v[28:31], v[196:199], v[40:55]
v_mfma_f32_32x32x16_bf16 v[40:55], v[32:35], v[200:203], v[40:55]
v_mfma_f32_32x32x16_bf16 v[40:55], v[36:39], v[204:207], v[40:55]
v_mfma_f32_32x32x16_bf16 v[56:71], v[24:27], v[208:211], 0
v_mfma_f32_32x32x16_bf16 v[56:71], v[28:31], v[212:215], v[56:71]
v_mfma_f32_32x32x16_bf16 v[56:71], v[32:35], v[216:219], v[56:71]
v_mfma_f32_32x32x16_bf16 v[56:71], v[36:39], v[220:223], v[56:71]
s_nop 7
v_mul_f32 v168, v40, v224
v_mul_f32 v169, v40, v240
s_nop 1
v_fma_f32 v168, -v56, v240, v168
v_fmac_f32 v169, v56, v224
v_cvt_pk_bf16_f32 v24, v168, v169
v_mul_f32 v170, v41, v225
v_mul_f32 v171, v41, v241
v_fma_f32 v170, -v57, v241, v170
v_fmac_f32 v171, v57, v225
v_cvt_pk_bf16_f32 v25, v170, v171
v_mul_f32 v172, v42, v226
v_mul_f32 v173, v42, v242
v_fma_f32 v172, -v58, v242, v172
v_fmac_f32 v173, v58, v226
v_cvt_pk_bf16_f32 v26, v172, v173
v_mul_f32 v174, v43, v227
v_mul_f32 v175, v43, v243
v_fma_f32 v174, -v59, v243, v174
v_fmac_f32 v175, v59, v227
v_cvt_pk_bf16_f32 v27, v174, v175
v_mul_f32 v168, v44, v228
v_mul_f32 v169, v44, v244
v_fma_f32 v168, -v60, v244, v168
v_fmac_f32 v169, v60, v228
v_cvt_pk_bf16_f32 v28, v168, v169
v_mul_f32 v170, v45, v229
v_mul_f32 v171, v45, v245
v_fma_f32 v170, -v61, v245, v170
v_fmac_f32 v171, v61, v229
v_cvt_pk_bf16_f32 v29, v170, v171
v_mul_f32 v172, v46, v230
v_mul_f32 v173, v46, v246
v_fma_f32 v172, -v62, v246, v172
v_fmac_f32 v173, v62, v230
v_cvt_pk_bf16_f32 v30, v172, v173
v_mul_f32 v174, v47, v231
v_mul_f32 v175, v47, v247
v_fma_f32 v174, -v63, v247, v174
v_fmac_f32 v175, v63, v231
v_cvt_pk_bf16_f32 v31, v174, v175
v_mul_f32 v168, v48, v232
v_mul_f32 v169, v48, v248
v_fma_f32 v168, -v64, v248, v168
v_fmac_f32 v169, v64, v232
v_cvt_pk_bf16_f32 v32, v168, v169
v_mul_f32 v170, v49, v233
v_mul_f32 v171, v49, v249
v_fma_f32 v170, -v65, v249, v170
v_fmac_f32 v171, v65, v233
v_cvt_pk_bf16_f32 v33, v170, v171
v_mul_f32 v172, v50, v234
v_mul_f32 v173, v50, v250
v_fma_f32 v172, -v66, v250, v172
v_fmac_f32 v173, v66, v234
v_cvt_pk_bf16_f32 v34, v172, v173
v_mul_f32 v174, v51, v235
v_mul_f32 v175, v51, v251
v_fma_f32 v174, -v67, v251, v174
v_fmac_f32 v175, v67, v235
v_cvt_pk_bf16_f32 v35, v174, v175
v_mul_f32 v168, v52, v236
v_mul_f32 v169, v52, v252
v_fma_f32 v168, -v68, v252, v168
v_fmac_f32 v169, v68, v236
v_cvt_pk_bf16_f32 v36, v168, v169
v_mul_f32 v170, v53, v237
v_mul_f32 v171, v53, v253
v_fma_f32 v170, -v69, v253, v170
v_fmac_f32 v171, v69, v237
v_cvt_pk_bf16_f32 v37, v170, v171
v_mul_f32 v172, v54, v238
v_mul_f32 v173, v54, v254
v_fma_f32 v172, -v70, v254, v172
v_fmac_f32 v173, v70, v238
v_cvt_pk_bf16_f32 v38, v172, v173
v_mul_f32 v174, v55, v239
v_mul_f32 v175, v55, v255
v_fma_f32 v174, -v71, v255, v174
v_fmac_f32 v175, v71, v239
v_cvt_pk_bf16_f32 v39, v174, v175
v_mfma_f32_32x32x16_bf16 v[40:55], v[192:195], v[24:27], 0
v_mfma_f32_32x32x16_bf16 v[40:55], v[196:199], v[28:31], v[40:55]
v_mfma_f32_32x32x16_bf16 v[40:55], v[200:203], v[32:35], v[40:55]
v_mfma_f32_32x32x16_bf16 v[40:55], v[204:207], v[36:39], v[40:55]
v_mfma_f32_32x32x16_bf16 v[56:71], v[208:211], v[24:27], 0
v_mfma_f32_32x32x16_bf16 v[56:71], v[212:215], v[28:31], v[56:71]
v_mfma_f32_32x32x16_bf16 v[56:71], v[216:219], v[32:35], v[56:71]
v_mfma_f32_32x32x16_bf16 v[56:71], v[220:223], v[36:39], v[56:71]
s_movk_i32 s64, 0x2000
s_nop 10
v_cvt_pk_bf16_f32 v73, v56, v40
v_lshlrev_b32 v72, 16, v73
v_and_b32 v73, 0xffff0000, v73
buffer_store_dword v72, v14, s[40:43], 0 offen offset:0 nt
buffer_store_dword v73, v14, s[40:43], s64 offen offset:0 nt
v_cvt_pk_bf16_f32 v75, v57, v41
v_lshlrev_b32 v74, 16, v75
v_and_b32 v75, 0xffff0000, v75
buffer_store_dword v74, v14, s[40:43], 0 offen offset:128 nt
buffer_store_dword v75, v14, s[40:43], s64 offen offset:128 nt
v_cvt_pk_bf16_f32 v77, v58, v42
v_lshlrev_b32 v76, 16, v77
v_and_b32 v77, 0xffff0000, v77
buffer_store_dword v76, v14, s[40:43], 0 offen offset:256 nt
buffer_store_dword v77, v14, s[40:43], s64 offen offset:256 nt
v_cvt_pk_bf16_f32 v79, v59, v43
v_lshlrev_b32 v78, 16, v79
v_and_b32 v79, 0xffff0000, v79
buffer_store_dword v78, v14, s[40:43], 0 offen offset:384 nt
buffer_store_dword v79, v14, s[40:43], s64 offen offset:384 nt
v_cvt_pk_bf16_f32 v81, v60, v44
v_lshlrev_b32 v80, 16, v81
v_and_b32 v81, 0xffff0000, v81
buffer_store_dword v80, v14, s[40:43], 0 offen offset:1024 nt
buffer_store_dword v81, v14, s[40:43], s64 offen offset:1024 nt
v_cvt_pk_bf16_f32 v83, v61, v45
v_lshlrev_b32 v82, 16, v83
v_and_b32 v83, 0xffff0000, v83
buffer_store_dword v82, v14, s[40:43], 0 offen offset:1152 nt
buffer_store_dword v83, v14, s[40:43], s64 offen offset:1152 nt
v_cvt_pk_bf16_f32 v85, v62, v46
v_lshlrev_b32 v84, 16, v85
v_and_b32 v85, 0xffff0000, v85
buffer_store_dword v84, v14, s[40:43], 0 offen offset:1280 nt
buffer_store_dword v85, v14, s[40:43], s64 offen offset:1280 nt
v_cvt_pk_bf16_f32 v87, v63, v47
v_lshlrev_b32 v86, 16, v87
v_and_b32 v87, 0xffff0000, v87
buffer_store_dword v86, v14, s[40:43], 0 offen offset:1408 nt
buffer_store_dword v87, v14, s[40:43], s64 offen offset:1408 nt
v_cvt_pk_bf16_f32 v89, v64, v48
v_lshlrev_b32 v88, 16, v89
v_and_b32 v89, 0xffff0000, v89
buffer_store_dword v88, v14, s[40:43], 0 offen offset:2048 nt
buffer_store_dword v89, v14, s[40:43], s64 offen offset:2048 nt
v_cvt_pk_bf16_f32 v91, v65, v49
v_lshlrev_b32 v90, 16, v91
v_and_b32 v91, 0xffff0000, v91
buffer_store_dword v90, v14, s[40:43], 0 offen offset:2176 nt
buffer_store_dword v91, v14, s[40:43], s64 offen offset:2176 nt
v_cvt_pk_bf16_f32 v93, v66, v50
v_lshlrev_b32 v92, 16, v93
v_and_b32 v93, 0xffff0000, v93
buffer_store_dword v92, v14, s[40:43], 0 offen offset:2304 nt
buffer_store_dword v93, v14, s[40:43], s64 offen offset:2304 nt
v_cvt_pk_bf16_f32 v95, v67, v51
v_lshlrev_b32 v94, 16, v95
v_and_b32 v95, 0xffff0000, v95
buffer_store_dword v94, v14, s[40:43], 0 offen offset:2432 nt
buffer_store_dword v95, v14, s[40:43], s64 offen offset:2432 nt
v_cvt_pk_bf16_f32 v97, v68, v52
v_lshlrev_b32 v96, 16, v97
v_and_b32 v97, 0xffff0000, v97
buffer_store_dword v96, v14, s[40:43], 0 offen offset:3072 nt
buffer_store_dword v97, v14, s[40:43], s64 offen offset:3072 nt
v_cvt_pk_bf16_f32 v99, v69, v53
v_lshlrev_b32 v98, 16, v99
v_and_b32 v99, 0xffff0000, v99
buffer_store_dword v98, v14, s[40:43], 0 offen offset:3200 nt
buffer_store_dword v99, v14, s[40:43], s64 offen offset:3200 nt
v_cvt_pk_bf16_f32 v101, v70, v54
v_lshlrev_b32 v100, 16, v101
v_and_b32 v101, 0xffff0000, v101
buffer_store_dword v100, v14, s[40:43], 0 offen offset:3328 nt
buffer_store_dword v101, v14, s[40:43], s64 offen offset:3328 nt
v_cvt_pk_bf16_f32 v103, v71, v55
v_lshlrev_b32 v102, 16, v103
v_and_b32 v103, 0xffff0000, v103
buffer_store_dword v102, v14, s[40:43], 0 offen offset:3456 nt
buffer_store_dword v103, v14, s[40:43], s64 offen offset:3456 nt
s_endpgm
L_concat_heads__spectral_gfnet__ssm_conv_s5__prompt_kernel_gemm:
s_lshr_b32 s68, s34, 1
s_and_b32 s66, s34, 1
v_and_b32 v6, 31, v1
v_lshrrev_b32 v5, 5, v1
v_and_b32 v4, 0x13, v6
v_bfe_u32 v7, v6, 2, 1
v_lshl_or_b32 v4, v7, 3, v4
v_bfe_u32 v7, v6, 3, 1
v_lshl_or_b32 v4, v7, 2, v4
s_lshl_b32 s60, s36, 6
s_lshl_b32 s61, s66, 5
s_add_u32 s60, s60, s61
v_add_u32 v4, s60, v4
v_lshlrev_b32 v7, 1, v4
v_lshlrev_b32 v11, 4, v1
s_waitcnt lgkmcnt(0)
global_load_ushort v8, v7, s[12:13]
global_load_ushort v9, v7, s[14:15]
global_load_ushort v10, v7, s[24:25]
s_lshl_b32 s60, s2, 3
s_add_u32 s60, s60, s34
s_cmp_lg_u32 s60, 1
s_cbranch_scc1 L_nn38
s_load_dword s60, s[32:33], 0
v_mov_b32 v16, 0
v_lshlrev_b32 v17, 7, v1
v_add_u32 v17, 4096, v17
global_store_dword v17, v16, s[32:33] sc1
s_waitcnt vmcnt(0) lgkmcnt(0)
s_add_u32 s60, s60, 1
s_cmp_eq_u32 s60, 0
s_cselect_b32 s60, 1, s60
v_mov_b32 v17, s60
s_mov_b64 exec, 1
global_store_dword v16, v17, s[30:31] sc1
global_store_dword v16, v17, s[32:33] offset:0
s_mov_b64 exec, -1
L_nn38:
s_cmp_lg_u32 s34, 0
s_cbranch_scc1 L_pf39
s_lshr_b32 s60, s2, 3
s_lshl_b32 s60, s60, 11
v_and_b32 v12, 15, v1
v_lshl_add_u32 v12, v12, 7, s60
v_min_u32 v12, L_concat_heads__spectral_gfnet__ssm_conv_s5__prompt_kernel_end-concat_heads__spectral_gfnet__ssm_conv_s5__prompt_kernel, v12
s_getpc_b64 s[60:61]
L_pc40:
s_sub_u32 s60, s60, L_pc40-concat_heads__spectral_gfnet__ssm_conv_s5__prompt_kernel
s_subb_u32 s61, s61, 0
global_load_dword v247, v12, s[60:61]
L_pf39:
v_bfe_u32 v7, v6, 1, 3
v_xor_b32 v7, v7, v5
v_lshlrev_b32 v7, 4, v7
v_lshl_add_u32 v7, v6, 7, v7
s_lshl_b32 s60, s68, 13
s_lshl_b32 s61, s66, 13
s_add_u32 s61, s61, 16384
v_xor_b32 v12, 0, v7
v_add_u32 v128, s60, v12
v_add_u32 v132, s61, v12
v_add_u32 v136, 0x10000, v128
v_add_u32 v140, 0x10000, v132
v_xor_b32 v12, 32, v7
v_add_u32 v129, s60, v12
v_add_u32 v133, s61, v12
v_add_u32 v137, 0x10000, v129
v_add_u32 v141, 0x10000, v133
v_xor_b32 v12, 64, v7
v_add_u32 v130, s60, v12
v_add_u32 v134, s61, v12
v_add_u32 v138, 0x10000, v130
v_add_u32 v142, 0x10000, v134
v_xor_b32 v12, 96, v7
v_add_u32 v131, s60, v12
v_add_u32 v135, s61, v12
v_add_u32 v139, 0x10000, v131
v_add_u32 v143, 0x10000, v135
v_mov_b64 v[64:65], 0
v_mov_b64 v[66:67], 0
v_mov_b64 v[68:69], 0
v_mov_b64 v[70:71], 0
v_mov_b64 v[72:73], 0
v_mov_b64 v[74:75], 0
v_mov_b64 v[76:77], 0
v_mov_b64 v[78:79], 0
v_mov_b64 v[80:81], 0
v_mov_b64 v[82:83], 0
v_mov_b64 v[84:85], 0
v_mov_b64 v[86:87], 0
v_mov_b64 v[88:89], 0
v_mov_b64 v[90:91], 0
v_mov_b64 v[92:93], 0
v_mov_b64 v[94:95], 0
v_mov_b64 v[96:97], 0
v_mov_b64 v[98:99], 0
v_mov_b64 v[100:101], 0
v_mov_b64 v[102:103], 0
v_mov_b64 v[104:105], 0
v_mov_b64 v[106:107], 0
v_mov_b64 v[108:109], 0
v_mov_b64 v[110:111], 0
v_mov_b64 v[112:113], 0
v_mov_b64 v[114:115], 0
v_mov_b64 v[116:117], 0
v_mov_b64 v[118:119], 0
v_mov_b64 v[120:121], 0
v_mov_b64 v[122:123], 0
v_mov_b64 v[124:125], 0
v_mov_b64 v[126:127], 0
v_mov_b32 v34, 126976
v_mov_b64 v[36:37], 0
v_mov_b64 v[38:39], 0
s_mov_b64 exec, 1
ds_write_b128 v34, v[36:39]
ds_write_b128 v34, v[36:39] offset:16
s_mov_b64 exec, -1
v_lshlrev_b32 v12, 4, v5
v_sub_u32 v12, v6, v12
v_mov_b32 v13, 0x3f80
v_mov_b32 v14, 1.0
v_cmp_eq_u32 vcc, 0, v12
v_cmp_eq_u32 s[60:61], 8, v12
s_nop 0
v_cndmask_b32 v248, 0, v13, vcc
v_cndmask_b32 v248, v248, v14, s[60:61]
v_cmp_eq_u32 vcc, 1, v12
v_cmp_eq_u32 s[60:61], 9, v12
s_nop 0
v_cndmask_b32 v249, 0, v13, vcc
v_cndmask_b32 v249, v249, v14, s[60:61]
v_cmp_eq_u32 vcc, 2, v12
v_cmp_eq_u32 s[60:61], 10, v12
s_nop 0
v_cndmask_b32 v250, 0, v13, vcc
v_cndmask_b32 v250, v250, v14, s[60:61]
v_cmp_eq_u32 vcc, 3, v12
v_cmp_eq_u32 s[60:61], 11, v12
s_nop 0
v_cndmask_b32 v251, 0, v13, vcc
v_cndmask_b32 v251, v251, v14, s[60:61]
v_cmp_eq_u32 vcc, 4, v12
v_cmp_eq_u32 s[60:61], 12, v12
s_nop 0
v_cndmask_b32 v252, 0, v13, vcc
v_cndmask_b32 v252, v252, v14, s[60:61]
v_cmp_eq_u32 vcc, 5, v12
v_cmp_eq_u32 s[60:61], 13, v12
s_nop 0
v_cndmask_b32 v253, 0, v13, vcc
v_cndmask_b32 v253, v253, v14, s[60:61]
v_cmp_eq_u32 vcc, 6, v12
v_cmp_eq_u32 s[60:61], 14, v12
s_nop 0
v_cndmask_b32 v254, 0, v13, vcc
v_cndmask_b32 v254, v254, v14, s[60:61]
v_cmp_eq_u32 vcc, 7, v12
v_cmp_eq_u32 s[60:61], 15, v12
s_nop 0
v_cndmask_b32 v255, 0, v13, vcc
v_cndmask_b32 v255, v255, v14, s[60:61]
s_add_u32 s40, s32, 65536
s_addc_u32 s41, s33, 0
s_mov_b32 s42, 262144
s_mov_b32 s43, 0x20000
s_add_u32 s44, s32, 1048576
s_addc_u32 s45, s33, 0
s_mov_b32 s46, 8388608
s_mov_b32 s47, 0x20000
s_waitcnt vmcnt(0)
v_lshlrev_b32 v8, 16, v8
v_lshlrev_b32 v9, 16, v9
v_lshlrev_b32 v10, 16, v10
v_mul_f32 v10, 0x3fb8aa3b, v10
v_exp_f32 v10, v10
s_nop 0
v_cvt_pk_bf16_f32 v10, v10, v10
v_lshlrev_b32 v10, 16, v10
v_mul_f32 v12, v10, v8
v_mul_f32 v13, v10, v9
v_mul_f32 v12, 0x3fb8aa3b, v12
v_exp_f32 v12, v12
v_mul_f32 v13, 0.15915494, v13
v_rndne_f32 v14, v13
v_sub_f32 v13, v13, v14
v_cos_f32 v14, v13
v_sin_f32 v15, v13
v_mul_f32 v24, v12, v14
v_mul_f32 v25, v12, v15
v_add_f32 v12, -1.0, v24
v_mul_f32 v13, v8, v8
v_fma_f32 v13, v9, v9, v13
v_rcp_f32 v13, v13
s_nop 0
v_add_f32 v13, v13, v13
v_mul_f32 v14, v12, v8
v_fma_f32 v14, v25, v9, v14
v_mul_f32 v26, v14, v13
v_mul_f32 v14, v25, v8
v_fma_f32 v14, -v12, v9, v14
v_mul_f32 v27, v14, v13
v_mul_f32 v12, v25, v25
v_mul_f32 v13, v24, v25
v_fma_f32 v28, v24, v24, -v12
v_add_f32 v29, v13, v13
v_mul_f32 v12, v29, v29
v_mul_f32 v13, v28, v29
v_fma_f32 v28, v28, v28, -v12
v_add_f32 v29, v13, v13
v_mul_f32 v12, v29, v29
v_mul_f32 v13, v28, v29
v_fma_f32 v28, v28, v28, -v12
v_add_f32 v29, v13, v13
v_mul_f32 v12, v29, v29
v_mul_f32 v13, v28, v29
v_fma_f32 v28, v28, v28, -v12
v_add_f32 v29, v13, v13
v_mul_f32 v12, v29, v29
v_mul_f32 v13, v28, v29
v_fma_f32 v20, v28, v28, -v12
v_add_f32 v21, v13, v13
v_mul_f32 v12, v21, v21
v_mul_f32 v13, v20, v21
v_fma_f32 v30, v20, v20, -v12
v_add_f32 v31, v13, v13
v_mul_f32 v12, v31, v31
v_mul_f32 v13, v30, v31
v_fma_f32 v30, v30, v30, -v12
v_add_f32 v31, v13, v13
v_mul_f32 v12, v31, v31
v_mul_f32 v13, v30, v31
v_fma_f32 v2, v30, v30, -v12
v_add_f32 v3, v13, v13
s_waitcnt lgkmcnt(0)
s_barrier
ds_read_b128 v[32:35], v128 offset:0
ds_read_b128 v[36:39], v132 offset:0
ds_read_b128 v[40:43], v132 offset:4096
ds_read_b128 v[44:47], v128 offset:4096
s_waitcnt lgkmcnt(2)
v_mfma_f32_32x32x16_bf16 v[64:79], v[32:35], v[36:39], v[64:79]
ds_read_b128 v[48:51], v129 offset:0
ds_read_b128 v[52:55], v133 offset:0
s_waitcnt lgkmcnt(3)
v_mfma_f32_32x32x16_bf16 v[80:95], v[32:35], v[40:43], v[80:95]
ds_read_b128 v[56:59], v133 offset:4096
ds_read_b128 v[60:63], v129 offset:4096
s_waitcnt lgkmcnt(4)
v_mfma_f32_32x32x16_bf16 v[96:111], v[44:47], v[36:39], v[96:111]
v_mfma_f32_32x32x16_bf16 v[112:127], v[44:47], v[40:43], v[112:127]
s_waitcnt lgkmcnt(2)
v_mfma_f32_32x32x16_bf16 v[64:79], v[48:51], v[52:55], v[64:79]
ds_read_b128 v[32:35], v130 offset:0
ds_read_b128 v[36:39], v134 offset:0
s_waitcnt lgkmcnt(3)
v_mfma_f32_32x32x16_bf16 v[80:95], v[48:51], v[56:59], v[80:95]
ds_read_b128 v[40:43], v134 offset:4096
ds_read_b128 v[44:47], v130 offset:4096
s_waitcnt lgkmcnt(4)
v_mfma_f32_32x32x16_bf16 v[96:111], v[60:63], v[52:55], v[96:111]
v_mfma_f32_32x32x16_bf16 v[112:127], v[60:63], v[56:59], v[112:127]
s_waitcnt lgkmcnt(2)
v_mfma_f32_32x32x16_bf16 v[64:79], v[32:35], v[36:39], v[64:79]
ds_read_b128 v[48:51], v131 offset:0
ds_read_b128 v[52:55], v135 offset:0
s_waitcnt lgkmcnt(3)
v_mfma_f32_32x32x16_bf16 v[80:95], v[32:35], v[40:43], v[80:95]
ds_read_b128 v[56:59], v135 offset:4096
ds_read_b128 v[60:63], v131 offset:4096
s_waitcnt lgkmcnt(4)
v_mfma_f32_32x32x16_bf16 v[96:111], v[44:47], v[36:39], v[96:111]
v_mfma_f32_32x32x16_bf16 v[112:127], v[44:47], v[40:43], v[112:127]
s_waitcnt lgkmcnt(0)
s_barrier
v_mfma_f32_32x32x16_bf16 v[64:79], v[48:51], v[52:55], v[64:79]
ds_read_b128 v[32:35], v128 offset:32768
ds_read_b128 v[36:39], v132 offset:32768
v_mfma_f32_32x32x16_bf16 v[80:95], v[48:51], v[56:59], v[80:95]
ds_read_b128 v[40:43], v132 offset:36864
ds_read_b128 v[44:47], v128 offset:36864
v_mfma_f32_32x32x16_bf16 v[96:111], v[60:63], v[52:55], v[96:111]
v_mfma_f32_32x32x16_bf16 v[112:127], v[60:63], v[56:59], v[112:127]
s_waitcnt lgkmcnt(2)
v_mfma_f32_32x32x16_bf16 v[64:79], v[32:35], v[36:39], v[64:79]
ds_read_b128 v[48:51], v129 offset:32768
ds_read_b128 v[52:55], v133 offset:32768
s_waitcnt lgkmcnt(3)
v_mfma_f32_32x32x16_bf16 v[80:95], v[32:35], v[40:43], v[80:95]
ds_read_b128 v[56:59], v133 offset:36864
ds_read_b128 v[60:63], v129 offset:36864
s_waitcnt lgkmcnt(4)
v_mfma_f32_32x32x16_bf16 v[96:111], v[44:47], v[36:39], v[96:111]
v_mfma_f32_32x32x16_bf16 v[112:127], v[44:47], v[40:43], v[112:127]
s_waitcnt lgkmcnt(2)
v_mfma_f32_32x32x16_bf16 v[64:79], v[48:51], v[52:55], v[64:79]
ds_read_b128 v[32:35], v130 offset:32768
ds_read_b128 v[36:39], v134 offset:32768
s_waitcnt lgkmcnt(3)
v_mfma_f32_32x32x16_bf16 v[80:95], v[48:51], v[56:59], v[80:95]
ds_read_b128 v[40:43], v134 offset:36864
ds_read_b128 v[44:47], v130 offset:36864
s_waitcnt lgkmcnt(4)
v_mfma_f32_32x32x16_bf16 v[96:111], v[60:63], v[52:55], v[96:111]
v_mfma_f32_32x32x16_bf16 v[112:127], v[60:63], v[56:59], v[112:127]
s_waitcnt lgkmcnt(2)
v_mfma_f32_32x32x16_bf16 v[64:79], v[32:35], v[36:39], v[64:79]
ds_read_b128 v[48:51], v131 offset:32768
ds_read_b128 v[52:55], v135 offset:32768
s_waitcnt lgkmcnt(3)
v_mfma_f32_32x32x16_bf16 v[80:95], v[32:35], v[40:43], v[80:95]
ds_read_b128 v[56:59], v135 offset:36864
ds_read_b128 v[60:63], v131 offset:36864
s_waitcnt lgkmcnt(4)
v_mfma_f32_32x32x16_bf16 v[96:111], v[44:47], v[36:39], v[96:111]
v_mfma_f32_32x32x16_bf16 v[112:127], v[44:47], v[40:43], v[112:127]
s_waitcnt lgkmcnt(0)
s_barrier
v_mfma_f32_32x32x16_bf16 v[64:79], v[48:51], v[52:55], v[64:79]
ds_read_b128 v[32:35], v136 offset:0
ds_read_b128 v[36:39], v140 offset:0
v_mfma_f32_32x32x16_bf16 v[80:95], v[48:51], v[56:59], v[80:95]
ds_read_b128 v[40:43], v140 offset:4096
ds_read_b128 v[44:47], v136 offset:4096
v_mfma_f32_32x32x16_bf16 v[96:111], v[60:63], v[52:55], v[96:111]
v_mfma_f32_32x32x16_bf16 v[112:127], v[60:63], v[56:59], v[112:127]
s_waitcnt lgkmcnt(2)
v_mfma_f32_32x32x16_bf16 v[64:79], v[32:35], v[36:39], v[64:79]
ds_read_b128 v[48:51], v137 offset:0
ds_read_b128 v[52:55], v141 offset:0
s_waitcnt lgkmcnt(3)
v_mfma_f32_32x32x16_bf16 v[80:95], v[32:35], v[40:43], v[80:95]
ds_read_b128 v[56:59], v141 offset:4096
ds_read_b128 v[60:63], v137 offset:4096
s_waitcnt lgkmcnt(4)
v_mfma_f32_32x32x16_bf16 v[96:111], v[44:47], v[36:39], v[96:111]
v_mfma_f32_32x32x16_bf16 v[112:127], v[44:47], v[40:43], v[112:127]
s_waitcnt lgkmcnt(2)
v_mfma_f32_32x32x16_bf16 v[64:79], v[48:51], v[52:55], v[64:79]
ds_read_b128 v[32:35], v138 offset:0
ds_read_b128 v[36:39], v142 offset:0
s_waitcnt lgkmcnt(3)
v_mfma_f32_32x32x16_bf16 v[80:95], v[48:51], v[56:59], v[80:95]
ds_read_b128 v[40:43], v142 offset:4096
ds_read_b128 v[44:47], v138 offset:4096
s_waitcnt lgkmcnt(4)
v_mfma_f32_32x32x16_bf16 v[96:111], v[60:63], v[52:55], v[96:111]
v_mfma_f32_32x32x16_bf16 v[112:127], v[60:63], v[56:59], v[112:127]
s_waitcnt lgkmcnt(2)
v_mfma_f32_32x32x16_bf16 v[64:79], v[32:35], v[36:39], v[64:79]
ds_read_b128 v[48:51], v139 offset:0
ds_read_b128 v[52:55], v143 offset:0
s_waitcnt lgkmcnt(3)
v_mfma_f32_32x32x16_bf16 v[80:95], v[32:35], v[40:43], v[80:95]
ds_read_b128 v[56:59], v143 offset:4096
ds_read_b128 v[60:63], v139 offset:4096
s_waitcnt lgkmcnt(4)
v_mfma_f32_32x32x16_bf16 v[96:111], v[44:47], v[36:39], v[96:111]
v_mfma_f32_32x32x16_bf16 v[112:127], v[44:47], v[40:43], v[112:127]
s_waitcnt lgkmcnt(0)
s_barrier
v_mfma_f32_32x32x16_bf16 v[64:79], v[48:51], v[52:55], v[64:79]
ds_read_b128 v[32:35], v128 offset:0
ds_read_b128 v[36:39], v132 offset:0
v_mfma_f32_32x32x16_bf16 v[80:95], v[48:51], v[56:59], v[80:95]
ds_read_b128 v[40:43], v132 offset:4096
ds_read_b128 v[44:47], v128 offset:4096
v_mfma_f32_32x32x16_bf16 v[96:111], v[60:63], v[52:55], v[96:111]
v_mfma_f32_32x32x16_bf16 v[112:127], v[60:63], v[56:59], v[112:127]
s_waitcnt lgkmcnt(2)
v_mfma_f32_32x32x16_bf16 v[64:79], v[32:35], v[36:39], v[64:79]
ds_read_b128 v[48:51], v129 offset:0
ds_read_b128 v[52:55], v133 offset:0
s_waitcnt lgkmcnt(3)
v_mfma_f32_32x32x16_bf16 v[80:95], v[32:35], v[40:43], v[80:95]
ds_read_b128 v[56:59], v133 offset:4096
ds_read_b128 v[60:63], v129 offset:4096
s_waitcnt lgkmcnt(4)
v_mfma_f32_32x32x16_bf16 v[96:111], v[44:47], v[36:39], v[96:111]
v_mfma_f32_32x32x16_bf16 v[112:127], v[44:47], v[40:43], v[112:127]
s_waitcnt lgkmcnt(2)
v_mfma_f32_32x32x16_bf16 v[64:79], v[48:51], v[52:55], v[64:79]
ds_read_b128 v[32:35], v130 offset:0
ds_read_b128 v[36:39], v134 offset:0
s_waitcnt lgkmcnt(3)
v_mfma_f32_32x32x16_bf16 v[80:95], v[48:51], v[56:59], v[80:95]
ds_read_b128 v[40:43], v134 offset:4096
ds_read_b128 v[44:47], v130 offset:4096
s_waitcnt lgkmcnt(4)
v_mfma_f32_32x32x16_bf16 v[96:111], v[60:63], v[52:55], v[96:111]
v_mfma_f32_32x32x16_bf16 v[112:127], v[60:63], v[56:59], v[112:127]
s_waitcnt lgkmcnt(2)
v_mfma_f32_32x32x16_bf16 v[64:79], v[32:35], v[36:39], v[64:79]
ds_read_b128 v[48:51], v131 offset:0
ds_read_b128 v[52:55], v135 offset:0
s_waitcnt lgkmcnt(3)
v_mfma_f32_32x32x16_bf16 v[80:95], v[32:35], v[40:43], v[80:95]
ds_read_b128 v[56:59], v135 offset:4096
ds_read_b128 v[60:63], v131 offset:4096
s_waitcnt lgkmcnt(4)
v_mfma_f32_32x32x16_bf16 v[96:111], v[44:47], v[36:39], v[96:111]
v_mfma_f32_32x32x16_bf16 v[112:127], v[44:47], v[40:43], v[112:127]
s_waitcnt lgkmcnt(0)
s_barrier
v_mfma_f32_32x32x16_bf16 v[64:79], v[48:51], v[52:55], v[64:79]
ds_read_b128 v[32:35], v128 offset:32768
ds_read_b128 v[36:39], v132 offset:32768
v_mfma_f32_32x32x16_bf16 v[80:95], v[48:51], v[56:59], v[80:95]
ds_read_b128 v[40:43], v132 offset:36864
ds_read_b128 v[44:47], v128 offset:36864
v_mfma_f32_32x32x16_bf16 v[96:111], v[60:63], v[52:55], v[96:111]
v_mfma_f32_32x32x16_bf16 v[112:127], v[60:63], v[56:59], v[112:127]
s_waitcnt lgkmcnt(2)
v_mfma_f32_32x32x16_bf16 v[64:79], v[32:35], v[36:39], v[64:79]
ds_read_b128 v[48:51], v129 offset:32768
ds_read_b128 v[52:55], v133 offset:32768
s_waitcnt lgkmcnt(3)
v_mfma_f32_32x32x16_bf16 v[80:95], v[32:35], v[40:43], v[80:95]
ds_read_b128 v[56:59], v133 offset:36864
ds_read_b128 v[60:63], v129 offset:36864
s_waitcnt lgkmcnt(4)
v_mfma_f32_32x32x16_bf16 v[96:111], v[44:47], v[36:39], v[96:111]
v_mfma_f32_32x32x16_bf16 v[112:127], v[44:47], v[40:43], v[112:127]
s_waitcnt lgkmcnt(2)
v_mfma_f32_32x32x16_bf16 v[64:79], v[48:51], v[52:55], v[64:79]
ds_read_b128 v[32:35], v130 offset:32768
ds_read_b128 v[36:39], v134 offset:32768
s_waitcnt lgkmcnt(3)
v_mfma_f32_32x32x16_bf16 v[80:95], v[48:51], v[56:59], v[80:95]
ds_read_b128 v[40:43], v134 offset:36864
ds_read_b128 v[44:47], v130 offset:36864
s_waitcnt lgkmcnt(4)
v_mfma_f32_32x32x16_bf16 v[96:111], v[60:63], v[52:55], v[96:111]
v_mfma_f32_32x32x16_bf16 v[112:127], v[60:63], v[56:59], v[112:127]
s_waitcnt lgkmcnt(2)
v_mfma_f32_32x32x16_bf16 v[64:79], v[32:35], v[36:39], v[64:79]
ds_read_b128 v[48:51], v131 offset:32768
ds_read_b128 v[52:55], v135 offset:32768
s_waitcnt lgkmcnt(3)
v_mfma_f32_32x32x16_bf16 v[80:95], v[32:35], v[40:43], v[80:95]
ds_read_b128 v[56:59], v135 offset:36864
ds_read_b128 v[60:63], v131 offset:36864
s_waitcnt lgkmcnt(4)
v_mfma_f32_32x32x16_bf16 v[96:111], v[44:47], v[36:39], v[96:111]
v_mfma_f32_32x32x16_bf16 v[112:127], v[44:47], v[40:43], v[112:127]
s_waitcnt lgkmcnt(0)
s_barrier
v_mfma_f32_32x32x16_bf16 v[64:79], v[48:51], v[52:55], v[64:79]
ds_read_b128 v[32:35], v136 offset:0
ds_read_b128 v[36:39], v140 offset:0
v_mfma_f32_32x32x16_bf16 v[80:95], v[48:51], v[56:59], v[80:95]
ds_read_b128 v[40:43], v140 offset:4096
ds_read_b128 v[44:47], v136 offset:4096
v_mfma_f32_32x32x16_bf16 v[96:111], v[60:63], v[52:55], v[96:111]
v_mfma_f32_32x32x16_bf16 v[112:127], v[60:63], v[56:59], v[112:127]
s_waitcnt lgkmcnt(2)
v_mfma_f32_32x32x16_bf16 v[64:79], v[32:35], v[36:39], v[64:79]
ds_read_b128 v[48:51], v137 offset:0
ds_read_b128 v[52:55], v141 offset:0
s_waitcnt lgkmcnt(3)
v_mfma_f32_32x32x16_bf16 v[80:95], v[32:35], v[40:43], v[80:95]
ds_read_b128 v[56:59], v141 offset:4096
ds_read_b128 v[60:63], v137 offset:4096
s_waitcnt lgkmcnt(4)
v_mfma_f32_32x32x16_bf16 v[96:111], v[44:47], v[36:39], v[96:111]
v_mfma_f32_32x32x16_bf16 v[112:127], v[44:47], v[40:43], v[112:127]
s_waitcnt lgkmcnt(2)
v_mfma_f32_32x32x16_bf16 v[64:79], v[48:51], v[52:55], v[64:79]
ds_read_b128 v[32:35], v138 offset:0
ds_read_b128 v[36:39], v142 offset:0
s_waitcnt lgkmcnt(3)
v_mfma_f32_32x32x16_bf16 v[80:95], v[48:51], v[56:59], v[80:95]
ds_read_b128 v[40:43], v142 offset:4096
ds_read_b128 v[44:47], v138 offset:4096
s_waitcnt lgkmcnt(4)
v_mfma_f32_32x32x16_bf16 v[96:111], v[60:63], v[52:55], v[96:111]
v_mfma_f32_32x32x16_bf16 v[112:127], v[60:63], v[56:59], v[112:127]
s_waitcnt lgkmcnt(2)
v_mfma_f32_32x32x16_bf16 v[64:79], v[32:35], v[36:39], v[64:79]
ds_read_b128 v[48:51], v139 offset:0
ds_read_b128 v[52:55], v143 offset:0
s_waitcnt lgkmcnt(3)
v_mfma_f32_32x32x16_bf16 v[80:95], v[32:35], v[40:43], v[80:95]
ds_read_b128 v[56:59], v143 offset:4096
ds_read_b128 v[60:63], v139 offset:4096
s_waitcnt lgkmcnt(4)
v_mfma_f32_32x32x16_bf16 v[96:111], v[44:47], v[36:39], v[96:111]
v_mfma_f32_32x32x16_bf16 v[112:127], v[44:47], v[40:43], v[112:127]
s_waitcnt lgkmcnt(0)
s_barrier
v_mfma_f32_32x32x16_bf16 v[64:79], v[48:51], v[52:55], v[64:79]
ds_read_b128 v[32:35], v128 offset:0
ds_read_b128 v[36:39], v132 offset:0
v_mfma_f32_32x32x16_bf16 v[80:95], v[48:51], v[56:59], v[80:95]
ds_read_b128 v[40:43], v132 offset:4096
ds_read_b128 v[44:47], v128 offset:4096
v_mfma_f32_32x32x16_bf16 v[96:111], v[60:63], v[52:55], v[96:111]
v_mfma_f32_32x32x16_bf16 v[112:127], v[60:63], v[56:59], v[112:127]
s_waitcnt lgkmcnt(2)
v_mfma_f32_32x32x16_bf16 v[64:79], v[32:35], v[36:39], v[64:79]
ds_read_b128 v[48:51], v129 offset:0
ds_read_b128 v[52:55], v133 offset:0
s_waitcnt lgkmcnt(3)
v_mfma_f32_32x32x16_bf16 v[80:95], v[32:35], v[40:43], v[80:95]
ds_read_b128 v[56:59], v133 offset:4096
ds_read_b128 v[60:63], v129 offset:4096
s_waitcnt lgkmcnt(4)
v_mfma_f32_32x32x16_bf16 v[96:111], v[44:47], v[36:39], v[96:111]
v_mfma_f32_32x32x16_bf16 v[112:127], v[44:47], v[40:43], v[112:127]
s_waitcnt lgkmcnt(2)
v_mfma_f32_32x32x16_bf16 v[64:79], v[48:51], v[52:55], v[64:79]
ds_read_b128 v[32:35], v130 offset:0
ds_read_b128 v[36:39], v134 offset:0
s_waitcnt lgkmcnt(3)
v_mfma_f32_32x32x16_bf16 v[80:95], v[48:51], v[56:59], v[80:95]
ds_read_b128 v[40:43], v134 offset:4096
ds_read_b128 v[44:47], v130 offset:4096
s_waitcnt lgkmcnt(4)
v_mfma_f32_32x32x16_bf16 v[96:111], v[60:63], v[52:55], v[96:111]
v_mfma_f32_32x32x16_bf16 v[112:127], v[60:63], v[56:59], v[112:127]
s_waitcnt lgkmcnt(2)
v_mfma_f32_32x32x16_bf16 v[64:79], v[32:35], v[36:39], v[64:79]
ds_read_b128 v[48:51], v131 offset:0
ds_read_b128 v[52:55], v135 offset:0
s_waitcnt lgkmcnt(3)
v_mfma_f32_32x32x16_bf16 v[80:95], v[32:35], v[40:43], v[80:95]
ds_read_b128 v[56:59], v135 offset:4096
ds_read_b128 v[60:63], v131 offset:4096
s_waitcnt lgkmcnt(4)
v_mfma_f32_32x32x16_bf16 v[96:111], v[44:47], v[36:39], v[96:111]
v_mfma_f32_32x32x16_bf16 v[112:127], v[44:47], v[40:43], v[112:127]
s_waitcnt lgkmcnt(0)
s_barrier
v_mfma_f32_32x32x16_bf16 v[64:79], v[48:51], v[52:55], v[64:79]
ds_read_b128 v[32:35], v128 offset:32768
ds_read_b128 v[36:39], v132 offset:32768
v_mfma_f32_32x32x16_bf16 v[80:95], v[48:51], v[56:59], v[80:95]
ds_read_b128 v[40:43], v132 offset:36864
ds_read_b128 v[44:47], v128 offset:36864
v_mfma_f32_32x32x16_bf16 v[96:111], v[60:63], v[52:55], v[96:111]
v_mfma_f32_32x32x16_bf16 v[112:127], v[60:63], v[56:59], v[112:127]
s_waitcnt lgkmcnt(2)
v_mfma_f32_32x32x16_bf16 v[64:79], v[32:35], v[36:39], v[64:79]
ds_read_b128 v[48:51], v129 offset:32768
ds_read_b128 v[52:55], v133 offset:32768
s_waitcnt lgkmcnt(3)
v_mfma_f32_32x32x16_bf16 v[80:95], v[32:35], v[40:43], v[80:95]
ds_read_b128 v[56:59], v133 offset:36864
ds_read_b128 v[60:63], v129 offset:36864
s_waitcnt lgkmcnt(4)
v_mfma_f32_32x32x16_bf16 v[96:111], v[44:47], v[36:39], v[96:111]
v_mfma_f32_32x32x16_bf16 v[112:127], v[44:47], v[40:43], v[112:127]
s_waitcnt lgkmcnt(2)
v_mfma_f32_32x32x16_bf16 v[64:79], v[48:51], v[52:55], v[64:79]
ds_read_b128 v[32:35], v130 offset:32768
ds_read_b128 v[36:39], v134 offset:32768
s_waitcnt lgkmcnt(3)
v_mfma_f32_32x32x16_bf16 v[80:95], v[48:51], v[56:59], v[80:95]
ds_read_b128 v[40:43], v134 offset:36864
ds_read_b128 v[44:47], v130 offset:36864
s_waitcnt lgkmcnt(4)
v_mfma_f32_32x32x16_bf16 v[96:111], v[60:63], v[52:55], v[96:111]
v_mfma_f32_32x32x16_bf16 v[112:127], v[60:63], v[56:59], v[112:127]
s_waitcnt lgkmcnt(2)
v_mfma_f32_32x32x16_bf16 v[64:79], v[32:35], v[36:39], v[64:79]
ds_read_b128 v[48:51], v131 offset:32768
ds_read_b128 v[52:55], v135 offset:32768
s_waitcnt lgkmcnt(3)
v_mfma_f32_32x32x16_bf16 v[80:95], v[32:35], v[40:43], v[80:95]
ds_read_b128 v[56:59], v135 offset:36864
ds_read_b128 v[60:63], v131 offset:36864
s_waitcnt lgkmcnt(4)
v_mfma_f32_32x32x16_bf16 v[96:111], v[44:47], v[36:39], v[96:111]
v_mfma_f32_32x32x16_bf16 v[112:127], v[44:47], v[40:43], v[112:127]
s_waitcnt lgkmcnt(0)
s_barrier
v_mfma_f32_32x32x16_bf16 v[64:79], v[48:51], v[52:55], v[64:79]
ds_read_b128 v[32:35], v136 offset:0
ds_read_b128 v[36:39], v140 offset:0
v_mfma_f32_32x32x16_bf16 v[80:95], v[48:51], v[56:59], v[80:95]
ds_read_b128 v[40:43], v140 offset:4096
ds_read_b128 v[44:47], v136 offset:4096
v_mfma_f32_32x32x16_bf16 v[96:111], v[60:63], v[52:55], v[96:111]
v_mfma_f32_32x32x16_bf16 v[112:127], v[60:63], v[56:59], v[112:127]
s_waitcnt lgkmcnt(2)
v_mfma_f32_32x32x16_bf16 v[64:79], v[32:35], v[36:39], v[64:79]
ds_read_b128 v[48:51], v137 offset:0
ds_read_b128 v[52:55], v141 offset:0
s_waitcnt lgkmcnt(3)
v_mfma_f32_32x32x16_bf16 v[80:95], v[32:35], v[40:43], v[80:95]
ds_read_b128 v[56:59], v141 offset:4096
ds_read_b128 v[60:63], v137 offset:4096
s_waitcnt lgkmcnt(4)
v_mfma_f32_32x32x16_bf16 v[96:111], v[44:47], v[36:39], v[96:111]
v_mfma_f32_32x32x16_bf16 v[112:127], v[44:47], v[40:43], v[112:127]
s_waitcnt lgkmcnt(2)
v_mfma_f32_32x32x16_bf16 v[64:79], v[48:51], v[52:55], v[64:79]
ds_read_b128 v[32:35], v138 offset:0
ds_read_b128 v[36:39], v142 offset:0
s_waitcnt lgkmcnt(3)
v_mfma_f32_32x32x16_bf16 v[80:95], v[48:51], v[56:59], v[80:95]
ds_read_b128 v[40:43], v142 offset:4096
ds_read_b128 v[44:47], v138 offset:4096
s_waitcnt lgkmcnt(4)
v_mfma_f32_32x32x16_bf16 v[96:111], v[60:63], v[52:55], v[96:111]
v_mfma_f32_32x32x16_bf16 v[112:127], v[60:63], v[56:59], v[112:127]
s_waitcnt lgkmcnt(2)
v_mfma_f32_32x32x16_bf16 v[64:79], v[32:35], v[36:39], v[64:79]
ds_read_b128 v[48:51], v139 offset:0
ds_read_b128 v[52:55], v143 offset:0
s_waitcnt lgkmcnt(3)
v_mfma_f32_32x32x16_bf16 v[80:95], v[32:35], v[40:43], v[80:95]
ds_read_b128 v[56:59], v143 offset:4096
ds_read_b128 v[60:63], v139 offset:4096
s_waitcnt lgkmcnt(4)
v_mfma_f32_32x32x16_bf16 v[96:111], v[44:47], v[36:39], v[96:111]
v_mfma_f32_32x32x16_bf16 v[112:127], v[44:47], v[40:43], v[112:127]
s_waitcnt lgkmcnt(0)
s_barrier
v_mfma_f32_32x32x16_bf16 v[64:79], v[48:51], v[52:55], v[64:79]
ds_read_b128 v[32:35], v128 offset:0
ds_read_b128 v[36:39], v132 offset:0
v_mfma_f32_32x32x16_bf16 v[80:95], v[48:51], v[56:59], v[80:95]
ds_read_b128 v[40:43], v132 offset:4096
ds_read_b128 v[44:47], v128 offset:4096
v_mfma_f32_32x32x16_bf16 v[96:111], v[60:63], v[52:55], v[96:111]
v_mfma_f32_32x32x16_bf16 v[112:127], v[60:63], v[56:59], v[112:127]
s_waitcnt lgkmcnt(2)
v_mfma_f32_32x32x16_bf16 v[64:79], v[32:35], v[36:39], v[64:79]
ds_read_b128 v[48:51], v129 offset:0
ds_read_b128 v[52:55], v133 offset:0
s_waitcnt lgkmcnt(3)
v_mfma_f32_32x32x16_bf16 v[80:95], v[32:35], v[40:43], v[80:95]
ds_read_b128 v[56:59], v133 offset:4096
ds_read_b128 v[60:63], v129 offset:4096
s_waitcnt lgkmcnt(4)
v_mfma_f32_32x32x16_bf16 v[96:111], v[44:47], v[36:39], v[96:111]
v_mfma_f32_32x32x16_bf16 v[112:127], v[44:47], v[40:43], v[112:127]
s_waitcnt lgkmcnt(2)
v_mfma_f32_32x32x16_bf16 v[64:79], v[48:51], v[52:55], v[64:79]
ds_read_b128 v[32:35], v130 offset:0
ds_read_b128 v[36:39], v134 offset:0
s_waitcnt lgkmcnt(3)
v_mfma_f32_32x32x16_bf16 v[80:95], v[48:51], v[56:59], v[80:95]
ds_read_b128 v[40:43], v134 offset:4096
ds_read_b128 v[44:47], v130 offset:4096
s_waitcnt lgkmcnt(4)
v_mfma_f32_32x32x16_bf16 v[96:111], v[60:63], v[52:55], v[96:111]
v_mfma_f32_32x32x16_bf16 v[112:127], v[60:63], v[56:59], v[112:127]
s_waitcnt lgkmcnt(2)
v_mfma_f32_32x32x16_bf16 v[64:79], v[32:35], v[36:39], v[64:79]
ds_read_b128 v[48:51], v131 offset:0
ds_read_b128 v[52:55], v135 offset:0
s_waitcnt lgkmcnt(3)
v_mfma_f32_32x32x16_bf16 v[80:95], v[32:35], v[40:43], v[80:95]
ds_read_b128 v[56:59], v135 offset:4096
ds_read_b128 v[60:63], v131 offset:4096
s_waitcnt lgkmcnt(4)
v_mfma_f32_32x32x16_bf16 v[96:111], v[44:47], v[36:39], v[96:111]
v_mfma_f32_32x32x16_bf16 v[112:127], v[44:47], v[40:43], v[112:127]
s_waitcnt lgkmcnt(0)
s_barrier
v_mfma_f32_32x32x16_bf16 v[64:79], v[48:51], v[52:55], v[64:79]
ds_read_b128 v[32:35], v128 offset:32768
ds_read_b128 v[36:39], v132 offset:32768
v_mfma_f32_32x32x16_bf16 v[80:95], v[48:51], v[56:59], v[80:95]
ds_read_b128 v[40:43], v132 offset:36864
ds_read_b128 v[44:47], v128 offset:36864
v_mfma_f32_32x32x16_bf16 v[96:111], v[60:63], v[52:55], v[96:111]
v_mfma_f32_32x32x16_bf16 v[112:127], v[60:63], v[56:59], v[112:127]
s_waitcnt lgkmcnt(2)
v_mfma_f32_32x32x16_bf16 v[64:79], v[32:35], v[36:39], v[64:79]
ds_read_b128 v[48:51], v129 offset:32768
ds_read_b128 v[52:55], v133 offset:32768
s_waitcnt lgkmcnt(3)
v_mfma_f32_32x32x16_bf16 v[80:95], v[32:35], v[40:43], v[80:95]
ds_read_b128 v[56:59], v133 offset:36864
ds_read_b128 v[60:63], v129 offset:36864
s_waitcnt lgkmcnt(4)
v_mfma_f32_32x32x16_bf16 v[96:111], v[44:47], v[36:39], v[96:111]
v_mfma_f32_32x32x16_bf16 v[112:127], v[44:47], v[40:43], v[112:127]
s_waitcnt lgkmcnt(2)
v_mfma_f32_32x32x16_bf16 v[64:79], v[48:51], v[52:55], v[64:79]
ds_read_b128 v[32:35], v130 offset:32768
ds_read_b128 v[36:39], v134 offset:32768
s_waitcnt lgkmcnt(3)
v_mfma_f32_32x32x16_bf16 v[80:95], v[48:51], v[56:59], v[80:95]
ds_read_b128 v[40:43], v134 offset:36864
ds_read_b128 v[44:47], v130 offset:36864
s_waitcnt lgkmcnt(4)
v_mfma_f32_32x32x16_bf16 v[96:111], v[60:63], v[52:55], v[96:111]
v_mfma_f32_32x32x16_bf16 v[112:127], v[60:63], v[56:59], v[112:127]
s_waitcnt lgkmcnt(2)
v_mfma_f32_32x32x16_bf16 v[64:79], v[32:35], v[36:39], v[64:79]
ds_read_b128 v[48:51], v131 offset:32768
ds_read_b128 v[52:55], v135 offset:32768
s_waitcnt lgkmcnt(3)
v_mfma_f32_32x32x16_bf16 v[80:95], v[32:35], v[40:43], v[80:95]
ds_read_b128 v[56:59], v135 offset:36864
ds_read_b128 v[60:63], v131 offset:36864
s_waitcnt lgkmcnt(4)
v_mfma_f32_32x32x16_bf16 v[96:111], v[44:47], v[36:39], v[96:111]
v_mfma_f32_32x32x16_bf16 v[112:127], v[44:47], v[40:43], v[112:127]
s_waitcnt lgkmcnt(0)
s_barrier
v_mfma_f32_32x32x16_bf16 v[64:79], v[48:51], v[52:55], v[64:79]
ds_read_b128 v[32:35], v136 offset:0
ds_read_b128 v[36:39], v140 offset:0
v_mfma_f32_32x32x16_bf16 v[80:95], v[48:51], v[56:59], v[80:95]
ds_read_b128 v[40:43], v140 offset:4096
ds_read_b128 v[44:47], v136 offset:4096
v_mfma_f32_32x32x16_bf16 v[96:111], v[60:63], v[52:55], v[96:111]
v_mfma_f32_32x32x16_bf16 v[112:127], v[60:63], v[56:59], v[112:127]
s_waitcnt lgkmcnt(2)
v_mfma_f32_32x32x16_bf16 v[64:79], v[32:35], v[36:39], v[64:79]
ds_read_b128 v[48:51], v137 offset:0
ds_read_b128 v[52:55], v141 offset:0
s_waitcnt lgkmcnt(3)
v_mfma_f32_32x32x16_bf16 v[80:95], v[32:35], v[40:43], v[80:95]
ds_read_b128 v[56:59], v141 offset:4096
ds_read_b128 v[60:63], v137 offset:4096
s_waitcnt lgkmcnt(4)
v_mfma_f32_32x32x16_bf16 v[96:111], v[44:47], v[36:39], v[96:111]
v_mfma_f32_32x32x16_bf16 v[112:127], v[44:47], v[40:43], v[112:127]
s_waitcnt lgkmcnt(2)
v_mfma_f32_32x32x16_bf16 v[64:79], v[48:51], v[52:55], v[64:79]
ds_read_b128 v[32:35], v138 offset:0
ds_read_b128 v[36:39], v142 offset:0
s_waitcnt lgkmcnt(3)
v_mfma_f32_32x32x16_bf16 v[80:95], v[48:51], v[56:59], v[80:95]
ds_read_b128 v[40:43], v142 offset:4096
ds_read_b128 v[44:47], v138 offset:4096
s_waitcnt lgkmcnt(4)
v_mfma_f32_32x32x16_bf16 v[96:111], v[60:63], v[52:55], v[96:111]
v_mfma_f32_32x32x16_bf16 v[112:127], v[60:63], v[56:59], v[112:127]
s_waitcnt lgkmcnt(2)
v_mfma_f32_32x32x16_bf16 v[64:79], v[32:35], v[36:39], v[64:79]
ds_read_b128 v[48:51], v139 offset:0
ds_read_b128 v[52:55], v143 offset:0
s_waitcnt lgkmcnt(3)
v_mfma_f32_32x32x16_bf16 v[80:95], v[32:35], v[40:43], v[80:95]
ds_read_b128 v[56:59], v143 offset:4096
ds_read_b128 v[60:63], v139 offset:4096
s_waitcnt lgkmcnt(4)
v_mfma_f32_32x32x16_bf16 v[96:111], v[44:47], v[36:39], v[96:111]
v_mfma_f32_32x32x16_bf16 v[112:127], v[44:47], v[40:43], v[112:127]
s_waitcnt lgkmcnt(0)
s_barrier
v_mfma_f32_32x32x16_bf16 v[64:79], v[48:51], v[52:55], v[64:79]
ds_read_b128 v[32:35], v128 offset:0
ds_read_b128 v[36:39], v132 offset:0
v_mfma_f32_32x32x16_bf16 v[80:95], v[48:51], v[56:59], v[80:95]
ds_read_b128 v[40:43], v132 offset:4096
ds_read_b128 v[44:47], v128 offset:4096
v_mfma_f32_32x32x16_bf16 v[96:111], v[60:63], v[52:55], v[96:111]
v_mfma_f32_32x32x16_bf16 v[112:127], v[60:63], v[56:59], v[112:127]
s_waitcnt lgkmcnt(2)
v_mov_b32 v12, 0
global_load_dword v13, v12, s[30:31] sc1
v_mfma_f32_32x32x16_bf16 v[64:79], v[32:35], v[36:39], v[64:79]
ds_read_b128 v[48:51], v129 offset:0
ds_read_b128 v[52:55], v133 offset:0
s_waitcnt lgkmcnt(3)
v_mfma_f32_32x32x16_bf16 v[80:95], v[32:35], v[40:43], v[80:95]
ds_read_b128 v[56:59], v133 offset:4096
ds_read_b128 v[60:63], v129 offset:4096
s_waitcnt lgkmcnt(4)
v_mfma_f32_32x32x16_bf16 v[96:111], v[44:47], v[36:39], v[96:111]
v_mfma_f32_32x32x16_bf16 v[112:127], v[44:47], v[40:43], v[112:127]
s_waitcnt lgkmcnt(2)
v_mfma_f32_32x32x16_bf16 v[64:79], v[48:51], v[52:55], v[64:79]
ds_read_b128 v[32:35], v130 offset:0
ds_read_b128 v[36:39], v134 offset:0
s_waitcnt lgkmcnt(3)
v_mfma_f32_32x32x16_bf16 v[80:95], v[48:51], v[56:59], v[80:95]
ds_read_b128 v[40:43], v134 offset:4096
ds_read_b128 v[44:47], v130 offset:4096
s_waitcnt lgkmcnt(4)
v_mfma_f32_32x32x16_bf16 v[96:111], v[60:63], v[52:55], v[96:111]
v_mfma_f32_32x32x16_bf16 v[112:127], v[60:63], v[56:59], v[112:127]
s_waitcnt lgkmcnt(2)
v_mfma_f32_32x32x16_bf16 v[64:79], v[32:35], v[36:39], v[64:79]
ds_read_b128 v[48:51], v131 offset:0
ds_read_b128 v[52:55], v135 offset:0
s_waitcnt lgkmcnt(3)
v_mfma_f32_32x32x16_bf16 v[80:95], v[32:35], v[40:43], v[80:95]
ds_read_b128 v[56:59], v135 offset:4096
ds_read_b128 v[60:63], v131 offset:4096
s_waitcnt lgkmcnt(4)
v_mfma_f32_32x32x16_bf16 v[96:111], v[44:47], v[36:39], v[96:111]
v_mfma_f32_32x32x16_bf16 v[112:127], v[44:47], v[40:43], v[112:127]
s_waitcnt lgkmcnt(0)
s_barrier
v_mfma_f32_32x32x16_bf16 v[64:79], v[48:51], v[52:55], v[64:79]
ds_read_b128 v[32:35], v128 offset:32768
ds_read_b128 v[36:39], v132 offset:32768
v_mfma_f32_32x32x16_bf16 v[80:95], v[48:51], v[56:59], v[80:95]
ds_read_b128 v[40:43], v132 offset:36864
ds_read_b128 v[44:47], v128 offset:36864
v_mfma_f32_32x32x16_bf16 v[96:111], v[60:63], v[52:55], v[96:111]
v_mfma_f32_32x32x16_bf16 v[112:127], v[60:63], v[56:59], v[112:127]
s_waitcnt lgkmcnt(2)
v_mfma_f32_32x32x16_bf16 v[64:79], v[32:35], v[36:39], v[64:79]
ds_read_b128 v[48:51], v129 offset:32768
ds_read_b128 v[52:55], v133 offset:32768
s_waitcnt lgkmcnt(3)
v_mfma_f32_32x32x16_bf16 v[80:95], v[32:35], v[40:43], v[80:95]
ds_read_b128 v[56:59], v133 offset:36864
ds_read_b128 v[60:63], v129 offset:36864
s_waitcnt lgkmcnt(4)
v_mfma_f32_32x32x16_bf16 v[96:111], v[44:47], v[36:39], v[96:111]
v_mfma_f32_32x32x16_bf16 v[112:127], v[44:47], v[40:43], v[112:127]
s_waitcnt lgkmcnt(2)
v_mfma_f32_32x32x16_bf16 v[64:79], v[48:51], v[52:55], v[64:79]
ds_read_b128 v[32:35], v130 offset:32768
ds_read_b128 v[36:39], v134 offset:32768
s_waitcnt lgkmcnt(3)
v_mfma_f32_32x32x16_bf16 v[80:95], v[48:51], v[56:59], v[80:95]
ds_read_b128 v[40:43], v134 offset:36864
ds_read_b128 v[44:47], v130 offset:36864
s_waitcnt lgkmcnt(4)
v_mfma_f32_32x32x16_bf16 v[96:111], v[60:63], v[52:55], v[96:111]
v_mfma_f32_32x32x16_bf16 v[112:127], v[60:63], v[56:59], v[112:127]
s_waitcnt lgkmcnt(2)
v_mfma_f32_32x32x16_bf16 v[64:79], v[32:35], v[36:39], v[64:79]
ds_read_b128 v[48:51], v131 offset:32768
ds_read_b128 v[52:55], v135 offset:32768
s_waitcnt lgkmcnt(3)
v_mfma_f32_32x32x16_bf16 v[80:95], v[32:35], v[40:43], v[80:95]
ds_read_b128 v[56:59], v135 offset:36864
ds_read_b128 v[60:63], v131 offset:36864
s_waitcnt lgkmcnt(4)
v_mfma_f32_32x32x16_bf16 v[96:111], v[44:47], v[36:39], v[96:111]
v_mfma_f32_32x32x16_bf16 v[112:127], v[44:47], v[40:43], v[112:127]
s_waitcnt lgkmcnt(0)
s_barrier
v_mfma_f32_32x32x16_bf16 v[64:79], v[48:51], v[52:55], v[64:79]
ds_read_b128 v[32:35], v136 offset:0
ds_read_b128 v[36:39], v140 offset:0
v_mfma_f32_32x32x16_bf16 v[80:95], v[48:51], v[56:59], v[80:95]
ds_read_b128 v[40:43], v140 offset:4096
ds_read_b128 v[44:47], v136 offset:4096
v_mfma_f32_32x32x16_bf16 v[96:111], v[60:63], v[52:55], v[96:111]
v_mfma_f32_32x32x16_bf16 v[112:127], v[60:63], v[56:59], v[112:127]
s_waitcnt lgkmcnt(2)
v_mfma_f32_32x32x16_bf16 v[64:79], v[32:35], v[36:39], v[64:79]
ds_read_b128 v[48:51], v137 offset:0
ds_read_b128 v[52:55], v141 offset:0
s_waitcnt lgkmcnt(3)
v_mfma_f32_32x32x16_bf16 v[80:95], v[32:35], v[40:43], v[80:95]
ds_read_b128 v[56:59], v141 offset:4096
ds_read_b128 v[60:63], v137 offset:4096
s_waitcnt lgkmcnt(4)
v_mfma_f32_32x32x16_bf16 v[96:111], v[44:47], v[36:39], v[96:111]
v_mfma_f32_32x32x16_bf16 v[112:127], v[44:47], v[40:43], v[112:127]
s_waitcnt lgkmcnt(2)
v_mfma_f32_32x32x16_bf16 v[64:79], v[48:51], v[52:55], v[64:79]
ds_read_b128 v[32:35], v138 offset:0
ds_read_b128 v[36:39], v142 offset:0
s_waitcnt lgkmcnt(3)
v_mfma_f32_32x32x16_bf16 v[80:95], v[48:51], v[56:59], v[80:95]
ds_read_b128 v[40:43], v142 offset:4096
ds_read_b128 v[44:47], v138 offset:4096
s_waitcnt lgkmcnt(4)
v_mfma_f32_32x32x16_bf16 v[96:111], v[60:63], v[52:55], v[96:111]
v_mfma_f32_32x32x16_bf16 v[112:127], v[60:63], v[56:59], v[112:127]
s_waitcnt lgkmcnt(2)
v_mfma_f32_32x32x16_bf16 v[64:79], v[32:35], v[36:39], v[64:79]
ds_read_b128 v[48:51], v139 offset:0
ds_read_b128 v[52:55], v143 offset:0
s_waitcnt lgkmcnt(3)
v_mfma_f32_32x32x16_bf16 v[80:95], v[32:35], v[40:43], v[80:95]
ds_read_b128 v[56:59], v143 offset:4096
ds_read_b128 v[60:63], v139 offset:4096
s_waitcnt lgkmcnt(4)
v_mfma_f32_32x32x16_bf16 v[96:111], v[44:47], v[36:39], v[96:111]
v_mfma_f32_32x32x16_bf16 v[112:127], v[44:47], v[40:43], v[112:127]
s_waitcnt lgkmcnt(0)
s_barrier
v_mfma_f32_32x32x16_bf16 v[64:79], v[48:51], v[52:55], v[64:79]
ds_read_b128 v[32:35], v128 offset:0
ds_read_b128 v[36:39], v132 offset:0
v_mfma_f32_32x32x16_bf16 v[80:95], v[48:51], v[56:59], v[80:95]
ds_read_b128 v[40:43], v132 offset:4096
ds_read_b128 v[44:47], v128 offset:4096
v_mfma_f32_32x32x16_bf16 v[96:111], v[60:63], v[52:55], v[96:111]
v_mfma_f32_32x32x16_bf16 v[112:127], v[60:63], v[56:59], v[112:127]
s_waitcnt lgkmcnt(2)
v_mfma_f32_32x32x16_bf16 v[64:79], v[32:35], v[36:39], v[64:79]
ds_read_b128 v[48:51], v129 offset:0
ds_read_b128 v[52:55], v133 offset:0
s_waitcnt lgkmcnt(3)
v_mfma_f32_32x32x16_bf16 v[80:95], v[32:35], v[40:43], v[80:95]
ds_read_b128 v[56:59], v133 offset:4096
ds_read_b128 v[60:63], v129 offset:4096
s_waitcnt lgkmcnt(4)
v_mfma_f32_32x32x16_bf16 v[96:111], v[44:47], v[36:39], v[96:111]
v_mfma_f32_32x32x16_bf16 v[112:127], v[44:47], v[40:43], v[112:127]
s_waitcnt lgkmcnt(2)
v_mfma_f32_32x32x16_bf16 v[64:79], v[48:51], v[52:55], v[64:79]
ds_read_b128 v[32:35], v130 offset:0
ds_read_b128 v[36:39], v134 offset:0
s_waitcnt lgkmcnt(3)
v_mfma_f32_32x32x16_bf16 v[80:95], v[48:51], v[56:59], v[80:95]
ds_read_b128 v[40:43], v134 offset:4096
ds_read_b128 v[44:47], v130 offset:4096
s_waitcnt lgkmcnt(4)
v_mfma_f32_32x32x16_bf16 v[96:111], v[60:63], v[52:55], v[96:111]
v_mfma_f32_32x32x16_bf16 v[112:127], v[60:63], v[56:59], v[112:127]
s_waitcnt lgkmcnt(2)
v_mfma_f32_32x32x16_bf16 v[64:79], v[32:35], v[36:39], v[64:79]
ds_read_b128 v[48:51], v131 offset:0
ds_read_b128 v[52:55], v135 offset:0
s_waitcnt lgkmcnt(3)
v_mfma_f32_32x32x16_bf16 v[80:95], v[32:35], v[40:43], v[80:95]
ds_read_b128 v[56:59], v135 offset:4096
ds_read_b128 v[60:63], v131 offset:4096
s_waitcnt lgkmcnt(4)
v_mfma_f32_32x32x16_bf16 v[96:111], v[44:47], v[36:39], v[96:111]
v_mfma_f32_32x32x16_bf16 v[112:127], v[44:47], v[40:43], v[112:127]
s_waitcnt lgkmcnt(0)
s_barrier
v_mfma_f32_32x32x16_bf16 v[64:79], v[48:51], v[52:55], v[64:79]
v_mfma_f32_32x32x16_bf16 v[80:95], v[48:51], v[56:59], v[80:95]
v_mfma_f32_32x32x16_bf16 v[96:111], v[60:63], v[52:55], v[96:111]
v_mfma_f32_32x32x16_bf16 v[112:127], v[60:63], v[56:59], v[112:127]
s_lshl_b32 s60, s66, 10
s_add_u32 s60, s60, 122880
s_lshl_b32 s61, s68, 4
v_lshl_add_u32 v14, v6, 5, s60
v_lshl_add_u32 v15, v5, 3, v14
v_add_u32 v15, s61, v15
s_nop 2
v_pk_fma_f32 v[40:41], v[24:25], v[64:65], v[66:67] op_sel_hi:[0,1,1]
v_pk_fma_f32 v[42:43], v[24:25], v[80:81], v[82:83] op_sel_hi:[0,1,1]
v_pk_fma_f32 v[66:67], v[24:25], v[80:81], v[40:41] op_sel:[1,0,0] neg_lo:[1,0,0] neg_hi:[1,0,0]
v_pk_fma_f32 v[82:83], v[24:25], v[64:65], v[42:43] op_sel:[1,0,0]
v_pk_fma_f32 v[40:41], v[24:25], v[66:67], v[68:69] op_sel_hi:[0,1,1]
v_pk_fma_f32 v[42:43], v[24:25], v[82:83], v[84:85] op_sel_hi:[0,1,1]
v_pk_fma_f32 v[68:69], v[24:25], v[82:83], v[40:41] op_sel:[1,0,0] neg_lo:[1,0,0] neg_hi:[1,0,0]
v_pk_fma_f32 v[84:85], v[24:25], v[66:67], v[42:43] op_sel:[1,0,0]
v_pk_fma_f32 v[40:41], v[24:25], v[68:69], v[70:71] op_sel_hi:[0,1,1]
v_pk_fma_f32 v[42:43], v[24:25], v[84:85], v[86:87] op_sel_hi:[0,1,1]
v_pk_fma_f32 v[70:71], v[24:25], v[84:85], v[40:41] op_sel:[1,0,0] neg_lo:[1,0,0] neg_hi:[1,0,0]
v_pk_fma_f32 v[86:87], v[24:25], v[68:69], v[42:43] op_sel:[1,0,0]
v_pk_fma_f32 v[40:41], v[24:25], v[70:71], v[72:73] op_sel_hi:[0,1,1]
v_pk_fma_f32 v[42:43], v[24:25], v[86:87], v[88:89] op_sel_hi:[0,1,1]
v_pk_fma_f32 v[72:73], v[24:25], v[86:87], v[40:41] op_sel:[1,0,0] neg_lo:[1,0,0] neg_hi:[1,0,0]
v_pk_fma_f32 v[88:89], v[24:25], v[70:71], v[42:43] op_sel:[1,0,0]
v_pk_fma_f32 v[40:41], v[24:25], v[72:73], v[74:75] op_sel_hi:[0,1,1]
v_pk_fma_f32 v[42:43], v[24:25], v[88:89], v[90:91] op_sel_hi:[0,1,1]
v_pk_fma_f32 v[74:75], v[24:25], v[88:89], v[40:41] op_sel:[1,0,0] neg_lo:[1,0,0] neg_hi:[1,0,0]
v_pk_fma_f32 v[90:91], v[24:25], v[72:73], v[42:43] op_sel:[1,0,0]
v_pk_fma_f32 v[40:41], v[24:25], v[74:75], v[76:77] op_sel_hi:[0,1,1]
v_pk_fma_f32 v[42:43], v[24:25], v[90:91], v[92:93] op_sel_hi:[0,1,1]
v_pk_fma_f32 v[76:77], v[24:25], v[90:91], v[40:41] op_sel:[1,0,0] neg_lo:[1,0,0] neg_hi:[1,0,0]
v_pk_fma_f32 v[92:93], v[24:25], v[74:75], v[42:43] op_sel:[1,0,0]
v_pk_fma_f32 v[40:41], v[24:25], v[76:77], v[78:79] op_sel_hi:[0,1,1]
v_pk_fma_f32 v[42:43], v[24:25], v[92:93], v[94:95] op_sel_hi:[0,1,1]
v_pk_fma_f32 v[78:79], v[24:25], v[92:93], v[40:41] op_sel:[1,0,0] neg_lo:[1,0,0] neg_hi:[1,0,0]
v_pk_fma_f32 v[94:95], v[24:25], v[76:77], v[42:43] op_sel:[1,0,0]
v_pk_fma_f32 v[40:41], v[24:25], v[78:79], v[96:97] op_sel_hi:[0,1,1]
v_pk_fma_f32 v[42:43], v[24:25], v[94:95], v[112:113] op_sel_hi:[0,1,1]
v_pk_fma_f32 v[96:97], v[24:25], v[94:95], v[40:41] op_sel:[1,0,0] neg_lo:[1,0,0] neg_hi:[1,0,0]
v_pk_fma_f32 v[112:113], v[24:25], v[78:79], v[42:43] op_sel:[1,0,0]
v_pk_fma_f32 v[40:41], v[24:25], v[96:97], v[98:99] op_sel_hi:[0,1,1]
v_pk_fma_f32 v[42:43], v[24:25], v[112:113], v[114:115] op_sel_hi:[0,1,1]
v_pk_fma_f32 v[98:99], v[24:25], v[112:113], v[40:41] op_sel:[1,0,0] neg_lo:[1,0,0] neg_hi:[1,0,0]
v_pk_fma_f32 v[114:115], v[24:25], v[96:97], v[42:43] op_sel:[1,0,0]
v_pk_fma_f32 v[40:41], v[24:25], v[98:99], v[100:101] op_sel_hi:[0,1,1]
v_pk_fma_f32 v[42:43], v[24:25], v[114:115], v[116:117] op_sel_hi:[0,1,1]
v_pk_fma_f32 v[100:101], v[24:25], v[114:115], v[40:41] op_sel:[1,0,0] neg_lo:[1,0,0] neg_hi:[1,0,0]
v_pk_fma_f32 v[116:117], v[24:25], v[98:99], v[42:43] op_sel:[1,0,0]
v_pk_fma_f32 v[40:41], v[24:25], v[100:101], v[102:103] op_sel_hi:[0,1,1]
v_pk_fma_f32 v[42:43], v[24:25], v[116:117], v[118:119] op_sel_hi:[0,1,1]
v_pk_fma_f32 v[102:103], v[24:25], v[116:117], v[40:41] op_sel:[1,0,0] neg_lo:[1,0,0] neg_hi:[1,0,0]
v_pk_fma_f32 v[118:119], v[24:25], v[100:101], v[42:43] op_sel:[1,0,0]
v_pk_fma_f32 v[40:41], v[24:25], v[102:103], v[104:105] op_sel_hi:[0,1,1]
v_pk_fma_f32 v[42:43], v[24:25], v[118:119], v[120:121] op_sel_hi:[0,1,1]
v_pk_fma_f32 v[104:105], v[24:25], v[118:119], v[40:41] op_sel:[1,0,0] neg_lo:[1,0,0] neg_hi:[1,0,0]
v_pk_fma_f32 v[120:121], v[24:25], v[102:103], v[42:43] op_sel:[1,0,0]
v_pk_fma_f32 v[40:41], v[24:25], v[104:105], v[106:107] op_sel_hi:[0,1,1]
v_pk_fma_f32 v[42:43], v[24:25], v[120:121], v[122:123] op_sel_hi:[0,1,1]
v_pk_fma_f32 v[106:107], v[24:25], v[120:121], v[40:41] op_sel:[1,0,0] neg_lo:[1,0,0] neg_hi:[1,0,0]
v_pk_fma_f32 v[122:123], v[24:25], v[104:105], v[42:43] op_sel:[1,0,0]
v_pk_fma_f32 v[40:41], v[24:25], v[106:107], v[108:109] op_sel_hi:[0,1,1]
v_pk_fma_f32 v[42:43], v[24:25], v[122:123], v[124:125] op_sel_hi:[0,1,1]
v_pk_fma_f32 v[108:109], v[24:25], v[122:123], v[40:41] op_sel:[1,0,0] neg_lo:[1,0,0] neg_hi:[1,0,0]
v_pk_fma_f32 v[124:125], v[24:25], v[106:107], v[42:43] op_sel:[1,0,0]
v_pk_fma_f32 v[40:41], v[24:25], v[108:109], v[110:111] op_sel_hi:[0,1,1]
v_pk_fma_f32 v[42:43], v[24:25], v[124:125], v[126:127] op_sel_hi:[0,1,1]
v_pk_fma_f32 v[110:111], v[24:25], v[124:125], v[40:41] op_sel:[1,0,0] neg_lo:[1,0,0] neg_hi:[1,0,0]
v_pk_fma_f32 v[126:127], v[24:25], v[108:109], v[42:43] op_sel:[1,0,0]
v_fma_f32 v40, v28, v110, v111
v_fma_f32 v41, v28, v126, v127
v_fma_f32 v32, -v29, v126, v40
v_fma_f32 v33, v29, v110, v41
ds_write_b64 v15, v[32:33]
s_sub_u32 s60, s35, 1
s_lshl_b32 s60, s60, 14
v_lshlrev_b32 v16, 4, v4
v_lshlrev_b32 v17, 14, v5
v_sub_u32 v17, v16, v17
v_add_u32 v128, s60, v17
s_lshl_b32 s60, s35, 14
v_add_u32 v16, s60, v16
v_lshlrev_b32 v17, 30, v5
v_or_b32 v16, v16, v17
s_waitcnt lgkmcnt(0)
s_barrier
ds_read_b128 v[144:147], v14
ds_read_b128 v[148:151], v14 offset:16
L_n41:
s_waitcnt vmcnt(0)
v_readfirstlane_b32 s37, v13
s_nop 0
s_cmp_lg_u32 s37, 0
s_cbranch_scc1 L_ng42
global_load_dword v13, v12, s[30:31] sc1
s_branch L_n41
L_ng42:
v_mov_b32 v46, s37
v_mov_b32 v47, s37
s_getreg_b32 s60, hwreg(HW_REG_XCC_ID, 0, 4)
s_lshl_b32 s61, s37, 4
s_or_b32 s100, s60, s61
v_mov_b32 v60, s100
s_lshr_b32 s101, s36, 3
s_lshl_b32 s60, s35, 11
s_add_u32 s60, s60, 32768
s_lshl_b32 s61, s36, 7
s_add_u32 s61, s61, s60
v_mov_b32 v61, s61
s_lshl_b32 s61, s101, 10
s_add_u32 s60, s60, s61
v_and_b32 v62, 7, v1
v_lshl_add_u32 v62, v62, 7, s60
s_waitcnt lgkmcnt(0)
v_fma_f32 v40, v20, v144, v146
v_fma_f32 v41, v20, v145, v147
v_fma_f32 v48, -v21, v145, v40
v_fma_f32 v49, v21, v144, v41
v_fma_f32 v40, v20, v48, v148
v_fma_f32 v41, v20, v49, v149
v_fma_f32 v50, -v21, v49, v40
v_fma_f32 v51, v21, v48, v41
v_fma_f32 v40, v20, v50, v150
v_fma_f32 v41, v20, v51, v151
v_fma_f32 v44, -v21, v51, v40
v_fma_f32 v45, v21, v50, v41
s_cmp_lg_u32 s68, 0
s_cbranch_scc1 L_np43
buffer_store_dwordx4 v[44:47], v16, s[40:43], 0 offen sc1
s_cmp_lg_u32 s66, 0
s_cbranch_scc1 L_np43
s_mov_b64 exec, 1
global_store_dword v61, v60, s[32:33] sc1
s_mov_b64 exec, -1
L_np43:
v_mov_b32 v17, 0x40000000
v_subrev_u32 v129, 32768, v128
v_subrev_u32 v130, 65536, v128
v_subrev_u32 v131, 98304, v128
v_subrev_u32 v132, 131072, v128
v_subrev_u32 v133, 163840, v128
v_subrev_u32 v134, 196608, v128
v_subrev_u32 v135, 229376, v128
v_cmp_le_i32 vcc, 0, v128
s_nop 1
v_cndmask_b32 v136, 0, v46, vcc
v_cndmask_b32 v128, v17, v128, vcc
v_cmp_le_i32 vcc, 0, v129
s_nop 1
v_cndmask_b32 v137, 0, v46, vcc
v_cndmask_b32 v129, v17, v129, vcc
v_cmp_le_i32 vcc, 0, v130
s_nop 1
v_cndmask_b32 v138, 0, v46, vcc
v_cndmask_b32 v130, v17, v130, vcc
v_cmp_le_i32 vcc, 0, v131
s_nop 1
v_cndmask_b32 v139, 0, v46, vcc
v_cndmask_b32 v131, v17, v131, vcc
v_cmp_le_i32 vcc, 0, v132
s_nop 1
v_cndmask_b32 v140, 0, v46, vcc
v_cndmask_b32 v132, v17, v132, vcc
v_cmp_le_i32 vcc, 0, v133
s_nop 1
v_cndmask_b32 v141, 0, v46, vcc
v_cndmask_b32 v133, v17, v133, vcc
v_cmp_le_i32 vcc, 0, v134
s_nop 1
v_cndmask_b32 v142, 0, v46, vcc
v_cndmask_b32 v134, v17, v134, vcc
v_cmp_le_i32 vcc, 0, v135
s_nop 1
v_cndmask_b32 v143, 0, v46, vcc
v_cndmask_b32 v135, v17, v135, vcc
s_lshl_b32 s60, s35, 1
s_add_u32 s60, s60, s68
s_lshl_b32 s60, s60, 12
s_add_u32 s60, s60, 393216
s_lshl_b32 s61, s101, 11
s_add_u32 s61, s61, s60
v_and_b32 v18, 15, v1
v_lshl_add_u32 v18, v18, 7, s61
s_lshl_b32 s61, s36, 8
s_add_u32 s60, s60, s61
s_lshl_b32 s61, s66, 7
s_add_u32 s60, s60, s61
v_mov_b32 v19, s60
global_load_dword v243, v18, s[32:33] sc1
v_mul_f32 v52, v27, v25
v_mul_f32 v53, v27, v24
v_fma_f32 v208, v26, v24, -v52
v_fma_f32 v209, v26, v25, v53
v_pk_mul_f32 v[52:53], v[26:27], v[64:65] op_sel_hi:[0,1]
v_pk_mul_f32 v[54:55], v[26:27], v[80:81] op_sel_hi:[0,1] neg_lo:[1,0] neg_hi:[1,0]
v_mul_f32 v58, v209, v25
v_mul_f32 v59, v209, v24
v_pk_fma_f32 v[54:55], v[26:27], v[64:65], v[54:55] op_sel:[1,0,0] neg_lo:[1,0,0] neg_hi:[1,0,0]
v_pk_fma_f32 v[64:65], v[26:27], v[80:81], v[52:53] op_sel:[1,0,0] neg_lo:[1,0,0] neg_hi:[1,0,0]
v_mov_b64 v[80:81], v[54:55]
v_fma_f32 v210, v208, v24, -v58
v_fma_f32 v211, v208, v25, v59
v_pk_mul_f32 v[52:53], v[26:27], v[66:67] op_sel_hi:[0,1]
v_pk_mul_f32 v[54:55], v[26:27], v[82:83] op_sel_hi:[0,1] neg_lo:[1,0] neg_hi:[1,0]
v_mul_f32 v58, v211, v25
v_mul_f32 v59, v211, v24
v_pk_fma_f32 v[54:55], v[26:27], v[66:67], v[54:55] op_sel:[1,0,0] neg_lo:[1,0,0] neg_hi:[1,0,0]
v_pk_fma_f32 v[66:67], v[26:27], v[82:83], v[52:53] op_sel:[1,0,0] neg_lo:[1,0,0] neg_hi:[1,0,0]
v_mov_b64 v[82:83], v[54:55]
v_fma_f32 v212, v210, v24, -v58
v_fma_f32 v213, v210, v25, v59
v_pk_mul_f32 v[52:53], v[26:27], v[68:69] op_sel_hi:[0,1]
v_pk_mul_f32 v[54:55], v[26:27], v[84:85] op_sel_hi:[0,1] neg_lo:[1,0] neg_hi:[1,0]
v_mul_f32 v58, v213, v25
v_mul_f32 v59, v213, v24
v_pk_fma_f32 v[54:55], v[26:27], v[68:69], v[54:55] op_sel:[1,0,0] neg_lo:[1,0,0] neg_hi:[1,0,0]
v_pk_fma_f32 v[68:69], v[26:27], v[84:85], v[52:53] op_sel:[1,0,0] neg_lo:[1,0,0] neg_hi:[1,0,0]
v_mov_b64 v[84:85], v[54:55]
v_fma_f32 v214, v212, v24, -v58
v_fma_f32 v215, v212, v25, v59
v_pk_mul_f32 v[52:53], v[26:27], v[70:71] op_sel_hi:[0,1]
v_pk_mul_f32 v[54:55], v[26:27], v[86:87] op_sel_hi:[0,1] neg_lo:[1,0] neg_hi:[1,0]
v_mul_f32 v58, v215, v25
v_mul_f32 v59, v215, v24
v_pk_fma_f32 v[54:55], v[26:27], v[70:71], v[54:55] op_sel:[1,0,0] neg_lo:[1,0,0] neg_hi:[1,0,0]
v_pk_fma_f32 v[70:71], v[26:27], v[86:87], v[52:53] op_sel:[1,0,0] neg_lo:[1,0,0] neg_hi:[1,0,0]
v_mov_b64 v[86:87], v[54:55]
v_fma_f32 v216, v214, v24, -v58
v_fma_f32 v217, v214, v25, v59
v_pk_mul_f32 v[52:53], v[26:27], v[72:73] op_sel_hi:[0,1]
v_pk_mul_f32 v[54:55], v[26:27], v[88:89] op_sel_hi:[0,1] neg_lo:[1,0] neg_hi:[1,0]
v_mul_f32 v58, v217, v25
v_mul_f32 v59, v217, v24
v_pk_fma_f32 v[54:55], v[26:27], v[72:73], v[54:55] op_sel:[1,0,0] neg_lo:[1,0,0] neg_hi:[1,0,0]
v_pk_fma_f32 v[72:73], v[26:27], v[88:89], v[52:53] op_sel:[1,0,0] neg_lo:[1,0,0] neg_hi:[1,0,0]
v_mov_b64 v[88:89], v[54:55]
v_fma_f32 v218, v216, v24, -v58
v_fma_f32 v219, v216, v25, v59
v_pk_mul_f32 v[52:53], v[26:27], v[74:75] op_sel_hi:[0,1]
v_pk_mul_f32 v[54:55], v[26:27], v[90:91] op_sel_hi:[0,1] neg_lo:[1,0] neg_hi:[1,0]
v_mul_f32 v58, v219, v25
v_mul_f32 v59, v219, v24
v_pk_fma_f32 v[54:55], v[26:27], v[74:75], v[54:55] op_sel:[1,0,0] neg_lo:[1,0,0] neg_hi:[1,0,0]
v_pk_fma_f32 v[74:75], v[26:27], v[90:91], v[52:53] op_sel:[1,0,0] neg_lo:[1,0,0] neg_hi:[1,0,0]
v_mov_b64 v[90:91], v[54:55]
v_fma_f32 v220, v218, v24, -v58
v_fma_f32 v221, v218, v25, v59
v_pk_mul_f32 v[52:53], v[26:27], v[76:77] op_sel_hi:[0,1]
v_pk_mul_f32 v[54:55], v[26:27], v[92:93] op_sel_hi:[0,1] neg_lo:[1,0] neg_hi:[1,0]
v_mul_f32 v58, v221, v25
v_mul_f32 v59, v221, v24
v_pk_fma_f32 v[54:55], v[26:27], v[76:77], v[54:55] op_sel:[1,0,0] neg_lo:[1,0,0] neg_hi:[1,0,0]
v_pk_fma_f32 v[76:77], v[26:27], v[92:93], v[52:53] op_sel:[1,0,0] neg_lo:[1,0,0] neg_hi:[1,0,0]
v_mov_b64 v[92:93], v[54:55]
v_fma_f32 v222, v220, v24, -v58
v_fma_f32 v223, v220, v25, v59
v_pk_mul_f32 v[52:53], v[26:27], v[78:79] op_sel_hi:[0,1]
v_pk_mul_f32 v[54:55], v[26:27], v[94:95] op_sel_hi:[0,1] neg_lo:[1,0] neg_hi:[1,0]
v_mul_f32 v58, v223, v25
v_mul_f32 v59, v223, v24
v_pk_fma_f32 v[54:55], v[26:27], v[78:79], v[54:55] op_sel:[1,0,0] neg_lo:[1,0,0] neg_hi:[1,0,0]
v_pk_fma_f32 v[78:79], v[26:27], v[94:95], v[52:53] op_sel:[1,0,0] neg_lo:[1,0,0] neg_hi:[1,0,0]
v_mov_b64 v[94:95], v[54:55]
v_fma_f32 v224, v222, v24, -v58
v_fma_f32 v225, v222, v25, v59
v_pk_mul_f32 v[52:53], v[26:27], v[96:97] op_sel_hi:[0,1]
v_pk_mul_f32 v[54:55], v[26:27], v[112:113] op_sel_hi:[0,1] neg_lo:[1,0] neg_hi:[1,0]
v_mul_f32 v58, v225, v25
v_mul_f32 v59, v225, v24
v_pk_fma_f32 v[54:55], v[26:27], v[96:97], v[54:55] op_sel:[1,0,0] neg_lo:[1,0,0] neg_hi:[1,0,0]
v_pk_fma_f32 v[96:97], v[26:27], v[112:113], v[52:53] op_sel:[1,0,0] neg_lo:[1,0,0] neg_hi:[1,0,0]
v_mov_b64 v[112:113], v[54:55]
v_fma_f32 v226, v224, v24, -v58
v_fma_f32 v227, v224, v25, v59
v_pk_mul_f32 v[52:53], v[26:27], v[98:99] op_sel_hi:[0,1]
v_pk_mul_f32 v[54:55], v[26:27], v[114:115] op_sel_hi:[0,1] neg_lo:[1,0] neg_hi:[1,0]
v_mul_f32 v58, v227, v25
v_mul_f32 v59, v227, v24
v_pk_fma_f32 v[54:55], v[26:27], v[98:99], v[54:55] op_sel:[1,0,0] neg_lo:[1,0,0] neg_hi:[1,0,0]
v_pk_fma_f32 v[98:99], v[26:27], v[114:115], v[52:53] op_sel:[1,0,0] neg_lo:[1,0,0] neg_hi:[1,0,0]
v_mov_b64 v[114:115], v[54:55]
v_fma_f32 v228, v226, v24, -v58
v_fma_f32 v229, v226, v25, v59
v_pk_mul_f32 v[52:53], v[26:27], v[100:101] op_sel_hi:[0,1]
v_pk_mul_f32 v[54:55], v[26:27], v[116:117] op_sel_hi:[0,1] neg_lo:[1,0] neg_hi:[1,0]
v_mul_f32 v58, v229, v25
v_mul_f32 v59, v229, v24
v_pk_fma_f32 v[54:55], v[26:27], v[100:101], v[54:55] op_sel:[1,0,0] neg_lo:[1,0,0] neg_hi:[1,0,0]
v_pk_fma_f32 v[100:101], v[26:27], v[116:117], v[52:53] op_sel:[1,0,0] neg_lo:[1,0,0] neg_hi:[1,0,0]
v_mov_b64 v[116:117], v[54:55]
v_fma_f32 v230, v228, v24, -v58
v_fma_f32 v231, v228, v25, v59
v_pk_mul_f32 v[52:53], v[26:27], v[102:103] op_sel_hi:[0,1]
v_pk_mul_f32 v[54:55], v[26:27], v[118:119] op_sel_hi:[0,1] neg_lo:[1,0] neg_hi:[1,0]
v_mul_f32 v58, v231, v25
v_mul_f32 v59, v231, v24
v_pk_fma_f32 v[54:55], v[26:27], v[102:103], v[54:55] op_sel:[1,0,0] neg_lo:[1,0,0] neg_hi:[1,0,0]
v_pk_fma_f32 v[102:103], v[26:27], v[118:119], v[52:53] op_sel:[1,0,0] neg_lo:[1,0,0] neg_hi:[1,0,0]
v_mov_b64 v[118:119], v[54:55]
v_fma_f32 v232, v230, v24, -v58
v_fma_f32 v233, v230, v25, v59
v_pk_mul_f32 v[52:53], v[26:27], v[104:105] op_sel_hi:[0,1]
v_pk_mul_f32 v[54:55], v[26:27], v[120:121] op_sel_hi:[0,1] neg_lo:[1,0] neg_hi:[1,0]
v_mul_f32 v58, v233, v25
v_mul_f32 v59, v233, v24
v_pk_fma_f32 v[54:55], v[26:27], v[104:105], v[54:55] op_sel:[1,0,0] neg_lo:[1,0,0] neg_hi:[1,0,0]
v_pk_fma_f32 v[104:105], v[26:27], v[120:121], v[52:53] op_sel:[1,0,0] neg_lo:[1,0,0] neg_hi:[1,0,0]
v_mov_b64 v[120:121], v[54:55]
v_fma_f32 v234, v232, v24, -v58
v_fma_f32 v235, v232, v25, v59
v_pk_mul_f32 v[52:53], v[26:27], v[106:107] op_sel_hi:[0,1]
v_pk_mul_f32 v[54:55], v[26:27], v[122:123] op_sel_hi:[0,1] neg_lo:[1,0] neg_hi:[1,0]
v_mul_f32 v58, v235, v25
v_mul_f32 v59, v235, v24
v_pk_fma_f32 v[54:55], v[26:27], v[106:107], v[54:55] op_sel:[1,0,0] neg_lo:[1,0,0] neg_hi:[1,0,0]
v_pk_fma_f32 v[106:107], v[26:27], v[122:123], v[52:53] op_sel:[1,0,0] neg_lo:[1,0,0] neg_hi:[1,0,0]
v_mov_b64 v[122:123], v[54:55]
v_fma_f32 v236, v234, v24, -v58
v_fma_f32 v237, v234, v25, v59
v_pk_mul_f32 v[52:53], v[26:27], v[108:109] op_sel_hi:[0,1]
v_pk_mul_f32 v[54:55], v[26:27], v[124:125] op_sel_hi:[0,1] neg_lo:[1,0] neg_hi:[1,0]
v_mul_f32 v58, v237, v25
v_mul_f32 v59, v237, v24
v_pk_fma_f32 v[54:55], v[26:27], v[108:109], v[54:55] op_sel:[1,0,0] neg_lo:[1,0,0] neg_hi:[1,0,0]
v_pk_fma_f32 v[108:109], v[26:27], v[124:125], v[52:53] op_sel:[1,0,0] neg_lo:[1,0,0] neg_hi:[1,0,0]
v_mov_b64 v[124:125], v[54:55]
v_fma_f32 v238, v236, v24, -v58
v_fma_f32 v239, v236, v25, v59
v_pk_mul_f32 v[52:53], v[26:27], v[110:111] op_sel_hi:[0,1]
v_pk_mul_f32 v[54:55], v[26:27], v[126:127] op_sel_hi:[0,1] neg_lo:[1,0] neg_hi:[1,0]
v_mov_b32 v56, v110
v_mov_b32 v57, v126
v_pk_fma_f32 v[54:55], v[26:27], v[110:111], v[54:55] op_sel:[1,0,0] neg_lo:[1,0,0] neg_hi:[1,0,0]
v_pk_fma_f32 v[110:111], v[26:27], v[126:127], v[52:53] op_sel:[1,0,0] neg_lo:[1,0,0] neg_hi:[1,0,0]
v_mov_b64 v[126:127], v[54:55]
buffer_load_dwordx4 v[160:163], v128, s[40:43], 0 offen sc1
buffer_load_dwordx4 v[164:167], v129, s[40:43], 0 offen sc1
buffer_load_dwordx4 v[168:171], v130, s[40:43], 0 offen sc1
buffer_load_dwordx4 v[172:175], v131, s[40:43], 0 offen sc1
buffer_load_dwordx4 v[176:179], v132, s[40:43], 0 offen sc1
buffer_load_dwordx4 v[180:183], v133, s[40:43], 0 offen sc1
buffer_load_dwordx4 v[184:187], v134, s[40:43], 0 offen sc1
buffer_load_dwordx4 v[188:191], v135, s[40:43], 0 offen sc1
global_load_dword v63, v62, s[32:33] sc1
v_mov_b32 v12, 126976
s_lshl_b32 s60, s34, 2
v_add_u32 v13, s60, v12
v_mov_b32 v14, 1
s_mov_b64 exec, 1
ds_write_b32 v13, v14
s_mov_b64 exec, -1
s_mov_b32 s12, 0
s_mov_b32 s13, 0x10001
s_bfe_u32 s14, s37, 0x20000
s_mul_i32 s14, s14, 0x8001
s_and_b32 s14, s14, 0x10001
s_bfe_u32 s15, s37, 0x20002
s_mul_i32 s15, s15, 0x8001
s_and_b32 s15, s15, 0x10001
s_xor_b32 s60, s68, s101
s_xor_b32 s60, s60, 1
s_lshl_b32 s60, s60, 6
s_add_u32 s60, s60, s66
v_lshrrev_b32 v8, 3, v1
v_lshl_add_u32 v8, v8, 1, s60
v_lshlrev_b32 v8, 11, v8
v_and_b32 v9, 7, v1
v_lshrrev_b32 v10, 4, v1
v_xor_b32 v9, v9, v10
v_lshlrev_b32 v9, 4, v9
v_xor_b32 v10, 64, v9
v_add_u32 v244, v8, v9
v_add_u32 v245, v8, v10
v_add_u32 v245, 31744, v245
v_add_u32 v246, v8, v9
v_add_u32 v246, 63488, v246
v_add_u32 v247, v8, v10
v_add_u32 v247, 95232, v247
s_and_b32 s64, s36, 7
s_lshl_b32 s60, s64, 18
s_lshl_b32 s61, s101, 10
s_add_u32 s60, s60, s61
s_add_u32 s48, s20, s60
s_addc_u32 s49, s21, 0
s_sub_u32 s50, 262144, s61
s_mov_b32 s51, 0x20000
s_add_u32 s52, s22, s60
s_addc_u32 s53, s23, 0
s_sub_u32 s54, 262144, s61
s_mov_b32 s55, 0x20000
s_lshl_b32 s61, s64, 1
s_add_u32 s61, s61, s101
s_lshl_b32 s61, s61, 7
s_lshl_b32 s63, s35, 1
s_add_u32 s63, s63, s68
s_lshl_b32 s60, s63, 17
s_add_u32 s60, s60, s61
s_add_u32 s56, s10, s60
s_addc_u32 s57, s11, 0
s_sub_u32 s58, 131072, s61
s_mov_b32 s59, 0x20000
s_add_u32 s26, s26, s61
s_addc_u32 s27, s27, 0
s_lshl_b32 s61, s61, 1
s_add_u32 s61, s61, 4096
s_lshl_b32 s60, s63, 19
s_add_u32 s60, s60, s61
s_add_u32 s28, s28, s60
s_addc_u32 s29, s29, 0
s_sub_u32 s24, 0x80000, s61
s_lshl_b32 s67, s34, 12
s_lshl_b32 s65, s64, 13
s_lshl_b32 s64, s64, 7
s_lshl_b32 s60, s68, 14
s_lshl_b32 s61, s66, 11
s_add_u32 s60, s60, s61
s_add_u32 s60, s60, 65536
v_add_u32 v16, s60, v11
s_lshl_b32 s60, s34, 13
s_add_u32 s60, s60, 65536
v_add_u32 v17, s60, v11
s_mov_b32 s69, 0
L_poll44:
s_mov_b64 s[60:61], 0
s_waitcnt vmcnt(8)
v_cmp_ne_u32 vcc, v162, v136
s_nop 0
s_or_b64 s[60:61], s[60:61], vcc
v_cmp_ne_u32 vcc, v163, v136
s_nop 0
s_or_b64 s[60:61], s[60:61], vcc
s_waitcnt vmcnt(7)
v_cmp_ne_u32 vcc, v166, v137
s_nop 0
s_or_b64 s[60:61], s[60:61], vcc
v_cmp_ne_u32 vcc, v167, v137
s_nop 0
s_or_b64 s[60:61], s[60:61], vcc
s_waitcnt vmcnt(6)
v_cmp_ne_u32 vcc, v170, v138
s_nop 0
s_or_b64 s[60:61], s[60:61], vcc
v_cmp_ne_u32 vcc, v171, v138
s_nop 0
s_or_b64 s[60:61], s[60:61], vcc
s_waitcnt vmcnt(5)
v_cmp_ne_u32 vcc, v174, v139
s_nop 0
s_or_b64 s[60:61], s[60:61], vcc
v_cmp_ne_u32 vcc, v175, v139
s_nop 0
s_or_b64 s[60:61], s[60:61], vcc
s_waitcnt vmcnt(4)
v_cmp_ne_u32 vcc, v178, v140
s_nop 0
s_or_b64 s[60:61], s[60:61], vcc
v_cmp_ne_u32 vcc, v179, v140
s_nop 0
s_or_b64 s[60:61], s[60:61], vcc
s_waitcnt vmcnt(3)
v_cmp_ne_u32 vcc, v182, v141
s_nop 0
s_or_b64 s[60:61], s[60:61], vcc
v_cmp_ne_u32 vcc, v183, v141
s_nop 0
s_or_b64 s[60:61], s[60:61], vcc
s_waitcnt vmcnt(2)
v_cmp_ne_u32 vcc, v186, v142
s_nop 0
s_or_b64 s[60:61], s[60:61], vcc
v_cmp_ne_u32 vcc, v187, v142
s_nop 0
s_or_b64 s[60:61], s[60:61], vcc
s_waitcnt vmcnt(1)
v_cmp_ne_u32 vcc, v190, v143
s_nop 0
s_or_b64 s[60:61], s[60:61], vcc
v_cmp_ne_u32 vcc, v191, v143
s_nop 0
s_or_b64 s[60:61], s[60:61], vcc
s_waitcnt vmcnt(0)
v_xor_b32 v63, v60, v63
v_cmp_lt_u32 vcc, 15, v63
s_nop 0
s_or_b64 s[60:61], s[60:61], vcc
s_add_u32 s69, s69, 1
s_cmp_eq_u64 s[60:61], 0
s_cbranch_scc1 L_polled45
s_cmp_ge_u32 s69, 200000
s_cbranch_scc1 L_polled45
buffer_load_dwordx4 v[160:163], v128, s[40:43], 0 offen sc1
buffer_load_dwordx4 v[164:167], v129, s[40:43], 0 offen sc1
buffer_load_dwordx4 v[168:171], v130, s[40:43], 0 offen sc1
buffer_load_dwordx4 v[172:175], v131, s[40:43], 0 offen sc1
buffer_load_dwordx4 v[176:179], v132, s[40:43], 0 offen sc1
buffer_load_dwordx4 v[180:183], v133, s[40:43], 0 offen sc1
buffer_load_dwordx4 v[184:187], v134, s[40:43], 0 offen sc1
buffer_load_dwordx4 v[188:191], v135, s[40:43], 0 offen sc1
global_load_dword v63, v62, s[32:33] sc1
s_branch L_poll44
L_polled45:
v_cmp_ne_u32 vcc, 0, v63
s_nop 0
s_cmp_eq_u64 vcc, 0
s_cselect_b32 s100, 1, 0
v_mov_b32 v14, 2
s_mov_b64 exec, 1
ds_write_b32 v13, v14
s_mov_b64 exec, -1
s_add_u32 m0, s67, 0
s_add_u32 s62, s64, 0
s_and_b32 s62, s62, 0x3ff
buffer_load_dwordx4 v244, s[48:51], s62 offen offset:0 lds
buffer_load_dwordx4 v245, s[48:51], s62 offen offset:1024 lds
buffer_load_dwordx4 v246, s[48:51], s62 offen offset:2048 lds
buffer_load_dwordx4 v247, s[48:51], s62 offen offset:3072 lds
s_add_u32 m0, s67, 16384
s_nop 0
buffer_load_dwordx4 v244, s[52:55], s62 offen offset:0 lds
buffer_load_dwordx4 v245, s[52:55], s62 offen offset:1024 lds
buffer_load_dwordx4 v246, s[52:55], s62 offen offset:2048 lds
buffer_load_dwordx4 v247, s[52:55], s62 offen offset:3072 lds
v_fma_f32 v40, v2, v188, v184
v_fma_f32 v41, v2, v189, v185
v_fma_f32 v48, -v3, v189, v40
v_fma_f32 v49, v3, v188, v41
v_fma_f32 v40, v2, v48, v180
v_fma_f32 v41, v2, v49, v181
v_fma_f32 v188, -v3, v49, v40
v_fma_f32 v189, v3, v48, v41
v_fma_f32 v40, v2, v188, v176
v_fma_f32 v41, v2, v189, v177
v_fma_f32 v48, -v3, v189, v40
v_fma_f32 v49, v3, v188, v41
v_fma_f32 v40, v2, v48, v172
v_fma_f32 v41, v2, v49, v173
v_fma_f32 v188, -v3, v49, v40
v_fma_f32 v189, v3, v48, v41
v_fma_f32 v40, v2, v188, v168
v_fma_f32 v41, v2, v189, v169
v_fma_f32 v48, -v3, v189, v40
v_fma_f32 v49, v3, v188, v41
v_fma_f32 v40, v2, v48, v164
v_fma_f32 v41, v2, v49, v165
v_fma_f32 v188, -v3, v49, v40
v_fma_f32 v189, v3, v48, v41
v_fma_f32 v40, v2, v188, v160
v_fma_f32 v41, v2, v189, v161
v_fma_f32 v48, -v3, v189, v40
v_fma_f32 v49, v3, v188, v41
v_mov_b32 v50, v48
v_mov_b32 v51, v49
s_nop 0
v_permlane32_swap_b32 v48, v50
v_permlane32_swap_b32 v49, v51
v_fma_f32 v40, v30, v50, v48
v_fma_f32 v41, v30, v51, v49
v_fma_f32 v192, -v31, v51, v40
v_fma_f32 v193, v31, v50, v41
v_fma_f32 v40, v20, v192, v144
v_fma_f32 v41, v20, v193, v145
v_fma_f32 v194, -v21, v193, v40
v_fma_f32 v195, v21, v192, v41
v_fma_f32 v40, v20, v194, v146
v_fma_f32 v41, v20, v195, v147
v_fma_f32 v196, -v21, v195, v40
v_fma_f32 v197, v21, v194, v41
v_fma_f32 v40, v20, v196, v148
v_fma_f32 v41, v20, v197, v149
v_fma_f32 v198, -v21, v197, v40
v_fma_f32 v199, v21, v196, v41
s_cmp_eq_u32 s68, 0
s_cbranch_scc1 L_wt046
v_mov_b64 v[192:193], v[196:197]
v_mov_b64 v[194:195], v[198:199]
L_wt046:
v_cmp_eq_u32 vcc, 1, v5
s_nop 1
v_cndmask_b32 v48, v192, v194, vcc
v_cndmask_b32 v50, v193, v195, vcc
v_fma_f32 v40, v28, v48, v56
v_fma_f32 v41, v28, v50, v57
v_fma_f32 v49, -v29, v50, v40
v_fma_f32 v51, v29, v48, v41
s_lshl_b32 s60, s35, 1
s_add_u32 s69, s60, s68
s_mul_i32 s60, s69, 262144
s_lshl_b32 s61, s36, 13
s_add_u32 s60, s60, s61
s_lshl_b32 s61, s66, 11
s_add_u32 s60, s60, s61
v_mov_b32 v3, 0xfffefffe
v_xor_b32 v20, 0, v7
v_add_u32 v24, 0x10000, v20
v_xor_b32 v21, 32, v7
v_add_u32 v25, 0x10000, v21
v_xor_b32 v22, 64, v7
v_add_u32 v26, 0x10000, v22
v_xor_b32 v23, 96, v7
v_add_u32 v27, 0x10000, v23
v_pk_fma_f32 v[64:65], v[208:209], v[48:49], v[64:65] op_sel_hi:[0,1,1]
v_pk_fma_f32 v[80:81], v[208:209], v[50:51], v[80:81] op_sel_hi:[0,1,1] neg_lo:[1,0,0] neg_hi:[1,0,0]
v_pk_fma_f32 v[64:65], v[208:209], v[50:51], v[64:65] op_sel:[1,0,0] neg_lo:[1,0,0] neg_hi:[1,0,0]
v_pk_fma_f32 v[80:81], v[208:209], v[48:49], v[80:81] op_sel:[1,0,0] neg_lo:[1,0,0] neg_hi:[1,0,0]
v_cvt_pk_bf16_f32 v128, v64, v65
v_cvt_pk_bf16_f32 v144, v80, v81
v_pk_fma_f32 v[66:67], v[210:211], v[48:49], v[66:67] op_sel_hi:[0,1,1]
v_pk_fma_f32 v[82:83], v[210:211], v[50:51], v[82:83] op_sel_hi:[0,1,1] neg_lo:[1,0,0] neg_hi:[1,0,0]
v_pk_fma_f32 v[66:67], v[210:211], v[50:51], v[66:67] op_sel:[1,0,0] neg_lo:[1,0,0] neg_hi:[1,0,0]
v_pk_fma_f32 v[82:83], v[210:211], v[48:49], v[82:83] op_sel:[1,0,0] neg_lo:[1,0,0] neg_hi:[1,0,0]
v_cvt_pk_bf16_f32 v129, v66, v67
v_cvt_pk_bf16_f32 v145, v82, v83
v_pk_fma_f32 v[68:69], v[212:213], v[48:49], v[68:69] op_sel_hi:[0,1,1]
v_pk_fma_f32 v[84:85], v[212:213], v[50:51], v[84:85] op_sel_hi:[0,1,1] neg_lo:[1,0,0] neg_hi:[1,0,0]
v_pk_fma_f32 v[68:69], v[212:213], v[50:51], v[68:69] op_sel:[1,0,0] neg_lo:[1,0,0] neg_hi:[1,0,0]
v_pk_fma_f32 v[84:85], v[212:213], v[48:49], v[84:85] op_sel:[1,0,0] neg_lo:[1,0,0] neg_hi:[1,0,0]
v_cvt_pk_bf16_f32 v130, v68, v69
v_cvt_pk_bf16_f32 v146, v84, v85
v_pk_fma_f32 v[70:71], v[214:215], v[48:49], v[70:71] op_sel_hi:[0,1,1]
v_pk_fma_f32 v[86:87], v[214:215], v[50:51], v[86:87] op_sel_hi:[0,1,1] neg_lo:[1,0,0] neg_hi:[1,0,0]
v_pk_fma_f32 v[70:71], v[214:215], v[50:51], v[70:71] op_sel:[1,0,0] neg_lo:[1,0,0] neg_hi:[1,0,0]
v_pk_fma_f32 v[86:87], v[214:215], v[48:49], v[86:87] op_sel:[1,0,0] neg_lo:[1,0,0] neg_hi:[1,0,0]
v_cvt_pk_bf16_f32 v131, v70, v71
v_cvt_pk_bf16_f32 v147, v86, v87
v_pk_fma_f32 v[72:73], v[216:217], v[48:49], v[72:73] op_sel_hi:[0,1,1]
v_pk_fma_f32 v[88:89], v[216:217], v[50:51], v[88:89] op_sel_hi:[0,1,1] neg_lo:[1,0,0] neg_hi:[1,0,0]
v_pk_fma_f32 v[72:73], v[216:217], v[50:51], v[72:73] op_sel:[1,0,0] neg_lo:[1,0,0] neg_hi:[1,0,0]
v_pk_fma_f32 v[88:89], v[216:217], v[48:49], v[88:89] op_sel:[1,0,0] neg_lo:[1,0,0] neg_hi:[1,0,0]
v_cvt_pk_bf16_f32 v132, v72, v73
v_cvt_pk_bf16_f32 v148, v88, v89
v_pk_fma_f32 v[74:75], v[218:219], v[48:49], v[74:75] op_sel_hi:[0,1,1]
v_pk_fma_f32 v[90:91], v[218:219], v[50:51], v[90:91] op_sel_hi:[0,1,1] neg_lo:[1,0,0] neg_hi:[1,0,0]
v_pk_fma_f32 v[74:75], v[218:219], v[50:51], v[74:75] op_sel:[1,0,0] neg_lo:[1,0,0] neg_hi:[1,0,0]
v_pk_fma_f32 v[90:91], v[218:219], v[48:49], v[90:91] op_sel:[1,0,0] neg_lo:[1,0,0] neg_hi:[1,0,0]
v_cvt_pk_bf16_f32 v133, v74, v75
v_cvt_pk_bf16_f32 v149, v90, v91
v_pk_fma_f32 v[76:77], v[220:221], v[48:49], v[76:77] op_sel_hi:[0,1,1]
v_pk_fma_f32 v[92:93], v[220:221], v[50:51], v[92:93] op_sel_hi:[0,1,1] neg_lo:[1,0,0] neg_hi:[1,0,0]
v_pk_fma_f32 v[76:77], v[220:221], v[50:51], v[76:77] op_sel:[1,0,0] neg_lo:[1,0,0] neg_hi:[1,0,0]
v_pk_fma_f32 v[92:93], v[220:221], v[48:49], v[92:93] op_sel:[1,0,0] neg_lo:[1,0,0] neg_hi:[1,0,0]
v_cvt_pk_bf16_f32 v134, v76, v77
v_cvt_pk_bf16_f32 v150, v92, v93
v_pk_fma_f32 v[78:79], v[222:223], v[48:49], v[78:79] op_sel_hi:[0,1,1]
v_pk_fma_f32 v[94:95], v[222:223], v[50:51], v[94:95] op_sel_hi:[0,1,1] neg_lo:[1,0,0] neg_hi:[1,0,0]
v_pk_fma_f32 v[78:79], v[222:223], v[50:51], v[78:79] op_sel:[1,0,0] neg_lo:[1,0,0] neg_hi:[1,0,0]
v_pk_fma_f32 v[94:95], v[222:223], v[48:49], v[94:95] op_sel:[1,0,0] neg_lo:[1,0,0] neg_hi:[1,0,0]
v_cvt_pk_bf16_f32 v135, v78, v79
v_cvt_pk_bf16_f32 v151, v94, v95
v_mfma_f32_32x32x16_bf16 v[160:175], v[128:131], v[248:251], 0
v_mfma_f32_32x32x16_bf16 v[160:175], v[132:135], v[252:255], v[160:175]
v_mfma_f32_32x32x16_bf16 v[176:191], v[144:147], v[248:251], 0
v_mfma_f32_32x32x16_bf16 v[176:191], v[148:151], v[252:255], v[176:191]
v_pk_fma_f32 v[96:97], v[224:225], v[48:49], v[96:97] op_sel_hi:[0,1,1]
v_pk_fma_f32 v[112:113], v[224:225], v[50:51], v[112:113] op_sel_hi:[0,1,1] neg_lo:[1,0,0] neg_hi:[1,0,0]
v_pk_fma_f32 v[96:97], v[224:225], v[50:51], v[96:97] op_sel:[1,0,0] neg_lo:[1,0,0] neg_hi:[1,0,0]
v_pk_fma_f32 v[112:113], v[224:225], v[48:49], v[112:113] op_sel:[1,0,0] neg_lo:[1,0,0] neg_hi:[1,0,0]
v_cvt_pk_bf16_f32 v136, v96, v97
v_cvt_pk_bf16_f32 v152, v112, v113
v_pk_fma_f32 v[98:99], v[226:227], v[48:49], v[98:99] op_sel_hi:[0,1,1]
v_pk_fma_f32 v[114:115], v[226:227], v[50:51], v[114:115] op_sel_hi:[0,1,1] neg_lo:[1,0,0] neg_hi:[1,0,0]
v_pk_fma_f32 v[98:99], v[226:227], v[50:51], v[98:99] op_sel:[1,0,0] neg_lo:[1,0,0] neg_hi:[1,0,0]
v_pk_fma_f32 v[114:115], v[226:227], v[48:49], v[114:115] op_sel:[1,0,0] neg_lo:[1,0,0] neg_hi:[1,0,0]
v_cvt_pk_bf16_f32 v137, v98, v99
v_cvt_pk_bf16_f32 v153, v114, v115
v_pk_fma_f32 v[100:101], v[228:229], v[48:49], v[100:101] op_sel_hi:[0,1,1]
v_pk_fma_f32 v[116:117], v[228:229], v[50:51], v[116:117] op_sel_hi:[0,1,1] neg_lo:[1,0,0] neg_hi:[1,0,0]
v_pk_fma_f32 v[100:101], v[228:229], v[50:51], v[100:101] op_sel:[1,0,0] neg_lo:[1,0,0] neg_hi:[1,0,0]
v_pk_fma_f32 v[116:117], v[228:229], v[48:49], v[116:117] op_sel:[1,0,0] neg_lo:[1,0,0] neg_hi:[1,0,0]
v_cvt_pk_bf16_f32 v138, v100, v101
v_cvt_pk_bf16_f32 v154, v116, v117
v_pk_fma_f32 v[102:103], v[230:231], v[48:49], v[102:103] op_sel_hi:[0,1,1]
v_pk_fma_f32 v[118:119], v[230:231], v[50:51], v[118:119] op_sel_hi:[0,1,1] neg_lo:[1,0,0] neg_hi:[1,0,0]
v_pk_fma_f32 v[102:103], v[230:231], v[50:51], v[102:103] op_sel:[1,0,0] neg_lo:[1,0,0] neg_hi:[1,0,0]
v_pk_fma_f32 v[118:119], v[230:231], v[48:49], v[118:119] op_sel:[1,0,0] neg_lo:[1,0,0] neg_hi:[1,0,0]
v_cvt_pk_bf16_f32 v139, v102, v103
v_cvt_pk_bf16_f32 v155, v118, v119
s_add_u32 s61, s60, 0
v_cvt_pk_bf16_f32 v64, v160, v161
v_cvt_pk_bf16_f32 v65, v162, v163
v_cvt_pk_bf16_f32 v66, v164, v165
v_cvt_pk_bf16_f32 v67, v166, v167
v_cvt_pk_bf16_f32 v68, v168, v169
v_cvt_pk_bf16_f32 v69, v170, v171
v_cvt_pk_bf16_f32 v70, v172, v173
v_cvt_pk_bf16_f32 v71, v174, v175
buffer_store_dwordx4 v[64:67], v11, s[44:47], s61 offen sc1
buffer_store_dwordx4 v[68:71], v11, s[44:47], s61 offen offset:1024 sc1
ds_write_b128 v16, v[64:67] offset:0
ds_write_b128 v16, v[68:71] offset:1024
s_add_u32 s61, s60, 4096
v_cvt_pk_bf16_f32 v72, v176, v177
v_cvt_pk_bf16_f32 v73, v178, v179
v_cvt_pk_bf16_f32 v74, v180, v181
v_cvt_pk_bf16_f32 v75, v182, v183
v_cvt_pk_bf16_f32 v76, v184, v185
v_cvt_pk_bf16_f32 v77, v186, v187
v_cvt_pk_bf16_f32 v78, v188, v189
v_cvt_pk_bf16_f32 v79, v190, v191
buffer_store_dwordx4 v[72:75], v11, s[44:47], s61 offen sc1
buffer_store_dwordx4 v[76:79], v11, s[44:47], s61 offen offset:1024 sc1
ds_write_b128 v16, v[72:75] offset:4096
ds_write_b128 v16, v[76:79] offset:5120
v_pk_fma_f32 v[104:105], v[232:233], v[48:49], v[104:105] op_sel_hi:[0,1,1]
v_pk_fma_f32 v[120:121], v[232:233], v[50:51], v[120:121] op_sel_hi:[0,1,1] neg_lo:[1,0,0] neg_hi:[1,0,0]
v_pk_fma_f32 v[104:105], v[232:233], v[50:51], v[104:105] op_sel:[1,0,0] neg_lo:[1,0,0] neg_hi:[1,0,0]
v_pk_fma_f32 v[120:121], v[232:233], v[48:49], v[120:121] op_sel:[1,0,0] neg_lo:[1,0,0] neg_hi:[1,0,0]
v_cvt_pk_bf16_f32 v140, v104, v105
v_cvt_pk_bf16_f32 v156, v120, v121
v_pk_fma_f32 v[106:107], v[234:235], v[48:49], v[106:107] op_sel_hi:[0,1,1]
v_pk_fma_f32 v[122:123], v[234:235], v[50:51], v[122:123] op_sel_hi:[0,1,1] neg_lo:[1,0,0] neg_hi:[1,0,0]
v_pk_fma_f32 v[106:107], v[234:235], v[50:51], v[106:107] op_sel:[1,0,0] neg_lo:[1,0,0] neg_hi:[1,0,0]
v_pk_fma_f32 v[122:123], v[234:235], v[48:49], v[122:123] op_sel:[1,0,0] neg_lo:[1,0,0] neg_hi:[1,0,0]
v_cvt_pk_bf16_f32 v141, v106, v107
v_cvt_pk_bf16_f32 v157, v122, v123
v_pk_fma_f32 v[108:109], v[236:237], v[48:49], v[108:109] op_sel_hi:[0,1,1]
v_pk_fma_f32 v[124:125], v[236:237], v[50:51], v[124:125] op_sel_hi:[0,1,1] neg_lo:[1,0,0] neg_hi:[1,0,0]
v_pk_fma_f32 v[108:109], v[236:237], v[50:51], v[108:109] op_sel:[1,0,0] neg_lo:[1,0,0] neg_hi:[1,0,0]
v_pk_fma_f32 v[124:125], v[236:237], v[48:49], v[124:125] op_sel:[1,0,0] neg_lo:[1,0,0] neg_hi:[1,0,0]
v_cvt_pk_bf16_f32 v142, v108, v109
v_cvt_pk_bf16_f32 v158, v124, v125
v_pk_fma_f32 v[110:111], v[238:239], v[48:49], v[110:111] op_sel_hi:[0,1,1]
v_pk_fma_f32 v[126:127], v[238:239], v[50:51], v[126:127] op_sel_hi:[0,1,1] neg_lo:[1,0,0] neg_hi:[1,0,0]
v_pk_fma_f32 v[110:111], v[238:239], v[50:51], v[110:111] op_sel:[1,0,0] neg_lo:[1,0,0] neg_hi:[1,0,0]
v_pk_fma_f32 v[126:127], v[238:239], v[48:49], v[126:127] op_sel:[1,0,0] neg_lo:[1,0,0] neg_hi:[1,0,0]
v_cvt_pk_bf16_f32 v143, v110, v111
v_cvt_pk_bf16_f32 v159, v126, v127
v_mfma_f32_32x32x16_bf16 v[192:207], v[136:139], v[248:251], 0
v_mfma_f32_32x32x16_bf16 v[192:207], v[140:143], v[252:255], v[192:207]
v_mfma_f32_32x32x16_bf16 v[32:47], v[152:155], v[248:251], 0
v_mfma_f32_32x32x16_bf16 v[32:47], v[156:159], v[252:255], v[32:47]
s_add_u32 s61, s60, 131072
s_nop 8
v_cvt_pk_bf16_f32 v80, v192, v193
v_cvt_pk_bf16_f32 v81, v194, v195
v_cvt_pk_bf16_f32 v82, v196, v197
v_cvt_pk_bf16_f32 v83, v198, v199
v_cvt_pk_bf16_f32 v84, v200, v201
v_cvt_pk_bf16_f32 v85, v202, v203
v_cvt_pk_bf16_f32 v86, v204, v205
v_cvt_pk_bf16_f32 v87, v206, v207
buffer_store_dwordx4 v[80:83], v11, s[44:47], s61 offen sc1
buffer_store_dwordx4 v[84:87], v11, s[44:47], s61 offen offset:1024 sc1
ds_write_b128 v16, v[80:83] offset:8192
ds_write_b128 v16, v[84:87] offset:9216
s_add_u32 s61, s60, 135168
v_cvt_pk_bf16_f32 v88, v32, v33
v_cvt_pk_bf16_f32 v89, v34, v35
v_cvt_pk_bf16_f32 v90, v36, v37
v_cvt_pk_bf16_f32 v91, v38, v39
v_cvt_pk_bf16_f32 v92, v40, v41
v_cvt_pk_bf16_f32 v93, v42, v43
v_cvt_pk_bf16_f32 v94, v44, v45
v_cvt_pk_bf16_f32 v95, v46, v47
buffer_store_dwordx4 v[88:91], v11, s[44:47], s61 offen sc1
buffer_store_dwordx4 v[92:95], v11, s[44:47], s61 offen offset:1024 sc1
ds_write_b128 v16, v[88:91] offset:12288
ds_write_b128 v16, v[92:95] offset:13312
v_mov_b32 v2, v11
s_lshl_b32 s60, s35, 2
s_add_u32 s60, s60, s34
s_mul_i32 s60, s60, 131072
s_lshl_b32 s61, s101, 16
s_add_u32 s60, s60, s61
s_add_u32 s42, s60, 1048576
s_add_u32 s40, s32, s42
s_addc_u32 s41, s33, 0
s_mov_b32 s42, 65536
s_mov_b32 s43, 0x20000
s_waitcnt vmcnt(8) lgkmcnt(0)
v_mov_b32 v14, 3
s_mov_b64 exec, 1
ds_write_b32 v13, v14
s_mov_b64 exec, -1
ds_read_b128 v[8:11], v12 offset:0
s_waitcnt lgkmcnt(0)
L_ck47:
v_min3_u32 v15, v8, v9, v10
v_min_u32 v15, v15, v11
s_nop 0
v_readfirstlane_b32 s60, v15
s_nop 0
s_cmp_ge_u32 s60, 3
s_cbranch_scc1 L_ckd48
ds_read_b128 v[8:11], v12 offset:0
s_waitcnt lgkmcnt(0)
s_branch L_ck47
L_ckd48:
ds_read_b128 v[148:151], v17 offset:0
ds_read_b128 v[152:155], v17 offset:1024
ds_read_b128 v[156:159], v17 offset:2048
ds_read_b128 v[160:163], v17 offset:3072
ds_read_b128 v[164:167], v17 offset:4096
ds_read_b128 v[168:171], v17 offset:5120
ds_read_b128 v[172:175], v17 offset:6144
ds_read_b128 v[176:179], v17 offset:7168
ds_read_b128 v[96:99], v20 offset:0
ds_read_b128 v[100:103], v20 offset:4096
ds_read_b128 v[104:107], v20 offset:8192
ds_read_b128 v[108:111], v20 offset:12288
s_waitcnt lgkmcnt(4)
v_mov_b32 v14, 4
s_mov_b64 exec, 1
ds_write_b32 v13, v14
s_mov_b64 exec, -1
s_waitcnt lgkmcnt(0)
v_mfma_f32_32x32x16_bf16 v[32:47], v[148:151], v[96:99], 0
ds_read_b128 v[112:115], v21 offset:0
ds_read_b128 v[116:119], v21 offset:4096
v_mfma_f32_32x32x16_bf16 v[48:63], v[148:151], v[100:103], 0
ds_read_b128 v[120:123], v21 offset:8192
ds_read_b128 v[124:127], v21 offset:12288
v_mfma_f32_32x32x16_bf16 v[64:79], v[148:151], v[104:107], 0
s_add_u32 m0, s67, 32768
s_add_u32 s62, s64, 128
s_and_b32 s62, s62, 0x3ff
buffer_load_dwordx4 v244, s[48:51], s62 offen offset:0 lds
v_mfma_f32_32x32x16_bf16 v[80:95], v[148:151], v[108:111], 0
s_waitcnt lgkmcnt(3)
v_mfma_f32_32x32x16_bf16 v[32:47], v[152:155], v[112:115], v[32:47]
ds_read_b128 v[96:99], v22 offset:0
ds_read_b128 v[100:103], v22 offset:4096
s_waitcnt lgkmcnt(4)
v_mfma_f32_32x32x16_bf16 v[48:63], v[152:155], v[116:119], v[48:63]
ds_read_b128 v[104:107], v22 offset:8192
ds_read_b128 v[108:111], v22 offset:12288
s_waitcnt lgkmcnt(5)
v_mfma_f32_32x32x16_bf16 v[64:79], v[152:155], v[120:123], v[64:79]
buffer_load_dwordx4 v245, s[48:51], s62 offen offset:1024 lds
s_waitcnt lgkmcnt(4)
v_mfma_f32_32x32x16_bf16 v[80:95], v[152:155], v[124:127], v[80:95]
s_waitcnt lgkmcnt(3)
v_mfma_f32_32x32x16_bf16 v[32:47], v[156:159], v[96:99], v[32:47]
ds_read_b128 v[112:115], v23 offset:0
ds_read_b128 v[116:119], v23 offset:4096
s_waitcnt lgkmcnt(4)
v_mfma_f32_32x32x16_bf16 v[48:63], v[156:159], v[100:103], v[48:63]
ds_read_b128 v[120:123], v23 offset:8192
ds_read_b128 v[124:127], v23 offset:12288
s_waitcnt lgkmcnt(5)
v_mfma_f32_32x32x16_bf16 v[64:79], v[156:159], v[104:107], v[64:79]
buffer_load_dwordx4 v246, s[48:51], s62 offen offset:2048 lds
s_waitcnt lgkmcnt(4)
v_mfma_f32_32x32x16_bf16 v[80:95], v[156:159], v[108:111], v[80:95]
s_waitcnt lgkmcnt(3)
v_mfma_f32_32x32x16_bf16 v[32:47], v[160:163], v[112:115], v[32:47]
ds_read_b128 v[96:99], v20 offset:16384
ds_read_b128 v[100:103], v20 offset:20480
s_waitcnt lgkmcnt(4)
v_mfma_f32_32x32x16_bf16 v[48:63], v[160:163], v[116:119], v[48:63]
ds_read_b128 v[104:107], v20 offset:24576
ds_read_b128 v[108:111], v20 offset:28672
s_waitcnt lgkmcnt(5)
v_mfma_f32_32x32x16_bf16 v[64:79], v[160:163], v[120:123], v[64:79]
buffer_load_dwordx4 v247, s[48:51], s62 offen offset:3072 lds
s_waitcnt lgkmcnt(4)
v_mfma_f32_32x32x16_bf16 v[80:95], v[160:163], v[124:127], v[80:95]
s_waitcnt lgkmcnt(3)
v_mfma_f32_32x32x16_bf16 v[32:47], v[164:167], v[96:99], v[32:47]
ds_read_b128 v[112:115], v21 offset:16384
ds_read_b128 v[116:119], v21 offset:20480
s_waitcnt lgkmcnt(4)
v_mfma_f32_32x32x16_bf16 v[48:63], v[164:167], v[100:103], v[48:63]
ds_read_b128 v[120:123], v21 offset:24576
ds_read_b128 v[124:127], v21 offset:28672
s_waitcnt lgkmcnt(5)
v_mfma_f32_32x32x16_bf16 v[64:79], v[164:167], v[104:107], v[64:79]
s_add_u32 m0, s67, 49152
s_nop 0
buffer_load_dwordx4 v244, s[52:55], s62 offen offset:0 lds
s_waitcnt lgkmcnt(4)
v_mfma_f32_32x32x16_bf16 v[80:95], v[164:167], v[108:111], v[80:95]
s_waitcnt lgkmcnt(3)
v_mfma_f32_32x32x16_bf16 v[32:47], v[168:171], v[112:115], v[32:47]
ds_read_b128 v[96:99], v22 offset:16384
ds_read_b128 v[100:103], v22 offset:20480
s_waitcnt lgkmcnt(4)
v_mfma_f32_32x32x16_bf16 v[48:63], v[168:171], v[116:119], v[48:63]
ds_read_b128 v[104:107], v22 offset:24576
ds_read_b128 v[108:111], v22 offset:28672
s_waitcnt lgkmcnt(5)
v_mfma_f32_32x32x16_bf16 v[64:79], v[168:171], v[120:123], v[64:79]
buffer_load_dwordx4 v245, s[52:55], s62 offen offset:1024 lds
s_waitcnt lgkmcnt(4)
v_mfma_f32_32x32x16_bf16 v[80:95], v[168:171], v[124:127], v[80:95]
s_waitcnt lgkmcnt(3)
v_mfma_f32_32x32x16_bf16 v[32:47], v[172:175], v[96:99], v[32:47]
ds_read_b128 v[112:115], v23 offset:16384
ds_read_b128 v[116:119], v23 offset:20480
s_waitcnt lgkmcnt(4)
v_mfma_f32_32x32x16_bf16 v[48:63], v[172:175], v[100:103], v[48:63]
ds_read_b128 v[120:123], v23 offset:24576
ds_read_b128 v[124:127], v23 offset:28672
s_waitcnt lgkmcnt(5)
v_mfma_f32_32x32x16_bf16 v[64:79], v[172:175], v[104:107], v[64:79]
buffer_load_dwordx4 v246, s[52:55], s62 offen offset:2048 lds
s_waitcnt lgkmcnt(4)
v_mfma_f32_32x32x16_bf16 v[80:95], v[172:175], v[108:111], v[80:95]
s_waitcnt lgkmcnt(0)
v_mfma_f32_32x32x16_bf16 v[32:47], v[176:179], v[112:115], v[32:47]
v_mfma_f32_32x32x16_bf16 v[48:63], v[176:179], v[116:119], v[48:63]
v_mfma_f32_32x32x16_bf16 v[64:79], v[176:179], v[120:123], v[64:79]
buffer_load_dwordx4 v247, s[52:55], s62 offen offset:3072 lds
v_mfma_f32_32x32x16_bf16 v[80:95], v[176:179], v[124:127], v[80:95]
s_lshl_b32 s60, s66, 3
v_lshl_add_u32 v17, v5, 2, s60
v_lshlrev_b32 v28, 11, v17
v_lshl_add_u32 v28, v6, 2, v28
v_lshlrev_b32 v29, 13, v17
v_lshl_add_u32 v29, v6, 3, v29
v_lshlrev_b32 v30, 2, v6
v_mov_b32 v15, s37
s_waitcnt vmcnt(8)
s_mov_b64 exec, 1
s_cmp_eq_u32 s100, 0
s_cbranch_scc1 L_rs49
global_store_dword v19, v15, s[32:33]
s_branch L_rd50
L_rs49:
global_store_dword v19, v15, s[32:33] sc1
L_rd50:
s_mov_b64 exec, -1
ds_read_b128 v[8:11], v12 offset:0
s_waitcnt lgkmcnt(0)
L_ck51:
v_min3_u32 v15, v8, v9, v10
v_min_u32 v15, v15, v11
s_nop 0
v_readfirstlane_b32 s60, v15
s_nop 0
s_cmp_ge_u32 s60, 4
s_cbranch_scc1 L_ckd52
ds_read_b128 v[8:11], v12 offset:0
s_waitcnt lgkmcnt(0)
s_branch L_ck51
L_ckd52:
ds_read_b128 v[8:11], v12 offset:16
s_waitcnt lgkmcnt(0)
L_ck53:
v_min3_u32 v15, v8, v9, v10
v_min_u32 v15, v15, v11
s_nop 0
v_readfirstlane_b32 s60, v15
s_nop 0
s_cmp_ge_u32 s60, 2
s_cbranch_scc1 L_ckd54
ds_read_b128 v[8:11], v12 offset:16
s_waitcnt lgkmcnt(0)
s_branch L_ck53
L_ckd54:
s_add_u32 m0, s67, 65536
s_add_u32 s62, s64, 256
s_and_b32 s62, s62, 0x3ff
buffer_load_dwordx4 v244, s[48:51], s62 offen offset:0 lds
buffer_load_dwordx4 v245, s[48:51], s62 offen offset:1024 lds
buffer_load_dwordx4 v246, s[48:51], s62 offen offset:2048 lds
buffer_load_dwordx4 v247, s[48:51], s62 offen offset:3072 lds
s_add_u32 m0, s67, 81920
s_nop 0
buffer_load_dwordx4 v244, s[52:55], s62 offen offset:0 lds
buffer_load_dwordx4 v245, s[52:55], s62 offen offset:1024 lds
buffer_load_dwordx4 v246, s[52:55], s62 offen offset:2048 lds
buffer_load_dwordx4 v247, s[52:55], s62 offen offset:3072 lds
s_mov_b32 s92, 0
L_w55:
global_load_dword v8, v18, s[32:33] sc1
s_waitcnt vmcnt(0)
v_cmp_ne_u32 vcc, s37, v8
s_nop 0
s_cbranch_vccz L_wd56
s_sleep 4
s_add_u32 s92, s92, 1
s_cmp_lt_u32 s92, 200000
s_cbranch_scc1 L_w55
L_wd56:
v_mov_b32 v14, 5
s_mov_b64 exec, 1
ds_write_b32 v13, v14
s_mov_b64 exec, -1
s_add_u32 s63, s65, 8192
s_and_b32 s63, s63, 0xffff
buffer_load_dwordx4 v[180:183], v2, s[40:43], s63 offen offset:0 sc1
buffer_load_dwordx4 v[184:187], v2, s[40:43], s63 offen offset:1024 sc1
buffer_load_dwordx4 v[188:191], v2, s[40:43], s63 offen offset:2048 sc1
buffer_load_dwordx4 v[192:195], v2, s[40:43], s63 offen offset:3072 sc1
s_add_u32 m0, s67, 98304
s_add_u32 s62, s64, 384
s_and_b32 s62, s62, 0x3ff
buffer_load_dwordx4 v244, s[48:51], s62 offen offset:0 lds
buffer_load_dwordx4 v245, s[48:51], s62 offen offset:1024 lds
buffer_load_dwordx4 v246, s[48:51], s62 offen offset:2048 lds
buffer_load_dwordx4 v247, s[48:51], s62 offen offset:3072 lds
s_add_u32 s63, s65, 12288
s_and_b32 s63, s63, 0xffff
buffer_load_dwordx4 v[196:199], v2, s[40:43], s63 offen offset:0 sc1
buffer_load_dwordx4 v[200:203], v2, s[40:43], s63 offen offset:1024 sc1
buffer_load_dwordx4 v[204:207], v2, s[40:43], s63 offen offset:2048 sc1
buffer_load_dwordx4 v[208:211], v2, s[40:43], s63 offen offset:3072 sc1
ds_read_b128 v[8:11], v12 offset:0
s_waitcnt lgkmcnt(0)
L_ck57:
v_min3_u32 v15, v8, v9, v10
v_min_u32 v15, v15, v11
s_nop 0
v_readfirstlane_b32 s60, v15
s_nop 0
s_cmp_ge_u32 s60, 5
s_cbranch_scc1 L_ckd58
ds_read_b128 v[8:11], v12 offset:0
s_waitcnt lgkmcnt(0)
s_branch L_ck57
L_ckd58:
ds_read_b128 v[96:99], v20 offset:32768
ds_read_b128 v[100:103], v20 offset:36864
ds_read_b128 v[104:107], v20 offset:40960
ds_read_b128 v[108:111], v20 offset:45056
s_waitcnt vmcnt(11) lgkmcnt(3)
v_mfma_f32_32x32x16_bf16 v[32:47], v[180:183], v[96:99], v[32:47]
ds_read_b128 v[112:115], v21 offset:32768
ds_read_b128 v[116:119], v21 offset:36864
s_waitcnt lgkmcnt(4)
v_mfma_f32_32x32x16_bf16 v[48:63], v[180:183], v[100:103], v[48:63]
ds_read_b128 v[120:123], v21 offset:40960
ds_read_b128 v[124:127], v21 offset:45056
s_waitcnt lgkmcnt(5)
v_mfma_f32_32x32x16_bf16 v[64:79], v[180:183], v[104:107], v[64:79]
s_waitcnt lgkmcnt(4)
v_mfma_f32_32x32x16_bf16 v[80:95], v[180:183], v[108:111], v[80:95]
s_add_u32 s63, s65, 16384
s_and_b32 s63, s63, 0xffff
buffer_load_dwordx4 v[212:215], v2, s[40:43], s63 offen offset:0 sc1
buffer_load_dwordx4 v[216:219], v2, s[40:43], s63 offen offset:1024 sc1
s_waitcnt vmcnt(12) lgkmcnt(3)
v_mfma_f32_32x32x16_bf16 v[32:47], v[184:187], v[112:115], v[32:47]
ds_read_b128 v[96:99], v22 offset:32768
ds_read_b128 v[100:103], v22 offset:36864
s_waitcnt lgkmcnt(4)
v_mfma_f32_32x32x16_bf16 v[48:63], v[184:187], v[116:119], v[48:63]
ds_read_b128 v[104:107], v22 offset:40960
ds_read_b128 v[108:111], v22 offset:45056
s_waitcnt lgkmcnt(5)
v_mfma_f32_32x32x16_bf16 v[64:79], v[184:187], v[120:123], v[64:79]
s_waitcnt lgkmcnt(4)
v_mfma_f32_32x32x16_bf16 v[80:95], v[184:187], v[124:127], v[80:95]
buffer_load_dwordx4 v[220:223], v2, s[40:43], s63 offen offset:2048 sc1
buffer_load_dwordx4 v[224:227], v2, s[40:43], s63 offen offset:3072 sc1
s_waitcnt vmcnt(13) lgkmcnt(3)
v_mfma_f32_32x32x16_bf16 v[32:47], v[188:191], v[96:99], v[32:47]
ds_read_b128 v[112:115], v23 offset:32768
ds_read_b128 v[116:119], v23 offset:36864
s_waitcnt lgkmcnt(4)
v_mfma_f32_32x32x16_bf16 v[48:63], v[188:191], v[100:103], v[48:63]
ds_read_b128 v[120:123], v23 offset:40960
ds_read_b128 v[124:127], v23 offset:45056
s_waitcnt lgkmcnt(5)
v_mfma_f32_32x32x16_bf16 v[64:79], v[188:191], v[104:107], v[64:79]
s_waitcnt lgkmcnt(4)
v_mfma_f32_32x32x16_bf16 v[80:95], v[188:191], v[108:111], v[80:95]
s_add_u32 s63, s65, 20480
s_and_b32 s63, s63, 0xffff
buffer_load_dwordx4 v[228:231], v2, s[40:43], s63 offen offset:0 sc1
buffer_load_dwordx4 v[232:235], v2, s[40:43], s63 offen offset:1024 sc1
s_waitcnt vmcnt(14) lgkmcnt(3)
v_mfma_f32_32x32x16_bf16 v[32:47], v[192:195], v[112:115], v[32:47]
ds_read_b128 v[96:99], v20 offset:49152
ds_read_b128 v[100:103], v20 offset:53248
s_waitcnt lgkmcnt(4)
v_mfma_f32_32x32x16_bf16 v[48:63], v[192:195], v[116:119], v[48:63]
ds_read_b128 v[104:107], v20 offset:57344
ds_read_b128 v[108:111], v20 offset:61440
s_waitcnt lgkmcnt(5)
v_mfma_f32_32x32x16_bf16 v[64:79], v[192:195], v[120:123], v[64:79]
s_waitcnt lgkmcnt(4)
v_mfma_f32_32x32x16_bf16 v[80:95], v[192:195], v[124:127], v[80:95]
buffer_load_dwordx4 v[236:239], v2, s[40:43], s63 offen offset:2048 sc1
buffer_load_dwordx4 v[240:243], v2, s[40:43], s63 offen offset:3072 sc1
s_waitcnt vmcnt(11) lgkmcnt(3)
v_mov_b32 v14, 6
s_mov_b64 exec, 1
ds_write_b32 v13, v14
s_mov_b64 exec, -1
v_mfma_f32_32x32x16_bf16 v[32:47], v[196:199], v[96:99], v[32:47]
ds_read_b128 v[112:115], v21 offset:49152
ds_read_b128 v[116:119], v21 offset:53248
s_waitcnt lgkmcnt(5)
v_mfma_f32_32x32x16_bf16 v[48:63], v[196:199], v[100:103], v[48:63]
ds_read_b128 v[120:123], v21 offset:57344
ds_read_b128 v[124:127], v21 offset:61440
s_waitcnt lgkmcnt(6)
v_mfma_f32_32x32x16_bf16 v[64:79], v[196:199], v[104:107], v[64:79]
s_add_u32 m0, s67, 0
s_nop 0
buffer_load_dwordx4 v244, s[52:55], s62 offen offset:0 lds
s_waitcnt lgkmcnt(5)
v_mfma_f32_32x32x16_bf16 v[80:95], v[196:199], v[108:111], v[80:95]
s_add_u32 s63, s65, 24576
s_and_b32 s63, s63, 0xffff
buffer_load_dwordx4 v[148:151], v2, s[40:43], s63 offen offset:0 sc1
buffer_load_dwordx4 v[152:155], v2, s[40:43], s63 offen offset:1024 sc1
s_waitcnt vmcnt(13) lgkmcnt(3)
v_mfma_f32_32x32x16_bf16 v[32:47], v[200:203], v[112:115], v[32:47]
ds_read_b128 v[96:99], v22 offset:49152
ds_read_b128 v[100:103], v22 offset:53248
s_waitcnt lgkmcnt(4)
v_mfma_f32_32x32x16_bf16 v[48:63], v[200:203], v[116:119], v[48:63]
ds_read_b128 v[104:107], v22 offset:57344
ds_read_b128 v[108:111], v22 offset:61440
s_waitcnt lgkmcnt(5)
v_mfma_f32_32x32x16_bf16 v[64:79], v[200:203], v[120:123], v[64:79]
buffer_load_dwordx4 v245, s[52:55], s62 offen offset:1024 lds
s_waitcnt lgkmcnt(4)
v_mfma_f32_32x32x16_bf16 v[80:95], v[200:203], v[124:127], v[80:95]
buffer_load_dwordx4 v[156:159], v2, s[40:43], s63 offen offset:2048 sc1
buffer_load_dwordx4 v[160:163], v2, s[40:43], s63 offen offset:3072 sc1
s_waitcnt vmcnt(15) lgkmcnt(3)
v_mfma_f32_32x32x16_bf16 v[32:47], v[204:207], v[96:99], v[32:47]
ds_read_b128 v[112:115], v23 offset:49152
ds_read_b128 v[116:119], v23 offset:53248
s_waitcnt lgkmcnt(4)
v_mfma_f32_32x32x16_bf16 v[48:63], v[204:207], v[100:103], v[48:63]
ds_read_b128 v[120:123], v23 offset:57344
ds_read_b128 v[124:127], v23 offset:61440
s_waitcnt lgkmcnt(5)
v_mfma_f32_32x32x16_bf16 v[64:79], v[204:207], v[104:107], v[64:79]
buffer_load_dwordx4 v246, s[52:55], s62 offen offset:2048 lds
s_waitcnt lgkmcnt(4)
v_mfma_f32_32x32x16_bf16 v[80:95], v[204:207], v[108:111], v[80:95]
s_add_u32 s63, s65, 28672
s_and_b32 s63, s63, 0xffff
buffer_load_dwordx4 v[164:167], v2, s[40:43], s63 offen offset:0 sc1
buffer_load_dwordx4 v[168:171], v2, s[40:43], s63 offen offset:1024 sc1
ds_read_b128 v[8:11], v12
s_waitcnt vmcnt(17) lgkmcnt(0)
L_ck59:
v_min3_u32 v15, v8, v9, v10
v_min_u32 v15, v15, v11
s_nop 0
v_readfirstlane_b32 s60, v15
s_nop 0
s_cmp_ge_u32 s60, 6
s_cbranch_scc1 L_ckd60
ds_read_b128 v[8:11], v12 offset:0
s_waitcnt lgkmcnt(0)
s_branch L_ck59
L_ckd60:
v_mfma_f32_32x32x16_bf16 v[32:47], v[208:211], v[112:115], v[32:47]
ds_read_b128 v[96:99], v24 offset:0
ds_read_b128 v[100:103], v24 offset:4096
v_mfma_f32_32x32x16_bf16 v[48:63], v[208:211], v[116:119], v[48:63]
ds_read_b128 v[104:107], v24 offset:8192
ds_read_b128 v[108:111], v24 offset:12288
v_mfma_f32_32x32x16_bf16 v[64:79], v[208:211], v[120:123], v[64:79]
buffer_load_dwordx4 v247, s[52:55], s62 offen offset:3072 lds
v_mfma_f32_32x32x16_bf16 v[80:95], v[208:211], v[124:127], v[80:95]
buffer_load_dwordx4 v[172:175], v2, s[40:43], s63 offen offset:2048 sc1
buffer_load_dwordx4 v[176:179], v2, s[40:43], s63 offen offset:3072 sc1
s_waitcnt vmcnt(19) lgkmcnt(3)
v_mfma_f32_32x32x16_bf16 v[32:47], v[212:215], v[96:99], v[32:47]
ds_read_b128 v[112:115], v25 offset:0
ds_read_b128 v[116:119], v25 offset:4096
s_waitcnt lgkmcnt(4)
v_mfma_f32_32x32x16_bf16 v[48:63], v[212:215], v[100:103], v[48:63]
ds_read_b128 v[120:123], v25 offset:8192
ds_read_b128 v[124:127], v25 offset:12288
s_waitcnt lgkmcnt(5)
v_mfma_f32_32x32x16_bf16 v[64:79], v[212:215], v[104:107], v[64:79]
s_add_u32 m0, s67, 16384
s_add_u32 s62, s64, 512
s_and_b32 s62, s62, 0x3ff
buffer_load_dwordx4 v244, s[48:51], s62 offen offset:0 lds
s_waitcnt lgkmcnt(4)
v_mfma_f32_32x32x16_bf16 v[80:95], v[212:215], v[108:111], v[80:95]
s_add_u32 s63, s65, 32768
s_and_b32 s63, s63, 0xffff
buffer_load_dwordx4 v[180:183], v2, s[40:43], s63 offen offset:0 sc1
buffer_load_dwordx4 v[184:187], v2, s[40:43], s63 offen offset:1024 sc1
s_waitcnt vmcnt(21) lgkmcnt(3)
v_mfma_f32_32x32x16_bf16 v[32:47], v[216:219], v[112:115], v[32:47]
ds_read_b128 v[96:99], v26 offset:0
ds_read_b128 v[100:103], v26 offset:4096
s_waitcnt lgkmcnt(4)
v_mfma_f32_32x32x16_bf16 v[48:63], v[216:219], v[116:119], v[48:63]
ds_read_b128 v[104:107], v26 offset:8192
ds_read_b128 v[108:111], v26 offset:12288
s_waitcnt lgkmcnt(5)
v_mfma_f32_32x32x16_bf16 v[64:79], v[216:219], v[120:123], v[64:79]
buffer_load_dwordx4 v245, s[48:51], s62 offen offset:1024 lds
s_waitcnt lgkmcnt(4)
v_mfma_f32_32x32x16_bf16 v[80:95], v[216:219], v[124:127], v[80:95]
buffer_load_dwordx4 v[188:191], v2, s[40:43], s63 offen offset:2048 sc1
buffer_load_dwordx4 v[192:195], v2, s[40:43], s63 offen offset:3072 sc1
s_waitcnt vmcnt(23) lgkmcnt(3)
v_mfma_f32_32x32x16_bf16 v[32:47], v[220:223], v[96:99], v[32:47]
ds_read_b128 v[112:115], v27 offset:0
ds_read_b128 v[116:119], v27 offset:4096
s_waitcnt lgkmcnt(4)
v_mfma_f32_32x32x16_bf16 v[48:63], v[220:223], v[100:103], v[48:63]
ds_read_b128 v[120:123], v27 offset:8192
ds_read_b128 v[124:127], v27 offset:12288
s_waitcnt lgkmcnt(5)
v_mfma_f32_32x32x16_bf16 v[64:79], v[220:223], v[104:107], v[64:79]
buffer_load_dwordx4 v246, s[48:51], s62 offen offset:2048 lds
s_waitcnt lgkmcnt(4)
v_mfma_f32_32x32x16_bf16 v[80:95], v[220:223], v[108:111], v[80:95]
s_add_u32 s63, s65, 36864
s_and_b32 s63, s63, 0xffff
buffer_load_dwordx4 v[196:199], v2, s[40:43], s63 offen offset:0 sc1
buffer_load_dwordx4 v[200:203], v2, s[40:43], s63 offen offset:1024 sc1
s_waitcnt vmcnt(25) lgkmcnt(3)
v_mfma_f32_32x32x16_bf16 v[32:47], v[224:227], v[112:115], v[32:47]
ds_read_b128 v[96:99], v24 offset:16384
ds_read_b128 v[100:103], v24 offset:20480
s_waitcnt lgkmcnt(4)
v_mfma_f32_32x32x16_bf16 v[48:63], v[224:227], v[116:119], v[48:63]
ds_read_b128 v[104:107], v24 offset:24576
ds_read_b128 v[108:111], v24 offset:28672
s_waitcnt lgkmcnt(5)
v_mfma_f32_32x32x16_bf16 v[64:79], v[224:227], v[120:123], v[64:79]
buffer_load_dwordx4 v247, s[48:51], s62 offen offset:3072 lds
s_waitcnt lgkmcnt(4)
v_mfma_f32_32x32x16_bf16 v[80:95], v[224:227], v[124:127], v[80:95]
buffer_load_dwordx4 v[204:207], v2, s[40:43], s63 offen offset:2048 sc1
buffer_load_dwordx4 v[208:211], v2, s[40:43], s63 offen offset:3072 sc1
s_waitcnt vmcnt(14) lgkmcnt(3)
v_mov_b32 v14, 7
s_mov_b64 exec, 1
ds_write_b32 v13, v14
s_mov_b64 exec, -1
v_mfma_f32_32x32x16_bf16 v[32:47], v[228:231], v[96:99], v[32:47]
ds_read_b128 v[112:115], v25 offset:16384
ds_read_b128 v[116:119], v25 offset:20480
s_waitcnt lgkmcnt(5)
v_mfma_f32_32x32x16_bf16 v[48:63], v[228:231], v[100:103], v[48:63]
ds_read_b128 v[120:123], v25 offset:24576
ds_read_b128 v[124:127], v25 offset:28672
s_waitcnt lgkmcnt(6)
v_mfma_f32_32x32x16_bf16 v[64:79], v[228:231], v[104:107], v[64:79]
s_add_u32 m0, s67, 32768
s_nop 0
buffer_load_dwordx4 v244, s[52:55], s62 offen offset:0 lds
s_waitcnt lgkmcnt(5)
v_mfma_f32_32x32x16_bf16 v[80:95], v[228:231], v[108:111], v[80:95]
s_add_u32 s63, s65, 40960
s_and_b32 s63, s63, 0xffff
buffer_load_dwordx4 v[212:215], v2, s[40:43], s63 offen offset:0 sc1
buffer_load_dwordx4 v[216:219], v2, s[40:43], s63 offen offset:1024 sc1
s_waitcnt vmcnt(29) lgkmcnt(3)
v_mfma_f32_32x32x16_bf16 v[32:47], v[232:235], v[112:115], v[32:47]
ds_read_b128 v[96:99], v26 offset:16384
ds_read_b128 v[100:103], v26 offset:20480
s_waitcnt lgkmcnt(4)
v_mfma_f32_32x32x16_bf16 v[48:63], v[232:235], v[116:119], v[48:63]
ds_read_b128 v[104:107], v26 offset:24576
ds_read_b128 v[108:111], v26 offset:28672
s_waitcnt lgkmcnt(5)
v_mfma_f32_32x32x16_bf16 v[64:79], v[232:235], v[120:123], v[64:79]
buffer_load_dwordx4 v245, s[52:55], s62 offen offset:1024 lds
s_waitcnt lgkmcnt(4)
v_mfma_f32_32x32x16_bf16 v[80:95], v[232:235], v[124:127], v[80:95]
buffer_load_dwordx4 v[220:223], v2, s[40:43], s63 offen offset:2048 sc1
buffer_load_dwordx4 v[224:227], v2, s[40:43], s63 offen offset:3072 sc1
s_waitcnt vmcnt(31) lgkmcnt(3)
v_mfma_f32_32x32x16_bf16 v[32:47], v[236:239], v[96:99], v[32:47]
ds_read_b128 v[112:115], v27 offset:16384
ds_read_b128 v[116:119], v27 offset:20480
s_waitcnt lgkmcnt(4)
v_mfma_f32_32x32x16_bf16 v[48:63], v[236:239], v[100:103], v[48:63]
ds_read_b128 v[120:123], v27 offset:24576
ds_read_b128 v[124:127], v27 offset:28672
s_waitcnt lgkmcnt(5)
v_mfma_f32_32x32x16_bf16 v[64:79], v[236:239], v[104:107], v[64:79]
buffer_load_dwordx4 v246, s[52:55], s62 offen offset:2048 lds
s_waitcnt lgkmcnt(4)
v_mfma_f32_32x32x16_bf16 v[80:95], v[236:239], v[108:111], v[80:95]
s_add_u32 s63, s65, 45056
s_and_b32 s63, s63, 0xffff
buffer_load_dwordx4 v[228:231], v2, s[40:43], s63 offen offset:0 sc1
buffer_load_dwordx4 v[232:235], v2, s[40:43], s63 offen offset:1024 sc1
ds_read_b128 v[8:11], v12
s_waitcnt vmcnt(33) lgkmcnt(0)
L_ck61:
v_min3_u32 v15, v8, v9, v10
v_min_u32 v15, v15, v11
s_nop 0
v_readfirstlane_b32 s60, v15
s_nop 0
s_cmp_ge_u32 s60, 7
s_cbranch_scc1 L_ckd62
ds_read_b128 v[8:11], v12 offset:0
s_waitcnt lgkmcnt(0)
s_branch L_ck61
L_ckd62:
v_mfma_f32_32x32x16_bf16 v[32:47], v[240:243], v[112:115], v[32:47]
ds_read_b128 v[96:99], v24 offset:32768
ds_read_b128 v[100:103], v24 offset:36864
v_mfma_f32_32x32x16_bf16 v[48:63], v[240:243], v[116:119], v[48:63]
ds_read_b128 v[104:107], v24 offset:40960
ds_read_b128 v[108:111], v24 offset:45056
v_mfma_f32_32x32x16_bf16 v[64:79], v[240:243], v[120:123], v[64:79]
buffer_load_dwordx4 v247, s[52:55], s62 offen offset:3072 lds
v_mfma_f32_32x32x16_bf16 v[80:95], v[240:243], v[124:127], v[80:95]
buffer_load_dwordx4 v[236:239], v2, s[40:43], s63 offen offset:2048 sc1
buffer_load_dwordx4 v[240:243], v2, s[40:43], s63 offen offset:3072 sc1
s_waitcnt vmcnt(34) lgkmcnt(3)
v_mfma_f32_32x32x16_bf16 v[32:47], v[148:151], v[96:99], v[32:47]
ds_read_b128 v[112:115], v25 offset:32768
ds_read_b128 v[116:119], v25 offset:36864
s_waitcnt lgkmcnt(4)
v_mfma_f32_32x32x16_bf16 v[48:63], v[148:151], v[100:103], v[48:63]
ds_read_b128 v[120:123], v25 offset:40960
ds_read_b128 v[124:127], v25 offset:45056
s_waitcnt lgkmcnt(5)
v_mfma_f32_32x32x16_bf16 v[64:79], v[148:151], v[104:107], v[64:79]
s_add_u32 m0, s67, 49152
s_add_u32 s62, s64, 640
s_and_b32 s62, s62, 0x3ff
buffer_load_dwordx4 v244, s[48:51], s62 offen offset:0 lds
s_waitcnt lgkmcnt(4)
v_mfma_f32_32x32x16_bf16 v[80:95], v[148:151], v[108:111], v[80:95]
s_add_u32 s63, s65, 49152
s_and_b32 s63, s63, 0xffff
buffer_load_dwordx4 v[148:151], v2, s[40:43], s63 offen offset:0 sc1
s_waitcnt vmcnt(35) lgkmcnt(3)
v_mfma_f32_32x32x16_bf16 v[32:47], v[152:155], v[112:115], v[32:47]
ds_read_b128 v[96:99], v26 offset:32768
ds_read_b128 v[100:103], v26 offset:36864
s_waitcnt lgkmcnt(4)
v_mfma_f32_32x32x16_bf16 v[48:63], v[152:155], v[116:119], v[48:63]
ds_read_b128 v[104:107], v26 offset:40960
ds_read_b128 v[108:111], v26 offset:45056
s_waitcnt lgkmcnt(5)
v_mfma_f32_32x32x16_bf16 v[64:79], v[152:155], v[120:123], v[64:79]
buffer_load_dwordx4 v245, s[48:51], s62 offen offset:1024 lds
s_waitcnt lgkmcnt(4)
v_mfma_f32_32x32x16_bf16 v[80:95], v[152:155], v[124:127], v[80:95]
buffer_load_dwordx4 v[152:155], v2, s[40:43], s63 offen offset:1024 sc1
s_waitcnt vmcnt(35) lgkmcnt(3)
v_mfma_f32_32x32x16_bf16 v[32:47], v[156:159], v[96:99], v[32:47]
ds_read_b128 v[112:115], v27 offset:32768
ds_read_b128 v[116:119], v27 offset:36864
s_waitcnt lgkmcnt(4)
v_mfma_f32_32x32x16_bf16 v[48:63], v[156:159], v[100:103], v[48:63]
ds_read_b128 v[120:123], v27 offset:40960
ds_read_b128 v[124:127], v27 offset:45056
s_waitcnt lgkmcnt(5)
v_mfma_f32_32x32x16_bf16 v[64:79], v[156:159], v[104:107], v[64:79]
buffer_load_dwordx4 v246, s[48:51], s62 offen offset:2048 lds
s_waitcnt lgkmcnt(4)
v_mfma_f32_32x32x16_bf16 v[80:95], v[156:159], v[108:111], v[80:95]
buffer_load_dwordx4 v[156:159], v2, s[40:43], s63 offen offset:2048 sc1
s_waitcnt vmcnt(36) lgkmcnt(3)
v_mfma_f32_32x32x16_bf16 v[32:47], v[160:163], v[112:115], v[32:47]
ds_read_b128 v[96:99], v20 offset:0
ds_read_b128 v[100:103], v20 offset:4096
s_waitcnt lgkmcnt(4)
v_mfma_f32_32x32x16_bf16 v[48:63], v[160:163], v[116:119], v[48:63]
ds_read_b128 v[104:107], v20 offset:8192
ds_read_b128 v[108:111], v20 offset:12288
s_waitcnt lgkmcnt(5)
v_mfma_f32_32x32x16_bf16 v[64:79], v[160:163], v[120:123], v[64:79]
buffer_load_dwordx4 v247, s[48:51], s62 offen offset:3072 lds
s_waitcnt lgkmcnt(4)
v_mfma_f32_32x32x16_bf16 v[80:95], v[160:163], v[124:127], v[80:95]
buffer_load_dwordx4 v[160:163], v2, s[40:43], s63 offen offset:3072 sc1
s_waitcnt vmcnt(10) lgkmcnt(3)
v_mov_b32 v14, 8
s_mov_b64 exec, 1
ds_write_b32 v13, v14
s_mov_b64 exec, -1
v_mfma_f32_32x32x16_bf16 v[32:47], v[164:167], v[96:99], v[32:47]
ds_read_b128 v[112:115], v21 offset:0
ds_read_b128 v[116:119], v21 offset:4096
s_waitcnt lgkmcnt(5)
v_mfma_f32_32x32x16_bf16 v[48:63], v[164:167], v[100:103], v[48:63]
ds_read_b128 v[120:123], v21 offset:8192
ds_read_b128 v[124:127], v21 offset:12288
s_waitcnt lgkmcnt(6)
v_mfma_f32_32x32x16_bf16 v[64:79], v[164:167], v[104:107], v[64:79]
s_add_u32 m0, s67, 65536
s_nop 0
buffer_load_dwordx4 v244, s[52:55], s62 offen offset:0 lds
s_waitcnt lgkmcnt(5)
v_mfma_f32_32x32x16_bf16 v[80:95], v[164:167], v[108:111], v[80:95]
s_add_u32 s63, s65, 53248
s_and_b32 s63, s63, 0xffff
buffer_load_dwordx4 v[164:167], v2, s[40:43], s63 offen offset:0 sc1
s_waitcnt vmcnt(37) lgkmcnt(3)
v_mfma_f32_32x32x16_bf16 v[32:47], v[168:171], v[112:115], v[32:47]
ds_read_b128 v[96:99], v22 offset:0
ds_read_b128 v[100:103], v22 offset:4096
s_waitcnt lgkmcnt(4)
v_mfma_f32_32x32x16_bf16 v[48:63], v[168:171], v[116:119], v[48:63]
ds_read_b128 v[104:107], v22 offset:8192
ds_read_b128 v[108:111], v22 offset:12288
s_waitcnt lgkmcnt(5)
v_mfma_f32_32x32x16_bf16 v[64:79], v[168:171], v[120:123], v[64:79]
buffer_load_dwordx4 v245, s[52:55], s62 offen offset:1024 lds
s_waitcnt lgkmcnt(4)
v_mfma_f32_32x32x16_bf16 v[80:95], v[168:171], v[124:127], v[80:95]
buffer_load_dwordx4 v[168:171], v2, s[40:43], s63 offen offset:1024 sc1
s_waitcnt vmcnt(37) lgkmcnt(3)
v_mfma_f32_32x32x16_bf16 v[32:47], v[172:175], v[96:99], v[32:47]
ds_read_b128 v[112:115], v23 offset:0
ds_read_b128 v[116:119], v23 offset:4096
s_waitcnt lgkmcnt(4)
v_mfma_f32_32x32x16_bf16 v[48:63], v[172:175], v[100:103], v[48:63]
ds_read_b128 v[120:123], v23 offset:8192
ds_read_b128 v[124:127], v23 offset:12288
s_waitcnt lgkmcnt(5)
v_mfma_f32_32x32x16_bf16 v[64:79], v[172:175], v[104:107], v[64:79]
buffer_load_dwordx4 v246, s[52:55], s62 offen offset:2048 lds
s_waitcnt lgkmcnt(4)
v_mfma_f32_32x32x16_bf16 v[80:95], v[172:175], v[108:111], v[80:95]
buffer_load_dwordx4 v[172:175], v2, s[40:43], s63 offen offset:2048 sc1
ds_read_b128 v[8:11], v12
s_waitcnt vmcnt(38) lgkmcnt(0)
L_ck63:
v_min3_u32 v15, v8, v9, v10
v_min_u32 v15, v15, v11
s_nop 0
v_readfirstlane_b32 s60, v15
s_nop 0
s_cmp_ge_u32 s60, 8
s_cbranch_scc1 L_ckd64
ds_read_b128 v[8:11], v12 offset:0
s_waitcnt lgkmcnt(0)
s_branch L_ck63
L_ckd64:
v_mfma_f32_32x32x16_bf16 v[32:47], v[176:179], v[112:115], v[32:47]
ds_read_b128 v[96:99], v20 offset:16384
ds_read_b128 v[100:103], v20 offset:20480
v_mfma_f32_32x32x16_bf16 v[48:63], v[176:179], v[116:119], v[48:63]
ds_read_b128 v[104:107], v20 offset:24576
ds_read_b128 v[108:111], v20 offset:28672
v_mfma_f32_32x32x16_bf16 v[64:79], v[176:179], v[120:123], v[64:79]
buffer_load_dwordx4 v247, s[52:55], s62 offen offset:3072 lds
v_mfma_f32_32x32x16_bf16 v[80:95], v[176:179], v[124:127], v[80:95]
buffer_load_dwordx4 v[176:179], v2, s[40:43], s63 offen offset:3072 sc1
s_waitcnt vmcnt(38) lgkmcnt(3)
v_mfma_f32_32x32x16_bf16 v[32:47], v[180:183], v[96:99], v[32:47]
ds_read_b128 v[112:115], v21 offset:16384
ds_read_b128 v[116:119], v21 offset:20480
s_waitcnt lgkmcnt(4)
v_mfma_f32_32x32x16_bf16 v[48:63], v[180:183], v[100:103], v[48:63]
ds_read_b128 v[120:123], v21 offset:24576
ds_read_b128 v[124:127], v21 offset:28672
s_waitcnt lgkmcnt(5)
v_mfma_f32_32x32x16_bf16 v[64:79], v[180:183], v[104:107], v[64:79]
s_add_u32 m0, s67, 81920
s_add_u32 s62, s64, 768
s_and_b32 s62, s62, 0x3ff
buffer_load_dwordx4 v244, s[48:51], s62 offen offset:0 lds
s_waitcnt lgkmcnt(4)
v_mfma_f32_32x32x16_bf16 v[80:95], v[180:183], v[108:111], v[80:95]
s_add_u32 s63, s65, 57344
s_and_b32 s63, s63, 0xffff
buffer_load_dwordx4 v[180:183], v2, s[40:43], s63 offen offset:0 sc1
s_waitcnt vmcnt(39) lgkmcnt(3)
v_mfma_f32_32x32x16_bf16 v[32:47], v[184:187], v[112:115], v[32:47]
ds_read_b128 v[96:99], v22 offset:16384
ds_read_b128 v[100:103], v22 offset:20480
s_waitcnt lgkmcnt(4)
v_mfma_f32_32x32x16_bf16 v[48:63], v[184:187], v[116:119], v[48:63]
ds_read_b128 v[104:107], v22 offset:24576
ds_read_b128 v[108:111], v22 offset:28672
s_waitcnt lgkmcnt(5)
v_mfma_f32_32x32x16_bf16 v[64:79], v[184:187], v[120:123], v[64:79]
buffer_load_dwordx4 v245, s[48:51], s62 offen offset:1024 lds
s_waitcnt lgkmcnt(4)
v_mfma_f32_32x32x16_bf16 v[80:95], v[184:187], v[124:127], v[80:95]
buffer_load_dwordx4 v[184:187], v2, s[40:43], s63 offen offset:1024 sc1
s_waitcnt vmcnt(39) lgkmcnt(3)
v_mfma_f32_32x32x16_bf16 v[32:47], v[188:191], v[96:99], v[32:47]
ds_read_b128 v[112:115], v23 offset:16384
ds_read_b128 v[116:119], v23 offset:20480
s_waitcnt lgkmcnt(4)
v_mfma_f32_32x32x16_bf16 v[48:63], v[188:191], v[100:103], v[48:63]
ds_read_b128 v[120:123], v23 offset:24576
ds_read_b128 v[124:127], v23 offset:28672
s_waitcnt lgkmcnt(5)
v_mfma_f32_32x32x16_bf16 v[64:79], v[188:191], v[104:107], v[64:79]
buffer_load_dwordx4 v246, s[48:51], s62 offen offset:2048 lds
s_waitcnt lgkmcnt(4)
v_mfma_f32_32x32x16_bf16 v[80:95], v[188:191], v[108:111], v[80:95]
buffer_load_dwordx4 v[188:191], v2, s[40:43], s63 offen offset:2048 sc1
s_waitcnt vmcnt(40) lgkmcnt(3)
v_mfma_f32_32x32x16_bf16 v[32:47], v[192:195], v[112:115], v[32:47]
ds_read_b128 v[96:99], v20 offset:32768
ds_read_b128 v[100:103], v20 offset:36864
s_waitcnt lgkmcnt(4)
v_mfma_f32_32x32x16_bf16 v[48:63], v[192:195], v[116:119], v[48:63]
ds_read_b128 v[104:107], v20 offset:40960
ds_read_b128 v[108:111], v20 offset:45056
s_waitcnt lgkmcnt(5)
v_mfma_f32_32x32x16_bf16 v[64:79], v[192:195], v[120:123], v[64:79]
buffer_load_dwordx4 v247, s[48:51], s62 offen offset:3072 lds
s_waitcnt lgkmcnt(4)
v_mfma_f32_32x32x16_bf16 v[80:95], v[192:195], v[124:127], v[80:95]
buffer_load_dwordx4 v[192:195], v2, s[40:43], s63 offen offset:3072 sc1
s_waitcnt vmcnt(9) lgkmcnt(3)
v_mov_b32 v14, 9
s_mov_b64 exec, 1
ds_write_b32 v13, v14
s_mov_b64 exec, -1
v_mfma_f32_32x32x16_bf16 v[32:47], v[196:199], v[96:99], v[32:47]
ds_read_b128 v[112:115], v21 offset:32768
ds_read_b128 v[116:119], v21 offset:36864
s_waitcnt lgkmcnt(5)
v_mfma_f32_32x32x16_bf16 v[48:63], v[196:199], v[100:103], v[48:63]
ds_read_b128 v[120:123], v21 offset:40960
ds_read_b128 v[124:127], v21 offset:45056
s_waitcnt lgkmcnt(6)
v_mfma_f32_32x32x16_bf16 v[64:79], v[196:199], v[104:107], v[64:79]
s_add_u32 m0, s67, 98304
s_nop 0
buffer_load_dwordx4 v244, s[52:55], s62 offen offset:0 lds
s_waitcnt lgkmcnt(5)
v_mfma_f32_32x32x16_bf16 v[80:95], v[196:199], v[108:111], v[80:95]
s_add_u32 s63, s65, 61440
s_and_b32 s63, s63, 0xffff
buffer_load_dwordx4 v[196:199], v2, s[40:43], s63 offen offset:0 sc1
s_waitcnt vmcnt(41) lgkmcnt(3)
v_mfma_f32_32x32x16_bf16 v[32:47], v[200:203], v[112:115], v[32:47]
ds_read_b128 v[96:99], v22 offset:32768
ds_read_b128 v[100:103], v22 offset:36864
s_waitcnt lgkmcnt(4)
v_mfma_f32_32x32x16_bf16 v[48:63], v[200:203], v[116:119], v[48:63]
ds_read_b128 v[104:107], v22 offset:40960
ds_read_b128 v[108:111], v22 offset:45056
s_waitcnt lgkmcnt(5)
v_mfma_f32_32x32x16_bf16 v[64:79], v[200:203], v[120:123], v[64:79]
buffer_load_dwordx4 v245, s[52:55], s62 offen offset:1024 lds
s_waitcnt lgkmcnt(4)
v_mfma_f32_32x32x16_bf16 v[80:95], v[200:203], v[124:127], v[80:95]
buffer_load_dwordx4 v[200:203], v2, s[40:43], s63 offen offset:1024 sc1
s_waitcnt vmcnt(41) lgkmcnt(3)
v_mfma_f32_32x32x16_bf16 v[32:47], v[204:207], v[96:99], v[32:47]
ds_read_b128 v[112:115], v23 offset:32768
ds_read_b128 v[116:119], v23 offset:36864
s_waitcnt lgkmcnt(4)
v_mfma_f32_32x32x16_bf16 v[48:63], v[204:207], v[100:103], v[48:63]
ds_read_b128 v[120:123], v23 offset:40960
ds_read_b128 v[124:127], v23 offset:45056
s_waitcnt lgkmcnt(5)
v_mfma_f32_32x32x16_bf16 v[64:79], v[204:207], v[104:107], v[64:79]
buffer_load_dwordx4 v246, s[52:55], s62 offen offset:2048 lds
s_waitcnt lgkmcnt(4)
v_mfma_f32_32x32x16_bf16 v[80:95], v[204:207], v[108:111], v[80:95]
buffer_load_dwordx4 v[204:207], v2, s[40:43], s63 offen offset:2048 sc1
ds_read_b128 v[8:11], v12
s_waitcnt vmcnt(42) lgkmcnt(0)
L_ck65:
v_min3_u32 v15, v8, v9, v10
v_min_u32 v15, v15, v11
s_nop 0
v_readfirstlane_b32 s60, v15
s_nop 0
s_cmp_ge_u32 s60, 9
s_cbranch_scc1 L_ckd66
ds_read_b128 v[8:11], v12 offset:0
s_waitcnt lgkmcnt(0)
s_branch L_ck65
L_ckd66:
v_mfma_f32_32x32x16_bf16 v[32:47], v[208:211], v[112:115], v[32:47]
ds_read_b128 v[96:99], v20 offset:49152
ds_read_b128 v[100:103], v20 offset:53248
v_mfma_f32_32x32x16_bf16 v[48:63], v[208:211], v[116:119], v[48:63]
ds_read_b128 v[104:107], v20 offset:57344
ds_read_b128 v[108:111], v20 offset:61440
v_mfma_f32_32x32x16_bf16 v[64:79], v[208:211], v[120:123], v[64:79]
buffer_load_dwordx4 v247, s[52:55], s62 offen offset:3072 lds
v_mfma_f32_32x32x16_bf16 v[80:95], v[208:211], v[124:127], v[80:95]
buffer_load_dwordx4 v[208:211], v2, s[40:43], s63 offen offset:3072 sc1
s_waitcnt vmcnt(42) lgkmcnt(3)
v_mfma_f32_32x32x16_bf16 v[32:47], v[212:215], v[96:99], v[32:47]
ds_read_b128 v[112:115], v21 offset:49152
ds_read_b128 v[116:119], v21 offset:53248
s_waitcnt lgkmcnt(4)
v_mfma_f32_32x32x16_bf16 v[48:63], v[212:215], v[100:103], v[48:63]
ds_read_b128 v[120:123], v21 offset:57344
ds_read_b128 v[124:127], v21 offset:61440
s_waitcnt lgkmcnt(5)
v_mfma_f32_32x32x16_bf16 v[64:79], v[212:215], v[104:107], v[64:79]
s_add_u32 m0, s67, 0
s_add_u32 s62, s64, 896
s_and_b32 s62, s62, 0x3ff
buffer_load_dwordx4 v244, s[48:51], s62 offen offset:0 lds
s_waitcnt lgkmcnt(4)
v_mfma_f32_32x32x16_bf16 v[80:95], v[212:215], v[108:111], v[80:95]
s_waitcnt vmcnt(42) lgkmcnt(3)
v_mfma_f32_32x32x16_bf16 v[32:47], v[216:219], v[112:115], v[32:47]
ds_read_b128 v[96:99], v22 offset:49152
ds_read_b128 v[100:103], v22 offset:53248
s_waitcnt lgkmcnt(4)
v_mfma_f32_32x32x16_bf16 v[48:63], v[216:219], v[116:119], v[48:63]
ds_read_b128 v[104:107], v22 offset:57344
ds_read_b128 v[108:111], v22 offset:61440
s_waitcnt lgkmcnt(5)
v_mfma_f32_32x32x16_bf16 v[64:79], v[216:219], v[120:123], v[64:79]
buffer_load_dwordx4 v245, s[48:51], s62 offen offset:1024 lds
s_waitcnt lgkmcnt(4)
v_mfma_f32_32x32x16_bf16 v[80:95], v[216:219], v[124:127], v[80:95]
s_waitcnt vmcnt(41) lgkmcnt(3)
v_mfma_f32_32x32x16_bf16 v[32:47], v[220:223], v[96:99], v[32:47]
ds_read_b128 v[112:115], v23 offset:49152
ds_read_b128 v[116:119], v23 offset:53248
s_waitcnt lgkmcnt(4)
v_mfma_f32_32x32x16_bf16 v[48:63], v[220:223], v[100:103], v[48:63]
ds_read_b128 v[120:123], v23 offset:57344
ds_read_b128 v[124:127], v23 offset:61440
s_waitcnt lgkmcnt(5)
v_mfma_f32_32x32x16_bf16 v[64:79], v[220:223], v[104:107], v[64:79]
buffer_load_dwordx4 v246, s[48:51], s62 offen offset:2048 lds
s_waitcnt lgkmcnt(4)
v_mfma_f32_32x32x16_bf16 v[80:95], v[220:223], v[108:111], v[80:95]
s_waitcnt vmcnt(41) lgkmcnt(3)
v_mfma_f32_32x32x16_bf16 v[32:47], v[224:227], v[112:115], v[32:47]
ds_read_b128 v[96:99], v24 offset:0
ds_read_b128 v[100:103], v24 offset:4096
s_waitcnt lgkmcnt(4)
v_mfma_f32_32x32x16_bf16 v[48:63], v[224:227], v[116:119], v[48:63]
ds_read_b128 v[104:107], v24 offset:8192
ds_read_b128 v[108:111], v24 offset:12288
s_waitcnt lgkmcnt(5)
v_mfma_f32_32x32x16_bf16 v[64:79], v[224:227], v[120:123], v[64:79]
buffer_load_dwordx4 v247, s[48:51], s62 offen offset:3072 lds
s_waitcnt lgkmcnt(4)
v_mfma_f32_32x32x16_bf16 v[80:95], v[224:227], v[124:127], v[80:95]
s_waitcnt vmcnt(5) lgkmcnt(3)
v_mov_b32 v14, 10
s_mov_b64 exec, 1
ds_write_b32 v13, v14
s_mov_b64 exec, -1
v_mfma_f32_32x32x16_bf16 v[32:47], v[228:231], v[96:99], v[32:47]
ds_read_b128 v[112:115], v25 offset:0
ds_read_b128 v[116:119], v25 offset:4096
s_waitcnt lgkmcnt(5)
v_mfma_f32_32x32x16_bf16 v[48:63], v[228:231], v[100:103], v[48:63]
ds_read_b128 v[120:123], v25 offset:8192
ds_read_b128 v[124:127], v25 offset:12288
s_waitcnt lgkmcnt(6)
v_mfma_f32_32x32x16_bf16 v[64:79], v[228:231], v[104:107], v[64:79]
s_add_u32 m0, s67, 16384
s_nop 0
buffer_load_dwordx4 v244, s[52:55], s62 offen offset:0 lds
s_waitcnt lgkmcnt(5)
v_mfma_f32_32x32x16_bf16 v[80:95], v[228:231], v[108:111], v[80:95]
s_waitcnt vmcnt(40) lgkmcnt(3)
v_mfma_f32_32x32x16_bf16 v[32:47], v[232:235], v[112:115], v[32:47]
ds_read_b128 v[96:99], v26 offset:0
ds_read_b128 v[100:103], v26 offset:4096
s_waitcnt lgkmcnt(4)
v_mfma_f32_32x32x16_bf16 v[48:63], v[232:235], v[116:119], v[48:63]
ds_read_b128 v[104:107], v26 offset:8192
ds_read_b128 v[108:111], v26 offset:12288
s_waitcnt lgkmcnt(5)
v_mfma_f32_32x32x16_bf16 v[64:79], v[232:235], v[120:123], v[64:79]
buffer_load_dwordx4 v245, s[52:55], s62 offen offset:1024 lds
s_waitcnt lgkmcnt(4)
v_mfma_f32_32x32x16_bf16 v[80:95], v[232:235], v[124:127], v[80:95]
s_waitcnt vmcnt(39) lgkmcnt(3)
v_mfma_f32_32x32x16_bf16 v[32:47], v[236:239], v[96:99], v[32:47]
ds_read_b128 v[112:115], v27 offset:0
ds_read_b128 v[116:119], v27 offset:4096
s_waitcnt lgkmcnt(4)
v_mfma_f32_32x32x16_bf16 v[48:63], v[236:239], v[100:103], v[48:63]
ds_read_b128 v[120:123], v27 offset:8192
ds_read_b128 v[124:127], v27 offset:12288
s_waitcnt lgkmcnt(5)
v_mfma_f32_32x32x16_bf16 v[64:79], v[236:239], v[104:107], v[64:79]
buffer_load_dwordx4 v246, s[52:55], s62 offen offset:2048 lds
s_waitcnt lgkmcnt(4)
v_mfma_f32_32x32x16_bf16 v[80:95], v[236:239], v[108:111], v[80:95]
ds_read_b128 v[8:11], v12
global_load_dword v31, v30, s[26:27]
s_waitcnt vmcnt(40) lgkmcnt(0)
L_ck67:
v_min3_u32 v15, v8, v9, v10
v_min_u32 v15, v15, v11
s_nop 0
v_readfirstlane_b32 s60, v15
s_nop 0
s_cmp_ge_u32 s60, 10
s_cbranch_scc1 L_ckd68
ds_read_b128 v[8:11], v12 offset:0
s_waitcnt lgkmcnt(0)
s_branch L_ck67
L_ckd68:
v_mfma_f32_32x32x16_bf16 v[32:47], v[240:243], v[112:115], v[32:47]
ds_read_b128 v[96:99], v24 offset:16384
ds_read_b128 v[100:103], v24 offset:20480
v_mfma_f32_32x32x16_bf16 v[48:63], v[240:243], v[116:119], v[48:63]
ds_read_b128 v[104:107], v24 offset:24576
ds_read_b128 v[108:111], v24 offset:28672
v_mfma_f32_32x32x16_bf16 v[64:79], v[240:243], v[120:123], v[64:79]
buffer_load_dwordx4 v247, s[52:55], s62 offen offset:3072 lds
v_mfma_f32_32x32x16_bf16 v[80:95], v[240:243], v[124:127], v[80:95]
s_mov_b32 s60, 0
buffer_load_dword v128, v28, s[56:59], s60 offen offset:0
s_waitcnt vmcnt(40) lgkmcnt(3)
v_mfma_f32_32x32x16_bf16 v[32:47], v[148:151], v[96:99], v[32:47]
ds_read_b128 v[112:115], v25 offset:16384
ds_read_b128 v[116:119], v25 offset:20480
s_waitcnt lgkmcnt(4)
v_mfma_f32_32x32x16_bf16 v[48:63], v[148:151], v[100:103], v[48:63]
ds_read_b128 v[120:123], v25 offset:24576
ds_read_b128 v[124:127], v25 offset:28672
s_waitcnt lgkmcnt(5)
v_mfma_f32_32x32x16_bf16 v[64:79], v[148:151], v[104:107], v[64:79]
s_waitcnt lgkmcnt(4)
v_mfma_f32_32x32x16_bf16 v[80:95], v[148:151], v[108:111], v[80:95]
s_mov_b32 s60, 0
buffer_load_dword v129, v28, s[56:59], s60 offen offset:2048
s_waitcnt vmcnt(39) lgkmcnt(3)
v_mfma_f32_32x32x16_bf16 v[32:47], v[152:155], v[112:115], v[32:47]
ds_read_b128 v[96:99], v26 offset:16384
ds_read_b128 v[100:103], v26 offset:20480
s_waitcnt lgkmcnt(4)
v_mfma_f32_32x32x16_bf16 v[48:63], v[152:155], v[116:119], v[48:63]
ds_read_b128 v[104:107], v26 offset:24576
ds_read_b128 v[108:111], v26 offset:28672
s_waitcnt lgkmcnt(5)
v_mfma_f32_32x32x16_bf16 v[64:79], v[152:155], v[120:123], v[64:79]
s_waitcnt lgkmcnt(4)
v_mfma_f32_32x32x16_bf16 v[80:95], v[152:155], v[124:127], v[80:95]
s_mov_b32 s60, 4096
buffer_load_dword v130, v28, s[56:59], s60 offen offset:0
s_waitcnt vmcnt(38) lgkmcnt(3)
v_mfma_f32_32x32x16_bf16 v[32:47], v[156:159], v[96:99], v[32:47]
ds_read_b128 v[112:115], v27 offset:16384
ds_read_b128 v[116:119], v27 offset:20480
s_waitcnt lgkmcnt(4)
v_mfma_f32_32x32x16_bf16 v[48:63], v[156:159], v[100:103], v[48:63]
ds_read_b128 v[120:123], v27 offset:24576
ds_read_b128 v[124:127], v27 offset:28672
s_waitcnt lgkmcnt(5)
v_mfma_f32_32x32x16_bf16 v[64:79], v[156:159], v[104:107], v[64:79]
s_waitcnt lgkmcnt(4)
v_mfma_f32_32x32x16_bf16 v[80:95], v[156:159], v[108:111], v[80:95]
s_mov_b32 s60, 4096
buffer_load_dword v131, v28, s[56:59], s60 offen offset:2048
s_waitcnt vmcnt(37) lgkmcnt(3)
v_mfma_f32_32x32x16_bf16 v[32:47], v[160:163], v[112:115], v[32:47]
ds_read_b128 v[96:99], v24 offset:32768
ds_read_b128 v[100:103], v24 offset:36864
s_waitcnt lgkmcnt(4)
v_mfma_f32_32x32x16_bf16 v[48:63], v[160:163], v[116:119], v[48:63]
s_waitcnt lgkmcnt(3)
v_mfma_f32_32x32x16_bf16 v[64:79], v[160:163], v[120:123], v[64:79]
s_waitcnt lgkmcnt(2)
v_mfma_f32_32x32x16_bf16 v[80:95], v[160:163], v[124:127], v[80:95]
s_mov_b32 s60, 32768
buffer_load_dword v132, v28, s[56:59], s60 offen offset:0
s_waitcnt vmcnt(5) lgkmcnt(1)
v_mov_b32 v14, 11
s_mov_b64 exec, 1
ds_write_b32 v13, v14
s_mov_b64 exec, -1
v_mfma_f32_32x32x16_bf16 v[32:47], v[164:167], v[96:99], v[32:47]
ds_read_b128 v[112:115], v25 offset:32768
ds_read_b128 v[116:119], v25 offset:36864
s_waitcnt lgkmcnt(3)
v_mfma_f32_32x32x16_bf16 v[48:63], v[164:167], v[100:103], v[48:63]
s_mov_b32 s60, 32768
buffer_load_dword v133, v28, s[56:59], s60 offen offset:2048
s_waitcnt vmcnt(35) lgkmcnt(1)
v_mfma_f32_32x32x16_bf16 v[32:47], v[168:171], v[112:115], v[32:47]
ds_read_b128 v[96:99], v26 offset:32768
ds_read_b128 v[100:103], v26 offset:36864
s_waitcnt lgkmcnt(2)
v_mfma_f32_32x32x16_bf16 v[48:63], v[168:171], v[116:119], v[48:63]
s_mov_b32 s60, 36864
buffer_load_dword v134, v28, s[56:59], s60 offen offset:0
s_waitcnt vmcnt(34) lgkmcnt(1)
v_mfma_f32_32x32x16_bf16 v[32:47], v[172:175], v[96:99], v[32:47]
ds_read_b128 v[112:115], v27 offset:32768
ds_read_b128 v[116:119], v27 offset:36864
s_waitcnt lgkmcnt(2)
v_mfma_f32_32x32x16_bf16 v[48:63], v[172:175], v[100:103], v[48:63]
ds_read_b128 v[8:11], v12
s_mov_b32 s60, 36864
buffer_load_dword v135, v28, s[56:59], s60 offen offset:2048
s_waitcnt vmcnt(33) lgkmcnt(0)
L_ck69:
v_min3_u32 v15, v8, v9, v10
v_min_u32 v15, v15, v11
s_nop 0
v_readfirstlane_b32 s60, v15
s_nop 0
s_cmp_ge_u32 s60, 11
s_cbranch_scc1 L_ckd70
ds_read_b128 v[8:11], v12 offset:0
s_waitcnt lgkmcnt(0)
s_branch L_ck69
L_ckd70:
v_mfma_f32_32x32x16_bf16 v[32:47], v[176:179], v[112:115], v[32:47]
ds_read_b128 v[96:99], v20 offset:0
ds_read_b128 v[100:103], v20 offset:4096
v_mfma_f32_32x32x16_bf16 v[48:63], v[176:179], v[116:119], v[48:63]
s_mov_b32 s60, 65536
buffer_load_dword v136, v28, s[56:59], s60 offen offset:0
s_waitcnt vmcnt(32) lgkmcnt(1)
v_mfma_f32_32x32x16_bf16 v[32:47], v[180:183], v[96:99], v[32:47]
ds_read_b128 v[112:115], v21 offset:0
ds_read_b128 v[116:119], v21 offset:4096
s_waitcnt lgkmcnt(2)
v_mfma_f32_32x32x16_bf16 v[48:63], v[180:183], v[100:103], v[48:63]
s_mov_b32 s60, 65536
buffer_load_dword v137, v28, s[56:59], s60 offen offset:2048
s_waitcnt vmcnt(31) lgkmcnt(1)
v_mfma_f32_32x32x16_bf16 v[32:47], v[184:187], v[112:115], v[32:47]
ds_read_b128 v[96:99], v22 offset:0
ds_read_b128 v[100:103], v22 offset:4096
s_waitcnt lgkmcnt(2)
v_mfma_f32_32x32x16_bf16 v[48:63], v[184:187], v[116:119], v[48:63]
s_mov_b32 s60, 69632
buffer_load_dword v138, v28, s[56:59], s60 offen offset:0
s_waitcnt vmcnt(30) lgkmcnt(1)
v_mfma_f32_32x32x16_bf16 v[32:47], v[188:191], v[96:99], v[32:47]
ds_read_b128 v[112:115], v23 offset:0
ds_read_b128 v[116:119], v23 offset:4096
s_waitcnt lgkmcnt(2)
v_mfma_f32_32x32x16_bf16 v[48:63], v[188:191], v[100:103], v[48:63]
s_mov_b32 s60, 69632
buffer_load_dword v139, v28, s[56:59], s60 offen offset:2048
s_waitcnt vmcnt(29) lgkmcnt(1)
v_mfma_f32_32x32x16_bf16 v[32:47], v[192:195], v[112:115], v[32:47]
ds_read_b128 v[96:99], v20 offset:16384
ds_read_b128 v[100:103], v20 offset:20480
s_waitcnt lgkmcnt(2)
v_mfma_f32_32x32x16_bf16 v[48:63], v[192:195], v[116:119], v[48:63]
s_mov_b32 s60, 98304
buffer_load_dword v140, v28, s[56:59], s60 offen offset:0
s_waitcnt vmcnt(28) lgkmcnt(1)
v_mfma_f32_32x32x16_bf16 v[32:47], v[196:199], v[96:99], v[32:47]
ds_read_b128 v[112:115], v21 offset:16384
ds_read_b128 v[116:119], v21 offset:20480
s_waitcnt lgkmcnt(2)
v_mfma_f32_32x32x16_bf16 v[48:63], v[196:199], v[100:103], v[48:63]
s_mov_b32 s60, 98304
buffer_load_dword v141, v28, s[56:59], s60 offen offset:2048
s_waitcnt vmcnt(27) lgkmcnt(1)
v_mfma_f32_32x32x16_bf16 v[32:47], v[200:203], v[112:115], v[32:47]
ds_read_b128 v[96:99], v22 offset:16384
ds_read_b128 v[100:103], v22 offset:20480
s_waitcnt lgkmcnt(2)
v_mfma_f32_32x32x16_bf16 v[48:63], v[200:203], v[116:119], v[48:63]
s_mov_b32 s60, 102400
buffer_load_dword v142, v28, s[56:59], s60 offen offset:0
s_waitcnt vmcnt(26) lgkmcnt(1)
v_mfma_f32_32x32x16_bf16 v[32:47], v[204:207], v[96:99], v[32:47]
ds_read_b128 v[112:115], v23 offset:16384
ds_read_b128 v[116:119], v23 offset:20480
s_waitcnt lgkmcnt(2)
v_mfma_f32_32x32x16_bf16 v[48:63], v[204:207], v[100:103], v[48:63]
s_mov_b32 s60, 102400
buffer_load_dword v143, v28, s[56:59], s60 offen offset:2048
s_waitcnt vmcnt(25) lgkmcnt(0)
v_mfma_f32_32x32x16_bf16 v[32:47], v[208:211], v[112:115], v[32:47]
v_mfma_f32_32x32x16_bf16 v[48:63], v[208:211], v[116:119], v[48:63]
s_mul_i32 s60, s37, 0x9e3779b1
s_and_b32 s60, s60, 0xbfff0000
s_or_b32 s60, s60, 0x20000000
s_sub_u32 s61, s37, 1
s_xor_b32 s61, s61, s60
s_cmp_lt_u32 s61, 0x10000
s_cselect_b32 s61, 0x10000, 0
s_xor_b32 s60, s60, s61
s_lshl_b32 s64, s35, 4
s_add_u32 s64, s64, s36
s_lshl_b32 s64, s64, 2
s_add_u32 s64, s64, s34
s_lshl_b32 s64, s64, 13
s_add_u32 s50, s64, 33554432
s_add_u32 s48, s32, s50
s_addc_u32 s49, s33, 0
s_mov_b32 s50, 8192
s_mov_b32 s51, 0x20000
s_xor_b32 s64, s64, 262144
s_add_u32 s54, s64, 33554432
s_add_u32 s52, s32, s54
s_addc_u32 s53, s33, 0
s_mov_b32 s54, 8192
s_mov_b32 s55, 0x20000
s_movk_i32 s64, 0x1000
v_cvt_pk_bf16_f32 v96, v32, v48
v_cvt_pk_bf16_f32 v97, v33, v49
v_cvt_pk_bf16_f32 v98, v34, v50
v_cvt_pk_bf16_f32 v99, v35, s60
buffer_store_dwordx4 v[96:99], v2, s[48:51], 0 offen offset:0 sc1
v_cvt_pk_bf16_f32 v100, v51, v36
v_cvt_pk_bf16_f32 v101, v52, v37
v_cvt_pk_bf16_f32 v102, v53, v38
v_cvt_pk_bf16_f32 v103, v54, s60
buffer_store_dwordx4 v[100:103], v2, s[48:51], 0 offen offset:1024 sc1
v_cvt_pk_bf16_f32 v244, v39, v55
v_cvt_pk_bf16_f32 v245, v40, v56
v_cvt_pk_bf16_f32 v246, v41, v57
v_cvt_pk_bf16_f32 v247, v42, s60
buffer_store_dwordx4 v[244:247], v2, s[48:51], 0 offen offset:2048 sc1
v_cvt_pk_bf16_f32 v248, v58, v43
v_cvt_pk_bf16_f32 v249, v59, v44
v_cvt_pk_bf16_f32 v250, v60, v45
v_cvt_pk_bf16_f32 v251, v61, s60
buffer_store_dwordx4 v[248:251], v2, s[48:51], 0 offen offset:3072 sc1
v_cvt_pk_bf16_f32 v252, v46, v62
v_cvt_pk_bf16_f32 v253, v47, v63
v_cvt_pk_bf16_f32 v254, v63, v63
v_cvt_pk_bf16_f32 v255, v63, s60
buffer_store_dwordx4 v[252:255], v2, s[48:51], s64 offen offset:0 sc1
ds_read_b128 v[104:107], v24 offset:40960
ds_read_b128 v[108:111], v24 offset:45056
ds_read_b128 v[120:123], v25 offset:40960
ds_read_b128 v[124:127], v25 offset:45056
s_waitcnt lgkmcnt(2)
v_mfma_f32_32x32x16_bf16 v[64:79], v[164:167], v[104:107], v[64:79]
v_mfma_f32_32x32x16_bf16 v[80:95], v[164:167], v[108:111], v[80:95]
ds_read_b128 v[104:107], v26 offset:40960
ds_read_b128 v[108:111], v26 offset:45056
s_waitcnt lgkmcnt(2)
v_mfma_f32_32x32x16_bf16 v[64:79], v[168:171], v[120:123], v[64:79]
v_mfma_f32_32x32x16_bf16 v[80:95], v[168:171], v[124:127], v[80:95]
ds_read_b128 v[120:123], v27 offset:40960
ds_read_b128 v[124:127], v27 offset:45056
s_waitcnt lgkmcnt(2)
v_mfma_f32_32x32x16_bf16 v[64:79], v[172:175], v[104:107], v[64:79]
v_mfma_f32_32x32x16_bf16 v[80:95], v[172:175], v[108:111], v[80:95]
ds_read_b128 v[104:107], v20 offset:8192
ds_read_b128 v[108:111], v20 offset:12288
s_waitcnt lgkmcnt(2)
v_mfma_f32_32x32x16_bf16 v[64:79], v[176:179], v[120:123], v[64:79]
v_mfma_f32_32x32x16_bf16 v[80:95], v[176:179], v[124:127], v[80:95]
ds_read_b128 v[120:123], v21 offset:8192
ds_read_b128 v[124:127], v21 offset:12288
s_waitcnt lgkmcnt(2)
v_mfma_f32_32x32x16_bf16 v[64:79], v[180:183], v[104:107], v[64:79]
v_mfma_f32_32x32x16_bf16 v[80:95], v[180:183], v[108:111], v[80:95]
ds_read_b128 v[104:107], v22 offset:8192
ds_read_b128 v[108:111], v22 offset:12288
s_waitcnt lgkmcnt(2)
v_mfma_f32_32x32x16_bf16 v[64:79], v[184:187], v[120:123], v[64:79]
v_mfma_f32_32x32x16_bf16 v[80:95], v[184:187], v[124:127], v[80:95]
ds_read_b128 v[120:123], v23 offset:8192
ds_read_b128 v[124:127], v23 offset:12288
s_waitcnt lgkmcnt(2)
v_mfma_f32_32x32x16_bf16 v[64:79], v[188:191], v[104:107], v[64:79]
v_mfma_f32_32x32x16_bf16 v[80:95], v[188:191], v[108:111], v[80:95]
ds_read_b128 v[104:107], v20 offset:24576
ds_read_b128 v[108:111], v20 offset:28672
s_waitcnt lgkmcnt(2)
v_mfma_f32_32x32x16_bf16 v[64:79], v[192:195], v[120:123], v[64:79]
v_mfma_f32_32x32x16_bf16 v[80:95], v[192:195], v[124:127], v[80:95]
ds_read_b128 v[120:123], v21 offset:24576
ds_read_b128 v[124:127], v21 offset:28672
s_waitcnt lgkmcnt(2)
v_mfma_f32_32x32x16_bf16 v[64:79], v[196:199], v[104:107], v[64:79]
v_mfma_f32_32x32x16_bf16 v[80:95], v[196:199], v[108:111], v[80:95]
ds_read_b128 v[104:107], v22 offset:24576
ds_read_b128 v[108:111], v22 offset:28672
s_waitcnt lgkmcnt(2)
v_mfma_f32_32x32x16_bf16 v[64:79], v[200:203], v[120:123], v[64:79]
v_mfma_f32_32x32x16_bf16 v[80:95], v[200:203], v[124:127], v[80:95]
ds_read_b128 v[120:123], v23 offset:24576
ds_read_b128 v[124:127], v23 offset:28672
s_waitcnt lgkmcnt(2)
v_mfma_f32_32x32x16_bf16 v[64:79], v[204:207], v[104:107], v[64:79]
v_mfma_f32_32x32x16_bf16 v[80:95], v[204:207], v[108:111], v[80:95]
s_waitcnt lgkmcnt(0)
v_mfma_f32_32x32x16_bf16 v[64:79], v[208:211], v[120:123], v[64:79]
v_mfma_f32_32x32x16_bf16 v[80:95], v[208:211], v[124:127], v[80:95]
s_waitcnt vmcnt(5)
v_lshlrev_b32 v8, 16, v31
v_and_b32 v9, 0xffff0000, v31
v_lshlrev_b32 v148, 16, v128
v_and_b32 v149, 0xffff0000, v128
v_pk_mul_f32 v[148:149], v[148:149], v[8:9]
v_cvt_pk_bf16_f32 v10, v148, v149
v_lshlrev_b32 v148, 16, v10
v_and_b32 v149, 0xffff0000, v10
s_nop 1
v_add_f32 v148, v148, v64
v_add_f32 v149, v149, v80
v_lshlrev_b32 v150, 16, v129
v_and_b32 v151, 0xffff0000, v129
v_pk_mul_f32 v[150:151], v[150:151], v[8:9]
v_cvt_pk_bf16_f32 v10, v150, v151
v_lshlrev_b32 v150, 16, v10
v_and_b32 v151, 0xffff0000, v10
v_add_f32 v150, v150, v65
v_add_f32 v151, v151, v81
v_lshlrev_b32 v152, 16, v130
v_and_b32 v153, 0xffff0000, v130
v_pk_mul_f32 v[152:153], v[152:153], v[8:9]
v_cvt_pk_bf16_f32 v10, v152, v153
v_lshlrev_b32 v152, 16, v10
v_and_b32 v153, 0xffff0000, v10
v_add_f32 v152, v152, v66
v_add_f32 v153, v153, v82
v_lshlrev_b32 v154, 16, v131
v_and_b32 v155, 0xffff0000, v131
v_pk_mul_f32 v[154:155], v[154:155], v[8:9]
v_cvt_pk_bf16_f32 v10, v154, v155
v_lshlrev_b32 v154, 16, v10
v_and_b32 v155, 0xffff0000, v10
v_add_f32 v154, v154, v67
v_add_f32 v155, v155, v83
v_lshlrev_b32 v156, 16, v132
v_and_b32 v157, 0xffff0000, v132
v_pk_mul_f32 v[156:157], v[156:157], v[8:9]
v_cvt_pk_bf16_f32 v10, v156, v157
v_lshlrev_b32 v156, 16, v10
v_and_b32 v157, 0xffff0000, v10
v_add_f32 v156, v156, v68
v_add_f32 v157, v157, v84
v_lshlrev_b32 v158, 16, v133
v_and_b32 v159, 0xffff0000, v133
v_pk_mul_f32 v[158:159], v[158:159], v[8:9]
v_cvt_pk_bf16_f32 v10, v158, v159
v_lshlrev_b32 v158, 16, v10
v_and_b32 v159, 0xffff0000, v10
v_add_f32 v158, v158, v69
v_add_f32 v159, v159, v85
v_lshlrev_b32 v160, 16, v134
v_and_b32 v161, 0xffff0000, v134
v_pk_mul_f32 v[160:161], v[160:161], v[8:9]
v_cvt_pk_bf16_f32 v10, v160, v161
v_lshlrev_b32 v160, 16, v10
v_and_b32 v161, 0xffff0000, v10
v_add_f32 v160, v160, v70
v_add_f32 v161, v161, v86
v_lshlrev_b32 v162, 16, v135
v_and_b32 v163, 0xffff0000, v135
v_pk_mul_f32 v[162:163], v[162:163], v[8:9]
v_cvt_pk_bf16_f32 v10, v162, v163
v_lshlrev_b32 v162, 16, v10
v_and_b32 v163, 0xffff0000, v10
v_add_f32 v162, v162, v71
v_add_f32 v163, v163, v87
v_lshlrev_b32 v164, 16, v136
v_and_b32 v165, 0xffff0000, v136
v_pk_mul_f32 v[164:165], v[164:165], v[8:9]
v_cvt_pk_bf16_f32 v10, v164, v165
v_lshlrev_b32 v164, 16, v10
v_and_b32 v165, 0xffff0000, v10
v_add_f32 v164, v164, v72
v_add_f32 v165, v165, v88
v_lshlrev_b32 v166, 16, v137
v_and_b32 v167, 0xffff0000, v137
v_pk_mul_f32 v[166:167], v[166:167], v[8:9]
v_cvt_pk_bf16_f32 v10, v166, v167
v_lshlrev_b32 v166, 16, v10
v_and_b32 v167, 0xffff0000, v10
v_add_f32 v166, v166, v73
v_add_f32 v167, v167, v89
v_lshlrev_b32 v168, 16, v138
v_and_b32 v169, 0xffff0000, v138
v_pk_mul_f32 v[168:169], v[168:169], v[8:9]
v_cvt_pk_bf16_f32 v10, v168, v169
v_lshlrev_b32 v168, 16, v10
v_and_b32 v169, 0xffff0000, v10
v_add_f32 v168, v168, v74
v_add_f32 v169, v169, v90
v_lshlrev_b32 v170, 16, v139
v_and_b32 v171, 0xffff0000, v139
v_pk_mul_f32 v[170:171], v[170:171], v[8:9]
v_cvt_pk_bf16_f32 v10, v170, v171
v_lshlrev_b32 v170, 16, v10
v_and_b32 v171, 0xffff0000, v10
v_add_f32 v170, v170, v75
v_add_f32 v171, v171, v91
v_lshlrev_b32 v172, 16, v140
v_and_b32 v173, 0xffff0000, v140
v_pk_mul_f32 v[172:173], v[172:173], v[8:9]
v_cvt_pk_bf16_f32 v10, v172, v173
v_lshlrev_b32 v172, 16, v10
v_and_b32 v173, 0xffff0000, v10
v_add_f32 v172, v172, v76
v_add_f32 v173, v173, v92
v_lshlrev_b32 v174, 16, v141
v_and_b32 v175, 0xffff0000, v141
v_pk_mul_f32 v[174:175], v[174:175], v[8:9]
v_cvt_pk_bf16_f32 v10, v174, v175
v_lshlrev_b32 v174, 16, v10
v_and_b32 v175, 0xffff0000, v10
v_add_f32 v174, v174, v77
v_add_f32 v175, v175, v93
v_lshlrev_b32 v176, 16, v142
v_and_b32 v177, 0xffff0000, v142
v_pk_mul_f32 v[176:177], v[176:177], v[8:9]
v_cvt_pk_bf16_f32 v10, v176, v177
v_lshlrev_b32 v176, 16, v10
v_and_b32 v177, 0xffff0000, v10
v_add_f32 v176, v176, v78
v_add_f32 v177, v177, v94
v_lshlrev_b32 v178, 16, v143
v_and_b32 v179, 0xffff0000, v143
v_pk_mul_f32 v[178:179], v[178:179], v[8:9]
v_cvt_pk_bf16_f32 v10, v178, v179
v_lshlrev_b32 v178, 16, v10
v_and_b32 v179, 0xffff0000, v10
v_add_f32 v178, v178, v79
v_add_f32 v179, v179, v95
s_mov_b32 s44, s28
s_mov_b32 s45, s29
s_mov_b32 s46, s24
s_mov_b32 s47, 0x20000
s_mov_b32 s92, 0
L_xw73:
s_load_dword s61, s[52:53], 5116 glc
s_add_u32 s92, s92, 1
s_waitcnt lgkmcnt(0)
s_xor_b32 s61, s61, s60
s_cmp_lt_u32 s61, 0x10000
s_cbranch_scc1 L_xwd74
s_cmp_lt_u32 s92, 200000
s_cbranch_scc1 L_xw73
L_xwd74:
s_mov_b32 s92, 0
buffer_load_dwordx4 v[180:183], v2, s[52:55], 0 offen offset:0 sc1
buffer_load_dwordx4 v[184:187], v2, s[52:55], 0 offen offset:1024 sc1
buffer_load_dwordx4 v[188:191], v2, s[52:55], 0 offen offset:2048 sc1
buffer_load_dwordx4 v[192:195], v2, s[52:55], 0 offen offset:3072 sc1
buffer_load_dwordx4 v[196:199], v2, s[52:55], s64 offen offset:0 sc1
L_xl71:
v_mov_b32 v10, 0
s_waitcnt vmcnt(4)
v_bitop3_b32 v10, v10, v183, s60 bitop3:0xf6
s_waitcnt vmcnt(3)
v_bitop3_b32 v10, v10, v187, s60 bitop3:0xf6
s_waitcnt vmcnt(2)
v_bitop3_b32 v10, v10, v191, s60 bitop3:0xf6
s_waitcnt vmcnt(1)
v_bitop3_b32 v10, v10, v195, s60 bitop3:0xf6
s_waitcnt vmcnt(0)
v_bitop3_b32 v10, v10, v199, s60 bitop3:0xf6
v_cmp_lt_u32 vcc, 0xffff, v10
s_nop 0
s_cbranch_vccz L_xd72
s_add_u32 s92, s92, 1
s_cmp_ge_u32 s92, 200000
s_cbranch_scc1 L_xd72
buffer_load_dwordx4 v[180:183], v2, s[52:55], 0 offen offset:0 sc1
buffer_load_dwordx4 v[184:187], v2, s[52:55], 0 offen offset:1024 sc1
buffer_load_dwordx4 v[188:191], v2, s[52:55], 0 offen offset:2048 sc1
buffer_load_dwordx4 v[192:195], v2, s[52:55], 0 offen offset:3072 sc1
buffer_load_dwordx4 v[196:199], v2, s[52:55], s64 offen offset:0 sc1
s_branch L_xl71
L_xd72:
v_lshlrev_b32 v10, 16, v180
v_and_b32 v11, 0xffff0000, v180
v_pk_add_f32 v[148:149], v[148:149], v[10:11]
s_mov_b32 s64, 0
buffer_store_dwordx2 v[148:149], v29, s[44:47], s64 offen nt
v_lshlrev_b32 v10, 16, v181
v_and_b32 v11, 0xffff0000, v181
v_pk_add_f32 v[150:151], v[150:151], v[10:11]
s_mov_b32 s64, 8192
buffer_store_dwordx2 v[150:151], v29, s[44:47], s64 offen nt
v_lshlrev_b32 v10, 16, v182
v_and_b32 v11, 0xffff0000, v182
v_pk_add_f32 v[152:153], v[152:153], v[10:11]
s_mov_b32 s64, 16384
buffer_store_dwordx2 v[152:153], v29, s[44:47], s64 offen nt
v_lshlrev_b32 v10, 16, v183
v_lshlrev_b32 v11, 16, v184
v_pk_add_f32 v[154:155], v[154:155], v[10:11]
s_mov_b32 s64, 24576
buffer_store_dwordx2 v[154:155], v29, s[44:47], s64 offen nt
v_and_b32 v10, 0xffff0000, v184
v_lshlrev_b32 v11, 16, v185
v_pk_add_f32 v[156:157], v[156:157], v[10:11]
s_mov_b32 s64, 131072
buffer_store_dwordx2 v[156:157], v29, s[44:47], s64 offen nt
v_and_b32 v10, 0xffff0000, v185
v_lshlrev_b32 v11, 16, v186
v_pk_add_f32 v[158:159], v[158:159], v[10:11]
s_mov_b32 s64, 139264
buffer_store_dwordx2 v[158:159], v29, s[44:47], s64 offen nt
v_and_b32 v10, 0xffff0000, v186
v_lshlrev_b32 v11, 16, v187
v_pk_add_f32 v[160:161], v[160:161], v[10:11]
s_mov_b32 s64, 147456
buffer_store_dwordx2 v[160:161], v29, s[44:47], s64 offen nt
v_lshlrev_b32 v10, 16, v188
v_and_b32 v11, 0xffff0000, v188
v_pk_add_f32 v[162:163], v[162:163], v[10:11]
s_mov_b32 s64, 155648
buffer_store_dwordx2 v[162:163], v29, s[44:47], s64 offen nt
v_lshlrev_b32 v10, 16, v189
v_and_b32 v11, 0xffff0000, v189
v_pk_add_f32 v[164:165], v[164:165], v[10:11]
s_mov_b32 s64, 262144
buffer_store_dwordx2 v[164:165], v29, s[44:47], s64 offen nt
v_lshlrev_b32 v10, 16, v190
v_and_b32 v11, 0xffff0000, v190
v_pk_add_f32 v[166:167], v[166:167], v[10:11]
s_mov_b32 s64, 270336
buffer_store_dwordx2 v[166:167], v29, s[44:47], s64 offen nt
v_lshlrev_b32 v10, 16, v191
v_lshlrev_b32 v11, 16, v192
v_pk_add_f32 v[168:169], v[168:169], v[10:11]
s_mov_b32 s64, 278528
buffer_store_dwordx2 v[168:169], v29, s[44:47], s64 offen nt
v_and_b32 v10, 0xffff0000, v192
v_lshlrev_b32 v11, 16, v193
v_pk_add_f32 v[170:171], v[170:171], v[10:11]
s_mov_b32 s64, 286720
buffer_store_dwordx2 v[170:171], v29, s[44:47], s64 offen nt
v_and_b32 v10, 0xffff0000, v193
v_lshlrev_b32 v11, 16, v194
v_pk_add_f32 v[172:173], v[172:173], v[10:11]
s_mov_b32 s64, 393216
buffer_store_dwordx2 v[172:173], v29, s[44:47], s64 offen nt
v_and_b32 v10, 0xffff0000, v194
v_lshlrev_b32 v11, 16, v195
v_pk_add_f32 v[174:175], v[174:175], v[10:11]
s_mov_b32 s64, 401408
buffer_store_dwordx2 v[174:175], v29, s[44:47], s64 offen nt
v_lshlrev_b32 v10, 16, v196
v_and_b32 v11, 0xffff0000, v196
v_pk_add_f32 v[176:177], v[176:177], v[10:11]
s_mov_b32 s64, 409600
buffer_store_dwordx2 v[176:177], v29, s[44:47], s64 offen nt
v_lshlrev_b32 v10, 16, v197
v_and_b32 v11, 0xffff0000, v197
v_pk_add_f32 v[178:179], v[178:179], v[10:11]
s_mov_b32 s64, 417792
buffer_store_dwordx2 v[178:179], v29, s[44:47], s64 offen nt
L_concat_heads__spectral_gfnet__ssm_conv_s5__prompt_kernel_end:
s_endpgm

.section .rodata,"a"
.p2align 6
.amdhsa_kernel concat_heads__spectral_gfnet__ssm_conv_s5__prompt_kernel
  .amdhsa_next_free_vgpr 256
  .amdhsa_next_free_sgpr 102
  .amdhsa_accum_offset 256
  .amdhsa_group_segment_fixed_size 0
  .amdhsa_kernarg_size 120
  .amdhsa_user_sgpr_count 2
  .amdhsa_user_sgpr_kernarg_segment_ptr 1
  .amdhsa_system_sgpr_workgroup_id_x 1
.end_amdhsa_kernel
.text
```

```asm
; @launch grid=(256,1,1) block=(512,1,1) lds=163840
.amdgcn_target "amdgcn-amd-amdhsa--gfx950"
.text
.globl concat_heads__spectral_gfnet__ssm_conv_s5__prompt_kernel
.p2align 8
.type concat_heads__spectral_gfnet__ssm_conv_s5__prompt_kernel,@function
concat_heads__spectral_gfnet__ssm_conv_s5__prompt_kernel:
s_cmp_ge_u32 s2, 256
s_cbranch_scc1 L_concat_heads__spectral_gfnet__ssm_conv_s5__prompt_kernel_end
s_load_dwordx16 s[4:19], s[0:1], 0
s_load_dwordx8 s[20:27], s[0:1], 64
s_load_dwordx4 s[28:31], s[0:1], 96
s_load_dwordx2 s[32:33], s[0:1], 112
v_lshrrev_b32 v2, 6, v0
v_and_b32 v1, 63, v0
v_readfirstlane_b32 s34, v2
s_and_b32 s60, s2, 7
s_lshr_b32 s61, s2, 3
s_lshr_b32 s35, s60, 1
s_lshl_b32 s35, s35, 2
s_lshr_b32 s62, s61, 3
s_add_u32 s35, s35, s62
s_and_b32 s36, s60, 1
s_lshl_b32 s36, s36, 3
s_and_b32 s62, s61, 7
s_add_u32 s36, s36, s62
s_cmp_ge_u32 s34, 4
s_cbranch_scc0 L_concat_heads__spectral_gfnet__ssm_conv_s5__prompt_kernel_gemm
s_sub_u32 s66, s34, 4
v_lshrrev_b32 v2, 5, v1
v_bfe_u32 v3, v1, 3, 2
v_and_b32 v4, 1, v3
v_lshrrev_b32 v5, 1, v3
v_lshlrev_b32 v6, 4, v2
v_lshl_add_u32 v6, v4, 3, v6
v_add_u32 v6, v6, v5
s_lshr_b32 s60, s66, 1
s_lshl_b32 s61, s60, 6
s_and_b32 s62, s66, 1
s_lshl_b32 s62, s62, 2
s_add_u32 s61, s61, s62
v_add_u32 v6, s61, v6
v_lshlrev_b32 v6, 11, v6
s_lshl_b32 s61, s60, 5
v_lshl_add_u32 v7, v2, 3, v3
v_add_u32 v7, s61, v7
v_lshlrev_b32 v7, 11, v7
v_and_b32 v4, 7, v1
v_lshrrev_b32 v5, 4, v1
v_xor_b32 v4, v4, v5
v_lshlrev_b32 v4, 4, v4
v_xor_b32 v5, 64, v4
v_add_u32 v176, v6, v4
v_add_u32 v180, v7, v4
v_add_u32 v177, v6, v5
v_add_u32 v177, 64512, v177
v_add_u32 v181, v7, v5
v_add_u32 v181, 31744, v181
v_add_u32 v178, v6, v4
v_add_u32 v178, 2048, v178
v_add_u32 v182, v7, v4
v_add_u32 v182, 6144, v182
v_add_u32 v179, v6, v5
v_add_u32 v179, 66560, v179
v_add_u32 v183, v7, v5
v_add_u32 v183, 37888, v183
s_and_b32 s64, s2, 7
s_mul_i32 s64, s64, 0
s_add_u32 s60, s35, s36
s_and_b32 s60, s60, 0
s_mul_i32 s60, s60, 2048
s_add_u32 s64, s64, s60
s_mul_i32 s60, s35, 128
s_add_u32 s64, s64, s60
s_mul_i32 s60, s36, 128
s_add_u32 s64, s64, s60
s_lshl_b32 s60, s35, 18
s_lshl_b32 s61, s36, 17
s_waitcnt lgkmcnt(0)
s_lshl_b32 s25, s66, 12
s_mov_b32 s24, s64
s_add_u32 s12, s10, s60
s_addc_u32 s13, s11, 0
s_mov_b32 s14, 262144
s_mov_b32 s15, 0x20000
s_bitcmp1_b32 s66, 0
s_cselect_b32 s62, s18, s16
s_cselect_b32 s63, s19, s17
s_cselect_b32 s100, s22, s20
s_cselect_b32 s101, s23, s21
s_add_u32 s20, s62, s61
s_addc_u32 s21, s63, 0
s_mov_b32 s22, 131072
s_mov_b32 s23, 0x20000
s_add_u32 m0, s25, 0
s_add_u32 s26, s24, 0
s_and_b32 s26, s26, 0x7ff
buffer_load_dwordx4 v176, s[12:15], s26 offen offset:0 lds
buffer_load_dwordx4 v177, s[12:15], s26 offen offset:1024 lds
buffer_load_dwordx4 v178, s[12:15], s26 offen offset:2048 lds
buffer_load_dwordx4 v179, s[12:15], s26 offen offset:3072 lds
s_add_u32 m0, s25, 16384
s_nop 0
buffer_load_dwordx4 v180, s[20:23], s26 offen offset:0 lds
buffer_load_dwordx4 v181, s[20:23], s26 offen offset:1024 lds
buffer_load_dwordx4 v182, s[20:23], s26 offen offset:2048 lds
buffer_load_dwordx4 v183, s[20:23], s26 offen offset:3072 lds
s_setprio 3
s_mov_b32 s48, s6
s_mov_b32 s49, s7
s_mov_b32 s50, 2101248
s_mov_b32 s51, 0x20000
s_mov_b32 s52, s8
s_mov_b32 s53, s9
s_mov_b32 s54, 2101248
s_mov_b32 s55, 0x20000
s_and_b32 s60, s2, 31
s_lshr_b32 s61, s2, 5
s_lshl_b32 s61, s61, 7
s_add_u32 s60, s60, s61
s_lshl_b32 s61, s66, 5
s_add_u32 s67, s60, s61
s_lshl_b32 s60, s67, 12
s_add_u32 s4, s4, s60
s_addc_u32 s5, s5, 0
s_mov_b32 s6, 4096
s_mov_b32 s7, 0x20000
v_lshlrev_b32 v2, 4, v1
v_xor_b32 v3, 128, v2
s_lshl_b32 s68, s66, 12
s_add_u32 s68, s68, 131072
s_and_b32 s60, s2, 7
s_bfe_u32 s61, s2, 0x10003
s_bfe_u32 s62, s2, 0x20004
s_lshr_b32 s63, s2, 6
s_lshr_b32 s64, s60, 1
s_lshl_b32 s64, s64, 3
s_lshl_b32 s65, s61, 2
s_add_u32 s64, s64, s65
s_and_b32 s65, s60, 1
s_lshl_b32 s65, s65, 1
s_add_u32 s64, s64, s65
s_lshl_b32 s64, s64, 5
s_lshl_b32 s65, s62, 3
s_add_u32 s64, s64, s65
s_lshl_b32 s65, s66, 1
s_add_u32 s64, s64, s65
s_mul_i32 s64, s64, 1026
s_lshl_b32 s65, s63, 8
s_add_u32 s69, s64, s65
v_bfe_u32 v8, v1, 4, 1
v_mul_u32_u24 v8, 32832, v8
v_lshrrev_b32 v9, 5, v1
s_mov_b32 s65, 1050624
v_mul_lo_u32 v9, s65, v9
v_add_u32 v8, v8, v9
v_and_b32 v9, 15, v1
s_lshl_b32 s65, s66, 1
v_xor_b32 v9, s65, v9
v_lshl_add_u32 v18, v9, 4, v8
v_xor_b32 v9, 1, v9
v_lshl_add_u32 v19, v9, 4, v8
v_add_u32 v19, 1026, v19
s_bfe_u32 s64, s2, 0x20005
s_lshl_b32 s64, s64, 8
s_bfe_u32 s65, s2, 0x10004
s_lshl_b32 s65, s65, 6
s_add_u32 s64, s64, s65
s_bfe_u32 s65, s2, 0x10003
s_lshl_b32 s65, s65, 7
s_add_u32 s64, s64, s65
s_and_b32 s65, s2, 7
s_lshl_b32 s65, s65, 2
s_add_u32 s64, s64, s65
v_bfe_u32 v8, v1, 3, 2
v_add_u32 v8, s64, v8
v_bfe_u32 v9, v1, 2, 1
v_lshl_add_u32 v8, v9, 5, v8
v_bfe_u32 v9, v1, 1, 1
v_lshl_add_u32 v8, v9, 10, v8
v_sub_u32 v9, 2048, v8
v_and_b32 v9, 2047, v9
v_and_b32 v10, 1, v1
v_cmp_eq_u32 vcc, 1, v10
s_nop 1
v_cndmask_b32 v8, v8, v9, vcc
v_mul_u32_u24 v17, 1026, v8
s_lshr_b32 s64, s2, 7
s_lshl_b32 s64, s64, 10
v_add_u32 v17, s64, v17
v_mov_b32 v184, 126992
s_lshl_b32 s64, s66, 2
v_add_u32 v185, s64, v184
v_and_b32 v8, 31, v1
v_lshrrev_b32 v9, 5, v1
v_and_b32 v10, 1, v1
v_lshrrev_b32 v11, 1, v8
v_lshlrev_b32 v4, 6, v11
v_lshl_add_u32 v4, v10, 4, v4
v_lshl_add_u32 v4, v9, 12, v4
v_add_u32 v11, v11, v10
v_lshlrev_b32 v11, 6, v11
v_lshl_add_u32 v11, v10, 4, v11
v_lshl_add_u32 v11, v9, 12, v11
v_sub_u32 v5, 5168, v11
v_bfe_u32 v11, v4, 7, 1
v_lshlrev_b32 v11, 5, v11
v_xor_b32 v4, v4, v11
v_bfe_u32 v11, v5, 7, 1
v_lshlrev_b32 v11, 5, v11
v_xor_b32 v5, v5, v11
v_add_u32 v6, 11264, v5
v_and_b32 v6, 0x3fff, v6
s_add_u32 s64, s64, 98304
v_add_u32 v4, s64, v4
v_add_u32 v5, s64, v5
v_add_u32 v6, s64, v6
v_bfe_u32 v11, v1, 3, 1
v_lshlrev_b32 v11, 5, v11
v_xor_b32 v7, v2, v11
v_bfe_u32 v12, v1, 2, 1
v_mul_u32_u24 v12, 2176, v12
v_bfe_u32 v13, v1, 3, 1
v_lshl_add_u32 v12, v13, 6, v12
v_lshl_add_u32 v12, v9, 8, v12
v_bfe_u32 v13, v1, 4, 1
v_lshl_add_u32 v12, v13, 5, v12
v_and_b32 v13, 3, v1
v_lshl_add_u32 v12, v13, 3, v12
v_add_u32 v12, s68, v12
v_xor_b32 v13, 128, v12
s_lshl_b32 s64, s2, 14
s_lshl_b32 s65, s66, 12
s_add_u32 s64, s64, s65
s_add_u32 s42, s64, 16777216
s_add_u32 s40, s32, s42
s_addc_u32 s41, s33, 0
s_mov_b32 s42, 4096
s_mov_b32 s43, 0x20000
s_add_u32 s46, s64, 16777216
s_add_u32 s44, s32, s46
s_addc_u32 s45, s33, 0
s_mov_b32 s46, 4096
s_mov_b32 s47, 0x20000
v_and_b32 v14, 7, v1
v_lshrrev_b32 v15, 3, v1
v_xor_b32 v16, v14, v15
v_lshlrev_b32 v16, 4, v16
v_lshl_add_u32 v16, v14, 11, v16
s_lshr_b32 s64, s66, 1
s_lshl_b32 s64, s64, 7
s_and_b32 s65, s66, 1
s_lshl_b32 s65, s65, 3
s_add_u32 s64, s64, s65
s_add_u32 s64, s64, 147456
v_add_u32 v16, s64, v16
v_lshlrev_b32 v15, 16, v15
v_lshl_add_u32 v15, v14, 4, v15
s_lshl_b32 s64, s63, 7
s_lshr_b32 s65, s66, 1
s_lshl_b32 s65, s65, 6
s_add_u32 s64, s64, s65
s_and_b32 s65, s66, 1
s_lshl_b32 s65, s65, 2
s_add_u32 s64, s64, s65
s_mul_i32 s64, s64, 8192
s_lshr_b32 s65, s60, 2
s_mul_i32 s65, s65, 0
s_add_u32 s64, s64, s65
s_lshl_b32 s65, s60, 10
s_add_u32 s64, s64, s65
s_lshl_b32 s65, s61, 9
s_add_u32 s64, s64, s65
s_lshl_b32 s65, s62, 7
s_add_u32 s64, s64, s65
s_add_u32 s58, s64, 25182208
s_add_u32 s56, s32, s58
s_addc_u32 s57, s33, 0
s_sub_u32 s58, 4194304, s64
s_mov_b32 s59, 0x20000
v_and_b32 v104, 31, v1
v_cvt_f32_u32 v104, v104
v_lshrrev_b32 v105, 5, v1
v_lshlrev_b32 v105, 2, v105
v_cvt_f32_u32 v105, v105
v_mul_f32 v105, v104, v105
v_mul_f32 v105, 0x3d000000, v105
v_fmamk_f32 v106, v104, 0x0, v105
v_fract_f32 v106, v106
v_cos_f32 v107, v106
v_sin_f32 v108, v106
s_nop 0
v_cvt_pk_bf16_f32 v192, v107, v108
v_cvt_pk_bf16_f32 v208, -v108, v107
v_fmamk_f32 v109, v104, 0x3d000000, v105
v_fract_f32 v109, v109
v_cos_f32 v110, v109
v_sin_f32 v111, v109
s_nop 0
v_cvt_pk_bf16_f32 v193, v110, v111
v_cvt_pk_bf16_f32 v209, -v111, v110
v_fmamk_f32 v106, v104, 0x3d800000, v105
v_fract_f32 v106, v106
v_cos_f32 v107, v106
v_sin_f32 v108, v106
s_nop 0
v_cvt_pk_bf16_f32 v194, v107, v108
v_cvt_pk_bf16_f32 v210, -v108, v107
v_fmamk_f32 v109, v104, 0x3dc00000, v105
v_fract_f32 v109, v109
v_cos_f32 v110, v109
v_sin_f32 v111, v109
s_nop 0
v_cvt_pk_bf16_f32 v195, v110, v111
v_cvt_pk_bf16_f32 v211, -v111, v110
v_fmamk_f32 v106, v104, 0x3e800000, v105
v_fract_f32 v106, v106
v_cos_f32 v107, v106
v_sin_f32 v108, v106
s_nop 0
v_cvt_pk_bf16_f32 v196, v107, v108
v_cvt_pk_bf16_f32 v212, -v108, v107
v_fmamk_f32 v109, v104, 0x3e900000, v105
v_fract_f32 v109, v109
v_cos_f32 v110, v109
v_sin_f32 v111, v109
s_nop 0
v_cvt_pk_bf16_f32 v197, v110, v111
v_cvt_pk_bf16_f32 v213, -v111, v110
v_fmamk_f32 v106, v104, 0x3ea00000, v105
v_fract_f32 v106, v106
v_cos_f32 v107, v106
v_sin_f32 v108, v106
s_nop 0
v_cvt_pk_bf16_f32 v198, v107, v108
v_cvt_pk_bf16_f32 v214, -v108, v107
v_fmamk_f32 v109, v104, 0x3eb00000, v105
v_fract_f32 v109, v109
v_cos_f32 v110, v109
v_sin_f32 v111, v109
s_nop 0
v_cvt_pk_bf16_f32 v199, v110, v111
v_cvt_pk_bf16_f32 v215, -v111, v110
v_fmamk_f32 v106, v104, 0x3f000000, v105
v_fract_f32 v106, v106
v_cos_f32 v107, v106
v_sin_f32 v108, v106
s_nop 0
v_cvt_pk_bf16_f32 v200, v107, v108
v_cvt_pk_bf16_f32 v216, -v108, v107
v_fmamk_f32 v109, v104, 0x3f080000, v105
v_fract_f32 v109, v109
v_cos_f32 v110, v109
v_sin_f32 v111, v109
s_nop 0
v_cvt_pk_bf16_f32 v201, v110, v111
v_cvt_pk_bf16_f32 v217, -v111, v110
v_fmamk_f32 v106, v104, 0x3f100000, v105
v_fract_f32 v106, v106
v_cos_f32 v107, v106
v_sin_f32 v108, v106
s_nop 0
v_cvt_pk_bf16_f32 v202, v107, v108
v_cvt_pk_bf16_f32 v218, -v108, v107
v_fmamk_f32 v109, v104, 0x3f180000, v105
v_fract_f32 v109, v109
v_cos_f32 v110, v109
v_sin_f32 v111, v109
s_nop 0
v_cvt_pk_bf16_f32 v203, v110, v111
v_cvt_pk_bf16_f32 v219, -v111, v110
v_fmamk_f32 v106, v104, 0x3f400000, v105
v_fract_f32 v106, v106
v_cos_f32 v107, v106
v_sin_f32 v108, v106
s_nop 0
v_cvt_pk_bf16_f32 v204, v107, v108
v_cvt_pk_bf16_f32 v220, -v108, v107
v_fmamk_f32 v109, v104, 0x3f480000, v105
v_fract_f32 v109, v109
v_cos_f32 v110, v109
v_sin_f32 v111, v109
s_nop 0
v_cvt_pk_bf16_f32 v205, v110, v111
v_cvt_pk_bf16_f32 v221, -v111, v110
v_fmamk_f32 v106, v104, 0x3f500000, v105
v_fract_f32 v106, v106
v_cos_f32 v107, v106
v_sin_f32 v108, v106
s_nop 0
v_cvt_pk_bf16_f32 v206, v107, v108
v_cvt_pk_bf16_f32 v222, -v108, v107
v_fmamk_f32 v109, v104, 0x3f580000, v105
v_fract_f32 v109, v109
v_cos_f32 v110, v109
v_sin_f32 v111, v109
s_nop 0
v_cvt_pk_bf16_f32 v207, v110, v111
v_cvt_pk_bf16_f32 v223, -v111, v110
v_and_b32 v104, 31, v1
v_cvt_f32_u32 v104, v104
v_lshrrev_b32 v105, 5, v1
v_lshlrev_b32 v105, 2, v105
v_cvt_f32_u32 v105, v105
v_mul_f32 v105, v104, v105
v_mul_f32 v105, 0x3a800000, v105
v_fmamk_f32 v106, v104, 0x0, v105
v_cos_f32 v224, v106
v_sin_f32 v240, -v106
v_fmamk_f32 v107, v104, 0x3a800000, v105
v_cos_f32 v225, v107
v_sin_f32 v241, -v107
v_fmamk_f32 v106, v104, 0x3b000000, v105
v_cos_f32 v226, v106
v_sin_f32 v242, -v106
v_fmamk_f32 v107, v104, 0x3b400000, v105
v_cos_f32 v227, v107
v_sin_f32 v243, -v107
v_fmamk_f32 v106, v104, 0x3c000000, v105
v_cos_f32 v228, v106
v_sin_f32 v244, -v106
v_fmamk_f32 v107, v104, 0x3c100000, v105
v_cos_f32 v229, v107
v_sin_f32 v245, -v107
v_fmamk_f32 v106, v104, 0x3c200000, v105
v_cos_f32 v230, v106
v_sin_f32 v246, -v106
v_fmamk_f32 v107, v104, 0x3c300000, v105
v_cos_f32 v231, v107
v_sin_f32 v247, -v107
v_fmamk_f32 v106, v104, 0x3c800000, v105
v_cos_f32 v232, v106
v_sin_f32 v248, -v106
v_fmamk_f32 v107, v104, 0x3c880000, v105
v_cos_f32 v233, v107
v_sin_f32 v249, -v107
v_fmamk_f32 v106, v104, 0x3c900000, v105
v_cos_f32 v234, v106
v_sin_f32 v250, -v106
v_fmamk_f32 v107, v104, 0x3c980000, v105
v_cos_f32 v235, v107
v_sin_f32 v251, -v107
v_fmamk_f32 v106, v104, 0x3cc00000, v105
v_cos_f32 v236, v106
v_sin_f32 v252, -v106
v_fmamk_f32 v107, v104, 0x3cc80000, v105
v_cos_f32 v237, v107
v_sin_f32 v253, -v107
v_fmamk_f32 v106, v104, 0x3cd00000, v105
v_cos_f32 v238, v106
v_sin_f32 v254, -v106
v_fmamk_f32 v107, v104, 0x3cd80000, v105
v_cos_f32 v239, v107
v_sin_f32 v255, -v107
v_and_b32 v104, 31, v1
v_cvt_f32_u32 v104, v104
v_lshrrev_b32 v105, 5, v1
v_lshlrev_b32 v105, 2, v105
v_cvt_f32_u32 v105, v105
v_mul_f32 v104, 0x3a000000, v104
v_fmamk_f32 v105, v105, 0x3c800000, v104
v_add_f32 v106, 0x0, v105
v_cos_f32 v136, v106
v_sin_f32 v152, -v106
v_add_f32 v107, 0x3c800000, v105
v_cos_f32 v137, v107
v_sin_f32 v153, -v107
v_add_f32 v106, 0x3d000000, v105
v_cos_f32 v138, v106
v_sin_f32 v154, -v106
v_add_f32 v107, 0x3d400000, v105
v_cos_f32 v139, v107
v_sin_f32 v155, -v107
v_add_f32 v106, 0x3e000000, v105
v_cos_f32 v140, v106
v_sin_f32 v156, -v106
v_add_f32 v107, 0x3e100000, v105
v_cos_f32 v141, v107
v_sin_f32 v157, -v107
v_add_f32 v106, 0x3e200000, v105
v_cos_f32 v142, v106
v_sin_f32 v158, -v106
v_add_f32 v107, 0x3e300000, v105
v_cos_f32 v143, v107
v_sin_f32 v159, -v107
v_add_f32 v106, 0x3e800000, v105
v_cos_f32 v144, v106
v_sin_f32 v160, -v106
v_add_f32 v107, 0x3e880000, v105
v_cos_f32 v145, v107
v_sin_f32 v161, -v107
v_add_f32 v106, 0x3e900000, v105
v_cos_f32 v146, v106
v_sin_f32 v162, -v106
v_add_f32 v107, 0x3e980000, v105
v_cos_f32 v147, v107
v_sin_f32 v163, -v107
v_add_f32 v106, 0x3ec00000, v105
v_cos_f32 v148, v106
v_sin_f32 v164, -v106
v_add_f32 v107, 0x3ec80000, v105
v_cos_f32 v149, v107
v_sin_f32 v165, -v107
v_add_f32 v106, 0x3ed00000, v105
v_cos_f32 v150, v106
v_sin_f32 v166, -v106
v_add_f32 v107, 0x3ed80000, v105
v_cos_f32 v151, v107
v_sin_f32 v167, -v107
s_add_u32 m0, s25, 32768
s_add_u32 s26, s24, 128
s_and_b32 s26, s26, 0x7ff
buffer_load_dwordx4 v176, s[12:15], s26 offen offset:0 lds
buffer_load_dwordx4 v177, s[12:15], s26 offen offset:1024 lds
buffer_load_dwordx4 v178, s[12:15], s26 offen offset:2048 lds
buffer_load_dwordx4 v179, s[12:15], s26 offen offset:3072 lds
s_add_u32 m0, s25, 49152
s_nop 0
buffer_load_dwordx4 v180, s[20:23], s26 offen offset:0 lds
buffer_load_dwordx4 v181, s[20:23], s26 offen offset:1024 lds
buffer_load_dwordx4 v182, s[20:23], s26 offen offset:2048 lds
buffer_load_dwordx4 v183, s[20:23], s26 offen offset:3072 lds
s_waitcnt vmcnt(8)
s_barrier
s_add_u32 m0, s25, 65536
s_add_u32 s26, s24, 256
s_and_b32 s26, s26, 0x7ff
buffer_load_dwordx4 v176, s[12:15], s26 offen offset:0 lds
buffer_load_dwordx4 v177, s[12:15], s26 offen offset:1024 lds
buffer_load_dwordx4 v178, s[12:15], s26 offen offset:2048 lds
buffer_load_dwordx4 v179, s[12:15], s26 offen offset:3072 lds
s_add_u32 m0, s25, 81920
s_nop 0
buffer_load_dwordx4 v180, s[20:23], s26 offen offset:0 lds
buffer_load_dwordx4 v181, s[20:23], s26 offen offset:1024 lds
buffer_load_dwordx4 v182, s[20:23], s26 offen offset:2048 lds
buffer_load_dwordx4 v183, s[20:23], s26 offen offset:3072 lds
s_waitcnt vmcnt(8)
s_barrier
s_add_u32 m0, s25, 0
s_add_u32 s26, s24, 384
s_and_b32 s26, s26, 0x7ff
buffer_load_dwordx4 v176, s[12:15], s26 offen offset:0 lds
buffer_load_dwordx4 v177, s[12:15], s26 offen offset:1024 lds
buffer_load_dwordx4 v178, s[12:15], s26 offen offset:2048 lds
buffer_load_dwordx4 v179, s[12:15], s26 offen offset:3072 lds
s_add_u32 m0, s25, 16384
s_nop 0
buffer_load_dwordx4 v180, s[20:23], s26 offen offset:0 lds
buffer_load_dwordx4 v181, s[20:23], s26 offen offset:1024 lds
buffer_load_dwordx4 v182, s[20:23], s26 offen offset:2048 lds
buffer_load_dwordx4 v183, s[20:23], s26 offen offset:3072 lds
s_add_u32 m0, s68, 16384
s_nop 0
buffer_load_dwordx4 v18, s[48:51], s69 offen nt lds
s_add_u32 m0, s68, 17408
s_nop 0
buffer_load_dwordx4 v18, s[52:55], s69 offen nt lds
s_add_u32 m0, s68, 18432
s_nop 0
buffer_load_dwordx4 v19, s[48:51], s69 offen nt lds
s_add_u32 m0, s68, 19456
s_nop 0
buffer_load_dwordx4 v19, s[52:55], s69 offen nt lds
s_cmp_lg_u32 s66, 3
s_cbranch_scc1 L_nw1
s_mov_b32 exec_hi, 0
buffer_load_ushort v88, v17, s[48:51], 0 offen nt
buffer_load_ushort v89, v17, s[52:55], 0 offen nt
s_mov_b64 exec, -1
L_nw1:
s_waitcnt vmcnt(12)
s_barrier
s_add_u32 m0, s25, 32768
s_add_u32 s26, s24, 512
s_and_b32 s26, s26, 0x7ff
buffer_load_dwordx4 v176, s[12:15], s26 offen offset:0 lds
buffer_load_dwordx4 v177, s[12:15], s26 offen offset:1024 lds
buffer_load_dwordx4 v178, s[12:15], s26 offen offset:2048 lds
buffer_load_dwordx4 v179, s[12:15], s26 offen offset:3072 lds
s_add_u32 m0, s25, 49152
s_nop 0
buffer_load_dwordx4 v180, s[20:23], s26 offen offset:0 lds
buffer_load_dwordx4 v181, s[20:23], s26 offen offset:1024 lds
buffer_load_dwordx4 v182, s[20:23], s26 offen offset:2048 lds
buffer_load_dwordx4 v183, s[20:23], s26 offen offset:3072 lds
s_waitcnt vmcnt(12)
s_barrier
s_add_u32 m0, s25, 65536
s_add_u32 s26, s24, 640
s_and_b32 s26, s26, 0x7ff
buffer_load_dwordx4 v176, s[12:15], s26 offen offset:0 lds
buffer_load_dwordx4 v177, s[12:15], s26 offen offset:1024 lds
buffer_load_dwordx4 v178, s[12:15], s26 offen offset:2048 lds
buffer_load_dwordx4 v179, s[12:15], s26 offen offset:3072 lds
s_add_u32 m0, s25, 81920
s_nop 0
buffer_load_dwordx4 v180, s[20:23], s26 offen offset:0 lds
buffer_load_dwordx4 v181, s[20:23], s26 offen offset:1024 lds
buffer_load_dwordx4 v182, s[20:23], s26 offen offset:2048 lds
buffer_load_dwordx4 v183, s[20:23], s26 offen offset:3072 lds
s_waitcnt vmcnt(8)
s_barrier
s_add_u32 m0, s25, 0
s_add_u32 s26, s24, 768
s_and_b32 s26, s26, 0x7ff
buffer_load_dwordx4 v176, s[12:15], s26 offen offset:0 lds
buffer_load_dwordx4 v177, s[12:15], s26 offen offset:1024 lds
buffer_load_dwordx4 v178, s[12:15], s26 offen offset:2048 lds
buffer_load_dwordx4 v179, s[12:15], s26 offen offset:3072 lds
s_add_u32 m0, s25, 16384
s_nop 0
buffer_load_dwordx4 v180, s[20:23], s26 offen offset:0 lds
buffer_load_dwordx4 v181, s[20:23], s26 offen offset:1024 lds
buffer_load_dwordx4 v182, s[20:23], s26 offen offset:2048 lds
buffer_load_dwordx4 v183, s[20:23], s26 offen offset:3072 lds
ds_read_b64 v[104:105], v16 offset:0
ds_read_b64 v[106:107], v16 offset:256
ds_read_b64 v[108:109], v16 offset:512
ds_read_b64 v[110:111], v16 offset:768
ds_read_b64 v[112:113], v16 offset:1024
ds_read_b64 v[114:115], v16 offset:1280
ds_read_b64 v[116:117], v16 offset:1536
ds_read_b64 v[118:119], v16 offset:1792
s_mov_b32 s64, 0x05040100
s_mov_b32 s65, 0x07060302
v_lshlrev_b32 v88, 16, v88
v_lshlrev_b32 v89, 16, v89
v_lshlrev_b32 v9, 1, v1
v_add_f32_dpp v90, v88, v88 quad_perm:[1,0,3,2] row_mask:0xf bank_mask:0xf
v_subrev_f32_dpp v91, v89, v89 quad_perm:[1,0,3,2] row_mask:0xf bank_mask:0xf
v_mul_f32 v90, 0.5, v90
v_mul_f32 v91, 0.5, v91
v_cvt_pk_bf16_f32 v88, v90, v91
s_waitcnt lgkmcnt(0)
v_perm_b32 v120, v112, v104, s64
v_perm_b32 v121, v116, v108, s64
v_perm_b32 v122, v114, v106, s64
v_perm_b32 v123, v118, v110, s64
v_perm_b32 v124, v112, v104, s65
v_perm_b32 v125, v116, v108, s65
v_perm_b32 v126, v114, v106, s65
v_perm_b32 v127, v118, v110, s65
v_perm_b32 v128, v113, v105, s64
v_perm_b32 v129, v117, v109, s64
v_perm_b32 v130, v115, v107, s64
v_perm_b32 v131, v119, v111, s64
v_perm_b32 v132, v113, v105, s65
v_perm_b32 v133, v117, v109, s65
v_perm_b32 v134, v115, v107, s65
v_perm_b32 v135, v119, v111, s65
s_waitcnt vmcnt(8)
s_barrier
s_add_u32 m0, s25, 32768
s_add_u32 s26, s24, 896
s_and_b32 s26, s26, 0x7ff
buffer_load_dwordx4 v176, s[12:15], s26 offen offset:0 lds
buffer_load_dwordx4 v177, s[12:15], s26 offen offset:1024 lds
buffer_load_dwordx4 v178, s[12:15], s26 offen offset:2048 lds
buffer_load_dwordx4 v179, s[12:15], s26 offen offset:3072 lds
s_add_u32 m0, s25, 49152
s_nop 0
buffer_load_dwordx4 v180, s[20:23], s26 offen offset:0 lds
buffer_load_dwordx4 v181, s[20:23], s26 offen offset:1024 lds
buffer_load_dwordx4 v182, s[20:23], s26 offen offset:2048 lds
buffer_load_dwordx4 v183, s[20:23], s26 offen offset:3072 lds
s_add_u32 m0, s68, 0
s_mov_b32 s92, 0
buffer_load_dwordx4 v2, s[4:7], s92 offen offset:0 nt lds
buffer_load_dwordx4 v2, s[4:7], s92 offen offset:1024 nt lds
s_add_u32 m0, s68, 2048
s_mov_b32 s92, 2048
buffer_load_dwordx4 v3, s[4:7], s92 offen offset:0 nt lds
buffer_load_dwordx4 v3, s[4:7], s92 offen offset:1024 nt lds
s_waitcnt vmcnt(12)
s_barrier
s_add_u32 m0, s25, 65536
s_add_u32 s26, s24, 1024
s_and_b32 s26, s26, 0x7ff
buffer_load_dwordx4 v176, s[12:15], s26 offen offset:0 lds
buffer_load_dwordx4 v177, s[12:15], s26 offen offset:1024 lds
buffer_load_dwordx4 v178, s[12:15], s26 offen offset:2048 lds
buffer_load_dwordx4 v179, s[12:15], s26 offen offset:3072 lds
s_add_u32 m0, s25, 81920
s_nop 0
buffer_load_dwordx4 v180, s[20:23], s26 offen offset:0 lds
buffer_load_dwordx4 v181, s[20:23], s26 offen offset:1024 lds
buffer_load_dwordx4 v182, s[20:23], s26 offen offset:2048 lds
buffer_load_dwordx4 v183, s[20:23], s26 offen offset:3072 lds
s_waitcnt vmcnt(12)
s_barrier
s_add_u32 m0, s25, 0
s_add_u32 s26, s24, 1152
s_and_b32 s26, s26, 0x7ff
buffer_load_dwordx4 v176, s[12:15], s26 offen offset:0 lds
buffer_load_dwordx4 v177, s[12:15], s26 offen offset:1024 lds
buffer_load_dwordx4 v178, s[12:15], s26 offen offset:2048 lds
buffer_load_dwordx4 v179, s[12:15], s26 offen offset:3072 lds
s_add_u32 m0, s25, 16384
s_nop 0
buffer_load_dwordx4 v180, s[20:23], s26 offen offset:0 lds
buffer_load_dwordx4 v181, s[20:23], s26 offen offset:1024 lds
buffer_load_dwordx4 v182, s[20:23], s26 offen offset:2048 lds
buffer_load_dwordx4 v183, s[20:23], s26 offen offset:3072 lds
v_mov_b32 v20, 0
global_load_dword v21, v20, s[30:31] sc1
s_waitcnt vmcnt(9)
s_barrier
s_add_u32 m0, s25, 32768
s_add_u32 s26, s24, 1280
s_and_b32 s26, s26, 0x7ff
buffer_load_dwordx4 v176, s[12:15], s26 offen offset:0 lds
buffer_load_dwordx4 v177, s[12:15], s26 offen offset:1024 lds
buffer_load_dwordx4 v178, s[12:15], s26 offen offset:2048 lds
buffer_load_dwordx4 v179, s[12:15], s26 offen offset:3072 lds
s_add_u32 m0, s25, 49152
s_nop 0
buffer_load_dwordx4 v180, s[20:23], s26 offen offset:0 lds
buffer_load_dwordx4 v181, s[20:23], s26 offen offset:1024 lds
buffer_load_dwordx4 v182, s[20:23], s26 offen offset:2048 lds
buffer_load_dwordx4 v183, s[20:23], s26 offen offset:3072 lds
s_waitcnt vmcnt(9)
s_barrier
s_add_u32 m0, s25, 65536
s_add_u32 s26, s24, 1408
s_and_b32 s26, s26, 0x7ff
buffer_load_dwordx4 v176, s[12:15], s26 offen offset:0 lds
buffer_load_dwordx4 v177, s[12:15], s26 offen offset:1024 lds
buffer_load_dwordx4 v178, s[12:15], s26 offen offset:2048 lds
buffer_load_dwordx4 v179, s[12:15], s26 offen offset:3072 lds
s_add_u32 m0, s25, 81920
s_nop 0
buffer_load_dwordx4 v180, s[20:23], s26 offen offset:0 lds
buffer_load_dwordx4 v181, s[20:23], s26 offen offset:1024 lds
buffer_load_dwordx4 v182, s[20:23], s26 offen offset:2048 lds
buffer_load_dwordx4 v183, s[20:23], s26 offen offset:3072 lds
s_cmp_lg_u32 s66, 3
s_cbranch_scc1 L_nw2
s_lshr_b32 s64, s2, 7
s_mul_i32 s64, s64, 8192
s_bfe_u32 s65, s2, 0x10006
s_mul_i32 s65, s65, 4096
s_add_u32 s64, s64, s65
s_and_b32 s65, s2, 63
s_lshl_b32 s65, s65, 6
s_add_u32 s64, s64, s65
s_add_u32 s54, s64, 25165824
s_add_u32 s52, s32, s54
s_addc_u32 s53, s33, 0
s_mov_b32 s54, 64
s_mov_b32 s55, 0x20000
s_mov_b32 exec_lo, 0x55555555
s_mov_b32 exec_hi, 0
buffer_store_dword v88, v9, s[52:55], 0 offen sc1
s_mov_b64 exec, -1
L_nw2:
s_mov_b32 s92, 0
buffer_store_dwordx4 v[120:123], v15, s[56:59], s92 offen sc1
s_mov_b32 s92, 8192
buffer_store_dwordx4 v[124:127], v15, s[56:59], s92 offen sc1
s_mov_b32 s92, 16384
buffer_store_dwordx4 v[128:131], v15, s[56:59], s92 offen sc1
s_mov_b32 s92, 24576
buffer_store_dwordx4 v[132:135], v15, s[56:59], s92 offen sc1
s_waitcnt vmcnt(12)
s_barrier
s_add_u32 m0, s25, 0
s_add_u32 s26, s24, 1536
s_and_b32 s26, s26, 0x7ff
buffer_load_dwordx4 v176, s[12:15], s26 offen offset:0 lds
buffer_load_dwordx4 v177, s[12:15], s26 offen offset:1024 lds
buffer_load_dwordx4 v178, s[12:15], s26 offen offset:2048 lds
buffer_load_dwordx4 v179, s[12:15], s26 offen offset:3072 lds
s_add_u32 m0, s25, 16384
s_nop 0
buffer_load_dwordx4 v180, s[20:23], s26 offen offset:0 lds
buffer_load_dwordx4 v181, s[20:23], s26 offen offset:1024 lds
buffer_load_dwordx4 v182, s[20:23], s26 offen offset:2048 lds
buffer_load_dwordx4 v183, s[20:23], s26 offen offset:3072 lds
s_waitcnt vmcnt(12)
s_barrier
s_add_u32 m0, s25, 32768
s_add_u32 s26, s24, 1664
s_and_b32 s26, s26, 0x7ff
buffer_load_dwordx4 v176, s[12:15], s26 offen offset:0 lds
buffer_load_dwordx4 v177, s[12:15], s26 offen offset:1024 lds
buffer_load_dwordx4 v178, s[12:15], s26 offen offset:2048 lds
buffer_load_dwordx4 v179, s[12:15], s26 offen offset:3072 lds
s_add_u32 m0, s25, 49152
s_nop 0
buffer_load_dwordx4 v180, s[20:23], s26 offen offset:0 lds
buffer_load_dwordx4 v181, s[20:23], s26 offen offset:1024 lds
buffer_load_dwordx4 v182, s[20:23], s26 offen offset:2048 lds
buffer_load_dwordx4 v183, s[20:23], s26 offen offset:3072 lds
s_waitcnt vmcnt(8)
s_barrier
s_add_u32 m0, s25, 65536
s_add_u32 s26, s24, 1792
s_and_b32 s26, s26, 0x7ff
buffer_load_dwordx4 v176, s[12:15], s26 offen offset:0 lds
buffer_load_dwordx4 v177, s[12:15], s26 offen offset:1024 lds
buffer_load_dwordx4 v178, s[12:15], s26 offen offset:2048 lds
buffer_load_dwordx4 v179, s[12:15], s26 offen offset:3072 lds
s_add_u32 m0, s25, 81920
s_nop 0
buffer_load_dwordx4 v180, s[20:23], s26 offen offset:0 lds
buffer_load_dwordx4 v181, s[20:23], s26 offen offset:1024 lds
buffer_load_dwordx4 v182, s[20:23], s26 offen offset:2048 lds
buffer_load_dwordx4 v183, s[20:23], s26 offen offset:3072 lds
s_waitcnt vmcnt(8)
s_barrier
s_add_u32 m0, s25, 0
s_add_u32 s26, s24, 1920
s_and_b32 s26, s26, 0x7ff
buffer_load_dwordx4 v176, s[12:15], s26 offen offset:0 lds
buffer_load_dwordx4 v177, s[12:15], s26 offen offset:1024 lds
buffer_load_dwordx4 v178, s[12:15], s26 offen offset:2048 lds
buffer_load_dwordx4 v179, s[12:15], s26 offen offset:3072 lds
s_add_u32 m0, s25, 16384
s_nop 0
buffer_load_dwordx4 v180, s[20:23], s26 offen offset:0 lds
buffer_load_dwordx4 v181, s[20:23], s26 offen offset:1024 lds
buffer_load_dwordx4 v182, s[20:23], s26 offen offset:2048 lds
buffer_load_dwordx4 v183, s[20:23], s26 offen offset:3072 lds
s_and_b32 s26, s2, 1
s_lshl_b32 s26, s26, 10
s_bfe_u32 s92, s2, 0x20001
s_lshl_b32 s92, s92, 19
s_add_u32 s26, s26, s92
s_lshr_b32 s92, s2, 3
s_lshl_b32 s92, s92, 14
s_add_u32 s26, s26, s92
s_lshr_b32 s92, s66, 1
s_lshl_b32 s92, s92, 13
s_add_u32 s26, s26, s92
v_bfe_u32 v22, v1, 3, 2
v_lshlrev_b32 v22, 11, v22
v_and_b32 v23, 7, v1
v_lshl_add_u32 v22, v23, 7, v22
v_add_u32 v22, s26, v22
s_mov_b32 exec_hi, 0
global_load_dword v23, v22, s[100:101]
s_mov_b64 exec, -1
s_waitcnt vmcnt(9)
s_barrier
s_waitcnt vmcnt(1)
s_barrier
s_barrier
s_barrier
s_setprio 3
v_readfirstlane_b32 s37, v21
s_nop 0
s_cmp_lg_u32 s37, 0
s_cbranch_scc1 L_sg3
v_mov_b32 v20, 0
L_n4:
global_load_dword v21, v20, s[30:31] sc1
s_waitcnt vmcnt(0)
v_readfirstlane_b32 s37, v21
s_nop 0
s_cmp_eq_u32 s37, 0
s_cbranch_scc1 L_n4
L_sg3:
s_waitcnt vmcnt(63)
ds_read_b64_tr_b16 v[24:25], v12 offset:0
ds_read_b64_tr_b16 v[26:27], v13 offset:0
ds_read_b64_tr_b16 v[28:29], v12 offset:512
ds_read_b64_tr_b16 v[30:31], v13 offset:512
ds_read_b64_tr_b16 v[32:33], v12 offset:1024
ds_read_b64_tr_b16 v[34:35], v13 offset:1024
ds_read_b64_tr_b16 v[36:37], v12 offset:1536
ds_read_b64_tr_b16 v[38:39], v13 offset:1536
s_waitcnt lgkmcnt(0)
v_mfma_f32_32x32x16_bf16 v[40:55], v[24:27], v[192:195], 0
v_mfma_f32_32x32x16_bf16 v[40:55], v[28:31], v[196:199], v[40:55]
v_mfma_f32_32x32x16_bf16 v[40:55], v[32:35], v[200:203], v[40:55]
v_mfma_f32_32x32x16_bf16 v[40:55], v[36:39], v[204:207], v[40:55]
v_mfma_f32_32x32x16_bf16 v[56:71], v[24:27], v[208:211], 0
v_mfma_f32_32x32x16_bf16 v[56:71], v[28:31], v[212:215], v[56:71]
v_mfma_f32_32x32x16_bf16 v[56:71], v[32:35], v[216:219], v[56:71]
v_mfma_f32_32x32x16_bf16 v[56:71], v[36:39], v[220:223], v[56:71]
s_nop 7
v_mul_f32 v168, v40, v224
v_mul_f32 v169, v40, v240
s_nop 1
v_fma_f32 v168, -v56, v240, v168
v_fmac_f32 v169, v56, v224
v_cvt_pk_bf16_f32 v72, v168, v169
v_mul_f32 v170, v41, v225
v_mul_f32 v171, v41, v241
v_fma_f32 v170, -v57, v241, v170
v_fmac_f32 v171, v57, v225
v_cvt_pk_bf16_f32 v73, v170, v171
v_mul_f32 v172, v42, v226
v_mul_f32 v173, v42, v242
v_fma_f32 v172, -v58, v242, v172
v_fmac_f32 v173, v58, v226
v_cvt_pk_bf16_f32 v74, v172, v173
v_mul_f32 v174, v43, v227
v_mul_f32 v175, v43, v243
v_fma_f32 v174, -v59, v243, v174
v_fmac_f32 v175, v59, v227
v_cvt_pk_bf16_f32 v75, v174, v175
v_mul_f32 v168, v44, v228
v_mul_f32 v169, v44, v244
v_fma_f32 v168, -v60, v244, v168
v_fmac_f32 v169, v60, v228
v_cvt_pk_bf16_f32 v76, v168, v169
v_mul_f32 v170, v45, v229
v_mul_f32 v171, v45, v245
v_fma_f32 v170, -v61, v245, v170
v_fmac_f32 v171, v61, v229
v_cvt_pk_bf16_f32 v77, v170, v171
v_mul_f32 v172, v46, v230
v_mul_f32 v173, v46, v246
v_fma_f32 v172, -v62, v246, v172
v_fmac_f32 v173, v62, v230
v_cvt_pk_bf16_f32 v78, v172, v173
v_mul_f32 v174, v47, v231
v_mul_f32 v175, v47, v247
v_fma_f32 v174, -v63, v247, v174
v_fmac_f32 v175, v63, v231
v_cvt_pk_bf16_f32 v79, v174, v175
v_mul_f32 v168, v48, v232
v_mul_f32 v169, v48, v248
v_fma_f32 v168, -v64, v248, v168
v_fmac_f32 v169, v64, v232
v_cvt_pk_bf16_f32 v80, v168, v169
v_mul_f32 v170, v49, v233
v_mul_f32 v171, v49, v249
v_fma_f32 v170, -v65, v249, v170
v_fmac_f32 v171, v65, v233
v_cvt_pk_bf16_f32 v81, v170, v171
v_mul_f32 v172, v50, v234
v_mul_f32 v173, v50, v250
v_fma_f32 v172, -v66, v250, v172
v_fmac_f32 v173, v66, v234
v_cvt_pk_bf16_f32 v82, v172, v173
v_mul_f32 v174, v51, v235
v_mul_f32 v175, v51, v251
v_fma_f32 v174, -v67, v251, v174
v_fmac_f32 v175, v67, v235
v_cvt_pk_bf16_f32 v83, v174, v175
v_mul_f32 v168, v52, v236
v_mul_f32 v169, v52, v252
v_fma_f32 v168, -v68, v252, v168
v_fmac_f32 v169, v68, v236
v_cvt_pk_bf16_f32 v84, v168, v169
v_mul_f32 v170, v53, v237
v_mul_f32 v171, v53, v253
v_fma_f32 v170, -v69, v253, v170
v_fmac_f32 v171, v69, v237
v_cvt_pk_bf16_f32 v85, v170, v171
v_mul_f32 v172, v54, v238
v_mul_f32 v173, v54, v254
v_fma_f32 v172, -v70, v254, v172
v_fmac_f32 v173, v70, v238
v_cvt_pk_bf16_f32 v86, v172, v173
v_mul_f32 v174, v55, v239
v_mul_f32 v175, v55, v255
v_fma_f32 v174, -v71, v255, v174
v_fmac_f32 v175, v71, v239
v_cvt_pk_bf16_f32 v87, v174, v175
v_mfma_f32_32x32x16_bf16 v[40:55], v[192:195], v[72:75], 0
v_mfma_f32_32x32x16_bf16 v[40:55], v[196:199], v[76:79], v[40:55]
v_mfma_f32_32x32x16_bf16 v[40:55], v[200:203], v[80:83], v[40:55]
v_mfma_f32_32x32x16_bf16 v[40:55], v[204:207], v[84:87], v[40:55]
v_mfma_f32_32x32x16_bf16 v[56:71], v[208:211], v[72:75], 0
v_mfma_f32_32x32x16_bf16 v[56:71], v[212:215], v[76:79], v[56:71]
v_mfma_f32_32x32x16_bf16 v[56:71], v[216:219], v[80:83], v[56:71]
v_mfma_f32_32x32x16_bf16 v[56:71], v[220:223], v[84:87], v[56:71]
s_lshl_b32 s92, s66, 12
s_add_u32 s92, s92, 98304
v_add_u32 v8, s92, v7
s_nop 8
v_cvt_pk_bf16_f32 v72, v40, v56
ds_write_b32 v4, v72 offset:0
v_cvt_pk_bf16_f32 v73, v41, v57
ds_write_b32 v4, v73 offset:1024
v_cvt_pk_bf16_f32 v74, v42, v58
ds_write_b32 v4, v74 offset:2048
v_cvt_pk_bf16_f32 v75, v43, v59
ds_write_b32 v4, v75 offset:3072
v_cvt_pk_bf16_f32 v76, v44, v60
ds_write_b32 v4, v76 offset:8192
v_cvt_pk_bf16_f32 v77, v45, v61
ds_write_b32 v4, v77 offset:9216
v_cvt_pk_bf16_f32 v78, v46, v62
ds_write_b32 v4, v78 offset:10240
v_cvt_pk_bf16_f32 v79, v47, v63
ds_write_b32 v4, v79 offset:11264
v_cvt_pk_bf16_f32 v80, v48, v64
ds_write_b32 v6, v80 offset:0
v_cvt_pk_bf16_f32 v81, v49, v65
ds_write_b32 v5, v81 offset:10240
v_cvt_pk_bf16_f32 v82, v50, v66
ds_write_b32 v5, v82 offset:9216
v_cvt_pk_bf16_f32 v83, v51, v67
ds_write_b32 v5, v83 offset:8192
v_cvt_pk_bf16_f32 v84, v52, v68
ds_write_b32 v5, v84 offset:3072
v_cvt_pk_bf16_f32 v85, v53, v69
ds_write_b32 v5, v85 offset:2048
v_cvt_pk_bf16_f32 v86, v54, v70
ds_write_b32 v5, v86 offset:1024
v_cvt_pk_bf16_f32 v87, v55, v71
ds_write_b32 v5, v87 offset:0
s_waitcnt lgkmcnt(0)
v_mov_b32 v190, 1
s_mov_b64 exec, 1
ds_write_b32 v185, v190
s_mov_b64 exec, -1
L_lc6:
ds_read_b128 v[186:189], v184
s_waitcnt lgkmcnt(0)
v_min3_u32 v186, v186, v187, v188
v_min_u32 v186, v186, v189
s_nop 0
v_readfirstlane_b32 s92, v186
s_nop 0
s_cmp_ge_u32 s92, 1
s_cbranch_scc1 L_lcd7
s_sleep 1
s_branch L_lc6
L_lcd7:
ds_read_b128 v[72:75], v8 offset:0
ds_read_b128 v[76:79], v8 offset:1024
ds_read_b128 v[80:83], v8 offset:2048
ds_read_b128 v[84:87], v8 offset:3072
v_add_u32 v4, 32768, v4
v_add_u32 v5, 32768, v5
v_add_u32 v6, 32768, v6
s_waitcnt lgkmcnt(0)
v_mov_b32 v190, 2
s_mov_b64 exec, 1
ds_write_b32 v185, v190
s_mov_b64 exec, -1
buffer_store_dwordx4 v[72:75], v2, s[40:43], 0 offen offset:0 sc1
buffer_store_dwordx4 v[76:79], v2, s[40:43], 0 offen offset:1024 sc1
buffer_store_dwordx4 v[80:83], v2, s[40:43], 0 offen offset:2048 sc1
buffer_store_dwordx4 v[84:87], v2, s[40:43], 0 offen offset:3072 sc1
s_and_b32 s60, s2, 7
s_lshl_b32 s60, s60, 5
s_lshr_b32 s64, s2, 3
s_add_u32 s60, s60, s64
s_lshr_b32 s64, s66, 1
s_xor_b32 s64, s64, s66
s_and_b32 s64, s64, 1
s_or_b32 s65, s64, s60
s_cmp_eq_u32 s65, 0
s_cselect_b32 s61, 1, 0
s_lshl_b32 s65, s60, 1
s_add_u32 s64, s64, s65
s_mul_i32 s64, s64, 8192
s_add_u32 s64, s64, 25182208
s_lshr_b32 s65, s66, 1
s_mul_i32 s69, s65, 8192
s_add_u32 s69, s69, 25165824
s_cmp_eq_u32 s61, 1
s_cselect_b32 s64, s69, s64
s_cselect_b32 s65, 0, s65
s_cselect_b32 s90, s32, s32
s_cselect_b32 s91, s33, s33
s_lshl_b32 s62, s65, 31
s_or_b32 s63, s62, 0x3f800000
s_add_u32 s48, s90, s64
s_addc_u32 s49, s91, 0
s_mov_b32 s50, 8192
s_mov_b32 s51, 0x20000
s_lshl_b32 s64, s66, 20
s_lshl_b32 s65, s60, 6
s_add_u32 s64, s64, s65
s_add_u32 s54, s64, 16777216
s_add_u32 s52, s32, s54
s_addc_u32 s53, s33, 0
s_sub_u32 s54, 1048576, s65
s_mov_b32 s55, 0x20000
s_add_u32 s58, s64, 16777216
s_add_u32 s56, s32, s58
s_addc_u32 s57, s33, 0
s_sub_u32 s58, 1048576, s65
s_mov_b32 s59, 0x20000
v_lshrrev_b32 v8, 2, v1
v_lshlrev_b32 v8, 14, v8
v_and_b32 v9, 3, v1
v_lshrrev_b32 v10, 4, v1
v_xor_b32 v9, v9, v10
v_lshl_add_u32 v14, v9, 4, v8
v_and_b32 v8, 31, v1
v_bfe_u32 v9, v1, 2, 2
v_xor_b32 v9, s66, v9
v_lshlrev_b32 v9, 4, v9
v_lshl_add_u32 v9, v8, 6, v9
v_lshrrev_b32 v8, 5, v1
v_lshl_add_u32 v9, v8, 11, v9
v_add_u32 v15, 131072, v9
s_lshl_b32 s64, s66, 13
s_add_u32 s64, s64, 131072
v_add_u32 v16, s64, v2
s_xor_b32 s65, s64, 24576
s_cmp_eq_u32 s61, 1
s_cselect_b32 s65, s64, s65
v_add_u32 v17, s65, v2
v_add_u32 v18, s68, v2
v_mul_f32 v136, s63, v136
v_mul_f32 v137, s63, v137
v_mul_f32 v138, s63, v138
v_mul_f32 v139, s63, v139
v_mul_f32 v140, s63, v140
v_mul_f32 v141, s63, v141
v_mul_f32 v142, s63, v142
v_mul_f32 v143, s63, v143
v_mul_f32 v144, s63, v144
v_mul_f32 v145, s63, v145
v_mul_f32 v146, s63, v146
v_mul_f32 v147, s63, v147
v_mul_f32 v148, s63, v148
v_mul_f32 v149, s63, v149
v_mul_f32 v150, s63, v150
v_mul_f32 v151, s63, v151
v_mul_f32 v152, s63, v152
v_mul_f32 v153, s63, v153
v_mul_f32 v154, s63, v154
v_mul_f32 v155, s63, v155
v_mul_f32 v156, s63, v156
v_mul_f32 v157, s63, v157
v_mul_f32 v158, s63, v158
v_mul_f32 v159, s63, v159
v_mul_f32 v160, s63, v160
v_mul_f32 v161, s63, v161
v_mul_f32 v162, s63, v162
v_mul_f32 v163, s63, v163
v_mul_f32 v164, s63, v164
v_mul_f32 v165, s63, v165
v_mul_f32 v166, s63, v166
v_mul_f32 v167, s63, v167
s_waitcnt vmcnt(0)
v_mov_b32 v190, 3
s_mov_b64 exec, 1
ds_write_b32 v185, v190
s_mov_b64 exec, -1
s_cmp_lg_u32 s66, 0
s_cbranch_scc1 L_ph8
L_lc9:
ds_read_b128 v[186:189], v184
s_waitcnt lgkmcnt(0)
v_min3_u32 v186, v186, v187, v188
v_min_u32 v186, v186, v189
s_nop 0
v_readfirstlane_b32 s92, v186
s_nop 0
s_cmp_ge_u32 s92, 3
s_cbranch_scc1 L_lcd10
s_sleep 1
s_branch L_lc9
L_lcd10:
s_and_b32 s64, s2, 15
s_lshl_b32 s65, s64, 7
s_add_u32 s65, s65, 4096
s_add_u32 s90, s32, s65
s_addc_u32 s91, s33, 0
s_mov_b32 s65, 1
s_atomic_add s65, s[90:91], 0x0 glc
s_lshl_b32 s64, s64, 2
s_add_u32 s64, s64, 540672
v_lshl_add_u32 v20, v1, 7, s64
v_mov_b32 v21, s37
s_add_u32 s4, s32, s64
s_addc_u32 s5, s33, 0
s_and_b32 s64, s2, 31
s_lshl_b32 s64, s64, 7
s_add_u32 s64, s64, 540672
s_waitcnt lgkmcnt(0)
s_cmp_lg_u32 s65, 15
s_cbranch_scc1 L_sg11
s_atomic_swap s37, s[4:5], 0x0
s_atomic_swap s37, s[4:5], 0x80
s_atomic_swap s37, s[4:5], 0x100
s_atomic_swap s37, s[4:5], 0x180
s_atomic_swap s37, s[4:5], 0x200
s_atomic_swap s37, s[4:5], 0x280
s_atomic_swap s37, s[4:5], 0x300
s_atomic_swap s37, s[4:5], 0x380
s_atomic_swap s37, s[4:5], 0x400
s_atomic_swap s37, s[4:5], 0x480
s_atomic_swap s37, s[4:5], 0x500
s_atomic_swap s37, s[4:5], 0x580
s_atomic_swap s37, s[4:5], 0x600
s_atomic_swap s37, s[4:5], 0x680
s_atomic_swap s37, s[4:5], 0x700
s_atomic_swap s37, s[4:5], 0x780
s_atomic_swap s37, s[4:5], 0x800
s_atomic_swap s37, s[4:5], 0x880
s_atomic_swap s37, s[4:5], 0x900
s_atomic_swap s37, s[4:5], 0x980
s_atomic_swap s37, s[4:5], 0xa00
s_atomic_swap s37, s[4:5], 0xa80
s_atomic_swap s37, s[4:5], 0xb00
s_atomic_swap s37, s[4:5], 0xb80
s_atomic_swap s37, s[4:5], 0xc00
s_atomic_swap s37, s[4:5], 0xc80
s_atomic_swap s37, s[4:5], 0xd00
s_atomic_swap s37, s[4:5], 0xd80
s_atomic_swap s37, s[4:5], 0xe00
s_atomic_swap s37, s[4:5], 0xe80
s_atomic_swap s37, s[4:5], 0xf00
s_atomic_swap s37, s[4:5], 0xf80
s_waitcnt lgkmcnt(0)
L_sg11:
s_add_u32 s90, s32, s64
s_addc_u32 s91, s33, 0
s_mov_b32 s64, s37
s_mov_b32 s65, s37
s_mov_b32 s92, 0
s_branch L_sp12
L_nok13:
s_add_u32 s92, s92, 1
s_cmp_ge_u32 s92, 200000
s_cbranch_scc1 L_ph8
s_sleep 6
L_sp12:
s_load_dwordx16 s[4:19], s[90:91], 0x0 glc
s_waitcnt lgkmcnt(0)
s_cmp_eq_u64 s[4:5], s[64:65]
s_cbranch_scc0 L_nok13
s_cmp_eq_u64 s[6:7], s[64:65]
s_cbranch_scc0 L_nok13
s_cmp_eq_u64 s[8:9], s[64:65]
s_cbranch_scc0 L_nok13
s_cmp_eq_u64 s[10:11], s[64:65]
s_cbranch_scc0 L_nok13
s_cmp_eq_u64 s[12:13], s[64:65]
s_cbranch_scc0 L_nok13
s_cmp_eq_u64 s[14:15], s[64:65]
s_cbranch_scc0 L_nok13
s_cmp_eq_u64 s[16:17], s[64:65]
s_cbranch_scc0 L_nok13
s_cmp_eq_u64 s[18:19], s[64:65]
s_cbranch_scc0 L_nok13
L_ph8:
v_mov_b32 v190, 4
s_mov_b64 exec, 1
ds_write_b32 v185, v190
s_mov_b64 exec, -1
L_lc14:
ds_read_b128 v[186:189], v184
s_waitcnt lgkmcnt(0)
v_min3_u32 v186, v186, v187, v188
v_min_u32 v186, v186, v189
s_nop 0
v_readfirstlane_b32 s92, v186
s_nop 0
s_cmp_ge_u32 s92, 4
s_cbranch_scc1 L_lcd15
s_sleep 1
s_branch L_lc14
L_lcd15:
s_setprio 3
s_add_u32 m0, s68, 0
s_mov_b32 s64, 0
buffer_load_dwordx4 v14, s[52:55], s64 offen sc1 lds
s_add_u32 m0, s68, 1024
s_mov_b32 s64, 262144
buffer_load_dwordx4 v14, s[52:55], s64 offen sc1 lds
s_add_u32 m0, s68, 2048
s_mov_b32 s64, 524288
buffer_load_dwordx4 v14, s[52:55], s64 offen sc1 lds
s_add_u32 m0, s68, 3072
s_mov_b32 s64, 786432
buffer_load_dwordx4 v14, s[52:55], s64 offen sc1 lds
s_movk_i32 s64, 4096
buffer_load_dwordx4 v[104:107], v2, s[48:51], 0 offen offset:0 sc1
buffer_load_dwordx4 v[108:111], v2, s[48:51], 0 offen offset:1024 sc1
buffer_load_dwordx4 v[112:115], v2, s[48:51], 0 offen offset:2048 sc1
buffer_load_dwordx4 v[116:119], v2, s[48:51], 0 offen offset:3072 sc1
buffer_load_dwordx4 v[120:123], v2, s[48:51], s64 offen offset:0 sc1
buffer_load_dwordx4 v[124:127], v2, s[48:51], s64 offen offset:1024 sc1
buffer_load_dwordx4 v[128:131], v2, s[48:51], s64 offen offset:2048 sc1
buffer_load_dwordx4 v[132:135], v2, s[48:51], s64 offen offset:3072 sc1
s_waitcnt vmcnt(8)
v_mov_b32 v190, 5
s_mov_b64 exec, 1
ds_write_b32 v185, v190
s_mov_b64 exec, -1
L_lc16:
ds_read_b128 v[186:189], v184
s_waitcnt lgkmcnt(0)
v_min3_u32 v186, v186, v187, v188
v_min_u32 v186, v186, v189
s_nop 0
v_readfirstlane_b32 s92, v186
s_nop 0
s_cmp_ge_u32 s92, 5
s_cbranch_scc1 L_lcd17
s_sleep 1
s_branch L_lc16
L_lcd17:
ds_read_b128 v[72:75], v15 offset:0
ds_read_b128 v[76:79], v15 offset:4096
ds_read_b128 v[80:83], v15 offset:8192
ds_read_b128 v[84:87], v15 offset:12288
s_waitcnt lgkmcnt(0)
v_mov_b32 v190, 6
s_mov_b64 exec, 1
ds_write_b32 v185, v190
s_mov_b64 exec, -1
s_lshl_b32 s64, s61, 31
s_or_b32 s64, s64, s62
L_fft18:
v_xor_b32 v24, s64, v72
v_xor_b32 v25, s64, v73
v_xor_b32 v26, s64, v74
v_xor_b32 v27, s64, v75
v_xor_b32 v28, s64, v76
v_xor_b32 v29, s64, v77
v_xor_b32 v30, s64, v78
v_xor_b32 v31, s64, v79
v_xor_b32 v32, s64, v80
v_xor_b32 v33, s64, v81
v_xor_b32 v34, s64, v82
v_xor_b32 v35, s64, v83
v_xor_b32 v36, s64, v84
v_xor_b32 v37, s64, v85
v_xor_b32 v38, s64, v86
v_xor_b32 v39, s64, v87
v_mfma_f32_32x32x16_bf16 v[40:55], v[24:27], v[192:195], 0
v_mfma_f32_32x32x16_bf16 v[40:55], v[28:31], v[196:199], v[40:55]
v_mfma_f32_32x32x16_bf16 v[40:55], v[32:35], v[200:203], v[40:55]
v_mfma_f32_32x32x16_bf16 v[40:55], v[36:39], v[204:207], v[40:55]
v_mfma_f32_32x32x16_bf16 v[56:71], v[24:27], v[208:211], 0
v_mfma_f32_32x32x16_bf16 v[56:71], v[28:31], v[212:215], v[56:71]
v_mfma_f32_32x32x16_bf16 v[56:71], v[32:35], v[216:219], v[56:71]
v_mfma_f32_32x32x16_bf16 v[56:71], v[36:39], v[220:223], v[56:71]
s_nop 7
v_mul_f32 v168, v40, v224
v_mul_f32 v169, v40, v240
s_nop 1
v_fma_f32 v168, -v56, v240, v168
v_fmac_f32 v169, v56, v224
v_cvt_pk_bf16_f32 v24, v168, v169
v_mul_f32 v170, v41, v225
v_mul_f32 v171, v41, v241
v_fma_f32 v170, -v57, v241, v170
v_fmac_f32 v171, v57, v225
v_cvt_pk_bf16_f32 v25, v170, v171
v_mul_f32 v172, v42, v226
v_mul_f32 v173, v42, v242
v_fma_f32 v172, -v58, v242, v172
v_fmac_f32 v173, v58, v226
v_cvt_pk_bf16_f32 v26, v172, v173
v_mul_f32 v174, v43, v227
v_mul_f32 v175, v43, v243
v_fma_f32 v174, -v59, v243, v174
v_fmac_f32 v175, v59, v227
v_cvt_pk_bf16_f32 v27, v174, v175
v_mul_f32 v168, v44, v228
v_mul_f32 v169, v44, v244
v_fma_f32 v168, -v60, v244, v168
v_fmac_f32 v169, v60, v228
v_cvt_pk_bf16_f32 v28, v168, v169
v_mul_f32 v170, v45, v229
v_mul_f32 v171, v45, v245
v_fma_f32 v170, -v61, v245, v170
v_fmac_f32 v171, v61, v229
v_cvt_pk_bf16_f32 v29, v170, v171
v_mul_f32 v172, v46, v230
v_mul_f32 v173, v46, v246
v_fma_f32 v172, -v62, v246, v172
v_fmac_f32 v173, v62, v230
v_cvt_pk_bf16_f32 v30, v172, v173
v_mul_f32 v174, v47, v231
v_mul_f32 v175, v47, v247
v_fma_f32 v174, -v63, v247, v174
v_fmac_f32 v175, v63, v231
v_cvt_pk_bf16_f32 v31, v174, v175
v_mul_f32 v168, v48, v232
v_mul_f32 v169, v48, v248
v_fma_f32 v168, -v64, v248, v168
v_fmac_f32 v169, v64, v232
v_cvt_pk_bf16_f32 v32, v168, v169
v_mul_f32 v170, v49, v233
v_mul_f32 v171, v49, v249
v_fma_f32 v170, -v65, v249, v170
v_fmac_f32 v171, v65, v233
v_cvt_pk_bf16_f32 v33, v170, v171
v_mul_f32 v172, v50, v234
v_mul_f32 v173, v50, v250
v_fma_f32 v172, -v66, v250, v172
v_fmac_f32 v173, v66, v234
v_cvt_pk_bf16_f32 v34, v172, v173
v_mul_f32 v174, v51, v235
v_mul_f32 v175, v51, v251
v_fma_f32 v174, -v67, v251, v174
v_fmac_f32 v175, v67, v235
v_cvt_pk_bf16_f32 v35, v174, v175
v_mul_f32 v168, v52, v236
v_mul_f32 v169, v52, v252
v_fma_f32 v168, -v68, v252, v168
v_fmac_f32 v169, v68, v236
v_cvt_pk_bf16_f32 v36, v168, v169
v_mul_f32 v170, v53, v237
v_mul_f32 v171, v53, v253
v_fma_f32 v170, -v69, v253, v170
v_fmac_f32 v171, v69, v237
v_cvt_pk_bf16_f32 v37, v170, v171
v_mul_f32 v172, v54, v238
v_mul_f32 v173, v54, v254
v_fma_f32 v172, -v70, v254, v172
v_fmac_f32 v173, v70, v238
v_cvt_pk_bf16_f32 v38, v172, v173
v_mul_f32 v174, v55, v239
v_mul_f32 v175, v55, v255
v_fma_f32 v174, -v71, v255, v174
v_fmac_f32 v175, v71, v239
v_cvt_pk_bf16_f32 v39, v174, v175
v_mfma_f32_32x32x16_bf16 v[40:55], v[192:195], v[24:27], 0
v_mfma_f32_32x32x16_bf16 v[40:55], v[196:199], v[28:31], v[40:55]
v_mfma_f32_32x32x16_bf16 v[40:55], v[200:203], v[32:35], v[40:55]
v_mfma_f32_32x32x16_bf16 v[40:55], v[204:207], v[36:39], v[40:55]
v_mfma_f32_32x32x16_bf16 v[56:71], v[208:211], v[24:27], 0
v_mfma_f32_32x32x16_bf16 v[56:71], v[212:215], v[28:31], v[56:71]
v_mfma_f32_32x32x16_bf16 v[56:71], v[216:219], v[32:35], v[56:71]
v_mfma_f32_32x32x16_bf16 v[56:71], v[220:223], v[36:39], v[56:71]
L_lc20:
ds_read_b128 v[186:189], v184
s_waitcnt lgkmcnt(0)
v_min3_u32 v186, v186, v187, v188
v_min_u32 v186, v186, v189
s_nop 0
v_readfirstlane_b32 s92, v186
s_nop 0
s_cmp_ge_u32 s92, 6
s_cbranch_scc1 L_lcd21
s_sleep 1
s_branch L_lc20
L_lcd21:
s_cmp_eq_u32 s61, 2
s_cbranch_scc1 L_nwr19
ds_write_b128 v16, v[40:43] offset:0
ds_write_b128 v16, v[44:47] offset:1024
ds_write_b128 v16, v[48:51] offset:2048
ds_write_b128 v16, v[52:55] offset:3072
ds_write_b128 v16, v[56:59] offset:4096
ds_write_b128 v16, v[60:63] offset:5120
ds_write_b128 v16, v[64:67] offset:6144
ds_write_b128 v16, v[68:71] offset:7168
s_cmp_eq_u32 s61, 0
s_cbranch_scc1 L_nwr19
s_mov_b32 s61, 2
s_mov_b32 s64, 0
s_branch L_fft18
L_nwr19:
s_waitcnt lgkmcnt(0)
v_mov_b32 v190, 7
s_mov_b64 exec, 1
ds_write_b32 v185, v190
s_mov_b64 exec, -1
L_lc22:
ds_read_b128 v[186:189], v184
s_waitcnt lgkmcnt(0)
v_min3_u32 v186, v186, v187, v188
v_min_u32 v186, v186, v189
s_nop 0
v_readfirstlane_b32 s92, v186
s_nop 0
s_cmp_ge_u32 s92, 7
s_cbranch_scc1 L_lcd23
s_sleep 1
s_branch L_lc22
L_lcd23:
ds_read_b128 v[72:75], v17 offset:0
ds_read_b128 v[76:79], v17 offset:1024
ds_read_b128 v[80:83], v17 offset:2048
ds_read_b128 v[84:87], v17 offset:3072
ds_read_b128 v[88:91], v17 offset:4096
ds_read_b128 v[92:95], v17 offset:5120
ds_read_b128 v[96:99], v17 offset:6144
ds_read_b128 v[100:103], v17 offset:7168
s_waitcnt vmcnt(0) lgkmcnt(0)
v_mov_b32 v190, 8
s_mov_b64 exec, 1
ds_write_b32 v185, v190
s_mov_b64 exec, -1
v_lshlrev_b32 v168, 16, v104
v_and_b32 v169, 0xffff0000, v104
v_lshlrev_b32 v170, 16, v105
v_and_b32 v171, 0xffff0000, v105
v_add_f32 v172, v168, v170
v_add_f32 v173, v169, v171
v_sub_f32 v168, v168, v170
v_sub_f32 v169, v169, v171
v_mul_f32 v170, v152, v40
v_mul_f32 v171, v152, v56
v_mul_f32 v174, v172, v40
v_mul_f32 v175, v172, v56
v_fma_f32 v170, -v136, v88, v170
v_fmac_f32 v171, v136, v72
v_fma_f32 v174, -v173, v56, v174
v_fmac_f32 v175, v173, v40
v_fmac_f32 v174, v168, v170
v_fmac_f32 v175, v168, v171
v_fma_f32 v174, -v169, v171, v174
v_fmac_f32 v175, v169, v170
v_cvt_pk_bf16_f32 v24, v175, v174
v_lshlrev_b32 v176, 16, v106
v_and_b32 v177, 0xffff0000, v106
v_lshlrev_b32 v178, 16, v107
v_and_b32 v179, 0xffff0000, v107
v_add_f32 v180, v176, v178
v_add_f32 v181, v177, v179
v_sub_f32 v176, v176, v178
v_sub_f32 v177, v177, v179
v_mul_f32 v178, v153, v41
v_mul_f32 v179, v153, v57
v_mul_f32 v182, v180, v41
v_mul_f32 v183, v180, v57
v_fma_f32 v178, -v137, v89, v178
v_fmac_f32 v179, v137, v73
v_fma_f32 v182, -v181, v57, v182
v_fmac_f32 v183, v181, v41
v_fmac_f32 v182, v176, v178
v_fmac_f32 v183, v176, v179
v_fma_f32 v182, -v177, v179, v182
v_fmac_f32 v183, v177, v178
v_cvt_pk_bf16_f32 v25, v183, v182
v_lshlrev_b32 v168, 16, v108
v_and_b32 v169, 0xffff0000, v108
v_lshlrev_b32 v170, 16, v109
v_and_b32 v171, 0xffff0000, v109
v_add_f32 v172, v168, v170
v_add_f32 v173, v169, v171
v_sub_f32 v168, v168, v170
v_sub_f32 v169, v169, v171
v_mul_f32 v170, v154, v42
v_mul_f32 v171, v154, v58
v_mul_f32 v174, v172, v42
v_mul_f32 v175, v172, v58
v_fma_f32 v170, -v138, v90, v170
v_fmac_f32 v171, v138, v74
v_fma_f32 v174, -v173, v58, v174
v_fmac_f32 v175, v173, v42
v_fmac_f32 v174, v168, v170
v_fmac_f32 v175, v168, v171
v_fma_f32 v174, -v169, v171, v174
v_fmac_f32 v175, v169, v170
v_cvt_pk_bf16_f32 v26, v175, v174
v_lshlrev_b32 v176, 16, v110
v_and_b32 v177, 0xffff0000, v110
v_lshlrev_b32 v178, 16, v111
v_and_b32 v179, 0xffff0000, v111
v_add_f32 v180, v176, v178
v_add_f32 v181, v177, v179
v_sub_f32 v176, v176, v178
v_sub_f32 v177, v177, v179
v_mul_f32 v178, v155, v43
v_mul_f32 v179, v155, v59
v_mul_f32 v182, v180, v43
v_mul_f32 v183, v180, v59
v_fma_f32 v178, -v139, v91, v178
v_fmac_f32 v179, v139, v75
v_fma_f32 v182, -v181, v59, v182
v_fmac_f32 v183, v181, v43
v_fmac_f32 v182, v176, v178
v_fmac_f32 v183, v176, v179
v_fma_f32 v182, -v177, v179, v182
v_fmac_f32 v183, v177, v178
v_cvt_pk_bf16_f32 v27, v183, v182
v_lshlrev_b32 v168, 16, v112
v_and_b32 v169, 0xffff0000, v112
v_lshlrev_b32 v170, 16, v113
v_and_b32 v171, 0xffff0000, v113
v_add_f32 v172, v168, v170
v_add_f32 v173, v169, v171
v_sub_f32 v168, v168, v170
v_sub_f32 v169, v169, v171
v_mul_f32 v170, v156, v44
v_mul_f32 v171, v156, v60
v_mul_f32 v174, v172, v44
v_mul_f32 v175, v172, v60
v_fma_f32 v170, -v140, v92, v170
v_fmac_f32 v171, v140, v76
v_fma_f32 v174, -v173, v60, v174
v_fmac_f32 v175, v173, v44
v_fmac_f32 v174, v168, v170
v_fmac_f32 v175, v168, v171
v_fma_f32 v174, -v169, v171, v174
v_fmac_f32 v175, v169, v170
v_cvt_pk_bf16_f32 v28, v175, v174
v_lshlrev_b32 v176, 16, v114
v_and_b32 v177, 0xffff0000, v114
v_lshlrev_b32 v178, 16, v115
v_and_b32 v179, 0xffff0000, v115
v_add_f32 v180, v176, v178
v_add_f32 v181, v177, v179
v_sub_f32 v176, v176, v178
v_sub_f32 v177, v177, v179
v_mul_f32 v178, v157, v45
v_mul_f32 v179, v157, v61
v_mul_f32 v182, v180, v45
v_mul_f32 v183, v180, v61
v_fma_f32 v178, -v141, v93, v178
v_fmac_f32 v179, v141, v77
v_fma_f32 v182, -v181, v61, v182
v_fmac_f32 v183, v181, v45
v_fmac_f32 v182, v176, v178
v_fmac_f32 v183, v176, v179
v_fma_f32 v182, -v177, v179, v182
v_fmac_f32 v183, v177, v178
v_cvt_pk_bf16_f32 v29, v183, v182
v_lshlrev_b32 v168, 16, v116
v_and_b32 v169, 0xffff0000, v116
v_lshlrev_b32 v170, 16, v117
v_and_b32 v171, 0xffff0000, v117
v_add_f32 v172, v168, v170
v_add_f32 v173, v169, v171
v_sub_f32 v168, v168, v170
v_sub_f32 v169, v169, v171
v_mul_f32 v170, v158, v46
v_mul_f32 v171, v158, v62
v_mul_f32 v174, v172, v46
v_mul_f32 v175, v172, v62
v_fma_f32 v170, -v142, v94, v170
v_fmac_f32 v171, v142, v78
v_fma_f32 v174, -v173, v62, v174
v_fmac_f32 v175, v173, v46
v_fmac_f32 v174, v168, v170
v_fmac_f32 v175, v168, v171
v_fma_f32 v174, -v169, v171, v174
v_fmac_f32 v175, v169, v170
v_cvt_pk_bf16_f32 v30, v175, v174
v_lshlrev_b32 v176, 16, v118
v_and_b32 v177, 0xffff0000, v118
v_lshlrev_b32 v178, 16, v119
v_and_b32 v179, 0xffff0000, v119
v_add_f32 v180, v176, v178
v_add_f32 v181, v177, v179
v_sub_f32 v176, v176, v178
v_sub_f32 v177, v177, v179
v_mul_f32 v178, v159, v47
v_mul_f32 v179, v159, v63
v_mul_f32 v182, v180, v47
v_mul_f32 v183, v180, v63
v_fma_f32 v178, -v143, v95, v178
v_fmac_f32 v179, v143, v79
v_fma_f32 v182, -v181, v63, v182
v_fmac_f32 v183, v181, v47
v_fmac_f32 v182, v176, v178
v_fmac_f32 v183, v176, v179
v_fma_f32 v182, -v177, v179, v182
v_fmac_f32 v183, v177, v178
v_cvt_pk_bf16_f32 v31, v183, v182
v_lshlrev_b32 v168, 16, v120
v_and_b32 v169, 0xffff0000, v120
v_lshlrev_b32 v170, 16, v121
v_and_b32 v171, 0xffff0000, v121
v_add_f32 v172, v168, v170
v_add_f32 v173, v169, v171
v_sub_f32 v168, v168, v170
v_sub_f32 v169, v169, v171
v_mul_f32 v170, v160, v48
v_mul_f32 v171, v160, v64
v_mul_f32 v174, v172, v48
v_mul_f32 v175, v172, v64
v_fma_f32 v170, -v144, v96, v170
v_fmac_f32 v171, v144, v80
v_fma_f32 v174, -v173, v64, v174
v_fmac_f32 v175, v173, v48
v_fmac_f32 v174, v168, v170
v_fmac_f32 v175, v168, v171
v_fma_f32 v174, -v169, v171, v174
v_fmac_f32 v175, v169, v170
v_cvt_pk_bf16_f32 v32, v175, v174
v_lshlrev_b32 v176, 16, v122
v_and_b32 v177, 0xffff0000, v122
v_lshlrev_b32 v178, 16, v123
v_and_b32 v179, 0xffff0000, v123
v_add_f32 v180, v176, v178
v_add_f32 v181, v177, v179
v_sub_f32 v176, v176, v178
v_sub_f32 v177, v177, v179
v_mul_f32 v178, v161, v49
v_mul_f32 v179, v161, v65
v_mul_f32 v182, v180, v49
v_mul_f32 v183, v180, v65
v_fma_f32 v178, -v145, v97, v178
v_fmac_f32 v179, v145, v81
v_fma_f32 v182, -v181, v65, v182
v_fmac_f32 v183, v181, v49
v_fmac_f32 v182, v176, v178
v_fmac_f32 v183, v176, v179
v_fma_f32 v182, -v177, v179, v182
v_fmac_f32 v183, v177, v178
v_cvt_pk_bf16_f32 v33, v183, v182
v_lshlrev_b32 v168, 16, v124
v_and_b32 v169, 0xffff0000, v124
v_lshlrev_b32 v170, 16, v125
v_and_b32 v171, 0xffff0000, v125
v_add_f32 v172, v168, v170
v_add_f32 v173, v169, v171
v_sub_f32 v168, v168, v170
v_sub_f32 v169, v169, v171
v_mul_f32 v170, v162, v50
v_mul_f32 v171, v162, v66
v_mul_f32 v174, v172, v50
v_mul_f32 v175, v172, v66
v_fma_f32 v170, -v146, v98, v170
v_fmac_f32 v171, v146, v82
v_fma_f32 v174, -v173, v66, v174
v_fmac_f32 v175, v173, v50
v_fmac_f32 v174, v168, v170
v_fmac_f32 v175, v168, v171
v_fma_f32 v174, -v169, v171, v174
v_fmac_f32 v175, v169, v170
v_cvt_pk_bf16_f32 v34, v175, v174
v_lshlrev_b32 v176, 16, v126
v_and_b32 v177, 0xffff0000, v126
v_lshlrev_b32 v178, 16, v127
v_and_b32 v179, 0xffff0000, v127
v_add_f32 v180, v176, v178
v_add_f32 v181, v177, v179
v_sub_f32 v176, v176, v178
v_sub_f32 v177, v177, v179
v_mul_f32 v178, v163, v51
v_mul_f32 v179, v163, v67
v_mul_f32 v182, v180, v51
v_mul_f32 v183, v180, v67
v_fma_f32 v178, -v147, v99, v178
v_fmac_f32 v179, v147, v83
v_fma_f32 v182, -v181, v67, v182
v_fmac_f32 v183, v181, v51
v_fmac_f32 v182, v176, v178
v_fmac_f32 v183, v176, v179
v_fma_f32 v182, -v177, v179, v182
v_fmac_f32 v183, v177, v178
v_cvt_pk_bf16_f32 v35, v183, v182
v_lshlrev_b32 v168, 16, v128
v_and_b32 v169, 0xffff0000, v128
v_lshlrev_b32 v170, 16, v129
v_and_b32 v171, 0xffff0000, v129
v_add_f32 v172, v168, v170
v_add_f32 v173, v169, v171
v_sub_f32 v168, v168, v170
v_sub_f32 v169, v169, v171
v_mul_f32 v170, v164, v52
v_mul_f32 v171, v164, v68
v_mul_f32 v174, v172, v52
v_mul_f32 v175, v172, v68
v_fma_f32 v170, -v148, v100, v170
v_fmac_f32 v171, v148, v84
v_fma_f32 v174, -v173, v68, v174
v_fmac_f32 v175, v173, v52
v_fmac_f32 v174, v168, v170
v_fmac_f32 v175, v168, v171
v_fma_f32 v174, -v169, v171, v174
v_fmac_f32 v175, v169, v170
v_cvt_pk_bf16_f32 v36, v175, v174
v_lshlrev_b32 v176, 16, v130
v_and_b32 v177, 0xffff0000, v130
v_lshlrev_b32 v178, 16, v131
v_and_b32 v179, 0xffff0000, v131
v_add_f32 v180, v176, v178
v_add_f32 v181, v177, v179
v_sub_f32 v176, v176, v178
v_sub_f32 v177, v177, v179
v_mul_f32 v178, v165, v53
v_mul_f32 v179, v165, v69
v_mul_f32 v182, v180, v53
v_mul_f32 v183, v180, v69
v_fma_f32 v178, -v149, v101, v178
v_fmac_f32 v179, v149, v85
v_fma_f32 v182, -v181, v69, v182
v_fmac_f32 v183, v181, v53
v_fmac_f32 v182, v176, v178
v_fmac_f32 v183, v176, v179
v_fma_f32 v182, -v177, v179, v182
v_fmac_f32 v183, v177, v178
v_cvt_pk_bf16_f32 v37, v183, v182
v_lshlrev_b32 v168, 16, v132
v_and_b32 v169, 0xffff0000, v132
v_lshlrev_b32 v170, 16, v133
v_and_b32 v171, 0xffff0000, v133
v_add_f32 v172, v168, v170
v_add_f32 v173, v169, v171
v_sub_f32 v168, v168, v170
v_sub_f32 v169, v169, v171
v_mul_f32 v170, v166, v54
v_mul_f32 v171, v166, v70
v_mul_f32 v174, v172, v54
v_mul_f32 v175, v172, v70
v_fma_f32 v170, -v150, v102, v170
v_fmac_f32 v171, v150, v86
v_fma_f32 v174, -v173, v70, v174
v_fmac_f32 v175, v173, v54
v_fmac_f32 v174, v168, v170
v_fmac_f32 v175, v168, v171
v_fma_f32 v174, -v169, v171, v174
v_fmac_f32 v175, v169, v170
v_cvt_pk_bf16_f32 v38, v175, v174
v_lshlrev_b32 v176, 16, v134
v_and_b32 v177, 0xffff0000, v134
v_lshlrev_b32 v178, 16, v135
v_and_b32 v179, 0xffff0000, v135
v_add_f32 v180, v176, v178
v_add_f32 v181, v177, v179
v_sub_f32 v176, v176, v178
v_sub_f32 v177, v177, v179
v_mul_f32 v178, v167, v55
v_mul_f32 v179, v167, v71
v_mul_f32 v182, v180, v55
v_mul_f32 v183, v180, v71
v_fma_f32 v178, -v151, v103, v178
v_fmac_f32 v179, v151, v87
v_fma_f32 v182, -v181, v71, v182
v_fmac_f32 v183, v181, v55
v_fmac_f32 v182, v176, v178
v_fmac_f32 v183, v176, v179
v_fma_f32 v182, -v177, v179, v182
v_fmac_f32 v183, v177, v178
v_cvt_pk_bf16_f32 v39, v183, v182
v_mfma_f32_32x32x16_bf16 v[40:55], v[24:27], v[192:195], 0
v_mfma_f32_32x32x16_bf16 v[40:55], v[28:31], v[196:199], v[40:55]
v_mfma_f32_32x32x16_bf16 v[40:55], v[32:35], v[200:203], v[40:55]
v_mfma_f32_32x32x16_bf16 v[40:55], v[36:39], v[204:207], v[40:55]
v_mfma_f32_32x32x16_bf16 v[56:71], v[24:27], v[208:211], 0
v_mfma_f32_32x32x16_bf16 v[56:71], v[28:31], v[212:215], v[56:71]
v_mfma_f32_32x32x16_bf16 v[56:71], v[32:35], v[216:219], v[56:71]
v_mfma_f32_32x32x16_bf16 v[56:71], v[36:39], v[220:223], v[56:71]
s_nop 7
v_mul_f32 v168, v40, v224
v_mul_f32 v169, v40, v240
s_nop 1
v_fma_f32 v168, -v56, v240, v168
v_fmac_f32 v169, v56, v224
v_cvt_pk_bf16_f32 v24, v168, v169
v_mul_f32 v170, v41, v225
v_mul_f32 v171, v41, v241
v_fma_f32 v170, -v57, v241, v170
v_fmac_f32 v171, v57, v225
v_cvt_pk_bf16_f32 v25, v170, v171
v_mul_f32 v172, v42, v226
v_mul_f32 v173, v42, v242
v_fma_f32 v172, -v58, v242, v172
v_fmac_f32 v173, v58, v226
v_cvt_pk_bf16_f32 v26, v172, v173
v_mul_f32 v174, v43, v227
v_mul_f32 v175, v43, v243
v_fma_f32 v174, -v59, v243, v174
v_fmac_f32 v175, v59, v227
v_cvt_pk_bf16_f32 v27, v174, v175
v_mul_f32 v168, v44, v228
v_mul_f32 v169, v44, v244
v_fma_f32 v168, -v60, v244, v168
v_fmac_f32 v169, v60, v228
v_cvt_pk_bf16_f32 v28, v168, v169
v_mul_f32 v170, v45, v229
v_mul_f32 v171, v45, v245
v_fma_f32 v170, -v61, v245, v170
v_fmac_f32 v171, v61, v229
v_cvt_pk_bf16_f32 v29, v170, v171
v_mul_f32 v172, v46, v230
v_mul_f32 v173, v46, v246
v_fma_f32 v172, -v62, v246, v172
v_fmac_f32 v173, v62, v230
v_cvt_pk_bf16_f32 v30, v172, v173
v_mul_f32 v174, v47, v231
v_mul_f32 v175, v47, v247
v_fma_f32 v174, -v63, v247, v174
v_fmac_f32 v175, v63, v231
v_cvt_pk_bf16_f32 v31, v174, v175
v_mul_f32 v168, v48, v232
v_mul_f32 v169, v48, v248
v_fma_f32 v168, -v64, v248, v168
v_fmac_f32 v169, v64, v232
v_cvt_pk_bf16_f32 v32, v168, v169
v_mul_f32 v170, v49, v233
v_mul_f32 v171, v49, v249
v_fma_f32 v170, -v65, v249, v170
v_fmac_f32 v171, v65, v233
v_cvt_pk_bf16_f32 v33, v170, v171
v_mul_f32 v172, v50, v234
v_mul_f32 v173, v50, v250
v_fma_f32 v172, -v66, v250, v172
v_fmac_f32 v173, v66, v234
v_cvt_pk_bf16_f32 v34, v172, v173
v_mul_f32 v174, v51, v235
v_mul_f32 v175, v51, v251
v_fma_f32 v174, -v67, v251, v174
v_fmac_f32 v175, v67, v235
v_cvt_pk_bf16_f32 v35, v174, v175
v_mul_f32 v168, v52, v236
v_mul_f32 v169, v52, v252
v_fma_f32 v168, -v68, v252, v168
v_fmac_f32 v169, v68, v236
v_cvt_pk_bf16_f32 v36, v168, v169
v_mul_f32 v170, v53, v237
v_mul_f32 v171, v53, v253
v_fma_f32 v170, -v69, v253, v170
v_fmac_f32 v171, v69, v237
v_cvt_pk_bf16_f32 v37, v170, v171
v_mul_f32 v172, v54, v238
v_mul_f32 v173, v54, v254
v_fma_f32 v172, -v70, v254, v172
v_fmac_f32 v173, v70, v238
v_cvt_pk_bf16_f32 v38, v172, v173
v_mul_f32 v174, v55, v239
v_mul_f32 v175, v55, v255
v_fma_f32 v174, -v71, v255, v174
v_fmac_f32 v175, v71, v239
v_cvt_pk_bf16_f32 v39, v174, v175
v_mfma_f32_32x32x16_bf16 v[40:55], v[192:195], v[24:27], 0
v_mfma_f32_32x32x16_bf16 v[40:55], v[196:199], v[28:31], v[40:55]
v_mfma_f32_32x32x16_bf16 v[40:55], v[200:203], v[32:35], v[40:55]
v_mfma_f32_32x32x16_bf16 v[40:55], v[204:207], v[36:39], v[40:55]
v_mfma_f32_32x32x16_bf16 v[56:71], v[208:211], v[24:27], 0
v_mfma_f32_32x32x16_bf16 v[56:71], v[212:215], v[28:31], v[56:71]
v_mfma_f32_32x32x16_bf16 v[56:71], v[216:219], v[32:35], v[56:71]
v_mfma_f32_32x32x16_bf16 v[56:71], v[220:223], v[36:39], v[56:71]
s_lshr_b32 s64, s62, 16
L_lc24:
ds_read_b128 v[186:189], v184
s_waitcnt lgkmcnt(0)
v_min3_u32 v186, v186, v187, v188
v_min_u32 v186, v186, v189
s_nop 0
v_readfirstlane_b32 s92, v186
s_nop 0
s_cmp_ge_u32 s92, 8
s_cbranch_scc1 L_lcd25
s_sleep 1
s_branch L_lc24
L_lcd25:
s_nop 1
v_cvt_pk_bf16_f32 v24, v40, v56
v_xor_b32 v24, s64, v24
v_cvt_pk_bf16_f32 v25, v41, v57
v_xor_b32 v25, s64, v25
v_cvt_pk_bf16_f32 v26, v42, v58
v_xor_b32 v26, s64, v26
v_cvt_pk_bf16_f32 v27, v43, v59
v_xor_b32 v27, s64, v27
ds_write_b128 v15, v[24:27] offset:0
v_cvt_pk_bf16_f32 v28, v44, v60
v_xor_b32 v28, s64, v28
v_cvt_pk_bf16_f32 v29, v45, v61
v_xor_b32 v29, s64, v29
v_cvt_pk_bf16_f32 v30, v46, v62
v_xor_b32 v30, s64, v30
v_cvt_pk_bf16_f32 v31, v47, v63
v_xor_b32 v31, s64, v31
ds_write_b128 v15, v[28:31] offset:4096
v_cvt_pk_bf16_f32 v32, v48, v64
v_xor_b32 v32, s64, v32
v_cvt_pk_bf16_f32 v33, v49, v65
v_xor_b32 v33, s64, v33
v_cvt_pk_bf16_f32 v34, v50, v66
v_xor_b32 v34, s64, v34
v_cvt_pk_bf16_f32 v35, v51, v67
v_xor_b32 v35, s64, v35
ds_write_b128 v15, v[32:35] offset:8192
v_cvt_pk_bf16_f32 v36, v52, v68
v_xor_b32 v36, s64, v36
v_cvt_pk_bf16_f32 v37, v53, v69
v_xor_b32 v37, s64, v37
v_cvt_pk_bf16_f32 v38, v54, v70
v_xor_b32 v38, s64, v38
v_cvt_pk_bf16_f32 v39, v55, v71
v_xor_b32 v39, s64, v39
ds_write_b128 v15, v[36:39] offset:12288
s_waitcnt lgkmcnt(0)
v_mov_b32 v190, 9
s_mov_b64 exec, 1
ds_write_b32 v185, v190
s_mov_b64 exec, -1
L_lc26:
ds_read_b128 v[186:189], v184
s_waitcnt lgkmcnt(0)
v_min3_u32 v186, v186, v187, v188
v_min_u32 v186, v186, v189
s_nop 0
v_readfirstlane_b32 s92, v186
s_nop 0
s_cmp_ge_u32 s92, 9
s_cbranch_scc1 L_lcd27
s_sleep 1
s_branch L_lc26
L_lcd27:
ds_read_b128 v[24:27], v18 offset:0
ds_read_b128 v[28:31], v18 offset:1024
ds_read_b128 v[32:35], v18 offset:2048
ds_read_b128 v[36:39], v18 offset:3072
s_mov_b32 s64, 0
s_waitcnt lgkmcnt(3)
buffer_store_dwordx4 v[24:27], v14, s[56:59], s64 offen sc1
s_mov_b32 s64, 262144
s_waitcnt lgkmcnt(2)
buffer_store_dwordx4 v[28:31], v14, s[56:59], s64 offen sc1
s_mov_b32 s64, 524288
s_waitcnt lgkmcnt(1)
buffer_store_dwordx4 v[32:35], v14, s[56:59], s64 offen sc1
s_mov_b32 s64, 786432
s_waitcnt lgkmcnt(0)
buffer_store_dwordx4 v[36:39], v14, s[56:59], s64 offen sc1
s_lshl_b32 s64, s67, 14
s_add_u32 s40, s28, s64
s_addc_u32 s41, s29, 0
s_mov_b32 s42, 16384
s_mov_b32 s43, 0x20000
v_and_b32 v8, 31, v1
v_lshrrev_b32 v9, 5, v1
v_lshlrev_b32 v14, 2, v8
v_lshl_add_u32 v14, v9, 9, v14
s_mov_b32 s64, 0x35000000
v_mul_f32 v224, s64, v224
v_mul_f32 v225, s64, v225
v_mul_f32 v226, s64, v226
v_mul_f32 v227, s64, v227
v_mul_f32 v228, s64, v228
v_mul_f32 v229, s64, v229
v_mul_f32 v230, s64, v230
v_mul_f32 v231, s64, v231
v_mul_f32 v232, s64, v232
v_mul_f32 v233, s64, v233
v_mul_f32 v234, s64, v234
v_mul_f32 v235, s64, v235
v_mul_f32 v236, s64, v236
v_mul_f32 v237, s64, v237
v_mul_f32 v238, s64, v238
v_mul_f32 v239, s64, v239
v_mul_f32 v240, s64, v240
v_mul_f32 v241, s64, v241
v_mul_f32 v242, s64, v242
v_mul_f32 v243, s64, v243
v_mul_f32 v244, s64, v244
v_mul_f32 v245, s64, v245
v_mul_f32 v246, s64, v246
v_mul_f32 v247, s64, v247
v_mul_f32 v248, s64, v248
v_mul_f32 v249, s64, v249
v_mul_f32 v250, s64, v250
v_mul_f32 v251, s64, v251
v_mul_f32 v252, s64, v252
v_mul_f32 v253, s64, v253
v_mul_f32 v254, s64, v254
v_mul_f32 v255, s64, v255
s_waitcnt vmcnt(0)
v_mov_b32 v190, 10
s_mov_b64 exec, 1
ds_write_b32 v185, v190
s_mov_b64 exec, -1
s_cmp_lg_u32 s66, 0
s_cbranch_scc1 L_ph28
L_lc29:
ds_read_b128 v[186:189], v184
s_waitcnt lgkmcnt(0)
v_min3_u32 v186, v186, v187, v188
v_min_u32 v186, v186, v189
s_nop 0
v_readfirstlane_b32 s92, v186
s_nop 0
s_cmp_ge_u32 s92, 10
s_cbranch_scc1 L_lcd30
s_sleep 1
s_branch L_lc29
L_lcd30:
s_and_b32 s64, s2, 15
s_lshl_b32 s65, s64, 7
s_add_u32 s65, s65, 6144
s_add_u32 s90, s32, s65
s_addc_u32 s91, s33, 0
s_mov_b32 s65, 1
s_atomic_add s65, s[90:91], 0x0 glc
s_lshl_b32 s64, s64, 2
s_add_u32 s64, s64, 548864
v_lshl_add_u32 v20, v1, 7, s64
v_mov_b32 v21, s37
s_add_u32 s4, s32, s64
s_addc_u32 s5, s33, 0
s_and_b32 s64, s2, 31
s_lshl_b32 s64, s64, 7
s_add_u32 s64, s64, 548864
s_waitcnt lgkmcnt(0)
s_cmp_lg_u32 s65, 15
s_cbranch_scc1 L_sg31
s_atomic_swap s37, s[4:5], 0x0
s_atomic_swap s37, s[4:5], 0x80
s_atomic_swap s37, s[4:5], 0x100
s_atomic_swap s37, s[4:5], 0x180
s_atomic_swap s37, s[4:5], 0x200
s_atomic_swap s37, s[4:5], 0x280
s_atomic_swap s37, s[4:5], 0x300
s_atomic_swap s37, s[4:5], 0x380
s_atomic_swap s37, s[4:5], 0x400
s_atomic_swap s37, s[4:5], 0x480
s_atomic_swap s37, s[4:5], 0x500
s_atomic_swap s37, s[4:5], 0x580
s_atomic_swap s37, s[4:5], 0x600
s_atomic_swap s37, s[4:5], 0x680
s_atomic_swap s37, s[4:5], 0x700
s_atomic_swap s37, s[4:5], 0x780
s_atomic_swap s37, s[4:5], 0x800
s_atomic_swap s37, s[4:5], 0x880
s_atomic_swap s37, s[4:5], 0x900
s_atomic_swap s37, s[4:5], 0x980
s_atomic_swap s37, s[4:5], 0xa00
s_atomic_swap s37, s[4:5], 0xa80
s_atomic_swap s37, s[4:5], 0xb00
s_atomic_swap s37, s[4:5], 0xb80
s_atomic_swap s37, s[4:5], 0xc00
s_atomic_swap s37, s[4:5], 0xc80
s_atomic_swap s37, s[4:5], 0xd00
s_atomic_swap s37, s[4:5], 0xd80
s_atomic_swap s37, s[4:5], 0xe00
s_atomic_swap s37, s[4:5], 0xe80
s_atomic_swap s37, s[4:5], 0xf00
s_atomic_swap s37, s[4:5], 0xf80
s_waitcnt lgkmcnt(0)
L_sg31:
s_add_u32 s90, s32, s64
s_addc_u32 s91, s33, 0
s_mov_b32 s64, s37
s_mov_b32 s65, s37
s_mov_b32 s92, 0
s_branch L_sp32
L_nok33:
s_add_u32 s92, s92, 1
s_cmp_ge_u32 s92, 200000
s_cbranch_scc1 L_ph28
s_sleep 6
L_sp32:
s_load_dwordx16 s[4:19], s[90:91], 0x0 glc
s_waitcnt lgkmcnt(0)
s_cmp_eq_u64 s[4:5], s[64:65]
s_cbranch_scc0 L_nok33
s_cmp_eq_u64 s[6:7], s[64:65]
s_cbranch_scc0 L_nok33
s_cmp_eq_u64 s[8:9], s[64:65]
s_cbranch_scc0 L_nok33
s_cmp_eq_u64 s[10:11], s[64:65]
s_cbranch_scc0 L_nok33
s_cmp_eq_u64 s[12:13], s[64:65]
s_cbranch_scc0 L_nok33
s_cmp_eq_u64 s[14:15], s[64:65]
s_cbranch_scc0 L_nok33
s_cmp_eq_u64 s[16:17], s[64:65]
s_cbranch_scc0 L_nok33
s_cmp_eq_u64 s[18:19], s[64:65]
s_cbranch_scc0 L_nok33
L_ph28:
v_mov_b32 v190, 11
s_mov_b64 exec, 1
ds_write_b32 v185, v190
s_mov_b64 exec, -1
L_lc34:
ds_read_b128 v[186:189], v184
s_waitcnt lgkmcnt(0)
v_min3_u32 v186, v186, v187, v188
v_min_u32 v186, v186, v189
s_nop 0
v_readfirstlane_b32 s92, v186
s_nop 0
s_cmp_ge_u32 s92, 11
s_cbranch_scc1 L_lcd35
s_sleep 1
s_branch L_lc34
L_lcd35:
s_setprio 3
s_mov_b32 m0, s68
s_nop 0
buffer_load_dwordx4 v7, s[44:47], 0 offen offset:0 sc1 lds
buffer_load_dwordx4 v7, s[44:47], 0 offen offset:1024 sc1 lds
buffer_load_dwordx4 v7, s[44:47], 0 offen offset:2048 sc1 lds
buffer_load_dwordx4 v7, s[44:47], 0 offen offset:3072 sc1 lds
s_waitcnt vmcnt(0)
v_mov_b32 v190, 12
s_mov_b64 exec, 1
ds_write_b32 v185, v190
s_mov_b64 exec, -1
L_lc36:
ds_read_b128 v[186:189], v184
s_waitcnt lgkmcnt(0)
v_min3_u32 v186, v186, v187, v188
v_min_u32 v186, v186, v189
s_nop 0
v_readfirstlane_b32 s92, v186
s_nop 0
s_cmp_ge_u32 s92, 12
s_cbranch_scc1 L_lcd37
s_sleep 1
s_branch L_lc36
L_lcd37:
ds_read_b32 v24, v4 offset:0
ds_read_b32 v25, v4 offset:1024
ds_read_b32 v26, v4 offset:2048
ds_read_b32 v27, v4 offset:3072
ds_read_b32 v28, v4 offset:8192
ds_read_b32 v29, v4 offset:9216
ds_read_b32 v30, v4 offset:10240
ds_read_b32 v31, v4 offset:11264
ds_read_b32 v32, v6 offset:0
ds_read_b32 v33, v5 offset:10240
ds_read_b32 v34, v5 offset:9216
ds_read_b32 v35, v5 offset:8192
ds_read_b32 v36, v5 offset:3072
ds_read_b32 v37, v5 offset:2048
ds_read_b32 v38, v5 offset:1024
ds_read_b32 v39, v5 offset:0
s_waitcnt lgkmcnt(0)
v_mfma_f32_32x32x16_bf16 v[40:55], v[24:27], v[192:195], 0
v_mfma_f32_32x32x16_bf16 v[40:55], v[28:31], v[196:199], v[40:55]
v_mfma_f32_32x32x16_bf16 v[40:55], v[32:35], v[200:203], v[40:55]
v_mfma_f32_32x32x16_bf16 v[40:55], v[36:39], v[204:207], v[40:55]
v_mfma_f32_32x32x16_bf16 v[56:71], v[24:27], v[208:211], 0
v_mfma_f32_32x32x16_bf16 v[56:71], v[28:31], v[212:215], v[56:71]
v_mfma_f32_32x32x16_bf16 v[56:71], v[32:35], v[216:219], v[56:71]
v_mfma_f32_32x32x16_bf16 v[56:71], v[36:39], v[220:223], v[56:71]
s_nop 7
v_mul_f32 v168, v40, v224
v_mul_f32 v169, v40, v240
s_nop 1
v_fma_f32 v168, -v56, v240, v168
v_fmac_f32 v169, v56, v224
v_cvt_pk_bf16_f32 v24, v168, v169
v_mul_f32 v170, v41, v225
v_mul_f32 v171, v41, v241
v_fma_f32 v170, -v57, v241, v170
v_fmac_f32 v171, v57, v225
v_cvt_pk_bf16_f32 v25, v170, v171
v_mul_f32 v172, v42, v226
v_mul_f32 v173, v42, v242
v_fma_f32 v172, -v58, v242, v172
v_fmac_f32 v173, v58, v226
v_cvt_pk_bf16_f32 v26, v172, v173
v_mul_f32 v174, v43, v227
v_mul_f32 v175, v43, v243
v_fma_f32 v174, -v59, v243, v174
v_fmac_f32 v175, v59, v227
v_cvt_pk_bf16_f32 v27, v174, v175
v_mul_f32 v168, v44, v228
v_mul_f32 v169, v44, v244
v_fma_f32 v168, -v60, v244, v168
v_fmac_f32 v169, v60, v228
v_cvt_pk_bf16_f32 v28, v168, v169
v_mul_f32 v170, v45, v229
v_mul_f32 v171, v45, v245
v_fma_f32 v170, -v61, v245, v170
v_fmac_f32 v171, v61, v229
v_cvt_pk_bf16_f32 v29, v170, v171
v_mul_f32 v172, v46, v230
v_mul_f32 v173, v46, v246
v_fma_f32 v172, -v62, v246, v172
v_fmac_f32 v173, v62, v230
v_cvt_pk_bf16_f32 v30, v172, v173
v_mul_f32 v174, v47, v231
v_mul_f32 v175, v47, v247
v_fma_f32 v174, -v63, v247, v174
v_fmac_f32 v175, v63, v231
v_cvt_pk_bf16_f32 v31, v174, v175
v_mul_f32 v168, v48, v232
v_mul_f32 v169, v48, v248
v_fma_f32 v168, -v64, v248, v168
v_fmac_f32 v169, v64, v232
v_cvt_pk_bf16_f32 v32, v168, v169
v_mul_f32 v170, v49, v233
v_mul_f32 v171, v49, v249
v_fma_f32 v170, -v65, v249, v170
v_fmac_f32 v171, v65, v233
v_cvt_pk_bf16_f32 v33, v170, v171
v_mul_f32 v172, v50, v234
v_mul_f32 v173, v50, v250
v_fma_f32 v172, -v66, v250, v172
v_fmac_f32 v173, v66, v234
v_cvt_pk_bf16_f32 v34, v172, v173
v_mul_f32 v174, v51, v235
v_mul_f32 v175, v51, v251
v_fma_f32 v174, -v67, v251, v174
v_fmac_f32 v175, v67, v235
v_cvt_pk_bf16_f32 v35, v174, v175
v_mul_f32 v168, v52, v236
v_mul_f32 v169, v52, v252
v_fma_f32 v168, -v68, v252, v168
v_fmac_f32 v169, v68, v236
v_cvt_pk_bf16_f32 v36, v168, v169
v_mul_f32 v170, v53, v237
v_mul_f32 v171, v53, v253
v_fma_f32 v170, -v69, v253, v170
v_fmac_f32 v171, v69, v237
v_cvt_pk_bf16_f32 v37, v170, v171
v_mul_f32 v172, v54, v238
v_mul_f32 v173, v54, v254
v_fma_f32 v172, -v70, v254, v172
v_fmac_f32 v173, v70, v238
v_cvt_pk_bf16_f32 v38, v172, v173
v_mul_f32 v174, v55, v239
v_mul_f32 v175, v55, v255
v_fma_f32 v174, -v71, v255, v174
v_fmac_f32 v175, v71, v239
v_cvt_pk_bf16_f32 v39, v174, v175
v_mfma_f32_32x32x16_bf16 v[40:55], v[192:195], v[24:27], 0
v_mfma_f32_32x32x16_bf16 v[40:55], v[196:199], v[28:31], v[40:55]
v_mfma_f32_32x32x16_bf16 v[40:55], v[200:203], v[32:35], v[40:55]
v_mfma_f32_32x32x16_bf16 v[40:55], v[204:207], v[36:39], v[40:55]
v_mfma_f32_32x32x16_bf16 v[56:71], v[208:211], v[24:27], 0
v_mfma_f32_32x32x16_bf16 v[56:71], v[212:215], v[28:31], v[56:71]
v_mfma_f32_32x32x16_bf16 v[56:71], v[216:219], v[32:35], v[56:71]
v_mfma_f32_32x32x16_bf16 v[56:71], v[220:223], v[36:39], v[56:71]
s_movk_i32 s64, 0x2000
s_nop 10
v_cvt_pk_bf16_f32 v73, v56, v40
v_lshlrev_b32 v72, 16, v73
v_and_b32 v73, 0xffff0000, v73
buffer_store_dword v72, v14, s[40:43], 0 offen offset:0 nt
buffer_store_dword v73, v14, s[40:43], s64 offen offset:0 nt
v_cvt_pk_bf16_f32 v75, v57, v41
v_lshlrev_b32 v74, 16, v75
v_and_b32 v75, 0xffff0000, v75
buffer_store_dword v74, v14, s[40:43], 0 offen offset:128 nt
buffer_store_dword v75, v14, s[40:43], s64 offen offset:128 nt
v_cvt_pk_bf16_f32 v77, v58, v42
v_lshlrev_b32 v76, 16, v77
v_and_b32 v77, 0xffff0000, v77
buffer_store_dword v76, v14, s[40:43], 0 offen offset:256 nt
buffer_store_dword v77, v14, s[40:43], s64 offen offset:256 nt
v_cvt_pk_bf16_f32 v79, v59, v43
v_lshlrev_b32 v78, 16, v79
v_and_b32 v79, 0xffff0000, v79
buffer_store_dword v78, v14, s[40:43], 0 offen offset:384 nt
buffer_store_dword v79, v14, s[40:43], s64 offen offset:384 nt
v_cvt_pk_bf16_f32 v81, v60, v44
v_lshlrev_b32 v80, 16, v81
v_and_b32 v81, 0xffff0000, v81
buffer_store_dword v80, v14, s[40:43], 0 offen offset:1024 nt
buffer_store_dword v81, v14, s[40:43], s64 offen offset:1024 nt
v_cvt_pk_bf16_f32 v83, v61, v45
v_lshlrev_b32 v82, 16, v83
v_and_b32 v83, 0xffff0000, v83
buffer_store_dword v82, v14, s[40:43], 0 offen offset:1152 nt
buffer_store_dword v83, v14, s[40:43], s64 offen offset:1152 nt
v_cvt_pk_bf16_f32 v85, v62, v46
v_lshlrev_b32 v84, 16, v85
v_and_b32 v85, 0xffff0000, v85
buffer_store_dword v84, v14, s[40:43], 0 offen offset:1280 nt
buffer_store_dword v85, v14, s[40:43], s64 offen offset:1280 nt
v_cvt_pk_bf16_f32 v87, v63, v47
v_lshlrev_b32 v86, 16, v87
v_and_b32 v87, 0xffff0000, v87
buffer_store_dword v86, v14, s[40:43], 0 offen offset:1408 nt
buffer_store_dword v87, v14, s[40:43], s64 offen offset:1408 nt
v_cvt_pk_bf16_f32 v89, v64, v48
v_lshlrev_b32 v88, 16, v89
v_and_b32 v89, 0xffff0000, v89
buffer_store_dword v88, v14, s[40:43], 0 offen offset:2048 nt
buffer_store_dword v89, v14, s[40:43], s64 offen offset:2048 nt
v_cvt_pk_bf16_f32 v91, v65, v49
v_lshlrev_b32 v90, 16, v91
v_and_b32 v91, 0xffff0000, v91
buffer_store_dword v90, v14, s[40:43], 0 offen offset:2176 nt
buffer_store_dword v91, v14, s[40:43], s64 offen offset:2176 nt
v_cvt_pk_bf16_f32 v93, v66, v50
v_lshlrev_b32 v92, 16, v93
v_and_b32 v93, 0xffff0000, v93
buffer_store_dword v92, v14, s[40:43], 0 offen offset:2304 nt
buffer_store_dword v93, v14, s[40:43], s64 offen offset:2304 nt
v_cvt_pk_bf16_f32 v95, v67, v51
v_lshlrev_b32 v94, 16, v95
v_and_b32 v95, 0xffff0000, v95
buffer_store_dword v94, v14, s[40:43], 0 offen offset:2432 nt
buffer_store_dword v95, v14, s[40:43], s64 offen offset:2432 nt
v_cvt_pk_bf16_f32 v97, v68, v52
v_lshlrev_b32 v96, 16, v97
v_and_b32 v97, 0xffff0000, v97
buffer_store_dword v96, v14, s[40:43], 0 offen offset:3072 nt
buffer_store_dword v97, v14, s[40:43], s64 offen offset:3072 nt
v_cvt_pk_bf16_f32 v99, v69, v53
v_lshlrev_b32 v98, 16, v99
v_and_b32 v99, 0xffff0000, v99
buffer_store_dword v98, v14, s[40:43], 0 offen offset:3200 nt
buffer_store_dword v99, v14, s[40:43], s64 offen offset:3200 nt
v_cvt_pk_bf16_f32 v101, v70, v54
v_lshlrev_b32 v100, 16, v101
v_and_b32 v101, 0xffff0000, v101
buffer_store_dword v100, v14, s[40:43], 0 offen offset:3328 nt
buffer_store_dword v101, v14, s[40:43], s64 offen offset:3328 nt
v_cvt_pk_bf16_f32 v103, v71, v55
v_lshlrev_b32 v102, 16, v103
v_and_b32 v103, 0xffff0000, v103
buffer_store_dword v102, v14, s[40:43], 0 offen offset:3456 nt
buffer_store_dword v103, v14, s[40:43], s64 offen offset:3456 nt
s_endpgm
L_concat_heads__spectral_gfnet__ssm_conv_s5__prompt_kernel_gemm:
s_lshr_b32 s68, s34, 1
s_and_b32 s66, s34, 1
s_lshr_b32 s101, s36, 3
v_and_b32 v6, 31, v1
v_lshrrev_b32 v5, 5, v1
v_lshlrev_b32 v11, 4, v1
v_bfe_u32 v4, v1, 2, 2
v_lshlrev_b32 v4, 3, v4
v_and_b32 v7, 3, v1
v_add_u32 v4, v4, v7
s_lshl_b32 s60, s36, 6
s_lshl_b32 s61, s66, 5
s_add_u32 s60, s60, s61
v_add_u32 v4, s60, v4
v_lshlrev_b32 v7, 1, v4
s_waitcnt lgkmcnt(0)
global_load_ushort v40, v7, s[12:13] offset:0
global_load_ushort v41, v7, s[14:15] offset:0
global_load_ushort v42, v7, s[24:25] offset:0
global_load_ushort v44, v7, s[12:13] offset:8
global_load_ushort v45, v7, s[14:15] offset:8
global_load_ushort v46, v7, s[24:25] offset:8
v_bfe_u32 v7, v1, 4, 1
v_lshl_add_u32 v4, v7, 2, v4
s_lshl_b32 s60, s2, 3
s_add_u32 s60, s60, s34
s_cmp_lg_u32 s60, 1
s_cbranch_scc1 L_nn38
s_load_dword s60, s[32:33], 0
v_mov_b32 v16, 0
v_lshlrev_b32 v17, 7, v1
v_add_u32 v17, 4096, v17
global_store_dword v17, v16, s[32:33] sc1
s_waitcnt vmcnt(0) lgkmcnt(0)
s_add_u32 s60, s60, 1
s_cmp_eq_u32 s60, 0
s_cselect_b32 s60, 1, s60
v_mov_b32 v17, s60
s_mov_b64 exec, 1
global_store_dword v16, v17, s[30:31] sc1
global_store_dword v16, v17, s[32:33] offset:0
s_mov_b64 exec, -1
L_nn38:
s_cmp_lg_u32 s34, 0
s_cbranch_scc1 L_pf39
s_lshr_b32 s60, s2, 3
s_lshl_b32 s60, s60, 11
v_and_b32 v12, 15, v1
v_lshl_add_u32 v12, v12, 7, s60
v_min_u32 v12, L_concat_heads__spectral_gfnet__ssm_conv_s5__prompt_kernel_end-concat_heads__spectral_gfnet__ssm_conv_s5__prompt_kernel, v12
s_getpc_b64 s[60:61]
L_pc40:
s_sub_u32 s60, s60, L_pc40-concat_heads__spectral_gfnet__ssm_conv_s5__prompt_kernel
s_subb_u32 s61, s61, 0
global_load_dword v247, v12, s[60:61]
L_pf39:
v_bfe_u32 v7, v6, 1, 3
v_xor_b32 v7, v7, v5
v_lshlrev_b32 v7, 4, v7
v_lshl_add_u32 v7, v6, 7, v7
v_and_b32 v8, 15, v1
v_lshrrev_b32 v9, 4, v1
v_lshrrev_b32 v12, 1, v8
v_xor_b32 v12, v12, v9
v_lshlrev_b32 v12, 4, v12
v_lshl_add_u32 v12, v8, 7, v12
s_lshl_b32 s60, s68, 13
s_lshl_b32 s61, s66, 13
s_add_u32 s61, s61, 16384
v_xor_b32 v13, 0, v12
v_add_u32 v128, s60, v13
v_add_u32 v130, s61, v13
v_add_u32 v132, 0x10000, v128
v_add_u32 v134, 0x10000, v130
v_xor_b32 v13, 64, v12
v_add_u32 v129, s60, v13
v_add_u32 v131, s61, v13
v_add_u32 v133, 0x10000, v129
v_add_u32 v135, 0x10000, v131
v_mov_b64 v[64:65], 0
v_mov_b64 v[66:67], 0
v_mov_b64 v[68:69], 0
v_mov_b64 v[70:71], 0
v_mov_b64 v[72:73], 0
v_mov_b64 v[74:75], 0
v_mov_b64 v[76:77], 0
v_mov_b64 v[78:79], 0
v_mov_b64 v[80:81], 0
v_mov_b64 v[82:83], 0
v_mov_b64 v[84:85], 0
v_mov_b64 v[86:87], 0
v_mov_b64 v[88:89], 0
v_mov_b64 v[90:91], 0
v_mov_b64 v[92:93], 0
v_mov_b64 v[94:95], 0
v_mov_b64 v[96:97], 0
v_mov_b64 v[98:99], 0
v_mov_b64 v[100:101], 0
v_mov_b64 v[102:103], 0
v_mov_b64 v[104:105], 0
v_mov_b64 v[106:107], 0
v_mov_b64 v[108:109], 0
v_mov_b64 v[110:111], 0
v_mov_b64 v[112:113], 0
v_mov_b64 v[114:115], 0
v_mov_b64 v[116:117], 0
v_mov_b64 v[118:119], 0
v_mov_b64 v[120:121], 0
v_mov_b64 v[122:123], 0
v_mov_b64 v[124:125], 0
v_mov_b64 v[126:127], 0
s_mul_i32 s60, s34, 2304
s_add_u32 s60, s60, 114688
v_add_u32 v13, s60, v11
v_mov_b32 v12, 126976
ds_write_b128 v13, v[64:67]
ds_write_b128 v13, v[64:67] offset:1024
ds_write_b128 v13, v[64:67] offset:2048
s_mov_b64 exec, 1
ds_write_b128 v12, v[64:67]
ds_write_b128 v12, v[64:67] offset:16
s_mov_b64 exec, -1
s_lshl_b32 s60, s34, 2
v_add_u32 v13, s60, v12
v_lshlrev_b32 v14, 2, v9
v_sub_u32 v14, v8, v14
v_mov_b32 v15, 0x3f80
v_mov_b32 v16, 1.0
v_cmp_eq_u32 vcc, 0, v14
s_nop 1
v_cndmask_b32 v248, 0, v15, vcc
v_cndmask_b32 v252, 0, v16, vcc
v_cmp_eq_u32 vcc, 1, v14
s_nop 1
v_cndmask_b32 v249, 0, v15, vcc
v_cndmask_b32 v253, 0, v16, vcc
v_cmp_eq_u32 vcc, 2, v14
s_nop 1
v_cndmask_b32 v250, 0, v15, vcc
v_cndmask_b32 v254, 0, v16, vcc
v_cmp_eq_u32 vcc, 3, v14
s_nop 1
v_cndmask_b32 v251, 0, v15, vcc
v_cndmask_b32 v255, 0, v16, vcc
s_add_u32 s40, s32, 65536
s_addc_u32 s41, s33, 0
s_mov_b32 s42, 262144
s_mov_b32 s43, 0x20000
s_add_u32 s44, s32, 1048576
s_addc_u32 s45, s33, 0
s_mov_b32 s46, 8388608
s_mov_b32 s47, 0x20000
s_mul_i32 s60, s66, 4608
s_add_u32 s60, s60, 114752
s_lshl_b32 s61, s68, 5
s_add_u32 s61, s61, s60
v_mul_u32_u24 v14, 144, v6
v_add_u32 v14, s60, v14
v_lshl_add_u32 v14, v5, 5, v14
v_mul_u32_u24 v15, 144, v8
v_add_u32 v15, s61, v15
v_lshl_add_u32 v15, v9, 3, v15
s_lshl_b32 s60, s35, 14
v_lshl_add_u32 v16, v4, 4, s60
v_mov_b32 v17, 0x40000000
v_lshlrev_b32 v10, 14, v5
v_sub_u32 v10, v16, v10
v_subrev_u32 v136, 16384, v10
v_cmp_le_i32 vcc, 0, v136
s_nop 1
v_cndmask_b32 v136, v17, v136, vcc
v_subrev_u32 v137, 49152, v10
v_cmp_le_i32 vcc, 0, v137
s_nop 1
v_cndmask_b32 v137, v17, v137, vcc
v_subrev_u32 v138, 81920, v10
v_cmp_le_i32 vcc, 0, v138
s_nop 1
v_cndmask_b32 v138, v17, v138, vcc
v_subrev_u32 v139, 114688, v10
v_cmp_le_i32 vcc, 0, v139
s_nop 1
v_cndmask_b32 v139, v17, v139, vcc
v_subrev_u32 v140, 147456, v10
v_cmp_le_i32 vcc, 0, v140
s_nop 1
v_cndmask_b32 v140, v17, v140, vcc
v_subrev_u32 v141, 180224, v10
v_cmp_le_i32 vcc, 0, v141
s_nop 1
v_cndmask_b32 v141, v17, v141, vcc
v_subrev_u32 v142, 212992, v10
v_cmp_le_i32 vcc, 0, v142
s_nop 1
v_cndmask_b32 v142, v17, v142, vcc
v_subrev_u32 v143, 245760, v10
v_cmp_le_i32 vcc, 0, v143
s_nop 1
v_cndmask_b32 v143, v17, v143, vcc
v_lshlrev_b32 v17, 30, v5
v_or_b32 v16, v16, v17
s_lshl_b32 s60, s35, 11
s_add_u32 s60, s60, 32768
s_lshl_b32 s61, s36, 7
s_add_u32 s61, s61, s60
v_mov_b32 v195, s61
s_lshl_b32 s61, s101, 10
s_add_u32 s60, s60, s61
v_and_b32 v196, 7, v1
v_lshl_add_u32 v196, v196, 7, s60
s_lshl_b32 s60, s35, 1
s_add_u32 s60, s60, s68
s_lshl_b32 s60, s60, 12
s_add_u32 s60, s60, 393216
s_lshl_b32 s61, s101, 11
s_add_u32 s61, s61, s60
v_lshl_add_u32 v18, v8, 7, s61
s_lshl_b32 s61, s36, 8
s_add_u32 s60, s60, s61
s_lshl_b32 s61, s66, 7
s_add_u32 s60, s60, s61
v_mov_b32 v19, s60
v_lshrrev_b32 v10, 1, v9
v_lshlrev_b32 v10, 10, v10
v_and_b32 v17, 1, v9
v_lshl_add_u32 v10, v17, 9, v10
v_lshl_add_u32 v10, v8, 4, v10
s_lshl_b32 s60, s68, 2
v_add_u32 v9, s60, v9
v_cvt_f32_u32 v9, v9
v_mul_f32 v9, 0x41800000, v9
v_add_f32 v8, 0x41000000, v9
s_waitcnt vmcnt(0)
v_lshlrev_b32 v40, 16, v40
v_lshlrev_b32 v41, 16, v41
v_lshlrev_b32 v42, 16, v42
v_mul_f32 v42, 0x3fb8aa3b, v42
v_exp_f32 v42, v42
s_nop 0
v_cvt_pk_bf16_f32 v42, v42, v42
v_lshlrev_b32 v42, 16, v42
v_mul_f32 v48, v42, v40
v_mul_f32 v50, v42, v41
v_mul_f32 v48, 0x3fb8aa3b, v48
v_mul_f32 v50, 0.15915494, v50
v_mul_f32 v52, 0x3f800000, v48
v_mul_f32 v53, 0x3f800000, v50
v_exp_f32 v52, v52
v_rndne_f32 v54, v53
v_sub_f32 v53, v53, v54
v_cos_f32 v54, v53
v_sin_f32 v53, v53
v_mul_f32 v20, v52, v54
v_mul_f32 v21, v52, v53
v_add_f32 v52, -1.0, v20
v_mul_f32 v53, v40, v40
v_fma_f32 v53, v41, v41, v53
v_rcp_f32 v53, v53
s_nop 0
v_add_f32 v53, v53, v53
v_mul_f32 v54, v52, v40
v_fma_f32 v54, v21, v41, v54
v_mul_f32 v24, v54, v53
v_mul_f32 v54, v21, v40
v_fma_f32 v54, -v52, v41, v54
v_mul_f32 v25, v54, v53
v_mul_f32 v52, 0x41000000, v48
v_mul_f32 v53, 0x41000000, v50
v_exp_f32 v52, v52
v_rndne_f32 v54, v53
v_sub_f32 v53, v53, v54
v_cos_f32 v54, v53
v_sin_f32 v53, v53
v_mul_f32 v176, v52, v54
v_mul_f32 v177, v52, v53
v_mul_f32 v52, 0x41800000, v48
v_mul_f32 v53, 0x41800000, v50
v_exp_f32 v52, v52
v_rndne_f32 v54, v53
v_sub_f32 v53, v53, v54
v_cos_f32 v54, v53
v_sin_f32 v53, v53
v_mul_f32 v180, v52, v54
v_mul_f32 v181, v52, v53
v_mul_f32 v52, v9, v48
v_mul_f32 v53, v9, v50
v_exp_f32 v52, v52
v_rndne_f32 v54, v53
v_sub_f32 v53, v53, v54
v_cos_f32 v54, v53
v_sin_f32 v53, v53
v_mul_f32 v56, v52, v54
v_mul_f32 v57, v52, v53
v_mov_b32 v184, v56
v_mov_b32 v186, v57
v_mul_f32 v52, v8, v48
v_mul_f32 v53, v8, v50
v_exp_f32 v52, v52
v_rndne_f32 v54, v53
v_sub_f32 v53, v53, v54
v_cos_f32 v54, v53
v_sin_f32 v53, v53
v_mul_f32 v56, v52, v54
v_mul_f32 v57, v52, v53
v_mov_b32 v185, v56
v_mov_b32 v187, v57
v_mul_f32 v52, v25, v21
v_mul_f32 v53, v25, v20
v_fma_f32 v208, v24, v20, -v52
v_fma_f32 v209, v24, v21, v53
v_mul_f32 v52, v209, v21
v_mul_f32 v53, v209, v20
v_fma_f32 v210, v208, v20, -v52
v_fma_f32 v211, v208, v21, v53
v_mul_f32 v52, v211, v21
v_mul_f32 v53, v211, v20
v_fma_f32 v212, v210, v20, -v52
v_fma_f32 v213, v210, v21, v53
v_mul_f32 v52, v213, v21
v_mul_f32 v53, v213, v20
v_fma_f32 v214, v212, v20, -v52
v_fma_f32 v215, v212, v21, v53
v_mul_f32 v52, v215, v21
v_mul_f32 v53, v215, v20
v_fma_f32 v216, v214, v20, -v52
v_fma_f32 v217, v214, v21, v53
v_mul_f32 v52, v217, v21
v_mul_f32 v53, v217, v20
v_fma_f32 v218, v216, v20, -v52
v_fma_f32 v219, v216, v21, v53
v_mul_f32 v52, v219, v21
v_mul_f32 v53, v219, v20
v_fma_f32 v220, v218, v20, -v52
v_fma_f32 v221, v218, v21, v53
v_mul_f32 v52, v221, v21
v_mul_f32 v53, v221, v20
v_fma_f32 v222, v220, v20, -v52
v_fma_f32 v223, v220, v21, v53
v_lshlrev_b32 v44, 16, v44
v_lshlrev_b32 v45, 16, v45
v_lshlrev_b32 v46, 16, v46
v_mul_f32 v46, 0x3fb8aa3b, v46
v_exp_f32 v46, v46
s_nop 0
v_cvt_pk_bf16_f32 v46, v46, v46
v_lshlrev_b32 v46, 16, v46
v_mul_f32 v49, v46, v44
v_mul_f32 v51, v46, v45
v_mul_f32 v49, 0x3fb8aa3b, v49
v_mul_f32 v51, 0.15915494, v51
v_mul_f32 v52, 0x3f800000, v49
v_mul_f32 v53, 0x3f800000, v51
v_exp_f32 v52, v52
v_rndne_f32 v54, v53
v_sub_f32 v53, v53, v54
v_cos_f32 v54, v53
v_sin_f32 v53, v53
v_mul_f32 v22, v52, v54
v_mul_f32 v23, v52, v53
v_add_f32 v52, -1.0, v22
v_mul_f32 v53, v44, v44
v_fma_f32 v53, v45, v45, v53
v_rcp_f32 v53, v53
s_nop 0
v_add_f32 v53, v53, v53
v_mul_f32 v54, v52, v44
v_fma_f32 v54, v23, v45, v54
v_mul_f32 v26, v54, v53
v_mul_f32 v54, v23, v44
v_fma_f32 v54, -v52, v45, v54
v_mul_f32 v27, v54, v53
v_mul_f32 v52, 0x41000000, v49
v_mul_f32 v53, 0x41000000, v51
v_exp_f32 v52, v52
v_rndne_f32 v54, v53
v_sub_f32 v53, v53, v54
v_cos_f32 v54, v53
v_sin_f32 v53, v53
v_mul_f32 v178, v52, v54
v_mul_f32 v179, v52, v53
v_mul_f32 v52, 0x41800000, v49
v_mul_f32 v53, 0x41800000, v51
v_exp_f32 v52, v52
v_rndne_f32 v54, v53
v_sub_f32 v53, v53, v54
v_cos_f32 v54, v53
v_sin_f32 v53, v53
v_mul_f32 v182, v52, v54
v_mul_f32 v183, v52, v53
v_mul_f32 v52, v9, v49
v_mul_f32 v53, v9, v51
v_exp_f32 v52, v52
v_rndne_f32 v54, v53
v_sub_f32 v53, v53, v54
v_cos_f32 v54, v53
v_sin_f32 v53, v53
v_mul_f32 v56, v52, v54
v_mul_f32 v57, v52, v53
v_mov_b32 v188, v56
v_mov_b32 v190, v57
v_mul_f32 v52, v8, v49
v_mul_f32 v53, v8, v51
v_exp_f32 v52, v52
v_rndne_f32 v54, v53
v_sub_f32 v53, v53, v54
v_cos_f32 v54, v53
v_sin_f32 v53, v53
v_mul_f32 v56, v52, v54
v_mul_f32 v57, v52, v53
v_mov_b32 v189, v56
v_mov_b32 v191, v57
v_mul_f32 v52, v27, v23
v_mul_f32 v53, v27, v22
v_fma_f32 v224, v26, v22, -v52
v_fma_f32 v225, v26, v23, v53
v_mul_f32 v52, v225, v23
v_mul_f32 v53, v225, v22
v_fma_f32 v226, v224, v22, -v52
v_fma_f32 v227, v224, v23, v53
v_mul_f32 v52, v227, v23
v_mul_f32 v53, v227, v22
v_fma_f32 v228, v226, v22, -v52
v_fma_f32 v229, v226, v23, v53
v_mul_f32 v52, v229, v23
v_mul_f32 v53, v229, v22
v_fma_f32 v230, v228, v22, -v52
v_fma_f32 v231, v228, v23, v53
v_mul_f32 v52, v231, v23
v_mul_f32 v53, v231, v22
v_fma_f32 v232, v230, v22, -v52
v_fma_f32 v233, v230, v23, v53
v_mul_f32 v52, v233, v23
v_mul_f32 v53, v233, v22
v_fma_f32 v234, v232, v22, -v52
v_fma_f32 v235, v232, v23, v53
v_mul_f32 v52, v235, v23
v_mul_f32 v53, v235, v22
v_fma_f32 v236, v234, v22, -v52
v_fma_f32 v237, v234, v23, v53
v_mul_f32 v52, v237, v23
v_mul_f32 v53, v237, v22
v_fma_f32 v238, v236, v22, -v52
v_fma_f32 v239, v236, v23, v53
v_and_b32 v52, 16, v1
v_cmp_ne_u32 vcc, 0, v52
s_nop 1
v_cndmask_b32 v48, v48, v49, vcc
v_cndmask_b32 v50, v50, v51, vcc
v_mul_f32 v52, 0x41800000, v48
v_mul_f32 v53, 0x41800000, v50
v_exp_f32 v52, v52
v_rndne_f32 v54, v53
v_sub_f32 v53, v53, v54
v_cos_f32 v54, v53
v_sin_f32 v53, v53
v_mul_f32 v28, v52, v54
v_mul_f32 v29, v52, v53
v_mul_f32 v52, 0x42800000, v48
v_mul_f32 v53, 0x42800000, v50
v_exp_f32 v52, v52
v_rndne_f32 v54, v53
v_sub_f32 v53, v53, v54
v_cos_f32 v54, v53
v_sin_f32 v53, v53
v_mul_f32 v192, v52, v54
v_mul_f32 v193, v52, v53
v_mul_f32 v52, 0x43000000, v48
v_mul_f32 v53, 0x43000000, v50
v_exp_f32 v52, v52
v_rndne_f32 v54, v53
v_sub_f32 v53, v53, v54
v_cos_f32 v54, v53
v_sin_f32 v53, v53
v_mul_f32 v30, v52, v54
v_mul_f32 v31, v52, v53
v_mul_f32 v52, 0x43800000, v48
v_mul_f32 v53, 0x43800000, v50
v_exp_f32 v52, v52
v_rndne_f32 v54, v53
v_sub_f32 v53, v53, v54
v_cos_f32 v54, v53
v_sin_f32 v53, v53
v_mul_f32 v2, v52, v54
v_mul_f32 v3, v52, v53
s_waitcnt lgkmcnt(0)
s_barrier
ds_read_b128 v[32:35], v128 offset:0
ds_read_b128 v[48:51], v130 offset:0
ds_read_b128 v[52:55], v130 offset:2048
ds_read_b128 v[56:59], v130 offset:4096
ds_read_b128 v[60:63], v130 offset:6144
ds_read_b128 v[36:39], v128 offset:2048
ds_read_b128 v[40:43], v128 offset:4096
ds_read_b128 v[44:47], v128 offset:6144
s_waitcnt lgkmcnt(6)
v_mfma_f32_16x16x32_bf16 v[64:67], v[32:35], v[48:51], v[64:67]
ds_read_b128 v[144:147], v129 offset:0
s_waitcnt lgkmcnt(6)
v_mfma_f32_16x16x32_bf16 v[96:99], v[32:35], v[52:55], v[96:99]
ds_read_b128 v[160:163], v131 offset:0
s_waitcnt lgkmcnt(6)
v_mfma_f32_16x16x32_bf16 v[80:83], v[32:35], v[56:59], v[80:83]
ds_read_b128 v[164:167], v131 offset:2048
s_waitcnt lgkmcnt(6)
v_mfma_f32_16x16x32_bf16 v[112:115], v[32:35], v[60:63], v[112:115]
ds_read_b128 v[168:171], v131 offset:4096
s_waitcnt lgkmcnt(6)
v_mfma_f32_16x16x32_bf16 v[68:71], v[36:39], v[48:51], v[68:71]
ds_read_b128 v[172:175], v131 offset:6144
v_mfma_f32_16x16x32_bf16 v[100:103], v[36:39], v[52:55], v[100:103]
ds_read_b128 v[148:151], v129 offset:2048
v_mfma_f32_16x16x32_bf16 v[84:87], v[36:39], v[56:59], v[84:87]
ds_read_b128 v[152:155], v129 offset:4096
v_mfma_f32_16x16x32_bf16 v[116:119], v[36:39], v[60:63], v[116:119]
ds_read_b128 v[156:159], v129 offset:6144
s_waitcnt lgkmcnt(9)
v_mfma_f32_16x16x32_bf16 v[72:75], v[40:43], v[48:51], v[72:75]
v_mfma_f32_16x16x32_bf16 v[104:107], v[40:43], v[52:55], v[104:107]
v_mfma_f32_16x16x32_bf16 v[88:91], v[40:43], v[56:59], v[88:91]
v_mfma_f32_16x16x32_bf16 v[120:123], v[40:43], v[60:63], v[120:123]
s_waitcnt lgkmcnt(8)
v_mfma_f32_16x16x32_bf16 v[76:79], v[44:47], v[48:51], v[76:79]
v_mfma_f32_16x16x32_bf16 v[108:111], v[44:47], v[52:55], v[108:111]
v_mfma_f32_16x16x32_bf16 v[92:95], v[44:47], v[56:59], v[92:95]
v_mfma_f32_16x16x32_bf16 v[124:127], v[44:47], v[60:63], v[124:127]
s_waitcnt lgkmcnt(0)
s_barrier
v_mfma_f32_16x16x32_bf16 v[64:67], v[144:147], v[160:163], v[64:67]
ds_read_b128 v[32:35], v128 offset:32768
v_mfma_f32_16x16x32_bf16 v[96:99], v[144:147], v[164:167], v[96:99]
ds_read_b128 v[48:51], v130 offset:32768
v_mfma_f32_16x16x32_bf16 v[80:83], v[144:147], v[168:171], v[80:83]
ds_read_b128 v[52:55], v130 offset:34816
v_mfma_f32_16x16x32_bf16 v[112:115], v[144:147], v[172:175], v[112:115]
ds_read_b128 v[56:59], v130 offset:36864
v_mfma_f32_16x16x32_bf16 v[68:71], v[148:151], v[160:163], v[68:71]
ds_read_b128 v[60:63], v130 offset:38912
v_mfma_f32_16x16x32_bf16 v[100:103], v[148:151], v[164:167], v[100:103]
ds_read_b128 v[36:39], v128 offset:34816
v_mfma_f32_16x16x32_bf16 v[84:87], v[148:151], v[168:171], v[84:87]
ds_read_b128 v[40:43], v128 offset:36864
v_mfma_f32_16x16x32_bf16 v[116:119], v[148:151], v[172:175], v[116:119]
ds_read_b128 v[44:47], v128 offset:38912
v_mfma_f32_16x16x32_bf16 v[72:75], v[152:155], v[160:163], v[72:75]
v_mfma_f32_16x16x32_bf16 v[104:107], v[152:155], v[164:167], v[104:107]
v_mfma_f32_16x16x32_bf16 v[88:91], v[152:155], v[168:171], v[88:91]
v_mfma_f32_16x16x32_bf16 v[120:123], v[152:155], v[172:175], v[120:123]
v_mfma_f32_16x16x32_bf16 v[76:79], v[156:159], v[160:163], v[76:79]
v_mfma_f32_16x16x32_bf16 v[108:111], v[156:159], v[164:167], v[108:111]
v_mfma_f32_16x16x32_bf16 v[92:95], v[156:159], v[168:171], v[92:95]
v_mfma_f32_16x16x32_bf16 v[124:127], v[156:159], v[172:175], v[124:127]
s_waitcnt lgkmcnt(6)
v_mfma_f32_16x16x32_bf16 v[64:67], v[32:35], v[48:51], v[64:67]
ds_read_b128 v[144:147], v129 offset:32768
s_waitcnt lgkmcnt(6)
v_mfma_f32_16x16x32_bf16 v[96:99], v[32:35], v[52:55], v[96:99]
ds_read_b128 v[160:163], v131 offset:32768
s_waitcnt lgkmcnt(6)
v_mfma_f32_16x16x32_bf16 v[80:83], v[32:35], v[56:59], v[80:83]
ds_read_b128 v[164:167], v131 offset:34816
s_waitcnt lgkmcnt(6)
v_mfma_f32_16x16x32_bf16 v[112:115], v[32:35], v[60:63], v[112:115]
ds_read_b128 v[168:171], v131 offset:36864
s_waitcnt lgkmcnt(6)
v_mfma_f32_16x16x32_bf16 v[68:71], v[36:39], v[48:51], v[68:71]
ds_read_b128 v[172:175], v131 offset:38912
v_mfma_f32_16x16x32_bf16 v[100:103], v[36:39], v[52:55], v[100:103]
ds_read_b128 v[148:151], v129 offset:34816
v_mfma_f32_16x16x32_bf16 v[84:87], v[36:39], v[56:59], v[84:87]
ds_read_b128 v[152:155], v129 offset:36864
v_mfma_f32_16x16x32_bf16 v[116:119], v[36:39], v[60:63], v[116:119]
ds_read_b128 v[156:159], v129 offset:38912
s_waitcnt lgkmcnt(9)
v_mfma_f32_16x16x32_bf16 v[72:75], v[40:43], v[48:51], v[72:75]
v_mfma_f32_16x16x32_bf16 v[104:107], v[40:43], v[52:55], v[104:107]
v_mfma_f32_16x16x32_bf16 v[88:91], v[40:43], v[56:59], v[88:91]
v_mfma_f32_16x16x32_bf16 v[120:123], v[40:43], v[60:63], v[120:123]
s_waitcnt lgkmcnt(8)
v_mfma_f32_16x16x32_bf16 v[76:79], v[44:47], v[48:51], v[76:79]
v_mfma_f32_16x16x32_bf16 v[108:111], v[44:47], v[52:55], v[108:111]
v_mfma_f32_16x16x32_bf16 v[92:95], v[44:47], v[56:59], v[92:95]
v_mfma_f32_16x16x32_bf16 v[124:127], v[44:47], v[60:63], v[124:127]
s_waitcnt lgkmcnt(0)
s_barrier
v_mfma_f32_16x16x32_bf16 v[64:67], v[144:147], v[160:163], v[64:67]
ds_read_b128 v[32:35], v132 offset:0
v_mfma_f32_16x16x32_bf16 v[96:99], v[144:147], v[164:167], v[96:99]
ds_read_b128 v[48:51], v134 offset:0
v_mfma_f32_16x16x32_bf16 v[80:83], v[144:147], v[168:171], v[80:83]
ds_read_b128 v[52:55], v134 offset:2048
v_mfma_f32_16x16x32_bf16 v[112:115], v[144:147], v[172:175], v[112:115]
ds_read_b128 v[56:59], v134 offset:4096
v_mfma_f32_16x16x32_bf16 v[68:71], v[148:151], v[160:163], v[68:71]
ds_read_b128 v[60:63], v134 offset:6144
v_mfma_f32_16x16x32_bf16 v[100:103], v[148:151], v[164:167], v[100:103]
ds_read_b128 v[36:39], v132 offset:2048
v_mfma_f32_16x16x32_bf16 v[84:87], v[148:151], v[168:171], v[84:87]
ds_read_b128 v[40:43], v132 offset:4096
v_mfma_f32_16x16x32_bf16 v[116:119], v[148:151], v[172:175], v[116:119]
ds_read_b128 v[44:47], v132 offset:6144
v_mfma_f32_16x16x32_bf16 v[72:75], v[152:155], v[160:163], v[72:75]
v_mfma_f32_16x16x32_bf16 v[104:107], v[152:155], v[164:167], v[104:107]
v_mfma_f32_16x16x32_bf16 v[88:91], v[152:155], v[168:171], v[88:91]
v_mfma_f32_16x16x32_bf16 v[120:123], v[152:155], v[172:175], v[120:123]
v_mfma_f32_16x16x32_bf16 v[76:79], v[156:159], v[160:163], v[76:79]
v_mfma_f32_16x16x32_bf16 v[108:111], v[156:159], v[164:167], v[108:111]
v_mfma_f32_16x16x32_bf16 v[92:95], v[156:159], v[168:171], v[92:95]
v_mfma_f32_16x16x32_bf16 v[124:127], v[156:159], v[172:175], v[124:127]
s_waitcnt lgkmcnt(6)
v_mfma_f32_16x16x32_bf16 v[64:67], v[32:35], v[48:51], v[64:67]
ds_read_b128 v[144:147], v133 offset:0
s_waitcnt lgkmcnt(6)
v_mfma_f32_16x16x32_bf16 v[96:99], v[32:35], v[52:55], v[96:99]
ds_read_b128 v[160:163], v135 offset:0
s_waitcnt lgkmcnt(6)
v_mfma_f32_16x16x32_bf16 v[80:83], v[32:35], v[56:59], v[80:83]
ds_read_b128 v[164:167], v135 offset:2048
s_waitcnt lgkmcnt(6)
v_mfma_f32_16x16x32_bf16 v[112:115], v[32:35], v[60:63], v[112:115]
ds_read_b128 v[168:171], v135 offset:4096
s_waitcnt lgkmcnt(6)
v_mfma_f32_16x16x32_bf16 v[68:71], v[36:39], v[48:51], v[68:71]
ds_read_b128 v[172:175], v135 offset:6144
v_mfma_f32_16x16x32_bf16 v[100:103], v[36:39], v[52:55], v[100:103]
ds_read_b128 v[148:151], v133 offset:2048
v_mfma_f32_16x16x32_bf16 v[84:87], v[36:39], v[56:59], v[84:87]
ds_read_b128 v[152:155], v133 offset:4096
v_mfma_f32_16x16x32_bf16 v[116:119], v[36:39], v[60:63], v[116:119]
ds_read_b128 v[156:159], v133 offset:6144
s_waitcnt lgkmcnt(9)
v_mfma_f32_16x16x32_bf16 v[72:75], v[40:43], v[48:51], v[72:75]
v_mfma_f32_16x16x32_bf16 v[104:107], v[40:43], v[52:55], v[104:107]
v_mfma_f32_16x16x32_bf16 v[88:91], v[40:43], v[56:59], v[88:91]
v_mfma_f32_16x16x32_bf16 v[120:123], v[40:43], v[60:63], v[120:123]
s_waitcnt lgkmcnt(8)
v_mfma_f32_16x16x32_bf16 v[76:79], v[44:47], v[48:51], v[76:79]
v_mfma_f32_16x16x32_bf16 v[108:111], v[44:47], v[52:55], v[108:111]
v_mfma_f32_16x16x32_bf16 v[92:95], v[44:47], v[56:59], v[92:95]
v_mfma_f32_16x16x32_bf16 v[124:127], v[44:47], v[60:63], v[124:127]
s_waitcnt lgkmcnt(0)
s_barrier
v_mfma_f32_16x16x32_bf16 v[64:67], v[144:147], v[160:163], v[64:67]
ds_read_b128 v[32:35], v128 offset:0
v_mfma_f32_16x16x32_bf16 v[96:99], v[144:147], v[164:167], v[96:99]
ds_read_b128 v[48:51], v130 offset:0
v_mfma_f32_16x16x32_bf16 v[80:83], v[144:147], v[168:171], v[80:83]
ds_read_b128 v[52:55], v130 offset:2048
v_mfma_f32_16x16x32_bf16 v[112:115], v[144:147], v[172:175], v[112:115]
ds_read_b128 v[56:59], v130 offset:4096
v_mfma_f32_16x16x32_bf16 v[68:71], v[148:151], v[160:163], v[68:71]
ds_read_b128 v[60:63], v130 offset:6144
v_mfma_f32_16x16x32_bf16 v[100:103], v[148:151], v[164:167], v[100:103]
ds_read_b128 v[36:39], v128 offset:2048
v_mfma_f32_16x16x32_bf16 v[84:87], v[148:151], v[168:171], v[84:87]
ds_read_b128 v[40:43], v128 offset:4096
v_mfma_f32_16x16x32_bf16 v[116:119], v[148:151], v[172:175], v[116:119]
ds_read_b128 v[44:47], v128 offset:6144
v_mfma_f32_16x16x32_bf16 v[72:75], v[152:155], v[160:163], v[72:75]
v_mfma_f32_16x16x32_bf16 v[104:107], v[152:155], v[164:167], v[104:107]
v_mfma_f32_16x16x32_bf16 v[88:91], v[152:155], v[168:171], v[88:91]
v_mfma_f32_16x16x32_bf16 v[120:123], v[152:155], v[172:175], v[120:123]
v_mfma_f32_16x16x32_bf16 v[76:79], v[156:159], v[160:163], v[76:79]
v_mfma_f32_16x16x32_bf16 v[108:111], v[156:159], v[164:167], v[108:111]
v_mfma_f32_16x16x32_bf16 v[92:95], v[156:159], v[168:171], v[92:95]
v_mfma_f32_16x16x32_bf16 v[124:127], v[156:159], v[172:175], v[124:127]
s_waitcnt lgkmcnt(6)
v_mfma_f32_16x16x32_bf16 v[64:67], v[32:35], v[48:51], v[64:67]
ds_read_b128 v[144:147], v129 offset:0
s_waitcnt lgkmcnt(6)
v_mfma_f32_16x16x32_bf16 v[96:99], v[32:35], v[52:55], v[96:99]
ds_read_b128 v[160:163], v131 offset:0
s_waitcnt lgkmcnt(6)
v_mfma_f32_16x16x32_bf16 v[80:83], v[32:35], v[56:59], v[80:83]
ds_read_b128 v[164:167], v131 offset:2048
s_waitcnt lgkmcnt(6)
v_mfma_f32_16x16x32_bf16 v[112:115], v[32:35], v[60:63], v[112:115]
ds_read_b128 v[168:171], v131 offset:4096
s_waitcnt lgkmcnt(6)
v_mfma_f32_16x16x32_bf16 v[68:71], v[36:39], v[48:51], v[68:71]
ds_read_b128 v[172:175], v131 offset:6144
v_mfma_f32_16x16x32_bf16 v[100:103], v[36:39], v[52:55], v[100:103]
ds_read_b128 v[148:151], v129 offset:2048
v_mfma_f32_16x16x32_bf16 v[84:87], v[36:39], v[56:59], v[84:87]
ds_read_b128 v[152:155], v129 offset:4096
v_mfma_f32_16x16x32_bf16 v[116:119], v[36:39], v[60:63], v[116:119]
ds_read_b128 v[156:159], v129 offset:6144
s_waitcnt lgkmcnt(9)
v_mfma_f32_16x16x32_bf16 v[72:75], v[40:43], v[48:51], v[72:75]
v_mfma_f32_16x16x32_bf16 v[104:107], v[40:43], v[52:55], v[104:107]
v_mfma_f32_16x16x32_bf16 v[88:91], v[40:43], v[56:59], v[88:91]
v_mfma_f32_16x16x32_bf16 v[120:123], v[40:43], v[60:63], v[120:123]
s_waitcnt lgkmcnt(8)
v_mfma_f32_16x16x32_bf16 v[76:79], v[44:47], v[48:51], v[76:79]
v_mfma_f32_16x16x32_bf16 v[108:111], v[44:47], v[52:55], v[108:111]
v_mfma_f32_16x16x32_bf16 v[92:95], v[44:47], v[56:59], v[92:95]
v_mfma_f32_16x16x32_bf16 v[124:127], v[44:47], v[60:63], v[124:127]
s_waitcnt lgkmcnt(0)
s_barrier
v_mfma_f32_16x16x32_bf16 v[64:67], v[144:147], v[160:163], v[64:67]
ds_read_b128 v[32:35], v128 offset:32768
v_mfma_f32_16x16x32_bf16 v[96:99], v[144:147], v[164:167], v[96:99]
ds_read_b128 v[48:51], v130 offset:32768
v_mfma_f32_16x16x32_bf16 v[80:83], v[144:147], v[168:171], v[80:83]
ds_read_b128 v[52:55], v130 offset:34816
v_mfma_f32_16x16x32_bf16 v[112:115], v[144:147], v[172:175], v[112:115]
ds_read_b128 v[56:59], v130 offset:36864
v_mfma_f32_16x16x32_bf16 v[68:71], v[148:151], v[160:163], v[68:71]
ds_read_b128 v[60:63], v130 offset:38912
v_mfma_f32_16x16x32_bf16 v[100:103], v[148:151], v[164:167], v[100:103]
ds_read_b128 v[36:39], v128 offset:34816
v_mfma_f32_16x16x32_bf16 v[84:87], v[148:151], v[168:171], v[84:87]
ds_read_b128 v[40:43], v128 offset:36864
v_mfma_f32_16x16x32_bf16 v[116:119], v[148:151], v[172:175], v[116:119]
ds_read_b128 v[44:47], v128 offset:38912
v_mfma_f32_16x16x32_bf16 v[72:75], v[152:155], v[160:163], v[72:75]
v_mfma_f32_16x16x32_bf16 v[104:107], v[152:155], v[164:167], v[104:107]
v_mfma_f32_16x16x32_bf16 v[88:91], v[152:155], v[168:171], v[88:91]
v_mfma_f32_16x16x32_bf16 v[120:123], v[152:155], v[172:175], v[120:123]
v_mfma_f32_16x16x32_bf16 v[76:79], v[156:159], v[160:163], v[76:79]
v_mfma_f32_16x16x32_bf16 v[108:111], v[156:159], v[164:167], v[108:111]
v_mfma_f32_16x16x32_bf16 v[92:95], v[156:159], v[168:171], v[92:95]
v_mfma_f32_16x16x32_bf16 v[124:127], v[156:159], v[172:175], v[124:127]
s_waitcnt lgkmcnt(6)
v_mfma_f32_16x16x32_bf16 v[64:67], v[32:35], v[48:51], v[64:67]
ds_read_b128 v[144:147], v129 offset:32768
s_waitcnt lgkmcnt(6)
v_mfma_f32_16x16x32_bf16 v[96:99], v[32:35], v[52:55], v[96:99]
ds_read_b128 v[160:163], v131 offset:32768
s_waitcnt lgkmcnt(6)
v_mfma_f32_16x16x32_bf16 v[80:83], v[32:35], v[56:59], v[80:83]
ds_read_b128 v[164:167], v131 offset:34816
s_waitcnt lgkmcnt(6)
v_mfma_f32_16x16x32_bf16 v[112:115], v[32:35], v[60:63], v[112:115]
ds_read_b128 v[168:171], v131 offset:36864
s_waitcnt lgkmcnt(6)
v_mfma_f32_16x16x32_bf16 v[68:71], v[36:39], v[48:51], v[68:71]
ds_read_b128 v[172:175], v131 offset:38912
v_mfma_f32_16x16x32_bf16 v[100:103], v[36:39], v[52:55], v[100:103]
ds_read_b128 v[148:151], v129 offset:34816
v_mfma_f32_16x16x32_bf16 v[84:87], v[36:39], v[56:59], v[84:87]
ds_read_b128 v[152:155], v129 offset:36864
v_mfma_f32_16x16x32_bf16 v[116:119], v[36:39], v[60:63], v[116:119]
ds_read_b128 v[156:159], v129 offset:38912
s_waitcnt lgkmcnt(9)
v_mfma_f32_16x16x32_bf16 v[72:75], v[40:43], v[48:51], v[72:75]
v_mfma_f32_16x16x32_bf16 v[104:107], v[40:43], v[52:55], v[104:107]
v_mfma_f32_16x16x32_bf16 v[88:91], v[40:43], v[56:59], v[88:91]
v_mfma_f32_16x16x32_bf16 v[120:123], v[40:43], v[60:63], v[120:123]
s_waitcnt lgkmcnt(8)
v_mfma_f32_16x16x32_bf16 v[76:79], v[44:47], v[48:51], v[76:79]
v_mfma_f32_16x16x32_bf16 v[108:111], v[44:47], v[52:55], v[108:111]
v_mfma_f32_16x16x32_bf16 v[92:95], v[44:47], v[56:59], v[92:95]
v_mfma_f32_16x16x32_bf16 v[124:127], v[44:47], v[60:63], v[124:127]
s_waitcnt lgkmcnt(0)
s_barrier
v_mfma_f32_16x16x32_bf16 v[64:67], v[144:147], v[160:163], v[64:67]
ds_read_b128 v[32:35], v132 offset:0
v_mfma_f32_16x16x32_bf16 v[96:99], v[144:147], v[164:167], v[96:99]
ds_read_b128 v[48:51], v134 offset:0
v_mfma_f32_16x16x32_bf16 v[80:83], v[144:147], v[168:171], v[80:83]
ds_read_b128 v[52:55], v134 offset:2048
v_mfma_f32_16x16x32_bf16 v[112:115], v[144:147], v[172:175], v[112:115]
ds_read_b128 v[56:59], v134 offset:4096
v_mfma_f32_16x16x32_bf16 v[68:71], v[148:151], v[160:163], v[68:71]
ds_read_b128 v[60:63], v134 offset:6144
v_mfma_f32_16x16x32_bf16 v[100:103], v[148:151], v[164:167], v[100:103]
ds_read_b128 v[36:39], v132 offset:2048
v_mfma_f32_16x16x32_bf16 v[84:87], v[148:151], v[168:171], v[84:87]
ds_read_b128 v[40:43], v132 offset:4096
v_mfma_f32_16x16x32_bf16 v[116:119], v[148:151], v[172:175], v[116:119]
ds_read_b128 v[44:47], v132 offset:6144
v_mfma_f32_16x16x32_bf16 v[72:75], v[152:155], v[160:163], v[72:75]
v_mfma_f32_16x16x32_bf16 v[104:107], v[152:155], v[164:167], v[104:107]
v_mfma_f32_16x16x32_bf16 v[88:91], v[152:155], v[168:171], v[88:91]
v_mfma_f32_16x16x32_bf16 v[120:123], v[152:155], v[172:175], v[120:123]
v_mfma_f32_16x16x32_bf16 v[76:79], v[156:159], v[160:163], v[76:79]
v_mfma_f32_16x16x32_bf16 v[108:111], v[156:159], v[164:167], v[108:111]
v_mfma_f32_16x16x32_bf16 v[92:95], v[156:159], v[168:171], v[92:95]
v_mfma_f32_16x16x32_bf16 v[124:127], v[156:159], v[172:175], v[124:127]
s_waitcnt lgkmcnt(6)
v_mfma_f32_16x16x32_bf16 v[64:67], v[32:35], v[48:51], v[64:67]
ds_read_b128 v[144:147], v133 offset:0
s_waitcnt lgkmcnt(6)
v_mfma_f32_16x16x32_bf16 v[96:99], v[32:35], v[52:55], v[96:99]
ds_read_b128 v[160:163], v135 offset:0
s_waitcnt lgkmcnt(6)
v_mfma_f32_16x16x32_bf16 v[80:83], v[32:35], v[56:59], v[80:83]
ds_read_b128 v[164:167], v135 offset:2048
s_waitcnt lgkmcnt(6)
v_mfma_f32_16x16x32_bf16 v[112:115], v[32:35], v[60:63], v[112:115]
ds_read_b128 v[168:171], v135 offset:4096
s_waitcnt lgkmcnt(6)
v_mfma_f32_16x16x32_bf16 v[68:71], v[36:39], v[48:51], v[68:71]
ds_read_b128 v[172:175], v135 offset:6144
v_mfma_f32_16x16x32_bf16 v[100:103], v[36:39], v[52:55], v[100:103]
ds_read_b128 v[148:151], v133 offset:2048
v_mfma_f32_16x16x32_bf16 v[84:87], v[36:39], v[56:59], v[84:87]
ds_read_b128 v[152:155], v133 offset:4096
v_mfma_f32_16x16x32_bf16 v[116:119], v[36:39], v[60:63], v[116:119]
ds_read_b128 v[156:159], v133 offset:6144
s_waitcnt lgkmcnt(9)
v_mfma_f32_16x16x32_bf16 v[72:75], v[40:43], v[48:51], v[72:75]
v_mfma_f32_16x16x32_bf16 v[104:107], v[40:43], v[52:55], v[104:107]
v_mfma_f32_16x16x32_bf16 v[88:91], v[40:43], v[56:59], v[88:91]
v_mfma_f32_16x16x32_bf16 v[120:123], v[40:43], v[60:63], v[120:123]
s_waitcnt lgkmcnt(8)
v_mfma_f32_16x16x32_bf16 v[76:79], v[44:47], v[48:51], v[76:79]
v_mfma_f32_16x16x32_bf16 v[108:111], v[44:47], v[52:55], v[108:111]
v_mfma_f32_16x16x32_bf16 v[92:95], v[44:47], v[56:59], v[92:95]
v_mfma_f32_16x16x32_bf16 v[124:127], v[44:47], v[60:63], v[124:127]
s_waitcnt lgkmcnt(0)
s_barrier
v_mfma_f32_16x16x32_bf16 v[64:67], v[144:147], v[160:163], v[64:67]
ds_read_b128 v[32:35], v128 offset:0
v_mfma_f32_16x16x32_bf16 v[96:99], v[144:147], v[164:167], v[96:99]
ds_read_b128 v[48:51], v130 offset:0
v_mfma_f32_16x16x32_bf16 v[80:83], v[144:147], v[168:171], v[80:83]
ds_read_b128 v[52:55], v130 offset:2048
v_mfma_f32_16x16x32_bf16 v[112:115], v[144:147], v[172:175], v[112:115]
ds_read_b128 v[56:59], v130 offset:4096
v_mfma_f32_16x16x32_bf16 v[68:71], v[148:151], v[160:163], v[68:71]
ds_read_b128 v[60:63], v130 offset:6144
v_mfma_f32_16x16x32_bf16 v[100:103], v[148:151], v[164:167], v[100:103]
ds_read_b128 v[36:39], v128 offset:2048
v_mfma_f32_16x16x32_bf16 v[84:87], v[148:151], v[168:171], v[84:87]
ds_read_b128 v[40:43], v128 offset:4096
v_mfma_f32_16x16x32_bf16 v[116:119], v[148:151], v[172:175], v[116:119]
ds_read_b128 v[44:47], v128 offset:6144
v_mfma_f32_16x16x32_bf16 v[72:75], v[152:155], v[160:163], v[72:75]
v_mfma_f32_16x16x32_bf16 v[104:107], v[152:155], v[164:167], v[104:107]
v_mfma_f32_16x16x32_bf16 v[88:91], v[152:155], v[168:171], v[88:91]
v_mfma_f32_16x16x32_bf16 v[120:123], v[152:155], v[172:175], v[120:123]
v_mfma_f32_16x16x32_bf16 v[76:79], v[156:159], v[160:163], v[76:79]
v_mfma_f32_16x16x32_bf16 v[108:111], v[156:159], v[164:167], v[108:111]
v_mfma_f32_16x16x32_bf16 v[92:95], v[156:159], v[168:171], v[92:95]
v_mfma_f32_16x16x32_bf16 v[124:127], v[156:159], v[172:175], v[124:127]
s_waitcnt lgkmcnt(6)
v_mfma_f32_16x16x32_bf16 v[64:67], v[32:35], v[48:51], v[64:67]
ds_read_b128 v[144:147], v129 offset:0
s_waitcnt lgkmcnt(6)
v_mfma_f32_16x16x32_bf16 v[96:99], v[32:35], v[52:55], v[96:99]
ds_read_b128 v[160:163], v131 offset:0
s_waitcnt lgkmcnt(6)
v_mfma_f32_16x16x32_bf16 v[80:83], v[32:35], v[56:59], v[80:83]
ds_read_b128 v[164:167], v131 offset:2048
s_waitcnt lgkmcnt(6)
v_mfma_f32_16x16x32_bf16 v[112:115], v[32:35], v[60:63], v[112:115]
ds_read_b128 v[168:171], v131 offset:4096
s_waitcnt lgkmcnt(6)
v_mfma_f32_16x16x32_bf16 v[68:71], v[36:39], v[48:51], v[68:71]
ds_read_b128 v[172:175], v131 offset:6144
v_mfma_f32_16x16x32_bf16 v[100:103], v[36:39], v[52:55], v[100:103]
ds_read_b128 v[148:151], v129 offset:2048
v_mfma_f32_16x16x32_bf16 v[84:87], v[36:39], v[56:59], v[84:87]
ds_read_b128 v[152:155], v129 offset:4096
v_mfma_f32_16x16x32_bf16 v[116:119], v[36:39], v[60:63], v[116:119]
ds_read_b128 v[156:159], v129 offset:6144
s_waitcnt lgkmcnt(9)
v_mfma_f32_16x16x32_bf16 v[72:75], v[40:43], v[48:51], v[72:75]
v_mfma_f32_16x16x32_bf16 v[104:107], v[40:43], v[52:55], v[104:107]
v_mfma_f32_16x16x32_bf16 v[88:91], v[40:43], v[56:59], v[88:91]
v_mfma_f32_16x16x32_bf16 v[120:123], v[40:43], v[60:63], v[120:123]
s_waitcnt lgkmcnt(8)
v_mfma_f32_16x16x32_bf16 v[76:79], v[44:47], v[48:51], v[76:79]
v_mfma_f32_16x16x32_bf16 v[108:111], v[44:47], v[52:55], v[108:111]
v_mfma_f32_16x16x32_bf16 v[92:95], v[44:47], v[56:59], v[92:95]
v_mfma_f32_16x16x32_bf16 v[124:127], v[44:47], v[60:63], v[124:127]
s_waitcnt lgkmcnt(0)
s_barrier
v_mfma_f32_16x16x32_bf16 v[64:67], v[144:147], v[160:163], v[64:67]
ds_read_b128 v[32:35], v128 offset:32768
v_mfma_f32_16x16x32_bf16 v[96:99], v[144:147], v[164:167], v[96:99]
ds_read_b128 v[48:51], v130 offset:32768
v_mfma_f32_16x16x32_bf16 v[80:83], v[144:147], v[168:171], v[80:83]
ds_read_b128 v[52:55], v130 offset:34816
v_mfma_f32_16x16x32_bf16 v[112:115], v[144:147], v[172:175], v[112:115]
ds_read_b128 v[56:59], v130 offset:36864
v_mfma_f32_16x16x32_bf16 v[68:71], v[148:151], v[160:163], v[68:71]
ds_read_b128 v[60:63], v130 offset:38912
v_mfma_f32_16x16x32_bf16 v[100:103], v[148:151], v[164:167], v[100:103]
ds_read_b128 v[36:39], v128 offset:34816
v_mfma_f32_16x16x32_bf16 v[84:87], v[148:151], v[168:171], v[84:87]
ds_read_b128 v[40:43], v128 offset:36864
v_mfma_f32_16x16x32_bf16 v[116:119], v[148:151], v[172:175], v[116:119]
ds_read_b128 v[44:47], v128 offset:38912
v_mfma_f32_16x16x32_bf16 v[72:75], v[152:155], v[160:163], v[72:75]
v_mfma_f32_16x16x32_bf16 v[104:107], v[152:155], v[164:167], v[104:107]
v_mfma_f32_16x16x32_bf16 v[88:91], v[152:155], v[168:171], v[88:91]
v_mfma_f32_16x16x32_bf16 v[120:123], v[152:155], v[172:175], v[120:123]
v_mfma_f32_16x16x32_bf16 v[76:79], v[156:159], v[160:163], v[76:79]
v_mfma_f32_16x16x32_bf16 v[108:111], v[156:159], v[164:167], v[108:111]
v_mfma_f32_16x16x32_bf16 v[92:95], v[156:159], v[168:171], v[92:95]
v_mfma_f32_16x16x32_bf16 v[124:127], v[156:159], v[172:175], v[124:127]
s_waitcnt lgkmcnt(6)
v_mfma_f32_16x16x32_bf16 v[64:67], v[32:35], v[48:51], v[64:67]
ds_read_b128 v[144:147], v129 offset:32768
s_waitcnt lgkmcnt(6)
v_mfma_f32_16x16x32_bf16 v[96:99], v[32:35], v[52:55], v[96:99]
ds_read_b128 v[160:163], v131 offset:32768
s_waitcnt lgkmcnt(6)
v_mfma_f32_16x16x32_bf16 v[80:83], v[32:35], v[56:59], v[80:83]
ds_read_b128 v[164:167], v131 offset:34816
s_waitcnt lgkmcnt(6)
v_mfma_f32_16x16x32_bf16 v[112:115], v[32:35], v[60:63], v[112:115]
ds_read_b128 v[168:171], v131 offset:36864
s_waitcnt lgkmcnt(6)
v_mfma_f32_16x16x32_bf16 v[68:71], v[36:39], v[48:51], v[68:71]
ds_read_b128 v[172:175], v131 offset:38912
v_mfma_f32_16x16x32_bf16 v[100:103], v[36:39], v[52:55], v[100:103]
ds_read_b128 v[148:151], v129 offset:34816
v_mfma_f32_16x16x32_bf16 v[84:87], v[36:39], v[56:59], v[84:87]
ds_read_b128 v[152:155], v129 offset:36864
v_mfma_f32_16x16x32_bf16 v[116:119], v[36:39], v[60:63], v[116:119]
ds_read_b128 v[156:159], v129 offset:38912
s_waitcnt lgkmcnt(9)
v_mfma_f32_16x16x32_bf16 v[72:75], v[40:43], v[48:51], v[72:75]
v_mfma_f32_16x16x32_bf16 v[104:107], v[40:43], v[52:55], v[104:107]
v_mfma_f32_16x16x32_bf16 v[88:91], v[40:43], v[56:59], v[88:91]
v_mfma_f32_16x16x32_bf16 v[120:123], v[40:43], v[60:63], v[120:123]
s_waitcnt lgkmcnt(8)
v_mfma_f32_16x16x32_bf16 v[76:79], v[44:47], v[48:51], v[76:79]
v_mfma_f32_16x16x32_bf16 v[108:111], v[44:47], v[52:55], v[108:111]
v_mfma_f32_16x16x32_bf16 v[92:95], v[44:47], v[56:59], v[92:95]
v_mfma_f32_16x16x32_bf16 v[124:127], v[44:47], v[60:63], v[124:127]
s_waitcnt lgkmcnt(0)
s_barrier
v_mfma_f32_16x16x32_bf16 v[64:67], v[144:147], v[160:163], v[64:67]
ds_read_b128 v[32:35], v132 offset:0
v_mfma_f32_16x16x32_bf16 v[96:99], v[144:147], v[164:167], v[96:99]
ds_read_b128 v[48:51], v134 offset:0
v_mfma_f32_16x16x32_bf16 v[80:83], v[144:147], v[168:171], v[80:83]
ds_read_b128 v[52:55], v134 offset:2048
v_mfma_f32_16x16x32_bf16 v[112:115], v[144:147], v[172:175], v[112:115]
ds_read_b128 v[56:59], v134 offset:4096
v_mfma_f32_16x16x32_bf16 v[68:71], v[148:151], v[160:163], v[68:71]
ds_read_b128 v[60:63], v134 offset:6144
v_mfma_f32_16x16x32_bf16 v[100:103], v[148:151], v[164:167], v[100:103]
ds_read_b128 v[36:39], v132 offset:2048
v_mfma_f32_16x16x32_bf16 v[84:87], v[148:151], v[168:171], v[84:87]
ds_read_b128 v[40:43], v132 offset:4096
v_mfma_f32_16x16x32_bf16 v[116:119], v[148:151], v[172:175], v[116:119]
ds_read_b128 v[44:47], v132 offset:6144
v_mfma_f32_16x16x32_bf16 v[72:75], v[152:155], v[160:163], v[72:75]
v_mfma_f32_16x16x32_bf16 v[104:107], v[152:155], v[164:167], v[104:107]
v_mfma_f32_16x16x32_bf16 v[88:91], v[152:155], v[168:171], v[88:91]
v_mfma_f32_16x16x32_bf16 v[120:123], v[152:155], v[172:175], v[120:123]
v_mfma_f32_16x16x32_bf16 v[76:79], v[156:159], v[160:163], v[76:79]
v_mfma_f32_16x16x32_bf16 v[108:111], v[156:159], v[164:167], v[108:111]
v_mfma_f32_16x16x32_bf16 v[92:95], v[156:159], v[168:171], v[92:95]
v_mfma_f32_16x16x32_bf16 v[124:127], v[156:159], v[172:175], v[124:127]
s_waitcnt lgkmcnt(6)
v_mfma_f32_16x16x32_bf16 v[64:67], v[32:35], v[48:51], v[64:67]
ds_read_b128 v[144:147], v133 offset:0
s_waitcnt lgkmcnt(6)
v_mfma_f32_16x16x32_bf16 v[96:99], v[32:35], v[52:55], v[96:99]
ds_read_b128 v[160:163], v135 offset:0
s_waitcnt lgkmcnt(6)
v_mfma_f32_16x16x32_bf16 v[80:83], v[32:35], v[56:59], v[80:83]
ds_read_b128 v[164:167], v135 offset:2048
s_waitcnt lgkmcnt(6)
v_mfma_f32_16x16x32_bf16 v[112:115], v[32:35], v[60:63], v[112:115]
ds_read_b128 v[168:171], v135 offset:4096
s_waitcnt lgkmcnt(6)
v_mfma_f32_16x16x32_bf16 v[68:71], v[36:39], v[48:51], v[68:71]
ds_read_b128 v[172:175], v135 offset:6144
v_mfma_f32_16x16x32_bf16 v[100:103], v[36:39], v[52:55], v[100:103]
ds_read_b128 v[148:151], v133 offset:2048
v_mfma_f32_16x16x32_bf16 v[84:87], v[36:39], v[56:59], v[84:87]
ds_read_b128 v[152:155], v133 offset:4096
v_mfma_f32_16x16x32_bf16 v[116:119], v[36:39], v[60:63], v[116:119]
ds_read_b128 v[156:159], v133 offset:6144
s_waitcnt lgkmcnt(9)
v_mfma_f32_16x16x32_bf16 v[72:75], v[40:43], v[48:51], v[72:75]
v_mfma_f32_16x16x32_bf16 v[104:107], v[40:43], v[52:55], v[104:107]
v_mfma_f32_16x16x32_bf16 v[88:91], v[40:43], v[56:59], v[88:91]
v_mfma_f32_16x16x32_bf16 v[120:123], v[40:43], v[60:63], v[120:123]
s_waitcnt lgkmcnt(8)
v_mfma_f32_16x16x32_bf16 v[76:79], v[44:47], v[48:51], v[76:79]
v_mfma_f32_16x16x32_bf16 v[108:111], v[44:47], v[52:55], v[108:111]
v_mfma_f32_16x16x32_bf16 v[92:95], v[44:47], v[56:59], v[92:95]
v_mfma_f32_16x16x32_bf16 v[124:127], v[44:47], v[60:63], v[124:127]
s_waitcnt lgkmcnt(0)
s_barrier
v_mfma_f32_16x16x32_bf16 v[64:67], v[144:147], v[160:163], v[64:67]
ds_read_b128 v[32:35], v128 offset:0
v_mfma_f32_16x16x32_bf16 v[96:99], v[144:147], v[164:167], v[96:99]
ds_read_b128 v[48:51], v130 offset:0
v_mfma_f32_16x16x32_bf16 v[80:83], v[144:147], v[168:171], v[80:83]
ds_read_b128 v[52:55], v130 offset:2048
v_mfma_f32_16x16x32_bf16 v[112:115], v[144:147], v[172:175], v[112:115]
ds_read_b128 v[56:59], v130 offset:4096
v_mfma_f32_16x16x32_bf16 v[68:71], v[148:151], v[160:163], v[68:71]
ds_read_b128 v[60:63], v130 offset:6144
v_mfma_f32_16x16x32_bf16 v[100:103], v[148:151], v[164:167], v[100:103]
ds_read_b128 v[36:39], v128 offset:2048
v_mfma_f32_16x16x32_bf16 v[84:87], v[148:151], v[168:171], v[84:87]
ds_read_b128 v[40:43], v128 offset:4096
v_mfma_f32_16x16x32_bf16 v[116:119], v[148:151], v[172:175], v[116:119]
ds_read_b128 v[44:47], v128 offset:6144
v_mfma_f32_16x16x32_bf16 v[72:75], v[152:155], v[160:163], v[72:75]
v_mfma_f32_16x16x32_bf16 v[104:107], v[152:155], v[164:167], v[104:107]
v_mfma_f32_16x16x32_bf16 v[88:91], v[152:155], v[168:171], v[88:91]
v_mfma_f32_16x16x32_bf16 v[120:123], v[152:155], v[172:175], v[120:123]
v_mfma_f32_16x16x32_bf16 v[76:79], v[156:159], v[160:163], v[76:79]
v_mfma_f32_16x16x32_bf16 v[108:111], v[156:159], v[164:167], v[108:111]
v_mfma_f32_16x16x32_bf16 v[92:95], v[156:159], v[168:171], v[92:95]
v_mfma_f32_16x16x32_bf16 v[124:127], v[156:159], v[172:175], v[124:127]
s_waitcnt lgkmcnt(6)
v_mfma_f32_16x16x32_bf16 v[64:67], v[32:35], v[48:51], v[64:67]
ds_read_b128 v[144:147], v129 offset:0
s_waitcnt lgkmcnt(6)
v_mfma_f32_16x16x32_bf16 v[96:99], v[32:35], v[52:55], v[96:99]
ds_read_b128 v[160:163], v131 offset:0
s_waitcnt lgkmcnt(6)
v_mfma_f32_16x16x32_bf16 v[80:83], v[32:35], v[56:59], v[80:83]
ds_read_b128 v[164:167], v131 offset:2048
s_waitcnt lgkmcnt(6)
v_mfma_f32_16x16x32_bf16 v[112:115], v[32:35], v[60:63], v[112:115]
ds_read_b128 v[168:171], v131 offset:4096
s_waitcnt lgkmcnt(6)
v_mfma_f32_16x16x32_bf16 v[68:71], v[36:39], v[48:51], v[68:71]
ds_read_b128 v[172:175], v131 offset:6144
v_mfma_f32_16x16x32_bf16 v[100:103], v[36:39], v[52:55], v[100:103]
ds_read_b128 v[148:151], v129 offset:2048
v_mfma_f32_16x16x32_bf16 v[84:87], v[36:39], v[56:59], v[84:87]
ds_read_b128 v[152:155], v129 offset:4096
v_mfma_f32_16x16x32_bf16 v[116:119], v[36:39], v[60:63], v[116:119]
ds_read_b128 v[156:159], v129 offset:6144
s_waitcnt lgkmcnt(9)
v_mfma_f32_16x16x32_bf16 v[72:75], v[40:43], v[48:51], v[72:75]
v_mfma_f32_16x16x32_bf16 v[104:107], v[40:43], v[52:55], v[104:107]
v_mfma_f32_16x16x32_bf16 v[88:91], v[40:43], v[56:59], v[88:91]
v_mfma_f32_16x16x32_bf16 v[120:123], v[40:43], v[60:63], v[120:123]
s_waitcnt lgkmcnt(8)
v_mfma_f32_16x16x32_bf16 v[76:79], v[44:47], v[48:51], v[76:79]
v_mfma_f32_16x16x32_bf16 v[108:111], v[44:47], v[52:55], v[108:111]
v_mfma_f32_16x16x32_bf16 v[92:95], v[44:47], v[56:59], v[92:95]
v_mfma_f32_16x16x32_bf16 v[124:127], v[44:47], v[60:63], v[124:127]
s_waitcnt lgkmcnt(0)
s_barrier
v_mfma_f32_16x16x32_bf16 v[64:67], v[144:147], v[160:163], v[64:67]
ds_read_b128 v[32:35], v128 offset:32768
v_mfma_f32_16x16x32_bf16 v[96:99], v[144:147], v[164:167], v[96:99]
ds_read_b128 v[48:51], v130 offset:32768
v_mfma_f32_16x16x32_bf16 v[80:83], v[144:147], v[168:171], v[80:83]
ds_read_b128 v[52:55], v130 offset:34816
v_mfma_f32_16x16x32_bf16 v[112:115], v[144:147], v[172:175], v[112:115]
ds_read_b128 v[56:59], v130 offset:36864
v_mfma_f32_16x16x32_bf16 v[68:71], v[148:151], v[160:163], v[68:71]
ds_read_b128 v[60:63], v130 offset:38912
v_mfma_f32_16x16x32_bf16 v[100:103], v[148:151], v[164:167], v[100:103]
ds_read_b128 v[36:39], v128 offset:34816
v_mfma_f32_16x16x32_bf16 v[84:87], v[148:151], v[168:171], v[84:87]
ds_read_b128 v[40:43], v128 offset:36864
v_mfma_f32_16x16x32_bf16 v[116:119], v[148:151], v[172:175], v[116:119]
ds_read_b128 v[44:47], v128 offset:38912
v_mfma_f32_16x16x32_bf16 v[72:75], v[152:155], v[160:163], v[72:75]
v_mfma_f32_16x16x32_bf16 v[104:107], v[152:155], v[164:167], v[104:107]
v_mfma_f32_16x16x32_bf16 v[88:91], v[152:155], v[168:171], v[88:91]
v_mfma_f32_16x16x32_bf16 v[120:123], v[152:155], v[172:175], v[120:123]
v_mfma_f32_16x16x32_bf16 v[76:79], v[156:159], v[160:163], v[76:79]
v_mfma_f32_16x16x32_bf16 v[108:111], v[156:159], v[164:167], v[108:111]
v_mfma_f32_16x16x32_bf16 v[92:95], v[156:159], v[168:171], v[92:95]
v_mfma_f32_16x16x32_bf16 v[124:127], v[156:159], v[172:175], v[124:127]
s_waitcnt lgkmcnt(6)
v_mfma_f32_16x16x32_bf16 v[64:67], v[32:35], v[48:51], v[64:67]
ds_read_b128 v[144:147], v129 offset:32768
s_waitcnt lgkmcnt(6)
v_mfma_f32_16x16x32_bf16 v[96:99], v[32:35], v[52:55], v[96:99]
ds_read_b128 v[160:163], v131 offset:32768
s_waitcnt lgkmcnt(6)
v_mfma_f32_16x16x32_bf16 v[80:83], v[32:35], v[56:59], v[80:83]
ds_read_b128 v[164:167], v131 offset:34816
s_waitcnt lgkmcnt(6)
v_mfma_f32_16x16x32_bf16 v[112:115], v[32:35], v[60:63], v[112:115]
ds_read_b128 v[168:171], v131 offset:36864
s_waitcnt lgkmcnt(6)
v_mfma_f32_16x16x32_bf16 v[68:71], v[36:39], v[48:51], v[68:71]
ds_read_b128 v[172:175], v131 offset:38912
v_mfma_f32_16x16x32_bf16 v[100:103], v[36:39], v[52:55], v[100:103]
ds_read_b128 v[148:151], v129 offset:34816
v_mfma_f32_16x16x32_bf16 v[84:87], v[36:39], v[56:59], v[84:87]
ds_read_b128 v[152:155], v129 offset:36864
v_mfma_f32_16x16x32_bf16 v[116:119], v[36:39], v[60:63], v[116:119]
ds_read_b128 v[156:159], v129 offset:38912
s_waitcnt lgkmcnt(9)
v_mfma_f32_16x16x32_bf16 v[72:75], v[40:43], v[48:51], v[72:75]
v_mfma_f32_16x16x32_bf16 v[104:107], v[40:43], v[52:55], v[104:107]
v_mfma_f32_16x16x32_bf16 v[88:91], v[40:43], v[56:59], v[88:91]
v_mfma_f32_16x16x32_bf16 v[120:123], v[40:43], v[60:63], v[120:123]
s_waitcnt lgkmcnt(8)
v_mfma_f32_16x16x32_bf16 v[76:79], v[44:47], v[48:51], v[76:79]
v_mfma_f32_16x16x32_bf16 v[108:111], v[44:47], v[52:55], v[108:111]
v_mfma_f32_16x16x32_bf16 v[92:95], v[44:47], v[56:59], v[92:95]
v_mfma_f32_16x16x32_bf16 v[124:127], v[44:47], v[60:63], v[124:127]
s_waitcnt lgkmcnt(0)
s_barrier
v_mfma_f32_16x16x32_bf16 v[64:67], v[144:147], v[160:163], v[64:67]
ds_read_b128 v[32:35], v132 offset:0
v_mfma_f32_16x16x32_bf16 v[96:99], v[144:147], v[164:167], v[96:99]
ds_read_b128 v[48:51], v134 offset:0
v_mfma_f32_16x16x32_bf16 v[80:83], v[144:147], v[168:171], v[80:83]
ds_read_b128 v[52:55], v134 offset:2048
v_mfma_f32_16x16x32_bf16 v[112:115], v[144:147], v[172:175], v[112:115]
ds_read_b128 v[56:59], v134 offset:4096
v_mfma_f32_16x16x32_bf16 v[68:71], v[148:151], v[160:163], v[68:71]
ds_read_b128 v[60:63], v134 offset:6144
v_mfma_f32_16x16x32_bf16 v[100:103], v[148:151], v[164:167], v[100:103]
ds_read_b128 v[36:39], v132 offset:2048
v_mfma_f32_16x16x32_bf16 v[84:87], v[148:151], v[168:171], v[84:87]
ds_read_b128 v[40:43], v132 offset:4096
v_mfma_f32_16x16x32_bf16 v[116:119], v[148:151], v[172:175], v[116:119]
ds_read_b128 v[44:47], v132 offset:6144
v_mfma_f32_16x16x32_bf16 v[72:75], v[152:155], v[160:163], v[72:75]
v_mfma_f32_16x16x32_bf16 v[104:107], v[152:155], v[164:167], v[104:107]
v_mfma_f32_16x16x32_bf16 v[88:91], v[152:155], v[168:171], v[88:91]
v_mfma_f32_16x16x32_bf16 v[120:123], v[152:155], v[172:175], v[120:123]
v_mfma_f32_16x16x32_bf16 v[76:79], v[156:159], v[160:163], v[76:79]
v_mfma_f32_16x16x32_bf16 v[108:111], v[156:159], v[164:167], v[108:111]
v_mfma_f32_16x16x32_bf16 v[92:95], v[156:159], v[168:171], v[92:95]
v_mfma_f32_16x16x32_bf16 v[124:127], v[156:159], v[172:175], v[124:127]
s_waitcnt lgkmcnt(6)
v_mfma_f32_16x16x32_bf16 v[64:67], v[32:35], v[48:51], v[64:67]
ds_read_b128 v[144:147], v133 offset:0
s_waitcnt lgkmcnt(6)
v_mfma_f32_16x16x32_bf16 v[96:99], v[32:35], v[52:55], v[96:99]
ds_read_b128 v[160:163], v135 offset:0
s_waitcnt lgkmcnt(6)
v_mfma_f32_16x16x32_bf16 v[80:83], v[32:35], v[56:59], v[80:83]
ds_read_b128 v[164:167], v135 offset:2048
s_waitcnt lgkmcnt(6)
v_mfma_f32_16x16x32_bf16 v[112:115], v[32:35], v[60:63], v[112:115]
ds_read_b128 v[168:171], v135 offset:4096
s_waitcnt lgkmcnt(6)
v_mfma_f32_16x16x32_bf16 v[68:71], v[36:39], v[48:51], v[68:71]
ds_read_b128 v[172:175], v135 offset:6144
v_mfma_f32_16x16x32_bf16 v[100:103], v[36:39], v[52:55], v[100:103]
ds_read_b128 v[148:151], v133 offset:2048
v_mfma_f32_16x16x32_bf16 v[84:87], v[36:39], v[56:59], v[84:87]
ds_read_b128 v[152:155], v133 offset:4096
v_mfma_f32_16x16x32_bf16 v[116:119], v[36:39], v[60:63], v[116:119]
ds_read_b128 v[156:159], v133 offset:6144
s_waitcnt lgkmcnt(9)
v_mfma_f32_16x16x32_bf16 v[72:75], v[40:43], v[48:51], v[72:75]
v_mfma_f32_16x16x32_bf16 v[104:107], v[40:43], v[52:55], v[104:107]
v_mfma_f32_16x16x32_bf16 v[88:91], v[40:43], v[56:59], v[88:91]
v_mfma_f32_16x16x32_bf16 v[120:123], v[40:43], v[60:63], v[120:123]
s_waitcnt lgkmcnt(8)
v_mfma_f32_16x16x32_bf16 v[76:79], v[44:47], v[48:51], v[76:79]
v_mfma_f32_16x16x32_bf16 v[108:111], v[44:47], v[52:55], v[108:111]
v_mfma_f32_16x16x32_bf16 v[92:95], v[44:47], v[56:59], v[92:95]
v_mfma_f32_16x16x32_bf16 v[124:127], v[44:47], v[60:63], v[124:127]
s_waitcnt lgkmcnt(0)
s_barrier
v_mfma_f32_16x16x32_bf16 v[64:67], v[144:147], v[160:163], v[64:67]
ds_read_b128 v[32:35], v128 offset:0
v_mfma_f32_16x16x32_bf16 v[96:99], v[144:147], v[164:167], v[96:99]
ds_read_b128 v[48:51], v130 offset:0
v_mfma_f32_16x16x32_bf16 v[80:83], v[144:147], v[168:171], v[80:83]
ds_read_b128 v[52:55], v130 offset:2048
v_mfma_f32_16x16x32_bf16 v[112:115], v[144:147], v[172:175], v[112:115]
ds_read_b128 v[56:59], v130 offset:4096
v_mfma_f32_16x16x32_bf16 v[68:71], v[148:151], v[160:163], v[68:71]
ds_read_b128 v[60:63], v130 offset:6144
v_mfma_f32_16x16x32_bf16 v[100:103], v[148:151], v[164:167], v[100:103]
ds_read_b128 v[36:39], v128 offset:2048
v_mfma_f32_16x16x32_bf16 v[84:87], v[148:151], v[168:171], v[84:87]
ds_read_b128 v[40:43], v128 offset:4096
v_mfma_f32_16x16x32_bf16 v[116:119], v[148:151], v[172:175], v[116:119]
ds_read_b128 v[44:47], v128 offset:6144
v_mfma_f32_16x16x32_bf16 v[72:75], v[152:155], v[160:163], v[72:75]
v_mfma_f32_16x16x32_bf16 v[104:107], v[152:155], v[164:167], v[104:107]
v_mfma_f32_16x16x32_bf16 v[88:91], v[152:155], v[168:171], v[88:91]
v_mfma_f32_16x16x32_bf16 v[120:123], v[152:155], v[172:175], v[120:123]
v_mfma_f32_16x16x32_bf16 v[76:79], v[156:159], v[160:163], v[76:79]
v_mfma_f32_16x16x32_bf16 v[108:111], v[156:159], v[164:167], v[108:111]
v_mfma_f32_16x16x32_bf16 v[92:95], v[156:159], v[168:171], v[92:95]
v_mfma_f32_16x16x32_bf16 v[124:127], v[156:159], v[172:175], v[124:127]
v_mov_b32 v8, 0
global_load_dword v9, v8, s[30:31] sc1
s_waitcnt lgkmcnt(6)
v_mfma_f32_16x16x32_bf16 v[64:67], v[32:35], v[48:51], v[64:67]
ds_read_b128 v[144:147], v129 offset:0
s_waitcnt lgkmcnt(6)
v_mfma_f32_16x16x32_bf16 v[96:99], v[32:35], v[52:55], v[96:99]
ds_read_b128 v[160:163], v131 offset:0
s_waitcnt lgkmcnt(6)
v_mfma_f32_16x16x32_bf16 v[80:83], v[32:35], v[56:59], v[80:83]
ds_read_b128 v[164:167], v131 offset:2048
s_waitcnt lgkmcnt(6)
v_mfma_f32_16x16x32_bf16 v[112:115], v[32:35], v[60:63], v[112:115]
ds_read_b128 v[168:171], v131 offset:4096
s_waitcnt lgkmcnt(6)
v_mfma_f32_16x16x32_bf16 v[68:71], v[36:39], v[48:51], v[68:71]
ds_read_b128 v[172:175], v131 offset:6144
v_mfma_f32_16x16x32_bf16 v[100:103], v[36:39], v[52:55], v[100:103]
ds_read_b128 v[148:151], v129 offset:2048
v_mfma_f32_16x16x32_bf16 v[84:87], v[36:39], v[56:59], v[84:87]
ds_read_b128 v[152:155], v129 offset:4096
v_mfma_f32_16x16x32_bf16 v[116:119], v[36:39], v[60:63], v[116:119]
ds_read_b128 v[156:159], v129 offset:6144
s_waitcnt lgkmcnt(9)
v_mfma_f32_16x16x32_bf16 v[72:75], v[40:43], v[48:51], v[72:75]
v_mfma_f32_16x16x32_bf16 v[104:107], v[40:43], v[52:55], v[104:107]
v_mfma_f32_16x16x32_bf16 v[88:91], v[40:43], v[56:59], v[88:91]
v_mfma_f32_16x16x32_bf16 v[120:123], v[40:43], v[60:63], v[120:123]
s_waitcnt lgkmcnt(8)
v_mfma_f32_16x16x32_bf16 v[76:79], v[44:47], v[48:51], v[76:79]
v_mfma_f32_16x16x32_bf16 v[108:111], v[44:47], v[52:55], v[108:111]
v_mfma_f32_16x16x32_bf16 v[92:95], v[44:47], v[56:59], v[92:95]
v_mfma_f32_16x16x32_bf16 v[124:127], v[44:47], v[60:63], v[124:127]
s_waitcnt lgkmcnt(0)
s_barrier
v_mfma_f32_16x16x32_bf16 v[64:67], v[144:147], v[160:163], v[64:67]
ds_read_b128 v[32:35], v128 offset:32768
v_mfma_f32_16x16x32_bf16 v[96:99], v[144:147], v[164:167], v[96:99]
ds_read_b128 v[48:51], v130 offset:32768
v_mfma_f32_16x16x32_bf16 v[80:83], v[144:147], v[168:171], v[80:83]
ds_read_b128 v[52:55], v130 offset:34816
v_mfma_f32_16x16x32_bf16 v[112:115], v[144:147], v[172:175], v[112:115]
ds_read_b128 v[56:59], v130 offset:36864
v_mfma_f32_16x16x32_bf16 v[68:71], v[148:151], v[160:163], v[68:71]
ds_read_b128 v[60:63], v130 offset:38912
v_mfma_f32_16x16x32_bf16 v[100:103], v[148:151], v[164:167], v[100:103]
ds_read_b128 v[36:39], v128 offset:34816
v_mfma_f32_16x16x32_bf16 v[84:87], v[148:151], v[168:171], v[84:87]
ds_read_b128 v[40:43], v128 offset:36864
v_mfma_f32_16x16x32_bf16 v[116:119], v[148:151], v[172:175], v[116:119]
ds_read_b128 v[44:47], v128 offset:38912
v_mfma_f32_16x16x32_bf16 v[72:75], v[152:155], v[160:163], v[72:75]
v_mfma_f32_16x16x32_bf16 v[104:107], v[152:155], v[164:167], v[104:107]
v_mfma_f32_16x16x32_bf16 v[88:91], v[152:155], v[168:171], v[88:91]
v_mfma_f32_16x16x32_bf16 v[120:123], v[152:155], v[172:175], v[120:123]
v_mfma_f32_16x16x32_bf16 v[76:79], v[156:159], v[160:163], v[76:79]
v_mfma_f32_16x16x32_bf16 v[108:111], v[156:159], v[164:167], v[108:111]
v_mfma_f32_16x16x32_bf16 v[92:95], v[156:159], v[168:171], v[92:95]
v_mfma_f32_16x16x32_bf16 v[124:127], v[156:159], v[172:175], v[124:127]
s_waitcnt lgkmcnt(6)
v_mfma_f32_16x16x32_bf16 v[64:67], v[32:35], v[48:51], v[64:67]
ds_read_b128 v[144:147], v129 offset:32768
s_waitcnt lgkmcnt(6)
v_mfma_f32_16x16x32_bf16 v[96:99], v[32:35], v[52:55], v[96:99]
ds_read_b128 v[160:163], v131 offset:32768
s_waitcnt lgkmcnt(6)
v_mfma_f32_16x16x32_bf16 v[80:83], v[32:35], v[56:59], v[80:83]
ds_read_b128 v[164:167], v131 offset:34816
s_waitcnt lgkmcnt(6)
v_mfma_f32_16x16x32_bf16 v[112:115], v[32:35], v[60:63], v[112:115]
ds_read_b128 v[168:171], v131 offset:36864
s_waitcnt lgkmcnt(6)
v_mfma_f32_16x16x32_bf16 v[68:71], v[36:39], v[48:51], v[68:71]
ds_read_b128 v[172:175], v131 offset:38912
v_mfma_f32_16x16x32_bf16 v[100:103], v[36:39], v[52:55], v[100:103]
ds_read_b128 v[148:151], v129 offset:34816
v_mfma_f32_16x16x32_bf16 v[84:87], v[36:39], v[56:59], v[84:87]
ds_read_b128 v[152:155], v129 offset:36864
v_mfma_f32_16x16x32_bf16 v[116:119], v[36:39], v[60:63], v[116:119]
ds_read_b128 v[156:159], v129 offset:38912
s_waitcnt lgkmcnt(9)
v_mfma_f32_16x16x32_bf16 v[72:75], v[40:43], v[48:51], v[72:75]
v_mfma_f32_16x16x32_bf16 v[104:107], v[40:43], v[52:55], v[104:107]
v_mfma_f32_16x16x32_bf16 v[88:91], v[40:43], v[56:59], v[88:91]
v_mfma_f32_16x16x32_bf16 v[120:123], v[40:43], v[60:63], v[120:123]
s_waitcnt lgkmcnt(8)
v_mfma_f32_16x16x32_bf16 v[76:79], v[44:47], v[48:51], v[76:79]
v_mfma_f32_16x16x32_bf16 v[108:111], v[44:47], v[52:55], v[108:111]
v_mfma_f32_16x16x32_bf16 v[92:95], v[44:47], v[56:59], v[92:95]
v_mfma_f32_16x16x32_bf16 v[124:127], v[44:47], v[60:63], v[124:127]
s_waitcnt lgkmcnt(0)
s_barrier
v_mfma_f32_16x16x32_bf16 v[64:67], v[144:147], v[160:163], v[64:67]
ds_read_b128 v[32:35], v132 offset:0
v_mfma_f32_16x16x32_bf16 v[96:99], v[144:147], v[164:167], v[96:99]
ds_read_b128 v[48:51], v134 offset:0
v_mfma_f32_16x16x32_bf16 v[80:83], v[144:147], v[168:171], v[80:83]
ds_read_b128 v[52:55], v134 offset:2048
v_mfma_f32_16x16x32_bf16 v[112:115], v[144:147], v[172:175], v[112:115]
ds_read_b128 v[56:59], v134 offset:4096
v_mfma_f32_16x16x32_bf16 v[68:71], v[148:151], v[160:163], v[68:71]
ds_read_b128 v[60:63], v134 offset:6144
v_mfma_f32_16x16x32_bf16 v[100:103], v[148:151], v[164:167], v[100:103]
ds_read_b128 v[36:39], v132 offset:2048
v_mfma_f32_16x16x32_bf16 v[84:87], v[148:151], v[168:171], v[84:87]
ds_read_b128 v[40:43], v132 offset:4096
v_mfma_f32_16x16x32_bf16 v[116:119], v[148:151], v[172:175], v[116:119]
ds_read_b128 v[44:47], v132 offset:6144
v_mfma_f32_16x16x32_bf16 v[72:75], v[152:155], v[160:163], v[72:75]
v_mfma_f32_16x16x32_bf16 v[104:107], v[152:155], v[164:167], v[104:107]
v_mfma_f32_16x16x32_bf16 v[88:91], v[152:155], v[168:171], v[88:91]
v_mfma_f32_16x16x32_bf16 v[120:123], v[152:155], v[172:175], v[120:123]
v_mfma_f32_16x16x32_bf16 v[76:79], v[156:159], v[160:163], v[76:79]
v_mfma_f32_16x16x32_bf16 v[108:111], v[156:159], v[164:167], v[108:111]
v_mfma_f32_16x16x32_bf16 v[92:95], v[156:159], v[168:171], v[92:95]
v_mfma_f32_16x16x32_bf16 v[124:127], v[156:159], v[172:175], v[124:127]
s_waitcnt lgkmcnt(6)
v_mfma_f32_16x16x32_bf16 v[64:67], v[32:35], v[48:51], v[64:67]
ds_read_b128 v[144:147], v133 offset:0
s_waitcnt lgkmcnt(6)
v_mfma_f32_16x16x32_bf16 v[96:99], v[32:35], v[52:55], v[96:99]
ds_read_b128 v[160:163], v135 offset:0
s_waitcnt lgkmcnt(6)
v_mfma_f32_16x16x32_bf16 v[80:83], v[32:35], v[56:59], v[80:83]
ds_read_b128 v[164:167], v135 offset:2048
s_waitcnt lgkmcnt(6)
v_mfma_f32_16x16x32_bf16 v[112:115], v[32:35], v[60:63], v[112:115]
ds_read_b128 v[168:171], v135 offset:4096
s_waitcnt lgkmcnt(6)
v_mfma_f32_16x16x32_bf16 v[68:71], v[36:39], v[48:51], v[68:71]
ds_read_b128 v[172:175], v135 offset:6144
v_mfma_f32_16x16x32_bf16 v[100:103], v[36:39], v[52:55], v[100:103]
ds_read_b128 v[148:151], v133 offset:2048
v_mfma_f32_16x16x32_bf16 v[84:87], v[36:39], v[56:59], v[84:87]
ds_read_b128 v[152:155], v133 offset:4096
v_mfma_f32_16x16x32_bf16 v[116:119], v[36:39], v[60:63], v[116:119]
ds_read_b128 v[156:159], v133 offset:6144
s_waitcnt lgkmcnt(9)
v_mfma_f32_16x16x32_bf16 v[72:75], v[40:43], v[48:51], v[72:75]
v_mfma_f32_16x16x32_bf16 v[104:107], v[40:43], v[52:55], v[104:107]
v_mfma_f32_16x16x32_bf16 v[88:91], v[40:43], v[56:59], v[88:91]
v_mfma_f32_16x16x32_bf16 v[120:123], v[40:43], v[60:63], v[120:123]
s_waitcnt lgkmcnt(8)
v_mfma_f32_16x16x32_bf16 v[76:79], v[44:47], v[48:51], v[76:79]
v_mfma_f32_16x16x32_bf16 v[108:111], v[44:47], v[52:55], v[108:111]
v_mfma_f32_16x16x32_bf16 v[92:95], v[44:47], v[56:59], v[92:95]
v_mfma_f32_16x16x32_bf16 v[124:127], v[44:47], v[60:63], v[124:127]
s_waitcnt lgkmcnt(0)
s_barrier
v_mfma_f32_16x16x32_bf16 v[64:67], v[144:147], v[160:163], v[64:67]
ds_read_b128 v[32:35], v128 offset:0
v_mfma_f32_16x16x32_bf16 v[96:99], v[144:147], v[164:167], v[96:99]
ds_read_b128 v[48:51], v130 offset:0
v_mfma_f32_16x16x32_bf16 v[80:83], v[144:147], v[168:171], v[80:83]
ds_read_b128 v[52:55], v130 offset:2048
v_mfma_f32_16x16x32_bf16 v[112:115], v[144:147], v[172:175], v[112:115]
ds_read_b128 v[56:59], v130 offset:4096
v_mfma_f32_16x16x32_bf16 v[68:71], v[148:151], v[160:163], v[68:71]
ds_read_b128 v[60:63], v130 offset:6144
v_mfma_f32_16x16x32_bf16 v[100:103], v[148:151], v[164:167], v[100:103]
ds_read_b128 v[36:39], v128 offset:2048
v_mfma_f32_16x16x32_bf16 v[84:87], v[148:151], v[168:171], v[84:87]
ds_read_b128 v[40:43], v128 offset:4096
v_mfma_f32_16x16x32_bf16 v[116:119], v[148:151], v[172:175], v[116:119]
ds_read_b128 v[44:47], v128 offset:6144
v_mfma_f32_16x16x32_bf16 v[72:75], v[152:155], v[160:163], v[72:75]
v_mfma_f32_16x16x32_bf16 v[104:107], v[152:155], v[164:167], v[104:107]
v_mfma_f32_16x16x32_bf16 v[88:91], v[152:155], v[168:171], v[88:91]
v_mfma_f32_16x16x32_bf16 v[120:123], v[152:155], v[172:175], v[120:123]
v_mfma_f32_16x16x32_bf16 v[76:79], v[156:159], v[160:163], v[76:79]
v_mfma_f32_16x16x32_bf16 v[108:111], v[156:159], v[164:167], v[108:111]
v_mfma_f32_16x16x32_bf16 v[92:95], v[156:159], v[168:171], v[92:95]
v_mfma_f32_16x16x32_bf16 v[124:127], v[156:159], v[172:175], v[124:127]
s_waitcnt lgkmcnt(6)
v_mfma_f32_16x16x32_bf16 v[64:67], v[32:35], v[48:51], v[64:67]
ds_read_b128 v[144:147], v129 offset:0
s_waitcnt lgkmcnt(6)
v_mfma_f32_16x16x32_bf16 v[96:99], v[32:35], v[52:55], v[96:99]
ds_read_b128 v[160:163], v131 offset:0
s_waitcnt lgkmcnt(6)
v_mfma_f32_16x16x32_bf16 v[80:83], v[32:35], v[56:59], v[80:83]
ds_read_b128 v[164:167], v131 offset:2048
s_waitcnt lgkmcnt(6)
v_mfma_f32_16x16x32_bf16 v[112:115], v[32:35], v[60:63], v[112:115]
ds_read_b128 v[168:171], v131 offset:4096
s_waitcnt lgkmcnt(6)
v_mfma_f32_16x16x32_bf16 v[68:71], v[36:39], v[48:51], v[68:71]
ds_read_b128 v[172:175], v131 offset:6144
v_mfma_f32_16x16x32_bf16 v[100:103], v[36:39], v[52:55], v[100:103]
ds_read_b128 v[148:151], v129 offset:2048
v_mfma_f32_16x16x32_bf16 v[84:87], v[36:39], v[56:59], v[84:87]
ds_read_b128 v[152:155], v129 offset:4096
v_mfma_f32_16x16x32_bf16 v[116:119], v[36:39], v[60:63], v[116:119]
ds_read_b128 v[156:159], v129 offset:6144
s_waitcnt lgkmcnt(9)
v_mfma_f32_16x16x32_bf16 v[72:75], v[40:43], v[48:51], v[72:75]
v_mfma_f32_16x16x32_bf16 v[104:107], v[40:43], v[52:55], v[104:107]
v_mfma_f32_16x16x32_bf16 v[88:91], v[40:43], v[56:59], v[88:91]
v_mfma_f32_16x16x32_bf16 v[120:123], v[40:43], v[60:63], v[120:123]
s_waitcnt lgkmcnt(8)
v_mfma_f32_16x16x32_bf16 v[76:79], v[44:47], v[48:51], v[76:79]
v_mfma_f32_16x16x32_bf16 v[108:111], v[44:47], v[52:55], v[108:111]
v_mfma_f32_16x16x32_bf16 v[92:95], v[44:47], v[56:59], v[92:95]
v_mfma_f32_16x16x32_bf16 v[124:127], v[44:47], v[60:63], v[124:127]
L_n41:
s_waitcnt vmcnt(0)
v_readfirstlane_b32 s37, v9
s_nop 0
s_cmp_lg_u32 s37, 0
s_cbranch_scc1 L_ng42
global_load_dword v9, v8, s[30:31] sc1
s_branch L_n41
L_ng42:
s_getreg_b32 s60, hwreg(HW_REG_XCC_ID, 0, 4)
s_lshl_b32 s61, s37, 4
s_or_b32 s100, s60, s61
v_mov_b32 v194, s100
v_mov_b32 v202, s37
v_mov_b32 v203, s37
s_waitcnt lgkmcnt(0)
s_barrier
v_mfma_f32_16x16x32_bf16 v[64:67], v[144:147], v[160:163], v[64:67]
v_mfma_f32_16x16x32_bf16 v[96:99], v[144:147], v[164:167], v[96:99]
v_mfma_f32_16x16x32_bf16 v[80:83], v[144:147], v[168:171], v[80:83]
v_mfma_f32_16x16x32_bf16 v[112:115], v[144:147], v[172:175], v[112:115]
v_mfma_f32_16x16x32_bf16 v[68:71], v[148:151], v[160:163], v[68:71]
v_mfma_f32_16x16x32_bf16 v[100:103], v[148:151], v[164:167], v[100:103]
v_mfma_f32_16x16x32_bf16 v[84:87], v[148:151], v[168:171], v[84:87]
v_mfma_f32_16x16x32_bf16 v[116:119], v[148:151], v[172:175], v[116:119]
v_mfma_f32_16x16x32_bf16 v[72:75], v[152:155], v[160:163], v[72:75]
v_mfma_f32_16x16x32_bf16 v[104:107], v[152:155], v[164:167], v[104:107]
v_mfma_f32_16x16x32_bf16 v[88:91], v[152:155], v[168:171], v[88:91]
v_mfma_f32_16x16x32_bf16 v[120:123], v[152:155], v[172:175], v[120:123]
v_mfma_f32_16x16x32_bf16 v[76:79], v[156:159], v[160:163], v[76:79]
v_mfma_f32_16x16x32_bf16 v[108:111], v[156:159], v[164:167], v[108:111]
v_mfma_f32_16x16x32_bf16 v[92:95], v[156:159], v[168:171], v[92:95]
v_mfma_f32_16x16x32_bf16 v[124:127], v[156:159], v[172:175], v[124:127]
v_pk_fma_f32 v[40:41], v[20:21], v[64:65], v[66:67] op_sel_hi:[0,1,1]
v_pk_fma_f32 v[42:43], v[20:21], v[80:81], v[82:83] op_sel_hi:[0,1,1]
v_pk_fma_f32 v[44:45], v[22:23], v[96:97], v[98:99] op_sel_hi:[0,1,1]
v_pk_fma_f32 v[46:47], v[22:23], v[112:113], v[114:115] op_sel_hi:[0,1,1]
v_pk_fma_f32 v[66:67], v[20:21], v[80:81], v[40:41] op_sel:[1,0,0] neg_lo:[1,0,0] neg_hi:[1,0,0]
v_pk_fma_f32 v[82:83], v[20:21], v[64:65], v[42:43] op_sel:[1,0,0]
v_pk_fma_f32 v[98:99], v[22:23], v[112:113], v[44:45] op_sel:[1,0,0] neg_lo:[1,0,0] neg_hi:[1,0,0]
v_pk_fma_f32 v[114:115], v[22:23], v[96:97], v[46:47] op_sel:[1,0,0]
v_pk_fma_f32 v[40:41], v[20:21], v[66:67], v[68:69] op_sel_hi:[0,1,1]
v_pk_fma_f32 v[42:43], v[20:21], v[82:83], v[84:85] op_sel_hi:[0,1,1]
v_pk_fma_f32 v[44:45], v[22:23], v[98:99], v[100:101] op_sel_hi:[0,1,1]
v_pk_fma_f32 v[46:47], v[22:23], v[114:115], v[116:117] op_sel_hi:[0,1,1]
v_pk_fma_f32 v[68:69], v[20:21], v[82:83], v[40:41] op_sel:[1,0,0] neg_lo:[1,0,0] neg_hi:[1,0,0]
v_pk_fma_f32 v[84:85], v[20:21], v[66:67], v[42:43] op_sel:[1,0,0]
v_pk_fma_f32 v[100:101], v[22:23], v[114:115], v[44:45] op_sel:[1,0,0] neg_lo:[1,0,0] neg_hi:[1,0,0]
v_pk_fma_f32 v[116:117], v[22:23], v[98:99], v[46:47] op_sel:[1,0,0]
v_pk_fma_f32 v[40:41], v[20:21], v[68:69], v[70:71] op_sel_hi:[0,1,1]
v_pk_fma_f32 v[42:43], v[20:21], v[84:85], v[86:87] op_sel_hi:[0,1,1]
v_pk_fma_f32 v[44:45], v[22:23], v[100:101], v[102:103] op_sel_hi:[0,1,1]
v_pk_fma_f32 v[46:47], v[22:23], v[116:117], v[118:119] op_sel_hi:[0,1,1]
v_pk_fma_f32 v[70:71], v[20:21], v[84:85], v[40:41] op_sel:[1,0,0] neg_lo:[1,0,0] neg_hi:[1,0,0]
v_pk_fma_f32 v[86:87], v[20:21], v[68:69], v[42:43] op_sel:[1,0,0]
v_pk_fma_f32 v[102:103], v[22:23], v[116:117], v[44:45] op_sel:[1,0,0] neg_lo:[1,0,0] neg_hi:[1,0,0]
v_pk_fma_f32 v[118:119], v[22:23], v[100:101], v[46:47] op_sel:[1,0,0]
v_pk_fma_f32 v[40:41], v[20:21], v[70:71], v[72:73] op_sel_hi:[0,1,1]
v_pk_fma_f32 v[42:43], v[20:21], v[86:87], v[88:89] op_sel_hi:[0,1,1]
v_pk_fma_f32 v[44:45], v[22:23], v[102:103], v[104:105] op_sel_hi:[0,1,1]
v_pk_fma_f32 v[46:47], v[22:23], v[118:119], v[120:121] op_sel_hi:[0,1,1]
v_pk_fma_f32 v[72:73], v[20:21], v[86:87], v[40:41] op_sel:[1,0,0] neg_lo:[1,0,0] neg_hi:[1,0,0]
v_pk_fma_f32 v[88:89], v[20:21], v[70:71], v[42:43] op_sel:[1,0,0]
v_pk_fma_f32 v[104:105], v[22:23], v[118:119], v[44:45] op_sel:[1,0,0] neg_lo:[1,0,0] neg_hi:[1,0,0]
v_pk_fma_f32 v[120:121], v[22:23], v[102:103], v[46:47] op_sel:[1,0,0]
v_pk_fma_f32 v[40:41], v[20:21], v[72:73], v[74:75] op_sel_hi:[0,1,1]
v_pk_fma_f32 v[42:43], v[20:21], v[88:89], v[90:91] op_sel_hi:[0,1,1]
v_pk_fma_f32 v[44:45], v[22:23], v[104:105], v[106:107] op_sel_hi:[0,1,1]
v_pk_fma_f32 v[46:47], v[22:23], v[120:121], v[122:123] op_sel_hi:[0,1,1]
v_pk_fma_f32 v[74:75], v[20:21], v[88:89], v[40:41] op_sel:[1,0,0] neg_lo:[1,0,0] neg_hi:[1,0,0]
v_pk_fma_f32 v[90:91], v[20:21], v[72:73], v[42:43] op_sel:[1,0,0]
v_pk_fma_f32 v[106:107], v[22:23], v[120:121], v[44:45] op_sel:[1,0,0] neg_lo:[1,0,0] neg_hi:[1,0,0]
v_pk_fma_f32 v[122:123], v[22:23], v[104:105], v[46:47] op_sel:[1,0,0]
v_pk_fma_f32 v[40:41], v[20:21], v[74:75], v[76:77] op_sel_hi:[0,1,1]
v_pk_fma_f32 v[42:43], v[20:21], v[90:91], v[92:93] op_sel_hi:[0,1,1]
v_pk_fma_f32 v[44:45], v[22:23], v[106:107], v[108:109] op_sel_hi:[0,1,1]
v_pk_fma_f32 v[46:47], v[22:23], v[122:123], v[124:125] op_sel_hi:[0,1,1]
v_pk_fma_f32 v[76:77], v[20:21], v[90:91], v[40:41] op_sel:[1,0,0] neg_lo:[1,0,0] neg_hi:[1,0,0]
v_pk_fma_f32 v[92:93], v[20:21], v[74:75], v[42:43] op_sel:[1,0,0]
v_pk_fma_f32 v[108:109], v[22:23], v[122:123], v[44:45] op_sel:[1,0,0] neg_lo:[1,0,0] neg_hi:[1,0,0]
v_pk_fma_f32 v[124:125], v[22:23], v[106:107], v[46:47] op_sel:[1,0,0]
v_pk_fma_f32 v[40:41], v[20:21], v[76:77], v[78:79] op_sel_hi:[0,1,1]
v_pk_fma_f32 v[42:43], v[20:21], v[92:93], v[94:95] op_sel_hi:[0,1,1]
v_pk_fma_f32 v[44:45], v[22:23], v[108:109], v[110:111] op_sel_hi:[0,1,1]
v_pk_fma_f32 v[46:47], v[22:23], v[124:125], v[126:127] op_sel_hi:[0,1,1]
v_pk_fma_f32 v[78:79], v[20:21], v[92:93], v[40:41] op_sel:[1,0,0] neg_lo:[1,0,0] neg_hi:[1,0,0]
v_pk_fma_f32 v[94:95], v[20:21], v[76:77], v[42:43] op_sel:[1,0,0]
v_pk_fma_f32 v[110:111], v[22:23], v[124:125], v[44:45] op_sel:[1,0,0] neg_lo:[1,0,0] neg_hi:[1,0,0]
v_pk_fma_f32 v[126:127], v[22:23], v[108:109], v[46:47] op_sel:[1,0,0]
v_fma_f32 v40, v176, v78, v79
v_fma_f32 v41, v176, v94, v95
v_fma_f32 v32, -v177, v94, v40
v_fma_f32 v33, v177, v78, v41
ds_write_b64 v15, v[32:33] offset:0
v_fma_f32 v40, v178, v110, v111
v_fma_f32 v41, v178, v126, v127
v_fma_f32 v34, -v179, v126, v40
v_fma_f32 v35, v179, v110, v41
ds_write_b64 v15, v[34:35] offset:2304
s_waitcnt lgkmcnt(0)
s_barrier
ds_read_b128 v[48:51], v14
ds_read_b128 v[52:55], v14 offset:16
s_waitcnt lgkmcnt(1)
v_fma_f32 v40, v28, v48, v50
v_fma_f32 v41, v28, v49, v51
v_fma_f32 v32, -v29, v49, v40
v_fma_f32 v33, v29, v48, v41
s_waitcnt lgkmcnt(0)
v_fma_f32 v40, v28, v32, v52
v_fma_f32 v41, v28, v33, v53
v_fma_f32 v34, -v29, v33, v40
v_fma_f32 v35, v29, v32, v41
v_fma_f32 v40, v28, v34, v54
v_fma_f32 v41, v28, v35, v55
v_fma_f32 v32, -v29, v35, v40
v_fma_f32 v33, v29, v34, v41
v_mov_b32 v34, v32
v_mov_b32 v35, v33
s_nop 0
v_permlane32_swap_b32 v32, v34
v_permlane32_swap_b32 v33, v35
v_fma_f32 v40, v192, v32, v34
v_fma_f32 v41, v192, v33, v35
v_fma_f32 v200, -v193, v33, v40
v_fma_f32 v201, v193, v32, v41
s_cmp_lg_u32 s68, 0
s_cbranch_scc1 L_np43
buffer_store_dwordx4 v[200:203], v16, s[40:43], 0 offen sc1
s_cmp_lg_u32 s66, 0
s_cbranch_scc1 L_np43
s_mov_b64 exec, 1
global_store_dword v195, v194, s[32:33] sc1
s_mov_b64 exec, -1
L_np43:
global_load_dword v243, v18, s[32:33] sc1
v_add_u32 v15, -56, v15
ds_read_b64 v[32:33], v15 offset:0
ds_read_b64 v[34:35], v15 offset:8
ds_read_b64 v[36:37], v15 offset:16
ds_read_b64 v[38:39], v15 offset:24
ds_read_b64 v[40:41], v15 offset:32
ds_read_b64 v[42:43], v15 offset:40
ds_read_b64 v[44:45], v15 offset:48
ds_read_b64 v[46:47], v15 offset:2304
ds_read_b64 v[48:49], v15 offset:2312
ds_read_b64 v[50:51], v15 offset:2320
ds_read_b64 v[52:53], v15 offset:2328
ds_read_b64 v[54:55], v15 offset:2336
ds_read_b64 v[56:57], v15 offset:2344
ds_read_b64 v[58:59], v15 offset:2352
s_waitcnt lgkmcnt(0)
v_fma_f32 v60, v180, v32, v34
v_fma_f32 v61, v180, v33, v35
v_fma_f32 v34, -v181, v33, v60
v_fma_f32 v35, v181, v32, v61
v_fma_f32 v60, v180, v34, v36
v_fma_f32 v61, v180, v35, v37
v_fma_f32 v36, -v181, v35, v60
v_fma_f32 v37, v181, v34, v61
v_fma_f32 v60, v180, v36, v38
v_fma_f32 v61, v180, v37, v39
v_fma_f32 v38, -v181, v37, v60
v_fma_f32 v39, v181, v36, v61
v_fma_f32 v60, v180, v38, v40
v_fma_f32 v61, v180, v39, v41
v_fma_f32 v40, -v181, v39, v60
v_fma_f32 v41, v181, v38, v61
v_fma_f32 v60, v180, v40, v42
v_fma_f32 v61, v180, v41, v43
v_fma_f32 v42, -v181, v41, v60
v_fma_f32 v43, v181, v40, v61
v_fma_f32 v60, v180, v42, v44
v_fma_f32 v61, v180, v43, v45
v_fma_f32 v128, -v181, v43, v60
v_fma_f32 v130, v181, v42, v61
v_fma_f32 v60, v176, v128, v78
v_fma_f32 v61, v176, v130, v94
v_fma_f32 v129, -v177, v130, v60
v_fma_f32 v131, v177, v128, v61
v_fma_f32 v60, v182, v46, v48
v_fma_f32 v61, v182, v47, v49
v_fma_f32 v48, -v183, v47, v60
v_fma_f32 v49, v183, v46, v61
v_fma_f32 v60, v182, v48, v50
v_fma_f32 v61, v182, v49, v51
v_fma_f32 v50, -v183, v49, v60
v_fma_f32 v51, v183, v48, v61
v_fma_f32 v60, v182, v50, v52
v_fma_f32 v61, v182, v51, v53
v_fma_f32 v52, -v183, v51, v60
v_fma_f32 v53, v183, v50, v61
v_fma_f32 v60, v182, v52, v54
v_fma_f32 v61, v182, v53, v55
v_fma_f32 v54, -v183, v53, v60
v_fma_f32 v55, v183, v52, v61
v_fma_f32 v60, v182, v54, v56
v_fma_f32 v61, v182, v55, v57
v_fma_f32 v56, -v183, v55, v60
v_fma_f32 v57, v183, v54, v61
v_fma_f32 v60, v182, v56, v58
v_fma_f32 v61, v182, v57, v59
v_fma_f32 v132, -v183, v57, v60
v_fma_f32 v134, v183, v56, v61
v_fma_f32 v60, v178, v132, v110
v_fma_f32 v61, v178, v134, v126
v_fma_f32 v133, -v179, v134, v60
v_fma_f32 v135, v179, v132, v61
v_pk_mul_f32 v[32:33], v[24:25], v[64:65] op_sel_hi:[0,1]
v_pk_mul_f32 v[34:35], v[24:25], v[80:81] op_sel_hi:[0,1] neg_lo:[1,0] neg_hi:[1,0]
v_pk_fma_f32 v[34:35], v[24:25], v[64:65], v[34:35] op_sel:[1,0,0] neg_lo:[1,0,0] neg_hi:[1,0,0]
v_pk_fma_f32 v[64:65], v[24:25], v[80:81], v[32:33] op_sel:[1,0,0] neg_lo:[1,0,0] neg_hi:[1,0,0]
v_mov_b64 v[80:81], v[34:35]
v_pk_mul_f32 v[36:37], v[26:27], v[96:97] op_sel_hi:[0,1]
v_pk_mul_f32 v[38:39], v[26:27], v[112:113] op_sel_hi:[0,1] neg_lo:[1,0] neg_hi:[1,0]
v_pk_fma_f32 v[38:39], v[26:27], v[96:97], v[38:39] op_sel:[1,0,0] neg_lo:[1,0,0] neg_hi:[1,0,0]
v_pk_fma_f32 v[96:97], v[26:27], v[112:113], v[36:37] op_sel:[1,0,0] neg_lo:[1,0,0] neg_hi:[1,0,0]
v_mov_b64 v[112:113], v[38:39]
v_pk_mul_f32 v[32:33], v[24:25], v[66:67] op_sel_hi:[0,1]
v_pk_mul_f32 v[34:35], v[24:25], v[82:83] op_sel_hi:[0,1] neg_lo:[1,0] neg_hi:[1,0]
v_pk_fma_f32 v[34:35], v[24:25], v[66:67], v[34:35] op_sel:[1,0,0] neg_lo:[1,0,0] neg_hi:[1,0,0]
v_pk_fma_f32 v[66:67], v[24:25], v[82:83], v[32:33] op_sel:[1,0,0] neg_lo:[1,0,0] neg_hi:[1,0,0]
v_mov_b64 v[82:83], v[34:35]
v_pk_mul_f32 v[36:37], v[26:27], v[98:99] op_sel_hi:[0,1]
v_pk_mul_f32 v[38:39], v[26:27], v[114:115] op_sel_hi:[0,1] neg_lo:[1,0] neg_hi:[1,0]
v_pk_fma_f32 v[38:39], v[26:27], v[98:99], v[38:39] op_sel:[1,0,0] neg_lo:[1,0,0] neg_hi:[1,0,0]
v_pk_fma_f32 v[98:99], v[26:27], v[114:115], v[36:37] op_sel:[1,0,0] neg_lo:[1,0,0] neg_hi:[1,0,0]
v_mov_b64 v[114:115], v[38:39]
v_pk_mul_f32 v[32:33], v[24:25], v[68:69] op_sel_hi:[0,1]
v_pk_mul_f32 v[34:35], v[24:25], v[84:85] op_sel_hi:[0,1] neg_lo:[1,0] neg_hi:[1,0]
v_pk_fma_f32 v[34:35], v[24:25], v[68:69], v[34:35] op_sel:[1,0,0] neg_lo:[1,0,0] neg_hi:[1,0,0]
v_pk_fma_f32 v[68:69], v[24:25], v[84:85], v[32:33] op_sel:[1,0,0] neg_lo:[1,0,0] neg_hi:[1,0,0]
v_mov_b64 v[84:85], v[34:35]
v_pk_mul_f32 v[36:37], v[26:27], v[100:101] op_sel_hi:[0,1]
v_pk_mul_f32 v[38:39], v[26:27], v[116:117] op_sel_hi:[0,1] neg_lo:[1,0] neg_hi:[1,0]
v_pk_fma_f32 v[38:39], v[26:27], v[100:101], v[38:39] op_sel:[1,0,0] neg_lo:[1,0,0] neg_hi:[1,0,0]
v_pk_fma_f32 v[100:101], v[26:27], v[116:117], v[36:37] op_sel:[1,0,0] neg_lo:[1,0,0] neg_hi:[1,0,0]
v_mov_b64 v[116:117], v[38:39]
v_pk_mul_f32 v[32:33], v[24:25], v[70:71] op_sel_hi:[0,1]
v_pk_mul_f32 v[34:35], v[24:25], v[86:87] op_sel_hi:[0,1] neg_lo:[1,0] neg_hi:[1,0]
v_pk_fma_f32 v[34:35], v[24:25], v[70:71], v[34:35] op_sel:[1,0,0] neg_lo:[1,0,0] neg_hi:[1,0,0]
v_pk_fma_f32 v[70:71], v[24:25], v[86:87], v[32:33] op_sel:[1,0,0] neg_lo:[1,0,0] neg_hi:[1,0,0]
v_mov_b64 v[86:87], v[34:35]
v_pk_mul_f32 v[36:37], v[26:27], v[102:103] op_sel_hi:[0,1]
v_pk_mul_f32 v[38:39], v[26:27], v[118:119] op_sel_hi:[0,1] neg_lo:[1,0] neg_hi:[1,0]
v_pk_fma_f32 v[38:39], v[26:27], v[102:103], v[38:39] op_sel:[1,0,0] neg_lo:[1,0,0] neg_hi:[1,0,0]
v_pk_fma_f32 v[102:103], v[26:27], v[118:119], v[36:37] op_sel:[1,0,0] neg_lo:[1,0,0] neg_hi:[1,0,0]
v_mov_b64 v[118:119], v[38:39]
v_pk_mul_f32 v[32:33], v[24:25], v[72:73] op_sel_hi:[0,1]
v_pk_mul_f32 v[34:35], v[24:25], v[88:89] op_sel_hi:[0,1] neg_lo:[1,0] neg_hi:[1,0]
v_pk_fma_f32 v[34:35], v[24:25], v[72:73], v[34:35] op_sel:[1,0,0] neg_lo:[1,0,0] neg_hi:[1,0,0]
v_pk_fma_f32 v[72:73], v[24:25], v[88:89], v[32:33] op_sel:[1,0,0] neg_lo:[1,0,0] neg_hi:[1,0,0]
v_mov_b64 v[88:89], v[34:35]
v_pk_mul_f32 v[36:37], v[26:27], v[104:105] op_sel_hi:[0,1]
v_pk_mul_f32 v[38:39], v[26:27], v[120:121] op_sel_hi:[0,1] neg_lo:[1,0] neg_hi:[1,0]
v_pk_fma_f32 v[38:39], v[26:27], v[104:105], v[38:39] op_sel:[1,0,0] neg_lo:[1,0,0] neg_hi:[1,0,0]
v_pk_fma_f32 v[104:105], v[26:27], v[120:121], v[36:37] op_sel:[1,0,0] neg_lo:[1,0,0] neg_hi:[1,0,0]
v_mov_b64 v[120:121], v[38:39]
v_pk_mul_f32 v[32:33], v[24:25], v[74:75] op_sel_hi:[0,1]
v_pk_mul_f32 v[34:35], v[24:25], v[90:91] op_sel_hi:[0,1] neg_lo:[1,0] neg_hi:[1,0]
v_pk_fma_f32 v[34:35], v[24:25], v[74:75], v[34:35] op_sel:[1,0,0] neg_lo:[1,0,0] neg_hi:[1,0,0]
v_pk_fma_f32 v[74:75], v[24:25], v[90:91], v[32:33] op_sel:[1,0,0] neg_lo:[1,0,0] neg_hi:[1,0,0]
v_mov_b64 v[90:91], v[34:35]
v_pk_mul_f32 v[36:37], v[26:27], v[106:107] op_sel_hi:[0,1]
v_pk_mul_f32 v[38:39], v[26:27], v[122:123] op_sel_hi:[0,1] neg_lo:[1,0] neg_hi:[1,0]
v_pk_fma_f32 v[38:39], v[26:27], v[106:107], v[38:39] op_sel:[1,0,0] neg_lo:[1,0,0] neg_hi:[1,0,0]
v_pk_fma_f32 v[106:107], v[26:27], v[122:123], v[36:37] op_sel:[1,0,0] neg_lo:[1,0,0] neg_hi:[1,0,0]
v_mov_b64 v[122:123], v[38:39]
v_pk_mul_f32 v[32:33], v[24:25], v[76:77] op_sel_hi:[0,1]
v_pk_mul_f32 v[34:35], v[24:25], v[92:93] op_sel_hi:[0,1] neg_lo:[1,0] neg_hi:[1,0]
v_pk_fma_f32 v[34:35], v[24:25], v[76:77], v[34:35] op_sel:[1,0,0] neg_lo:[1,0,0] neg_hi:[1,0,0]
v_pk_fma_f32 v[76:77], v[24:25], v[92:93], v[32:33] op_sel:[1,0,0] neg_lo:[1,0,0] neg_hi:[1,0,0]
v_mov_b64 v[92:93], v[34:35]
v_pk_mul_f32 v[36:37], v[26:27], v[108:109] op_sel_hi:[0,1]
v_pk_mul_f32 v[38:39], v[26:27], v[124:125] op_sel_hi:[0,1] neg_lo:[1,0] neg_hi:[1,0]
v_pk_fma_f32 v[38:39], v[26:27], v[108:109], v[38:39] op_sel:[1,0,0] neg_lo:[1,0,0] neg_hi:[1,0,0]
v_pk_fma_f32 v[108:109], v[26:27], v[124:125], v[36:37] op_sel:[1,0,0] neg_lo:[1,0,0] neg_hi:[1,0,0]
v_mov_b64 v[124:125], v[38:39]
v_pk_mul_f32 v[32:33], v[24:25], v[78:79] op_sel_hi:[0,1]
v_pk_mul_f32 v[34:35], v[24:25], v[94:95] op_sel_hi:[0,1] neg_lo:[1,0] neg_hi:[1,0]
v_pk_fma_f32 v[34:35], v[24:25], v[78:79], v[34:35] op_sel:[1,0,0] neg_lo:[1,0,0] neg_hi:[1,0,0]
v_pk_fma_f32 v[78:79], v[24:25], v[94:95], v[32:33] op_sel:[1,0,0] neg_lo:[1,0,0] neg_hi:[1,0,0]
v_mov_b64 v[94:95], v[34:35]
v_pk_mul_f32 v[36:37], v[26:27], v[110:111] op_sel_hi:[0,1]
v_pk_mul_f32 v[38:39], v[26:27], v[126:127] op_sel_hi:[0,1] neg_lo:[1,0] neg_hi:[1,0]
v_pk_fma_f32 v[38:39], v[26:27], v[110:111], v[38:39] op_sel:[1,0,0] neg_lo:[1,0,0] neg_hi:[1,0,0]
v_pk_fma_f32 v[110:111], v[26:27], v[126:127], v[36:37] op_sel:[1,0,0] neg_lo:[1,0,0] neg_hi:[1,0,0]
v_mov_b64 v[126:127], v[38:39]
buffer_load_dwordx4 v[144:147], v136, s[40:43], 0 offen sc1
buffer_load_dwordx4 v[148:151], v137, s[40:43], 0 offen sc1
buffer_load_dwordx4 v[152:155], v138, s[40:43], 0 offen sc1
buffer_load_dwordx4 v[156:159], v139, s[40:43], 0 offen sc1
buffer_load_dwordx4 v[160:163], v140, s[40:43], 0 offen sc1
buffer_load_dwordx4 v[164:167], v141, s[40:43], 0 offen sc1
buffer_load_dwordx4 v[168:171], v142, s[40:43], 0 offen sc1
buffer_load_dwordx4 v[172:175], v143, s[40:43], 0 offen sc1
global_load_dword v197, v196, s[32:33] sc1
v_mov_b32 v14, 1
s_mov_b64 exec, 1
ds_write_b32 v13, v14
s_mov_b64 exec, -1
s_xor_b32 s60, s68, s101
s_xor_b32 s60, s60, 1
s_lshl_b32 s60, s60, 6
s_add_u32 s60, s60, s66
v_lshrrev_b32 v8, 3, v1
v_lshl_add_u32 v8, v8, 1, s60
v_lshlrev_b32 v8, 11, v8
v_and_b32 v14, 7, v1
v_lshrrev_b32 v15, 4, v1
v_xor_b32 v14, v14, v15
v_lshlrev_b32 v14, 4, v14
v_xor_b32 v15, 64, v14
v_add_u32 v244, v8, v14
v_add_u32 v245, v8, v15
v_add_u32 v245, 31744, v245
v_add_u32 v246, v8, v14
v_add_u32 v246, 63488, v246
v_add_u32 v247, v8, v15
v_add_u32 v247, 95232, v247
s_and_b32 s64, s36, 7
s_lshl_b32 s60, s64, 18
s_lshl_b32 s61, s101, 10
s_add_u32 s60, s60, s61
s_add_u32 s48, s20, s60
s_addc_u32 s49, s21, 0
s_sub_u32 s50, 262144, s61
s_mov_b32 s51, 0x20000
s_add_u32 s52, s22, s60
s_addc_u32 s53, s23, 0
s_sub_u32 s54, 262144, s61
s_mov_b32 s55, 0x20000
s_lshl_b32 s61, s64, 1
s_add_u32 s61, s61, s101
s_lshl_b32 s61, s61, 7
s_lshl_b32 s63, s35, 1
s_add_u32 s63, s63, s68
s_lshl_b32 s60, s63, 17
s_add_u32 s60, s60, s61
s_add_u32 s56, s10, s60
s_addc_u32 s57, s11, 0
s_sub_u32 s58, 131072, s61
s_mov_b32 s59, 0x20000
s_add_u32 s26, s26, s61
s_addc_u32 s27, s27, 0
s_lshl_b32 s61, s61, 1
s_add_u32 s61, s61, 4096
s_lshl_b32 s60, s63, 19
s_add_u32 s60, s60, s61
s_add_u32 s28, s28, s60
s_addc_u32 s29, s29, 0
s_sub_u32 s24, 0x80000, s61
s_lshl_b32 s67, s34, 12
s_lshl_b32 s65, s64, 13
s_lshl_b32 s64, s64, 7
s_lshl_b32 s60, s68, 14
s_lshl_b32 s61, s66, 11
s_add_u32 s60, s60, s61
s_add_u32 s60, s60, 65536
v_add_u32 v16, s60, v10
s_lshl_b32 s60, s34, 13
s_add_u32 s60, s60, 65536
v_add_u32 v17, s60, v11
v_xor_b32 v20, 0, v7
v_add_u32 v24, 0x10000, v20
v_xor_b32 v21, 32, v7
v_add_u32 v25, 0x10000, v21
v_xor_b32 v22, 64, v7
v_add_u32 v26, 0x10000, v22
v_xor_b32 v23, 96, v7
v_add_u32 v27, 0x10000, v23
s_mul_i32 s14, s63, 262144
s_lshl_b32 s61, s36, 13
s_add_u32 s14, s14, s61
s_lshl_b32 s61, s66, 11
s_add_u32 s14, s14, s61
v_cmp_gt_u32 vcc, 0x40000, v136
s_nop 1
v_cndmask_b32 v40, 0, v202, vcc
v_cmp_gt_u32 vcc, 0x40000, v137
s_nop 1
v_cndmask_b32 v41, 0, v202, vcc
v_cmp_gt_u32 vcc, 0x40000, v138
s_nop 1
v_cndmask_b32 v42, 0, v202, vcc
v_cmp_gt_u32 vcc, 0x40000, v139
s_nop 1
v_cndmask_b32 v43, 0, v202, vcc
v_cmp_gt_u32 vcc, 0x40000, v140
s_nop 1
v_cndmask_b32 v44, 0, v202, vcc
v_cmp_gt_u32 vcc, 0x40000, v141
s_nop 1
v_cndmask_b32 v45, 0, v202, vcc
v_cmp_gt_u32 vcc, 0x40000, v142
s_nop 1
v_cndmask_b32 v46, 0, v202, vcc
v_cmp_gt_u32 vcc, 0x40000, v143
s_nop 1
v_cndmask_b32 v47, 0, v202, vcc
s_mov_b32 s69, 0
L_poll44:
v_mov_b32 v8, 0
s_waitcnt vmcnt(8)
v_bitop3_b32 v8, v8, v146, v40 bitop3:0xf6
v_bitop3_b32 v8, v8, v147, v40 bitop3:0xf6
s_waitcnt vmcnt(7)
v_bitop3_b32 v8, v8, v150, v41 bitop3:0xf6
v_bitop3_b32 v8, v8, v151, v41 bitop3:0xf6
s_waitcnt vmcnt(6)
v_bitop3_b32 v8, v8, v154, v42 bitop3:0xf6
v_bitop3_b32 v8, v8, v155, v42 bitop3:0xf6
s_waitcnt vmcnt(5)
v_bitop3_b32 v8, v8, v158, v43 bitop3:0xf6
v_bitop3_b32 v8, v8, v159, v43 bitop3:0xf6
s_waitcnt vmcnt(4)
v_bitop3_b32 v8, v8, v162, v44 bitop3:0xf6
v_bitop3_b32 v8, v8, v163, v44 bitop3:0xf6
s_waitcnt vmcnt(3)
v_bitop3_b32 v8, v8, v166, v45 bitop3:0xf6
v_bitop3_b32 v8, v8, v167, v45 bitop3:0xf6
s_waitcnt vmcnt(2)
v_bitop3_b32 v8, v8, v170, v46 bitop3:0xf6
v_bitop3_b32 v8, v8, v171, v46 bitop3:0xf6
s_waitcnt vmcnt(1)
v_bitop3_b32 v8, v8, v174, v47 bitop3:0xf6
v_bitop3_b32 v8, v8, v175, v47 bitop3:0xf6
s_waitcnt vmcnt(0)
v_xor_b32 v197, v194, v197
v_lshrrev_b32 v9, 4, v197
v_or_b32 v8, v8, v9
v_cmp_ne_u32 vcc, 0, v8
s_nop 0
s_cbranch_vccz L_polled45
s_add_u32 s69, s69, 1
s_cmp_ge_u32 s69, 200000
s_cbranch_scc1 L_polled45
buffer_load_dwordx4 v[144:147], v136, s[40:43], 0 offen sc1
buffer_load_dwordx4 v[148:151], v137, s[40:43], 0 offen sc1
buffer_load_dwordx4 v[152:155], v138, s[40:43], 0 offen sc1
buffer_load_dwordx4 v[156:159], v139, s[40:43], 0 offen sc1
buffer_load_dwordx4 v[160:163], v140, s[40:43], 0 offen sc1
buffer_load_dwordx4 v[164:167], v141, s[40:43], 0 offen sc1
buffer_load_dwordx4 v[168:171], v142, s[40:43], 0 offen sc1
buffer_load_dwordx4 v[172:175], v143, s[40:43], 0 offen sc1
global_load_dword v197, v196, s[32:33] sc1
s_branch L_poll44
L_polled45:
v_cmp_ne_u32 vcc, 0, v197
s_nop 0
s_cmp_eq_u64 vcc, 0
s_cselect_b32 s100, 1, 0
s_add_u32 m0, s67, 0
s_add_u32 s62, s64, 0
s_and_b32 s62, s62, 0x3ff
buffer_load_dwordx4 v244, s[48:51], s62 offen offset:0 lds
buffer_load_dwordx4 v245, s[48:51], s62 offen offset:1024 lds
buffer_load_dwordx4 v246, s[48:51], s62 offen offset:2048 lds
buffer_load_dwordx4 v247, s[48:51], s62 offen offset:3072 lds
s_add_u32 m0, s67, 16384
s_nop 0
buffer_load_dwordx4 v244, s[52:55], s62 offen offset:0 lds
buffer_load_dwordx4 v245, s[52:55], s62 offen offset:1024 lds
buffer_load_dwordx4 v246, s[52:55], s62 offen offset:2048 lds
buffer_load_dwordx4 v247, s[52:55], s62 offen offset:3072 lds
v_mov_b32 v14, 2
s_mov_b64 exec, 1
ds_write_b32 v13, v14
s_mov_b64 exec, -1
v_fma_f32 v40, v2, v172, v168
v_fma_f32 v41, v2, v173, v169
v_fma_f32 v48, -v3, v173, v40
v_fma_f32 v49, v3, v172, v41
v_fma_f32 v40, v2, v48, v164
v_fma_f32 v41, v2, v49, v165
v_fma_f32 v172, -v3, v49, v40
v_fma_f32 v173, v3, v48, v41
v_fma_f32 v40, v2, v172, v160
v_fma_f32 v41, v2, v173, v161
v_fma_f32 v48, -v3, v173, v40
v_fma_f32 v49, v3, v172, v41
v_fma_f32 v40, v2, v48, v156
v_fma_f32 v41, v2, v49, v157
v_fma_f32 v172, -v3, v49, v40
v_fma_f32 v173, v3, v48, v41
v_fma_f32 v40, v2, v172, v152
v_fma_f32 v41, v2, v173, v153
v_fma_f32 v48, -v3, v173, v40
v_fma_f32 v49, v3, v172, v41
v_fma_f32 v40, v2, v48, v148
v_fma_f32 v41, v2, v49, v149
v_fma_f32 v172, -v3, v49, v40
v_fma_f32 v173, v3, v48, v41
v_fma_f32 v40, v2, v172, v144
v_fma_f32 v41, v2, v173, v145
v_fma_f32 v48, -v3, v173, v40
v_fma_f32 v49, v3, v172, v41
v_mov_b32 v50, v48
v_mov_b32 v51, v49
s_nop 0
v_permlane32_swap_b32 v48, v50
v_permlane32_swap_b32 v49, v51
v_fma_f32 v40, v30, v50, v48
v_fma_f32 v41, v30, v51, v49
v_fma_f32 v52, -v31, v51, v40
v_fma_f32 v53, v31, v50, v41
v_mov_b32 v54, v52
v_mov_b32 v55, v53
s_nop 0
v_permlane16_swap_b32 v52, v54
v_permlane16_swap_b32 v53, v55
v_pk_fma_f32 v[128:129], v[52:53], v[184:185], v[128:129] op_sel_hi:[0,1,1]
v_pk_fma_f32 v[130:131], v[52:53], v[186:187], v[130:131] op_sel_hi:[0,1,1]
v_pk_fma_f32 v[128:129], v[52:53], v[186:187], v[128:129] op_sel:[1,0,0] neg_lo:[1,0,0] neg_hi:[1,0,0]
v_pk_fma_f32 v[130:131], v[52:53], v[184:185], v[130:131] op_sel:[1,0,0]
v_pk_fma_f32 v[132:133], v[54:55], v[188:189], v[132:133] op_sel_hi:[0,1,1]
v_pk_fma_f32 v[134:135], v[54:55], v[190:191], v[134:135] op_sel_hi:[0,1,1]
v_pk_fma_f32 v[132:133], v[54:55], v[190:191], v[132:133] op_sel:[1,0,0] neg_lo:[1,0,0] neg_hi:[1,0,0]
v_pk_fma_f32 v[134:135], v[54:55], v[188:189], v[134:135] op_sel:[1,0,0]
v_pk_fma_f32 v[64:65], v[208:209], v[128:129], v[64:65] op_sel_hi:[0,1,1]
v_pk_fma_f32 v[80:81], v[208:209], v[130:131], v[80:81] op_sel_hi:[0,1,1] neg_lo:[1,0,0] neg_hi:[1,0,0]
v_pk_fma_f32 v[64:65], v[208:209], v[130:131], v[64:65] op_sel:[1,0,0] neg_lo:[1,0,0] neg_hi:[1,0,0]
v_pk_fma_f32 v[80:81], v[208:209], v[128:129], v[80:81] op_sel:[1,0,0] neg_lo:[1,0,0] neg_hi:[1,0,0]
v_cvt_pk_bf16_f32 v144, v64, v65
v_cvt_pk_bf16_f32 v152, v80, v81
v_pk_fma_f32 v[96:97], v[224:225], v[132:133], v[96:97] op_sel_hi:[0,1,1]
v_pk_fma_f32 v[112:113], v[224:225], v[134:135], v[112:113] op_sel_hi:[0,1,1] neg_lo:[1,0,0] neg_hi:[1,0,0]
v_pk_fma_f32 v[96:97], v[224:225], v[134:135], v[96:97] op_sel:[1,0,0] neg_lo:[1,0,0] neg_hi:[1,0,0]
v_pk_fma_f32 v[112:113], v[224:225], v[132:133], v[112:113] op_sel:[1,0,0] neg_lo:[1,0,0] neg_hi:[1,0,0]
v_cvt_pk_bf16_f32 v160, v96, v97
v_cvt_pk_bf16_f32 v168, v112, v113
v_pk_fma_f32 v[66:67], v[210:211], v[128:129], v[66:67] op_sel_hi:[0,1,1]
v_pk_fma_f32 v[82:83], v[210:211], v[130:131], v[82:83] op_sel_hi:[0,1,1] neg_lo:[1,0,0] neg_hi:[1,0,0]
v_pk_fma_f32 v[66:67], v[210:211], v[130:131], v[66:67] op_sel:[1,0,0] neg_lo:[1,0,0] neg_hi:[1,0,0]
v_pk_fma_f32 v[82:83], v[210:211], v[128:129], v[82:83] op_sel:[1,0,0] neg_lo:[1,0,0] neg_hi:[1,0,0]
v_cvt_pk_bf16_f32 v145, v66, v67
v_cvt_pk_bf16_f32 v153, v82, v83
v_pk_fma_f32 v[98:99], v[226:227], v[132:133], v[98:99] op_sel_hi:[0,1,1]
v_pk_fma_f32 v[114:115], v[226:227], v[134:135], v[114:115] op_sel_hi:[0,1,1] neg_lo:[1,0,0] neg_hi:[1,0,0]
v_pk_fma_f32 v[98:99], v[226:227], v[134:135], v[98:99] op_sel:[1,0,0] neg_lo:[1,0,0] neg_hi:[1,0,0]
v_pk_fma_f32 v[114:115], v[226:227], v[132:133], v[114:115] op_sel:[1,0,0] neg_lo:[1,0,0] neg_hi:[1,0,0]
v_cvt_pk_bf16_f32 v161, v98, v99
v_cvt_pk_bf16_f32 v169, v114, v115
v_pk_fma_f32 v[68:69], v[212:213], v[128:129], v[68:69] op_sel_hi:[0,1,1]
v_pk_fma_f32 v[84:85], v[212:213], v[130:131], v[84:85] op_sel_hi:[0,1,1] neg_lo:[1,0,0] neg_hi:[1,0,0]
v_pk_fma_f32 v[68:69], v[212:213], v[130:131], v[68:69] op_sel:[1,0,0] neg_lo:[1,0,0] neg_hi:[1,0,0]
v_pk_fma_f32 v[84:85], v[212:213], v[128:129], v[84:85] op_sel:[1,0,0] neg_lo:[1,0,0] neg_hi:[1,0,0]
v_cvt_pk_bf16_f32 v146, v68, v69
v_cvt_pk_bf16_f32 v154, v84, v85
v_pk_fma_f32 v[100:101], v[228:229], v[132:133], v[100:101] op_sel_hi:[0,1,1]
v_pk_fma_f32 v[116:117], v[228:229], v[134:135], v[116:117] op_sel_hi:[0,1,1] neg_lo:[1,0,0] neg_hi:[1,0,0]
v_pk_fma_f32 v[100:101], v[228:229], v[134:135], v[100:101] op_sel:[1,0,0] neg_lo:[1,0,0] neg_hi:[1,0,0]
v_pk_fma_f32 v[116:117], v[228:229], v[132:133], v[116:117] op_sel:[1,0,0] neg_lo:[1,0,0] neg_hi:[1,0,0]
v_cvt_pk_bf16_f32 v162, v100, v101
v_cvt_pk_bf16_f32 v170, v116, v117
v_pk_fma_f32 v[70:71], v[214:215], v[128:129], v[70:71] op_sel_hi:[0,1,1]
v_pk_fma_f32 v[86:87], v[214:215], v[130:131], v[86:87] op_sel_hi:[0,1,1] neg_lo:[1,0,0] neg_hi:[1,0,0]
v_pk_fma_f32 v[70:71], v[214:215], v[130:131], v[70:71] op_sel:[1,0,0] neg_lo:[1,0,0] neg_hi:[1,0,0]
v_pk_fma_f32 v[86:87], v[214:215], v[128:129], v[86:87] op_sel:[1,0,0] neg_lo:[1,0,0] neg_hi:[1,0,0]
v_cvt_pk_bf16_f32 v147, v70, v71
v_cvt_pk_bf16_f32 v155, v86, v87
v_pk_fma_f32 v[102:103], v[230:231], v[132:133], v[102:103] op_sel_hi:[0,1,1]
v_pk_fma_f32 v[118:119], v[230:231], v[134:135], v[118:119] op_sel_hi:[0,1,1] neg_lo:[1,0,0] neg_hi:[1,0,0]
v_pk_fma_f32 v[102:103], v[230:231], v[134:135], v[102:103] op_sel:[1,0,0] neg_lo:[1,0,0] neg_hi:[1,0,0]
v_pk_fma_f32 v[118:119], v[230:231], v[132:133], v[118:119] op_sel:[1,0,0] neg_lo:[1,0,0] neg_hi:[1,0,0]
v_cvt_pk_bf16_f32 v163, v102, v103
v_cvt_pk_bf16_f32 v171, v118, v119
v_mfma_f32_16x16x32_bf16 v[32:35], v[144:147], v[248:251], 0
v_mfma_f32_16x16x32_bf16 v[36:39], v[160:163], v[248:251], 0
v_mfma_f32_16x16x32_bf16 v[40:43], v[144:147], v[252:255], 0
v_mfma_f32_16x16x32_bf16 v[44:47], v[160:163], v[252:255], 0
v_mfma_f32_16x16x32_bf16 v[48:51], v[152:155], v[248:251], 0
v_mfma_f32_16x16x32_bf16 v[52:55], v[168:171], v[248:251], 0
v_mfma_f32_16x16x32_bf16 v[56:59], v[152:155], v[252:255], 0
v_mfma_f32_16x16x32_bf16 v[60:63], v[168:171], v[252:255], 0
v_pk_fma_f32 v[72:73], v[216:217], v[128:129], v[72:73] op_sel_hi:[0,1,1]
v_pk_fma_f32 v[88:89], v[216:217], v[130:131], v[88:89] op_sel_hi:[0,1,1] neg_lo:[1,0,0] neg_hi:[1,0,0]
v_pk_fma_f32 v[72:73], v[216:217], v[130:131], v[72:73] op_sel:[1,0,0] neg_lo:[1,0,0] neg_hi:[1,0,0]
v_pk_fma_f32 v[88:89], v[216:217], v[128:129], v[88:89] op_sel:[1,0,0] neg_lo:[1,0,0] neg_hi:[1,0,0]
v_cvt_pk_bf16_f32 v148, v72, v73
v_cvt_pk_bf16_f32 v156, v88, v89
v_pk_fma_f32 v[104:105], v[232:233], v[132:133], v[104:105] op_sel_hi:[0,1,1]
v_pk_fma_f32 v[120:121], v[232:233], v[134:135], v[120:121] op_sel_hi:[0,1,1] neg_lo:[1,0,0] neg_hi:[1,0,0]
v_pk_fma_f32 v[104:105], v[232:233], v[134:135], v[104:105] op_sel:[1,0,0] neg_lo:[1,0,0] neg_hi:[1,0,0]
v_pk_fma_f32 v[120:121], v[232:233], v[132:133], v[120:121] op_sel:[1,0,0] neg_lo:[1,0,0] neg_hi:[1,0,0]
v_cvt_pk_bf16_f32 v164, v104, v105
v_cvt_pk_bf16_f32 v172, v120, v121
v_pk_fma_f32 v[74:75], v[218:219], v[128:129], v[74:75] op_sel_hi:[0,1,1]
v_pk_fma_f32 v[90:91], v[218:219], v[130:131], v[90:91] op_sel_hi:[0,1,1] neg_lo:[1,0,0] neg_hi:[1,0,0]
v_pk_fma_f32 v[74:75], v[218:219], v[130:131], v[74:75] op_sel:[1,0,0] neg_lo:[1,0,0] neg_hi:[1,0,0]
v_pk_fma_f32 v[90:91], v[218:219], v[128:129], v[90:91] op_sel:[1,0,0] neg_lo:[1,0,0] neg_hi:[1,0,0]
v_cvt_pk_bf16_f32 v149, v74, v75
v_cvt_pk_bf16_f32 v157, v90, v91
v_pk_fma_f32 v[106:107], v[234:235], v[132:133], v[106:107] op_sel_hi:[0,1,1]
v_pk_fma_f32 v[122:123], v[234:235], v[134:135], v[122:123] op_sel_hi:[0,1,1] neg_lo:[1,0,0] neg_hi:[1,0,0]
v_pk_fma_f32 v[106:107], v[234:235], v[134:135], v[106:107] op_sel:[1,0,0] neg_lo:[1,0,0] neg_hi:[1,0,0]
v_pk_fma_f32 v[122:123], v[234:235], v[132:133], v[122:123] op_sel:[1,0,0] neg_lo:[1,0,0] neg_hi:[1,0,0]
v_cvt_pk_bf16_f32 v165, v106, v107
v_cvt_pk_bf16_f32 v173, v122, v123
s_add_u32 s61, s14, 0
v_cvt_pk_bf16_f32 v176, v32, v33
v_cvt_pk_bf16_f32 v177, v34, v35
v_cvt_pk_bf16_f32 v178, v36, v37
v_cvt_pk_bf16_f32 v179, v38, v39
buffer_store_dwordx4 v[176:179], v10, s[44:47], s61 offen offset:0 sc1
ds_write_b128 v16, v[176:179] offset:0
s_add_u32 s61, s14, 131072
v_cvt_pk_bf16_f32 v180, v40, v41
v_cvt_pk_bf16_f32 v181, v42, v43
v_cvt_pk_bf16_f32 v182, v44, v45
v_cvt_pk_bf16_f32 v183, v46, v47
buffer_store_dwordx4 v[180:183], v10, s[44:47], s61 offen offset:0 sc1
ds_write_b128 v16, v[180:183] offset:8192
s_add_u32 s61, s14, 4096
v_cvt_pk_bf16_f32 v184, v48, v49
v_cvt_pk_bf16_f32 v185, v50, v51
v_cvt_pk_bf16_f32 v186, v52, v53
v_cvt_pk_bf16_f32 v187, v54, v55
buffer_store_dwordx4 v[184:187], v10, s[44:47], s61 offen offset:0 sc1
ds_write_b128 v16, v[184:187] offset:4096
s_add_u32 s61, s14, 135168
v_cvt_pk_bf16_f32 v188, v56, v57
v_cvt_pk_bf16_f32 v189, v58, v59
v_cvt_pk_bf16_f32 v190, v60, v61
v_cvt_pk_bf16_f32 v191, v62, v63
buffer_store_dwordx4 v[188:191], v10, s[44:47], s61 offen offset:0 sc1
ds_write_b128 v16, v[188:191] offset:12288
v_pk_fma_f32 v[76:77], v[220:221], v[128:129], v[76:77] op_sel_hi:[0,1,1]
v_pk_fma_f32 v[92:93], v[220:221], v[130:131], v[92:93] op_sel_hi:[0,1,1] neg_lo:[1,0,0] neg_hi:[1,0,0]
v_pk_fma_f32 v[76:77], v[220:221], v[130:131], v[76:77] op_sel:[1,0,0] neg_lo:[1,0,0] neg_hi:[1,0,0]
v_pk_fma_f32 v[92:93], v[220:221], v[128:129], v[92:93] op_sel:[1,0,0] neg_lo:[1,0,0] neg_hi:[1,0,0]
v_cvt_pk_bf16_f32 v150, v76, v77
v_cvt_pk_bf16_f32 v158, v92, v93
v_pk_fma_f32 v[108:109], v[236:237], v[132:133], v[108:109] op_sel_hi:[0,1,1]
v_pk_fma_f32 v[124:125], v[236:237], v[134:135], v[124:125] op_sel_hi:[0,1,1] neg_lo:[1,0,0] neg_hi:[1,0,0]
v_pk_fma_f32 v[108:109], v[236:237], v[134:135], v[108:109] op_sel:[1,0,0] neg_lo:[1,0,0] neg_hi:[1,0,0]
v_pk_fma_f32 v[124:125], v[236:237], v[132:133], v[124:125] op_sel:[1,0,0] neg_lo:[1,0,0] neg_hi:[1,0,0]
v_cvt_pk_bf16_f32 v166, v108, v109
v_cvt_pk_bf16_f32 v174, v124, v125
v_pk_fma_f32 v[78:79], v[222:223], v[128:129], v[78:79] op_sel_hi:[0,1,1]
v_pk_fma_f32 v[94:95], v[222:223], v[130:131], v[94:95] op_sel_hi:[0,1,1] neg_lo:[1,0,0] neg_hi:[1,0,0]
v_pk_fma_f32 v[78:79], v[222:223], v[130:131], v[78:79] op_sel:[1,0,0] neg_lo:[1,0,0] neg_hi:[1,0,0]
v_pk_fma_f32 v[94:95], v[222:223], v[128:129], v[94:95] op_sel:[1,0,0] neg_lo:[1,0,0] neg_hi:[1,0,0]
v_cvt_pk_bf16_f32 v151, v78, v79
v_cvt_pk_bf16_f32 v159, v94, v95
v_pk_fma_f32 v[110:111], v[238:239], v[132:133], v[110:111] op_sel_hi:[0,1,1]
v_pk_fma_f32 v[126:127], v[238:239], v[134:135], v[126:127] op_sel_hi:[0,1,1] neg_lo:[1,0,0] neg_hi:[1,0,0]
v_pk_fma_f32 v[110:111], v[238:239], v[134:135], v[110:111] op_sel:[1,0,0] neg_lo:[1,0,0] neg_hi:[1,0,0]
v_pk_fma_f32 v[126:127], v[238:239], v[132:133], v[126:127] op_sel:[1,0,0] neg_lo:[1,0,0] neg_hi:[1,0,0]
v_cvt_pk_bf16_f32 v167, v110, v111
v_cvt_pk_bf16_f32 v175, v126, v127
v_mfma_f32_16x16x32_bf16 v[32:35], v[148:151], v[248:251], 0
v_mfma_f32_16x16x32_bf16 v[36:39], v[164:167], v[248:251], 0
v_mfma_f32_16x16x32_bf16 v[40:43], v[148:151], v[252:255], 0
v_mfma_f32_16x16x32_bf16 v[44:47], v[164:167], v[252:255], 0
v_mfma_f32_16x16x32_bf16 v[48:51], v[156:159], v[248:251], 0
v_mfma_f32_16x16x32_bf16 v[52:55], v[172:175], v[248:251], 0
v_mfma_f32_16x16x32_bf16 v[56:59], v[156:159], v[252:255], 0
v_mfma_f32_16x16x32_bf16 v[60:63], v[172:175], v[252:255], 0
s_add_u32 s61, s14, 0
v_cvt_pk_bf16_f32 v192, v32, v33
v_cvt_pk_bf16_f32 v193, v34, v35
v_cvt_pk_bf16_f32 v194, v36, v37
v_cvt_pk_bf16_f32 v195, v38, v39
buffer_store_dwordx4 v[192:195], v10, s[44:47], s61 offen offset:256 sc1
ds_write_b128 v16, v[192:195] offset:256
s_add_u32 s61, s14, 131072
v_cvt_pk_bf16_f32 v196, v40, v41
v_cvt_pk_bf16_f32 v197, v42, v43
v_cvt_pk_bf16_f32 v198, v44, v45
v_cvt_pk_bf16_f32 v199, v46, v47
buffer_store_dwordx4 v[196:199], v10, s[44:47], s61 offen offset:256 sc1
ds_write_b128 v16, v[196:199] offset:8448
s_add_u32 s61, s14, 4096
v_cvt_pk_bf16_f32 v200, v48, v49
v_cvt_pk_bf16_f32 v201, v50, v51
v_cvt_pk_bf16_f32 v202, v52, v53
v_cvt_pk_bf16_f32 v203, v54, v55
buffer_store_dwordx4 v[200:203], v10, s[44:47], s61 offen offset:256 sc1
ds_write_b128 v16, v[200:203] offset:4352
s_add_u32 s61, s14, 135168
v_cvt_pk_bf16_f32 v204, v56, v57
v_cvt_pk_bf16_f32 v205, v58, v59
v_cvt_pk_bf16_f32 v206, v60, v61
v_cvt_pk_bf16_f32 v207, v62, v63
buffer_store_dwordx4 v[204:207], v10, s[44:47], s61 offen offset:256 sc1
ds_write_b128 v16, v[204:207] offset:12544
v_mov_b32 v2, v11
s_lshl_b32 s60, s35, 2
s_add_u32 s60, s60, s34
s_mul_i32 s60, s60, 131072
s_lshl_b32 s61, s101, 16
s_add_u32 s60, s60, s61
s_add_u32 s42, s60, 1048576
s_add_u32 s40, s32, s42
s_addc_u32 s41, s33, 0
s_mov_b32 s42, 65536
s_mov_b32 s43, 0x20000
s_waitcnt vmcnt(8) lgkmcnt(0)
v_mov_b32 v14, 3
s_mov_b64 exec, 1
ds_write_b32 v13, v14
s_mov_b64 exec, -1
ds_read_b128 v[8:11], v12 offset:0
s_waitcnt lgkmcnt(0)
L_ck46:
v_min3_u32 v15, v8, v9, v10
v_min_u32 v15, v15, v11
s_nop 0
v_readfirstlane_b32 s60, v15
s_nop 0
s_cmp_ge_u32 s60, 3
s_cbranch_scc1 L_ckd47
ds_read_b128 v[8:11], v12 offset:0
s_waitcnt lgkmcnt(0)
s_branch L_ck46
L_ckd47:
ds_read_b128 v[148:151], v17 offset:0
ds_read_b128 v[152:155], v17 offset:1024
ds_read_b128 v[156:159], v17 offset:2048
ds_read_b128 v[160:163], v17 offset:3072
ds_read_b128 v[164:167], v17 offset:4096
ds_read_b128 v[168:171], v17 offset:5120
ds_read_b128 v[172:175], v17 offset:6144
ds_read_b128 v[176:179], v17 offset:7168
ds_read_b128 v[96:99], v20 offset:0
ds_read_b128 v[100:103], v20 offset:4096
ds_read_b128 v[104:107], v20 offset:8192
ds_read_b128 v[108:111], v20 offset:12288
s_waitcnt lgkmcnt(4)
v_mov_b32 v14, 4
s_mov_b64 exec, 1
ds_write_b32 v13, v14
s_mov_b64 exec, -1
s_waitcnt lgkmcnt(0)
v_mfma_f32_32x32x16_bf16 v[32:47], v[148:151], v[96:99], 0
ds_read_b128 v[112:115], v21 offset:0
ds_read_b128 v[116:119], v21 offset:4096
v_mfma_f32_32x32x16_bf16 v[48:63], v[148:151], v[100:103], 0
ds_read_b128 v[120:123], v21 offset:8192
ds_read_b128 v[124:127], v21 offset:12288
v_mfma_f32_32x32x16_bf16 v[64:79], v[148:151], v[104:107], 0
s_add_u32 m0, s67, 32768
s_add_u32 s62, s64, 128
s_and_b32 s62, s62, 0x3ff
buffer_load_dwordx4 v244, s[48:51], s62 offen offset:0 lds
v_mfma_f32_32x32x16_bf16 v[80:95], v[148:151], v[108:111], 0
s_waitcnt lgkmcnt(3)
v_mfma_f32_32x32x16_bf16 v[32:47], v[152:155], v[112:115], v[32:47]
ds_read_b128 v[96:99], v22 offset:0
ds_read_b128 v[100:103], v22 offset:4096
s_waitcnt lgkmcnt(4)
v_mfma_f32_32x32x16_bf16 v[48:63], v[152:155], v[116:119], v[48:63]
ds_read_b128 v[104:107], v22 offset:8192
ds_read_b128 v[108:111], v22 offset:12288
s_waitcnt lgkmcnt(5)
v_mfma_f32_32x32x16_bf16 v[64:79], v[152:155], v[120:123], v[64:79]
buffer_load_dwordx4 v245, s[48:51], s62 offen offset:1024 lds
s_waitcnt lgkmcnt(4)
v_mfma_f32_32x32x16_bf16 v[80:95], v[152:155], v[124:127], v[80:95]
s_waitcnt lgkmcnt(3)
v_mfma_f32_32x32x16_bf16 v[32:47], v[156:159], v[96:99], v[32:47]
ds_read_b128 v[112:115], v23 offset:0
ds_read_b128 v[116:119], v23 offset:4096
s_waitcnt lgkmcnt(4)
v_mfma_f32_32x32x16_bf16 v[48:63], v[156:159], v[100:103], v[48:63]
ds_read_b128 v[120:123], v23 offset:8192
ds_read_b128 v[124:127], v23 offset:12288
s_waitcnt lgkmcnt(5)
v_mfma_f32_32x32x16_bf16 v[64:79], v[156:159], v[104:107], v[64:79]
buffer_load_dwordx4 v246, s[48:51], s62 offen offset:2048 lds
s_waitcnt lgkmcnt(4)
v_mfma_f32_32x32x16_bf16 v[80:95], v[156:159], v[108:111], v[80:95]
s_waitcnt lgkmcnt(3)
v_mfma_f32_32x32x16_bf16 v[32:47], v[160:163], v[112:115], v[32:47]
ds_read_b128 v[96:99], v20 offset:16384
ds_read_b128 v[100:103], v20 offset:20480
s_waitcnt lgkmcnt(4)
v_mfma_f32_32x32x16_bf16 v[48:63], v[160:163], v[116:119], v[48:63]
ds_read_b128 v[104:107], v20 offset:24576
ds_read_b128 v[108:111], v20 offset:28672
s_waitcnt lgkmcnt(5)
v_mfma_f32_32x32x16_bf16 v[64:79], v[160:163], v[120:123], v[64:79]
buffer_load_dwordx4 v247, s[48:51], s62 offen offset:3072 lds
s_waitcnt lgkmcnt(4)
v_mfma_f32_32x32x16_bf16 v[80:95], v[160:163], v[124:127], v[80:95]
s_waitcnt lgkmcnt(3)
v_mfma_f32_32x32x16_bf16 v[32:47], v[164:167], v[96:99], v[32:47]
ds_read_b128 v[112:115], v21 offset:16384
ds_read_b128 v[116:119], v21 offset:20480
s_waitcnt lgkmcnt(4)
v_mfma_f32_32x32x16_bf16 v[48:63], v[164:167], v[100:103], v[48:63]
ds_read_b128 v[120:123], v21 offset:24576
ds_read_b128 v[124:127], v21 offset:28672
s_waitcnt lgkmcnt(5)
v_mfma_f32_32x32x16_bf16 v[64:79], v[164:167], v[104:107], v[64:79]
s_add_u32 m0, s67, 49152
s_nop 0
buffer_load_dwordx4 v244, s[52:55], s62 offen offset:0 lds
s_waitcnt lgkmcnt(4)
v_mfma_f32_32x32x16_bf16 v[80:95], v[164:167], v[108:111], v[80:95]
s_waitcnt lgkmcnt(3)
v_mfma_f32_32x32x16_bf16 v[32:47], v[168:171], v[112:115], v[32:47]
ds_read_b128 v[96:99], v22 offset:16384
ds_read_b128 v[100:103], v22 offset:20480
s_waitcnt lgkmcnt(4)
v_mfma_f32_32x32x16_bf16 v[48:63], v[168:171], v[116:119], v[48:63]
ds_read_b128 v[104:107], v22 offset:24576
ds_read_b128 v[108:111], v22 offset:28672
s_waitcnt lgkmcnt(5)
v_mfma_f32_32x32x16_bf16 v[64:79], v[168:171], v[120:123], v[64:79]
buffer_load_dwordx4 v245, s[52:55], s62 offen offset:1024 lds
s_waitcnt lgkmcnt(4)
v_mfma_f32_32x32x16_bf16 v[80:95], v[168:171], v[124:127], v[80:95]
s_waitcnt lgkmcnt(3)
v_mfma_f32_32x32x16_bf16 v[32:47], v[172:175], v[96:99], v[32:47]
ds_read_b128 v[112:115], v23 offset:16384
ds_read_b128 v[116:119], v23 offset:20480
s_waitcnt lgkmcnt(4)
v_mfma_f32_32x32x16_bf16 v[48:63], v[172:175], v[100:103], v[48:63]
ds_read_b128 v[120:123], v23 offset:24576
ds_read_b128 v[124:127], v23 offset:28672
s_waitcnt lgkmcnt(5)
v_mfma_f32_32x32x16_bf16 v[64:79], v[172:175], v[104:107], v[64:79]
buffer_load_dwordx4 v246, s[52:55], s62 offen offset:2048 lds
s_waitcnt lgkmcnt(4)
v_mfma_f32_32x32x16_bf16 v[80:95], v[172:175], v[108:111], v[80:95]
s_waitcnt lgkmcnt(0)
v_mfma_f32_32x32x16_bf16 v[32:47], v[176:179], v[112:115], v[32:47]
v_mfma_f32_32x32x16_bf16 v[48:63], v[176:179], v[116:119], v[48:63]
v_mfma_f32_32x32x16_bf16 v[64:79], v[176:179], v[120:123], v[64:79]
buffer_load_dwordx4 v247, s[52:55], s62 offen offset:3072 lds
v_mfma_f32_32x32x16_bf16 v[80:95], v[176:179], v[124:127], v[80:95]
s_lshl_b32 s60, s66, 3
v_lshl_add_u32 v17, v5, 4, s60
v_lshlrev_b32 v28, 11, v17
v_lshl_add_u32 v28, v6, 2, v28
v_lshlrev_b32 v29, 13, v17
v_lshl_add_u32 v29, v6, 3, v29
v_lshlrev_b32 v30, 2, v6
v_mov_b32 v15, s37
s_waitcnt vmcnt(8)
s_mov_b64 exec, 1
s_cmp_eq_u32 s100, 0
s_cbranch_scc1 L_rs48
global_store_dword v19, v15, s[32:33]
s_branch L_rd49
L_rs48:
global_store_dword v19, v15, s[32:33] sc1
L_rd49:
s_mov_b64 exec, -1
ds_read_b128 v[8:11], v12 offset:0
s_waitcnt lgkmcnt(0)
L_ck50:
v_min3_u32 v15, v8, v9, v10
v_min_u32 v15, v15, v11
s_nop 0
v_readfirstlane_b32 s60, v15
s_nop 0
s_cmp_ge_u32 s60, 4
s_cbranch_scc1 L_ckd51
ds_read_b128 v[8:11], v12 offset:0
s_waitcnt lgkmcnt(0)
s_branch L_ck50
L_ckd51:
ds_read_b128 v[8:11], v12 offset:16
s_waitcnt lgkmcnt(0)
L_ck52:
v_min3_u32 v15, v8, v9, v10
v_min_u32 v15, v15, v11
s_nop 0
v_readfirstlane_b32 s60, v15
s_nop 0
s_cmp_ge_u32 s60, 2
s_cbranch_scc1 L_ckd53
ds_read_b128 v[8:11], v12 offset:16
s_waitcnt lgkmcnt(0)
s_branch L_ck52
L_ckd53:
s_add_u32 m0, s67, 65536
s_add_u32 s62, s64, 256
s_and_b32 s62, s62, 0x3ff
buffer_load_dwordx4 v244, s[48:51], s62 offen offset:0 lds
buffer_load_dwordx4 v245, s[48:51], s62 offen offset:1024 lds
buffer_load_dwordx4 v246, s[48:51], s62 offen offset:2048 lds
buffer_load_dwordx4 v247, s[48:51], s62 offen offset:3072 lds
s_add_u32 m0, s67, 81920
s_nop 0
buffer_load_dwordx4 v244, s[52:55], s62 offen offset:0 lds
buffer_load_dwordx4 v245, s[52:55], s62 offen offset:1024 lds
buffer_load_dwordx4 v246, s[52:55], s62 offen offset:2048 lds
buffer_load_dwordx4 v247, s[52:55], s62 offen offset:3072 lds
s_mov_b32 s92, 0
L_w54:
global_load_dword v8, v18, s[32:33] sc1
s_waitcnt vmcnt(0)
v_cmp_ne_u32 vcc, s37, v8
s_nop 0
s_cbranch_vccz L_wd55
s_sleep 4
s_add_u32 s92, s92, 1
s_cmp_lt_u32 s92, 200000
s_cbranch_scc1 L_w54
L_wd55:
v_mov_b32 v14, 5
s_mov_b64 exec, 1
ds_write_b32 v13, v14
s_mov_b64 exec, -1
s_add_u32 s63, s65, 8192
s_and_b32 s63, s63, 0xffff
buffer_load_dwordx4 v[180:183], v2, s[40:43], s63 offen offset:0 sc1
buffer_load_dwordx4 v[184:187], v2, s[40:43], s63 offen offset:1024 sc1
buffer_load_dwordx4 v[188:191], v2, s[40:43], s63 offen offset:2048 sc1
buffer_load_dwordx4 v[192:195], v2, s[40:43], s63 offen offset:3072 sc1
s_add_u32 m0, s67, 98304
s_add_u32 s62, s64, 384
s_and_b32 s62, s62, 0x3ff
buffer_load_dwordx4 v244, s[48:51], s62 offen offset:0 lds
buffer_load_dwordx4 v245, s[48:51], s62 offen offset:1024 lds
buffer_load_dwordx4 v246, s[48:51], s62 offen offset:2048 lds
buffer_load_dwordx4 v247, s[48:51], s62 offen offset:3072 lds
s_add_u32 s63, s65, 12288
s_and_b32 s63, s63, 0xffff
buffer_load_dwordx4 v[196:199], v2, s[40:43], s63 offen offset:0 sc1
buffer_load_dwordx4 v[200:203], v2, s[40:43], s63 offen offset:1024 sc1
buffer_load_dwordx4 v[204:207], v2, s[40:43], s63 offen offset:2048 sc1
buffer_load_dwordx4 v[208:211], v2, s[40:43], s63 offen offset:3072 sc1
ds_read_b128 v[8:11], v12 offset:0
s_waitcnt lgkmcnt(0)
L_ck56:
v_min3_u32 v15, v8, v9, v10
v_min_u32 v15, v15, v11
s_nop 0
v_readfirstlane_b32 s60, v15
s_nop 0
s_cmp_ge_u32 s60, 5
s_cbranch_scc1 L_ckd57
ds_read_b128 v[8:11], v12 offset:0
s_waitcnt lgkmcnt(0)
s_branch L_ck56
L_ckd57:
ds_read_b128 v[96:99], v20 offset:32768
ds_read_b128 v[100:103], v20 offset:36864
ds_read_b128 v[104:107], v20 offset:40960
ds_read_b128 v[108:111], v20 offset:45056
s_waitcnt vmcnt(11) lgkmcnt(3)
v_mfma_f32_32x32x16_bf16 v[32:47], v[180:183], v[96:99], v[32:47]
ds_read_b128 v[112:115], v21 offset:32768
ds_read_b128 v[116:119], v21 offset:36864
s_waitcnt lgkmcnt(4)
v_mfma_f32_32x32x16_bf16 v[48:63], v[180:183], v[100:103], v[48:63]
ds_read_b128 v[120:123], v21 offset:40960
ds_read_b128 v[124:127], v21 offset:45056
s_waitcnt lgkmcnt(5)
v_mfma_f32_32x32x16_bf16 v[64:79], v[180:183], v[104:107], v[64:79]
s_waitcnt lgkmcnt(4)
v_mfma_f32_32x32x16_bf16 v[80:95], v[180:183], v[108:111], v[80:95]
s_add_u32 s63, s65, 16384
s_and_b32 s63, s63, 0xffff
buffer_load_dwordx4 v[212:215], v2, s[40:43], s63 offen offset:0 sc1
buffer_load_dwordx4 v[216:219], v2, s[40:43], s63 offen offset:1024 sc1
s_waitcnt vmcnt(12) lgkmcnt(3)
v_mfma_f32_32x32x16_bf16 v[32:47], v[184:187], v[112:115], v[32:47]
ds_read_b128 v[96:99], v22 offset:32768
ds_read_b128 v[100:103], v22 offset:36864
s_waitcnt lgkmcnt(4)
v_mfma_f32_32x32x16_bf16 v[48:63], v[184:187], v[116:119], v[48:63]
ds_read_b128 v[104:107], v22 offset:40960
ds_read_b128 v[108:111], v22 offset:45056
s_waitcnt lgkmcnt(5)
v_mfma_f32_32x32x16_bf16 v[64:79], v[184:187], v[120:123], v[64:79]
s_waitcnt lgkmcnt(4)
v_mfma_f32_32x32x16_bf16 v[80:95], v[184:187], v[124:127], v[80:95]
buffer_load_dwordx4 v[220:223], v2, s[40:43], s63 offen offset:2048 sc1
buffer_load_dwordx4 v[224:227], v2, s[40:43], s63 offen offset:3072 sc1
s_waitcnt vmcnt(13) lgkmcnt(3)
v_mfma_f32_32x32x16_bf16 v[32:47], v[188:191], v[96:99], v[32:47]
ds_read_b128 v[112:115], v23 offset:32768
ds_read_b128 v[116:119], v23 offset:36864
s_waitcnt lgkmcnt(4)
v_mfma_f32_32x32x16_bf16 v[48:63], v[188:191], v[100:103], v[48:63]
ds_read_b128 v[120:123], v23 offset:40960
ds_read_b128 v[124:127], v23 offset:45056
s_waitcnt lgkmcnt(5)
v_mfma_f32_32x32x16_bf16 v[64:79], v[188:191], v[104:107], v[64:79]
s_waitcnt lgkmcnt(4)
v_mfma_f32_32x32x16_bf16 v[80:95], v[188:191], v[108:111], v[80:95]
s_add_u32 s63, s65, 20480
s_and_b32 s63, s63, 0xffff
buffer_load_dwordx4 v[228:231], v2, s[40:43], s63 offen offset:0 sc1
buffer_load_dwordx4 v[232:235], v2, s[40:43], s63 offen offset:1024 sc1
s_waitcnt vmcnt(14) lgkmcnt(3)
v_mfma_f32_32x32x16_bf16 v[32:47], v[192:195], v[112:115], v[32:47]
ds_read_b128 v[96:99], v20 offset:49152
ds_read_b128 v[100:103], v20 offset:53248
s_waitcnt lgkmcnt(4)
v_mfma_f32_32x32x16_bf16 v[48:63], v[192:195], v[116:119], v[48:63]
ds_read_b128 v[104:107], v20 offset:57344
ds_read_b128 v[108:111], v20 offset:61440
s_waitcnt lgkmcnt(5)
v_mfma_f32_32x32x16_bf16 v[64:79], v[192:195], v[120:123], v[64:79]
s_waitcnt lgkmcnt(4)
v_mfma_f32_32x32x16_bf16 v[80:95], v[192:195], v[124:127], v[80:95]
buffer_load_dwordx4 v[236:239], v2, s[40:43], s63 offen offset:2048 sc1
buffer_load_dwordx4 v[240:243], v2, s[40:43], s63 offen offset:3072 sc1
s_waitcnt vmcnt(11) lgkmcnt(3)
v_mov_b32 v14, 6
s_mov_b64 exec, 1
ds_write_b32 v13, v14
s_mov_b64 exec, -1
v_mfma_f32_32x32x16_bf16 v[32:47], v[196:199], v[96:99], v[32:47]
ds_read_b128 v[112:115], v21 offset:49152
ds_read_b128 v[116:119], v21 offset:53248
s_waitcnt lgkmcnt(5)
v_mfma_f32_32x32x16_bf16 v[48:63], v[196:199], v[100:103], v[48:63]
ds_read_b128 v[120:123], v21 offset:57344
ds_read_b128 v[124:127], v21 offset:61440
s_waitcnt lgkmcnt(6)
v_mfma_f32_32x32x16_bf16 v[64:79], v[196:199], v[104:107], v[64:79]
s_add_u32 m0, s67, 0
s_nop 0
buffer_load_dwordx4 v244, s[52:55], s62 offen offset:0 lds
s_waitcnt lgkmcnt(5)
v_mfma_f32_32x32x16_bf16 v[80:95], v[196:199], v[108:111], v[80:95]
s_add_u32 s63, s65, 24576
s_and_b32 s63, s63, 0xffff
buffer_load_dwordx4 v[148:151], v2, s[40:43], s63 offen offset:0 sc1
buffer_load_dwordx4 v[152:155], v2, s[40:43], s63 offen offset:1024 sc1
s_waitcnt vmcnt(13) lgkmcnt(3)
v_mfma_f32_32x32x16_bf16 v[32:47], v[200:203], v[112:115], v[32:47]
ds_read_b128 v[96:99], v22 offset:49152
ds_read_b128 v[100:103], v22 offset:53248
s_waitcnt lgkmcnt(4)
v_mfma_f32_32x32x16_bf16 v[48:63], v[200:203], v[116:119], v[48:63]
ds_read_b128 v[104:107], v22 offset:57344
ds_read_b128 v[108:111], v22 offset:61440
s_waitcnt lgkmcnt(5)
v_mfma_f32_32x32x16_bf16 v[64:79], v[200:203], v[120:123], v[64:79]
buffer_load_dwordx4 v245, s[52:55], s62 offen offset:1024 lds
s_waitcnt lgkmcnt(4)
v_mfma_f32_32x32x16_bf16 v[80:95], v[200:203], v[124:127], v[80:95]
buffer_load_dwordx4 v[156:159], v2, s[40:43], s63 offen offset:2048 sc1
buffer_load_dwordx4 v[160:163], v2, s[40:43], s63 offen offset:3072 sc1
s_waitcnt vmcnt(15) lgkmcnt(3)
v_mfma_f32_32x32x16_bf16 v[32:47], v[204:207], v[96:99], v[32:47]
ds_read_b128 v[112:115], v23 offset:49152
ds_read_b128 v[116:119], v23 offset:53248
s_waitcnt lgkmcnt(4)
v_mfma_f32_32x32x16_bf16 v[48:63], v[204:207], v[100:103], v[48:63]
ds_read_b128 v[120:123], v23 offset:57344
ds_read_b128 v[124:127], v23 offset:61440
s_waitcnt lgkmcnt(5)
v_mfma_f32_32x32x16_bf16 v[64:79], v[204:207], v[104:107], v[64:79]
buffer_load_dwordx4 v246, s[52:55], s62 offen offset:2048 lds
s_waitcnt lgkmcnt(4)
v_mfma_f32_32x32x16_bf16 v[80:95], v[204:207], v[108:111], v[80:95]
s_add_u32 s63, s65, 28672
s_and_b32 s63, s63, 0xffff
buffer_load_dwordx4 v[164:167], v2, s[40:43], s63 offen offset:0 sc1
buffer_load_dwordx4 v[168:171], v2, s[40:43], s63 offen offset:1024 sc1
ds_read_b128 v[8:11], v12
s_waitcnt vmcnt(17) lgkmcnt(0)
L_ck58:
v_min3_u32 v15, v8, v9, v10
v_min_u32 v15, v15, v11
s_nop 0
v_readfirstlane_b32 s60, v15
s_nop 0
s_cmp_ge_u32 s60, 6
s_cbranch_scc1 L_ckd59
ds_read_b128 v[8:11], v12 offset:0
s_waitcnt lgkmcnt(0)
s_branch L_ck58
L_ckd59:
v_mfma_f32_32x32x16_bf16 v[32:47], v[208:211], v[112:115], v[32:47]
ds_read_b128 v[96:99], v24 offset:0
ds_read_b128 v[100:103], v24 offset:4096
v_mfma_f32_32x32x16_bf16 v[48:63], v[208:211], v[116:119], v[48:63]
ds_read_b128 v[104:107], v24 offset:8192
ds_read_b128 v[108:111], v24 offset:12288
v_mfma_f32_32x32x16_bf16 v[64:79], v[208:211], v[120:123], v[64:79]
buffer_load_dwordx4 v247, s[52:55], s62 offen offset:3072 lds
v_mfma_f32_32x32x16_bf16 v[80:95], v[208:211], v[124:127], v[80:95]
buffer_load_dwordx4 v[172:175], v2, s[40:43], s63 offen offset:2048 sc1
buffer_load_dwordx4 v[176:179], v2, s[40:43], s63 offen offset:3072 sc1
s_waitcnt vmcnt(19) lgkmcnt(3)
v_mfma_f32_32x32x16_bf16 v[32:47], v[212:215], v[96:99], v[32:47]
ds_read_b128 v[112:115], v25 offset:0
ds_read_b128 v[116:119], v25 offset:4096
s_waitcnt lgkmcnt(4)
v_mfma_f32_32x32x16_bf16 v[48:63], v[212:215], v[100:103], v[48:63]
ds_read_b128 v[120:123], v25 offset:8192
ds_read_b128 v[124:127], v25 offset:12288
s_waitcnt lgkmcnt(5)
v_mfma_f32_32x32x16_bf16 v[64:79], v[212:215], v[104:107], v[64:79]
s_add_u32 m0, s67, 16384
s_add_u32 s62, s64, 512
s_and_b32 s62, s62, 0x3ff
buffer_load_dwordx4 v244, s[48:51], s62 offen offset:0 lds
s_waitcnt lgkmcnt(4)
v_mfma_f32_32x32x16_bf16 v[80:95], v[212:215], v[108:111], v[80:95]
s_add_u32 s63, s65, 32768
s_and_b32 s63, s63, 0xffff
buffer_load_dwordx4 v[180:183], v2, s[40:43], s63 offen offset:0 sc1
buffer_load_dwordx4 v[184:187], v2, s[40:43], s63 offen offset:1024 sc1
s_waitcnt vmcnt(21) lgkmcnt(3)
v_mfma_f32_32x32x16_bf16 v[32:47], v[216:219], v[112:115], v[32:47]
ds_read_b128 v[96:99], v26 offset:0
ds_read_b128 v[100:103], v26 offset:4096
s_waitcnt lgkmcnt(4)
v_mfma_f32_32x32x16_bf16 v[48:63], v[216:219], v[116:119], v[48:63]
ds_read_b128 v[104:107], v26 offset:8192
ds_read_b128 v[108:111], v26 offset:12288
s_waitcnt lgkmcnt(5)
v_mfma_f32_32x32x16_bf16 v[64:79], v[216:219], v[120:123], v[64:79]
buffer_load_dwordx4 v245, s[48:51], s62 offen offset:1024 lds
s_waitcnt lgkmcnt(4)
v_mfma_f32_32x32x16_bf16 v[80:95], v[216:219], v[124:127], v[80:95]
buffer_load_dwordx4 v[188:191], v2, s[40:43], s63 offen offset:2048 sc1
buffer_load_dwordx4 v[192:195], v2, s[40:43], s63 offen offset:3072 sc1
s_waitcnt vmcnt(23) lgkmcnt(3)
v_mfma_f32_32x32x16_bf16 v[32:47], v[220:223], v[96:99], v[32:47]
ds_read_b128 v[112:115], v27 offset:0
ds_read_b128 v[116:119], v27 offset:4096
s_waitcnt lgkmcnt(4)
v_mfma_f32_32x32x16_bf16 v[48:63], v[220:223], v[100:103], v[48:63]
ds_read_b128 v[120:123], v27 offset:8192
ds_read_b128 v[124:127], v27 offset:12288
s_waitcnt lgkmcnt(5)
v_mfma_f32_32x32x16_bf16 v[64:79], v[220:223], v[104:107], v[64:79]
buffer_load_dwordx4 v246, s[48:51], s62 offen offset:2048 lds
s_waitcnt lgkmcnt(4)
v_mfma_f32_32x32x16_bf16 v[80:95], v[220:223], v[108:111], v[80:95]
s_add_u32 s63, s65, 36864
s_and_b32 s63, s63, 0xffff
buffer_load_dwordx4 v[196:199], v2, s[40:43], s63 offen offset:0 sc1
buffer_load_dwordx4 v[200:203], v2, s[40:43], s63 offen offset:1024 sc1
s_waitcnt vmcnt(25) lgkmcnt(3)
v_mfma_f32_32x32x16_bf16 v[32:47], v[224:227], v[112:115], v[32:47]
ds_read_b128 v[96:99], v24 offset:16384
ds_read_b128 v[100:103], v24 offset:20480
s_waitcnt lgkmcnt(4)
v_mfma_f32_32x32x16_bf16 v[48:63], v[224:227], v[116:119], v[48:63]
ds_read_b128 v[104:107], v24 offset:24576
ds_read_b128 v[108:111], v24 offset:28672
s_waitcnt lgkmcnt(5)
v_mfma_f32_32x32x16_bf16 v[64:79], v[224:227], v[120:123], v[64:79]
buffer_load_dwordx4 v247, s[48:51], s62 offen offset:3072 lds
s_waitcnt lgkmcnt(4)
v_mfma_f32_32x32x16_bf16 v[80:95], v[224:227], v[124:127], v[80:95]
buffer_load_dwordx4 v[204:207], v2, s[40:43], s63 offen offset:2048 sc1
buffer_load_dwordx4 v[208:211], v2, s[40:43], s63 offen offset:3072 sc1
s_waitcnt vmcnt(14) lgkmcnt(3)
v_mov_b32 v14, 7
s_mov_b64 exec, 1
ds_write_b32 v13, v14
s_mov_b64 exec, -1
v_mfma_f32_32x32x16_bf16 v[32:47], v[228:231], v[96:99], v[32:47]
ds_read_b128 v[112:115], v25 offset:16384
ds_read_b128 v[116:119], v25 offset:20480
s_waitcnt lgkmcnt(5)
v_mfma_f32_32x32x16_bf16 v[48:63], v[228:231], v[100:103], v[48:63]
ds_read_b128 v[120:123], v25 offset:24576
ds_read_b128 v[124:127], v25 offset:28672
s_waitcnt lgkmcnt(6)
v_mfma_f32_32x32x16_bf16 v[64:79], v[228:231], v[104:107], v[64:79]
s_add_u32 m0, s67, 32768
s_nop 0
buffer_load_dwordx4 v244, s[52:55], s62 offen offset:0 lds
s_waitcnt lgkmcnt(5)
v_mfma_f32_32x32x16_bf16 v[80:95], v[228:231], v[108:111], v[80:95]
s_add_u32 s63, s65, 40960
s_and_b32 s63, s63, 0xffff
buffer_load_dwordx4 v[212:215], v2, s[40:43], s63 offen offset:0 sc1
buffer_load_dwordx4 v[216:219], v2, s[40:43], s63 offen offset:1024 sc1
s_waitcnt vmcnt(29) lgkmcnt(3)
v_mfma_f32_32x32x16_bf16 v[32:47], v[232:235], v[112:115], v[32:47]
ds_read_b128 v[96:99], v26 offset:16384
ds_read_b128 v[100:103], v26 offset:20480
s_waitcnt lgkmcnt(4)
v_mfma_f32_32x32x16_bf16 v[48:63], v[232:235], v[116:119], v[48:63]
ds_read_b128 v[104:107], v26 offset:24576
ds_read_b128 v[108:111], v26 offset:28672
s_waitcnt lgkmcnt(5)
v_mfma_f32_32x32x16_bf16 v[64:79], v[232:235], v[120:123], v[64:79]
buffer_load_dwordx4 v245, s[52:55], s62 offen offset:1024 lds
s_waitcnt lgkmcnt(4)
v_mfma_f32_32x32x16_bf16 v[80:95], v[232:235], v[124:127], v[80:95]
buffer_load_dwordx4 v[220:223], v2, s[40:43], s63 offen offset:2048 sc1
buffer_load_dwordx4 v[224:227], v2, s[40:43], s63 offen offset:3072 sc1
s_waitcnt vmcnt(31) lgkmcnt(3)
v_mfma_f32_32x32x16_bf16 v[32:47], v[236:239], v[96:99], v[32:47]
ds_read_b128 v[112:115], v27 offset:16384
ds_read_b128 v[116:119], v27 offset:20480
s_waitcnt lgkmcnt(4)
v_mfma_f32_32x32x16_bf16 v[48:63], v[236:239], v[100:103], v[48:63]
ds_read_b128 v[120:123], v27 offset:24576
ds_read_b128 v[124:127], v27 offset:28672
s_waitcnt lgkmcnt(5)
v_mfma_f32_32x32x16_bf16 v[64:79], v[236:239], v[104:107], v[64:79]
buffer_load_dwordx4 v246, s[52:55], s62 offen offset:2048 lds
s_waitcnt lgkmcnt(4)
v_mfma_f32_32x32x16_bf16 v[80:95], v[236:239], v[108:111], v[80:95]
s_add_u32 s63, s65, 45056
s_and_b32 s63, s63, 0xffff
buffer_load_dwordx4 v[228:231], v2, s[40:43], s63 offen offset:0 sc1
buffer_load_dwordx4 v[232:235], v2, s[40:43], s63 offen offset:1024 sc1
ds_read_b128 v[8:11], v12
s_waitcnt vmcnt(33) lgkmcnt(0)
L_ck60:
v_min3_u32 v15, v8, v9, v10
v_min_u32 v15, v15, v11
s_nop 0
v_readfirstlane_b32 s60, v15
s_nop 0
s_cmp_ge_u32 s60, 7
s_cbranch_scc1 L_ckd61
ds_read_b128 v[8:11], v12 offset:0
s_waitcnt lgkmcnt(0)
s_branch L_ck60
L_ckd61:
v_mfma_f32_32x32x16_bf16 v[32:47], v[240:243], v[112:115], v[32:47]
ds_read_b128 v[96:99], v24 offset:32768
ds_read_b128 v[100:103], v24 offset:36864
v_mfma_f32_32x32x16_bf16 v[48:63], v[240:243], v[116:119], v[48:63]
ds_read_b128 v[104:107], v24 offset:40960
ds_read_b128 v[108:111], v24 offset:45056
v_mfma_f32_32x32x16_bf16 v[64:79], v[240:243], v[120:123], v[64:79]
buffer_load_dwordx4 v247, s[52:55], s62 offen offset:3072 lds
v_mfma_f32_32x32x16_bf16 v[80:95], v[240:243], v[124:127], v[80:95]
buffer_load_dwordx4 v[236:239], v2, s[40:43], s63 offen offset:2048 sc1
buffer_load_dwordx4 v[240:243], v2, s[40:43], s63 offen offset:3072 sc1
s_waitcnt vmcnt(34) lgkmcnt(3)
v_mfma_f32_32x32x16_bf16 v[32:47], v[148:151], v[96:99], v[32:47]
ds_read_b128 v[112:115], v25 offset:32768
ds_read_b128 v[116:119], v25 offset:36864
s_waitcnt lgkmcnt(4)
v_mfma_f32_32x32x16_bf16 v[48:63], v[148:151], v[100:103], v[48:63]
ds_read_b128 v[120:123], v25 offset:40960
ds_read_b128 v[124:127], v25 offset:45056
s_waitcnt lgkmcnt(5)
v_mfma_f32_32x32x16_bf16 v[64:79], v[148:151], v[104:107], v[64:79]
s_add_u32 m0, s67, 49152
s_add_u32 s62, s64, 640
s_and_b32 s62, s62, 0x3ff
buffer_load_dwordx4 v244, s[48:51], s62 offen offset:0 lds
s_waitcnt lgkmcnt(4)
v_mfma_f32_32x32x16_bf16 v[80:95], v[148:151], v[108:111], v[80:95]
s_add_u32 s63, s65, 49152
s_and_b32 s63, s63, 0xffff
buffer_load_dwordx4 v[148:151], v2, s[40:43], s63 offen offset:0 sc1
s_waitcnt vmcnt(35) lgkmcnt(3)
v_mfma_f32_32x32x16_bf16 v[32:47], v[152:155], v[112:115], v[32:47]
ds_read_b128 v[96:99], v26 offset:32768
ds_read_b128 v[100:103], v26 offset:36864
s_waitcnt lgkmcnt(4)
v_mfma_f32_32x32x16_bf16 v[48:63], v[152:155], v[116:119], v[48:63]
ds_read_b128 v[104:107], v26 offset:40960
ds_read_b128 v[108:111], v26 offset:45056
s_waitcnt lgkmcnt(5)
v_mfma_f32_32x32x16_bf16 v[64:79], v[152:155], v[120:123], v[64:79]
buffer_load_dwordx4 v245, s[48:51], s62 offen offset:1024 lds
s_waitcnt lgkmcnt(4)
v_mfma_f32_32x32x16_bf16 v[80:95], v[152:155], v[124:127], v[80:95]
buffer_load_dwordx4 v[152:155], v2, s[40:43], s63 offen offset:1024 sc1
s_waitcnt vmcnt(35) lgkmcnt(3)
v_mfma_f32_32x32x16_bf16 v[32:47], v[156:159], v[96:99], v[32:47]
ds_read_b128 v[112:115], v27 offset:32768
ds_read_b128 v[116:119], v27 offset:36864
s_waitcnt lgkmcnt(4)
v_mfma_f32_32x32x16_bf16 v[48:63], v[156:159], v[100:103], v[48:63]
ds_read_b128 v[120:123], v27 offset:40960
ds_read_b128 v[124:127], v27 offset:45056
s_waitcnt lgkmcnt(5)
v_mfma_f32_32x32x16_bf16 v[64:79], v[156:159], v[104:107], v[64:79]
buffer_load_dwordx4 v246, s[48:51], s62 offen offset:2048 lds
s_waitcnt lgkmcnt(4)
v_mfma_f32_32x32x16_bf16 v[80:95], v[156:159], v[108:111], v[80:95]
buffer_load_dwordx4 v[156:159], v2, s[40:43], s63 offen offset:2048 sc1
s_waitcnt vmcnt(36) lgkmcnt(3)
v_mfma_f32_32x32x16_bf16 v[32:47], v[160:163], v[112:115], v[32:47]
ds_read_b128 v[96:99], v20 offset:0
ds_read_b128 v[100:103], v20 offset:4096
s_waitcnt lgkmcnt(4)
v_mfma_f32_32x32x16_bf16 v[48:63], v[160:163], v[116:119], v[48:63]
ds_read_b128 v[104:107], v20 offset:8192
ds_read_b128 v[108:111], v20 offset:12288
s_waitcnt lgkmcnt(5)
v_mfma_f32_32x32x16_bf16 v[64:79], v[160:163], v[120:123], v[64:79]
buffer_load_dwordx4 v247, s[48:51], s62 offen offset:3072 lds
s_waitcnt lgkmcnt(4)
v_mfma_f32_32x32x16_bf16 v[80:95], v[160:163], v[124:127], v[80:95]
buffer_load_dwordx4 v[160:163], v2, s[40:43], s63 offen offset:3072 sc1
s_waitcnt vmcnt(10) lgkmcnt(3)
v_mov_b32 v14, 8
s_mov_b64 exec, 1
ds_write_b32 v13, v14
s_mov_b64 exec, -1
v_mfma_f32_32x32x16_bf16 v[32:47], v[164:167], v[96:99], v[32:47]
ds_read_b128 v[112:115], v21 offset:0
ds_read_b128 v[116:119], v21 offset:4096
s_waitcnt lgkmcnt(5)
v_mfma_f32_32x32x16_bf16 v[48:63], v[164:167], v[100:103], v[48:63]
ds_read_b128 v[120:123], v21 offset:8192
ds_read_b128 v[124:127], v21 offset:12288
s_waitcnt lgkmcnt(6)
v_mfma_f32_32x32x16_bf16 v[64:79], v[164:167], v[104:107], v[64:79]
s_add_u32 m0, s67, 65536
s_nop 0
buffer_load_dwordx4 v244, s[52:55], s62 offen offset:0 lds
s_waitcnt lgkmcnt(5)
v_mfma_f32_32x32x16_bf16 v[80:95], v[164:167], v[108:111], v[80:95]
s_add_u32 s63, s65, 53248
s_and_b32 s63, s63, 0xffff
buffer_load_dwordx4 v[164:167], v2, s[40:43], s63 offen offset:0 sc1
s_waitcnt vmcnt(37) lgkmcnt(3)
v_mfma_f32_32x32x16_bf16 v[32:47], v[168:171], v[112:115], v[32:47]
ds_read_b128 v[96:99], v22 offset:0
ds_read_b128 v[100:103], v22 offset:4096
s_waitcnt lgkmcnt(4)
v_mfma_f32_32x32x16_bf16 v[48:63], v[168:171], v[116:119], v[48:63]
ds_read_b128 v[104:107], v22 offset:8192
ds_read_b128 v[108:111], v22 offset:12288
s_waitcnt lgkmcnt(5)
v_mfma_f32_32x32x16_bf16 v[64:79], v[168:171], v[120:123], v[64:79]
buffer_load_dwordx4 v245, s[52:55], s62 offen offset:1024 lds
s_waitcnt lgkmcnt(4)
v_mfma_f32_32x32x16_bf16 v[80:95], v[168:171], v[124:127], v[80:95]
buffer_load_dwordx4 v[168:171], v2, s[40:43], s63 offen offset:1024 sc1
s_waitcnt vmcnt(37) lgkmcnt(3)
v_mfma_f32_32x32x16_bf16 v[32:47], v[172:175], v[96:99], v[32:47]
ds_read_b128 v[112:115], v23 offset:0
ds_read_b128 v[116:119], v23 offset:4096
s_waitcnt lgkmcnt(4)
v_mfma_f32_32x32x16_bf16 v[48:63], v[172:175], v[100:103], v[48:63]
ds_read_b128 v[120:123], v23 offset:8192
ds_read_b128 v[124:127], v23 offset:12288
s_waitcnt lgkmcnt(5)
v_mfma_f32_32x32x16_bf16 v[64:79], v[172:175], v[104:107], v[64:79]
buffer_load_dwordx4 v246, s[52:55], s62 offen offset:2048 lds
s_waitcnt lgkmcnt(4)
v_mfma_f32_32x32x16_bf16 v[80:95], v[172:175], v[108:111], v[80:95]
buffer_load_dwordx4 v[172:175], v2, s[40:43], s63 offen offset:2048 sc1
ds_read_b128 v[8:11], v12
s_waitcnt vmcnt(38) lgkmcnt(0)
L_ck62:
v_min3_u32 v15, v8, v9, v10
v_min_u32 v15, v15, v11
s_nop 0
v_readfirstlane_b32 s60, v15
s_nop 0
s_cmp_ge_u32 s60, 8
s_cbranch_scc1 L_ckd63
ds_read_b128 v[8:11], v12 offset:0
s_waitcnt lgkmcnt(0)
s_branch L_ck62
L_ckd63:
v_mfma_f32_32x32x16_bf16 v[32:47], v[176:179], v[112:115], v[32:47]
ds_read_b128 v[96:99], v20 offset:16384
ds_read_b128 v[100:103], v20 offset:20480
v_mfma_f32_32x32x16_bf16 v[48:63], v[176:179], v[116:119], v[48:63]
ds_read_b128 v[104:107], v20 offset:24576
ds_read_b128 v[108:111], v20 offset:28672
v_mfma_f32_32x32x16_bf16 v[64:79], v[176:179], v[120:123], v[64:79]
buffer_load_dwordx4 v247, s[52:55], s62 offen offset:3072 lds
v_mfma_f32_32x32x16_bf16 v[80:95], v[176:179], v[124:127], v[80:95]
buffer_load_dwordx4 v[176:179], v2, s[40:43], s63 offen offset:3072 sc1
s_waitcnt vmcnt(38) lgkmcnt(3)
v_mfma_f32_32x32x16_bf16 v[32:47], v[180:183], v[96:99], v[32:47]
ds_read_b128 v[112:115], v21 offset:16384
ds_read_b128 v[116:119], v21 offset:20480
s_waitcnt lgkmcnt(4)
v_mfma_f32_32x32x16_bf16 v[48:63], v[180:183], v[100:103], v[48:63]
ds_read_b128 v[120:123], v21 offset:24576
ds_read_b128 v[124:127], v21 offset:28672
s_waitcnt lgkmcnt(5)
v_mfma_f32_32x32x16_bf16 v[64:79], v[180:183], v[104:107], v[64:79]
s_add_u32 m0, s67, 81920
s_add_u32 s62, s64, 768
s_and_b32 s62, s62, 0x3ff
buffer_load_dwordx4 v244, s[48:51], s62 offen offset:0 lds
s_waitcnt lgkmcnt(4)
v_mfma_f32_32x32x16_bf16 v[80:95], v[180:183], v[108:111], v[80:95]
s_add_u32 s63, s65, 57344
s_and_b32 s63, s63, 0xffff
buffer_load_dwordx4 v[180:183], v2, s[40:43], s63 offen offset:0 sc1
s_waitcnt vmcnt(39) lgkmcnt(3)
v_mfma_f32_32x32x16_bf16 v[32:47], v[184:187], v[112:115], v[32:47]
ds_read_b128 v[96:99], v22 offset:16384
ds_read_b128 v[100:103], v22 offset:20480
s_waitcnt lgkmcnt(4)
v_mfma_f32_32x32x16_bf16 v[48:63], v[184:187], v[116:119], v[48:63]
ds_read_b128 v[104:107], v22 offset:24576
ds_read_b128 v[108:111], v22 offset:28672
s_waitcnt lgkmcnt(5)
v_mfma_f32_32x32x16_bf16 v[64:79], v[184:187], v[120:123], v[64:79]
buffer_load_dwordx4 v245, s[48:51], s62 offen offset:1024 lds
s_waitcnt lgkmcnt(4)
v_mfma_f32_32x32x16_bf16 v[80:95], v[184:187], v[124:127], v[80:95]
buffer_load_dwordx4 v[184:187], v2, s[40:43], s63 offen offset:1024 sc1
s_waitcnt vmcnt(39) lgkmcnt(3)
v_mfma_f32_32x32x16_bf16 v[32:47], v[188:191], v[96:99], v[32:47]
ds_read_b128 v[112:115], v23 offset:16384
ds_read_b128 v[116:119], v23 offset:20480
s_waitcnt lgkmcnt(4)
v_mfma_f32_32x32x16_bf16 v[48:63], v[188:191], v[100:103], v[48:63]
ds_read_b128 v[120:123], v23 offset:24576
ds_read_b128 v[124:127], v23 offset:28672
s_waitcnt lgkmcnt(5)
v_mfma_f32_32x32x16_bf16 v[64:79], v[188:191], v[104:107], v[64:79]
buffer_load_dwordx4 v246, s[48:51], s62 offen offset:2048 lds
s_waitcnt lgkmcnt(4)
v_mfma_f32_32x32x16_bf16 v[80:95], v[188:191], v[108:111], v[80:95]
buffer_load_dwordx4 v[188:191], v2, s[40:43], s63 offen offset:2048 sc1
s_waitcnt vmcnt(40) lgkmcnt(3)
v_mfma_f32_32x32x16_bf16 v[32:47], v[192:195], v[112:115], v[32:47]
ds_read_b128 v[96:99], v20 offset:32768
ds_read_b128 v[100:103], v20 offset:36864
s_waitcnt lgkmcnt(4)
v_mfma_f32_32x32x16_bf16 v[48:63], v[192:195], v[116:119], v[48:63]
ds_read_b128 v[104:107], v20 offset:40960
ds_read_b128 v[108:111], v20 offset:45056
s_waitcnt lgkmcnt(5)
v_mfma_f32_32x32x16_bf16 v[64:79], v[192:195], v[120:123], v[64:79]
buffer_load_dwordx4 v247, s[48:51], s62 offen offset:3072 lds
s_waitcnt lgkmcnt(4)
v_mfma_f32_32x32x16_bf16 v[80:95], v[192:195], v[124:127], v[80:95]
buffer_load_dwordx4 v[192:195], v2, s[40:43], s63 offen offset:3072 sc1
s_waitcnt vmcnt(9) lgkmcnt(3)
v_mov_b32 v14, 9
s_mov_b64 exec, 1
ds_write_b32 v13, v14
s_mov_b64 exec, -1
v_mfma_f32_32x32x16_bf16 v[32:47], v[196:199], v[96:99], v[32:47]
ds_read_b128 v[112:115], v21 offset:32768
ds_read_b128 v[116:119], v21 offset:36864
s_waitcnt lgkmcnt(5)
v_mfma_f32_32x32x16_bf16 v[48:63], v[196:199], v[100:103], v[48:63]
ds_read_b128 v[120:123], v21 offset:40960
ds_read_b128 v[124:127], v21 offset:45056
s_waitcnt lgkmcnt(6)
v_mfma_f32_32x32x16_bf16 v[64:79], v[196:199], v[104:107], v[64:79]
s_add_u32 m0, s67, 98304
s_nop 0
buffer_load_dwordx4 v244, s[52:55], s62 offen offset:0 lds
s_waitcnt lgkmcnt(5)
v_mfma_f32_32x32x16_bf16 v[80:95], v[196:199], v[108:111], v[80:95]
s_add_u32 s63, s65, 61440
s_and_b32 s63, s63, 0xffff
buffer_load_dwordx4 v[196:199], v2, s[40:43], s63 offen offset:0 sc1
s_waitcnt vmcnt(41) lgkmcnt(3)
v_mfma_f32_32x32x16_bf16 v[32:47], v[200:203], v[112:115], v[32:47]
ds_read_b128 v[96:99], v22 offset:32768
ds_read_b128 v[100:103], v22 offset:36864
s_waitcnt lgkmcnt(4)
v_mfma_f32_32x32x16_bf16 v[48:63], v[200:203], v[116:119], v[48:63]
ds_read_b128 v[104:107], v22 offset:40960
ds_read_b128 v[108:111], v22 offset:45056
s_waitcnt lgkmcnt(5)
v_mfma_f32_32x32x16_bf16 v[64:79], v[200:203], v[120:123], v[64:79]
buffer_load_dwordx4 v245, s[52:55], s62 offen offset:1024 lds
s_waitcnt lgkmcnt(4)
v_mfma_f32_32x32x16_bf16 v[80:95], v[200:203], v[124:127], v[80:95]
buffer_load_dwordx4 v[200:203], v2, s[40:43], s63 offen offset:1024 sc1
s_waitcnt vmcnt(41) lgkmcnt(3)
v_mfma_f32_32x32x16_bf16 v[32:47], v[204:207], v[96:99], v[32:47]
ds_read_b128 v[112:115], v23 offset:32768
ds_read_b128 v[116:119], v23 offset:36864
s_waitcnt lgkmcnt(4)
v_mfma_f32_32x32x16_bf16 v[48:63], v[204:207], v[100:103], v[48:63]
ds_read_b128 v[120:123], v23 offset:40960
ds_read_b128 v[124:127], v23 offset:45056
s_waitcnt lgkmcnt(5)
v_mfma_f32_32x32x16_bf16 v[64:79], v[204:207], v[104:107], v[64:79]
buffer_load_dwordx4 v246, s[52:55], s62 offen offset:2048 lds
s_waitcnt lgkmcnt(4)
v_mfma_f32_32x32x16_bf16 v[80:95], v[204:207], v[108:111], v[80:95]
buffer_load_dwordx4 v[204:207], v2, s[40:43], s63 offen offset:2048 sc1
ds_read_b128 v[8:11], v12
s_waitcnt vmcnt(42) lgkmcnt(0)
L_ck64:
v_min3_u32 v15, v8, v9, v10
v_min_u32 v15, v15, v11
s_nop 0
v_readfirstlane_b32 s60, v15
s_nop 0
s_cmp_ge_u32 s60, 9
s_cbranch_scc1 L_ckd65
ds_read_b128 v[8:11], v12 offset:0
s_waitcnt lgkmcnt(0)
s_branch L_ck64
L_ckd65:
v_mfma_f32_32x32x16_bf16 v[32:47], v[208:211], v[112:115], v[32:47]
ds_read_b128 v[96:99], v20 offset:49152
ds_read_b128 v[100:103], v20 offset:53248
v_mfma_f32_32x32x16_bf16 v[48:63], v[208:211], v[116:119], v[48:63]
ds_read_b128 v[104:107], v20 offset:57344
ds_read_b128 v[108:111], v20 offset:61440
v_mfma_f32_32x32x16_bf16 v[64:79], v[208:211], v[120:123], v[64:79]
buffer_load_dwordx4 v247, s[52:55], s62 offen offset:3072 lds
v_mfma_f32_32x32x16_bf16 v[80:95], v[208:211], v[124:127], v[80:95]
buffer_load_dwordx4 v[208:211], v2, s[40:43], s63 offen offset:3072 sc1
s_waitcnt vmcnt(42) lgkmcnt(3)
v_mfma_f32_32x32x16_bf16 v[32:47], v[212:215], v[96:99], v[32:47]
ds_read_b128 v[112:115], v21 offset:49152
ds_read_b128 v[116:119], v21 offset:53248
s_waitcnt lgkmcnt(4)
v_mfma_f32_32x32x16_bf16 v[48:63], v[212:215], v[100:103], v[48:63]
ds_read_b128 v[120:123], v21 offset:57344
ds_read_b128 v[124:127], v21 offset:61440
s_waitcnt lgkmcnt(5)
v_mfma_f32_32x32x16_bf16 v[64:79], v[212:215], v[104:107], v[64:79]
s_add_u32 m0, s67, 0
s_add_u32 s62, s64, 896
s_and_b32 s62, s62, 0x3ff
buffer_load_dwordx4 v244, s[48:51], s62 offen offset:0 lds
s_waitcnt lgkmcnt(4)
v_mfma_f32_32x32x16_bf16 v[80:95], v[212:215], v[108:111], v[80:95]
s_waitcnt vmcnt(42) lgkmcnt(3)
v_mfma_f32_32x32x16_bf16 v[32:47], v[216:219], v[112:115], v[32:47]
ds_read_b128 v[96:99], v22 offset:49152
ds_read_b128 v[100:103], v22 offset:53248
s_waitcnt lgkmcnt(4)
v_mfma_f32_32x32x16_bf16 v[48:63], v[216:219], v[116:119], v[48:63]
ds_read_b128 v[104:107], v22 offset:57344
ds_read_b128 v[108:111], v22 offset:61440
s_waitcnt lgkmcnt(5)
v_mfma_f32_32x32x16_bf16 v[64:79], v[216:219], v[120:123], v[64:79]
buffer_load_dwordx4 v245, s[48:51], s62 offen offset:1024 lds
s_waitcnt lgkmcnt(4)
v_mfma_f32_32x32x16_bf16 v[80:95], v[216:219], v[124:127], v[80:95]
s_waitcnt vmcnt(41) lgkmcnt(3)
v_mfma_f32_32x32x16_bf16 v[32:47], v[220:223], v[96:99], v[32:47]
ds_read_b128 v[112:115], v23 offset:49152
ds_read_b128 v[116:119], v23 offset:53248
s_waitcnt lgkmcnt(4)
v_mfma_f32_32x32x16_bf16 v[48:63], v[220:223], v[100:103], v[48:63]
ds_read_b128 v[120:123], v23 offset:57344
ds_read_b128 v[124:127], v23 offset:61440
s_waitcnt lgkmcnt(5)
v_mfma_f32_32x32x16_bf16 v[64:79], v[220:223], v[104:107], v[64:79]
buffer_load_dwordx4 v246, s[48:51], s62 offen offset:2048 lds
s_waitcnt lgkmcnt(4)
v_mfma_f32_32x32x16_bf16 v[80:95], v[220:223], v[108:111], v[80:95]
s_waitcnt vmcnt(41) lgkmcnt(3)
v_mfma_f32_32x32x16_bf16 v[32:47], v[224:227], v[112:115], v[32:47]
ds_read_b128 v[96:99], v24 offset:0
ds_read_b128 v[100:103], v24 offset:4096
s_waitcnt lgkmcnt(4)
v_mfma_f32_32x32x16_bf16 v[48:63], v[224:227], v[116:119], v[48:63]
ds_read_b128 v[104:107], v24 offset:8192
ds_read_b128 v[108:111], v24 offset:12288
s_waitcnt lgkmcnt(5)
v_mfma_f32_32x32x16_bf16 v[64:79], v[224:227], v[120:123], v[64:79]
buffer_load_dwordx4 v247, s[48:51], s62 offen offset:3072 lds
s_waitcnt lgkmcnt(4)
v_mfma_f32_32x32x16_bf16 v[80:95], v[224:227], v[124:127], v[80:95]
s_waitcnt vmcnt(5) lgkmcnt(3)
v_mov_b32 v14, 10
s_mov_b64 exec, 1
ds_write_b32 v13, v14
s_mov_b64 exec, -1
v_mfma_f32_32x32x16_bf16 v[32:47], v[228:231], v[96:99], v[32:47]
ds_read_b128 v[112:115], v25 offset:0
ds_read_b128 v[116:119], v25 offset:4096
s_waitcnt lgkmcnt(5)
v_mfma_f32_32x32x16_bf16 v[48:63], v[228:231], v[100:103], v[48:63]
ds_read_b128 v[120:123], v25 offset:8192
ds_read_b128 v[124:127], v25 offset:12288
s_waitcnt lgkmcnt(6)
v_mfma_f32_32x32x16_bf16 v[64:79], v[228:231], v[104:107], v[64:79]
s_add_u32 m0, s67, 16384
s_nop 0
buffer_load_dwordx4 v244, s[52:55], s62 offen offset:0 lds
s_waitcnt lgkmcnt(5)
v_mfma_f32_32x32x16_bf16 v[80:95], v[228:231], v[108:111], v[80:95]
s_waitcnt vmcnt(40) lgkmcnt(3)
v_mfma_f32_32x32x16_bf16 v[32:47], v[232:235], v[112:115], v[32:47]
ds_read_b128 v[96:99], v26 offset:0
ds_read_b128 v[100:103], v26 offset:4096
s_waitcnt lgkmcnt(4)
v_mfma_f32_32x32x16_bf16 v[48:63], v[232:235], v[116:119], v[48:63]
ds_read_b128 v[104:107], v26 offset:8192
ds_read_b128 v[108:111], v26 offset:12288
s_waitcnt lgkmcnt(5)
v_mfma_f32_32x32x16_bf16 v[64:79], v[232:235], v[120:123], v[64:79]
buffer_load_dwordx4 v245, s[52:55], s62 offen offset:1024 lds
s_waitcnt lgkmcnt(4)
v_mfma_f32_32x32x16_bf16 v[80:95], v[232:235], v[124:127], v[80:95]
s_waitcnt vmcnt(39) lgkmcnt(3)
v_mfma_f32_32x32x16_bf16 v[32:47], v[236:239], v[96:99], v[32:47]
ds_read_b128 v[112:115], v27 offset:0
ds_read_b128 v[116:119], v27 offset:4096
s_waitcnt lgkmcnt(4)
v_mfma_f32_32x32x16_bf16 v[48:63], v[236:239], v[100:103], v[48:63]
ds_read_b128 v[120:123], v27 offset:8192
ds_read_b128 v[124:127], v27 offset:12288
s_waitcnt lgkmcnt(5)
v_mfma_f32_32x32x16_bf16 v[64:79], v[236:239], v[104:107], v[64:79]
buffer_load_dwordx4 v246, s[52:55], s62 offen offset:2048 lds
s_waitcnt lgkmcnt(4)
v_mfma_f32_32x32x16_bf16 v[80:95], v[236:239], v[108:111], v[80:95]
ds_read_b128 v[8:11], v12
global_load_dword v31, v30, s[26:27]
s_waitcnt vmcnt(40) lgkmcnt(0)
L_ck66:
v_min3_u32 v15, v8, v9, v10
v_min_u32 v15, v15, v11
s_nop 0
v_readfirstlane_b32 s60, v15
s_nop 0
s_cmp_ge_u32 s60, 10
s_cbranch_scc1 L_ckd67
ds_read_b128 v[8:11], v12 offset:0
s_waitcnt lgkmcnt(0)
s_branch L_ck66
L_ckd67:
v_mfma_f32_32x32x16_bf16 v[32:47], v[240:243], v[112:115], v[32:47]
ds_read_b128 v[96:99], v24 offset:16384
ds_read_b128 v[100:103], v24 offset:20480
v_mfma_f32_32x32x16_bf16 v[48:63], v[240:243], v[116:119], v[48:63]
ds_read_b128 v[104:107], v24 offset:24576
ds_read_b128 v[108:111], v24 offset:28672
v_mfma_f32_32x32x16_bf16 v[64:79], v[240:243], v[120:123], v[64:79]
buffer_load_dwordx4 v247, s[52:55], s62 offen offset:3072 lds
v_mfma_f32_32x32x16_bf16 v[80:95], v[240:243], v[124:127], v[80:95]
s_mov_b32 s60, 0
buffer_load_dword v128, v28, s[56:59], s60 offen offset:0
s_waitcnt vmcnt(40) lgkmcnt(3)
v_mfma_f32_32x32x16_bf16 v[32:47], v[148:151], v[96:99], v[32:47]
ds_read_b128 v[112:115], v25 offset:16384
ds_read_b128 v[116:119], v25 offset:20480
s_waitcnt lgkmcnt(4)
v_mfma_f32_32x32x16_bf16 v[48:63], v[148:151], v[100:103], v[48:63]
ds_read_b128 v[120:123], v25 offset:24576
ds_read_b128 v[124:127], v25 offset:28672
s_waitcnt lgkmcnt(5)
v_mfma_f32_32x32x16_bf16 v[64:79], v[148:151], v[104:107], v[64:79]
s_waitcnt lgkmcnt(4)
v_mfma_f32_32x32x16_bf16 v[80:95], v[148:151], v[108:111], v[80:95]
s_mov_b32 s60, 0
buffer_load_dword v129, v28, s[56:59], s60 offen offset:2048
s_waitcnt vmcnt(39) lgkmcnt(3)
v_mfma_f32_32x32x16_bf16 v[32:47], v[152:155], v[112:115], v[32:47]
ds_read_b128 v[96:99], v26 offset:16384
ds_read_b128 v[100:103], v26 offset:20480
s_waitcnt lgkmcnt(4)
v_mfma_f32_32x32x16_bf16 v[48:63], v[152:155], v[116:119], v[48:63]
ds_read_b128 v[104:107], v26 offset:24576
ds_read_b128 v[108:111], v26 offset:28672
s_waitcnt lgkmcnt(5)
v_mfma_f32_32x32x16_bf16 v[64:79], v[152:155], v[120:123], v[64:79]
s_waitcnt lgkmcnt(4)
v_mfma_f32_32x32x16_bf16 v[80:95], v[152:155], v[124:127], v[80:95]
s_mov_b32 s60, 4096
buffer_load_dword v130, v28, s[56:59], s60 offen offset:0
s_waitcnt vmcnt(38) lgkmcnt(3)
v_mfma_f32_32x32x16_bf16 v[32:47], v[156:159], v[96:99], v[32:47]
ds_read_b128 v[112:115], v27 offset:16384
ds_read_b128 v[116:119], v27 offset:20480
s_waitcnt lgkmcnt(4)
v_mfma_f32_32x32x16_bf16 v[48:63], v[156:159], v[100:103], v[48:63]
ds_read_b128 v[120:123], v27 offset:24576
ds_read_b128 v[124:127], v27 offset:28672
s_waitcnt lgkmcnt(5)
v_mfma_f32_32x32x16_bf16 v[64:79], v[156:159], v[104:107], v[64:79]
s_waitcnt lgkmcnt(4)
v_mfma_f32_32x32x16_bf16 v[80:95], v[156:159], v[108:111], v[80:95]
s_mov_b32 s60, 4096
buffer_load_dword v131, v28, s[56:59], s60 offen offset:2048
s_waitcnt vmcnt(37) lgkmcnt(3)
v_mfma_f32_32x32x16_bf16 v[32:47], v[160:163], v[112:115], v[32:47]
ds_read_b128 v[96:99], v24 offset:32768
ds_read_b128 v[100:103], v24 offset:36864
s_waitcnt lgkmcnt(4)
v_mfma_f32_32x32x16_bf16 v[48:63], v[160:163], v[116:119], v[48:63]
s_waitcnt lgkmcnt(3)
v_mfma_f32_32x32x16_bf16 v[64:79], v[160:163], v[120:123], v[64:79]
s_waitcnt lgkmcnt(2)
v_mfma_f32_32x32x16_bf16 v[80:95], v[160:163], v[124:127], v[80:95]
s_mov_b32 s60, 65536
buffer_load_dword v132, v28, s[56:59], s60 offen offset:0
s_waitcnt vmcnt(5) lgkmcnt(1)
v_mov_b32 v14, 11
s_mov_b64 exec, 1
ds_write_b32 v13, v14
s_mov_b64 exec, -1
v_mfma_f32_32x32x16_bf16 v[32:47], v[164:167], v[96:99], v[32:47]
ds_read_b128 v[112:115], v25 offset:32768
ds_read_b128 v[116:119], v25 offset:36864
s_waitcnt lgkmcnt(3)
v_mfma_f32_32x32x16_bf16 v[48:63], v[164:167], v[100:103], v[48:63]
s_mov_b32 s60, 65536
buffer_load_dword v133, v28, s[56:59], s60 offen offset:2048
s_waitcnt vmcnt(35) lgkmcnt(1)
v_mfma_f32_32x32x16_bf16 v[32:47], v[168:171], v[112:115], v[32:47]
ds_read_b128 v[96:99], v26 offset:32768
ds_read_b128 v[100:103], v26 offset:36864
s_waitcnt lgkmcnt(2)
v_mfma_f32_32x32x16_bf16 v[48:63], v[168:171], v[116:119], v[48:63]
s_mov_b32 s60, 69632
buffer_load_dword v134, v28, s[56:59], s60 offen offset:0
s_waitcnt vmcnt(34) lgkmcnt(1)
v_mfma_f32_32x32x16_bf16 v[32:47], v[172:175], v[96:99], v[32:47]
ds_read_b128 v[112:115], v27 offset:32768
ds_read_b128 v[116:119], v27 offset:36864
s_waitcnt lgkmcnt(2)
v_mfma_f32_32x32x16_bf16 v[48:63], v[172:175], v[100:103], v[48:63]
ds_read_b128 v[8:11], v12
s_mov_b32 s60, 69632
buffer_load_dword v135, v28, s[56:59], s60 offen offset:2048
s_waitcnt vmcnt(33) lgkmcnt(0)
L_ck68:
v_min3_u32 v15, v8, v9, v10
v_min_u32 v15, v15, v11
s_nop 0
v_readfirstlane_b32 s60, v15
s_nop 0
s_cmp_ge_u32 s60, 11
s_cbranch_scc1 L_ckd69
ds_read_b128 v[8:11], v12 offset:0
s_waitcnt lgkmcnt(0)
s_branch L_ck68
L_ckd69:
v_mfma_f32_32x32x16_bf16 v[32:47], v[176:179], v[112:115], v[32:47]
ds_read_b128 v[96:99], v20 offset:0
ds_read_b128 v[100:103], v20 offset:4096
v_mfma_f32_32x32x16_bf16 v[48:63], v[176:179], v[116:119], v[48:63]
s_mov_b32 s60, 8192
buffer_load_dword v136, v28, s[56:59], s60 offen offset:0
s_waitcnt vmcnt(32) lgkmcnt(1)
v_mfma_f32_32x32x16_bf16 v[32:47], v[180:183], v[96:99], v[32:47]
ds_read_b128 v[112:115], v21 offset:0
ds_read_b128 v[116:119], v21 offset:4096
s_waitcnt lgkmcnt(2)
v_mfma_f32_32x32x16_bf16 v[48:63], v[180:183], v[100:103], v[48:63]
s_mov_b32 s60, 8192
buffer_load_dword v137, v28, s[56:59], s60 offen offset:2048
s_waitcnt vmcnt(31) lgkmcnt(1)
v_mfma_f32_32x32x16_bf16 v[32:47], v[184:187], v[112:115], v[32:47]
ds_read_b128 v[96:99], v22 offset:0
ds_read_b128 v[100:103], v22 offset:4096
s_waitcnt lgkmcnt(2)
v_mfma_f32_32x32x16_bf16 v[48:63], v[184:187], v[116:119], v[48:63]
s_mov_b32 s60, 12288
buffer_load_dword v138, v28, s[56:59], s60 offen offset:0
s_waitcnt vmcnt(30) lgkmcnt(1)
v_mfma_f32_32x32x16_bf16 v[32:47], v[188:191], v[96:99], v[32:47]
ds_read_b128 v[112:115], v23 offset:0
ds_read_b128 v[116:119], v23 offset:4096
s_waitcnt lgkmcnt(2)
v_mfma_f32_32x32x16_bf16 v[48:63], v[188:191], v[100:103], v[48:63]
s_mov_b32 s60, 12288
buffer_load_dword v139, v28, s[56:59], s60 offen offset:2048
s_waitcnt vmcnt(29) lgkmcnt(1)
v_mfma_f32_32x32x16_bf16 v[32:47], v[192:195], v[112:115], v[32:47]
ds_read_b128 v[96:99], v20 offset:16384
ds_read_b128 v[100:103], v20 offset:20480
s_waitcnt lgkmcnt(2)
v_mfma_f32_32x32x16_bf16 v[48:63], v[192:195], v[116:119], v[48:63]
s_mov_b32 s60, 73728
buffer_load_dword v140, v28, s[56:59], s60 offen offset:0
s_waitcnt vmcnt(28) lgkmcnt(1)
v_mfma_f32_32x32x16_bf16 v[32:47], v[196:199], v[96:99], v[32:47]
ds_read_b128 v[112:115], v21 offset:16384
ds_read_b128 v[116:119], v21 offset:20480
s_waitcnt lgkmcnt(2)
v_mfma_f32_32x32x16_bf16 v[48:63], v[196:199], v[100:103], v[48:63]
s_mov_b32 s60, 73728
buffer_load_dword v141, v28, s[56:59], s60 offen offset:2048
s_waitcnt vmcnt(27) lgkmcnt(1)
v_mfma_f32_32x32x16_bf16 v[32:47], v[200:203], v[112:115], v[32:47]
ds_read_b128 v[96:99], v22 offset:16384
ds_read_b128 v[100:103], v22 offset:20480
s_waitcnt lgkmcnt(2)
v_mfma_f32_32x32x16_bf16 v[48:63], v[200:203], v[116:119], v[48:63]
s_mov_b32 s60, 77824
buffer_load_dword v142, v28, s[56:59], s60 offen offset:0
s_waitcnt vmcnt(26) lgkmcnt(1)
v_mfma_f32_32x32x16_bf16 v[32:47], v[204:207], v[96:99], v[32:47]
ds_read_b128 v[112:115], v23 offset:16384
ds_read_b128 v[116:119], v23 offset:20480
s_waitcnt lgkmcnt(2)
v_mfma_f32_32x32x16_bf16 v[48:63], v[204:207], v[100:103], v[48:63]
s_mov_b32 s60, 77824
buffer_load_dword v143, v28, s[56:59], s60 offen offset:2048
s_waitcnt vmcnt(25) lgkmcnt(0)
v_mfma_f32_32x32x16_bf16 v[32:47], v[208:211], v[112:115], v[32:47]
v_mfma_f32_32x32x16_bf16 v[48:63], v[208:211], v[116:119], v[48:63]
s_mul_i32 s60, s37, 0x9e3779b1
s_and_b32 s60, s60, 0xbfff0000
s_or_b32 s60, s60, 0x20000000
s_sub_u32 s61, s37, 1
s_xor_b32 s61, s61, s60
s_cmp_lt_u32 s61, 0x10000
s_cselect_b32 s61, 0x10000, 0
s_xor_b32 s60, s60, s61
s_lshl_b32 s64, s35, 4
s_add_u32 s64, s64, s36
s_lshl_b32 s64, s64, 2
s_add_u32 s64, s64, s34
s_lshl_b32 s64, s64, 13
s_add_u32 s50, s64, 33554432
s_add_u32 s48, s32, s50
s_addc_u32 s49, s33, 0
s_mov_b32 s50, 8192
s_mov_b32 s51, 0x20000
s_xor_b32 s64, s64, 262144
s_add_u32 s54, s64, 33554432
s_add_u32 s52, s32, s54
s_addc_u32 s53, s33, 0
s_mov_b32 s54, 8192
s_mov_b32 s55, 0x20000
s_movk_i32 s64, 0x1000
v_cvt_pk_bf16_f32 v96, v32, v48
v_cvt_pk_bf16_f32 v97, v33, v49
v_cvt_pk_bf16_f32 v98, v34, v50
v_cvt_pk_bf16_f32 v99, v35, s60
buffer_store_dwordx4 v[96:99], v2, s[48:51], 0 offen offset:0 sc1
v_cvt_pk_bf16_f32 v100, v51, v36
v_cvt_pk_bf16_f32 v101, v52, v37
v_cvt_pk_bf16_f32 v102, v53, v38
v_cvt_pk_bf16_f32 v103, v54, s60
buffer_store_dwordx4 v[100:103], v2, s[48:51], 0 offen offset:1024 sc1
v_cvt_pk_bf16_f32 v244, v39, v55
v_cvt_pk_bf16_f32 v245, v40, v56
v_cvt_pk_bf16_f32 v246, v41, v57
v_cvt_pk_bf16_f32 v247, v42, s60
buffer_store_dwordx4 v[244:247], v2, s[48:51], 0 offen offset:2048 sc1
v_cvt_pk_bf16_f32 v248, v58, v43
v_cvt_pk_bf16_f32 v249, v59, v44
v_cvt_pk_bf16_f32 v250, v60, v45
v_cvt_pk_bf16_f32 v251, v61, s60
buffer_store_dwordx4 v[248:251], v2, s[48:51], 0 offen offset:3072 sc1
v_cvt_pk_bf16_f32 v252, v46, v62
v_cvt_pk_bf16_f32 v253, v47, v63
v_cvt_pk_bf16_f32 v254, v63, v63
v_cvt_pk_bf16_f32 v255, v63, s60
buffer_store_dwordx4 v[252:255], v2, s[48:51], s64 offen offset:0 sc1
ds_read_b128 v[104:107], v24 offset:40960
ds_read_b128 v[108:111], v24 offset:45056
ds_read_b128 v[120:123], v25 offset:40960
ds_read_b128 v[124:127], v25 offset:45056
s_waitcnt lgkmcnt(2)
v_mfma_f32_32x32x16_bf16 v[64:79], v[164:167], v[104:107], v[64:79]
v_mfma_f32_32x32x16_bf16 v[80:95], v[164:167], v[108:111], v[80:95]
ds_read_b128 v[104:107], v26 offset:40960
ds_read_b128 v[108:111], v26 offset:45056
s_waitcnt lgkmcnt(2)
v_mfma_f32_32x32x16_bf16 v[64:79], v[168:171], v[120:123], v[64:79]
v_mfma_f32_32x32x16_bf16 v[80:95], v[168:171], v[124:127], v[80:95]
ds_read_b128 v[120:123], v27 offset:40960
ds_read_b128 v[124:127], v27 offset:45056
s_waitcnt lgkmcnt(2)
v_mfma_f32_32x32x16_bf16 v[64:79], v[172:175], v[104:107], v[64:79]
v_mfma_f32_32x32x16_bf16 v[80:95], v[172:175], v[108:111], v[80:95]
ds_read_b128 v[104:107], v20 offset:8192
ds_read_b128 v[108:111], v20 offset:12288
s_waitcnt lgkmcnt(2)
v_mfma_f32_32x32x16_bf16 v[64:79], v[176:179], v[120:123], v[64:79]
v_mfma_f32_32x32x16_bf16 v[80:95], v[176:179], v[124:127], v[80:95]
ds_read_b128 v[120:123], v21 offset:8192
ds_read_b128 v[124:127], v21 offset:12288
s_waitcnt lgkmcnt(2)
v_mfma_f32_32x32x16_bf16 v[64:79], v[180:183], v[104:107], v[64:79]
v_mfma_f32_32x32x16_bf16 v[80:95], v[180:183], v[108:111], v[80:95]
ds_read_b128 v[104:107], v22 offset:8192
ds_read_b128 v[108:111], v22 offset:12288
s_waitcnt lgkmcnt(2)
v_mfma_f32_32x32x16_bf16 v[64:79], v[184:187], v[120:123], v[64:79]
v_mfma_f32_32x32x16_bf16 v[80:95], v[184:187], v[124:127], v[80:95]
ds_read_b128 v[120:123], v23 offset:8192
ds_read_b128 v[124:127], v23 offset:12288
s_waitcnt lgkmcnt(2)
v_mfma_f32_32x32x16_bf16 v[64:79], v[188:191], v[104:107], v[64:79]
v_mfma_f32_32x32x16_bf16 v[80:95], v[188:191], v[108:111], v[80:95]
ds_read_b128 v[104:107], v20 offset:24576
ds_read_b128 v[108:111], v20 offset:28672
s_waitcnt lgkmcnt(2)
v_mfma_f32_32x32x16_bf16 v[64:79], v[192:195], v[120:123], v[64:79]
v_mfma_f32_32x32x16_bf16 v[80:95], v[192:195], v[124:127], v[80:95]
ds_read_b128 v[120:123], v21 offset:24576
ds_read_b128 v[124:127], v21 offset:28672
s_waitcnt lgkmcnt(2)
v_mfma_f32_32x32x16_bf16 v[64:79], v[196:199], v[104:107], v[64:79]
v_mfma_f32_32x32x16_bf16 v[80:95], v[196:199], v[108:111], v[80:95]
ds_read_b128 v[104:107], v22 offset:24576
ds_read_b128 v[108:111], v22 offset:28672
s_waitcnt lgkmcnt(2)
v_mfma_f32_32x32x16_bf16 v[64:79], v[200:203], v[120:123], v[64:79]
v_mfma_f32_32x32x16_bf16 v[80:95], v[200:203], v[124:127], v[80:95]
ds_read_b128 v[120:123], v23 offset:24576
ds_read_b128 v[124:127], v23 offset:28672
s_waitcnt lgkmcnt(2)
v_mfma_f32_32x32x16_bf16 v[64:79], v[204:207], v[104:107], v[64:79]
v_mfma_f32_32x32x16_bf16 v[80:95], v[204:207], v[108:111], v[80:95]
s_waitcnt lgkmcnt(0)
v_mfma_f32_32x32x16_bf16 v[64:79], v[208:211], v[120:123], v[64:79]
v_mfma_f32_32x32x16_bf16 v[80:95], v[208:211], v[124:127], v[80:95]
s_waitcnt vmcnt(5)
v_lshlrev_b32 v8, 16, v31
v_and_b32 v9, 0xffff0000, v31
v_lshlrev_b32 v148, 16, v128
v_and_b32 v149, 0xffff0000, v128
v_pk_mul_f32 v[148:149], v[148:149], v[8:9]
v_cvt_pk_bf16_f32 v10, v148, v149
v_lshlrev_b32 v148, 16, v10
v_and_b32 v149, 0xffff0000, v10
s_nop 1
v_add_f32 v148, v148, v64
v_add_f32 v149, v149, v80
v_lshlrev_b32 v150, 16, v129
v_and_b32 v151, 0xffff0000, v129
v_pk_mul_f32 v[150:151], v[150:151], v[8:9]
v_cvt_pk_bf16_f32 v10, v150, v151
v_lshlrev_b32 v150, 16, v10
v_and_b32 v151, 0xffff0000, v10
v_add_f32 v150, v150, v65
v_add_f32 v151, v151, v81
v_lshlrev_b32 v152, 16, v130
v_and_b32 v153, 0xffff0000, v130
v_pk_mul_f32 v[152:153], v[152:153], v[8:9]
v_cvt_pk_bf16_f32 v10, v152, v153
v_lshlrev_b32 v152, 16, v10
v_and_b32 v153, 0xffff0000, v10
v_add_f32 v152, v152, v66
v_add_f32 v153, v153, v82
v_lshlrev_b32 v154, 16, v131
v_and_b32 v155, 0xffff0000, v131
v_pk_mul_f32 v[154:155], v[154:155], v[8:9]
v_cvt_pk_bf16_f32 v10, v154, v155
v_lshlrev_b32 v154, 16, v10
v_and_b32 v155, 0xffff0000, v10
v_add_f32 v154, v154, v67
v_add_f32 v155, v155, v83
v_lshlrev_b32 v156, 16, v132
v_and_b32 v157, 0xffff0000, v132
v_pk_mul_f32 v[156:157], v[156:157], v[8:9]
v_cvt_pk_bf16_f32 v10, v156, v157
v_lshlrev_b32 v156, 16, v10
v_and_b32 v157, 0xffff0000, v10
v_add_f32 v156, v156, v68
v_add_f32 v157, v157, v84
v_lshlrev_b32 v158, 16, v133
v_and_b32 v159, 0xffff0000, v133
v_pk_mul_f32 v[158:159], v[158:159], v[8:9]
v_cvt_pk_bf16_f32 v10, v158, v159
v_lshlrev_b32 v158, 16, v10
v_and_b32 v159, 0xffff0000, v10
v_add_f32 v158, v158, v69
v_add_f32 v159, v159, v85
v_lshlrev_b32 v160, 16, v134
v_and_b32 v161, 0xffff0000, v134
v_pk_mul_f32 v[160:161], v[160:161], v[8:9]
v_cvt_pk_bf16_f32 v10, v160, v161
v_lshlrev_b32 v160, 16, v10
v_and_b32 v161, 0xffff0000, v10
v_add_f32 v160, v160, v70
v_add_f32 v161, v161, v86
v_lshlrev_b32 v162, 16, v135
v_and_b32 v163, 0xffff0000, v135
v_pk_mul_f32 v[162:163], v[162:163], v[8:9]
v_cvt_pk_bf16_f32 v10, v162, v163
v_lshlrev_b32 v162, 16, v10
v_and_b32 v163, 0xffff0000, v10
v_add_f32 v162, v162, v71
v_add_f32 v163, v163, v87
v_lshlrev_b32 v164, 16, v136
v_and_b32 v165, 0xffff0000, v136
v_pk_mul_f32 v[164:165], v[164:165], v[8:9]
v_cvt_pk_bf16_f32 v10, v164, v165
v_lshlrev_b32 v164, 16, v10
v_and_b32 v165, 0xffff0000, v10
v_add_f32 v164, v164, v72
v_add_f32 v165, v165, v88
v_lshlrev_b32 v166, 16, v137
v_and_b32 v167, 0xffff0000, v137
v_pk_mul_f32 v[166:167], v[166:167], v[8:9]
v_cvt_pk_bf16_f32 v10, v166, v167
v_lshlrev_b32 v166, 16, v10
v_and_b32 v167, 0xffff0000, v10
v_add_f32 v166, v166, v73
v_add_f32 v167, v167, v89
v_lshlrev_b32 v168, 16, v138
v_and_b32 v169, 0xffff0000, v138
v_pk_mul_f32 v[168:169], v[168:169], v[8:9]
v_cvt_pk_bf16_f32 v10, v168, v169
v_lshlrev_b32 v168, 16, v10
v_and_b32 v169, 0xffff0000, v10
v_add_f32 v168, v168, v74
v_add_f32 v169, v169, v90
v_lshlrev_b32 v170, 16, v139
v_and_b32 v171, 0xffff0000, v139
v_pk_mul_f32 v[170:171], v[170:171], v[8:9]
v_cvt_pk_bf16_f32 v10, v170, v171
v_lshlrev_b32 v170, 16, v10
v_and_b32 v171, 0xffff0000, v10
v_add_f32 v170, v170, v75
v_add_f32 v171, v171, v91
v_lshlrev_b32 v172, 16, v140
v_and_b32 v173, 0xffff0000, v140
v_pk_mul_f32 v[172:173], v[172:173], v[8:9]
v_cvt_pk_bf16_f32 v10, v172, v173
v_lshlrev_b32 v172, 16, v10
v_and_b32 v173, 0xffff0000, v10
v_add_f32 v172, v172, v76
v_add_f32 v173, v173, v92
v_lshlrev_b32 v174, 16, v141
v_and_b32 v175, 0xffff0000, v141
v_pk_mul_f32 v[174:175], v[174:175], v[8:9]
v_cvt_pk_bf16_f32 v10, v174, v175
v_lshlrev_b32 v174, 16, v10
v_and_b32 v175, 0xffff0000, v10
v_add_f32 v174, v174, v77
v_add_f32 v175, v175, v93
v_lshlrev_b32 v176, 16, v142
v_and_b32 v177, 0xffff0000, v142
v_pk_mul_f32 v[176:177], v[176:177], v[8:9]
v_cvt_pk_bf16_f32 v10, v176, v177
v_lshlrev_b32 v176, 16, v10
v_and_b32 v177, 0xffff0000, v10
v_add_f32 v176, v176, v78
v_add_f32 v177, v177, v94
v_lshlrev_b32 v178, 16, v143
v_and_b32 v179, 0xffff0000, v143
v_pk_mul_f32 v[178:179], v[178:179], v[8:9]
v_cvt_pk_bf16_f32 v10, v178, v179
v_lshlrev_b32 v178, 16, v10
v_and_b32 v179, 0xffff0000, v10
v_add_f32 v178, v178, v79
v_add_f32 v179, v179, v95
s_mov_b32 s44, s28
s_mov_b32 s45, s29
s_mov_b32 s46, s24
s_mov_b32 s47, 0x20000
s_mov_b32 s92, 0
L_xw72:
s_load_dword s61, s[52:53], 5116 glc
s_add_u32 s92, s92, 1
s_waitcnt lgkmcnt(0)
s_xor_b32 s61, s61, s60
s_cmp_lt_u32 s61, 0x10000
s_cbranch_scc1 L_xwd73
s_cmp_lt_u32 s92, 200000
s_cbranch_scc1 L_xw72
L_xwd73:
s_mov_b32 s92, 0
buffer_load_dwordx4 v[180:183], v2, s[52:55], 0 offen offset:0 sc1
buffer_load_dwordx4 v[184:187], v2, s[52:55], 0 offen offset:1024 sc1
buffer_load_dwordx4 v[188:191], v2, s[52:55], 0 offen offset:2048 sc1
buffer_load_dwordx4 v[192:195], v2, s[52:55], 0 offen offset:3072 sc1
buffer_load_dwordx4 v[196:199], v2, s[52:55], s64 offen offset:0 sc1
L_xl70:
v_mov_b32 v10, 0
s_waitcnt vmcnt(4)
v_bitop3_b32 v10, v10, v183, s60 bitop3:0xf6
s_waitcnt vmcnt(3)
v_bitop3_b32 v10, v10, v187, s60 bitop3:0xf6
s_waitcnt vmcnt(2)
v_bitop3_b32 v10, v10, v191, s60 bitop3:0xf6
s_waitcnt vmcnt(1)
v_bitop3_b32 v10, v10, v195, s60 bitop3:0xf6
s_waitcnt vmcnt(0)
v_bitop3_b32 v10, v10, v199, s60 bitop3:0xf6
v_cmp_lt_u32 vcc, 0xffff, v10
s_nop 0
s_cbranch_vccz L_xd71
s_add_u32 s92, s92, 1
s_cmp_ge_u32 s92, 200000
s_cbranch_scc1 L_xd71
buffer_load_dwordx4 v[180:183], v2, s[52:55], 0 offen offset:0 sc1
buffer_load_dwordx4 v[184:187], v2, s[52:55], 0 offen offset:1024 sc1
buffer_load_dwordx4 v[188:191], v2, s[52:55], 0 offen offset:2048 sc1
buffer_load_dwordx4 v[192:195], v2, s[52:55], 0 offen offset:3072 sc1
buffer_load_dwordx4 v[196:199], v2, s[52:55], s64 offen offset:0 sc1
s_branch L_xl70
L_xd71:
v_lshlrev_b32 v10, 16, v180
v_and_b32 v11, 0xffff0000, v180
v_pk_add_f32 v[148:149], v[148:149], v[10:11]
s_mov_b32 s64, 0
buffer_store_dwordx2 v[148:149], v29, s[44:47], s64 offen nt
v_lshlrev_b32 v10, 16, v181
v_and_b32 v11, 0xffff0000, v181
v_pk_add_f32 v[150:151], v[150:151], v[10:11]
s_mov_b32 s64, 8192
buffer_store_dwordx2 v[150:151], v29, s[44:47], s64 offen nt
v_lshlrev_b32 v10, 16, v182
v_and_b32 v11, 0xffff0000, v182
v_pk_add_f32 v[152:153], v[152:153], v[10:11]
s_mov_b32 s64, 16384
buffer_store_dwordx2 v[152:153], v29, s[44:47], s64 offen nt
v_lshlrev_b32 v10, 16, v183
v_lshlrev_b32 v11, 16, v184
v_pk_add_f32 v[154:155], v[154:155], v[10:11]
s_mov_b32 s64, 24576
buffer_store_dwordx2 v[154:155], v29, s[44:47], s64 offen nt
v_and_b32 v10, 0xffff0000, v184
v_lshlrev_b32 v11, 16, v185
v_pk_add_f32 v[156:157], v[156:157], v[10:11]
s_mov_b32 s64, 262144
buffer_store_dwordx2 v[156:157], v29, s[44:47], s64 offen nt
v_and_b32 v10, 0xffff0000, v185
v_lshlrev_b32 v11, 16, v186
v_pk_add_f32 v[158:159], v[158:159], v[10:11]
s_mov_b32 s64, 270336
buffer_store_dwordx2 v[158:159], v29, s[44:47], s64 offen nt
v_and_b32 v10, 0xffff0000, v186
v_lshlrev_b32 v11, 16, v187
v_pk_add_f32 v[160:161], v[160:161], v[10:11]
s_mov_b32 s64, 278528
buffer_store_dwordx2 v[160:161], v29, s[44:47], s64 offen nt
v_lshlrev_b32 v10, 16, v188
v_and_b32 v11, 0xffff0000, v188
v_pk_add_f32 v[162:163], v[162:163], v[10:11]
s_mov_b32 s64, 286720
buffer_store_dwordx2 v[162:163], v29, s[44:47], s64 offen nt
v_lshlrev_b32 v10, 16, v189
v_and_b32 v11, 0xffff0000, v189
v_pk_add_f32 v[164:165], v[164:165], v[10:11]
s_mov_b32 s64, 32768
buffer_store_dwordx2 v[164:165], v29, s[44:47], s64 offen nt
v_lshlrev_b32 v10, 16, v190
v_and_b32 v11, 0xffff0000, v190
v_pk_add_f32 v[166:167], v[166:167], v[10:11]
s_mov_b32 s64, 40960
buffer_store_dwordx2 v[166:167], v29, s[44:47], s64 offen nt
v_lshlrev_b32 v10, 16, v191
v_lshlrev_b32 v11, 16, v192
v_pk_add_f32 v[168:169], v[168:169], v[10:11]
s_mov_b32 s64, 49152
buffer_store_dwordx2 v[168:169], v29, s[44:47], s64 offen nt
v_and_b32 v10, 0xffff0000, v192
v_lshlrev_b32 v11, 16, v193
v_pk_add_f32 v[170:171], v[170:171], v[10:11]
s_mov_b32 s64, 57344
buffer_store_dwordx2 v[170:171], v29, s[44:47], s64 offen nt
v_and_b32 v10, 0xffff0000, v193
v_lshlrev_b32 v11, 16, v194
v_pk_add_f32 v[172:173], v[172:173], v[10:11]
s_mov_b32 s64, 294912
buffer_store_dwordx2 v[172:173], v29, s[44:47], s64 offen nt
v_and_b32 v10, 0xffff0000, v194
v_lshlrev_b32 v11, 16, v195
v_pk_add_f32 v[174:175], v[174:175], v[10:11]
s_mov_b32 s64, 303104
buffer_store_dwordx2 v[174:175], v29, s[44:47], s64 offen nt
v_lshlrev_b32 v10, 16, v196
v_and_b32 v11, 0xffff0000, v196
v_pk_add_f32 v[176:177], v[176:177], v[10:11]
s_mov_b32 s64, 311296
buffer_store_dwordx2 v[176:177], v29, s[44:47], s64 offen nt
v_lshlrev_b32 v10, 16, v197
v_and_b32 v11, 0xffff0000, v197
v_pk_add_f32 v[178:179], v[178:179], v[10:11]
s_mov_b32 s64, 319488
buffer_store_dwordx2 v[178:179], v29, s[44:47], s64 offen nt
L_concat_heads__spectral_gfnet__ssm_conv_s5__prompt_kernel_end:
s_endpgm

.section .rodata,"a"
.p2align 6
.amdhsa_kernel concat_heads__spectral_gfnet__ssm_conv_s5__prompt_kernel
  .amdhsa_next_free_vgpr 256
  .amdhsa_next_free_sgpr 102
  .amdhsa_accum_offset 256
  .amdhsa_group_segment_fixed_size 0
  .amdhsa_kernarg_size 120
  .amdhsa_user_sgpr_count 2
  .amdhsa_user_sgpr_kernarg_segment_ptr 1
  .amdhsa_system_sgpr_workgroup_id_x 1
.end_amdhsa_kernel
.text
```

```asm
; @launch grid=(256,1,1) block=(512,1,1) lds=163840
.amdgcn_target "amdgcn-amd-amdhsa--gfx950"
.text
.globl concat_heads__spectral_gfnet__ssm_conv_s5__prompt_kernel
.p2align 8
.type concat_heads__spectral_gfnet__ssm_conv_s5__prompt_kernel,@function
concat_heads__spectral_gfnet__ssm_conv_s5__prompt_kernel:
s_cmp_ge_u32 s2, 256
s_cbranch_scc1 L_concat_heads__spectral_gfnet__ssm_conv_s5__prompt_kernel_end
s_load_dwordx16 s[4:19], s[0:1], 0
s_load_dwordx8 s[20:27], s[0:1], 64
s_load_dwordx4 s[28:31], s[0:1], 96
s_load_dwordx2 s[32:33], s[0:1], 112
v_lshrrev_b32 v2, 6, v0
v_and_b32 v1, 63, v0
v_readfirstlane_b32 s34, v2
s_and_b32 s60, s2, 7
s_lshr_b32 s61, s2, 3
s_lshr_b32 s35, s60, 1
s_lshl_b32 s35, s35, 2
s_lshr_b32 s62, s61, 3
s_add_u32 s35, s35, s62
s_and_b32 s36, s60, 1
s_lshl_b32 s36, s36, 3
s_and_b32 s62, s61, 7
s_add_u32 s36, s36, s62
s_cmp_ge_u32 s34, 4
s_cbranch_scc0 L_concat_heads__spectral_gfnet__ssm_conv_s5__prompt_kernel_gemm
s_sub_u32 s66, s34, 4
v_lshrrev_b32 v2, 5, v1
v_bfe_u32 v3, v1, 3, 2
v_and_b32 v4, 1, v3
v_lshrrev_b32 v5, 1, v3
v_lshlrev_b32 v6, 4, v2
v_lshl_add_u32 v6, v4, 3, v6
v_add_u32 v6, v6, v5
s_lshr_b32 s60, s66, 1
s_lshl_b32 s61, s60, 6
s_and_b32 s62, s66, 1
s_lshl_b32 s62, s62, 2
s_add_u32 s61, s61, s62
v_add_u32 v6, s61, v6
v_lshlrev_b32 v6, 11, v6
s_lshl_b32 s61, s60, 5
v_lshl_add_u32 v7, v2, 3, v3
v_add_u32 v7, s61, v7
v_lshlrev_b32 v7, 11, v7
v_and_b32 v4, 7, v1
v_lshrrev_b32 v5, 4, v1
v_xor_b32 v4, v4, v5
v_lshlrev_b32 v4, 4, v4
v_xor_b32 v5, 64, v4
v_add_u32 v176, v6, v4
v_add_u32 v180, v7, v4
v_add_u32 v177, v6, v5
v_add_u32 v177, 64512, v177
v_add_u32 v181, v7, v5
v_add_u32 v181, 31744, v181
v_add_u32 v178, v6, v4
v_add_u32 v178, 2048, v178
v_add_u32 v182, v7, v4
v_add_u32 v182, 6144, v182
v_add_u32 v179, v6, v5
v_add_u32 v179, 66560, v179
v_add_u32 v183, v7, v5
v_add_u32 v183, 37888, v183
s_and_b32 s64, s2, 7
s_mul_i32 s64, s64, 0
s_add_u32 s60, s35, s36
s_and_b32 s60, s60, 0
s_mul_i32 s60, s60, 2048
s_add_u32 s64, s64, s60
s_mul_i32 s60, s35, 128
s_add_u32 s64, s64, s60
s_mul_i32 s60, s36, 128
s_add_u32 s64, s64, s60
s_lshl_b32 s60, s35, 18
s_lshl_b32 s61, s36, 17
s_waitcnt lgkmcnt(0)
s_lshl_b32 s25, s66, 12
s_mov_b32 s24, s64
s_add_u32 s12, s10, s60
s_addc_u32 s13, s11, 0
s_mov_b32 s14, 262144
s_mov_b32 s15, 0x20000
s_bitcmp1_b32 s66, 0
s_cselect_b32 s62, s18, s16
s_cselect_b32 s63, s19, s17
s_cselect_b32 s100, s22, s20
s_cselect_b32 s101, s23, s21
s_add_u32 s20, s62, s61
s_addc_u32 s21, s63, 0
s_mov_b32 s22, 131072
s_mov_b32 s23, 0x20000
s_add_u32 m0, s25, 0
s_add_u32 s26, s24, 0
s_and_b32 s26, s26, 0x7ff
buffer_load_dwordx4 v176, s[12:15], s26 offen offset:0 lds
buffer_load_dwordx4 v177, s[12:15], s26 offen offset:1024 lds
buffer_load_dwordx4 v178, s[12:15], s26 offen offset:2048 lds
buffer_load_dwordx4 v179, s[12:15], s26 offen offset:3072 lds
s_add_u32 m0, s25, 16384
s_nop 0
buffer_load_dwordx4 v180, s[20:23], s26 offen offset:0 lds
buffer_load_dwordx4 v181, s[20:23], s26 offen offset:1024 lds
buffer_load_dwordx4 v182, s[20:23], s26 offen offset:2048 lds
buffer_load_dwordx4 v183, s[20:23], s26 offen offset:3072 lds
s_setprio 3
s_mov_b32 s48, s6
s_mov_b32 s49, s7
s_mov_b32 s50, 2101248
s_mov_b32 s51, 0x20000
s_mov_b32 s52, s8
s_mov_b32 s53, s9
s_mov_b32 s54, 2101248
s_mov_b32 s55, 0x20000
s_and_b32 s60, s2, 31
s_lshr_b32 s61, s2, 5
s_lshl_b32 s61, s61, 7
s_add_u32 s60, s60, s61
s_lshl_b32 s61, s66, 5
s_add_u32 s67, s60, s61
s_lshl_b32 s60, s67, 12
s_add_u32 s4, s4, s60
s_addc_u32 s5, s5, 0
s_mov_b32 s6, 4096
s_mov_b32 s7, 0x20000
v_lshlrev_b32 v2, 4, v1
v_xor_b32 v3, 128, v2
s_lshl_b32 s68, s66, 12
s_add_u32 s68, s68, 131072
s_and_b32 s60, s2, 7
s_bfe_u32 s61, s2, 0x10003
s_bfe_u32 s62, s2, 0x20004
s_lshr_b32 s63, s2, 6
s_lshr_b32 s64, s60, 1
s_lshl_b32 s64, s64, 3
s_lshl_b32 s65, s61, 2
s_add_u32 s64, s64, s65
s_and_b32 s65, s60, 1
s_lshl_b32 s65, s65, 1
s_add_u32 s64, s64, s65
s_lshl_b32 s64, s64, 5
s_lshl_b32 s65, s62, 3
s_add_u32 s64, s64, s65
s_lshl_b32 s65, s66, 1
s_add_u32 s64, s64, s65
s_mul_i32 s64, s64, 1026
s_lshl_b32 s65, s63, 8
s_add_u32 s69, s64, s65
v_bfe_u32 v8, v1, 4, 1
v_mul_u32_u24 v8, 32832, v8
v_lshrrev_b32 v9, 5, v1
s_mov_b32 s65, 1050624
v_mul_lo_u32 v9, s65, v9
v_add_u32 v8, v8, v9
v_and_b32 v9, 15, v1
s_lshl_b32 s65, s66, 1
v_xor_b32 v9, s65, v9
v_lshl_add_u32 v18, v9, 4, v8
v_xor_b32 v9, 1, v9
v_lshl_add_u32 v19, v9, 4, v8
v_add_u32 v19, 1026, v19
s_bfe_u32 s64, s2, 0x20005
s_lshl_b32 s64, s64, 8
s_bfe_u32 s65, s2, 0x10004
s_lshl_b32 s65, s65, 6
s_add_u32 s64, s64, s65
s_bfe_u32 s65, s2, 0x10003
s_lshl_b32 s65, s65, 7
s_add_u32 s64, s64, s65
s_and_b32 s65, s2, 7
s_lshl_b32 s65, s65, 2
s_add_u32 s64, s64, s65
v_bfe_u32 v8, v1, 3, 2
v_add_u32 v8, s64, v8
v_bfe_u32 v9, v1, 2, 1
v_lshl_add_u32 v8, v9, 5, v8
v_bfe_u32 v9, v1, 1, 1
v_lshl_add_u32 v8, v9, 10, v8
v_sub_u32 v9, 2048, v8
v_and_b32 v9, 2047, v9
v_and_b32 v10, 1, v1
v_cmp_eq_u32 vcc, 1, v10
s_nop 1
v_cndmask_b32 v8, v8, v9, vcc
v_mul_u32_u24 v17, 1026, v8
s_lshr_b32 s64, s2, 7
s_lshl_b32 s64, s64, 10
v_add_u32 v17, s64, v17
v_mov_b32 v184, 126992
s_lshl_b32 s64, s66, 2
v_add_u32 v185, s64, v184
v_and_b32 v8, 31, v1
v_lshrrev_b32 v9, 5, v1
v_and_b32 v10, 1, v1
v_lshrrev_b32 v11, 1, v8
v_lshlrev_b32 v4, 6, v11
v_lshl_add_u32 v4, v10, 4, v4
v_lshl_add_u32 v4, v9, 12, v4
v_add_u32 v11, v11, v10
v_lshlrev_b32 v11, 6, v11
v_lshl_add_u32 v11, v10, 4, v11
v_lshl_add_u32 v11, v9, 12, v11
v_sub_u32 v5, 5168, v11
v_bfe_u32 v11, v4, 7, 1
v_lshlrev_b32 v11, 5, v11
v_xor_b32 v4, v4, v11
v_bfe_u32 v11, v5, 7, 1
v_lshlrev_b32 v11, 5, v11
v_xor_b32 v5, v5, v11
v_add_u32 v6, 11264, v5
v_and_b32 v6, 0x3fff, v6
s_add_u32 s64, s64, 98304
v_add_u32 v4, s64, v4
v_add_u32 v5, s64, v5
v_add_u32 v6, s64, v6
v_bfe_u32 v11, v1, 3, 1
v_lshlrev_b32 v11, 5, v11
v_xor_b32 v7, v2, v11
v_bfe_u32 v12, v1, 2, 1
v_mul_u32_u24 v12, 2176, v12
v_bfe_u32 v13, v1, 3, 1
v_lshl_add_u32 v12, v13, 6, v12
v_lshl_add_u32 v12, v9, 8, v12
v_bfe_u32 v13, v1, 4, 1
v_lshl_add_u32 v12, v13, 5, v12
v_and_b32 v13, 3, v1
v_lshl_add_u32 v12, v13, 3, v12
v_add_u32 v12, s68, v12
v_xor_b32 v13, 128, v12
s_lshl_b32 s64, s2, 14
s_lshl_b32 s65, s66, 12
s_add_u32 s64, s64, s65
s_add_u32 s42, s64, 16777216
s_add_u32 s40, s32, s42
s_addc_u32 s41, s33, 0
s_mov_b32 s42, 4096
s_mov_b32 s43, 0x20000
s_add_u32 s46, s64, 16777216
s_add_u32 s44, s32, s46
s_addc_u32 s45, s33, 0
s_mov_b32 s46, 4096
s_mov_b32 s47, 0x20000
v_and_b32 v14, 7, v1
v_lshrrev_b32 v15, 3, v1
v_xor_b32 v16, v14, v15
v_lshlrev_b32 v16, 4, v16
v_lshl_add_u32 v16, v14, 11, v16
s_lshr_b32 s64, s66, 1
s_lshl_b32 s64, s64, 7
s_and_b32 s65, s66, 1
s_lshl_b32 s65, s65, 3
s_add_u32 s64, s64, s65
s_add_u32 s64, s64, 147456
v_add_u32 v16, s64, v16
v_lshlrev_b32 v15, 16, v15
v_lshl_add_u32 v15, v14, 4, v15
s_lshl_b32 s64, s63, 7
s_lshr_b32 s65, s66, 1
s_lshl_b32 s65, s65, 6
s_add_u32 s64, s64, s65
s_and_b32 s65, s66, 1
s_lshl_b32 s65, s65, 2
s_add_u32 s64, s64, s65
s_mul_i32 s64, s64, 8192
s_lshr_b32 s65, s60, 2
s_mul_i32 s65, s65, 0
s_add_u32 s64, s64, s65
s_lshl_b32 s65, s60, 10
s_add_u32 s64, s64, s65
s_lshl_b32 s65, s61, 9
s_add_u32 s64, s64, s65
s_lshl_b32 s65, s62, 7
s_add_u32 s64, s64, s65
s_add_u32 s58, s64, 25182208
s_add_u32 s56, s32, s58
s_addc_u32 s57, s33, 0
s_sub_u32 s58, 4194304, s64
s_mov_b32 s59, 0x20000
v_and_b32 v92, 31, v1
v_cvt_f32_u32 v92, v92
v_lshrrev_b32 v93, 5, v1
v_lshlrev_b32 v93, 2, v93
v_cvt_f32_u32 v93, v93
v_mul_f32 v93, v92, v93
v_mul_f32 v93, 0x3d000000, v93
v_fmamk_f32 v94, v92, 0x0, v93
v_fract_f32 v94, v94
v_cos_f32 v95, v94
v_sin_f32 v96, v94
s_nop 0
v_cvt_pk_bf16_f32 v192, v95, v96
v_cvt_pk_bf16_f32 v208, -v96, v95
v_fmamk_f32 v97, v92, 0x3d000000, v93
v_fract_f32 v97, v97
v_cos_f32 v98, v97
v_sin_f32 v99, v97
s_nop 0
v_cvt_pk_bf16_f32 v193, v98, v99
v_cvt_pk_bf16_f32 v209, -v99, v98
v_fmamk_f32 v94, v92, 0x3d800000, v93
v_fract_f32 v94, v94
v_cos_f32 v95, v94
v_sin_f32 v96, v94
s_nop 0
v_cvt_pk_bf16_f32 v194, v95, v96
v_cvt_pk_bf16_f32 v210, -v96, v95
v_fmamk_f32 v97, v92, 0x3dc00000, v93
v_fract_f32 v97, v97
v_cos_f32 v98, v97
v_sin_f32 v99, v97
s_nop 0
v_cvt_pk_bf16_f32 v195, v98, v99
v_cvt_pk_bf16_f32 v211, -v99, v98
v_fmamk_f32 v94, v92, 0x3e800000, v93
v_fract_f32 v94, v94
v_cos_f32 v95, v94
v_sin_f32 v96, v94
s_nop 0
v_cvt_pk_bf16_f32 v196, v95, v96
v_cvt_pk_bf16_f32 v212, -v96, v95
v_fmamk_f32 v97, v92, 0x3e900000, v93
v_fract_f32 v97, v97
v_cos_f32 v98, v97
v_sin_f32 v99, v97
s_nop 0
v_cvt_pk_bf16_f32 v197, v98, v99
v_cvt_pk_bf16_f32 v213, -v99, v98
v_fmamk_f32 v94, v92, 0x3ea00000, v93
v_fract_f32 v94, v94
v_cos_f32 v95, v94
v_sin_f32 v96, v94
s_nop 0
v_cvt_pk_bf16_f32 v198, v95, v96
v_cvt_pk_bf16_f32 v214, -v96, v95
v_fmamk_f32 v97, v92, 0x3eb00000, v93
v_fract_f32 v97, v97
v_cos_f32 v98, v97
v_sin_f32 v99, v97
s_nop 0
v_cvt_pk_bf16_f32 v199, v98, v99
v_cvt_pk_bf16_f32 v215, -v99, v98
v_fmamk_f32 v94, v92, 0x3f000000, v93
v_fract_f32 v94, v94
v_cos_f32 v95, v94
v_sin_f32 v96, v94
s_nop 0
v_cvt_pk_bf16_f32 v200, v95, v96
v_cvt_pk_bf16_f32 v216, -v96, v95
v_fmamk_f32 v97, v92, 0x3f080000, v93
v_fract_f32 v97, v97
v_cos_f32 v98, v97
v_sin_f32 v99, v97
s_nop 0
v_cvt_pk_bf16_f32 v201, v98, v99
v_cvt_pk_bf16_f32 v217, -v99, v98
v_fmamk_f32 v94, v92, 0x3f100000, v93
v_fract_f32 v94, v94
v_cos_f32 v95, v94
v_sin_f32 v96, v94
s_nop 0
v_cvt_pk_bf16_f32 v202, v95, v96
v_cvt_pk_bf16_f32 v218, -v96, v95
v_fmamk_f32 v97, v92, 0x3f180000, v93
v_fract_f32 v97, v97
v_cos_f32 v98, v97
v_sin_f32 v99, v97
s_nop 0
v_cvt_pk_bf16_f32 v203, v98, v99
v_cvt_pk_bf16_f32 v219, -v99, v98
v_fmamk_f32 v94, v92, 0x3f400000, v93
v_fract_f32 v94, v94
v_cos_f32 v95, v94
v_sin_f32 v96, v94
s_nop 0
v_cvt_pk_bf16_f32 v204, v95, v96
v_cvt_pk_bf16_f32 v220, -v96, v95
v_fmamk_f32 v97, v92, 0x3f480000, v93
v_fract_f32 v97, v97
v_cos_f32 v98, v97
v_sin_f32 v99, v97
s_nop 0
v_cvt_pk_bf16_f32 v205, v98, v99
v_cvt_pk_bf16_f32 v221, -v99, v98
v_fmamk_f32 v94, v92, 0x3f500000, v93
v_fract_f32 v94, v94
v_cos_f32 v95, v94
v_sin_f32 v96, v94
s_nop 0
v_cvt_pk_bf16_f32 v206, v95, v96
v_cvt_pk_bf16_f32 v222, -v96, v95
v_fmamk_f32 v97, v92, 0x3f580000, v93
v_fract_f32 v97, v97
v_cos_f32 v98, v97
v_sin_f32 v99, v97
s_nop 0
v_cvt_pk_bf16_f32 v207, v98, v99
v_cvt_pk_bf16_f32 v223, -v99, v98
v_and_b32 v92, 31, v1
v_cvt_f32_u32 v92, v92
v_lshrrev_b32 v93, 5, v1
v_lshlrev_b32 v93, 2, v93
v_cvt_f32_u32 v93, v93
v_mul_f32 v93, v92, v93
v_mul_f32 v93, 0x3a800000, v93
v_fmamk_f32 v94, v92, 0x0, v93
v_cos_f32 v224, v94
v_sin_f32 v240, -v94
v_fmamk_f32 v95, v92, 0x3a800000, v93
v_cos_f32 v225, v95
v_sin_f32 v241, -v95
v_fmamk_f32 v94, v92, 0x3b000000, v93
v_cos_f32 v226, v94
v_sin_f32 v242, -v94
v_fmamk_f32 v95, v92, 0x3b400000, v93
v_cos_f32 v227, v95
v_sin_f32 v243, -v95
v_fmamk_f32 v94, v92, 0x3c000000, v93
v_cos_f32 v228, v94
v_sin_f32 v244, -v94
v_fmamk_f32 v95, v92, 0x3c100000, v93
v_cos_f32 v229, v95
v_sin_f32 v245, -v95
v_fmamk_f32 v94, v92, 0x3c200000, v93
v_cos_f32 v230, v94
v_sin_f32 v246, -v94
v_fmamk_f32 v95, v92, 0x3c300000, v93
v_cos_f32 v231, v95
v_sin_f32 v247, -v95
v_fmamk_f32 v94, v92, 0x3c800000, v93
v_cos_f32 v232, v94
v_sin_f32 v248, -v94
v_fmamk_f32 v95, v92, 0x3c880000, v93
v_cos_f32 v233, v95
v_sin_f32 v249, -v95
v_fmamk_f32 v94, v92, 0x3c900000, v93
v_cos_f32 v234, v94
v_sin_f32 v250, -v94
v_fmamk_f32 v95, v92, 0x3c980000, v93
v_cos_f32 v235, v95
v_sin_f32 v251, -v95
v_fmamk_f32 v94, v92, 0x3cc00000, v93
v_cos_f32 v236, v94
v_sin_f32 v252, -v94
v_fmamk_f32 v95, v92, 0x3cc80000, v93
v_cos_f32 v237, v95
v_sin_f32 v253, -v95
v_fmamk_f32 v94, v92, 0x3cd00000, v93
v_cos_f32 v238, v94
v_sin_f32 v254, -v94
v_fmamk_f32 v95, v92, 0x3cd80000, v93
v_cos_f32 v239, v95
v_sin_f32 v255, -v95
v_and_b32 v92, 31, v1
v_cvt_f32_u32 v92, v92
v_lshrrev_b32 v93, 5, v1
v_lshlrev_b32 v93, 2, v93
v_cvt_f32_u32 v93, v93
v_mul_f32 v92, 0x3a000000, v92
v_fmamk_f32 v93, v93, 0x3c800000, v92
v_add_f32 v94, 0x0, v93
v_cos_f32 v136, v94
v_sin_f32 v152, -v94
v_add_f32 v95, 0x3c800000, v93
v_cos_f32 v137, v95
v_sin_f32 v153, -v95
v_add_f32 v94, 0x3d000000, v93
v_cos_f32 v138, v94
v_sin_f32 v154, -v94
v_add_f32 v95, 0x3d400000, v93
v_cos_f32 v139, v95
v_sin_f32 v155, -v95
v_add_f32 v94, 0x3e000000, v93
v_cos_f32 v140, v94
v_sin_f32 v156, -v94
v_add_f32 v95, 0x3e100000, v93
v_cos_f32 v141, v95
v_sin_f32 v157, -v95
v_add_f32 v94, 0x3e200000, v93
v_cos_f32 v142, v94
v_sin_f32 v158, -v94
v_add_f32 v95, 0x3e300000, v93
v_cos_f32 v143, v95
v_sin_f32 v159, -v95
v_add_f32 v94, 0x3e800000, v93
v_cos_f32 v144, v94
v_sin_f32 v160, -v94
v_add_f32 v95, 0x3e880000, v93
v_cos_f32 v145, v95
v_sin_f32 v161, -v95
v_add_f32 v94, 0x3e900000, v93
v_cos_f32 v146, v94
v_sin_f32 v162, -v94
v_add_f32 v95, 0x3e980000, v93
v_cos_f32 v147, v95
v_sin_f32 v163, -v95
v_add_f32 v94, 0x3ec00000, v93
v_cos_f32 v148, v94
v_sin_f32 v164, -v94
v_add_f32 v95, 0x3ec80000, v93
v_cos_f32 v149, v95
v_sin_f32 v165, -v95
v_add_f32 v94, 0x3ed00000, v93
v_cos_f32 v150, v94
v_sin_f32 v166, -v94
v_add_f32 v95, 0x3ed80000, v93
v_cos_f32 v151, v95
v_sin_f32 v167, -v95
s_add_u32 m0, s25, 32768
s_add_u32 s26, s24, 128
s_and_b32 s26, s26, 0x7ff
buffer_load_dwordx4 v176, s[12:15], s26 offen offset:0 lds
buffer_load_dwordx4 v177, s[12:15], s26 offen offset:1024 lds
buffer_load_dwordx4 v178, s[12:15], s26 offen offset:2048 lds
buffer_load_dwordx4 v179, s[12:15], s26 offen offset:3072 lds
s_add_u32 m0, s25, 49152
s_nop 0
buffer_load_dwordx4 v180, s[20:23], s26 offen offset:0 lds
buffer_load_dwordx4 v181, s[20:23], s26 offen offset:1024 lds
buffer_load_dwordx4 v182, s[20:23], s26 offen offset:2048 lds
buffer_load_dwordx4 v183, s[20:23], s26 offen offset:3072 lds
s_waitcnt vmcnt(8)
s_barrier
s_add_u32 m0, s25, 65536
s_add_u32 s26, s24, 256
s_and_b32 s26, s26, 0x7ff
buffer_load_dwordx4 v176, s[12:15], s26 offen offset:0 lds
buffer_load_dwordx4 v177, s[12:15], s26 offen offset:1024 lds
buffer_load_dwordx4 v178, s[12:15], s26 offen offset:2048 lds
buffer_load_dwordx4 v179, s[12:15], s26 offen offset:3072 lds
s_add_u32 m0, s25, 81920
s_nop 0
buffer_load_dwordx4 v180, s[20:23], s26 offen offset:0 lds
buffer_load_dwordx4 v181, s[20:23], s26 offen offset:1024 lds
buffer_load_dwordx4 v182, s[20:23], s26 offen offset:2048 lds
buffer_load_dwordx4 v183, s[20:23], s26 offen offset:3072 lds
s_waitcnt vmcnt(8)
s_barrier
s_add_u32 m0, s25, 0
s_add_u32 s26, s24, 384
s_and_b32 s26, s26, 0x7ff
buffer_load_dwordx4 v176, s[12:15], s26 offen offset:0 lds
buffer_load_dwordx4 v177, s[12:15], s26 offen offset:1024 lds
buffer_load_dwordx4 v178, s[12:15], s26 offen offset:2048 lds
buffer_load_dwordx4 v179, s[12:15], s26 offen offset:3072 lds
s_add_u32 m0, s25, 16384
s_nop 0
buffer_load_dwordx4 v180, s[20:23], s26 offen offset:0 lds
buffer_load_dwordx4 v181, s[20:23], s26 offen offset:1024 lds
buffer_load_dwordx4 v182, s[20:23], s26 offen offset:2048 lds
buffer_load_dwordx4 v183, s[20:23], s26 offen offset:3072 lds
s_add_u32 m0, s68, 16384
s_nop 0
buffer_load_dwordx4 v18, s[48:51], s69 offen nt lds
s_add_u32 m0, s68, 17408
s_nop 0
buffer_load_dwordx4 v18, s[52:55], s69 offen nt lds
s_add_u32 m0, s68, 18432
s_nop 0
buffer_load_dwordx4 v19, s[48:51], s69 offen nt lds
s_add_u32 m0, s68, 19456
s_nop 0
buffer_load_dwordx4 v19, s[52:55], s69 offen nt lds
s_cmp_lg_u32 s66, 3
s_cbranch_scc1 L_nw1
s_mov_b32 exec_hi, 0
buffer_load_ushort v88, v17, s[48:51], 0 offen nt
buffer_load_ushort v89, v17, s[52:55], 0 offen nt
s_mov_b64 exec, -1
L_nw1:
s_waitcnt vmcnt(12)
s_barrier
s_add_u32 m0, s25, 32768
s_add_u32 s26, s24, 512
s_and_b32 s26, s26, 0x7ff
buffer_load_dwordx4 v176, s[12:15], s26 offen offset:0 lds
buffer_load_dwordx4 v177, s[12:15], s26 offen offset:1024 lds
buffer_load_dwordx4 v178, s[12:15], s26 offen offset:2048 lds
buffer_load_dwordx4 v179, s[12:15], s26 offen offset:3072 lds
s_add_u32 m0, s25, 49152
s_nop 0
buffer_load_dwordx4 v180, s[20:23], s26 offen offset:0 lds
buffer_load_dwordx4 v181, s[20:23], s26 offen offset:1024 lds
buffer_load_dwordx4 v182, s[20:23], s26 offen offset:2048 lds
buffer_load_dwordx4 v183, s[20:23], s26 offen offset:3072 lds
s_waitcnt vmcnt(12)
s_barrier
s_add_u32 m0, s25, 65536
s_add_u32 s26, s24, 640
s_and_b32 s26, s26, 0x7ff
buffer_load_dwordx4 v176, s[12:15], s26 offen offset:0 lds
buffer_load_dwordx4 v177, s[12:15], s26 offen offset:1024 lds
buffer_load_dwordx4 v178, s[12:15], s26 offen offset:2048 lds
buffer_load_dwordx4 v179, s[12:15], s26 offen offset:3072 lds
s_add_u32 m0, s25, 81920
s_nop 0
buffer_load_dwordx4 v180, s[20:23], s26 offen offset:0 lds
buffer_load_dwordx4 v181, s[20:23], s26 offen offset:1024 lds
buffer_load_dwordx4 v182, s[20:23], s26 offen offset:2048 lds
buffer_load_dwordx4 v183, s[20:23], s26 offen offset:3072 lds
s_waitcnt vmcnt(8)
s_barrier
s_add_u32 m0, s25, 0
s_add_u32 s26, s24, 768
s_and_b32 s26, s26, 0x7ff
buffer_load_dwordx4 v176, s[12:15], s26 offen offset:0 lds
buffer_load_dwordx4 v177, s[12:15], s26 offen offset:1024 lds
buffer_load_dwordx4 v178, s[12:15], s26 offen offset:2048 lds
buffer_load_dwordx4 v179, s[12:15], s26 offen offset:3072 lds
s_add_u32 m0, s25, 16384
s_nop 0
buffer_load_dwordx4 v180, s[20:23], s26 offen offset:0 lds
buffer_load_dwordx4 v181, s[20:23], s26 offen offset:1024 lds
buffer_load_dwordx4 v182, s[20:23], s26 offen offset:2048 lds
buffer_load_dwordx4 v183, s[20:23], s26 offen offset:3072 lds
ds_read_b64 v[104:105], v16 offset:0
ds_read_b64 v[106:107], v16 offset:256
ds_read_b64 v[108:109], v16 offset:512
ds_read_b64 v[110:111], v16 offset:768
ds_read_b64 v[112:113], v16 offset:1024
ds_read_b64 v[114:115], v16 offset:1280
ds_read_b64 v[116:117], v16 offset:1536
ds_read_b64 v[118:119], v16 offset:1792
s_mov_b32 s64, 0x05040100
s_mov_b32 s65, 0x07060302
v_lshlrev_b32 v88, 16, v88
v_lshlrev_b32 v89, 16, v89
v_lshlrev_b32 v9, 1, v1
v_add_f32_dpp v90, v88, v88 quad_perm:[1,0,3,2] row_mask:0xf bank_mask:0xf
v_subrev_f32_dpp v91, v89, v89 quad_perm:[1,0,3,2] row_mask:0xf bank_mask:0xf
v_mul_f32 v90, 0.5, v90
v_mul_f32 v91, 0.5, v91
v_cvt_pk_bf16_f32 v88, v90, v91
s_waitcnt lgkmcnt(0)
v_perm_b32 v120, v112, v104, s64
v_perm_b32 v121, v116, v108, s64
v_perm_b32 v122, v114, v106, s64
v_perm_b32 v123, v118, v110, s64
v_perm_b32 v124, v112, v104, s65
v_perm_b32 v125, v116, v108, s65
v_perm_b32 v126, v114, v106, s65
v_perm_b32 v127, v118, v110, s65
v_perm_b32 v128, v113, v105, s64
v_perm_b32 v129, v117, v109, s64
v_perm_b32 v130, v115, v107, s64
v_perm_b32 v131, v119, v111, s64
v_perm_b32 v132, v113, v105, s65
v_perm_b32 v133, v117, v109, s65
v_perm_b32 v134, v115, v107, s65
v_perm_b32 v135, v119, v111, s65
s_waitcnt vmcnt(8)
s_barrier
s_add_u32 m0, s25, 32768
s_add_u32 s26, s24, 896
s_and_b32 s26, s26, 0x7ff
buffer_load_dwordx4 v176, s[12:15], s26 offen offset:0 lds
buffer_load_dwordx4 v177, s[12:15], s26 offen offset:1024 lds
buffer_load_dwordx4 v178, s[12:15], s26 offen offset:2048 lds
buffer_load_dwordx4 v179, s[12:15], s26 offen offset:3072 lds
s_add_u32 m0, s25, 49152
s_nop 0
buffer_load_dwordx4 v180, s[20:23], s26 offen offset:0 lds
buffer_load_dwordx4 v181, s[20:23], s26 offen offset:1024 lds
buffer_load_dwordx4 v182, s[20:23], s26 offen offset:2048 lds
buffer_load_dwordx4 v183, s[20:23], s26 offen offset:3072 lds
s_add_u32 m0, s68, 0
s_mov_b32 s92, 0
buffer_load_dwordx4 v2, s[4:7], s92 offen offset:0 nt lds
buffer_load_dwordx4 v2, s[4:7], s92 offen offset:1024 nt lds
s_add_u32 m0, s68, 2048
s_mov_b32 s92, 2048
buffer_load_dwordx4 v3, s[4:7], s92 offen offset:0 nt lds
buffer_load_dwordx4 v3, s[4:7], s92 offen offset:1024 nt lds
s_waitcnt vmcnt(12)
s_barrier
s_add_u32 m0, s25, 65536
s_add_u32 s26, s24, 1024
s_and_b32 s26, s26, 0x7ff
buffer_load_dwordx4 v176, s[12:15], s26 offen offset:0 lds
buffer_load_dwordx4 v177, s[12:15], s26 offen offset:1024 lds
buffer_load_dwordx4 v178, s[12:15], s26 offen offset:2048 lds
buffer_load_dwordx4 v179, s[12:15], s26 offen offset:3072 lds
s_add_u32 m0, s25, 81920
s_nop 0
buffer_load_dwordx4 v180, s[20:23], s26 offen offset:0 lds
buffer_load_dwordx4 v181, s[20:23], s26 offen offset:1024 lds
buffer_load_dwordx4 v182, s[20:23], s26 offen offset:2048 lds
buffer_load_dwordx4 v183, s[20:23], s26 offen offset:3072 lds
s_waitcnt vmcnt(12)
s_barrier
s_add_u32 m0, s25, 0
s_add_u32 s26, s24, 1152
s_and_b32 s26, s26, 0x7ff
buffer_load_dwordx4 v176, s[12:15], s26 offen offset:0 lds
buffer_load_dwordx4 v177, s[12:15], s26 offen offset:1024 lds
buffer_load_dwordx4 v178, s[12:15], s26 offen offset:2048 lds
buffer_load_dwordx4 v179, s[12:15], s26 offen offset:3072 lds
s_add_u32 m0, s25, 16384
s_nop 0
buffer_load_dwordx4 v180, s[20:23], s26 offen offset:0 lds
buffer_load_dwordx4 v181, s[20:23], s26 offen offset:1024 lds
buffer_load_dwordx4 v182, s[20:23], s26 offen offset:2048 lds
buffer_load_dwordx4 v183, s[20:23], s26 offen offset:3072 lds
v_mov_b32 v20, 0
global_load_dword v21, v20, s[30:31] sc1
s_waitcnt vmcnt(9)
s_barrier
s_add_u32 m0, s25, 32768
s_add_u32 s26, s24, 1280
s_and_b32 s26, s26, 0x7ff
buffer_load_dwordx4 v176, s[12:15], s26 offen offset:0 lds
buffer_load_dwordx4 v177, s[12:15], s26 offen offset:1024 lds
buffer_load_dwordx4 v178, s[12:15], s26 offen offset:2048 lds
buffer_load_dwordx4 v179, s[12:15], s26 offen offset:3072 lds
s_add_u32 m0, s25, 49152
s_nop 0
buffer_load_dwordx4 v180, s[20:23], s26 offen offset:0 lds
buffer_load_dwordx4 v181, s[20:23], s26 offen offset:1024 lds
buffer_load_dwordx4 v182, s[20:23], s26 offen offset:2048 lds
buffer_load_dwordx4 v183, s[20:23], s26 offen offset:3072 lds
s_waitcnt vmcnt(9)
s_barrier
s_add_u32 m0, s25, 65536
s_add_u32 s26, s24, 1408
s_and_b32 s26, s26, 0x7ff
buffer_load_dwordx4 v176, s[12:15], s26 offen offset:0 lds
buffer_load_dwordx4 v177, s[12:15], s26 offen offset:1024 lds
buffer_load_dwordx4 v178, s[12:15], s26 offen offset:2048 lds
buffer_load_dwordx4 v179, s[12:15], s26 offen offset:3072 lds
s_add_u32 m0, s25, 81920
s_nop 0
buffer_load_dwordx4 v180, s[20:23], s26 offen offset:0 lds
buffer_load_dwordx4 v181, s[20:23], s26 offen offset:1024 lds
buffer_load_dwordx4 v182, s[20:23], s26 offen offset:2048 lds
buffer_load_dwordx4 v183, s[20:23], s26 offen offset:3072 lds
s_cmp_lg_u32 s66, 3
s_cbranch_scc1 L_nw2
s_lshr_b32 s64, s2, 7
s_mul_i32 s64, s64, 8192
s_bfe_u32 s65, s2, 0x10006
s_mul_i32 s65, s65, 4096
s_add_u32 s64, s64, s65
s_and_b32 s65, s2, 63
s_lshl_b32 s65, s65, 6
s_add_u32 s64, s64, s65
s_add_u32 s54, s64, 25165824
s_add_u32 s52, s32, s54
s_addc_u32 s53, s33, 0
s_mov_b32 s54, 64
s_mov_b32 s55, 0x20000
s_mov_b32 exec_lo, 0x55555555
s_mov_b32 exec_hi, 0
buffer_store_dword v88, v9, s[52:55], 0 offen sc1
s_mov_b64 exec, -1
L_nw2:
s_mov_b32 s92, 0
buffer_store_dwordx4 v[120:123], v15, s[56:59], s92 offen sc1
s_mov_b32 s92, 8192
buffer_store_dwordx4 v[124:127], v15, s[56:59], s92 offen sc1
s_mov_b32 s92, 16384
buffer_store_dwordx4 v[128:131], v15, s[56:59], s92 offen sc1
s_mov_b32 s92, 24576
buffer_store_dwordx4 v[132:135], v15, s[56:59], s92 offen sc1
s_waitcnt vmcnt(12)
s_barrier
s_add_u32 m0, s25, 0
s_add_u32 s26, s24, 1536
s_and_b32 s26, s26, 0x7ff
buffer_load_dwordx4 v176, s[12:15], s26 offen offset:0 lds
buffer_load_dwordx4 v177, s[12:15], s26 offen offset:1024 lds
buffer_load_dwordx4 v178, s[12:15], s26 offen offset:2048 lds
buffer_load_dwordx4 v179, s[12:15], s26 offen offset:3072 lds
s_add_u32 m0, s25, 16384
s_nop 0
buffer_load_dwordx4 v180, s[20:23], s26 offen offset:0 lds
buffer_load_dwordx4 v181, s[20:23], s26 offen offset:1024 lds
buffer_load_dwordx4 v182, s[20:23], s26 offen offset:2048 lds
buffer_load_dwordx4 v183, s[20:23], s26 offen offset:3072 lds
s_waitcnt vmcnt(12)
s_barrier
s_add_u32 m0, s25, 32768
s_add_u32 s26, s24, 1664
s_and_b32 s26, s26, 0x7ff
buffer_load_dwordx4 v176, s[12:15], s26 offen offset:0 lds
buffer_load_dwordx4 v177, s[12:15], s26 offen offset:1024 lds
buffer_load_dwordx4 v178, s[12:15], s26 offen offset:2048 lds
buffer_load_dwordx4 v179, s[12:15], s26 offen offset:3072 lds
s_add_u32 m0, s25, 49152
s_nop 0
buffer_load_dwordx4 v180, s[20:23], s26 offen offset:0 lds
buffer_load_dwordx4 v181, s[20:23], s26 offen offset:1024 lds
buffer_load_dwordx4 v182, s[20:23], s26 offen offset:2048 lds
buffer_load_dwordx4 v183, s[20:23], s26 offen offset:3072 lds
s_waitcnt vmcnt(8)
s_barrier
s_add_u32 m0, s25, 65536
s_add_u32 s26, s24, 1792
s_and_b32 s26, s26, 0x7ff
buffer_load_dwordx4 v176, s[12:15], s26 offen offset:0 lds
buffer_load_dwordx4 v177, s[12:15], s26 offen offset:1024 lds
buffer_load_dwordx4 v178, s[12:15], s26 offen offset:2048 lds
buffer_load_dwordx4 v179, s[12:15], s26 offen offset:3072 lds
s_add_u32 m0, s25, 81920
s_nop 0
buffer_load_dwordx4 v180, s[20:23], s26 offen offset:0 lds
buffer_load_dwordx4 v181, s[20:23], s26 offen offset:1024 lds
buffer_load_dwordx4 v182, s[20:23], s26 offen offset:2048 lds
buffer_load_dwordx4 v183, s[20:23], s26 offen offset:3072 lds
s_waitcnt vmcnt(8)
s_barrier
s_add_u32 m0, s25, 0
s_add_u32 s26, s24, 1920
s_and_b32 s26, s26, 0x7ff
buffer_load_dwordx4 v176, s[12:15], s26 offen offset:0 lds
buffer_load_dwordx4 v177, s[12:15], s26 offen offset:1024 lds
buffer_load_dwordx4 v178, s[12:15], s26 offen offset:2048 lds
buffer_load_dwordx4 v179, s[12:15], s26 offen offset:3072 lds
s_add_u32 m0, s25, 16384
s_nop 0
buffer_load_dwordx4 v180, s[20:23], s26 offen offset:0 lds
buffer_load_dwordx4 v181, s[20:23], s26 offen offset:1024 lds
buffer_load_dwordx4 v182, s[20:23], s26 offen offset:2048 lds
buffer_load_dwordx4 v183, s[20:23], s26 offen offset:3072 lds
s_and_b32 s26, s2, 1
s_lshl_b32 s26, s26, 10
s_bfe_u32 s92, s2, 0x20001
s_lshl_b32 s92, s92, 19
s_add_u32 s26, s26, s92
s_lshr_b32 s92, s2, 3
s_lshl_b32 s92, s92, 14
s_add_u32 s26, s26, s92
s_lshr_b32 s92, s66, 1
s_lshl_b32 s92, s92, 13
s_add_u32 s26, s26, s92
v_bfe_u32 v22, v1, 3, 2
v_lshlrev_b32 v22, 11, v22
v_and_b32 v23, 7, v1
v_lshl_add_u32 v22, v23, 7, v22
v_add_u32 v22, s26, v22
s_mov_b32 exec_hi, 0
global_load_dword v23, v22, s[100:101]
s_mov_b64 exec, -1
s_waitcnt vmcnt(9)
s_barrier
s_waitcnt vmcnt(1)
s_barrier
s_barrier
s_barrier
s_setprio 3
v_readfirstlane_b32 s37, v21
s_nop 0
s_cmp_lg_u32 s37, 0
s_cbranch_scc1 L_sg3
v_mov_b32 v20, 0
L_n4:
global_load_dword v21, v20, s[30:31] sc1
s_waitcnt vmcnt(0)
v_readfirstlane_b32 s37, v21
s_nop 0
s_cmp_eq_u32 s37, 0
s_cbranch_scc1 L_n4
L_sg3:
s_waitcnt vmcnt(63)
ds_read_b64_tr_b16 v[24:25], v12 offset:0
ds_read_b64_tr_b16 v[26:27], v13 offset:0
ds_read_b64_tr_b16 v[28:29], v12 offset:512
ds_read_b64_tr_b16 v[30:31], v13 offset:512
ds_read_b64_tr_b16 v[32:33], v12 offset:1024
ds_read_b64_tr_b16 v[34:35], v13 offset:1024
ds_read_b64_tr_b16 v[36:37], v12 offset:1536
ds_read_b64_tr_b16 v[38:39], v13 offset:1536
s_waitcnt lgkmcnt(0)
v_mfma_f32_32x32x16_bf16 v[40:55], v[24:27], v[192:195], 0
v_mfma_f32_32x32x16_bf16 v[40:55], v[28:31], v[196:199], v[40:55]
v_mfma_f32_32x32x16_bf16 v[40:55], v[32:35], v[200:203], v[40:55]
v_mfma_f32_32x32x16_bf16 v[40:55], v[36:39], v[204:207], v[40:55]
v_mfma_f32_32x32x16_bf16 v[56:71], v[24:27], v[208:211], 0
v_mfma_f32_32x32x16_bf16 v[56:71], v[28:31], v[212:215], v[56:71]
v_mfma_f32_32x32x16_bf16 v[56:71], v[32:35], v[216:219], v[56:71]
v_mfma_f32_32x32x16_bf16 v[56:71], v[36:39], v[220:223], v[56:71]
s_nop 7
v_mul_f32 v168, v40, v224
v_mul_f32 v169, v40, v240
s_nop 1
v_fma_f32 v168, -v56, v240, v168
v_fmac_f32 v169, v56, v224
v_cvt_pk_bf16_f32 v72, v168, v169
v_mul_f32 v170, v41, v225
v_mul_f32 v171, v41, v241
v_fma_f32 v170, -v57, v241, v170
v_fmac_f32 v171, v57, v225
v_cvt_pk_bf16_f32 v73, v170, v171
v_mul_f32 v172, v42, v226
v_mul_f32 v173, v42, v242
v_fma_f32 v172, -v58, v242, v172
v_fmac_f32 v173, v58, v226
v_cvt_pk_bf16_f32 v74, v172, v173
v_mul_f32 v174, v43, v227
v_mul_f32 v175, v43, v243
v_fma_f32 v174, -v59, v243, v174
v_fmac_f32 v175, v59, v227
v_cvt_pk_bf16_f32 v75, v174, v175
v_mul_f32 v168, v44, v228
v_mul_f32 v169, v44, v244
v_fma_f32 v168, -v60, v244, v168
v_fmac_f32 v169, v60, v228
v_cvt_pk_bf16_f32 v76, v168, v169
v_mul_f32 v170, v45, v229
v_mul_f32 v171, v45, v245
v_fma_f32 v170, -v61, v245, v170
v_fmac_f32 v171, v61, v229
v_cvt_pk_bf16_f32 v77, v170, v171
v_mul_f32 v172, v46, v230
v_mul_f32 v173, v46, v246
v_fma_f32 v172, -v62, v246, v172
v_fmac_f32 v173, v62, v230
v_cvt_pk_bf16_f32 v78, v172, v173
v_mul_f32 v174, v47, v231
v_mul_f32 v175, v47, v247
v_fma_f32 v174, -v63, v247, v174
v_fmac_f32 v175, v63, v231
v_cvt_pk_bf16_f32 v79, v174, v175
v_mul_f32 v168, v48, v232
v_mul_f32 v169, v48, v248
v_fma_f32 v168, -v64, v248, v168
v_fmac_f32 v169, v64, v232
v_cvt_pk_bf16_f32 v80, v168, v169
v_mul_f32 v170, v49, v233
v_mul_f32 v171, v49, v249
v_fma_f32 v170, -v65, v249, v170
v_fmac_f32 v171, v65, v233
v_cvt_pk_bf16_f32 v81, v170, v171
v_mul_f32 v172, v50, v234
v_mul_f32 v173, v50, v250
v_fma_f32 v172, -v66, v250, v172
v_fmac_f32 v173, v66, v234
v_cvt_pk_bf16_f32 v82, v172, v173
v_mul_f32 v174, v51, v235
v_mul_f32 v175, v51, v251
v_fma_f32 v174, -v67, v251, v174
v_fmac_f32 v175, v67, v235
v_cvt_pk_bf16_f32 v83, v174, v175
v_mul_f32 v168, v52, v236
v_mul_f32 v169, v52, v252
v_fma_f32 v168, -v68, v252, v168
v_fmac_f32 v169, v68, v236
v_cvt_pk_bf16_f32 v84, v168, v169
v_mul_f32 v170, v53, v237
v_mul_f32 v171, v53, v253
v_fma_f32 v170, -v69, v253, v170
v_fmac_f32 v171, v69, v237
v_cvt_pk_bf16_f32 v85, v170, v171
v_mul_f32 v172, v54, v238
v_mul_f32 v173, v54, v254
v_fma_f32 v172, -v70, v254, v172
v_fmac_f32 v173, v70, v238
v_cvt_pk_bf16_f32 v86, v172, v173
v_mul_f32 v174, v55, v239
v_mul_f32 v175, v55, v255
v_fma_f32 v174, -v71, v255, v174
v_fmac_f32 v175, v71, v239
v_cvt_pk_bf16_f32 v87, v174, v175
v_mfma_f32_32x32x16_bf16 v[40:55], v[192:195], v[72:75], 0
v_mfma_f32_32x32x16_bf16 v[40:55], v[196:199], v[76:79], v[40:55]
v_mfma_f32_32x32x16_bf16 v[40:55], v[200:203], v[80:83], v[40:55]
v_mfma_f32_32x32x16_bf16 v[40:55], v[204:207], v[84:87], v[40:55]
v_mfma_f32_32x32x16_bf16 v[56:71], v[208:211], v[72:75], 0
v_mfma_f32_32x32x16_bf16 v[56:71], v[212:215], v[76:79], v[56:71]
v_mfma_f32_32x32x16_bf16 v[56:71], v[216:219], v[80:83], v[56:71]
v_mfma_f32_32x32x16_bf16 v[56:71], v[220:223], v[84:87], v[56:71]
s_lshl_b32 s92, s66, 12
s_add_u32 s92, s92, 98304
v_add_u32 v8, s92, v7
s_nop 8
v_cvt_pk_bf16_f32 v72, v40, v56
ds_write_b32 v4, v72 offset:0
v_cvt_pk_bf16_f32 v73, v41, v57
ds_write_b32 v4, v73 offset:1024
v_cvt_pk_bf16_f32 v74, v42, v58
ds_write_b32 v4, v74 offset:2048
v_cvt_pk_bf16_f32 v75, v43, v59
ds_write_b32 v4, v75 offset:3072
v_cvt_pk_bf16_f32 v76, v44, v60
ds_write_b32 v4, v76 offset:8192
v_cvt_pk_bf16_f32 v77, v45, v61
ds_write_b32 v4, v77 offset:9216
v_cvt_pk_bf16_f32 v78, v46, v62
ds_write_b32 v4, v78 offset:10240
v_cvt_pk_bf16_f32 v79, v47, v63
ds_write_b32 v4, v79 offset:11264
v_cvt_pk_bf16_f32 v80, v48, v64
ds_write_b32 v6, v80 offset:0
v_cvt_pk_bf16_f32 v81, v49, v65
ds_write_b32 v5, v81 offset:10240
v_cvt_pk_bf16_f32 v82, v50, v66
ds_write_b32 v5, v82 offset:9216
v_cvt_pk_bf16_f32 v83, v51, v67
ds_write_b32 v5, v83 offset:8192
v_cvt_pk_bf16_f32 v84, v52, v68
ds_write_b32 v5, v84 offset:3072
v_cvt_pk_bf16_f32 v85, v53, v69
ds_write_b32 v5, v85 offset:2048
v_cvt_pk_bf16_f32 v86, v54, v70
ds_write_b32 v5, v86 offset:1024
v_cvt_pk_bf16_f32 v87, v55, v71
ds_write_b32 v5, v87 offset:0
s_waitcnt lgkmcnt(0)
v_mov_b32 v190, 1
s_mov_b64 exec, 1
ds_write_b32 v185, v190
s_mov_b64 exec, -1
L_lc6:
ds_read_b128 v[186:189], v184
s_waitcnt lgkmcnt(0)
v_min3_u32 v186, v186, v187, v188
v_min_u32 v186, v186, v189
s_nop 0
v_readfirstlane_b32 s92, v186
s_nop 0
s_cmp_ge_u32 s92, 1
s_cbranch_scc1 L_lcd7
s_sleep 1
s_branch L_lc6
L_lcd7:
ds_read_b128 v[72:75], v8 offset:0
ds_read_b128 v[76:79], v8 offset:1024
ds_read_b128 v[80:83], v8 offset:2048
ds_read_b128 v[84:87], v8 offset:3072
v_add_u32 v4, 32768, v4
v_add_u32 v5, 32768, v5
v_add_u32 v6, 32768, v6
s_waitcnt lgkmcnt(0)
v_mov_b32 v190, 2
s_mov_b64 exec, 1
ds_write_b32 v185, v190
s_mov_b64 exec, -1
buffer_store_dwordx4 v[72:75], v2, s[40:43], 0 offen offset:0 sc1
buffer_store_dwordx4 v[76:79], v2, s[40:43], 0 offen offset:1024 sc1
buffer_store_dwordx4 v[80:83], v2, s[40:43], 0 offen offset:2048 sc1
buffer_store_dwordx4 v[84:87], v2, s[40:43], 0 offen offset:3072 sc1
s_and_b32 s60, s2, 7
s_lshl_b32 s60, s60, 5
s_lshr_b32 s64, s2, 3
s_add_u32 s60, s60, s64
s_lshr_b32 s64, s66, 1
s_xor_b32 s64, s64, s66
s_and_b32 s64, s64, 1
s_or_b32 s65, s64, s60
s_cmp_eq_u32 s65, 0
s_cselect_b32 s61, 1, 0
s_lshl_b32 s65, s60, 1
s_add_u32 s64, s64, s65
s_mul_i32 s64, s64, 8192
s_add_u32 s64, s64, 25182208
s_lshr_b32 s65, s66, 1
s_mul_i32 s69, s65, 8192
s_add_u32 s69, s69, 25165824
s_cmp_eq_u32 s61, 1
s_cselect_b32 s64, s69, s64
s_cselect_b32 s65, 0, s65
s_cselect_b32 s90, s32, s32
s_cselect_b32 s91, s33, s33
s_lshl_b32 s62, s65, 31
s_or_b32 s63, s62, 0x3f800000
s_add_u32 s48, s90, s64
s_addc_u32 s49, s91, 0
s_mov_b32 s50, 8192
s_mov_b32 s51, 0x20000
s_lshl_b32 s64, s66, 20
s_lshl_b32 s65, s60, 6
s_add_u32 s64, s64, s65
s_add_u32 s54, s64, 16777216
s_add_u32 s52, s32, s54
s_addc_u32 s53, s33, 0
s_sub_u32 s54, 1048576, s65
s_mov_b32 s55, 0x20000
s_add_u32 s58, s64, 16777216
s_add_u32 s56, s32, s58
s_addc_u32 s57, s33, 0
s_sub_u32 s58, 1048576, s65
s_mov_b32 s59, 0x20000
v_lshrrev_b32 v8, 2, v1
v_lshlrev_b32 v8, 14, v8
v_and_b32 v9, 3, v1
v_lshrrev_b32 v10, 4, v1
v_xor_b32 v9, v9, v10
v_lshl_add_u32 v14, v9, 4, v8
v_and_b32 v8, 31, v1
v_bfe_u32 v9, v1, 2, 2
v_xor_b32 v9, s66, v9
v_lshlrev_b32 v9, 4, v9
v_lshl_add_u32 v9, v8, 6, v9
v_lshrrev_b32 v8, 5, v1
v_lshl_add_u32 v9, v8, 11, v9
v_add_u32 v15, 131072, v9
s_lshl_b32 s64, s66, 13
s_add_u32 s64, s64, 131072
v_add_u32 v16, s64, v2
s_xor_b32 s65, s64, 24576
s_cmp_eq_u32 s61, 1
s_cselect_b32 s65, s64, s65
v_add_u32 v17, s65, v2
v_add_u32 v18, s68, v2
s_lshr_b32 s64, s66, 1
s_xor_b32 s64, s64, s66
s_and_b32 s64, s64, 1
s_lshl_b32 s69, s64, 13
s_add_u32 s69, s69, 147456
v_add_u32 v19, s69, v2
v_mul_f32 v136, s63, v136
v_mul_f32 v137, s63, v137
v_mul_f32 v138, s63, v138
v_mul_f32 v139, s63, v139
v_mul_f32 v140, s63, v140
v_mul_f32 v141, s63, v141
v_mul_f32 v142, s63, v142
v_mul_f32 v143, s63, v143
v_mul_f32 v144, s63, v144
v_mul_f32 v145, s63, v145
v_mul_f32 v146, s63, v146
v_mul_f32 v147, s63, v147
v_mul_f32 v148, s63, v148
v_mul_f32 v149, s63, v149
v_mul_f32 v150, s63, v150
v_mul_f32 v151, s63, v151
v_mul_f32 v152, s63, v152
v_mul_f32 v153, s63, v153
v_mul_f32 v154, s63, v154
v_mul_f32 v155, s63, v155
v_mul_f32 v156, s63, v156
v_mul_f32 v157, s63, v157
v_mul_f32 v158, s63, v158
v_mul_f32 v159, s63, v159
v_mul_f32 v160, s63, v160
v_mul_f32 v161, s63, v161
v_mul_f32 v162, s63, v162
v_mul_f32 v163, s63, v163
v_mul_f32 v164, s63, v164
v_mul_f32 v165, s63, v165
v_mul_f32 v166, s63, v166
v_mul_f32 v167, s63, v167
s_waitcnt vmcnt(0)
v_mov_b32 v190, 3
s_mov_b64 exec, 1
ds_write_b32 v185, v190
s_mov_b64 exec, -1
s_cmp_lg_u32 s66, 0
s_cbranch_scc1 L_ph8
L_lc9:
ds_read_b128 v[186:189], v184
s_waitcnt lgkmcnt(0)
v_min3_u32 v186, v186, v187, v188
v_min_u32 v186, v186, v189
s_nop 0
v_readfirstlane_b32 s92, v186
s_nop 0
s_cmp_ge_u32 s92, 3
s_cbranch_scc1 L_lcd10
s_sleep 1
s_branch L_lc9
L_lcd10:
s_and_b32 s64, s2, 15
s_lshl_b32 s65, s64, 7
s_add_u32 s65, s65, 4096
s_add_u32 s90, s32, s65
s_addc_u32 s91, s33, 0
s_mov_b32 s65, 1
s_atomic_add s65, s[90:91], 0x0 glc
s_lshl_b32 s64, s64, 2
s_add_u32 s64, s64, 540672
v_lshl_add_u32 v20, v1, 7, s64
v_mov_b32 v21, s37
s_add_u32 s4, s32, s64
s_addc_u32 s5, s33, 0
s_and_b32 s64, s2, 31
s_lshl_b32 s64, s64, 7
s_add_u32 s64, s64, 540672
s_waitcnt lgkmcnt(0)
s_cmp_lg_u32 s65, 15
s_cbranch_scc1 L_sg11
s_atomic_swap s37, s[4:5], 0x0
s_atomic_swap s37, s[4:5], 0x80
s_atomic_swap s37, s[4:5], 0x100
s_atomic_swap s37, s[4:5], 0x180
s_atomic_swap s37, s[4:5], 0x200
s_atomic_swap s37, s[4:5], 0x280
s_atomic_swap s37, s[4:5], 0x300
s_atomic_swap s37, s[4:5], 0x380
s_atomic_swap s37, s[4:5], 0x400
s_atomic_swap s37, s[4:5], 0x480
s_atomic_swap s37, s[4:5], 0x500
s_atomic_swap s37, s[4:5], 0x580
s_atomic_swap s37, s[4:5], 0x600
s_atomic_swap s37, s[4:5], 0x680
s_atomic_swap s37, s[4:5], 0x700
s_atomic_swap s37, s[4:5], 0x780
s_atomic_swap s37, s[4:5], 0x800
s_atomic_swap s37, s[4:5], 0x880
s_atomic_swap s37, s[4:5], 0x900
s_atomic_swap s37, s[4:5], 0x980
s_atomic_swap s37, s[4:5], 0xa00
s_atomic_swap s37, s[4:5], 0xa80
s_atomic_swap s37, s[4:5], 0xb00
s_atomic_swap s37, s[4:5], 0xb80
s_atomic_swap s37, s[4:5], 0xc00
s_atomic_swap s37, s[4:5], 0xc80
s_atomic_swap s37, s[4:5], 0xd00
s_atomic_swap s37, s[4:5], 0xd80
s_atomic_swap s37, s[4:5], 0xe00
s_atomic_swap s37, s[4:5], 0xe80
s_atomic_swap s37, s[4:5], 0xf00
s_atomic_swap s37, s[4:5], 0xf80
s_waitcnt lgkmcnt(0)
L_sg11:
s_add_u32 s90, s32, s64
s_addc_u32 s91, s33, 0
s_mov_b32 s64, s37
s_mov_b32 s65, s37
s_mov_b32 s92, 0
s_branch L_sp12
L_nok13:
s_add_u32 s92, s92, 1
s_cmp_ge_u32 s92, 200000
s_cbranch_scc1 L_ph8
s_sleep 10
L_sp12:
s_load_dwordx16 s[4:19], s[90:91], 0x0 glc
s_waitcnt lgkmcnt(0)
s_cmp_eq_u64 s[4:5], s[64:65]
s_cbranch_scc0 L_nok13
s_cmp_eq_u64 s[6:7], s[64:65]
s_cbranch_scc0 L_nok13
s_cmp_eq_u64 s[8:9], s[64:65]
s_cbranch_scc0 L_nok13
s_cmp_eq_u64 s[10:11], s[64:65]
s_cbranch_scc0 L_nok13
s_cmp_eq_u64 s[12:13], s[64:65]
s_cbranch_scc0 L_nok13
s_cmp_eq_u64 s[14:15], s[64:65]
s_cbranch_scc0 L_nok13
s_cmp_eq_u64 s[16:17], s[64:65]
s_cbranch_scc0 L_nok13
s_cmp_eq_u64 s[18:19], s[64:65]
s_cbranch_scc0 L_nok13
L_ph8:
v_mov_b32 v190, 4
s_mov_b64 exec, 1
ds_write_b32 v185, v190
s_mov_b64 exec, -1
L_lc14:
ds_read_b128 v[186:189], v184
s_waitcnt lgkmcnt(0)
v_min3_u32 v186, v186, v187, v188
v_min_u32 v186, v186, v189
s_nop 0
v_readfirstlane_b32 s92, v186
s_nop 0
s_cmp_ge_u32 s92, 4
s_cbranch_scc1 L_lcd15
s_sleep 1
s_branch L_lc14
L_lcd15:
s_setprio 3
s_add_u32 m0, s68, 0
s_mov_b32 s64, 0
buffer_load_dwordx4 v14, s[52:55], s64 offen sc1 lds
s_add_u32 m0, s68, 1024
s_mov_b32 s64, 262144
buffer_load_dwordx4 v14, s[52:55], s64 offen sc1 lds
s_add_u32 m0, s68, 2048
s_mov_b32 s64, 524288
buffer_load_dwordx4 v14, s[52:55], s64 offen sc1 lds
s_add_u32 m0, s68, 3072
s_mov_b32 s64, 786432
buffer_load_dwordx4 v14, s[52:55], s64 offen sc1 lds
s_cmp_eq_u32 s61, 1
s_cbranch_scc1 L_ws16
s_lshr_b32 s64, s66, 1
s_lshl_b32 s65, s64, 12
s_mul_i32 s64, s64, 4096
s_add_u32 m0, s69, s65
s_nop 0
buffer_load_dwordx4 v2, s[48:51], s64 offen offset:0 sc1 lds
buffer_load_dwordx4 v2, s[48:51], s64 offen offset:1024 sc1 lds
buffer_load_dwordx4 v2, s[48:51], s64 offen offset:2048 sc1 lds
buffer_load_dwordx4 v2, s[48:51], s64 offen offset:3072 sc1 lds
s_waitcnt vmcnt(0)
s_branch L_wd17
L_ws16:
s_movk_i32 s64, 4096
buffer_load_dwordx4 v[104:107], v2, s[48:51], 0 offen offset:0 sc1
buffer_load_dwordx4 v[108:111], v2, s[48:51], 0 offen offset:1024 sc1
buffer_load_dwordx4 v[112:115], v2, s[48:51], 0 offen offset:2048 sc1
buffer_load_dwordx4 v[116:119], v2, s[48:51], 0 offen offset:3072 sc1
buffer_load_dwordx4 v[120:123], v2, s[48:51], s64 offen offset:0 sc1
buffer_load_dwordx4 v[124:127], v2, s[48:51], s64 offen offset:1024 sc1
buffer_load_dwordx4 v[128:131], v2, s[48:51], s64 offen offset:2048 sc1
buffer_load_dwordx4 v[132:135], v2, s[48:51], s64 offen offset:3072 sc1
L_wd17:
s_waitcnt vmcnt(8)
v_mov_b32 v190, 5
s_mov_b64 exec, 1
ds_write_b32 v185, v190
s_mov_b64 exec, -1
L_lc18:
ds_read_b128 v[186:189], v184
s_waitcnt lgkmcnt(0)
v_min3_u32 v186, v186, v187, v188
v_min_u32 v186, v186, v189
s_nop 0
v_readfirstlane_b32 s92, v186
s_nop 0
s_cmp_ge_u32 s92, 5
s_cbranch_scc1 L_lcd19
s_sleep 1
s_branch L_lc18
L_lcd19:
ds_read_b128 v[72:75], v15 offset:0
ds_read_b128 v[76:79], v15 offset:4096
ds_read_b128 v[80:83], v15 offset:8192
ds_read_b128 v[84:87], v15 offset:12288
s_cmp_eq_u32 s61, 1
s_cbranch_scc1 L_wr20
ds_read_b128 v[104:107], v19 offset:0
ds_read_b128 v[108:111], v19 offset:1024
ds_read_b128 v[112:115], v19 offset:2048
ds_read_b128 v[116:119], v19 offset:3072
ds_read_b128 v[120:123], v19 offset:4096
ds_read_b128 v[124:127], v19 offset:5120
ds_read_b128 v[128:131], v19 offset:6144
ds_read_b128 v[132:135], v19 offset:7168
L_wr20:
s_waitcnt lgkmcnt(0)
v_mov_b32 v190, 6
s_mov_b64 exec, 1
ds_write_b32 v185, v190
s_mov_b64 exec, -1
s_lshl_b32 s64, s61, 31
s_or_b32 s64, s64, s62
L_fft21:
v_xor_b32 v24, s64, v72
v_xor_b32 v25, s64, v73
v_xor_b32 v26, s64, v74
v_xor_b32 v27, s64, v75
v_xor_b32 v28, s64, v76
v_xor_b32 v29, s64, v77
v_xor_b32 v30, s64, v78
v_xor_b32 v31, s64, v79
v_xor_b32 v32, s64, v80
v_xor_b32 v33, s64, v81
v_xor_b32 v34, s64, v82
v_xor_b32 v35, s64, v83
v_xor_b32 v36, s64, v84
v_xor_b32 v37, s64, v85
v_xor_b32 v38, s64, v86
v_xor_b32 v39, s64, v87
v_mfma_f32_32x32x16_bf16 v[40:55], v[24:27], v[192:195], 0
v_mfma_f32_32x32x16_bf16 v[40:55], v[28:31], v[196:199], v[40:55]
v_mfma_f32_32x32x16_bf16 v[40:55], v[32:35], v[200:203], v[40:55]
v_mfma_f32_32x32x16_bf16 v[40:55], v[36:39], v[204:207], v[40:55]
v_mfma_f32_32x32x16_bf16 v[56:71], v[24:27], v[208:211], 0
v_mfma_f32_32x32x16_bf16 v[56:71], v[28:31], v[212:215], v[56:71]
v_mfma_f32_32x32x16_bf16 v[56:71], v[32:35], v[216:219], v[56:71]
v_mfma_f32_32x32x16_bf16 v[56:71], v[36:39], v[220:223], v[56:71]
s_cmp_eq_u32 s61, 2
s_cbranch_scc1 L_once23
s_waitcnt vmcnt(0)
v_lshlrev_b32 v176, 16, v104
v_and_b32 v177, 0xffff0000, v104
v_lshlrev_b32 v178, 16, v105
v_and_b32 v179, 0xffff0000, v105
v_add_f32 v180, v176, v178
v_add_f32 v181, v177, v179
v_sub_f32 v176, v176, v178
v_sub_f32 v177, v177, v179
v_mul_f32 v104, v136, v176
v_mul_f32 v105, v136, v177
v_fma_f32 v136, v152, v176, v180
v_fma_f32 v152, v152, v177, v181
v_lshlrev_b32 v176, 16, v106
v_and_b32 v177, 0xffff0000, v106
v_lshlrev_b32 v178, 16, v107
v_and_b32 v179, 0xffff0000, v107
v_add_f32 v180, v176, v178
v_add_f32 v181, v177, v179
v_sub_f32 v176, v176, v178
v_sub_f32 v177, v177, v179
v_mul_f32 v106, v137, v176
v_mul_f32 v107, v137, v177
v_fma_f32 v137, v153, v176, v180
v_fma_f32 v153, v153, v177, v181
v_lshlrev_b32 v176, 16, v108
v_and_b32 v177, 0xffff0000, v108
v_lshlrev_b32 v178, 16, v109
v_and_b32 v179, 0xffff0000, v109
v_add_f32 v180, v176, v178
v_add_f32 v181, v177, v179
v_sub_f32 v176, v176, v178
v_sub_f32 v177, v177, v179
v_mul_f32 v108, v138, v176
v_mul_f32 v109, v138, v177
v_fma_f32 v138, v154, v176, v180
v_fma_f32 v154, v154, v177, v181
v_lshlrev_b32 v176, 16, v110
v_and_b32 v177, 0xffff0000, v110
v_lshlrev_b32 v178, 16, v111
v_and_b32 v179, 0xffff0000, v111
v_add_f32 v180, v176, v178
v_add_f32 v181, v177, v179
v_sub_f32 v176, v176, v178
v_sub_f32 v177, v177, v179
v_mul_f32 v110, v139, v176
v_mul_f32 v111, v139, v177
v_fma_f32 v139, v155, v176, v180
v_fma_f32 v155, v155, v177, v181
v_lshlrev_b32 v176, 16, v112
v_and_b32 v177, 0xffff0000, v112
v_lshlrev_b32 v178, 16, v113
v_and_b32 v179, 0xffff0000, v113
v_add_f32 v180, v176, v178
v_add_f32 v181, v177, v179
v_sub_f32 v176, v176, v178
v_sub_f32 v177, v177, v179
v_mul_f32 v112, v140, v176
v_mul_f32 v113, v140, v177
v_fma_f32 v140, v156, v176, v180
v_fma_f32 v156, v156, v177, v181
v_lshlrev_b32 v176, 16, v114
v_and_b32 v177, 0xffff0000, v114
v_lshlrev_b32 v178, 16, v115
v_and_b32 v179, 0xffff0000, v115
v_add_f32 v180, v176, v178
v_add_f32 v181, v177, v179
v_sub_f32 v176, v176, v178
v_sub_f32 v177, v177, v179
v_mul_f32 v114, v141, v176
v_mul_f32 v115, v141, v177
v_fma_f32 v141, v157, v176, v180
v_fma_f32 v157, v157, v177, v181
L_once23:
s_nop 5
v_mul_f32 v168, v40, v224
v_mul_f32 v169, v40, v240
s_nop 1
v_fma_f32 v168, -v56, v240, v168
v_fmac_f32 v169, v56, v224
v_cvt_pk_bf16_f32 v24, v168, v169
v_mul_f32 v170, v41, v225
v_mul_f32 v171, v41, v241
v_fma_f32 v170, -v57, v241, v170
v_fmac_f32 v171, v57, v225
v_cvt_pk_bf16_f32 v25, v170, v171
v_mul_f32 v172, v42, v226
v_mul_f32 v173, v42, v242
v_fma_f32 v172, -v58, v242, v172
v_fmac_f32 v173, v58, v226
v_cvt_pk_bf16_f32 v26, v172, v173
v_mul_f32 v174, v43, v227
v_mul_f32 v175, v43, v243
v_fma_f32 v174, -v59, v243, v174
v_fmac_f32 v175, v59, v227
v_cvt_pk_bf16_f32 v27, v174, v175
v_mul_f32 v168, v44, v228
v_mul_f32 v169, v44, v244
v_fma_f32 v168, -v60, v244, v168
v_fmac_f32 v169, v60, v228
v_cvt_pk_bf16_f32 v28, v168, v169
v_mul_f32 v170, v45, v229
v_mul_f32 v171, v45, v245
v_fma_f32 v170, -v61, v245, v170
v_fmac_f32 v171, v61, v229
v_cvt_pk_bf16_f32 v29, v170, v171
v_mul_f32 v172, v46, v230
v_mul_f32 v173, v46, v246
v_fma_f32 v172, -v62, v246, v172
v_fmac_f32 v173, v62, v230
v_cvt_pk_bf16_f32 v30, v172, v173
v_mul_f32 v174, v47, v231
v_mul_f32 v175, v47, v247
v_fma_f32 v174, -v63, v247, v174
v_fmac_f32 v175, v63, v231
v_cvt_pk_bf16_f32 v31, v174, v175
v_mul_f32 v168, v48, v232
v_mul_f32 v169, v48, v248
v_fma_f32 v168, -v64, v248, v168
v_fmac_f32 v169, v64, v232
v_cvt_pk_bf16_f32 v32, v168, v169
v_mul_f32 v170, v49, v233
v_mul_f32 v171, v49, v249
v_fma_f32 v170, -v65, v249, v170
v_fmac_f32 v171, v65, v233
v_cvt_pk_bf16_f32 v33, v170, v171
v_mul_f32 v172, v50, v234
v_mul_f32 v173, v50, v250
v_fma_f32 v172, -v66, v250, v172
v_fmac_f32 v173, v66, v234
v_cvt_pk_bf16_f32 v34, v172, v173
v_mul_f32 v174, v51, v235
v_mul_f32 v175, v51, v251
v_fma_f32 v174, -v67, v251, v174
v_fmac_f32 v175, v67, v235
v_cvt_pk_bf16_f32 v35, v174, v175
v_mul_f32 v168, v52, v236
v_mul_f32 v169, v52, v252
v_fma_f32 v168, -v68, v252, v168
v_fmac_f32 v169, v68, v236
v_cvt_pk_bf16_f32 v36, v168, v169
v_mul_f32 v170, v53, v237
v_mul_f32 v171, v53, v253
v_fma_f32 v170, -v69, v253, v170
v_fmac_f32 v171, v69, v237
v_cvt_pk_bf16_f32 v37, v170, v171
v_mul_f32 v172, v54, v238
v_mul_f32 v173, v54, v254
v_fma_f32 v172, -v70, v254, v172
v_fmac_f32 v173, v70, v238
v_cvt_pk_bf16_f32 v38, v172, v173
v_mul_f32 v174, v55, v239
v_mul_f32 v175, v55, v255
v_fma_f32 v174, -v71, v255, v174
v_fmac_f32 v175, v71, v239
v_cvt_pk_bf16_f32 v39, v174, v175
v_mfma_f32_32x32x16_bf16 v[40:55], v[192:195], v[24:27], 0
v_mfma_f32_32x32x16_bf16 v[40:55], v[196:199], v[28:31], v[40:55]
v_mfma_f32_32x32x16_bf16 v[40:55], v[200:203], v[32:35], v[40:55]
v_mfma_f32_32x32x16_bf16 v[40:55], v[204:207], v[36:39], v[40:55]
v_mfma_f32_32x32x16_bf16 v[56:71], v[208:211], v[24:27], 0
v_mfma_f32_32x32x16_bf16 v[56:71], v[212:215], v[28:31], v[56:71]
v_mfma_f32_32x32x16_bf16 v[56:71], v[216:219], v[32:35], v[56:71]
v_mfma_f32_32x32x16_bf16 v[56:71], v[220:223], v[36:39], v[56:71]
s_cmp_eq_u32 s61, 2
s_cbranch_scc1 L_once24
s_waitcnt vmcnt(0)
v_lshlrev_b32 v176, 16, v116
v_and_b32 v177, 0xffff0000, v116
v_lshlrev_b32 v178, 16, v117
v_and_b32 v179, 0xffff0000, v117
v_add_f32 v180, v176, v178
v_add_f32 v181, v177, v179
v_sub_f32 v176, v176, v178
v_sub_f32 v177, v177, v179
v_mul_f32 v116, v142, v176
v_mul_f32 v117, v142, v177
v_fma_f32 v142, v158, v176, v180
v_fma_f32 v158, v158, v177, v181
v_lshlrev_b32 v176, 16, v118
v_and_b32 v177, 0xffff0000, v118
v_lshlrev_b32 v178, 16, v119
v_and_b32 v179, 0xffff0000, v119
v_add_f32 v180, v176, v178
v_add_f32 v181, v177, v179
v_sub_f32 v176, v176, v178
v_sub_f32 v177, v177, v179
v_mul_f32 v118, v143, v176
v_mul_f32 v119, v143, v177
v_fma_f32 v143, v159, v176, v180
v_fma_f32 v159, v159, v177, v181
v_lshlrev_b32 v176, 16, v120
v_and_b32 v177, 0xffff0000, v120
v_lshlrev_b32 v178, 16, v121
v_and_b32 v179, 0xffff0000, v121
v_add_f32 v180, v176, v178
v_add_f32 v181, v177, v179
v_sub_f32 v176, v176, v178
v_sub_f32 v177, v177, v179
v_mul_f32 v120, v144, v176
v_mul_f32 v121, v144, v177
v_fma_f32 v144, v160, v176, v180
v_fma_f32 v160, v160, v177, v181
v_lshlrev_b32 v176, 16, v122
v_and_b32 v177, 0xffff0000, v122
v_lshlrev_b32 v178, 16, v123
v_and_b32 v179, 0xffff0000, v123
v_add_f32 v180, v176, v178
v_add_f32 v181, v177, v179
v_sub_f32 v176, v176, v178
v_sub_f32 v177, v177, v179
v_mul_f32 v122, v145, v176
v_mul_f32 v123, v145, v177
v_fma_f32 v145, v161, v176, v180
v_fma_f32 v161, v161, v177, v181
v_lshlrev_b32 v176, 16, v124
v_and_b32 v177, 0xffff0000, v124
v_lshlrev_b32 v178, 16, v125
v_and_b32 v179, 0xffff0000, v125
v_add_f32 v180, v176, v178
v_add_f32 v181, v177, v179
v_sub_f32 v176, v176, v178
v_sub_f32 v177, v177, v179
v_mul_f32 v124, v146, v176
v_mul_f32 v125, v146, v177
v_fma_f32 v146, v162, v176, v180
v_fma_f32 v162, v162, v177, v181
v_lshlrev_b32 v176, 16, v126
v_and_b32 v177, 0xffff0000, v126
v_lshlrev_b32 v178, 16, v127
v_and_b32 v179, 0xffff0000, v127
v_add_f32 v180, v176, v178
v_add_f32 v181, v177, v179
v_sub_f32 v176, v176, v178
v_sub_f32 v177, v177, v179
v_mul_f32 v126, v147, v176
v_mul_f32 v127, v147, v177
v_fma_f32 v147, v163, v176, v180
v_fma_f32 v163, v163, v177, v181
L_once24:
L_lc25:
ds_read_b128 v[186:189], v184
s_waitcnt lgkmcnt(0)
v_min3_u32 v186, v186, v187, v188
v_min_u32 v186, v186, v189
s_nop 0
v_readfirstlane_b32 s92, v186
s_nop 0
s_cmp_ge_u32 s92, 6
s_cbranch_scc1 L_lcd26
s_sleep 1
s_branch L_lc25
L_lcd26:
s_cmp_eq_u32 s61, 2
s_cbranch_scc1 L_nwr22
ds_write_b128 v16, v[40:43] offset:0
ds_write_b128 v16, v[44:47] offset:1024
ds_write_b128 v16, v[48:51] offset:2048
ds_write_b128 v16, v[52:55] offset:3072
ds_write_b128 v16, v[56:59] offset:4096
ds_write_b128 v16, v[60:63] offset:5120
ds_write_b128 v16, v[64:67] offset:6144
ds_write_b128 v16, v[68:71] offset:7168
s_cmp_eq_u32 s61, 0
s_cbranch_scc1 L_nwr22
s_mov_b32 s61, 2
s_mov_b32 s64, 0
s_branch L_fft21
L_nwr22:
v_lshlrev_b32 v176, 16, v128
v_and_b32 v177, 0xffff0000, v128
v_lshlrev_b32 v178, 16, v129
v_and_b32 v179, 0xffff0000, v129
v_add_f32 v180, v176, v178
v_add_f32 v181, v177, v179
v_sub_f32 v176, v176, v178
v_sub_f32 v177, v177, v179
v_mul_f32 v128, v148, v176
v_mul_f32 v129, v148, v177
v_fma_f32 v148, v164, v176, v180
v_fma_f32 v164, v164, v177, v181
v_lshlrev_b32 v176, 16, v130
v_and_b32 v177, 0xffff0000, v130
v_lshlrev_b32 v178, 16, v131
v_and_b32 v179, 0xffff0000, v131
v_add_f32 v180, v176, v178
v_add_f32 v181, v177, v179
v_sub_f32 v176, v176, v178
v_sub_f32 v177, v177, v179
v_mul_f32 v130, v149, v176
v_mul_f32 v131, v149, v177
v_fma_f32 v149, v165, v176, v180
v_fma_f32 v165, v165, v177, v181
s_waitcnt lgkmcnt(0)
v_mov_b32 v190, 7
s_mov_b64 exec, 1
ds_write_b32 v185, v190
s_mov_b64 exec, -1
v_lshlrev_b32 v176, 16, v132
v_and_b32 v177, 0xffff0000, v132
v_lshlrev_b32 v178, 16, v133
v_and_b32 v179, 0xffff0000, v133
v_add_f32 v180, v176, v178
v_add_f32 v181, v177, v179
v_sub_f32 v176, v176, v178
v_sub_f32 v177, v177, v179
v_mul_f32 v132, v150, v176
v_mul_f32 v133, v150, v177
v_fma_f32 v150, v166, v176, v180
v_fma_f32 v166, v166, v177, v181
v_lshlrev_b32 v176, 16, v134
v_and_b32 v177, 0xffff0000, v134
v_lshlrev_b32 v178, 16, v135
v_and_b32 v179, 0xffff0000, v135
v_add_f32 v180, v176, v178
v_add_f32 v181, v177, v179
v_sub_f32 v176, v176, v178
v_sub_f32 v177, v177, v179
v_mul_f32 v134, v151, v176
v_mul_f32 v135, v151, v177
v_fma_f32 v151, v167, v176, v180
v_fma_f32 v167, v167, v177, v181
v_mul_f32 v168, v152, v56
v_mul_f32 v56, v136, v56
v_fmac_f32 v56, v152, v40
v_fma_f32 v40, v136, v40, -v168
v_mul_f32 v169, v153, v57
v_mul_f32 v57, v137, v57
v_fmac_f32 v57, v153, v41
v_fma_f32 v41, v137, v41, -v169
v_mul_f32 v168, v154, v58
v_mul_f32 v58, v138, v58
v_fmac_f32 v58, v154, v42
v_fma_f32 v42, v138, v42, -v168
v_mul_f32 v169, v155, v59
v_mul_f32 v59, v139, v59
v_fmac_f32 v59, v155, v43
v_fma_f32 v43, v139, v43, -v169
v_mul_f32 v168, v156, v60
v_mul_f32 v60, v140, v60
v_fmac_f32 v60, v156, v44
v_fma_f32 v44, v140, v44, -v168
v_mul_f32 v169, v157, v61
v_mul_f32 v61, v141, v61
v_fmac_f32 v61, v157, v45
v_fma_f32 v45, v141, v45, -v169
L_lc27:
ds_read_b128 v[186:189], v184
s_waitcnt lgkmcnt(0)
v_min3_u32 v186, v186, v187, v188
v_min_u32 v186, v186, v189
s_nop 0
v_readfirstlane_b32 s92, v186
s_nop 0
s_cmp_ge_u32 s92, 7
s_cbranch_scc1 L_lcd28
s_sleep 1
s_branch L_lc27
L_lcd28:
ds_read_b128 v[72:75], v17 offset:0
ds_read_b128 v[76:79], v17 offset:1024
ds_read_b128 v[80:83], v17 offset:2048
ds_read_b128 v[84:87], v17 offset:3072
ds_read_b128 v[88:91], v17 offset:4096
ds_read_b128 v[92:95], v17 offset:5120
ds_read_b128 v[96:99], v17 offset:6144
ds_read_b128 v[100:103], v17 offset:7168
v_mul_f32 v168, v158, v62
v_mul_f32 v62, v142, v62
v_fmac_f32 v62, v158, v46
v_fma_f32 v46, v142, v46, -v168
v_mul_f32 v169, v159, v63
v_mul_f32 v63, v143, v63
v_fmac_f32 v63, v159, v47
v_fma_f32 v47, v143, v47, -v169
v_mul_f32 v168, v160, v64
v_mul_f32 v64, v144, v64
v_fmac_f32 v64, v160, v48
v_fma_f32 v48, v144, v48, -v168
v_mul_f32 v169, v161, v65
v_mul_f32 v65, v145, v65
v_fmac_f32 v65, v161, v49
v_fma_f32 v49, v145, v49, -v169
v_mul_f32 v168, v162, v66
v_mul_f32 v66, v146, v66
v_fmac_f32 v66, v162, v50
v_fma_f32 v50, v146, v50, -v168
v_mul_f32 v169, v163, v67
v_mul_f32 v67, v147, v67
v_fmac_f32 v67, v163, v51
v_fma_f32 v51, v147, v51, -v169
v_mul_f32 v168, v164, v68
v_mul_f32 v68, v148, v68
v_fmac_f32 v68, v164, v52
v_fma_f32 v52, v148, v52, -v168
v_mul_f32 v169, v165, v69
v_mul_f32 v69, v149, v69
v_fmac_f32 v69, v165, v53
v_fma_f32 v53, v149, v53, -v169
v_mul_f32 v168, v166, v70
v_mul_f32 v70, v150, v70
v_fmac_f32 v70, v166, v54
v_fma_f32 v54, v150, v54, -v168
v_mul_f32 v169, v167, v71
v_mul_f32 v71, v151, v71
v_fmac_f32 v71, v167, v55
v_fma_f32 v55, v151, v55, -v169
s_waitcnt lgkmcnt(0)
v_mov_b32 v190, 8
s_mov_b64 exec, 1
ds_write_b32 v185, v190
s_mov_b64 exec, -1
v_fma_f32 v40, -v104, v88, v40
v_fmac_f32 v56, v104, v72
v_fma_f32 v40, -v105, v72, v40
v_fma_f32 v56, -v105, v88, v56
v_cvt_pk_bf16_f32 v24, v56, v40
v_fma_f32 v41, -v106, v89, v41
v_fmac_f32 v57, v106, v73
v_fma_f32 v41, -v107, v73, v41
v_fma_f32 v57, -v107, v89, v57
v_cvt_pk_bf16_f32 v25, v57, v41
v_fma_f32 v42, -v108, v90, v42
v_fmac_f32 v58, v108, v74
v_fma_f32 v42, -v109, v74, v42
v_fma_f32 v58, -v109, v90, v58
v_cvt_pk_bf16_f32 v26, v58, v42
v_fma_f32 v43, -v110, v91, v43
v_fmac_f32 v59, v110, v75
v_fma_f32 v43, -v111, v75, v43
v_fma_f32 v59, -v111, v91, v59
v_cvt_pk_bf16_f32 v27, v59, v43
v_fma_f32 v44, -v112, v92, v44
v_fmac_f32 v60, v112, v76
v_fma_f32 v44, -v113, v76, v44
v_fma_f32 v60, -v113, v92, v60
v_cvt_pk_bf16_f32 v28, v60, v44
v_fma_f32 v45, -v114, v93, v45
v_fmac_f32 v61, v114, v77
v_fma_f32 v45, -v115, v77, v45
v_fma_f32 v61, -v115, v93, v61
v_cvt_pk_bf16_f32 v29, v61, v45
v_fma_f32 v46, -v116, v94, v46
v_fmac_f32 v62, v116, v78
v_fma_f32 v46, -v117, v78, v46
v_fma_f32 v62, -v117, v94, v62
v_cvt_pk_bf16_f32 v30, v62, v46
v_fma_f32 v47, -v118, v95, v47
v_fmac_f32 v63, v118, v79
v_fma_f32 v47, -v119, v79, v47
v_fma_f32 v63, -v119, v95, v63
v_cvt_pk_bf16_f32 v31, v63, v47
v_fma_f32 v48, -v120, v96, v48
v_fmac_f32 v64, v120, v80
v_fma_f32 v48, -v121, v80, v48
v_fma_f32 v64, -v121, v96, v64
v_cvt_pk_bf16_f32 v32, v64, v48
v_fma_f32 v49, -v122, v97, v49
v_fmac_f32 v65, v122, v81
v_fma_f32 v49, -v123, v81, v49
v_fma_f32 v65, -v123, v97, v65
v_cvt_pk_bf16_f32 v33, v65, v49
v_fma_f32 v50, -v124, v98, v50
v_fmac_f32 v66, v124, v82
v_fma_f32 v50, -v125, v82, v50
v_fma_f32 v66, -v125, v98, v66
v_cvt_pk_bf16_f32 v34, v66, v50
v_fma_f32 v51, -v126, v99, v51
v_fmac_f32 v67, v126, v83
v_fma_f32 v51, -v127, v83, v51
v_fma_f32 v67, -v127, v99, v67
v_cvt_pk_bf16_f32 v35, v67, v51
v_fma_f32 v52, -v128, v100, v52
v_fmac_f32 v68, v128, v84
v_fma_f32 v52, -v129, v84, v52
v_fma_f32 v68, -v129, v100, v68
v_cvt_pk_bf16_f32 v36, v68, v52
v_fma_f32 v53, -v130, v101, v53
v_fmac_f32 v69, v130, v85
v_fma_f32 v53, -v131, v85, v53
v_fma_f32 v69, -v131, v101, v69
v_cvt_pk_bf16_f32 v37, v69, v53
v_fma_f32 v54, -v132, v102, v54
v_fmac_f32 v70, v132, v86
v_fma_f32 v54, -v133, v86, v54
v_fma_f32 v70, -v133, v102, v70
v_cvt_pk_bf16_f32 v38, v70, v54
v_fma_f32 v55, -v134, v103, v55
v_fmac_f32 v71, v134, v87
v_fma_f32 v55, -v135, v87, v55
v_fma_f32 v71, -v135, v103, v71
v_cvt_pk_bf16_f32 v39, v71, v55
v_mfma_f32_32x32x16_bf16 v[40:55], v[24:27], v[192:195], 0
v_mfma_f32_32x32x16_bf16 v[40:55], v[28:31], v[196:199], v[40:55]
v_mfma_f32_32x32x16_bf16 v[40:55], v[32:35], v[200:203], v[40:55]
v_mfma_f32_32x32x16_bf16 v[40:55], v[36:39], v[204:207], v[40:55]
v_mfma_f32_32x32x16_bf16 v[56:71], v[24:27], v[208:211], 0
v_mfma_f32_32x32x16_bf16 v[56:71], v[28:31], v[212:215], v[56:71]
v_mfma_f32_32x32x16_bf16 v[56:71], v[32:35], v[216:219], v[56:71]
v_mfma_f32_32x32x16_bf16 v[56:71], v[36:39], v[220:223], v[56:71]
s_nop 7
v_mul_f32 v168, v40, v224
v_mul_f32 v169, v40, v240
s_nop 1
v_fma_f32 v168, -v56, v240, v168
v_fmac_f32 v169, v56, v224
v_cvt_pk_bf16_f32 v24, v168, v169
v_mul_f32 v170, v41, v225
v_mul_f32 v171, v41, v241
v_fma_f32 v170, -v57, v241, v170
v_fmac_f32 v171, v57, v225
v_cvt_pk_bf16_f32 v25, v170, v171
v_mul_f32 v172, v42, v226
v_mul_f32 v173, v42, v242
v_fma_f32 v172, -v58, v242, v172
v_fmac_f32 v173, v58, v226
v_cvt_pk_bf16_f32 v26, v172, v173
v_mul_f32 v174, v43, v227
v_mul_f32 v175, v43, v243
v_fma_f32 v174, -v59, v243, v174
v_fmac_f32 v175, v59, v227
v_cvt_pk_bf16_f32 v27, v174, v175
v_mul_f32 v168, v44, v228
v_mul_f32 v169, v44, v244
v_fma_f32 v168, -v60, v244, v168
v_fmac_f32 v169, v60, v228
v_cvt_pk_bf16_f32 v28, v168, v169
v_mul_f32 v170, v45, v229
v_mul_f32 v171, v45, v245
v_fma_f32 v170, -v61, v245, v170
v_fmac_f32 v171, v61, v229
v_cvt_pk_bf16_f32 v29, v170, v171
v_mul_f32 v172, v46, v230
v_mul_f32 v173, v46, v246
v_fma_f32 v172, -v62, v246, v172
v_fmac_f32 v173, v62, v230
v_cvt_pk_bf16_f32 v30, v172, v173
v_mul_f32 v174, v47, v231
v_mul_f32 v175, v47, v247
v_fma_f32 v174, -v63, v247, v174
v_fmac_f32 v175, v63, v231
v_cvt_pk_bf16_f32 v31, v174, v175
v_mul_f32 v168, v48, v232
v_mul_f32 v169, v48, v248
v_fma_f32 v168, -v64, v248, v168
v_fmac_f32 v169, v64, v232
v_cvt_pk_bf16_f32 v32, v168, v169
v_mul_f32 v170, v49, v233
v_mul_f32 v171, v49, v249
v_fma_f32 v170, -v65, v249, v170
v_fmac_f32 v171, v65, v233
v_cvt_pk_bf16_f32 v33, v170, v171
v_mul_f32 v172, v50, v234
v_mul_f32 v173, v50, v250
v_fma_f32 v172, -v66, v250, v172
v_fmac_f32 v173, v66, v234
v_cvt_pk_bf16_f32 v34, v172, v173
v_mul_f32 v174, v51, v235
v_mul_f32 v175, v51, v251
v_fma_f32 v174, -v67, v251, v174
v_fmac_f32 v175, v67, v235
v_cvt_pk_bf16_f32 v35, v174, v175
v_mul_f32 v168, v52, v236
v_mul_f32 v169, v52, v252
v_fma_f32 v168, -v68, v252, v168
v_fmac_f32 v169, v68, v236
v_cvt_pk_bf16_f32 v36, v168, v169
v_mul_f32 v170, v53, v237
v_mul_f32 v171, v53, v253
v_fma_f32 v170, -v69, v253, v170
v_fmac_f32 v171, v69, v237
v_cvt_pk_bf16_f32 v37, v170, v171
v_mul_f32 v172, v54, v238
v_mul_f32 v173, v54, v254
v_fma_f32 v172, -v70, v254, v172
v_fmac_f32 v173, v70, v238
v_cvt_pk_bf16_f32 v38, v172, v173
v_mul_f32 v174, v55, v239
v_mul_f32 v175, v55, v255
v_fma_f32 v174, -v71, v255, v174
v_fmac_f32 v175, v71, v239
v_cvt_pk_bf16_f32 v39, v174, v175
v_mfma_f32_32x32x16_bf16 v[40:55], v[192:195], v[24:27], 0
v_mfma_f32_32x32x16_bf16 v[40:55], v[196:199], v[28:31], v[40:55]
v_mfma_f32_32x32x16_bf16 v[40:55], v[200:203], v[32:35], v[40:55]
v_mfma_f32_32x32x16_bf16 v[40:55], v[204:207], v[36:39], v[40:55]
v_mfma_f32_32x32x16_bf16 v[56:71], v[208:211], v[24:27], 0
v_mfma_f32_32x32x16_bf16 v[56:71], v[212:215], v[28:31], v[56:71]
v_mfma_f32_32x32x16_bf16 v[56:71], v[216:219], v[32:35], v[56:71]
v_mfma_f32_32x32x16_bf16 v[56:71], v[220:223], v[36:39], v[56:71]
s_lshr_b32 s64, s62, 16
L_lc29:
ds_read_b128 v[186:189], v184
s_waitcnt lgkmcnt(0)
v_min3_u32 v186, v186, v187, v188
v_min_u32 v186, v186, v189
s_nop 0
v_readfirstlane_b32 s92, v186
s_nop 0
s_cmp_ge_u32 s92, 8
s_cbranch_scc1 L_lcd30
s_sleep 1
s_branch L_lc29
L_lcd30:
s_nop 1
v_cvt_pk_bf16_f32 v24, v40, v56
v_xor_b32 v24, s64, v24
v_cvt_pk_bf16_f32 v25, v41, v57
v_xor_b32 v25, s64, v25
v_cvt_pk_bf16_f32 v26, v42, v58
v_xor_b32 v26, s64, v26
v_cvt_pk_bf16_f32 v27, v43, v59
v_xor_b32 v27, s64, v27
ds_write_b128 v15, v[24:27] offset:0
v_cvt_pk_bf16_f32 v28, v44, v60
v_xor_b32 v28, s64, v28
v_cvt_pk_bf16_f32 v29, v45, v61
v_xor_b32 v29, s64, v29
v_cvt_pk_bf16_f32 v30, v46, v62
v_xor_b32 v30, s64, v30
v_cvt_pk_bf16_f32 v31, v47, v63
v_xor_b32 v31, s64, v31
ds_write_b128 v15, v[28:31] offset:4096
v_cvt_pk_bf16_f32 v32, v48, v64
v_xor_b32 v32, s64, v32
v_cvt_pk_bf16_f32 v33, v49, v65
v_xor_b32 v33, s64, v33
v_cvt_pk_bf16_f32 v34, v50, v66
v_xor_b32 v34, s64, v34
v_cvt_pk_bf16_f32 v35, v51, v67
v_xor_b32 v35, s64, v35
ds_write_b128 v15, v[32:35] offset:8192
v_cvt_pk_bf16_f32 v36, v52, v68
v_xor_b32 v36, s64, v36
v_cvt_pk_bf16_f32 v37, v53, v69
v_xor_b32 v37, s64, v37
v_cvt_pk_bf16_f32 v38, v54, v70
v_xor_b32 v38, s64, v38
v_cvt_pk_bf16_f32 v39, v55, v71
v_xor_b32 v39, s64, v39
ds_write_b128 v15, v[36:39] offset:12288
s_waitcnt lgkmcnt(0)
v_mov_b32 v190, 9
s_mov_b64 exec, 1
ds_write_b32 v185, v190
s_mov_b64 exec, -1
L_lc31:
ds_read_b128 v[186:189], v184
s_waitcnt lgkmcnt(0)
v_min3_u32 v186, v186, v187, v188
v_min_u32 v186, v186, v189
s_nop 0
v_readfirstlane_b32 s92, v186
s_nop 0
s_cmp_ge_u32 s92, 9
s_cbranch_scc1 L_lcd32
s_sleep 1
s_branch L_lc31
L_lcd32:
ds_read_b128 v[24:27], v18 offset:0
ds_read_b128 v[28:31], v18 offset:1024
ds_read_b128 v[32:35], v18 offset:2048
ds_read_b128 v[36:39], v18 offset:3072
s_mov_b32 s64, 0
s_waitcnt lgkmcnt(3)
buffer_store_dwordx4 v[24:27], v14, s[56:59], s64 offen sc1
s_mov_b32 s64, 262144
s_waitcnt lgkmcnt(2)
buffer_store_dwordx4 v[28:31], v14, s[56:59], s64 offen sc1
s_mov_b32 s64, 524288
s_waitcnt lgkmcnt(1)
buffer_store_dwordx4 v[32:35], v14, s[56:59], s64 offen sc1
s_mov_b32 s64, 786432
s_waitcnt lgkmcnt(0)
buffer_store_dwordx4 v[36:39], v14, s[56:59], s64 offen sc1
s_lshl_b32 s64, s67, 14
s_add_u32 s40, s28, s64
s_addc_u32 s41, s29, 0
s_mov_b32 s42, 16384
s_mov_b32 s43, 0x20000
v_and_b32 v8, 31, v1
v_lshrrev_b32 v9, 5, v1
v_lshlrev_b32 v14, 2, v8
v_lshl_add_u32 v14, v9, 9, v14
s_mov_b32 s64, 0x35000000
v_mul_f32 v224, s64, v224
v_mul_f32 v225, s64, v225
v_mul_f32 v226, s64, v226
v_mul_f32 v227, s64, v227
v_mul_f32 v228, s64, v228
v_mul_f32 v229, s64, v229
v_mul_f32 v230, s64, v230
v_mul_f32 v231, s64, v231
v_mul_f32 v232, s64, v232
v_mul_f32 v233, s64, v233
v_mul_f32 v234, s64, v234
v_mul_f32 v235, s64, v235
v_mul_f32 v236, s64, v236
v_mul_f32 v237, s64, v237
v_mul_f32 v238, s64, v238
v_mul_f32 v239, s64, v239
v_mul_f32 v240, s64, v240
v_mul_f32 v241, s64, v241
v_mul_f32 v242, s64, v242
v_mul_f32 v243, s64, v243
v_mul_f32 v244, s64, v244
v_mul_f32 v245, s64, v245
v_mul_f32 v246, s64, v246
v_mul_f32 v247, s64, v247
v_mul_f32 v248, s64, v248
v_mul_f32 v249, s64, v249
v_mul_f32 v250, s64, v250
v_mul_f32 v251, s64, v251
v_mul_f32 v252, s64, v252
v_mul_f32 v253, s64, v253
v_mul_f32 v254, s64, v254
v_mul_f32 v255, s64, v255
s_waitcnt vmcnt(0)
v_mov_b32 v190, 10
s_mov_b64 exec, 1
ds_write_b32 v185, v190
s_mov_b64 exec, -1
s_cmp_lg_u32 s66, 0
s_cbranch_scc1 L_ph33
L_lc34:
ds_read_b128 v[186:189], v184
s_waitcnt lgkmcnt(0)
v_min3_u32 v186, v186, v187, v188
v_min_u32 v186, v186, v189
s_nop 0
v_readfirstlane_b32 s92, v186
s_nop 0
s_cmp_ge_u32 s92, 10
s_cbranch_scc1 L_lcd35
s_sleep 1
s_branch L_lc34
L_lcd35:
s_and_b32 s64, s2, 15
s_lshl_b32 s65, s64, 7
s_add_u32 s65, s65, 6144
s_add_u32 s90, s32, s65
s_addc_u32 s91, s33, 0
s_mov_b32 s65, 1
s_atomic_add s65, s[90:91], 0x0 glc
s_lshl_b32 s64, s64, 2
s_add_u32 s64, s64, 548864
v_lshl_add_u32 v20, v1, 7, s64
v_mov_b32 v21, s37
s_add_u32 s4, s32, s64
s_addc_u32 s5, s33, 0
s_and_b32 s64, s2, 31
s_lshl_b32 s64, s64, 7
s_add_u32 s64, s64, 548864
s_waitcnt lgkmcnt(0)
s_cmp_lg_u32 s65, 15
s_cbranch_scc1 L_sg36
s_atomic_swap s37, s[4:5], 0x0
s_atomic_swap s37, s[4:5], 0x80
s_atomic_swap s37, s[4:5], 0x100
s_atomic_swap s37, s[4:5], 0x180
s_atomic_swap s37, s[4:5], 0x200
s_atomic_swap s37, s[4:5], 0x280
s_atomic_swap s37, s[4:5], 0x300
s_atomic_swap s37, s[4:5], 0x380
s_atomic_swap s37, s[4:5], 0x400
s_atomic_swap s37, s[4:5], 0x480
s_atomic_swap s37, s[4:5], 0x500
s_atomic_swap s37, s[4:5], 0x580
s_atomic_swap s37, s[4:5], 0x600
s_atomic_swap s37, s[4:5], 0x680
s_atomic_swap s37, s[4:5], 0x700
s_atomic_swap s37, s[4:5], 0x780
s_atomic_swap s37, s[4:5], 0x800
s_atomic_swap s37, s[4:5], 0x880
s_atomic_swap s37, s[4:5], 0x900
s_atomic_swap s37, s[4:5], 0x980
s_atomic_swap s37, s[4:5], 0xa00
s_atomic_swap s37, s[4:5], 0xa80
s_atomic_swap s37, s[4:5], 0xb00
s_atomic_swap s37, s[4:5], 0xb80
s_atomic_swap s37, s[4:5], 0xc00
s_atomic_swap s37, s[4:5], 0xc80
s_atomic_swap s37, s[4:5], 0xd00
s_atomic_swap s37, s[4:5], 0xd80
s_atomic_swap s37, s[4:5], 0xe00
s_atomic_swap s37, s[4:5], 0xe80
s_atomic_swap s37, s[4:5], 0xf00
s_atomic_swap s37, s[4:5], 0xf80
s_waitcnt lgkmcnt(0)
L_sg36:
s_add_u32 s90, s32, s64
s_addc_u32 s91, s33, 0
s_mov_b32 s64, s37
s_mov_b32 s65, s37
s_mov_b32 s92, 0
s_branch L_sp37
L_nok38:
s_add_u32 s92, s92, 1
s_cmp_ge_u32 s92, 200000
s_cbranch_scc1 L_ph33
s_sleep 10
L_sp37:
s_load_dwordx16 s[4:19], s[90:91], 0x0 glc
s_waitcnt lgkmcnt(0)
s_cmp_eq_u64 s[4:5], s[64:65]
s_cbranch_scc0 L_nok38
s_cmp_eq_u64 s[6:7], s[64:65]
s_cbranch_scc0 L_nok38
s_cmp_eq_u64 s[8:9], s[64:65]
s_cbranch_scc0 L_nok38
s_cmp_eq_u64 s[10:11], s[64:65]
s_cbranch_scc0 L_nok38
s_cmp_eq_u64 s[12:13], s[64:65]
s_cbranch_scc0 L_nok38
s_cmp_eq_u64 s[14:15], s[64:65]
s_cbranch_scc0 L_nok38
s_cmp_eq_u64 s[16:17], s[64:65]
s_cbranch_scc0 L_nok38
s_cmp_eq_u64 s[18:19], s[64:65]
s_cbranch_scc0 L_nok38
L_ph33:
v_mov_b32 v190, 11
s_mov_b64 exec, 1
ds_write_b32 v185, v190
s_mov_b64 exec, -1
L_lc39:
ds_read_b128 v[186:189], v184
s_waitcnt lgkmcnt(0)
v_min3_u32 v186, v186, v187, v188
v_min_u32 v186, v186, v189
s_nop 0
v_readfirstlane_b32 s92, v186
s_nop 0
s_cmp_ge_u32 s92, 11
s_cbranch_scc1 L_lcd40
s_sleep 1
s_branch L_lc39
L_lcd40:
s_setprio 3
s_mov_b32 m0, s68
s_nop 0
buffer_load_dwordx4 v7, s[44:47], 0 offen offset:0 sc1 lds
buffer_load_dwordx4 v7, s[44:47], 0 offen offset:1024 sc1 lds
buffer_load_dwordx4 v7, s[44:47], 0 offen offset:2048 sc1 lds
buffer_load_dwordx4 v7, s[44:47], 0 offen offset:3072 sc1 lds
s_waitcnt vmcnt(0)
v_mov_b32 v190, 12
s_mov_b64 exec, 1
ds_write_b32 v185, v190
s_mov_b64 exec, -1
L_lc41:
ds_read_b128 v[186:189], v184
s_waitcnt lgkmcnt(0)
v_min3_u32 v186, v186, v187, v188
v_min_u32 v186, v186, v189
s_nop 0
v_readfirstlane_b32 s92, v186
s_nop 0
s_cmp_ge_u32 s92, 12
s_cbranch_scc1 L_lcd42
s_sleep 1
s_branch L_lc41
L_lcd42:
ds_read_b32 v24, v4 offset:0
ds_read_b32 v25, v4 offset:1024
ds_read_b32 v26, v4 offset:2048
ds_read_b32 v27, v4 offset:3072
ds_read_b32 v28, v4 offset:8192
ds_read_b32 v29, v4 offset:9216
ds_read_b32 v30, v4 offset:10240
ds_read_b32 v31, v4 offset:11264
ds_read_b32 v32, v6 offset:0
ds_read_b32 v33, v5 offset:10240
ds_read_b32 v34, v5 offset:9216
ds_read_b32 v35, v5 offset:8192
ds_read_b32 v36, v5 offset:3072
ds_read_b32 v37, v5 offset:2048
ds_read_b32 v38, v5 offset:1024
ds_read_b32 v39, v5 offset:0
s_waitcnt lgkmcnt(0)
v_mfma_f32_32x32x16_bf16 v[40:55], v[24:27], v[192:195], 0
v_mfma_f32_32x32x16_bf16 v[40:55], v[28:31], v[196:199], v[40:55]
v_mfma_f32_32x32x16_bf16 v[40:55], v[32:35], v[200:203], v[40:55]
v_mfma_f32_32x32x16_bf16 v[40:55], v[36:39], v[204:207], v[40:55]
v_mfma_f32_32x32x16_bf16 v[56:71], v[24:27], v[208:211], 0
v_mfma_f32_32x32x16_bf16 v[56:71], v[28:31], v[212:215], v[56:71]
v_mfma_f32_32x32x16_bf16 v[56:71], v[32:35], v[216:219], v[56:71]
v_mfma_f32_32x32x16_bf16 v[56:71], v[36:39], v[220:223], v[56:71]
s_nop 7
v_mul_f32 v168, v40, v224
v_mul_f32 v169, v40, v240
s_nop 1
v_fma_f32 v168, -v56, v240, v168
v_fmac_f32 v169, v56, v224
v_cvt_pk_bf16_f32 v24, v168, v169
v_mul_f32 v170, v41, v225
v_mul_f32 v171, v41, v241
v_fma_f32 v170, -v57, v241, v170
v_fmac_f32 v171, v57, v225
v_cvt_pk_bf16_f32 v25, v170, v171
v_mul_f32 v172, v42, v226
v_mul_f32 v173, v42, v242
v_fma_f32 v172, -v58, v242, v172
v_fmac_f32 v173, v58, v226
v_cvt_pk_bf16_f32 v26, v172, v173
v_mul_f32 v174, v43, v227
v_mul_f32 v175, v43, v243
v_fma_f32 v174, -v59, v243, v174
v_fmac_f32 v175, v59, v227
v_cvt_pk_bf16_f32 v27, v174, v175
v_mul_f32 v168, v44, v228
v_mul_f32 v169, v44, v244
v_fma_f32 v168, -v60, v244, v168
v_fmac_f32 v169, v60, v228
v_cvt_pk_bf16_f32 v28, v168, v169
v_mul_f32 v170, v45, v229
v_mul_f32 v171, v45, v245
v_fma_f32 v170, -v61, v245, v170
v_fmac_f32 v171, v61, v229
v_cvt_pk_bf16_f32 v29, v170, v171
v_mul_f32 v172, v46, v230
v_mul_f32 v173, v46, v246
v_fma_f32 v172, -v62, v246, v172
v_fmac_f32 v173, v62, v230
v_cvt_pk_bf16_f32 v30, v172, v173
v_mul_f32 v174, v47, v231
v_mul_f32 v175, v47, v247
v_fma_f32 v174, -v63, v247, v174
v_fmac_f32 v175, v63, v231
v_cvt_pk_bf16_f32 v31, v174, v175
v_mul_f32 v168, v48, v232
v_mul_f32 v169, v48, v248
v_fma_f32 v168, -v64, v248, v168
v_fmac_f32 v169, v64, v232
v_cvt_pk_bf16_f32 v32, v168, v169
v_mul_f32 v170, v49, v233
v_mul_f32 v171, v49, v249
v_fma_f32 v170, -v65, v249, v170
v_fmac_f32 v171, v65, v233
v_cvt_pk_bf16_f32 v33, v170, v171
v_mul_f32 v172, v50, v234
v_mul_f32 v173, v50, v250
v_fma_f32 v172, -v66, v250, v172
v_fmac_f32 v173, v66, v234
v_cvt_pk_bf16_f32 v34, v172, v173
v_mul_f32 v174, v51, v235
v_mul_f32 v175, v51, v251
v_fma_f32 v174, -v67, v251, v174
v_fmac_f32 v175, v67, v235
v_cvt_pk_bf16_f32 v35, v174, v175
v_mul_f32 v168, v52, v236
v_mul_f32 v169, v52, v252
v_fma_f32 v168, -v68, v252, v168
v_fmac_f32 v169, v68, v236
v_cvt_pk_bf16_f32 v36, v168, v169
v_mul_f32 v170, v53, v237
v_mul_f32 v171, v53, v253
v_fma_f32 v170, -v69, v253, v170
v_fmac_f32 v171, v69, v237
v_cvt_pk_bf16_f32 v37, v170, v171
v_mul_f32 v172, v54, v238
v_mul_f32 v173, v54, v254
v_fma_f32 v172, -v70, v254, v172
v_fmac_f32 v173, v70, v238
v_cvt_pk_bf16_f32 v38, v172, v173
v_mul_f32 v174, v55, v239
v_mul_f32 v175, v55, v255
v_fma_f32 v174, -v71, v255, v174
v_fmac_f32 v175, v71, v239
v_cvt_pk_bf16_f32 v39, v174, v175
v_mfma_f32_32x32x16_bf16 v[40:55], v[192:195], v[24:27], 0
v_mfma_f32_32x32x16_bf16 v[40:55], v[196:199], v[28:31], v[40:55]
v_mfma_f32_32x32x16_bf16 v[40:55], v[200:203], v[32:35], v[40:55]
v_mfma_f32_32x32x16_bf16 v[40:55], v[204:207], v[36:39], v[40:55]
v_mfma_f32_32x32x16_bf16 v[56:71], v[208:211], v[24:27], 0
v_mfma_f32_32x32x16_bf16 v[56:71], v[212:215], v[28:31], v[56:71]
v_mfma_f32_32x32x16_bf16 v[56:71], v[216:219], v[32:35], v[56:71]
v_mfma_f32_32x32x16_bf16 v[56:71], v[220:223], v[36:39], v[56:71]
s_movk_i32 s64, 0x2000
s_nop 10
v_cvt_pk_bf16_f32 v73, v56, v40
v_lshlrev_b32 v72, 16, v73
v_and_b32 v73, 0xffff0000, v73
buffer_store_dword v72, v14, s[40:43], 0 offen offset:0 nt
buffer_store_dword v73, v14, s[40:43], s64 offen offset:0 nt
v_cvt_pk_bf16_f32 v75, v57, v41
v_lshlrev_b32 v74, 16, v75
v_and_b32 v75, 0xffff0000, v75
buffer_store_dword v74, v14, s[40:43], 0 offen offset:128 nt
buffer_store_dword v75, v14, s[40:43], s64 offen offset:128 nt
v_cvt_pk_bf16_f32 v77, v58, v42
v_lshlrev_b32 v76, 16, v77
v_and_b32 v77, 0xffff0000, v77
buffer_store_dword v76, v14, s[40:43], 0 offen offset:256 nt
buffer_store_dword v77, v14, s[40:43], s64 offen offset:256 nt
v_cvt_pk_bf16_f32 v79, v59, v43
v_lshlrev_b32 v78, 16, v79
v_and_b32 v79, 0xffff0000, v79
buffer_store_dword v78, v14, s[40:43], 0 offen offset:384 nt
buffer_store_dword v79, v14, s[40:43], s64 offen offset:384 nt
v_cvt_pk_bf16_f32 v81, v60, v44
v_lshlrev_b32 v80, 16, v81
v_and_b32 v81, 0xffff0000, v81
buffer_store_dword v80, v14, s[40:43], 0 offen offset:1024 nt
buffer_store_dword v81, v14, s[40:43], s64 offen offset:1024 nt
v_cvt_pk_bf16_f32 v83, v61, v45
v_lshlrev_b32 v82, 16, v83
v_and_b32 v83, 0xffff0000, v83
buffer_store_dword v82, v14, s[40:43], 0 offen offset:1152 nt
buffer_store_dword v83, v14, s[40:43], s64 offen offset:1152 nt
v_cvt_pk_bf16_f32 v85, v62, v46
v_lshlrev_b32 v84, 16, v85
v_and_b32 v85, 0xffff0000, v85
buffer_store_dword v84, v14, s[40:43], 0 offen offset:1280 nt
buffer_store_dword v85, v14, s[40:43], s64 offen offset:1280 nt
v_cvt_pk_bf16_f32 v87, v63, v47
v_lshlrev_b32 v86, 16, v87
v_and_b32 v87, 0xffff0000, v87
buffer_store_dword v86, v14, s[40:43], 0 offen offset:1408 nt
buffer_store_dword v87, v14, s[40:43], s64 offen offset:1408 nt
v_cvt_pk_bf16_f32 v89, v64, v48
v_lshlrev_b32 v88, 16, v89
v_and_b32 v89, 0xffff0000, v89
buffer_store_dword v88, v14, s[40:43], 0 offen offset:2048 nt
buffer_store_dword v89, v14, s[40:43], s64 offen offset:2048 nt
v_cvt_pk_bf16_f32 v91, v65, v49
v_lshlrev_b32 v90, 16, v91
v_and_b32 v91, 0xffff0000, v91
buffer_store_dword v90, v14, s[40:43], 0 offen offset:2176 nt
buffer_store_dword v91, v14, s[40:43], s64 offen offset:2176 nt
v_cvt_pk_bf16_f32 v93, v66, v50
v_lshlrev_b32 v92, 16, v93
v_and_b32 v93, 0xffff0000, v93
buffer_store_dword v92, v14, s[40:43], 0 offen offset:2304 nt
buffer_store_dword v93, v14, s[40:43], s64 offen offset:2304 nt
v_cvt_pk_bf16_f32 v95, v67, v51
v_lshlrev_b32 v94, 16, v95
v_and_b32 v95, 0xffff0000, v95
buffer_store_dword v94, v14, s[40:43], 0 offen offset:2432 nt
buffer_store_dword v95, v14, s[40:43], s64 offen offset:2432 nt
v_cvt_pk_bf16_f32 v97, v68, v52
v_lshlrev_b32 v96, 16, v97
v_and_b32 v97, 0xffff0000, v97
buffer_store_dword v96, v14, s[40:43], 0 offen offset:3072 nt
buffer_store_dword v97, v14, s[40:43], s64 offen offset:3072 nt
v_cvt_pk_bf16_f32 v99, v69, v53
v_lshlrev_b32 v98, 16, v99
v_and_b32 v99, 0xffff0000, v99
buffer_store_dword v98, v14, s[40:43], 0 offen offset:3200 nt
buffer_store_dword v99, v14, s[40:43], s64 offen offset:3200 nt
v_cvt_pk_bf16_f32 v101, v70, v54
v_lshlrev_b32 v100, 16, v101
v_and_b32 v101, 0xffff0000, v101
buffer_store_dword v100, v14, s[40:43], 0 offen offset:3328 nt
buffer_store_dword v101, v14, s[40:43], s64 offen offset:3328 nt
v_cvt_pk_bf16_f32 v103, v71, v55
v_lshlrev_b32 v102, 16, v103
v_and_b32 v103, 0xffff0000, v103
buffer_store_dword v102, v14, s[40:43], 0 offen offset:3456 nt
buffer_store_dword v103, v14, s[40:43], s64 offen offset:3456 nt
s_endpgm
L_concat_heads__spectral_gfnet__ssm_conv_s5__prompt_kernel_gemm:
s_lshr_b32 s68, s34, 1
s_and_b32 s66, s34, 1
s_lshr_b32 s101, s36, 3
v_and_b32 v6, 31, v1
v_lshrrev_b32 v5, 5, v1
v_lshlrev_b32 v11, 4, v1
v_bfe_u32 v4, v1, 2, 2
v_lshlrev_b32 v4, 3, v4
v_and_b32 v7, 3, v1
v_add_u32 v4, v4, v7
s_lshl_b32 s60, s36, 6
s_lshl_b32 s61, s66, 5
s_add_u32 s60, s60, s61
v_add_u32 v4, s60, v4
v_lshlrev_b32 v7, 1, v4
s_waitcnt lgkmcnt(0)
global_load_ushort v240, v7, s[12:13] offset:0
global_load_ushort v241, v7, s[14:15] offset:0
global_load_ushort v242, v7, s[24:25] offset:0
global_load_ushort v243, v7, s[12:13] offset:8
global_load_ushort v244, v7, s[14:15] offset:8
global_load_ushort v245, v7, s[24:25] offset:8
v_bfe_u32 v7, v1, 4, 1
v_lshl_add_u32 v4, v7, 2, v4
s_lshl_b32 s60, s2, 3
s_add_u32 s60, s60, s34
s_cmp_lg_u32 s60, 1
s_cbranch_scc1 L_nn43
s_load_dword s60, s[32:33], 0
v_mov_b32 v16, 0
v_lshlrev_b32 v17, 7, v1
v_add_u32 v17, 4096, v17
global_store_dword v17, v16, s[32:33] sc1
s_waitcnt vmcnt(0) lgkmcnt(0)
s_add_u32 s60, s60, 1
s_cmp_eq_u32 s60, 0
s_cselect_b32 s60, 1, s60
v_mov_b32 v17, s60
s_mov_b64 exec, 1
global_store_dword v16, v17, s[30:31] sc1
global_store_dword v16, v17, s[32:33] offset:0
s_mov_b64 exec, -1
L_nn43:
s_cmp_lg_u32 s34, 0
s_cbranch_scc1 L_pf44
s_lshr_b32 s60, s2, 3
s_lshl_b32 s60, s60, 11
v_and_b32 v12, 15, v1
v_lshl_add_u32 v12, v12, 7, s60
v_min_u32 v12, L_concat_heads__spectral_gfnet__ssm_conv_s5__prompt_kernel_end-concat_heads__spectral_gfnet__ssm_conv_s5__prompt_kernel, v12
s_getpc_b64 s[60:61]
L_pc45:
s_sub_u32 s60, s60, L_pc45-concat_heads__spectral_gfnet__ssm_conv_s5__prompt_kernel
s_subb_u32 s61, s61, 0
global_load_dword v247, v12, s[60:61]
L_pf44:
v_bfe_u32 v7, v6, 1, 3
v_xor_b32 v7, v7, v5
v_lshlrev_b32 v7, 4, v7
v_lshl_add_u32 v7, v6, 7, v7
v_and_b32 v8, 15, v1
v_lshrrev_b32 v9, 4, v1
v_lshrrev_b32 v12, 1, v8
v_xor_b32 v12, v12, v9
v_lshlrev_b32 v12, 4, v12
v_lshl_add_u32 v12, v8, 7, v12
s_lshl_b32 s60, s68, 13
s_lshl_b32 s61, s66, 13
s_add_u32 s61, s61, 16384
v_xor_b32 v13, 0, v12
v_add_u32 v128, s60, v13
v_add_u32 v130, s61, v13
v_add_u32 v132, 0x10000, v128
v_add_u32 v134, 0x10000, v130
v_xor_b32 v13, 64, v12
v_add_u32 v129, s60, v13
v_add_u32 v131, s61, v13
v_add_u32 v133, 0x10000, v129
v_add_u32 v135, 0x10000, v131
v_mov_b64 v[64:65], 0
v_mov_b64 v[66:67], 0
s_mul_i32 s60, s34, 2304
s_add_u32 s60, s60, 114688
v_add_u32 v13, s60, v11
v_mov_b32 v12, 126976
ds_write_b128 v13, v[64:67]
ds_write_b128 v13, v[64:67] offset:1024
ds_write_b128 v13, v[64:67] offset:2048
s_mov_b64 exec, 1
ds_write_b128 v12, v[64:67]
ds_write_b128 v12, v[64:67] offset:16
s_mov_b64 exec, -1
s_lshl_b32 s60, s34, 2
v_add_u32 v13, s60, v12
v_lshlrev_b32 v14, 2, v9
v_sub_u32 v14, v8, v14
v_mov_b32 v15, 0x3f80
v_mov_b32 v16, 1.0
v_cmp_eq_u32 vcc, 0, v14
s_nop 1
v_cndmask_b32 v248, 0, v15, vcc
v_cndmask_b32 v252, 0, v16, vcc
v_cmp_eq_u32 vcc, 1, v14
s_nop 1
v_cndmask_b32 v249, 0, v15, vcc
v_cndmask_b32 v253, 0, v16, vcc
v_cmp_eq_u32 vcc, 2, v14
s_nop 1
v_cndmask_b32 v250, 0, v15, vcc
v_cndmask_b32 v254, 0, v16, vcc
v_cmp_eq_u32 vcc, 3, v14
s_nop 1
v_cndmask_b32 v251, 0, v15, vcc
v_cndmask_b32 v255, 0, v16, vcc
s_add_u32 s40, s32, 65536
s_addc_u32 s41, s33, 0
s_mov_b32 s42, 262144
s_mov_b32 s43, 0x20000
s_add_u32 s44, s32, 1048576
s_addc_u32 s45, s33, 0
s_mov_b32 s46, 8388608
s_mov_b32 s47, 0x20000
s_mul_i32 s60, s66, 4608
s_add_u32 s60, s60, 114752
s_lshl_b32 s61, s68, 5
s_add_u32 s61, s61, s60
v_mul_u32_u24 v14, 144, v6
v_add_u32 v14, s60, v14
v_lshl_add_u32 v14, v5, 5, v14
v_mul_u32_u24 v15, 144, v8
v_add_u32 v15, s61, v15
v_lshl_add_u32 v15, v9, 3, v15
s_lshl_b32 s60, s35, 14
v_lshl_add_u32 v16, v4, 4, s60
v_mov_b32 v17, 0x40000000
v_lshlrev_b32 v10, 14, v5
v_sub_u32 v10, v16, v10
v_subrev_u32 v136, 16384, v10
v_cmp_le_i32 vcc, 0, v136
s_nop 1
v_cndmask_b32 v136, v17, v136, vcc
v_subrev_u32 v137, 49152, v10
v_cmp_le_i32 vcc, 0, v137
s_nop 1
v_cndmask_b32 v137, v17, v137, vcc
v_subrev_u32 v138, 81920, v10
v_cmp_le_i32 vcc, 0, v138
s_nop 1
v_cndmask_b32 v138, v17, v138, vcc
v_subrev_u32 v139, 114688, v10
v_cmp_le_i32 vcc, 0, v139
s_nop 1
v_cndmask_b32 v139, v17, v139, vcc
v_subrev_u32 v140, 147456, v10
v_cmp_le_i32 vcc, 0, v140
s_nop 1
v_cndmask_b32 v140, v17, v140, vcc
v_subrev_u32 v141, 180224, v10
v_cmp_le_i32 vcc, 0, v141
s_nop 1
v_cndmask_b32 v141, v17, v141, vcc
v_subrev_u32 v142, 212992, v10
v_cmp_le_i32 vcc, 0, v142
s_nop 1
v_cndmask_b32 v142, v17, v142, vcc
v_subrev_u32 v143, 245760, v10
v_cmp_le_i32 vcc, 0, v143
s_nop 1
v_cndmask_b32 v143, v17, v143, vcc
v_lshlrev_b32 v17, 30, v5
v_or_b32 v16, v16, v17
s_lshl_b32 s60, s35, 11
s_add_u32 s60, s60, 32768
s_lshl_b32 s61, s36, 7
s_add_u32 s61, s61, s60
v_mov_b32 v195, s61
s_lshl_b32 s61, s101, 10
s_add_u32 s60, s60, s61
v_and_b32 v196, 7, v1
v_lshl_add_u32 v196, v196, 7, s60
s_lshl_b32 s60, s35, 1
s_add_u32 s60, s60, s68
s_lshl_b32 s60, s60, 12
s_add_u32 s60, s60, 393216
s_lshl_b32 s61, s101, 11
s_add_u32 s61, s61, s60
v_lshl_add_u32 v18, v8, 7, s61
s_lshl_b32 s61, s36, 8
s_add_u32 s60, s60, s61
s_lshl_b32 s61, s66, 7
s_add_u32 s60, s60, s61
v_mov_b32 v19, s60
v_lshrrev_b32 v10, 1, v9
v_lshlrev_b32 v10, 10, v10
v_and_b32 v17, 1, v9
v_lshl_add_u32 v10, v17, 9, v10
v_lshl_add_u32 v10, v8, 4, v10
s_lshl_b32 s60, s68, 2
v_add_u32 v9, s60, v9
v_cvt_f32_u32 v9, v9
v_mul_f32 v9, 0x41800000, v9
v_add_f32 v8, 0x41000000, v9
s_waitcnt vmcnt(0)
v_lshlrev_b32 v240, 16, v240
v_lshlrev_b32 v241, 16, v241
v_lshlrev_b32 v242, 16, v242
v_mul_f32 v242, 0x3fb8aa3b, v242
v_exp_f32 v242, v242
s_nop 0
v_cvt_pk_bf16_f32 v242, v242, v242
v_lshlrev_b32 v242, 16, v242
v_mul_f32 v204, v242, v240
v_mul_f32 v206, v242, v241
v_mul_f32 v204, 0x3fb8aa3b, v204
v_mul_f32 v206, 0.15915494, v206
v_mul_f32 v197, 0x3f800000, v204
v_mul_f32 v198, 0x3f800000, v206
v_exp_f32 v197, v197
v_rndne_f32 v199, v198
v_sub_f32 v198, v198, v199
v_cos_f32 v199, v198
v_sin_f32 v198, v198
v_mul_f32 v20, v197, v199
v_mul_f32 v21, v197, v198
v_add_f32 v197, -1.0, v20
v_mul_f32 v198, v240, v240
v_fma_f32 v198, v241, v241, v198
v_rcp_f32 v198, v198
s_nop 0
v_add_f32 v198, v198, v198
v_mul_f32 v199, v197, v240
v_fma_f32 v199, v21, v241, v199
v_mul_f32 v24, v199, v198
v_mul_f32 v199, v21, v240
v_fma_f32 v199, -v197, v241, v199
v_mul_f32 v25, v199, v198
v_mul_f32 v197, 0x41000000, v204
v_mul_f32 v198, 0x41000000, v206
v_exp_f32 v197, v197
v_rndne_f32 v199, v198
v_sub_f32 v198, v198, v199
v_cos_f32 v199, v198
v_sin_f32 v198, v198
v_mul_f32 v176, v197, v199
v_mul_f32 v177, v197, v198
v_mul_f32 v197, 0x41800000, v204
v_mul_f32 v198, 0x41800000, v206
v_exp_f32 v197, v197
v_rndne_f32 v199, v198
v_sub_f32 v198, v198, v199
v_cos_f32 v199, v198
v_sin_f32 v198, v198
v_mul_f32 v180, v197, v199
v_mul_f32 v181, v197, v198
v_mul_f32 v197, v9, v204
v_mul_f32 v198, v9, v206
v_exp_f32 v197, v197
v_rndne_f32 v199, v198
v_sub_f32 v198, v198, v199
v_cos_f32 v199, v198
v_sin_f32 v198, v198
v_mul_f32 v200, v197, v199
v_mul_f32 v201, v197, v198
v_mov_b32 v184, v200
v_mov_b32 v186, v201
v_mul_f32 v197, v8, v204
v_mul_f32 v198, v8, v206
v_exp_f32 v197, v197
v_rndne_f32 v199, v198
v_sub_f32 v198, v198, v199
v_cos_f32 v199, v198
v_sin_f32 v198, v198
v_mul_f32 v200, v197, v199
v_mul_f32 v201, v197, v198
v_mov_b32 v185, v200
v_mov_b32 v187, v201
v_mul_f32 v197, v25, v21
v_mul_f32 v198, v25, v20
v_fma_f32 v208, v24, v20, -v197
v_fma_f32 v209, v24, v21, v198
v_mul_f32 v197, v209, v21
v_mul_f32 v198, v209, v20
v_fma_f32 v210, v208, v20, -v197
v_fma_f32 v211, v208, v21, v198
v_mul_f32 v197, v211, v21
v_mul_f32 v198, v211, v20
v_fma_f32 v212, v210, v20, -v197
v_fma_f32 v213, v210, v21, v198
v_mul_f32 v197, v213, v21
v_mul_f32 v198, v213, v20
v_fma_f32 v214, v212, v20, -v197
v_fma_f32 v215, v212, v21, v198
v_mul_f32 v197, v215, v21
v_mul_f32 v198, v215, v20
v_fma_f32 v216, v214, v20, -v197
v_fma_f32 v217, v214, v21, v198
v_mul_f32 v197, v217, v21
v_mul_f32 v198, v217, v20
v_fma_f32 v218, v216, v20, -v197
v_fma_f32 v219, v216, v21, v198
v_mul_f32 v197, v219, v21
v_mul_f32 v198, v219, v20
v_fma_f32 v220, v218, v20, -v197
v_fma_f32 v221, v218, v21, v198
v_mul_f32 v197, v221, v21
v_mul_f32 v198, v221, v20
v_fma_f32 v222, v220, v20, -v197
v_fma_f32 v223, v220, v21, v198
v_lshlrev_b32 v243, 16, v243
v_lshlrev_b32 v244, 16, v244
v_lshlrev_b32 v245, 16, v245
v_mul_f32 v245, 0x3fb8aa3b, v245
v_exp_f32 v245, v245
s_nop 0
v_cvt_pk_bf16_f32 v245, v245, v245
v_lshlrev_b32 v245, 16, v245
v_mul_f32 v205, v245, v243
v_mul_f32 v207, v245, v244
v_mul_f32 v205, 0x3fb8aa3b, v205
v_mul_f32 v207, 0.15915494, v207
v_mul_f32 v197, 0x3f800000, v205
v_mul_f32 v198, 0x3f800000, v207
v_exp_f32 v197, v197
v_rndne_f32 v199, v198
v_sub_f32 v198, v198, v199
v_cos_f32 v199, v198
v_sin_f32 v198, v198
v_mul_f32 v22, v197, v199
v_mul_f32 v23, v197, v198
v_add_f32 v197, -1.0, v22
v_mul_f32 v198, v243, v243
v_fma_f32 v198, v244, v244, v198
v_rcp_f32 v198, v198
s_nop 0
v_add_f32 v198, v198, v198
v_mul_f32 v199, v197, v243
v_fma_f32 v199, v23, v244, v199
v_mul_f32 v26, v199, v198
v_mul_f32 v199, v23, v243
v_fma_f32 v199, -v197, v244, v199
v_mul_f32 v27, v199, v198
v_mul_f32 v197, 0x41000000, v205
v_mul_f32 v198, 0x41000000, v207
v_exp_f32 v197, v197
v_rndne_f32 v199, v198
v_sub_f32 v198, v198, v199
v_cos_f32 v199, v198
v_sin_f32 v198, v198
v_mul_f32 v178, v197, v199
v_mul_f32 v179, v197, v198
v_mul_f32 v197, 0x41800000, v205
v_mul_f32 v198, 0x41800000, v207
v_exp_f32 v197, v197
v_rndne_f32 v199, v198
v_sub_f32 v198, v198, v199
v_cos_f32 v199, v198
v_sin_f32 v198, v198
v_mul_f32 v182, v197, v199
v_mul_f32 v183, v197, v198
v_mul_f32 v197, v9, v205
v_mul_f32 v198, v9, v207
v_exp_f32 v197, v197
v_rndne_f32 v199, v198
v_sub_f32 v198, v198, v199
v_cos_f32 v199, v198
v_sin_f32 v198, v198
v_mul_f32 v200, v197, v199
v_mul_f32 v201, v197, v198
v_mov_b32 v188, v200
v_mov_b32 v190, v201
v_mul_f32 v197, v8, v205
v_mul_f32 v198, v8, v207
v_exp_f32 v197, v197
v_rndne_f32 v199, v198
v_sub_f32 v198, v198, v199
v_cos_f32 v199, v198
v_sin_f32 v198, v198
v_mul_f32 v200, v197, v199
v_mul_f32 v201, v197, v198
v_mov_b32 v189, v200
v_mov_b32 v191, v201
v_mul_f32 v197, v27, v23
v_mul_f32 v198, v27, v22
v_fma_f32 v224, v26, v22, -v197
v_fma_f32 v225, v26, v23, v198
v_mul_f32 v197, v225, v23
v_mul_f32 v198, v225, v22
v_fma_f32 v226, v224, v22, -v197
v_fma_f32 v227, v224, v23, v198
v_mul_f32 v197, v227, v23
v_mul_f32 v198, v227, v22
v_fma_f32 v228, v226, v22, -v197
v_fma_f32 v229, v226, v23, v198
v_mul_f32 v197, v229, v23
v_mul_f32 v198, v229, v22
v_fma_f32 v230, v228, v22, -v197
v_fma_f32 v231, v228, v23, v198
v_mul_f32 v197, v231, v23
v_mul_f32 v198, v231, v22
v_fma_f32 v232, v230, v22, -v197
v_fma_f32 v233, v230, v23, v198
v_mul_f32 v197, v233, v23
v_mul_f32 v198, v233, v22
v_fma_f32 v234, v232, v22, -v197
v_fma_f32 v235, v232, v23, v198
v_mul_f32 v197, v235, v23
v_mul_f32 v198, v235, v22
v_fma_f32 v236, v234, v22, -v197
v_fma_f32 v237, v234, v23, v198
v_mul_f32 v197, v237, v23
v_mul_f32 v198, v237, v22
v_fma_f32 v238, v236, v22, -v197
v_fma_f32 v239, v236, v23, v198
v_and_b32 v197, 16, v1
v_cmp_ne_u32 vcc, 0, v197
s_nop 1
v_cndmask_b32 v204, v204, v205, vcc
v_cndmask_b32 v206, v206, v207, vcc
v_mul_f32 v197, 0x41800000, v204
v_mul_f32 v198, 0x41800000, v206
v_exp_f32 v197, v197
v_rndne_f32 v199, v198
v_sub_f32 v198, v198, v199
v_cos_f32 v199, v198
v_sin_f32 v198, v198
v_mul_f32 v28, v197, v199
v_mul_f32 v29, v197, v198
v_mul_f32 v197, 0x42800000, v204
v_mul_f32 v198, 0x42800000, v206
v_exp_f32 v197, v197
v_rndne_f32 v199, v198
v_sub_f32 v198, v198, v199
v_cos_f32 v199, v198
v_sin_f32 v198, v198
v_mul_f32 v192, v197, v199
v_mul_f32 v193, v197, v198
v_mul_f32 v197, 0x43000000, v204
v_mul_f32 v198, 0x43000000, v206
v_exp_f32 v197, v197
v_rndne_f32 v199, v198
v_sub_f32 v198, v198, v199
v_cos_f32 v199, v198
v_sin_f32 v198, v198
v_mul_f32 v30, v197, v199
v_mul_f32 v31, v197, v198
v_mul_f32 v197, 0x43800000, v204
v_mul_f32 v198, 0x43800000, v206
v_exp_f32 v197, v197
v_rndne_f32 v199, v198
v_sub_f32 v198, v198, v199
v_cos_f32 v199, v198
v_sin_f32 v198, v198
v_mul_f32 v2, v197, v199
v_mul_f32 v3, v197, v198
s_waitcnt lgkmcnt(0)
s_barrier
ds_read_b128 v[32:35], v128 offset:0
ds_read_b128 v[48:51], v130 offset:0
ds_read_b128 v[52:55], v130 offset:2048
ds_read_b128 v[56:59], v130 offset:4096
ds_read_b128 v[60:63], v130 offset:6144
ds_read_b128 v[36:39], v128 offset:2048
ds_read_b128 v[40:43], v128 offset:4096
ds_read_b128 v[44:47], v128 offset:6144
s_waitcnt lgkmcnt(6)
v_mfma_f32_16x16x32_bf16 v[64:67], v[32:35], v[48:51], 0
ds_read_b128 v[144:147], v129 offset:0
s_waitcnt lgkmcnt(6)
v_mfma_f32_16x16x32_bf16 v[96:99], v[32:35], v[52:55], 0
ds_read_b128 v[160:163], v131 offset:0
s_waitcnt lgkmcnt(6)
v_mfma_f32_16x16x32_bf16 v[80:83], v[32:35], v[56:59], 0
ds_read_b128 v[164:167], v131 offset:2048
s_waitcnt lgkmcnt(6)
v_mfma_f32_16x16x32_bf16 v[112:115], v[32:35], v[60:63], 0
ds_read_b128 v[168:171], v131 offset:4096
s_waitcnt lgkmcnt(6)
v_mfma_f32_16x16x32_bf16 v[68:71], v[36:39], v[48:51], 0
ds_read_b128 v[172:175], v131 offset:6144
v_mfma_f32_16x16x32_bf16 v[100:103], v[36:39], v[52:55], 0
ds_read_b128 v[148:151], v129 offset:2048
v_mfma_f32_16x16x32_bf16 v[84:87], v[36:39], v[56:59], 0
ds_read_b128 v[152:155], v129 offset:4096
v_mfma_f32_16x16x32_bf16 v[116:119], v[36:39], v[60:63], 0
ds_read_b128 v[156:159], v129 offset:6144
s_waitcnt lgkmcnt(9)
v_mfma_f32_16x16x32_bf16 v[72:75], v[40:43], v[48:51], 0
v_mfma_f32_16x16x32_bf16 v[104:107], v[40:43], v[52:55], 0
v_mfma_f32_16x16x32_bf16 v[88:91], v[40:43], v[56:59], 0
v_mfma_f32_16x16x32_bf16 v[120:123], v[40:43], v[60:63], 0
s_waitcnt lgkmcnt(8)
v_mfma_f32_16x16x32_bf16 v[76:79], v[44:47], v[48:51], 0
v_mfma_f32_16x16x32_bf16 v[108:111], v[44:47], v[52:55], 0
v_mfma_f32_16x16x32_bf16 v[92:95], v[44:47], v[56:59], 0
v_mfma_f32_16x16x32_bf16 v[124:127], v[44:47], v[60:63], 0
s_waitcnt lgkmcnt(0)
s_barrier
v_mfma_f32_16x16x32_bf16 v[64:67], v[144:147], v[160:163], v[64:67]
ds_read_b128 v[32:35], v128 offset:32768
v_mfma_f32_16x16x32_bf16 v[96:99], v[144:147], v[164:167], v[96:99]
ds_read_b128 v[48:51], v130 offset:32768
v_mfma_f32_16x16x32_bf16 v[80:83], v[144:147], v[168:171], v[80:83]
ds_read_b128 v[52:55], v130 offset:34816
v_mfma_f32_16x16x32_bf16 v[112:115], v[144:147], v[172:175], v[112:115]
ds_read_b128 v[56:59], v130 offset:36864
v_mfma_f32_16x16x32_bf16 v[68:71], v[148:151], v[160:163], v[68:71]
ds_read_b128 v[60:63], v130 offset:38912
v_mfma_f32_16x16x32_bf16 v[100:103], v[148:151], v[164:167], v[100:103]
ds_read_b128 v[36:39], v128 offset:34816
v_mfma_f32_16x16x32_bf16 v[84:87], v[148:151], v[168:171], v[84:87]
ds_read_b128 v[40:43], v128 offset:36864
v_mfma_f32_16x16x32_bf16 v[116:119], v[148:151], v[172:175], v[116:119]
ds_read_b128 v[44:47], v128 offset:38912
v_mfma_f32_16x16x32_bf16 v[72:75], v[152:155], v[160:163], v[72:75]
v_mfma_f32_16x16x32_bf16 v[104:107], v[152:155], v[164:167], v[104:107]
v_mfma_f32_16x16x32_bf16 v[88:91], v[152:155], v[168:171], v[88:91]
v_mfma_f32_16x16x32_bf16 v[120:123], v[152:155], v[172:175], v[120:123]
v_mfma_f32_16x16x32_bf16 v[76:79], v[156:159], v[160:163], v[76:79]
v_mfma_f32_16x16x32_bf16 v[108:111], v[156:159], v[164:167], v[108:111]
v_mfma_f32_16x16x32_bf16 v[92:95], v[156:159], v[168:171], v[92:95]
v_mfma_f32_16x16x32_bf16 v[124:127], v[156:159], v[172:175], v[124:127]
s_waitcnt lgkmcnt(6)
v_mfma_f32_16x16x32_bf16 v[64:67], v[32:35], v[48:51], v[64:67]
ds_read_b128 v[144:147], v129 offset:32768
s_waitcnt lgkmcnt(6)
v_mfma_f32_16x16x32_bf16 v[96:99], v[32:35], v[52:55], v[96:99]
ds_read_b128 v[160:163], v131 offset:32768
s_waitcnt lgkmcnt(6)
v_mfma_f32_16x16x32_bf16 v[80:83], v[32:35], v[56:59], v[80:83]
ds_read_b128 v[164:167], v131 offset:34816
s_waitcnt lgkmcnt(6)
v_mfma_f32_16x16x32_bf16 v[112:115], v[32:35], v[60:63], v[112:115]
ds_read_b128 v[168:171], v131 offset:36864
s_waitcnt lgkmcnt(6)
v_mfma_f32_16x16x32_bf16 v[68:71], v[36:39], v[48:51], v[68:71]
ds_read_b128 v[172:175], v131 offset:38912
v_mfma_f32_16x16x32_bf16 v[100:103], v[36:39], v[52:55], v[100:103]
ds_read_b128 v[148:151], v129 offset:34816
v_mfma_f32_16x16x32_bf16 v[84:87], v[36:39], v[56:59], v[84:87]
ds_read_b128 v[152:155], v129 offset:36864
v_mfma_f32_16x16x32_bf16 v[116:119], v[36:39], v[60:63], v[116:119]
ds_read_b128 v[156:159], v129 offset:38912
s_waitcnt lgkmcnt(9)
v_mfma_f32_16x16x32_bf16 v[72:75], v[40:43], v[48:51], v[72:75]
v_mfma_f32_16x16x32_bf16 v[104:107], v[40:43], v[52:55], v[104:107]
v_mfma_f32_16x16x32_bf16 v[88:91], v[40:43], v[56:59], v[88:91]
v_mfma_f32_16x16x32_bf16 v[120:123], v[40:43], v[60:63], v[120:123]
s_waitcnt lgkmcnt(8)
v_mfma_f32_16x16x32_bf16 v[76:79], v[44:47], v[48:51], v[76:79]
v_mfma_f32_16x16x32_bf16 v[108:111], v[44:47], v[52:55], v[108:111]
v_mfma_f32_16x16x32_bf16 v[92:95], v[44:47], v[56:59], v[92:95]
v_mfma_f32_16x16x32_bf16 v[124:127], v[44:47], v[60:63], v[124:127]
s_waitcnt lgkmcnt(0)
s_barrier
v_mfma_f32_16x16x32_bf16 v[64:67], v[144:147], v[160:163], v[64:67]
ds_read_b128 v[32:35], v132 offset:0
v_mfma_f32_16x16x32_bf16 v[96:99], v[144:147], v[164:167], v[96:99]
ds_read_b128 v[48:51], v134 offset:0
v_mfma_f32_16x16x32_bf16 v[80:83], v[144:147], v[168:171], v[80:83]
ds_read_b128 v[52:55], v134 offset:2048
v_mfma_f32_16x16x32_bf16 v[112:115], v[144:147], v[172:175], v[112:115]
ds_read_b128 v[56:59], v134 offset:4096
v_mfma_f32_16x16x32_bf16 v[68:71], v[148:151], v[160:163], v[68:71]
ds_read_b128 v[60:63], v134 offset:6144
v_mfma_f32_16x16x32_bf16 v[100:103], v[148:151], v[164:167], v[100:103]
ds_read_b128 v[36:39], v132 offset:2048
v_mfma_f32_16x16x32_bf16 v[84:87], v[148:151], v[168:171], v[84:87]
ds_read_b128 v[40:43], v132 offset:4096
v_mfma_f32_16x16x32_bf16 v[116:119], v[148:151], v[172:175], v[116:119]
ds_read_b128 v[44:47], v132 offset:6144
v_mfma_f32_16x16x32_bf16 v[72:75], v[152:155], v[160:163], v[72:75]
v_mfma_f32_16x16x32_bf16 v[104:107], v[152:155], v[164:167], v[104:107]
v_mfma_f32_16x16x32_bf16 v[88:91], v[152:155], v[168:171], v[88:91]
v_mfma_f32_16x16x32_bf16 v[120:123], v[152:155], v[172:175], v[120:123]
v_mfma_f32_16x16x32_bf16 v[76:79], v[156:159], v[160:163], v[76:79]
v_mfma_f32_16x16x32_bf16 v[108:111], v[156:159], v[164:167], v[108:111]
v_mfma_f32_16x16x32_bf16 v[92:95], v[156:159], v[168:171], v[92:95]
v_mfma_f32_16x16x32_bf16 v[124:127], v[156:159], v[172:175], v[124:127]
s_waitcnt lgkmcnt(6)
v_mfma_f32_16x16x32_bf16 v[64:67], v[32:35], v[48:51], v[64:67]
ds_read_b128 v[144:147], v133 offset:0
s_waitcnt lgkmcnt(6)
v_mfma_f32_16x16x32_bf16 v[96:99], v[32:35], v[52:55], v[96:99]
ds_read_b128 v[160:163], v135 offset:0
s_waitcnt lgkmcnt(6)
v_mfma_f32_16x16x32_bf16 v[80:83], v[32:35], v[56:59], v[80:83]
ds_read_b128 v[164:167], v135 offset:2048
s_waitcnt lgkmcnt(6)
v_mfma_f32_16x16x32_bf16 v[112:115], v[32:35], v[60:63], v[112:115]
ds_read_b128 v[168:171], v135 offset:4096
s_waitcnt lgkmcnt(6)
v_mfma_f32_16x16x32_bf16 v[68:71], v[36:39], v[48:51], v[68:71]
ds_read_b128 v[172:175], v135 offset:6144
v_mfma_f32_16x16x32_bf16 v[100:103], v[36:39], v[52:55], v[100:103]
ds_read_b128 v[148:151], v133 offset:2048
v_mfma_f32_16x16x32_bf16 v[84:87], v[36:39], v[56:59], v[84:87]
ds_read_b128 v[152:155], v133 offset:4096
v_mfma_f32_16x16x32_bf16 v[116:119], v[36:39], v[60:63], v[116:119]
ds_read_b128 v[156:159], v133 offset:6144
s_waitcnt lgkmcnt(9)
v_mfma_f32_16x16x32_bf16 v[72:75], v[40:43], v[48:51], v[72:75]
v_mfma_f32_16x16x32_bf16 v[104:107], v[40:43], v[52:55], v[104:107]
v_mfma_f32_16x16x32_bf16 v[88:91], v[40:43], v[56:59], v[88:91]
v_mfma_f32_16x16x32_bf16 v[120:123], v[40:43], v[60:63], v[120:123]
s_waitcnt lgkmcnt(8)
v_mfma_f32_16x16x32_bf16 v[76:79], v[44:47], v[48:51], v[76:79]
v_mfma_f32_16x16x32_bf16 v[108:111], v[44:47], v[52:55], v[108:111]
v_mfma_f32_16x16x32_bf16 v[92:95], v[44:47], v[56:59], v[92:95]
v_mfma_f32_16x16x32_bf16 v[124:127], v[44:47], v[60:63], v[124:127]
s_waitcnt lgkmcnt(0)
s_barrier
v_mfma_f32_16x16x32_bf16 v[64:67], v[144:147], v[160:163], v[64:67]
ds_read_b128 v[32:35], v128 offset:0
v_mfma_f32_16x16x32_bf16 v[96:99], v[144:147], v[164:167], v[96:99]
ds_read_b128 v[48:51], v130 offset:0
v_mfma_f32_16x16x32_bf16 v[80:83], v[144:147], v[168:171], v[80:83]
ds_read_b128 v[52:55], v130 offset:2048
v_mfma_f32_16x16x32_bf16 v[112:115], v[144:147], v[172:175], v[112:115]
ds_read_b128 v[56:59], v130 offset:4096
v_mfma_f32_16x16x32_bf16 v[68:71], v[148:151], v[160:163], v[68:71]
ds_read_b128 v[60:63], v130 offset:6144
v_mfma_f32_16x16x32_bf16 v[100:103], v[148:151], v[164:167], v[100:103]
ds_read_b128 v[36:39], v128 offset:2048
v_mfma_f32_16x16x32_bf16 v[84:87], v[148:151], v[168:171], v[84:87]
ds_read_b128 v[40:43], v128 offset:4096
v_mfma_f32_16x16x32_bf16 v[116:119], v[148:151], v[172:175], v[116:119]
ds_read_b128 v[44:47], v128 offset:6144
v_mfma_f32_16x16x32_bf16 v[72:75], v[152:155], v[160:163], v[72:75]
v_mfma_f32_16x16x32_bf16 v[104:107], v[152:155], v[164:167], v[104:107]
v_mfma_f32_16x16x32_bf16 v[88:91], v[152:155], v[168:171], v[88:91]
v_mfma_f32_16x16x32_bf16 v[120:123], v[152:155], v[172:175], v[120:123]
v_mfma_f32_16x16x32_bf16 v[76:79], v[156:159], v[160:163], v[76:79]
v_mfma_f32_16x16x32_bf16 v[108:111], v[156:159], v[164:167], v[108:111]
v_mfma_f32_16x16x32_bf16 v[92:95], v[156:159], v[168:171], v[92:95]
v_mfma_f32_16x16x32_bf16 v[124:127], v[156:159], v[172:175], v[124:127]
s_waitcnt lgkmcnt(6)
v_mfma_f32_16x16x32_bf16 v[64:67], v[32:35], v[48:51], v[64:67]
ds_read_b128 v[144:147], v129 offset:0
s_waitcnt lgkmcnt(6)
v_mfma_f32_16x16x32_bf16 v[96:99], v[32:35], v[52:55], v[96:99]
ds_read_b128 v[160:163], v131 offset:0
s_waitcnt lgkmcnt(6)
v_mfma_f32_16x16x32_bf16 v[80:83], v[32:35], v[56:59], v[80:83]
ds_read_b128 v[164:167], v131 offset:2048
s_waitcnt lgkmcnt(6)
v_mfma_f32_16x16x32_bf16 v[112:115], v[32:35], v[60:63], v[112:115]
ds_read_b128 v[168:171], v131 offset:4096
s_waitcnt lgkmcnt(6)
v_mfma_f32_16x16x32_bf16 v[68:71], v[36:39], v[48:51], v[68:71]
ds_read_b128 v[172:175], v131 offset:6144
v_mfma_f32_16x16x32_bf16 v[100:103], v[36:39], v[52:55], v[100:103]
ds_read_b128 v[148:151], v129 offset:2048
v_mfma_f32_16x16x32_bf16 v[84:87], v[36:39], v[56:59], v[84:87]
ds_read_b128 v[152:155], v129 offset:4096
v_mfma_f32_16x16x32_bf16 v[116:119], v[36:39], v[60:63], v[116:119]
ds_read_b128 v[156:159], v129 offset:6144
s_waitcnt lgkmcnt(9)
v_mfma_f32_16x16x32_bf16 v[72:75], v[40:43], v[48:51], v[72:75]
v_mfma_f32_16x16x32_bf16 v[104:107], v[40:43], v[52:55], v[104:107]
v_mfma_f32_16x16x32_bf16 v[88:91], v[40:43], v[56:59], v[88:91]
v_mfma_f32_16x16x32_bf16 v[120:123], v[40:43], v[60:63], v[120:123]
s_waitcnt lgkmcnt(8)
v_mfma_f32_16x16x32_bf16 v[76:79], v[44:47], v[48:51], v[76:79]
v_mfma_f32_16x16x32_bf16 v[108:111], v[44:47], v[52:55], v[108:111]
v_mfma_f32_16x16x32_bf16 v[92:95], v[44:47], v[56:59], v[92:95]
v_mfma_f32_16x16x32_bf16 v[124:127], v[44:47], v[60:63], v[124:127]
s_waitcnt lgkmcnt(0)
s_barrier
v_mfma_f32_16x16x32_bf16 v[64:67], v[144:147], v[160:163], v[64:67]
ds_read_b128 v[32:35], v128 offset:32768
v_mfma_f32_16x16x32_bf16 v[96:99], v[144:147], v[164:167], v[96:99]
ds_read_b128 v[48:51], v130 offset:32768
v_mfma_f32_16x16x32_bf16 v[80:83], v[144:147], v[168:171], v[80:83]
ds_read_b128 v[52:55], v130 offset:34816
v_mfma_f32_16x16x32_bf16 v[112:115], v[144:147], v[172:175], v[112:115]
ds_read_b128 v[56:59], v130 offset:36864
v_mfma_f32_16x16x32_bf16 v[68:71], v[148:151], v[160:163], v[68:71]
ds_read_b128 v[60:63], v130 offset:38912
v_mfma_f32_16x16x32_bf16 v[100:103], v[148:151], v[164:167], v[100:103]
ds_read_b128 v[36:39], v128 offset:34816
v_mfma_f32_16x16x32_bf16 v[84:87], v[148:151], v[168:171], v[84:87]
ds_read_b128 v[40:43], v128 offset:36864
v_mfma_f32_16x16x32_bf16 v[116:119], v[148:151], v[172:175], v[116:119]
ds_read_b128 v[44:47], v128 offset:38912
v_mfma_f32_16x16x32_bf16 v[72:75], v[152:155], v[160:163], v[72:75]
v_mfma_f32_16x16x32_bf16 v[104:107], v[152:155], v[164:167], v[104:107]
v_mfma_f32_16x16x32_bf16 v[88:91], v[152:155], v[168:171], v[88:91]
v_mfma_f32_16x16x32_bf16 v[120:123], v[152:155], v[172:175], v[120:123]
v_mfma_f32_16x16x32_bf16 v[76:79], v[156:159], v[160:163], v[76:79]
v_mfma_f32_16x16x32_bf16 v[108:111], v[156:159], v[164:167], v[108:111]
v_mfma_f32_16x16x32_bf16 v[92:95], v[156:159], v[168:171], v[92:95]
v_mfma_f32_16x16x32_bf16 v[124:127], v[156:159], v[172:175], v[124:127]
s_waitcnt lgkmcnt(6)
v_mfma_f32_16x16x32_bf16 v[64:67], v[32:35], v[48:51], v[64:67]
ds_read_b128 v[144:147], v129 offset:32768
s_waitcnt lgkmcnt(6)
v_mfma_f32_16x16x32_bf16 v[96:99], v[32:35], v[52:55], v[96:99]
ds_read_b128 v[160:163], v131 offset:32768
s_waitcnt lgkmcnt(6)
v_mfma_f32_16x16x32_bf16 v[80:83], v[32:35], v[56:59], v[80:83]
ds_read_b128 v[164:167], v131 offset:34816
s_waitcnt lgkmcnt(6)
v_mfma_f32_16x16x32_bf16 v[112:115], v[32:35], v[60:63], v[112:115]
ds_read_b128 v[168:171], v131 offset:36864
s_waitcnt lgkmcnt(6)
v_mfma_f32_16x16x32_bf16 v[68:71], v[36:39], v[48:51], v[68:71]
ds_read_b128 v[172:175], v131 offset:38912
v_mfma_f32_16x16x32_bf16 v[100:103], v[36:39], v[52:55], v[100:103]
ds_read_b128 v[148:151], v129 offset:34816
v_mfma_f32_16x16x32_bf16 v[84:87], v[36:39], v[56:59], v[84:87]
ds_read_b128 v[152:155], v129 offset:36864
v_mfma_f32_16x16x32_bf16 v[116:119], v[36:39], v[60:63], v[116:119]
ds_read_b128 v[156:159], v129 offset:38912
s_waitcnt lgkmcnt(9)
v_mfma_f32_16x16x32_bf16 v[72:75], v[40:43], v[48:51], v[72:75]
v_mfma_f32_16x16x32_bf16 v[104:107], v[40:43], v[52:55], v[104:107]
v_mfma_f32_16x16x32_bf16 v[88:91], v[40:43], v[56:59], v[88:91]
v_mfma_f32_16x16x32_bf16 v[120:123], v[40:43], v[60:63], v[120:123]
s_waitcnt lgkmcnt(8)
v_mfma_f32_16x16x32_bf16 v[76:79], v[44:47], v[48:51], v[76:79]
v_mfma_f32_16x16x32_bf16 v[108:111], v[44:47], v[52:55], v[108:111]
v_mfma_f32_16x16x32_bf16 v[92:95], v[44:47], v[56:59], v[92:95]
v_mfma_f32_16x16x32_bf16 v[124:127], v[44:47], v[60:63], v[124:127]
s_waitcnt lgkmcnt(0)
s_barrier
v_mfma_f32_16x16x32_bf16 v[64:67], v[144:147], v[160:163], v[64:67]
ds_read_b128 v[32:35], v132 offset:0
v_mfma_f32_16x16x32_bf16 v[96:99], v[144:147], v[164:167], v[96:99]
ds_read_b128 v[48:51], v134 offset:0
v_mfma_f32_16x16x32_bf16 v[80:83], v[144:147], v[168:171], v[80:83]
ds_read_b128 v[52:55], v134 offset:2048
v_mfma_f32_16x16x32_bf16 v[112:115], v[144:147], v[172:175], v[112:115]
ds_read_b128 v[56:59], v134 offset:4096
v_mfma_f32_16x16x32_bf16 v[68:71], v[148:151], v[160:163], v[68:71]
ds_read_b128 v[60:63], v134 offset:6144
v_mfma_f32_16x16x32_bf16 v[100:103], v[148:151], v[164:167], v[100:103]
ds_read_b128 v[36:39], v132 offset:2048
v_mfma_f32_16x16x32_bf16 v[84:87], v[148:151], v[168:171], v[84:87]
ds_read_b128 v[40:43], v132 offset:4096
v_mfma_f32_16x16x32_bf16 v[116:119], v[148:151], v[172:175], v[116:119]
ds_read_b128 v[44:47], v132 offset:6144
v_mfma_f32_16x16x32_bf16 v[72:75], v[152:155], v[160:163], v[72:75]
v_mfma_f32_16x16x32_bf16 v[104:107], v[152:155], v[164:167], v[104:107]
v_mfma_f32_16x16x32_bf16 v[88:91], v[152:155], v[168:171], v[88:91]
v_mfma_f32_16x16x32_bf16 v[120:123], v[152:155], v[172:175], v[120:123]
v_mfma_f32_16x16x32_bf16 v[76:79], v[156:159], v[160:163], v[76:79]
v_mfma_f32_16x16x32_bf16 v[108:111], v[156:159], v[164:167], v[108:111]
v_mfma_f32_16x16x32_bf16 v[92:95], v[156:159], v[168:171], v[92:95]
v_mfma_f32_16x16x32_bf16 v[124:127], v[156:159], v[172:175], v[124:127]
s_waitcnt lgkmcnt(6)
v_mfma_f32_16x16x32_bf16 v[64:67], v[32:35], v[48:51], v[64:67]
ds_read_b128 v[144:147], v133 offset:0
s_waitcnt lgkmcnt(6)
v_mfma_f32_16x16x32_bf16 v[96:99], v[32:35], v[52:55], v[96:99]
ds_read_b128 v[160:163], v135 offset:0
s_waitcnt lgkmcnt(6)
v_mfma_f32_16x16x32_bf16 v[80:83], v[32:35], v[56:59], v[80:83]
ds_read_b128 v[164:167], v135 offset:2048
s_waitcnt lgkmcnt(6)
v_mfma_f32_16x16x32_bf16 v[112:115], v[32:35], v[60:63], v[112:115]
ds_read_b128 v[168:171], v135 offset:4096
s_waitcnt lgkmcnt(6)
v_mfma_f32_16x16x32_bf16 v[68:71], v[36:39], v[48:51], v[68:71]
ds_read_b128 v[172:175], v135 offset:6144
v_mfma_f32_16x16x32_bf16 v[100:103], v[36:39], v[52:55], v[100:103]
ds_read_b128 v[148:151], v133 offset:2048
v_mfma_f32_16x16x32_bf16 v[84:87], v[36:39], v[56:59], v[84:87]
ds_read_b128 v[152:155], v133 offset:4096
v_mfma_f32_16x16x32_bf16 v[116:119], v[36:39], v[60:63], v[116:119]
ds_read_b128 v[156:159], v133 offset:6144
s_waitcnt lgkmcnt(9)
v_mfma_f32_16x16x32_bf16 v[72:75], v[40:43], v[48:51], v[72:75]
v_mfma_f32_16x16x32_bf16 v[104:107], v[40:43], v[52:55], v[104:107]
v_mfma_f32_16x16x32_bf16 v[88:91], v[40:43], v[56:59], v[88:91]
v_mfma_f32_16x16x32_bf16 v[120:123], v[40:43], v[60:63], v[120:123]
s_waitcnt lgkmcnt(8)
v_mfma_f32_16x16x32_bf16 v[76:79], v[44:47], v[48:51], v[76:79]
v_mfma_f32_16x16x32_bf16 v[108:111], v[44:47], v[52:55], v[108:111]
v_mfma_f32_16x16x32_bf16 v[92:95], v[44:47], v[56:59], v[92:95]
v_mfma_f32_16x16x32_bf16 v[124:127], v[44:47], v[60:63], v[124:127]
s_waitcnt lgkmcnt(0)
s_barrier
v_mfma_f32_16x16x32_bf16 v[64:67], v[144:147], v[160:163], v[64:67]
ds_read_b128 v[32:35], v128 offset:0
v_mfma_f32_16x16x32_bf16 v[96:99], v[144:147], v[164:167], v[96:99]
ds_read_b128 v[48:51], v130 offset:0
v_mfma_f32_16x16x32_bf16 v[80:83], v[144:147], v[168:171], v[80:83]
ds_read_b128 v[52:55], v130 offset:2048
v_mfma_f32_16x16x32_bf16 v[112:115], v[144:147], v[172:175], v[112:115]
ds_read_b128 v[56:59], v130 offset:4096
v_mfma_f32_16x16x32_bf16 v[68:71], v[148:151], v[160:163], v[68:71]
ds_read_b128 v[60:63], v130 offset:6144
v_mfma_f32_16x16x32_bf16 v[100:103], v[148:151], v[164:167], v[100:103]
ds_read_b128 v[36:39], v128 offset:2048
v_mfma_f32_16x16x32_bf16 v[84:87], v[148:151], v[168:171], v[84:87]
ds_read_b128 v[40:43], v128 offset:4096
v_mfma_f32_16x16x32_bf16 v[116:119], v[148:151], v[172:175], v[116:119]
ds_read_b128 v[44:47], v128 offset:6144
v_mfma_f32_16x16x32_bf16 v[72:75], v[152:155], v[160:163], v[72:75]
v_mfma_f32_16x16x32_bf16 v[104:107], v[152:155], v[164:167], v[104:107]
v_mfma_f32_16x16x32_bf16 v[88:91], v[152:155], v[168:171], v[88:91]
v_mfma_f32_16x16x32_bf16 v[120:123], v[152:155], v[172:175], v[120:123]
v_mfma_f32_16x16x32_bf16 v[76:79], v[156:159], v[160:163], v[76:79]
v_mfma_f32_16x16x32_bf16 v[108:111], v[156:159], v[164:167], v[108:111]
v_mfma_f32_16x16x32_bf16 v[92:95], v[156:159], v[168:171], v[92:95]
v_mfma_f32_16x16x32_bf16 v[124:127], v[156:159], v[172:175], v[124:127]
s_waitcnt lgkmcnt(6)
v_mfma_f32_16x16x32_bf16 v[64:67], v[32:35], v[48:51], v[64:67]
ds_read_b128 v[144:147], v129 offset:0
s_waitcnt lgkmcnt(6)
v_mfma_f32_16x16x32_bf16 v[96:99], v[32:35], v[52:55], v[96:99]
ds_read_b128 v[160:163], v131 offset:0
s_waitcnt lgkmcnt(6)
v_mfma_f32_16x16x32_bf16 v[80:83], v[32:35], v[56:59], v[80:83]
ds_read_b128 v[164:167], v131 offset:2048
s_waitcnt lgkmcnt(6)
v_mfma_f32_16x16x32_bf16 v[112:115], v[32:35], v[60:63], v[112:115]
ds_read_b128 v[168:171], v131 offset:4096
s_waitcnt lgkmcnt(6)
v_mfma_f32_16x16x32_bf16 v[68:71], v[36:39], v[48:51], v[68:71]
ds_read_b128 v[172:175], v131 offset:6144
v_mfma_f32_16x16x32_bf16 v[100:103], v[36:39], v[52:55], v[100:103]
ds_read_b128 v[148:151], v129 offset:2048
v_mfma_f32_16x16x32_bf16 v[84:87], v[36:39], v[56:59], v[84:87]
ds_read_b128 v[152:155], v129 offset:4096
v_mfma_f32_16x16x32_bf16 v[116:119], v[36:39], v[60:63], v[116:119]
ds_read_b128 v[156:159], v129 offset:6144
s_waitcnt lgkmcnt(9)
v_mfma_f32_16x16x32_bf16 v[72:75], v[40:43], v[48:51], v[72:75]
v_mfma_f32_16x16x32_bf16 v[104:107], v[40:43], v[52:55], v[104:107]
v_mfma_f32_16x16x32_bf16 v[88:91], v[40:43], v[56:59], v[88:91]
v_mfma_f32_16x16x32_bf16 v[120:123], v[40:43], v[60:63], v[120:123]
s_waitcnt lgkmcnt(8)
v_mfma_f32_16x16x32_bf16 v[76:79], v[44:47], v[48:51], v[76:79]
v_mfma_f32_16x16x32_bf16 v[108:111], v[44:47], v[52:55], v[108:111]
v_mfma_f32_16x16x32_bf16 v[92:95], v[44:47], v[56:59], v[92:95]
v_mfma_f32_16x16x32_bf16 v[124:127], v[44:47], v[60:63], v[124:127]
s_waitcnt lgkmcnt(0)
s_barrier
v_mfma_f32_16x16x32_bf16 v[64:67], v[144:147], v[160:163], v[64:67]
ds_read_b128 v[32:35], v128 offset:32768
v_mfma_f32_16x16x32_bf16 v[96:99], v[144:147], v[164:167], v[96:99]
ds_read_b128 v[48:51], v130 offset:32768
v_mfma_f32_16x16x32_bf16 v[80:83], v[144:147], v[168:171], v[80:83]
ds_read_b128 v[52:55], v130 offset:34816
v_mfma_f32_16x16x32_bf16 v[112:115], v[144:147], v[172:175], v[112:115]
ds_read_b128 v[56:59], v130 offset:36864
v_mfma_f32_16x16x32_bf16 v[68:71], v[148:151], v[160:163], v[68:71]
ds_read_b128 v[60:63], v130 offset:38912
v_mfma_f32_16x16x32_bf16 v[100:103], v[148:151], v[164:167], v[100:103]
ds_read_b128 v[36:39], v128 offset:34816
v_mfma_f32_16x16x32_bf16 v[84:87], v[148:151], v[168:171], v[84:87]
ds_read_b128 v[40:43], v128 offset:36864
v_mfma_f32_16x16x32_bf16 v[116:119], v[148:151], v[172:175], v[116:119]
ds_read_b128 v[44:47], v128 offset:38912
v_mfma_f32_16x16x32_bf16 v[72:75], v[152:155], v[160:163], v[72:75]
v_mfma_f32_16x16x32_bf16 v[104:107], v[152:155], v[164:167], v[104:107]
v_mfma_f32_16x16x32_bf16 v[88:91], v[152:155], v[168:171], v[88:91]
v_mfma_f32_16x16x32_bf16 v[120:123], v[152:155], v[172:175], v[120:123]
v_mfma_f32_16x16x32_bf16 v[76:79], v[156:159], v[160:163], v[76:79]
v_mfma_f32_16x16x32_bf16 v[108:111], v[156:159], v[164:167], v[108:111]
v_mfma_f32_16x16x32_bf16 v[92:95], v[156:159], v[168:171], v[92:95]
v_mfma_f32_16x16x32_bf16 v[124:127], v[156:159], v[172:175], v[124:127]
s_waitcnt lgkmcnt(6)
v_mfma_f32_16x16x32_bf16 v[64:67], v[32:35], v[48:51], v[64:67]
ds_read_b128 v[144:147], v129 offset:32768
s_waitcnt lgkmcnt(6)
v_mfma_f32_16x16x32_bf16 v[96:99], v[32:35], v[52:55], v[96:99]
ds_read_b128 v[160:163], v131 offset:32768
s_waitcnt lgkmcnt(6)
v_mfma_f32_16x16x32_bf16 v[80:83], v[32:35], v[56:59], v[80:83]
ds_read_b128 v[164:167], v131 offset:34816
s_waitcnt lgkmcnt(6)
v_mfma_f32_16x16x32_bf16 v[112:115], v[32:35], v[60:63], v[112:115]
ds_read_b128 v[168:171], v131 offset:36864
s_waitcnt lgkmcnt(6)
v_mfma_f32_16x16x32_bf16 v[68:71], v[36:39], v[48:51], v[68:71]
ds_read_b128 v[172:175], v131 offset:38912
v_mfma_f32_16x16x32_bf16 v[100:103], v[36:39], v[52:55], v[100:103]
ds_read_b128 v[148:151], v129 offset:34816
v_mfma_f32_16x16x32_bf16 v[84:87], v[36:39], v[56:59], v[84:87]
ds_read_b128 v[152:155], v129 offset:36864
v_mfma_f32_16x16x32_bf16 v[116:119], v[36:39], v[60:63], v[116:119]
ds_read_b128 v[156:159], v129 offset:38912
s_waitcnt lgkmcnt(9)
v_mfma_f32_16x16x32_bf16 v[72:75], v[40:43], v[48:51], v[72:75]
v_mfma_f32_16x16x32_bf16 v[104:107], v[40:43], v[52:55], v[104:107]
v_mfma_f32_16x16x32_bf16 v[88:91], v[40:43], v[56:59], v[88:91]
v_mfma_f32_16x16x32_bf16 v[120:123], v[40:43], v[60:63], v[120:123]
s_waitcnt lgkmcnt(8)
v_mfma_f32_16x16x32_bf16 v[76:79], v[44:47], v[48:51], v[76:79]
v_mfma_f32_16x16x32_bf16 v[108:111], v[44:47], v[52:55], v[108:111]
v_mfma_f32_16x16x32_bf16 v[92:95], v[44:47], v[56:59], v[92:95]
v_mfma_f32_16x16x32_bf16 v[124:127], v[44:47], v[60:63], v[124:127]
s_waitcnt lgkmcnt(0)
s_barrier
v_mfma_f32_16x16x32_bf16 v[64:67], v[144:147], v[160:163], v[64:67]
ds_read_b128 v[32:35], v132 offset:0
v_mfma_f32_16x16x32_bf16 v[96:99], v[144:147], v[164:167], v[96:99]
ds_read_b128 v[48:51], v134 offset:0
v_mfma_f32_16x16x32_bf16 v[80:83], v[144:147], v[168:171], v[80:83]
ds_read_b128 v[52:55], v134 offset:2048
v_mfma_f32_16x16x32_bf16 v[112:115], v[144:147], v[172:175], v[112:115]
ds_read_b128 v[56:59], v134 offset:4096
v_mfma_f32_16x16x32_bf16 v[68:71], v[148:151], v[160:163], v[68:71]
ds_read_b128 v[60:63], v134 offset:6144
v_mfma_f32_16x16x32_bf16 v[100:103], v[148:151], v[164:167], v[100:103]
ds_read_b128 v[36:39], v132 offset:2048
v_mfma_f32_16x16x32_bf16 v[84:87], v[148:151], v[168:171], v[84:87]
ds_read_b128 v[40:43], v132 offset:4096
v_mfma_f32_16x16x32_bf16 v[116:119], v[148:151], v[172:175], v[116:119]
ds_read_b128 v[44:47], v132 offset:6144
v_mfma_f32_16x16x32_bf16 v[72:75], v[152:155], v[160:163], v[72:75]
v_mfma_f32_16x16x32_bf16 v[104:107], v[152:155], v[164:167], v[104:107]
v_mfma_f32_16x16x32_bf16 v[88:91], v[152:155], v[168:171], v[88:91]
v_mfma_f32_16x16x32_bf16 v[120:123], v[152:155], v[172:175], v[120:123]
v_mfma_f32_16x16x32_bf16 v[76:79], v[156:159], v[160:163], v[76:79]
v_mfma_f32_16x16x32_bf16 v[108:111], v[156:159], v[164:167], v[108:111]
v_mfma_f32_16x16x32_bf16 v[92:95], v[156:159], v[168:171], v[92:95]
v_mfma_f32_16x16x32_bf16 v[124:127], v[156:159], v[172:175], v[124:127]
s_waitcnt lgkmcnt(6)
v_mfma_f32_16x16x32_bf16 v[64:67], v[32:35], v[48:51], v[64:67]
ds_read_b128 v[144:147], v133 offset:0
s_waitcnt lgkmcnt(6)
v_mfma_f32_16x16x32_bf16 v[96:99], v[32:35], v[52:55], v[96:99]
ds_read_b128 v[160:163], v135 offset:0
s_waitcnt lgkmcnt(6)
v_mfma_f32_16x16x32_bf16 v[80:83], v[32:35], v[56:59], v[80:83]
ds_read_b128 v[164:167], v135 offset:2048
s_waitcnt lgkmcnt(6)
v_mfma_f32_16x16x32_bf16 v[112:115], v[32:35], v[60:63], v[112:115]
ds_read_b128 v[168:171], v135 offset:4096
s_waitcnt lgkmcnt(6)
v_mfma_f32_16x16x32_bf16 v[68:71], v[36:39], v[48:51], v[68:71]
ds_read_b128 v[172:175], v135 offset:6144
v_mfma_f32_16x16x32_bf16 v[100:103], v[36:39], v[52:55], v[100:103]
ds_read_b128 v[148:151], v133 offset:2048
v_mfma_f32_16x16x32_bf16 v[84:87], v[36:39], v[56:59], v[84:87]
ds_read_b128 v[152:155], v133 offset:4096
v_mfma_f32_16x16x32_bf16 v[116:119], v[36:39], v[60:63], v[116:119]
ds_read_b128 v[156:159], v133 offset:6144
s_waitcnt lgkmcnt(9)
v_mfma_f32_16x16x32_bf16 v[72:75], v[40:43], v[48:51], v[72:75]
v_mfma_f32_16x16x32_bf16 v[104:107], v[40:43], v[52:55], v[104:107]
v_mfma_f32_16x16x32_bf16 v[88:91], v[40:43], v[56:59], v[88:91]
v_mfma_f32_16x16x32_bf16 v[120:123], v[40:43], v[60:63], v[120:123]
s_waitcnt lgkmcnt(8)
v_mfma_f32_16x16x32_bf16 v[76:79], v[44:47], v[48:51], v[76:79]
v_mfma_f32_16x16x32_bf16 v[108:111], v[44:47], v[52:55], v[108:111]
v_mfma_f32_16x16x32_bf16 v[92:95], v[44:47], v[56:59], v[92:95]
v_mfma_f32_16x16x32_bf16 v[124:127], v[44:47], v[60:63], v[124:127]
s_waitcnt lgkmcnt(0)
s_barrier
v_mfma_f32_16x16x32_bf16 v[64:67], v[144:147], v[160:163], v[64:67]
ds_read_b128 v[32:35], v128 offset:0
v_mfma_f32_16x16x32_bf16 v[96:99], v[144:147], v[164:167], v[96:99]
ds_read_b128 v[48:51], v130 offset:0
v_mfma_f32_16x16x32_bf16 v[80:83], v[144:147], v[168:171], v[80:83]
ds_read_b128 v[52:55], v130 offset:2048
v_mfma_f32_16x16x32_bf16 v[112:115], v[144:147], v[172:175], v[112:115]
ds_read_b128 v[56:59], v130 offset:4096
v_mfma_f32_16x16x32_bf16 v[68:71], v[148:151], v[160:163], v[68:71]
ds_read_b128 v[60:63], v130 offset:6144
v_mfma_f32_16x16x32_bf16 v[100:103], v[148:151], v[164:167], v[100:103]
ds_read_b128 v[36:39], v128 offset:2048
v_mfma_f32_16x16x32_bf16 v[84:87], v[148:151], v[168:171], v[84:87]
ds_read_b128 v[40:43], v128 offset:4096
v_mfma_f32_16x16x32_bf16 v[116:119], v[148:151], v[172:175], v[116:119]
ds_read_b128 v[44:47], v128 offset:6144
v_mfma_f32_16x16x32_bf16 v[72:75], v[152:155], v[160:163], v[72:75]
v_mfma_f32_16x16x32_bf16 v[104:107], v[152:155], v[164:167], v[104:107]
v_mfma_f32_16x16x32_bf16 v[88:91], v[152:155], v[168:171], v[88:91]
v_mfma_f32_16x16x32_bf16 v[120:123], v[152:155], v[172:175], v[120:123]
v_mfma_f32_16x16x32_bf16 v[76:79], v[156:159], v[160:163], v[76:79]
v_mfma_f32_16x16x32_bf16 v[108:111], v[156:159], v[164:167], v[108:111]
v_mfma_f32_16x16x32_bf16 v[92:95], v[156:159], v[168:171], v[92:95]
v_mfma_f32_16x16x32_bf16 v[124:127], v[156:159], v[172:175], v[124:127]
s_waitcnt lgkmcnt(6)
v_mfma_f32_16x16x32_bf16 v[64:67], v[32:35], v[48:51], v[64:67]
ds_read_b128 v[144:147], v129 offset:0
s_waitcnt lgkmcnt(6)
v_mfma_f32_16x16x32_bf16 v[96:99], v[32:35], v[52:55], v[96:99]
ds_read_b128 v[160:163], v131 offset:0
s_waitcnt lgkmcnt(6)
v_mfma_f32_16x16x32_bf16 v[80:83], v[32:35], v[56:59], v[80:83]
ds_read_b128 v[164:167], v131 offset:2048
s_waitcnt lgkmcnt(6)
v_mfma_f32_16x16x32_bf16 v[112:115], v[32:35], v[60:63], v[112:115]
ds_read_b128 v[168:171], v131 offset:4096
s_waitcnt lgkmcnt(6)
v_mfma_f32_16x16x32_bf16 v[68:71], v[36:39], v[48:51], v[68:71]
ds_read_b128 v[172:175], v131 offset:6144
v_mfma_f32_16x16x32_bf16 v[100:103], v[36:39], v[52:55], v[100:103]
ds_read_b128 v[148:151], v129 offset:2048
v_mfma_f32_16x16x32_bf16 v[84:87], v[36:39], v[56:59], v[84:87]
ds_read_b128 v[152:155], v129 offset:4096
v_mfma_f32_16x16x32_bf16 v[116:119], v[36:39], v[60:63], v[116:119]
ds_read_b128 v[156:159], v129 offset:6144
s_waitcnt lgkmcnt(9)
v_mfma_f32_16x16x32_bf16 v[72:75], v[40:43], v[48:51], v[72:75]
v_mfma_f32_16x16x32_bf16 v[104:107], v[40:43], v[52:55], v[104:107]
v_mfma_f32_16x16x32_bf16 v[88:91], v[40:43], v[56:59], v[88:91]
v_mfma_f32_16x16x32_bf16 v[120:123], v[40:43], v[60:63], v[120:123]
s_waitcnt lgkmcnt(8)
v_mfma_f32_16x16x32_bf16 v[76:79], v[44:47], v[48:51], v[76:79]
v_mfma_f32_16x16x32_bf16 v[108:111], v[44:47], v[52:55], v[108:111]
v_mfma_f32_16x16x32_bf16 v[92:95], v[44:47], v[56:59], v[92:95]
v_mfma_f32_16x16x32_bf16 v[124:127], v[44:47], v[60:63], v[124:127]
s_waitcnt lgkmcnt(0)
s_barrier
v_mfma_f32_16x16x32_bf16 v[64:67], v[144:147], v[160:163], v[64:67]
ds_read_b128 v[32:35], v128 offset:32768
v_mfma_f32_16x16x32_bf16 v[96:99], v[144:147], v[164:167], v[96:99]
ds_read_b128 v[48:51], v130 offset:32768
v_mfma_f32_16x16x32_bf16 v[80:83], v[144:147], v[168:171], v[80:83]
ds_read_b128 v[52:55], v130 offset:34816
v_mfma_f32_16x16x32_bf16 v[112:115], v[144:147], v[172:175], v[112:115]
ds_read_b128 v[56:59], v130 offset:36864
v_mfma_f32_16x16x32_bf16 v[68:71], v[148:151], v[160:163], v[68:71]
ds_read_b128 v[60:63], v130 offset:38912
v_mfma_f32_16x16x32_bf16 v[100:103], v[148:151], v[164:167], v[100:103]
ds_read_b128 v[36:39], v128 offset:34816
v_mfma_f32_16x16x32_bf16 v[84:87], v[148:151], v[168:171], v[84:87]
ds_read_b128 v[40:43], v128 offset:36864
v_mfma_f32_16x16x32_bf16 v[116:119], v[148:151], v[172:175], v[116:119]
ds_read_b128 v[44:47], v128 offset:38912
v_mfma_f32_16x16x32_bf16 v[72:75], v[152:155], v[160:163], v[72:75]
v_mfma_f32_16x16x32_bf16 v[104:107], v[152:155], v[164:167], v[104:107]
v_mfma_f32_16x16x32_bf16 v[88:91], v[152:155], v[168:171], v[88:91]
v_mfma_f32_16x16x32_bf16 v[120:123], v[152:155], v[172:175], v[120:123]
v_mfma_f32_16x16x32_bf16 v[76:79], v[156:159], v[160:163], v[76:79]
v_mfma_f32_16x16x32_bf16 v[108:111], v[156:159], v[164:167], v[108:111]
v_mfma_f32_16x16x32_bf16 v[92:95], v[156:159], v[168:171], v[92:95]
v_mfma_f32_16x16x32_bf16 v[124:127], v[156:159], v[172:175], v[124:127]
s_waitcnt lgkmcnt(6)
v_mfma_f32_16x16x32_bf16 v[64:67], v[32:35], v[48:51], v[64:67]
ds_read_b128 v[144:147], v129 offset:32768
s_waitcnt lgkmcnt(6)
v_mfma_f32_16x16x32_bf16 v[96:99], v[32:35], v[52:55], v[96:99]
ds_read_b128 v[160:163], v131 offset:32768
s_waitcnt lgkmcnt(6)
v_mfma_f32_16x16x32_bf16 v[80:83], v[32:35], v[56:59], v[80:83]
ds_read_b128 v[164:167], v131 offset:34816
s_waitcnt lgkmcnt(6)
v_mfma_f32_16x16x32_bf16 v[112:115], v[32:35], v[60:63], v[112:115]
ds_read_b128 v[168:171], v131 offset:36864
s_waitcnt lgkmcnt(6)
v_mfma_f32_16x16x32_bf16 v[68:71], v[36:39], v[48:51], v[68:71]
ds_read_b128 v[172:175], v131 offset:38912
v_mfma_f32_16x16x32_bf16 v[100:103], v[36:39], v[52:55], v[100:103]
ds_read_b128 v[148:151], v129 offset:34816
v_mfma_f32_16x16x32_bf16 v[84:87], v[36:39], v[56:59], v[84:87]
ds_read_b128 v[152:155], v129 offset:36864
v_mfma_f32_16x16x32_bf16 v[116:119], v[36:39], v[60:63], v[116:119]
ds_read_b128 v[156:159], v129 offset:38912
s_waitcnt lgkmcnt(9)
v_mfma_f32_16x16x32_bf16 v[72:75], v[40:43], v[48:51], v[72:75]
v_mfma_f32_16x16x32_bf16 v[104:107], v[40:43], v[52:55], v[104:107]
v_mfma_f32_16x16x32_bf16 v[88:91], v[40:43], v[56:59], v[88:91]
v_mfma_f32_16x16x32_bf16 v[120:123], v[40:43], v[60:63], v[120:123]
s_waitcnt lgkmcnt(8)
v_mfma_f32_16x16x32_bf16 v[76:79], v[44:47], v[48:51], v[76:79]
v_mfma_f32_16x16x32_bf16 v[108:111], v[44:47], v[52:55], v[108:111]
v_mfma_f32_16x16x32_bf16 v[92:95], v[44:47], v[56:59], v[92:95]
v_mfma_f32_16x16x32_bf16 v[124:127], v[44:47], v[60:63], v[124:127]
s_waitcnt lgkmcnt(0)
s_barrier
v_mfma_f32_16x16x32_bf16 v[64:67], v[144:147], v[160:163], v[64:67]
ds_read_b128 v[32:35], v132 offset:0
v_mfma_f32_16x16x32_bf16 v[96:99], v[144:147], v[164:167], v[96:99]
ds_read_b128 v[48:51], v134 offset:0
v_mfma_f32_16x16x32_bf16 v[80:83], v[144:147], v[168:171], v[80:83]
ds_read_b128 v[52:55], v134 offset:2048
v_mfma_f32_16x16x32_bf16 v[112:115], v[144:147], v[172:175], v[112:115]
ds_read_b128 v[56:59], v134 offset:4096
v_mfma_f32_16x16x32_bf16 v[68:71], v[148:151], v[160:163], v[68:71]
ds_read_b128 v[60:63], v134 offset:6144
v_mfma_f32_16x16x32_bf16 v[100:103], v[148:151], v[164:167], v[100:103]
ds_read_b128 v[36:39], v132 offset:2048
v_mfma_f32_16x16x32_bf16 v[84:87], v[148:151], v[168:171], v[84:87]
ds_read_b128 v[40:43], v132 offset:4096
v_mfma_f32_16x16x32_bf16 v[116:119], v[148:151], v[172:175], v[116:119]
ds_read_b128 v[44:47], v132 offset:6144
v_mfma_f32_16x16x32_bf16 v[72:75], v[152:155], v[160:163], v[72:75]
v_mfma_f32_16x16x32_bf16 v[104:107], v[152:155], v[164:167], v[104:107]
v_mfma_f32_16x16x32_bf16 v[88:91], v[152:155], v[168:171], v[88:91]
v_mfma_f32_16x16x32_bf16 v[120:123], v[152:155], v[172:175], v[120:123]
v_mfma_f32_16x16x32_bf16 v[76:79], v[156:159], v[160:163], v[76:79]
v_mfma_f32_16x16x32_bf16 v[108:111], v[156:159], v[164:167], v[108:111]
v_mfma_f32_16x16x32_bf16 v[92:95], v[156:159], v[168:171], v[92:95]
v_mfma_f32_16x16x32_bf16 v[124:127], v[156:159], v[172:175], v[124:127]
s_waitcnt lgkmcnt(6)
v_mfma_f32_16x16x32_bf16 v[64:67], v[32:35], v[48:51], v[64:67]
ds_read_b128 v[144:147], v133 offset:0
s_waitcnt lgkmcnt(6)
v_mfma_f32_16x16x32_bf16 v[96:99], v[32:35], v[52:55], v[96:99]
ds_read_b128 v[160:163], v135 offset:0
s_waitcnt lgkmcnt(6)
v_mfma_f32_16x16x32_bf16 v[80:83], v[32:35], v[56:59], v[80:83]
ds_read_b128 v[164:167], v135 offset:2048
s_waitcnt lgkmcnt(6)
v_mfma_f32_16x16x32_bf16 v[112:115], v[32:35], v[60:63], v[112:115]
ds_read_b128 v[168:171], v135 offset:4096
s_waitcnt lgkmcnt(6)
v_mfma_f32_16x16x32_bf16 v[68:71], v[36:39], v[48:51], v[68:71]
ds_read_b128 v[172:175], v135 offset:6144
v_mfma_f32_16x16x32_bf16 v[100:103], v[36:39], v[52:55], v[100:103]
ds_read_b128 v[148:151], v133 offset:2048
v_mfma_f32_16x16x32_bf16 v[84:87], v[36:39], v[56:59], v[84:87]
ds_read_b128 v[152:155], v133 offset:4096
v_mfma_f32_16x16x32_bf16 v[116:119], v[36:39], v[60:63], v[116:119]
ds_read_b128 v[156:159], v133 offset:6144
s_waitcnt lgkmcnt(9)
v_mfma_f32_16x16x32_bf16 v[72:75], v[40:43], v[48:51], v[72:75]
v_mfma_f32_16x16x32_bf16 v[104:107], v[40:43], v[52:55], v[104:107]
v_mfma_f32_16x16x32_bf16 v[88:91], v[40:43], v[56:59], v[88:91]
v_mfma_f32_16x16x32_bf16 v[120:123], v[40:43], v[60:63], v[120:123]
s_waitcnt lgkmcnt(8)
v_mfma_f32_16x16x32_bf16 v[76:79], v[44:47], v[48:51], v[76:79]
v_mfma_f32_16x16x32_bf16 v[108:111], v[44:47], v[52:55], v[108:111]
v_mfma_f32_16x16x32_bf16 v[92:95], v[44:47], v[56:59], v[92:95]
v_mfma_f32_16x16x32_bf16 v[124:127], v[44:47], v[60:63], v[124:127]
s_waitcnt lgkmcnt(0)
s_barrier
v_mfma_f32_16x16x32_bf16 v[64:67], v[144:147], v[160:163], v[64:67]
ds_read_b128 v[32:35], v128 offset:0
v_mfma_f32_16x16x32_bf16 v[96:99], v[144:147], v[164:167], v[96:99]
ds_read_b128 v[48:51], v130 offset:0
v_mfma_f32_16x16x32_bf16 v[80:83], v[144:147], v[168:171], v[80:83]
ds_read_b128 v[52:55], v130 offset:2048
v_mfma_f32_16x16x32_bf16 v[112:115], v[144:147], v[172:175], v[112:115]
ds_read_b128 v[56:59], v130 offset:4096
v_mfma_f32_16x16x32_bf16 v[68:71], v[148:151], v[160:163], v[68:71]
ds_read_b128 v[60:63], v130 offset:6144
v_mfma_f32_16x16x32_bf16 v[100:103], v[148:151], v[164:167], v[100:103]
ds_read_b128 v[36:39], v128 offset:2048
v_mfma_f32_16x16x32_bf16 v[84:87], v[148:151], v[168:171], v[84:87]
ds_read_b128 v[40:43], v128 offset:4096
v_mfma_f32_16x16x32_bf16 v[116:119], v[148:151], v[172:175], v[116:119]
ds_read_b128 v[44:47], v128 offset:6144
v_mfma_f32_16x16x32_bf16 v[72:75], v[152:155], v[160:163], v[72:75]
v_mfma_f32_16x16x32_bf16 v[104:107], v[152:155], v[164:167], v[104:107]
v_mfma_f32_16x16x32_bf16 v[88:91], v[152:155], v[168:171], v[88:91]
v_mfma_f32_16x16x32_bf16 v[120:123], v[152:155], v[172:175], v[120:123]
v_mfma_f32_16x16x32_bf16 v[76:79], v[156:159], v[160:163], v[76:79]
v_mfma_f32_16x16x32_bf16 v[108:111], v[156:159], v[164:167], v[108:111]
v_mfma_f32_16x16x32_bf16 v[92:95], v[156:159], v[168:171], v[92:95]
v_mfma_f32_16x16x32_bf16 v[124:127], v[156:159], v[172:175], v[124:127]
s_waitcnt lgkmcnt(6)
v_mfma_f32_16x16x32_bf16 v[64:67], v[32:35], v[48:51], v[64:67]
ds_read_b128 v[144:147], v129 offset:0
s_waitcnt lgkmcnt(6)
v_mfma_f32_16x16x32_bf16 v[96:99], v[32:35], v[52:55], v[96:99]
ds_read_b128 v[160:163], v131 offset:0
s_waitcnt lgkmcnt(6)
v_mfma_f32_16x16x32_bf16 v[80:83], v[32:35], v[56:59], v[80:83]
ds_read_b128 v[164:167], v131 offset:2048
s_waitcnt lgkmcnt(6)
v_mfma_f32_16x16x32_bf16 v[112:115], v[32:35], v[60:63], v[112:115]
ds_read_b128 v[168:171], v131 offset:4096
s_waitcnt lgkmcnt(6)
v_mfma_f32_16x16x32_bf16 v[68:71], v[36:39], v[48:51], v[68:71]
ds_read_b128 v[172:175], v131 offset:6144
v_mfma_f32_16x16x32_bf16 v[100:103], v[36:39], v[52:55], v[100:103]
ds_read_b128 v[148:151], v129 offset:2048
v_mfma_f32_16x16x32_bf16 v[84:87], v[36:39], v[56:59], v[84:87]
ds_read_b128 v[152:155], v129 offset:4096
v_mfma_f32_16x16x32_bf16 v[116:119], v[36:39], v[60:63], v[116:119]
ds_read_b128 v[156:159], v129 offset:6144
s_waitcnt lgkmcnt(9)
v_mfma_f32_16x16x32_bf16 v[72:75], v[40:43], v[48:51], v[72:75]
v_mfma_f32_16x16x32_bf16 v[104:107], v[40:43], v[52:55], v[104:107]
v_mfma_f32_16x16x32_bf16 v[88:91], v[40:43], v[56:59], v[88:91]
v_mfma_f32_16x16x32_bf16 v[120:123], v[40:43], v[60:63], v[120:123]
s_waitcnt lgkmcnt(8)
v_mfma_f32_16x16x32_bf16 v[76:79], v[44:47], v[48:51], v[76:79]
v_mfma_f32_16x16x32_bf16 v[108:111], v[44:47], v[52:55], v[108:111]
v_mfma_f32_16x16x32_bf16 v[92:95], v[44:47], v[56:59], v[92:95]
v_mfma_f32_16x16x32_bf16 v[124:127], v[44:47], v[60:63], v[124:127]
s_waitcnt lgkmcnt(0)
s_barrier
v_mfma_f32_16x16x32_bf16 v[64:67], v[144:147], v[160:163], v[64:67]
ds_read_b128 v[32:35], v128 offset:32768
v_mfma_f32_16x16x32_bf16 v[96:99], v[144:147], v[164:167], v[96:99]
ds_read_b128 v[48:51], v130 offset:32768
v_mfma_f32_16x16x32_bf16 v[80:83], v[144:147], v[168:171], v[80:83]
ds_read_b128 v[52:55], v130 offset:34816
v_mfma_f32_16x16x32_bf16 v[112:115], v[144:147], v[172:175], v[112:115]
ds_read_b128 v[56:59], v130 offset:36864
v_mfma_f32_16x16x32_bf16 v[68:71], v[148:151], v[160:163], v[68:71]
ds_read_b128 v[60:63], v130 offset:38912
v_mfma_f32_16x16x32_bf16 v[100:103], v[148:151], v[164:167], v[100:103]
ds_read_b128 v[36:39], v128 offset:34816
v_mfma_f32_16x16x32_bf16 v[84:87], v[148:151], v[168:171], v[84:87]
ds_read_b128 v[40:43], v128 offset:36864
v_mfma_f32_16x16x32_bf16 v[116:119], v[148:151], v[172:175], v[116:119]
ds_read_b128 v[44:47], v128 offset:38912
v_mfma_f32_16x16x32_bf16 v[72:75], v[152:155], v[160:163], v[72:75]
v_mfma_f32_16x16x32_bf16 v[104:107], v[152:155], v[164:167], v[104:107]
v_mfma_f32_16x16x32_bf16 v[88:91], v[152:155], v[168:171], v[88:91]
v_mfma_f32_16x16x32_bf16 v[120:123], v[152:155], v[172:175], v[120:123]
v_mfma_f32_16x16x32_bf16 v[76:79], v[156:159], v[160:163], v[76:79]
v_mfma_f32_16x16x32_bf16 v[108:111], v[156:159], v[164:167], v[108:111]
v_mfma_f32_16x16x32_bf16 v[92:95], v[156:159], v[168:171], v[92:95]
v_mfma_f32_16x16x32_bf16 v[124:127], v[156:159], v[172:175], v[124:127]
v_mov_b32 v8, 0
global_load_dword v9, v8, s[30:31] sc1
s_waitcnt lgkmcnt(6)
v_mfma_f32_16x16x32_bf16 v[64:67], v[32:35], v[48:51], v[64:67]
ds_read_b128 v[144:147], v129 offset:32768
s_waitcnt lgkmcnt(6)
v_mfma_f32_16x16x32_bf16 v[96:99], v[32:35], v[52:55], v[96:99]
ds_read_b128 v[160:163], v131 offset:32768
s_waitcnt lgkmcnt(6)
v_mfma_f32_16x16x32_bf16 v[80:83], v[32:35], v[56:59], v[80:83]
ds_read_b128 v[164:167], v131 offset:34816
s_waitcnt lgkmcnt(6)
v_mfma_f32_16x16x32_bf16 v[112:115], v[32:35], v[60:63], v[112:115]
ds_read_b128 v[168:171], v131 offset:36864
s_waitcnt lgkmcnt(6)
v_mfma_f32_16x16x32_bf16 v[68:71], v[36:39], v[48:51], v[68:71]
ds_read_b128 v[172:175], v131 offset:38912
v_mfma_f32_16x16x32_bf16 v[100:103], v[36:39], v[52:55], v[100:103]
ds_read_b128 v[148:151], v129 offset:34816
v_mfma_f32_16x16x32_bf16 v[84:87], v[36:39], v[56:59], v[84:87]
ds_read_b128 v[152:155], v129 offset:36864
v_mfma_f32_16x16x32_bf16 v[116:119], v[36:39], v[60:63], v[116:119]
ds_read_b128 v[156:159], v129 offset:38912
s_waitcnt lgkmcnt(9)
v_mfma_f32_16x16x32_bf16 v[72:75], v[40:43], v[48:51], v[72:75]
v_mfma_f32_16x16x32_bf16 v[104:107], v[40:43], v[52:55], v[104:107]
v_mfma_f32_16x16x32_bf16 v[88:91], v[40:43], v[56:59], v[88:91]
v_mfma_f32_16x16x32_bf16 v[120:123], v[40:43], v[60:63], v[120:123]
s_waitcnt lgkmcnt(8)
v_mfma_f32_16x16x32_bf16 v[76:79], v[44:47], v[48:51], v[76:79]
v_mfma_f32_16x16x32_bf16 v[108:111], v[44:47], v[52:55], v[108:111]
v_mfma_f32_16x16x32_bf16 v[92:95], v[44:47], v[56:59], v[92:95]
v_mfma_f32_16x16x32_bf16 v[124:127], v[44:47], v[60:63], v[124:127]
s_waitcnt lgkmcnt(0)
s_barrier
v_mfma_f32_16x16x32_bf16 v[64:67], v[144:147], v[160:163], v[64:67]
ds_read_b128 v[32:35], v132 offset:0
v_mfma_f32_16x16x32_bf16 v[96:99], v[144:147], v[164:167], v[96:99]
ds_read_b128 v[48:51], v134 offset:0
v_mfma_f32_16x16x32_bf16 v[80:83], v[144:147], v[168:171], v[80:83]
ds_read_b128 v[52:55], v134 offset:2048
v_mfma_f32_16x16x32_bf16 v[112:115], v[144:147], v[172:175], v[112:115]
ds_read_b128 v[56:59], v134 offset:4096
v_mfma_f32_16x16x32_bf16 v[68:71], v[148:151], v[160:163], v[68:71]
ds_read_b128 v[60:63], v134 offset:6144
v_mfma_f32_16x16x32_bf16 v[100:103], v[148:151], v[164:167], v[100:103]
ds_read_b128 v[36:39], v132 offset:2048
v_mfma_f32_16x16x32_bf16 v[84:87], v[148:151], v[168:171], v[84:87]
ds_read_b128 v[40:43], v132 offset:4096
v_mfma_f32_16x16x32_bf16 v[116:119], v[148:151], v[172:175], v[116:119]
ds_read_b128 v[44:47], v132 offset:6144
v_mfma_f32_16x16x32_bf16 v[72:75], v[152:155], v[160:163], v[72:75]
v_mfma_f32_16x16x32_bf16 v[104:107], v[152:155], v[164:167], v[104:107]
v_mfma_f32_16x16x32_bf16 v[88:91], v[152:155], v[168:171], v[88:91]
v_mfma_f32_16x16x32_bf16 v[120:123], v[152:155], v[172:175], v[120:123]
v_mfma_f32_16x16x32_bf16 v[76:79], v[156:159], v[160:163], v[76:79]
v_mfma_f32_16x16x32_bf16 v[108:111], v[156:159], v[164:167], v[108:111]
v_mfma_f32_16x16x32_bf16 v[92:95], v[156:159], v[168:171], v[92:95]
v_mfma_f32_16x16x32_bf16 v[124:127], v[156:159], v[172:175], v[124:127]
s_waitcnt lgkmcnt(6)
v_mfma_f32_16x16x32_bf16 v[64:67], v[32:35], v[48:51], v[64:67]
ds_read_b128 v[144:147], v133 offset:0
s_waitcnt lgkmcnt(6)
v_mfma_f32_16x16x32_bf16 v[96:99], v[32:35], v[52:55], v[96:99]
ds_read_b128 v[160:163], v135 offset:0
s_waitcnt lgkmcnt(6)
v_mfma_f32_16x16x32_bf16 v[80:83], v[32:35], v[56:59], v[80:83]
ds_read_b128 v[164:167], v135 offset:2048
s_waitcnt lgkmcnt(6)
v_mfma_f32_16x16x32_bf16 v[112:115], v[32:35], v[60:63], v[112:115]
ds_read_b128 v[168:171], v135 offset:4096
s_waitcnt lgkmcnt(6)
v_mfma_f32_16x16x32_bf16 v[68:71], v[36:39], v[48:51], v[68:71]
ds_read_b128 v[172:175], v135 offset:6144
v_mfma_f32_16x16x32_bf16 v[100:103], v[36:39], v[52:55], v[100:103]
ds_read_b128 v[148:151], v133 offset:2048
v_mfma_f32_16x16x32_bf16 v[84:87], v[36:39], v[56:59], v[84:87]
ds_read_b128 v[152:155], v133 offset:4096
v_mfma_f32_16x16x32_bf16 v[116:119], v[36:39], v[60:63], v[116:119]
ds_read_b128 v[156:159], v133 offset:6144
s_waitcnt lgkmcnt(9)
v_mfma_f32_16x16x32_bf16 v[72:75], v[40:43], v[48:51], v[72:75]
v_mfma_f32_16x16x32_bf16 v[104:107], v[40:43], v[52:55], v[104:107]
v_mfma_f32_16x16x32_bf16 v[88:91], v[40:43], v[56:59], v[88:91]
v_mfma_f32_16x16x32_bf16 v[120:123], v[40:43], v[60:63], v[120:123]
s_waitcnt lgkmcnt(8)
v_mfma_f32_16x16x32_bf16 v[76:79], v[44:47], v[48:51], v[76:79]
v_mfma_f32_16x16x32_bf16 v[108:111], v[44:47], v[52:55], v[108:111]
v_mfma_f32_16x16x32_bf16 v[92:95], v[44:47], v[56:59], v[92:95]
v_mfma_f32_16x16x32_bf16 v[124:127], v[44:47], v[60:63], v[124:127]
s_waitcnt lgkmcnt(0)
s_barrier
v_mfma_f32_16x16x32_bf16 v[64:67], v[144:147], v[160:163], v[64:67]
ds_read_b128 v[32:35], v128 offset:0
v_mfma_f32_16x16x32_bf16 v[96:99], v[144:147], v[164:167], v[96:99]
ds_read_b128 v[48:51], v130 offset:0
v_mfma_f32_16x16x32_bf16 v[80:83], v[144:147], v[168:171], v[80:83]
ds_read_b128 v[52:55], v130 offset:2048
v_mfma_f32_16x16x32_bf16 v[112:115], v[144:147], v[172:175], v[112:115]
ds_read_b128 v[56:59], v130 offset:4096
v_mfma_f32_16x16x32_bf16 v[68:71], v[148:151], v[160:163], v[68:71]
ds_read_b128 v[60:63], v130 offset:6144
v_mfma_f32_16x16x32_bf16 v[100:103], v[148:151], v[164:167], v[100:103]
ds_read_b128 v[36:39], v128 offset:2048
v_mfma_f32_16x16x32_bf16 v[84:87], v[148:151], v[168:171], v[84:87]
ds_read_b128 v[40:43], v128 offset:4096
v_mfma_f32_16x16x32_bf16 v[116:119], v[148:151], v[172:175], v[116:119]
ds_read_b128 v[44:47], v128 offset:6144
v_mfma_f32_16x16x32_bf16 v[72:75], v[152:155], v[160:163], v[72:75]
v_mfma_f32_16x16x32_bf16 v[104:107], v[152:155], v[164:167], v[104:107]
v_mfma_f32_16x16x32_bf16 v[88:91], v[152:155], v[168:171], v[88:91]
v_mfma_f32_16x16x32_bf16 v[120:123], v[152:155], v[172:175], v[120:123]
v_mfma_f32_16x16x32_bf16 v[76:79], v[156:159], v[160:163], v[76:79]
v_mfma_f32_16x16x32_bf16 v[108:111], v[156:159], v[164:167], v[108:111]
v_mfma_f32_16x16x32_bf16 v[92:95], v[156:159], v[168:171], v[92:95]
v_mfma_f32_16x16x32_bf16 v[124:127], v[156:159], v[172:175], v[124:127]
s_waitcnt lgkmcnt(6)
v_mfma_f32_16x16x32_bf16 v[64:67], v[32:35], v[48:51], v[64:67]
ds_read_b128 v[144:147], v129 offset:0
s_waitcnt lgkmcnt(6)
v_mfma_f32_16x16x32_bf16 v[96:99], v[32:35], v[52:55], v[96:99]
ds_read_b128 v[160:163], v131 offset:0
s_waitcnt lgkmcnt(6)
v_mfma_f32_16x16x32_bf16 v[80:83], v[32:35], v[56:59], v[80:83]
ds_read_b128 v[164:167], v131 offset:2048
s_waitcnt lgkmcnt(6)
v_mfma_f32_16x16x32_bf16 v[112:115], v[32:35], v[60:63], v[112:115]
ds_read_b128 v[168:171], v131 offset:4096
s_waitcnt lgkmcnt(6)
v_mfma_f32_16x16x32_bf16 v[68:71], v[36:39], v[48:51], v[68:71]
ds_read_b128 v[172:175], v131 offset:6144
v_mfma_f32_16x16x32_bf16 v[100:103], v[36:39], v[52:55], v[100:103]
ds_read_b128 v[148:151], v129 offset:2048
v_mfma_f32_16x16x32_bf16 v[84:87], v[36:39], v[56:59], v[84:87]
ds_read_b128 v[152:155], v129 offset:4096
v_mfma_f32_16x16x32_bf16 v[116:119], v[36:39], v[60:63], v[116:119]
ds_read_b128 v[156:159], v129 offset:6144
s_waitcnt lgkmcnt(9)
v_mfma_f32_16x16x32_bf16 v[72:75], v[40:43], v[48:51], v[72:75]
v_mfma_f32_16x16x32_bf16 v[104:107], v[40:43], v[52:55], v[104:107]
v_mfma_f32_16x16x32_bf16 v[88:91], v[40:43], v[56:59], v[88:91]
v_mfma_f32_16x16x32_bf16 v[120:123], v[40:43], v[60:63], v[120:123]
s_waitcnt lgkmcnt(8)
v_mfma_f32_16x16x32_bf16 v[76:79], v[44:47], v[48:51], v[76:79]
v_mfma_f32_16x16x32_bf16 v[108:111], v[44:47], v[52:55], v[108:111]
v_mfma_f32_16x16x32_bf16 v[92:95], v[44:47], v[56:59], v[92:95]
v_mfma_f32_16x16x32_bf16 v[124:127], v[44:47], v[60:63], v[124:127]
L_n46:
s_waitcnt vmcnt(0)
v_readfirstlane_b32 s37, v9
s_nop 0
s_cmp_lg_u32 s37, 0
s_cbranch_scc1 L_ng47
global_load_dword v9, v8, s[30:31] sc1
s_branch L_n46
L_ng47:
s_getreg_b32 s60, hwreg(HW_REG_XCC_ID, 0, 4)
s_lshl_b32 s61, s37, 4
s_or_b32 s100, s60, s61
v_mov_b32 v194, s100
v_mov_b32 v202, s37
v_mov_b32 v203, s37
s_waitcnt lgkmcnt(0)
s_barrier
v_mfma_f32_16x16x32_bf16 v[64:67], v[144:147], v[160:163], v[64:67]
v_mfma_f32_16x16x32_bf16 v[96:99], v[144:147], v[164:167], v[96:99]
v_mfma_f32_16x16x32_bf16 v[80:83], v[144:147], v[168:171], v[80:83]
v_mfma_f32_16x16x32_bf16 v[112:115], v[144:147], v[172:175], v[112:115]
v_mfma_f32_16x16x32_bf16 v[68:71], v[148:151], v[160:163], v[68:71]
v_mfma_f32_16x16x32_bf16 v[100:103], v[148:151], v[164:167], v[100:103]
v_mfma_f32_16x16x32_bf16 v[84:87], v[148:151], v[168:171], v[84:87]
v_mfma_f32_16x16x32_bf16 v[116:119], v[148:151], v[172:175], v[116:119]
v_mfma_f32_16x16x32_bf16 v[72:75], v[152:155], v[160:163], v[72:75]
v_mfma_f32_16x16x32_bf16 v[104:107], v[152:155], v[164:167], v[104:107]
v_mfma_f32_16x16x32_bf16 v[88:91], v[152:155], v[168:171], v[88:91]
v_mfma_f32_16x16x32_bf16 v[120:123], v[152:155], v[172:175], v[120:123]
v_mfma_f32_16x16x32_bf16 v[76:79], v[156:159], v[160:163], v[76:79]
v_mfma_f32_16x16x32_bf16 v[108:111], v[156:159], v[164:167], v[108:111]
v_mfma_f32_16x16x32_bf16 v[92:95], v[156:159], v[168:171], v[92:95]
v_mfma_f32_16x16x32_bf16 v[124:127], v[156:159], v[172:175], v[124:127]
v_pk_fma_f32 v[40:41], v[20:21], v[64:65], v[66:67] op_sel_hi:[0,1,1]
v_pk_fma_f32 v[42:43], v[20:21], v[80:81], v[82:83] op_sel_hi:[0,1,1]
v_pk_fma_f32 v[44:45], v[22:23], v[96:97], v[98:99] op_sel_hi:[0,1,1]
v_pk_fma_f32 v[46:47], v[22:23], v[112:113], v[114:115] op_sel_hi:[0,1,1]
v_pk_fma_f32 v[66:67], v[20:21], v[80:81], v[40:41] op_sel:[1,0,0] neg_lo:[1,0,0] neg_hi:[1,0,0]
v_pk_fma_f32 v[82:83], v[20:21], v[64:65], v[42:43] op_sel:[1,0,0]
v_pk_fma_f32 v[98:99], v[22:23], v[112:113], v[44:45] op_sel:[1,0,0] neg_lo:[1,0,0] neg_hi:[1,0,0]
v_pk_fma_f32 v[114:115], v[22:23], v[96:97], v[46:47] op_sel:[1,0,0]
v_pk_fma_f32 v[40:41], v[20:21], v[66:67], v[68:69] op_sel_hi:[0,1,1]
v_pk_fma_f32 v[42:43], v[20:21], v[82:83], v[84:85] op_sel_hi:[0,1,1]
v_pk_fma_f32 v[44:45], v[22:23], v[98:99], v[100:101] op_sel_hi:[0,1,1]
v_pk_fma_f32 v[46:47], v[22:23], v[114:115], v[116:117] op_sel_hi:[0,1,1]
v_pk_fma_f32 v[68:69], v[20:21], v[82:83], v[40:41] op_sel:[1,0,0] neg_lo:[1,0,0] neg_hi:[1,0,0]
v_pk_fma_f32 v[84:85], v[20:21], v[66:67], v[42:43] op_sel:[1,0,0]
v_pk_fma_f32 v[100:101], v[22:23], v[114:115], v[44:45] op_sel:[1,0,0] neg_lo:[1,0,0] neg_hi:[1,0,0]
v_pk_fma_f32 v[116:117], v[22:23], v[98:99], v[46:47] op_sel:[1,0,0]
v_pk_fma_f32 v[40:41], v[20:21], v[68:69], v[70:71] op_sel_hi:[0,1,1]
v_pk_fma_f32 v[42:43], v[20:21], v[84:85], v[86:87] op_sel_hi:[0,1,1]
v_pk_fma_f32 v[44:45], v[22:23], v[100:101], v[102:103] op_sel_hi:[0,1,1]
v_pk_fma_f32 v[46:47], v[22:23], v[116:117], v[118:119] op_sel_hi:[0,1,1]
v_pk_fma_f32 v[70:71], v[20:21], v[84:85], v[40:41] op_sel:[1,0,0] neg_lo:[1,0,0] neg_hi:[1,0,0]
v_pk_fma_f32 v[86:87], v[20:21], v[68:69], v[42:43] op_sel:[1,0,0]
v_pk_fma_f32 v[102:103], v[22:23], v[116:117], v[44:45] op_sel:[1,0,0] neg_lo:[1,0,0] neg_hi:[1,0,0]
v_pk_fma_f32 v[118:119], v[22:23], v[100:101], v[46:47] op_sel:[1,0,0]
v_pk_fma_f32 v[40:41], v[20:21], v[70:71], v[72:73] op_sel_hi:[0,1,1]
v_pk_fma_f32 v[42:43], v[20:21], v[86:87], v[88:89] op_sel_hi:[0,1,1]
v_pk_fma_f32 v[44:45], v[22:23], v[102:103], v[104:105] op_sel_hi:[0,1,1]
v_pk_fma_f32 v[46:47], v[22:23], v[118:119], v[120:121] op_sel_hi:[0,1,1]
v_pk_fma_f32 v[72:73], v[20:21], v[86:87], v[40:41] op_sel:[1,0,0] neg_lo:[1,0,0] neg_hi:[1,0,0]
v_pk_fma_f32 v[88:89], v[20:21], v[70:71], v[42:43] op_sel:[1,0,0]
v_pk_fma_f32 v[104:105], v[22:23], v[118:119], v[44:45] op_sel:[1,0,0] neg_lo:[1,0,0] neg_hi:[1,0,0]
v_pk_fma_f32 v[120:121], v[22:23], v[102:103], v[46:47] op_sel:[1,0,0]
v_pk_fma_f32 v[40:41], v[20:21], v[72:73], v[74:75] op_sel_hi:[0,1,1]
v_pk_fma_f32 v[42:43], v[20:21], v[88:89], v[90:91] op_sel_hi:[0,1,1]
v_pk_fma_f32 v[44:45], v[22:23], v[104:105], v[106:107] op_sel_hi:[0,1,1]
v_pk_fma_f32 v[46:47], v[22:23], v[120:121], v[122:123] op_sel_hi:[0,1,1]
v_pk_fma_f32 v[74:75], v[20:21], v[88:89], v[40:41] op_sel:[1,0,0] neg_lo:[1,0,0] neg_hi:[1,0,0]
v_pk_fma_f32 v[90:91], v[20:21], v[72:73], v[42:43] op_sel:[1,0,0]
v_pk_fma_f32 v[106:107], v[22:23], v[120:121], v[44:45] op_sel:[1,0,0] neg_lo:[1,0,0] neg_hi:[1,0,0]
v_pk_fma_f32 v[122:123], v[22:23], v[104:105], v[46:47] op_sel:[1,0,0]
v_pk_fma_f32 v[40:41], v[20:21], v[74:75], v[76:77] op_sel_hi:[0,1,1]
v_pk_fma_f32 v[42:43], v[20:21], v[90:91], v[92:93] op_sel_hi:[0,1,1]
v_pk_fma_f32 v[44:45], v[22:23], v[106:107], v[108:109] op_sel_hi:[0,1,1]
v_pk_fma_f32 v[46:47], v[22:23], v[122:123], v[124:125] op_sel_hi:[0,1,1]
v_pk_fma_f32 v[76:77], v[20:21], v[90:91], v[40:41] op_sel:[1,0,0] neg_lo:[1,0,0] neg_hi:[1,0,0]
v_pk_fma_f32 v[92:93], v[20:21], v[74:75], v[42:43] op_sel:[1,0,0]
v_pk_fma_f32 v[108:109], v[22:23], v[122:123], v[44:45] op_sel:[1,0,0] neg_lo:[1,0,0] neg_hi:[1,0,0]
v_pk_fma_f32 v[124:125], v[22:23], v[106:107], v[46:47] op_sel:[1,0,0]
v_pk_fma_f32 v[40:41], v[20:21], v[76:77], v[78:79] op_sel_hi:[0,1,1]
v_pk_fma_f32 v[42:43], v[20:21], v[92:93], v[94:95] op_sel_hi:[0,1,1]
v_pk_fma_f32 v[44:45], v[22:23], v[108:109], v[110:111] op_sel_hi:[0,1,1]
v_pk_fma_f32 v[46:47], v[22:23], v[124:125], v[126:127] op_sel_hi:[0,1,1]
v_pk_fma_f32 v[78:79], v[20:21], v[92:93], v[40:41] op_sel:[1,0,0] neg_lo:[1,0,0] neg_hi:[1,0,0]
v_pk_fma_f32 v[94:95], v[20:21], v[76:77], v[42:43] op_sel:[1,0,0]
v_pk_fma_f32 v[110:111], v[22:23], v[124:125], v[44:45] op_sel:[1,0,0] neg_lo:[1,0,0] neg_hi:[1,0,0]
v_pk_fma_f32 v[126:127], v[22:23], v[108:109], v[46:47] op_sel:[1,0,0]
v_fma_f32 v40, v176, v78, v79
v_fma_f32 v41, v176, v94, v95
v_fma_f32 v32, -v177, v94, v40
v_fma_f32 v33, v177, v78, v41
ds_write_b64 v15, v[32:33] offset:0
v_fma_f32 v40, v178, v110, v111
v_fma_f32 v41, v178, v126, v127
v_fma_f32 v34, -v179, v126, v40
v_fma_f32 v35, v179, v110, v41
ds_write_b64 v15, v[34:35] offset:2304
s_waitcnt lgkmcnt(0)
s_barrier
ds_read_b128 v[48:51], v14
ds_read_b128 v[52:55], v14 offset:16
s_waitcnt lgkmcnt(1)
v_fma_f32 v40, v28, v48, v50
v_fma_f32 v41, v28, v49, v51
v_fma_f32 v32, -v29, v49, v40
v_fma_f32 v33, v29, v48, v41
s_waitcnt lgkmcnt(0)
v_fma_f32 v40, v28, v32, v52
v_fma_f32 v41, v28, v33, v53
v_fma_f32 v34, -v29, v33, v40
v_fma_f32 v35, v29, v32, v41
v_fma_f32 v40, v28, v34, v54
v_fma_f32 v41, v28, v35, v55
v_fma_f32 v32, -v29, v35, v40
v_fma_f32 v33, v29, v34, v41
v_mov_b32 v34, v32
v_mov_b32 v35, v33
s_nop 0
v_permlane32_swap_b32 v32, v34
v_permlane32_swap_b32 v33, v35
v_fma_f32 v40, v192, v32, v34
v_fma_f32 v41, v192, v33, v35
v_fma_f32 v200, -v193, v33, v40
v_fma_f32 v201, v193, v32, v41
s_cmp_lg_u32 s68, 0
s_cbranch_scc1 L_np48
buffer_store_dwordx4 v[200:203], v16, s[40:43], 0 offen sc1
s_cmp_lg_u32 s66, 0
s_cbranch_scc1 L_np48
s_mov_b64 exec, 1
global_store_dword v195, v194, s[32:33] sc1
s_mov_b64 exec, -1
L_np48:
global_load_dword v243, v18, s[32:33] sc1
v_add_u32 v15, -56, v15
ds_read_b64 v[32:33], v15 offset:0
ds_read_b64 v[34:35], v15 offset:8
ds_read_b64 v[36:37], v15 offset:16
ds_read_b64 v[38:39], v15 offset:24
ds_read_b64 v[40:41], v15 offset:32
ds_read_b64 v[42:43], v15 offset:40
ds_read_b64 v[44:45], v15 offset:48
ds_read_b64 v[46:47], v15 offset:2304
ds_read_b64 v[48:49], v15 offset:2312
ds_read_b64 v[50:51], v15 offset:2320
ds_read_b64 v[52:53], v15 offset:2328
ds_read_b64 v[54:55], v15 offset:2336
ds_read_b64 v[56:57], v15 offset:2344
ds_read_b64 v[58:59], v15 offset:2352
s_waitcnt lgkmcnt(0)
v_fma_f32 v60, v180, v32, v34
v_fma_f32 v61, v180, v33, v35
v_fma_f32 v34, -v181, v33, v60
v_fma_f32 v35, v181, v32, v61
v_fma_f32 v60, v180, v34, v36
v_fma_f32 v61, v180, v35, v37
v_fma_f32 v36, -v181, v35, v60
v_fma_f32 v37, v181, v34, v61
v_fma_f32 v60, v180, v36, v38
v_fma_f32 v61, v180, v37, v39
v_fma_f32 v38, -v181, v37, v60
v_fma_f32 v39, v181, v36, v61
v_fma_f32 v60, v180, v38, v40
v_fma_f32 v61, v180, v39, v41
v_fma_f32 v40, -v181, v39, v60
v_fma_f32 v41, v181, v38, v61
v_fma_f32 v60, v180, v40, v42
v_fma_f32 v61, v180, v41, v43
v_fma_f32 v42, -v181, v41, v60
v_fma_f32 v43, v181, v40, v61
v_fma_f32 v60, v180, v42, v44
v_fma_f32 v61, v180, v43, v45
v_fma_f32 v128, -v181, v43, v60
v_fma_f32 v130, v181, v42, v61
v_fma_f32 v60, v176, v128, v78
v_fma_f32 v61, v176, v130, v94
v_fma_f32 v129, -v177, v130, v60
v_fma_f32 v131, v177, v128, v61
v_fma_f32 v60, v182, v46, v48
v_fma_f32 v61, v182, v47, v49
v_fma_f32 v48, -v183, v47, v60
v_fma_f32 v49, v183, v46, v61
v_fma_f32 v60, v182, v48, v50
v_fma_f32 v61, v182, v49, v51
v_fma_f32 v50, -v183, v49, v60
v_fma_f32 v51, v183, v48, v61
v_fma_f32 v60, v182, v50, v52
v_fma_f32 v61, v182, v51, v53
v_fma_f32 v52, -v183, v51, v60
v_fma_f32 v53, v183, v50, v61
v_fma_f32 v60, v182, v52, v54
v_fma_f32 v61, v182, v53, v55
v_fma_f32 v54, -v183, v53, v60
v_fma_f32 v55, v183, v52, v61
v_fma_f32 v60, v182, v54, v56
v_fma_f32 v61, v182, v55, v57
v_fma_f32 v56, -v183, v55, v60
v_fma_f32 v57, v183, v54, v61
v_fma_f32 v60, v182, v56, v58
v_fma_f32 v61, v182, v57, v59
v_fma_f32 v132, -v183, v57, v60
v_fma_f32 v134, v183, v56, v61
v_fma_f32 v60, v178, v132, v110
v_fma_f32 v61, v178, v134, v126
v_fma_f32 v133, -v179, v134, v60
v_fma_f32 v135, v179, v132, v61
v_pk_mul_f32 v[32:33], v[24:25], v[64:65] op_sel_hi:[0,1]
v_pk_mul_f32 v[34:35], v[24:25], v[80:81] op_sel_hi:[0,1] neg_lo:[1,0] neg_hi:[1,0]
v_pk_fma_f32 v[34:35], v[24:25], v[64:65], v[34:35] op_sel:[1,0,0] neg_lo:[1,0,0] neg_hi:[1,0,0]
v_pk_fma_f32 v[64:65], v[24:25], v[80:81], v[32:33] op_sel:[1,0,0] neg_lo:[1,0,0] neg_hi:[1,0,0]
v_mov_b64 v[80:81], v[34:35]
v_pk_mul_f32 v[36:37], v[26:27], v[96:97] op_sel_hi:[0,1]
v_pk_mul_f32 v[38:39], v[26:27], v[112:113] op_sel_hi:[0,1] neg_lo:[1,0] neg_hi:[1,0]
v_pk_fma_f32 v[38:39], v[26:27], v[96:97], v[38:39] op_sel:[1,0,0] neg_lo:[1,0,0] neg_hi:[1,0,0]
v_pk_fma_f32 v[96:97], v[26:27], v[112:113], v[36:37] op_sel:[1,0,0] neg_lo:[1,0,0] neg_hi:[1,0,0]
v_mov_b64 v[112:113], v[38:39]
v_pk_mul_f32 v[32:33], v[24:25], v[66:67] op_sel_hi:[0,1]
v_pk_mul_f32 v[34:35], v[24:25], v[82:83] op_sel_hi:[0,1] neg_lo:[1,0] neg_hi:[1,0]
v_pk_fma_f32 v[34:35], v[24:25], v[66:67], v[34:35] op_sel:[1,0,0] neg_lo:[1,0,0] neg_hi:[1,0,0]
v_pk_fma_f32 v[66:67], v[24:25], v[82:83], v[32:33] op_sel:[1,0,0] neg_lo:[1,0,0] neg_hi:[1,0,0]
v_mov_b64 v[82:83], v[34:35]
v_pk_mul_f32 v[36:37], v[26:27], v[98:99] op_sel_hi:[0,1]
v_pk_mul_f32 v[38:39], v[26:27], v[114:115] op_sel_hi:[0,1] neg_lo:[1,0] neg_hi:[1,0]
v_pk_fma_f32 v[38:39], v[26:27], v[98:99], v[38:39] op_sel:[1,0,0] neg_lo:[1,0,0] neg_hi:[1,0,0]
v_pk_fma_f32 v[98:99], v[26:27], v[114:115], v[36:37] op_sel:[1,0,0] neg_lo:[1,0,0] neg_hi:[1,0,0]
v_mov_b64 v[114:115], v[38:39]
v_pk_mul_f32 v[32:33], v[24:25], v[68:69] op_sel_hi:[0,1]
v_pk_mul_f32 v[34:35], v[24:25], v[84:85] op_sel_hi:[0,1] neg_lo:[1,0] neg_hi:[1,0]
v_pk_fma_f32 v[34:35], v[24:25], v[68:69], v[34:35] op_sel:[1,0,0] neg_lo:[1,0,0] neg_hi:[1,0,0]
v_pk_fma_f32 v[68:69], v[24:25], v[84:85], v[32:33] op_sel:[1,0,0] neg_lo:[1,0,0] neg_hi:[1,0,0]
v_mov_b64 v[84:85], v[34:35]
v_pk_mul_f32 v[36:37], v[26:27], v[100:101] op_sel_hi:[0,1]
v_pk_mul_f32 v[38:39], v[26:27], v[116:117] op_sel_hi:[0,1] neg_lo:[1,0] neg_hi:[1,0]
v_pk_fma_f32 v[38:39], v[26:27], v[100:101], v[38:39] op_sel:[1,0,0] neg_lo:[1,0,0] neg_hi:[1,0,0]
v_pk_fma_f32 v[100:101], v[26:27], v[116:117], v[36:37] op_sel:[1,0,0] neg_lo:[1,0,0] neg_hi:[1,0,0]
v_mov_b64 v[116:117], v[38:39]
v_pk_mul_f32 v[32:33], v[24:25], v[70:71] op_sel_hi:[0,1]
v_pk_mul_f32 v[34:35], v[24:25], v[86:87] op_sel_hi:[0,1] neg_lo:[1,0] neg_hi:[1,0]
v_pk_fma_f32 v[34:35], v[24:25], v[70:71], v[34:35] op_sel:[1,0,0] neg_lo:[1,0,0] neg_hi:[1,0,0]
v_pk_fma_f32 v[70:71], v[24:25], v[86:87], v[32:33] op_sel:[1,0,0] neg_lo:[1,0,0] neg_hi:[1,0,0]
v_mov_b64 v[86:87], v[34:35]
v_pk_mul_f32 v[36:37], v[26:27], v[102:103] op_sel_hi:[0,1]
v_pk_mul_f32 v[38:39], v[26:27], v[118:119] op_sel_hi:[0,1] neg_lo:[1,0] neg_hi:[1,0]
v_pk_fma_f32 v[38:39], v[26:27], v[102:103], v[38:39] op_sel:[1,0,0] neg_lo:[1,0,0] neg_hi:[1,0,0]
v_pk_fma_f32 v[102:103], v[26:27], v[118:119], v[36:37] op_sel:[1,0,0] neg_lo:[1,0,0] neg_hi:[1,0,0]
v_mov_b64 v[118:119], v[38:39]
v_pk_mul_f32 v[32:33], v[24:25], v[72:73] op_sel_hi:[0,1]
v_pk_mul_f32 v[34:35], v[24:25], v[88:89] op_sel_hi:[0,1] neg_lo:[1,0] neg_hi:[1,0]
v_pk_fma_f32 v[34:35], v[24:25], v[72:73], v[34:35] op_sel:[1,0,0] neg_lo:[1,0,0] neg_hi:[1,0,0]
v_pk_fma_f32 v[72:73], v[24:25], v[88:89], v[32:33] op_sel:[1,0,0] neg_lo:[1,0,0] neg_hi:[1,0,0]
v_mov_b64 v[88:89], v[34:35]
v_pk_mul_f32 v[36:37], v[26:27], v[104:105] op_sel_hi:[0,1]
v_pk_mul_f32 v[38:39], v[26:27], v[120:121] op_sel_hi:[0,1] neg_lo:[1,0] neg_hi:[1,0]
v_pk_fma_f32 v[38:39], v[26:27], v[104:105], v[38:39] op_sel:[1,0,0] neg_lo:[1,0,0] neg_hi:[1,0,0]
v_pk_fma_f32 v[104:105], v[26:27], v[120:121], v[36:37] op_sel:[1,0,0] neg_lo:[1,0,0] neg_hi:[1,0,0]
v_mov_b64 v[120:121], v[38:39]
v_pk_mul_f32 v[32:33], v[24:25], v[74:75] op_sel_hi:[0,1]
v_pk_mul_f32 v[34:35], v[24:25], v[90:91] op_sel_hi:[0,1] neg_lo:[1,0] neg_hi:[1,0]
v_pk_fma_f32 v[34:35], v[24:25], v[74:75], v[34:35] op_sel:[1,0,0] neg_lo:[1,0,0] neg_hi:[1,0,0]
v_pk_fma_f32 v[74:75], v[24:25], v[90:91], v[32:33] op_sel:[1,0,0] neg_lo:[1,0,0] neg_hi:[1,0,0]
v_mov_b64 v[90:91], v[34:35]
v_pk_mul_f32 v[36:37], v[26:27], v[106:107] op_sel_hi:[0,1]
v_pk_mul_f32 v[38:39], v[26:27], v[122:123] op_sel_hi:[0,1] neg_lo:[1,0] neg_hi:[1,0]
v_pk_fma_f32 v[38:39], v[26:27], v[106:107], v[38:39] op_sel:[1,0,0] neg_lo:[1,0,0] neg_hi:[1,0,0]
v_pk_fma_f32 v[106:107], v[26:27], v[122:123], v[36:37] op_sel:[1,0,0] neg_lo:[1,0,0] neg_hi:[1,0,0]
v_mov_b64 v[122:123], v[38:39]
v_pk_mul_f32 v[32:33], v[24:25], v[76:77] op_sel_hi:[0,1]
v_pk_mul_f32 v[34:35], v[24:25], v[92:93] op_sel_hi:[0,1] neg_lo:[1,0] neg_hi:[1,0]
v_pk_fma_f32 v[34:35], v[24:25], v[76:77], v[34:35] op_sel:[1,0,0] neg_lo:[1,0,0] neg_hi:[1,0,0]
v_pk_fma_f32 v[76:77], v[24:25], v[92:93], v[32:33] op_sel:[1,0,0] neg_lo:[1,0,0] neg_hi:[1,0,0]
v_mov_b64 v[92:93], v[34:35]
v_pk_mul_f32 v[36:37], v[26:27], v[108:109] op_sel_hi:[0,1]
v_pk_mul_f32 v[38:39], v[26:27], v[124:125] op_sel_hi:[0,1] neg_lo:[1,0] neg_hi:[1,0]
v_pk_fma_f32 v[38:39], v[26:27], v[108:109], v[38:39] op_sel:[1,0,0] neg_lo:[1,0,0] neg_hi:[1,0,0]
v_pk_fma_f32 v[108:109], v[26:27], v[124:125], v[36:37] op_sel:[1,0,0] neg_lo:[1,0,0] neg_hi:[1,0,0]
v_mov_b64 v[124:125], v[38:39]
v_pk_mul_f32 v[32:33], v[24:25], v[78:79] op_sel_hi:[0,1]
v_pk_mul_f32 v[34:35], v[24:25], v[94:95] op_sel_hi:[0,1] neg_lo:[1,0] neg_hi:[1,0]
v_pk_fma_f32 v[34:35], v[24:25], v[78:79], v[34:35] op_sel:[1,0,0] neg_lo:[1,0,0] neg_hi:[1,0,0]
v_pk_fma_f32 v[78:79], v[24:25], v[94:95], v[32:33] op_sel:[1,0,0] neg_lo:[1,0,0] neg_hi:[1,0,0]
v_mov_b64 v[94:95], v[34:35]
v_pk_mul_f32 v[36:37], v[26:27], v[110:111] op_sel_hi:[0,1]
v_pk_mul_f32 v[38:39], v[26:27], v[126:127] op_sel_hi:[0,1] neg_lo:[1,0] neg_hi:[1,0]
v_pk_fma_f32 v[38:39], v[26:27], v[110:111], v[38:39] op_sel:[1,0,0] neg_lo:[1,0,0] neg_hi:[1,0,0]
v_pk_fma_f32 v[110:111], v[26:27], v[126:127], v[36:37] op_sel:[1,0,0] neg_lo:[1,0,0] neg_hi:[1,0,0]
v_mov_b64 v[126:127], v[38:39]
buffer_load_dwordx4 v[144:147], v136, s[40:43], 0 offen sc1
buffer_load_dwordx4 v[148:151], v137, s[40:43], 0 offen sc1
buffer_load_dwordx4 v[152:155], v138, s[40:43], 0 offen sc1
buffer_load_dwordx4 v[156:159], v139, s[40:43], 0 offen sc1
buffer_load_dwordx4 v[160:163], v140, s[40:43], 0 offen sc1
buffer_load_dwordx4 v[164:167], v141, s[40:43], 0 offen sc1
buffer_load_dwordx4 v[168:171], v142, s[40:43], 0 offen sc1
buffer_load_dwordx4 v[172:175], v143, s[40:43], 0 offen sc1
global_load_dword v197, v196, s[32:33] sc1
v_mov_b32 v14, 1
s_mov_b64 exec, 1
ds_write_b32 v13, v14
s_mov_b64 exec, -1
s_xor_b32 s60, s68, s101
s_xor_b32 s60, s60, 1
s_lshl_b32 s60, s60, 6
s_add_u32 s60, s60, s66
v_lshrrev_b32 v8, 3, v1
v_lshl_add_u32 v8, v8, 1, s60
v_lshlrev_b32 v8, 11, v8
v_and_b32 v14, 7, v1
v_lshrrev_b32 v15, 4, v1
v_xor_b32 v14, v14, v15
v_lshlrev_b32 v14, 4, v14
v_xor_b32 v15, 64, v14
v_add_u32 v244, v8, v14
v_add_u32 v245, v8, v15
v_add_u32 v245, 31744, v245
v_add_u32 v246, v8, v14
v_add_u32 v246, 63488, v246
v_add_u32 v247, v8, v15
v_add_u32 v247, 95232, v247
s_and_b32 s64, s36, 7
s_lshl_b32 s60, s64, 18
s_lshl_b32 s61, s101, 10
s_add_u32 s60, s60, s61
s_add_u32 s48, s20, s60
s_addc_u32 s49, s21, 0
s_sub_u32 s50, 262144, s61
s_mov_b32 s51, 0x20000
s_add_u32 s52, s22, s60
s_addc_u32 s53, s23, 0
s_sub_u32 s54, 262144, s61
s_mov_b32 s55, 0x20000
s_lshl_b32 s61, s64, 1
s_add_u32 s61, s61, s101
s_lshl_b32 s61, s61, 7
s_lshl_b32 s63, s35, 1
s_add_u32 s63, s63, s68
s_lshl_b32 s60, s63, 17
s_add_u32 s60, s60, s61
s_add_u32 s56, s10, s60
s_addc_u32 s57, s11, 0
s_sub_u32 s58, 131072, s61
s_mov_b32 s59, 0x20000
s_add_u32 s26, s26, s61
s_addc_u32 s27, s27, 0
s_lshl_b32 s61, s61, 1
s_add_u32 s61, s61, 4096
s_lshl_b32 s60, s63, 19
s_add_u32 s60, s60, s61
s_add_u32 s28, s28, s60
s_addc_u32 s29, s29, 0
s_sub_u32 s24, 0x80000, s61
s_lshl_b32 s67, s34, 12
s_lshl_b32 s65, s64, 13
s_lshl_b32 s64, s64, 7
s_lshl_b32 s60, s68, 14
s_lshl_b32 s61, s66, 11
s_add_u32 s60, s60, s61
s_add_u32 s60, s60, 65536
v_add_u32 v16, s60, v10
s_lshl_b32 s60, s34, 13
s_add_u32 s60, s60, 65536
v_add_u32 v17, s60, v11
v_xor_b32 v20, 0, v7
v_add_u32 v24, 0x10000, v20
v_xor_b32 v21, 32, v7
v_add_u32 v25, 0x10000, v21
v_xor_b32 v22, 64, v7
v_add_u32 v26, 0x10000, v22
v_xor_b32 v23, 96, v7
v_add_u32 v27, 0x10000, v23
s_mul_i32 s14, s63, 262144
s_lshl_b32 s61, s36, 13
s_add_u32 s14, s14, s61
s_lshl_b32 s61, s66, 11
s_add_u32 s14, s14, s61
v_cmp_gt_u32 vcc, 0x40000, v136
s_nop 1
v_cndmask_b32 v40, 0, v202, vcc
v_cmp_gt_u32 vcc, 0x40000, v137
s_nop 1
v_cndmask_b32 v41, 0, v202, vcc
v_cmp_gt_u32 vcc, 0x40000, v138
s_nop 1
v_cndmask_b32 v42, 0, v202, vcc
v_cmp_gt_u32 vcc, 0x40000, v139
s_nop 1
v_cndmask_b32 v43, 0, v202, vcc
v_cmp_gt_u32 vcc, 0x40000, v140
s_nop 1
v_cndmask_b32 v44, 0, v202, vcc
v_cmp_gt_u32 vcc, 0x40000, v141
s_nop 1
v_cndmask_b32 v45, 0, v202, vcc
v_cmp_gt_u32 vcc, 0x40000, v142
s_nop 1
v_cndmask_b32 v46, 0, v202, vcc
v_cmp_gt_u32 vcc, 0x40000, v143
s_nop 1
v_cndmask_b32 v47, 0, v202, vcc
s_mov_b32 s69, 0
L_poll49:
v_mov_b32 v8, 0
s_waitcnt vmcnt(8)
v_bitop3_b32 v8, v8, v146, v40 bitop3:0xf6
v_bitop3_b32 v8, v8, v147, v40 bitop3:0xf6
s_waitcnt vmcnt(7)
v_bitop3_b32 v8, v8, v150, v41 bitop3:0xf6
v_bitop3_b32 v8, v8, v151, v41 bitop3:0xf6
s_waitcnt vmcnt(6)
v_bitop3_b32 v8, v8, v154, v42 bitop3:0xf6
v_bitop3_b32 v8, v8, v155, v42 bitop3:0xf6
s_waitcnt vmcnt(5)
v_bitop3_b32 v8, v8, v158, v43 bitop3:0xf6
v_bitop3_b32 v8, v8, v159, v43 bitop3:0xf6
s_waitcnt vmcnt(4)
v_bitop3_b32 v8, v8, v162, v44 bitop3:0xf6
v_bitop3_b32 v8, v8, v163, v44 bitop3:0xf6
s_waitcnt vmcnt(3)
v_bitop3_b32 v8, v8, v166, v45 bitop3:0xf6
v_bitop3_b32 v8, v8, v167, v45 bitop3:0xf6
s_waitcnt vmcnt(2)
v_bitop3_b32 v8, v8, v170, v46 bitop3:0xf6
v_bitop3_b32 v8, v8, v171, v46 bitop3:0xf6
s_waitcnt vmcnt(1)
v_bitop3_b32 v8, v8, v174, v47 bitop3:0xf6
v_bitop3_b32 v8, v8, v175, v47 bitop3:0xf6
s_waitcnt vmcnt(0)
v_xor_b32 v197, v194, v197
v_lshrrev_b32 v9, 4, v197
v_or_b32 v8, v8, v9
v_cmp_ne_u32 vcc, 0, v8
s_nop 0
s_cbranch_vccz L_polled50
s_add_u32 s69, s69, 1
s_cmp_ge_u32 s69, 200000
s_cbranch_scc1 L_polled50
buffer_load_dwordx4 v[144:147], v136, s[40:43], 0 offen sc1
buffer_load_dwordx4 v[148:151], v137, s[40:43], 0 offen sc1
buffer_load_dwordx4 v[152:155], v138, s[40:43], 0 offen sc1
buffer_load_dwordx4 v[156:159], v139, s[40:43], 0 offen sc1
buffer_load_dwordx4 v[160:163], v140, s[40:43], 0 offen sc1
buffer_load_dwordx4 v[164:167], v141, s[40:43], 0 offen sc1
buffer_load_dwordx4 v[168:171], v142, s[40:43], 0 offen sc1
buffer_load_dwordx4 v[172:175], v143, s[40:43], 0 offen sc1
global_load_dword v197, v196, s[32:33] sc1
s_branch L_poll49
L_polled50:
v_cmp_ne_u32 vcc, 0, v197
s_nop 0
s_cmp_eq_u64 vcc, 0
s_cselect_b32 s100, 1, 0
s_add_u32 m0, s67, 0
s_add_u32 s62, s64, 0
s_and_b32 s62, s62, 0x3ff
buffer_load_dwordx4 v244, s[48:51], s62 offen offset:0 lds
buffer_load_dwordx4 v245, s[48:51], s62 offen offset:1024 lds
buffer_load_dwordx4 v246, s[48:51], s62 offen offset:2048 lds
buffer_load_dwordx4 v247, s[48:51], s62 offen offset:3072 lds
s_add_u32 m0, s67, 16384
s_nop 0
buffer_load_dwordx4 v244, s[52:55], s62 offen offset:0 lds
buffer_load_dwordx4 v245, s[52:55], s62 offen offset:1024 lds
buffer_load_dwordx4 v246, s[52:55], s62 offen offset:2048 lds
buffer_load_dwordx4 v247, s[52:55], s62 offen offset:3072 lds
v_mov_b32 v14, 2
s_mov_b64 exec, 1
ds_write_b32 v13, v14
s_mov_b64 exec, -1
v_fma_f32 v40, v2, v172, v168
v_fma_f32 v41, v2, v173, v169
v_fma_f32 v48, -v3, v173, v40
v_fma_f32 v49, v3, v172, v41
v_fma_f32 v40, v2, v48, v164
v_fma_f32 v41, v2, v49, v165
v_fma_f32 v172, -v3, v49, v40
v_fma_f32 v173, v3, v48, v41
v_fma_f32 v40, v2, v172, v160
v_fma_f32 v41, v2, v173, v161
v_fma_f32 v48, -v3, v173, v40
v_fma_f32 v49, v3, v172, v41
v_fma_f32 v40, v2, v48, v156
v_fma_f32 v41, v2, v49, v157
v_fma_f32 v172, -v3, v49, v40
v_fma_f32 v173, v3, v48, v41
v_fma_f32 v40, v2, v172, v152
v_fma_f32 v41, v2, v173, v153
v_fma_f32 v48, -v3, v173, v40
v_fma_f32 v49, v3, v172, v41
v_fma_f32 v40, v2, v48, v148
v_fma_f32 v41, v2, v49, v149
v_fma_f32 v172, -v3, v49, v40
v_fma_f32 v173, v3, v48, v41
v_fma_f32 v40, v2, v172, v144
v_fma_f32 v41, v2, v173, v145
v_fma_f32 v48, -v3, v173, v40
v_fma_f32 v49, v3, v172, v41
v_mov_b32 v50, v48
v_mov_b32 v51, v49
s_nop 0
v_permlane32_swap_b32 v48, v50
v_permlane32_swap_b32 v49, v51
v_fma_f32 v40, v30, v50, v48
v_fma_f32 v41, v30, v51, v49
v_fma_f32 v52, -v31, v51, v40
v_fma_f32 v53, v31, v50, v41
v_mov_b32 v54, v52
v_mov_b32 v55, v53
s_nop 0
v_permlane16_swap_b32 v52, v54
v_permlane16_swap_b32 v53, v55
v_pk_fma_f32 v[128:129], v[52:53], v[184:185], v[128:129] op_sel_hi:[0,1,1]
v_pk_fma_f32 v[130:131], v[52:53], v[186:187], v[130:131] op_sel_hi:[0,1,1]
v_pk_fma_f32 v[128:129], v[52:53], v[186:187], v[128:129] op_sel:[1,0,0] neg_lo:[1,0,0] neg_hi:[1,0,0]
v_pk_fma_f32 v[130:131], v[52:53], v[184:185], v[130:131] op_sel:[1,0,0]
v_pk_fma_f32 v[132:133], v[54:55], v[188:189], v[132:133] op_sel_hi:[0,1,1]
v_pk_fma_f32 v[134:135], v[54:55], v[190:191], v[134:135] op_sel_hi:[0,1,1]
v_pk_fma_f32 v[132:133], v[54:55], v[190:191], v[132:133] op_sel:[1,0,0] neg_lo:[1,0,0] neg_hi:[1,0,0]
v_pk_fma_f32 v[134:135], v[54:55], v[188:189], v[134:135] op_sel:[1,0,0]
v_pk_fma_f32 v[64:65], v[208:209], v[128:129], v[64:65] op_sel_hi:[0,1,1]
v_pk_fma_f32 v[80:81], v[208:209], v[130:131], v[80:81] op_sel_hi:[0,1,1] neg_lo:[1,0,0] neg_hi:[1,0,0]
v_pk_fma_f32 v[64:65], v[208:209], v[130:131], v[64:65] op_sel:[1,0,0] neg_lo:[1,0,0] neg_hi:[1,0,0]
v_pk_fma_f32 v[80:81], v[208:209], v[128:129], v[80:81] op_sel:[1,0,0] neg_lo:[1,0,0] neg_hi:[1,0,0]
v_cvt_pk_bf16_f32 v144, v64, v65
v_cvt_pk_bf16_f32 v152, v80, v81
v_pk_fma_f32 v[96:97], v[224:225], v[132:133], v[96:97] op_sel_hi:[0,1,1]
v_pk_fma_f32 v[112:113], v[224:225], v[134:135], v[112:113] op_sel_hi:[0,1,1] neg_lo:[1,0,0] neg_hi:[1,0,0]
v_pk_fma_f32 v[96:97], v[224:225], v[134:135], v[96:97] op_sel:[1,0,0] neg_lo:[1,0,0] neg_hi:[1,0,0]
v_pk_fma_f32 v[112:113], v[224:225], v[132:133], v[112:113] op_sel:[1,0,0] neg_lo:[1,0,0] neg_hi:[1,0,0]
v_cvt_pk_bf16_f32 v160, v96, v97
v_cvt_pk_bf16_f32 v168, v112, v113
v_pk_fma_f32 v[66:67], v[210:211], v[128:129], v[66:67] op_sel_hi:[0,1,1]
v_pk_fma_f32 v[82:83], v[210:211], v[130:131], v[82:83] op_sel_hi:[0,1,1] neg_lo:[1,0,0] neg_hi:[1,0,0]
v_pk_fma_f32 v[66:67], v[210:211], v[130:131], v[66:67] op_sel:[1,0,0] neg_lo:[1,0,0] neg_hi:[1,0,0]
v_pk_fma_f32 v[82:83], v[210:211], v[128:129], v[82:83] op_sel:[1,0,0] neg_lo:[1,0,0] neg_hi:[1,0,0]
v_cvt_pk_bf16_f32 v145, v66, v67
v_cvt_pk_bf16_f32 v153, v82, v83
v_pk_fma_f32 v[98:99], v[226:227], v[132:133], v[98:99] op_sel_hi:[0,1,1]
v_pk_fma_f32 v[114:115], v[226:227], v[134:135], v[114:115] op_sel_hi:[0,1,1] neg_lo:[1,0,0] neg_hi:[1,0,0]
v_pk_fma_f32 v[98:99], v[226:227], v[134:135], v[98:99] op_sel:[1,0,0] neg_lo:[1,0,0] neg_hi:[1,0,0]
v_pk_fma_f32 v[114:115], v[226:227], v[132:133], v[114:115] op_sel:[1,0,0] neg_lo:[1,0,0] neg_hi:[1,0,0]
v_cvt_pk_bf16_f32 v161, v98, v99
v_cvt_pk_bf16_f32 v169, v114, v115
v_pk_fma_f32 v[68:69], v[212:213], v[128:129], v[68:69] op_sel_hi:[0,1,1]
v_pk_fma_f32 v[84:85], v[212:213], v[130:131], v[84:85] op_sel_hi:[0,1,1] neg_lo:[1,0,0] neg_hi:[1,0,0]
v_pk_fma_f32 v[68:69], v[212:213], v[130:131], v[68:69] op_sel:[1,0,0] neg_lo:[1,0,0] neg_hi:[1,0,0]
v_pk_fma_f32 v[84:85], v[212:213], v[128:129], v[84:85] op_sel:[1,0,0] neg_lo:[1,0,0] neg_hi:[1,0,0]
v_cvt_pk_bf16_f32 v146, v68, v69
v_cvt_pk_bf16_f32 v154, v84, v85
v_pk_fma_f32 v[100:101], v[228:229], v[132:133], v[100:101] op_sel_hi:[0,1,1]
v_pk_fma_f32 v[116:117], v[228:229], v[134:135], v[116:117] op_sel_hi:[0,1,1] neg_lo:[1,0,0] neg_hi:[1,0,0]
v_pk_fma_f32 v[100:101], v[228:229], v[134:135], v[100:101] op_sel:[1,0,0] neg_lo:[1,0,0] neg_hi:[1,0,0]
v_pk_fma_f32 v[116:117], v[228:229], v[132:133], v[116:117] op_sel:[1,0,0] neg_lo:[1,0,0] neg_hi:[1,0,0]
v_cvt_pk_bf16_f32 v162, v100, v101
v_cvt_pk_bf16_f32 v170, v116, v117
v_pk_fma_f32 v[70:71], v[214:215], v[128:129], v[70:71] op_sel_hi:[0,1,1]
v_pk_fma_f32 v[86:87], v[214:215], v[130:131], v[86:87] op_sel_hi:[0,1,1] neg_lo:[1,0,0] neg_hi:[1,0,0]
v_pk_fma_f32 v[70:71], v[214:215], v[130:131], v[70:71] op_sel:[1,0,0] neg_lo:[1,0,0] neg_hi:[1,0,0]
v_pk_fma_f32 v[86:87], v[214:215], v[128:129], v[86:87] op_sel:[1,0,0] neg_lo:[1,0,0] neg_hi:[1,0,0]
v_cvt_pk_bf16_f32 v147, v70, v71
v_cvt_pk_bf16_f32 v155, v86, v87
v_pk_fma_f32 v[102:103], v[230:231], v[132:133], v[102:103] op_sel_hi:[0,1,1]
v_pk_fma_f32 v[118:119], v[230:231], v[134:135], v[118:119] op_sel_hi:[0,1,1] neg_lo:[1,0,0] neg_hi:[1,0,0]
v_pk_fma_f32 v[102:103], v[230:231], v[134:135], v[102:103] op_sel:[1,0,0] neg_lo:[1,0,0] neg_hi:[1,0,0]
v_pk_fma_f32 v[118:119], v[230:231], v[132:133], v[118:119] op_sel:[1,0,0] neg_lo:[1,0,0] neg_hi:[1,0,0]
v_cvt_pk_bf16_f32 v163, v102, v103
v_cvt_pk_bf16_f32 v171, v118, v119
v_mfma_f32_16x16x32_bf16 v[32:35], v[144:147], v[248:251], 0
v_mfma_f32_16x16x32_bf16 v[36:39], v[160:163], v[248:251], 0
v_mfma_f32_16x16x32_bf16 v[40:43], v[144:147], v[252:255], 0
v_mfma_f32_16x16x32_bf16 v[44:47], v[160:163], v[252:255], 0
v_mfma_f32_16x16x32_bf16 v[48:51], v[152:155], v[248:251], 0
v_mfma_f32_16x16x32_bf16 v[52:55], v[168:171], v[248:251], 0
v_mfma_f32_16x16x32_bf16 v[56:59], v[152:155], v[252:255], 0
v_mfma_f32_16x16x32_bf16 v[60:63], v[168:171], v[252:255], 0
v_pk_fma_f32 v[72:73], v[216:217], v[128:129], v[72:73] op_sel_hi:[0,1,1]
v_pk_fma_f32 v[88:89], v[216:217], v[130:131], v[88:89] op_sel_hi:[0,1,1] neg_lo:[1,0,0] neg_hi:[1,0,0]
v_pk_fma_f32 v[72:73], v[216:217], v[130:131], v[72:73] op_sel:[1,0,0] neg_lo:[1,0,0] neg_hi:[1,0,0]
v_pk_fma_f32 v[88:89], v[216:217], v[128:129], v[88:89] op_sel:[1,0,0] neg_lo:[1,0,0] neg_hi:[1,0,0]
v_cvt_pk_bf16_f32 v148, v72, v73
v_cvt_pk_bf16_f32 v156, v88, v89
v_pk_fma_f32 v[104:105], v[232:233], v[132:133], v[104:105] op_sel_hi:[0,1,1]
v_pk_fma_f32 v[120:121], v[232:233], v[134:135], v[120:121] op_sel_hi:[0,1,1] neg_lo:[1,0,0] neg_hi:[1,0,0]
v_pk_fma_f32 v[104:105], v[232:233], v[134:135], v[104:105] op_sel:[1,0,0] neg_lo:[1,0,0] neg_hi:[1,0,0]
v_pk_fma_f32 v[120:121], v[232:233], v[132:133], v[120:121] op_sel:[1,0,0] neg_lo:[1,0,0] neg_hi:[1,0,0]
v_cvt_pk_bf16_f32 v164, v104, v105
v_cvt_pk_bf16_f32 v172, v120, v121
v_pk_fma_f32 v[74:75], v[218:219], v[128:129], v[74:75] op_sel_hi:[0,1,1]
v_pk_fma_f32 v[90:91], v[218:219], v[130:131], v[90:91] op_sel_hi:[0,1,1] neg_lo:[1,0,0] neg_hi:[1,0,0]
v_pk_fma_f32 v[74:75], v[218:219], v[130:131], v[74:75] op_sel:[1,0,0] neg_lo:[1,0,0] neg_hi:[1,0,0]
v_pk_fma_f32 v[90:91], v[218:219], v[128:129], v[90:91] op_sel:[1,0,0] neg_lo:[1,0,0] neg_hi:[1,0,0]
v_cvt_pk_bf16_f32 v149, v74, v75
v_cvt_pk_bf16_f32 v157, v90, v91
v_pk_fma_f32 v[106:107], v[234:235], v[132:133], v[106:107] op_sel_hi:[0,1,1]
v_pk_fma_f32 v[122:123], v[234:235], v[134:135], v[122:123] op_sel_hi:[0,1,1] neg_lo:[1,0,0] neg_hi:[1,0,0]
v_pk_fma_f32 v[106:107], v[234:235], v[134:135], v[106:107] op_sel:[1,0,0] neg_lo:[1,0,0] neg_hi:[1,0,0]
v_pk_fma_f32 v[122:123], v[234:235], v[132:133], v[122:123] op_sel:[1,0,0] neg_lo:[1,0,0] neg_hi:[1,0,0]
v_cvt_pk_bf16_f32 v165, v106, v107
v_cvt_pk_bf16_f32 v173, v122, v123
s_add_u32 s61, s14, 0
v_cvt_pk_bf16_f32 v176, v32, v33
v_cvt_pk_bf16_f32 v177, v34, v35
v_cvt_pk_bf16_f32 v178, v36, v37
v_cvt_pk_bf16_f32 v179, v38, v39
buffer_store_dwordx4 v[176:179], v10, s[44:47], s61 offen offset:0 sc1
ds_write_b128 v16, v[176:179] offset:0
s_add_u32 s61, s14, 131072
v_cvt_pk_bf16_f32 v180, v40, v41
v_cvt_pk_bf16_f32 v181, v42, v43
v_cvt_pk_bf16_f32 v182, v44, v45
v_cvt_pk_bf16_f32 v183, v46, v47
buffer_store_dwordx4 v[180:183], v10, s[44:47], s61 offen offset:0 sc1
ds_write_b128 v16, v[180:183] offset:8192
s_add_u32 s61, s14, 4096
v_cvt_pk_bf16_f32 v184, v48, v49
v_cvt_pk_bf16_f32 v185, v50, v51
v_cvt_pk_bf16_f32 v186, v52, v53
v_cvt_pk_bf16_f32 v187, v54, v55
buffer_store_dwordx4 v[184:187], v10, s[44:47], s61 offen offset:0 sc1
ds_write_b128 v16, v[184:187] offset:4096
s_add_u32 s61, s14, 135168
v_cvt_pk_bf16_f32 v188, v56, v57
v_cvt_pk_bf16_f32 v189, v58, v59
v_cvt_pk_bf16_f32 v190, v60, v61
v_cvt_pk_bf16_f32 v191, v62, v63
buffer_store_dwordx4 v[188:191], v10, s[44:47], s61 offen offset:0 sc1
ds_write_b128 v16, v[188:191] offset:12288
v_pk_fma_f32 v[76:77], v[220:221], v[128:129], v[76:77] op_sel_hi:[0,1,1]
v_pk_fma_f32 v[92:93], v[220:221], v[130:131], v[92:93] op_sel_hi:[0,1,1] neg_lo:[1,0,0] neg_hi:[1,0,0]
v_pk_fma_f32 v[76:77], v[220:221], v[130:131], v[76:77] op_sel:[1,0,0] neg_lo:[1,0,0] neg_hi:[1,0,0]
v_pk_fma_f32 v[92:93], v[220:221], v[128:129], v[92:93] op_sel:[1,0,0] neg_lo:[1,0,0] neg_hi:[1,0,0]
v_cvt_pk_bf16_f32 v150, v76, v77
v_cvt_pk_bf16_f32 v158, v92, v93
v_pk_fma_f32 v[108:109], v[236:237], v[132:133], v[108:109] op_sel_hi:[0,1,1]
v_pk_fma_f32 v[124:125], v[236:237], v[134:135], v[124:125] op_sel_hi:[0,1,1] neg_lo:[1,0,0] neg_hi:[1,0,0]
v_pk_fma_f32 v[108:109], v[236:237], v[134:135], v[108:109] op_sel:[1,0,0] neg_lo:[1,0,0] neg_hi:[1,0,0]
v_pk_fma_f32 v[124:125], v[236:237], v[132:133], v[124:125] op_sel:[1,0,0] neg_lo:[1,0,0] neg_hi:[1,0,0]
v_cvt_pk_bf16_f32 v166, v108, v109
v_cvt_pk_bf16_f32 v174, v124, v125
v_pk_fma_f32 v[78:79], v[222:223], v[128:129], v[78:79] op_sel_hi:[0,1,1]
v_pk_fma_f32 v[94:95], v[222:223], v[130:131], v[94:95] op_sel_hi:[0,1,1] neg_lo:[1,0,0] neg_hi:[1,0,0]
v_pk_fma_f32 v[78:79], v[222:223], v[130:131], v[78:79] op_sel:[1,0,0] neg_lo:[1,0,0] neg_hi:[1,0,0]
v_pk_fma_f32 v[94:95], v[222:223], v[128:129], v[94:95] op_sel:[1,0,0] neg_lo:[1,0,0] neg_hi:[1,0,0]
v_cvt_pk_bf16_f32 v151, v78, v79
v_cvt_pk_bf16_f32 v159, v94, v95
v_pk_fma_f32 v[110:111], v[238:239], v[132:133], v[110:111] op_sel_hi:[0,1,1]
v_pk_fma_f32 v[126:127], v[238:239], v[134:135], v[126:127] op_sel_hi:[0,1,1] neg_lo:[1,0,0] neg_hi:[1,0,0]
v_pk_fma_f32 v[110:111], v[238:239], v[134:135], v[110:111] op_sel:[1,0,0] neg_lo:[1,0,0] neg_hi:[1,0,0]
v_pk_fma_f32 v[126:127], v[238:239], v[132:133], v[126:127] op_sel:[1,0,0] neg_lo:[1,0,0] neg_hi:[1,0,0]
v_cvt_pk_bf16_f32 v167, v110, v111
v_cvt_pk_bf16_f32 v175, v126, v127
v_mfma_f32_16x16x32_bf16 v[32:35], v[148:151], v[248:251], 0
v_mfma_f32_16x16x32_bf16 v[36:39], v[164:167], v[248:251], 0
v_mfma_f32_16x16x32_bf16 v[40:43], v[148:151], v[252:255], 0
v_mfma_f32_16x16x32_bf16 v[44:47], v[164:167], v[252:255], 0
v_mfma_f32_16x16x32_bf16 v[48:51], v[156:159], v[248:251], 0
v_mfma_f32_16x16x32_bf16 v[52:55], v[172:175], v[248:251], 0
v_mfma_f32_16x16x32_bf16 v[56:59], v[156:159], v[252:255], 0
v_mfma_f32_16x16x32_bf16 v[60:63], v[172:175], v[252:255], 0
s_add_u32 s61, s14, 0
v_cvt_pk_bf16_f32 v192, v32, v33
v_cvt_pk_bf16_f32 v193, v34, v35
v_cvt_pk_bf16_f32 v194, v36, v37
v_cvt_pk_bf16_f32 v195, v38, v39
buffer_store_dwordx4 v[192:195], v10, s[44:47], s61 offen offset:256 sc1
ds_write_b128 v16, v[192:195] offset:256
s_add_u32 s61, s14, 131072
v_cvt_pk_bf16_f32 v196, v40, v41
v_cvt_pk_bf16_f32 v197, v42, v43
v_cvt_pk_bf16_f32 v198, v44, v45
v_cvt_pk_bf16_f32 v199, v46, v47
buffer_store_dwordx4 v[196:199], v10, s[44:47], s61 offen offset:256 sc1
ds_write_b128 v16, v[196:199] offset:8448
s_add_u32 s61, s14, 4096
v_cvt_pk_bf16_f32 v200, v48, v49
v_cvt_pk_bf16_f32 v201, v50, v51
v_cvt_pk_bf16_f32 v202, v52, v53
v_cvt_pk_bf16_f32 v203, v54, v55
buffer_store_dwordx4 v[200:203], v10, s[44:47], s61 offen offset:256 sc1
ds_write_b128 v16, v[200:203] offset:4352
s_add_u32 s61, s14, 135168
v_cvt_pk_bf16_f32 v204, v56, v57
v_cvt_pk_bf16_f32 v205, v58, v59
v_cvt_pk_bf16_f32 v206, v60, v61
v_cvt_pk_bf16_f32 v207, v62, v63
buffer_store_dwordx4 v[204:207], v10, s[44:47], s61 offen offset:256 sc1
ds_write_b128 v16, v[204:207] offset:12544
v_mov_b32 v2, v11
s_lshl_b32 s60, s35, 2
s_add_u32 s60, s60, s34
s_mul_i32 s60, s60, 131072
s_lshl_b32 s61, s101, 16
s_add_u32 s60, s60, s61
s_add_u32 s42, s60, 1048576
s_add_u32 s40, s32, s42
s_addc_u32 s41, s33, 0
s_mov_b32 s42, 65536
s_mov_b32 s43, 0x20000
s_waitcnt vmcnt(8) lgkmcnt(0)
v_mov_b32 v14, 3
s_mov_b64 exec, 1
ds_write_b32 v13, v14
s_mov_b64 exec, -1
ds_read_b128 v[8:11], v12 offset:0
s_waitcnt lgkmcnt(0)
L_ck51:
v_min3_u32 v15, v8, v9, v10
v_min_u32 v15, v15, v11
s_nop 0
v_readfirstlane_b32 s60, v15
s_nop 0
s_cmp_ge_u32 s60, 3
s_cbranch_scc1 L_ckd52
ds_read_b128 v[8:11], v12 offset:0
s_waitcnt lgkmcnt(0)
s_branch L_ck51
L_ckd52:
ds_read_b128 v[148:151], v17 offset:0
ds_read_b128 v[152:155], v17 offset:1024
ds_read_b128 v[156:159], v17 offset:2048
ds_read_b128 v[160:163], v17 offset:3072
ds_read_b128 v[164:167], v17 offset:4096
ds_read_b128 v[168:171], v17 offset:5120
ds_read_b128 v[172:175], v17 offset:6144
ds_read_b128 v[176:179], v17 offset:7168
ds_read_b128 v[96:99], v20 offset:0
ds_read_b128 v[100:103], v20 offset:4096
ds_read_b128 v[104:107], v20 offset:8192
ds_read_b128 v[108:111], v20 offset:12288
s_waitcnt lgkmcnt(4)
v_mov_b32 v14, 4
s_mov_b64 exec, 1
ds_write_b32 v13, v14
s_mov_b64 exec, -1
s_waitcnt lgkmcnt(0)
v_mfma_f32_32x32x16_bf16 v[32:47], v[148:151], v[96:99], 0
ds_read_b128 v[112:115], v21 offset:0
ds_read_b128 v[116:119], v21 offset:4096
v_mfma_f32_32x32x16_bf16 v[48:63], v[148:151], v[100:103], 0
ds_read_b128 v[120:123], v21 offset:8192
ds_read_b128 v[124:127], v21 offset:12288
v_mfma_f32_32x32x16_bf16 v[64:79], v[148:151], v[104:107], 0
s_add_u32 m0, s67, 32768
s_add_u32 s62, s64, 128
s_and_b32 s62, s62, 0x3ff
buffer_load_dwordx4 v244, s[48:51], s62 offen offset:0 lds
v_mfma_f32_32x32x16_bf16 v[80:95], v[148:151], v[108:111], 0
s_waitcnt lgkmcnt(3)
v_mfma_f32_32x32x16_bf16 v[32:47], v[152:155], v[112:115], v[32:47]
ds_read_b128 v[96:99], v22 offset:0
ds_read_b128 v[100:103], v22 offset:4096
s_waitcnt lgkmcnt(4)
v_mfma_f32_32x32x16_bf16 v[48:63], v[152:155], v[116:119], v[48:63]
ds_read_b128 v[104:107], v22 offset:8192
ds_read_b128 v[108:111], v22 offset:12288
s_waitcnt lgkmcnt(5)
v_mfma_f32_32x32x16_bf16 v[64:79], v[152:155], v[120:123], v[64:79]
buffer_load_dwordx4 v245, s[48:51], s62 offen offset:1024 lds
s_waitcnt lgkmcnt(4)
v_mfma_f32_32x32x16_bf16 v[80:95], v[152:155], v[124:127], v[80:95]
s_waitcnt lgkmcnt(3)
v_mfma_f32_32x32x16_bf16 v[32:47], v[156:159], v[96:99], v[32:47]
ds_read_b128 v[112:115], v23 offset:0
ds_read_b128 v[116:119], v23 offset:4096
s_waitcnt lgkmcnt(4)
v_mfma_f32_32x32x16_bf16 v[48:63], v[156:159], v[100:103], v[48:63]
ds_read_b128 v[120:123], v23 offset:8192
ds_read_b128 v[124:127], v23 offset:12288
s_waitcnt lgkmcnt(5)
v_mfma_f32_32x32x16_bf16 v[64:79], v[156:159], v[104:107], v[64:79]
buffer_load_dwordx4 v246, s[48:51], s62 offen offset:2048 lds
s_waitcnt lgkmcnt(4)
v_mfma_f32_32x32x16_bf16 v[80:95], v[156:159], v[108:111], v[80:95]
s_waitcnt lgkmcnt(3)
v_mfma_f32_32x32x16_bf16 v[32:47], v[160:163], v[112:115], v[32:47]
ds_read_b128 v[96:99], v20 offset:16384
ds_read_b128 v[100:103], v20 offset:20480
s_waitcnt lgkmcnt(4)
v_mfma_f32_32x32x16_bf16 v[48:63], v[160:163], v[116:119], v[48:63]
ds_read_b128 v[104:107], v20 offset:24576
ds_read_b128 v[108:111], v20 offset:28672
s_waitcnt lgkmcnt(5)
v_mfma_f32_32x32x16_bf16 v[64:79], v[160:163], v[120:123], v[64:79]
buffer_load_dwordx4 v247, s[48:51], s62 offen offset:3072 lds
s_waitcnt lgkmcnt(4)
v_mfma_f32_32x32x16_bf16 v[80:95], v[160:163], v[124:127], v[80:95]
s_waitcnt lgkmcnt(3)
v_mfma_f32_32x32x16_bf16 v[32:47], v[164:167], v[96:99], v[32:47]
ds_read_b128 v[112:115], v21 offset:16384
ds_read_b128 v[116:119], v21 offset:20480
s_waitcnt lgkmcnt(4)
v_mfma_f32_32x32x16_bf16 v[48:63], v[164:167], v[100:103], v[48:63]
ds_read_b128 v[120:123], v21 offset:24576
ds_read_b128 v[124:127], v21 offset:28672
s_waitcnt lgkmcnt(5)
v_mfma_f32_32x32x16_bf16 v[64:79], v[164:167], v[104:107], v[64:79]
s_add_u32 m0, s67, 49152
s_nop 0
buffer_load_dwordx4 v244, s[52:55], s62 offen offset:0 lds
s_waitcnt lgkmcnt(4)
v_mfma_f32_32x32x16_bf16 v[80:95], v[164:167], v[108:111], v[80:95]
s_waitcnt lgkmcnt(3)
v_mfma_f32_32x32x16_bf16 v[32:47], v[168:171], v[112:115], v[32:47]
ds_read_b128 v[96:99], v22 offset:16384
ds_read_b128 v[100:103], v22 offset:20480
s_waitcnt lgkmcnt(4)
v_mfma_f32_32x32x16_bf16 v[48:63], v[168:171], v[116:119], v[48:63]
ds_read_b128 v[104:107], v22 offset:24576
ds_read_b128 v[108:111], v22 offset:28672
s_waitcnt lgkmcnt(5)
v_mfma_f32_32x32x16_bf16 v[64:79], v[168:171], v[120:123], v[64:79]
buffer_load_dwordx4 v245, s[52:55], s62 offen offset:1024 lds
s_waitcnt lgkmcnt(4)
v_mfma_f32_32x32x16_bf16 v[80:95], v[168:171], v[124:127], v[80:95]
s_waitcnt lgkmcnt(3)
v_mfma_f32_32x32x16_bf16 v[32:47], v[172:175], v[96:99], v[32:47]
ds_read_b128 v[112:115], v23 offset:16384
ds_read_b128 v[116:119], v23 offset:20480
s_waitcnt lgkmcnt(4)
v_mfma_f32_32x32x16_bf16 v[48:63], v[172:175], v[100:103], v[48:63]
ds_read_b128 v[120:123], v23 offset:24576
ds_read_b128 v[124:127], v23 offset:28672
s_waitcnt lgkmcnt(5)
v_mfma_f32_32x32x16_bf16 v[64:79], v[172:175], v[104:107], v[64:79]
buffer_load_dwordx4 v246, s[52:55], s62 offen offset:2048 lds
s_waitcnt lgkmcnt(4)
v_mfma_f32_32x32x16_bf16 v[80:95], v[172:175], v[108:111], v[80:95]
s_waitcnt lgkmcnt(0)
v_mfma_f32_32x32x16_bf16 v[32:47], v[176:179], v[112:115], v[32:47]
v_mfma_f32_32x32x16_bf16 v[48:63], v[176:179], v[116:119], v[48:63]
v_mfma_f32_32x32x16_bf16 v[64:79], v[176:179], v[120:123], v[64:79]
buffer_load_dwordx4 v247, s[52:55], s62 offen offset:3072 lds
v_mfma_f32_32x32x16_bf16 v[80:95], v[176:179], v[124:127], v[80:95]
s_lshl_b32 s60, s66, 3
v_lshl_add_u32 v17, v5, 4, s60
v_lshlrev_b32 v28, 11, v17
v_lshl_add_u32 v28, v6, 2, v28
v_lshlrev_b32 v29, 13, v17
v_lshl_add_u32 v29, v6, 3, v29
v_lshlrev_b32 v30, 2, v6
v_mov_b32 v15, s37
s_waitcnt vmcnt(8)
s_mov_b64 exec, 1
s_cmp_eq_u32 s100, 0
s_cbranch_scc1 L_rs53
global_store_dword v19, v15, s[32:33]
s_branch L_rd54
L_rs53:
global_store_dword v19, v15, s[32:33] sc1
L_rd54:
s_mov_b64 exec, -1
ds_read_b128 v[8:11], v12 offset:0
s_waitcnt lgkmcnt(0)
L_ck55:
v_min3_u32 v15, v8, v9, v10
v_min_u32 v15, v15, v11
s_nop 0
v_readfirstlane_b32 s60, v15
s_nop 0
s_cmp_ge_u32 s60, 4
s_cbranch_scc1 L_ckd56
ds_read_b128 v[8:11], v12 offset:0
s_waitcnt lgkmcnt(0)
s_branch L_ck55
L_ckd56:
ds_read_b128 v[8:11], v12 offset:16
s_waitcnt lgkmcnt(0)
L_ck57:
v_min3_u32 v15, v8, v9, v10
v_min_u32 v15, v15, v11
s_nop 0
v_readfirstlane_b32 s60, v15
s_nop 0
s_cmp_ge_u32 s60, 2
s_cbranch_scc1 L_ckd58
ds_read_b128 v[8:11], v12 offset:16
s_waitcnt lgkmcnt(0)
s_branch L_ck57
L_ckd58:
s_add_u32 m0, s67, 65536
s_add_u32 s62, s64, 256
s_and_b32 s62, s62, 0x3ff
buffer_load_dwordx4 v244, s[48:51], s62 offen offset:0 lds
buffer_load_dwordx4 v245, s[48:51], s62 offen offset:1024 lds
buffer_load_dwordx4 v246, s[48:51], s62 offen offset:2048 lds
buffer_load_dwordx4 v247, s[48:51], s62 offen offset:3072 lds
s_add_u32 m0, s67, 81920
s_nop 0
buffer_load_dwordx4 v244, s[52:55], s62 offen offset:0 lds
buffer_load_dwordx4 v245, s[52:55], s62 offen offset:1024 lds
buffer_load_dwordx4 v246, s[52:55], s62 offen offset:2048 lds
buffer_load_dwordx4 v247, s[52:55], s62 offen offset:3072 lds
s_mov_b32 s92, 0
L_w59:
global_load_dword v8, v18, s[32:33] sc1
s_waitcnt vmcnt(0)
v_cmp_ne_u32 vcc, s37, v8
s_nop 0
s_cbranch_vccz L_wd60
s_sleep 4
s_add_u32 s92, s92, 1
s_cmp_lt_u32 s92, 200000
s_cbranch_scc1 L_w59
L_wd60:
v_mov_b32 v14, 5
s_mov_b64 exec, 1
ds_write_b32 v13, v14
s_mov_b64 exec, -1
s_add_u32 s63, s65, 8192
s_and_b32 s63, s63, 0xffff
buffer_load_dwordx4 v[180:183], v2, s[40:43], s63 offen offset:0 sc1
buffer_load_dwordx4 v[184:187], v2, s[40:43], s63 offen offset:1024 sc1
buffer_load_dwordx4 v[188:191], v2, s[40:43], s63 offen offset:2048 sc1
buffer_load_dwordx4 v[192:195], v2, s[40:43], s63 offen offset:3072 sc1
s_add_u32 m0, s67, 98304
s_add_u32 s62, s64, 384
s_and_b32 s62, s62, 0x3ff
buffer_load_dwordx4 v244, s[48:51], s62 offen offset:0 lds
buffer_load_dwordx4 v245, s[48:51], s62 offen offset:1024 lds
buffer_load_dwordx4 v246, s[48:51], s62 offen offset:2048 lds
buffer_load_dwordx4 v247, s[48:51], s62 offen offset:3072 lds
s_add_u32 s63, s65, 12288
s_and_b32 s63, s63, 0xffff
buffer_load_dwordx4 v[196:199], v2, s[40:43], s63 offen offset:0 sc1
buffer_load_dwordx4 v[200:203], v2, s[40:43], s63 offen offset:1024 sc1
buffer_load_dwordx4 v[204:207], v2, s[40:43], s63 offen offset:2048 sc1
buffer_load_dwordx4 v[208:211], v2, s[40:43], s63 offen offset:3072 sc1
ds_read_b128 v[8:11], v12 offset:0
s_waitcnt lgkmcnt(0)
L_ck61:
v_min3_u32 v15, v8, v9, v10
v_min_u32 v15, v15, v11
s_nop 0
v_readfirstlane_b32 s60, v15
s_nop 0
s_cmp_ge_u32 s60, 5
s_cbranch_scc1 L_ckd62
ds_read_b128 v[8:11], v12 offset:0
s_waitcnt lgkmcnt(0)
s_branch L_ck61
L_ckd62:
ds_read_b128 v[96:99], v20 offset:32768
ds_read_b128 v[100:103], v20 offset:36864
ds_read_b128 v[104:107], v20 offset:40960
ds_read_b128 v[108:111], v20 offset:45056
s_waitcnt vmcnt(11) lgkmcnt(3)
v_mfma_f32_32x32x16_bf16 v[32:47], v[180:183], v[96:99], v[32:47]
ds_read_b128 v[112:115], v21 offset:32768
ds_read_b128 v[116:119], v21 offset:36864
s_waitcnt lgkmcnt(4)
v_mfma_f32_32x32x16_bf16 v[48:63], v[180:183], v[100:103], v[48:63]
ds_read_b128 v[120:123], v21 offset:40960
ds_read_b128 v[124:127], v21 offset:45056
s_waitcnt lgkmcnt(5)
v_mfma_f32_32x32x16_bf16 v[64:79], v[180:183], v[104:107], v[64:79]
s_waitcnt lgkmcnt(4)
v_mfma_f32_32x32x16_bf16 v[80:95], v[180:183], v[108:111], v[80:95]
s_add_u32 s63, s65, 16384
s_and_b32 s63, s63, 0xffff
buffer_load_dwordx4 v[212:215], v2, s[40:43], s63 offen offset:0 sc1
buffer_load_dwordx4 v[216:219], v2, s[40:43], s63 offen offset:1024 sc1
s_waitcnt vmcnt(12) lgkmcnt(3)
v_mfma_f32_32x32x16_bf16 v[32:47], v[184:187], v[112:115], v[32:47]
ds_read_b128 v[96:99], v22 offset:32768
ds_read_b128 v[100:103], v22 offset:36864
s_waitcnt lgkmcnt(4)
v_mfma_f32_32x32x16_bf16 v[48:63], v[184:187], v[116:119], v[48:63]
ds_read_b128 v[104:107], v22 offset:40960
ds_read_b128 v[108:111], v22 offset:45056
s_waitcnt lgkmcnt(5)
v_mfma_f32_32x32x16_bf16 v[64:79], v[184:187], v[120:123], v[64:79]
s_waitcnt lgkmcnt(4)
v_mfma_f32_32x32x16_bf16 v[80:95], v[184:187], v[124:127], v[80:95]
buffer_load_dwordx4 v[220:223], v2, s[40:43], s63 offen offset:2048 sc1
buffer_load_dwordx4 v[224:227], v2, s[40:43], s63 offen offset:3072 sc1
s_waitcnt vmcnt(13) lgkmcnt(3)
v_mfma_f32_32x32x16_bf16 v[32:47], v[188:191], v[96:99], v[32:47]
ds_read_b128 v[112:115], v23 offset:32768
ds_read_b128 v[116:119], v23 offset:36864
s_waitcnt lgkmcnt(4)
v_mfma_f32_32x32x16_bf16 v[48:63], v[188:191], v[100:103], v[48:63]
ds_read_b128 v[120:123], v23 offset:40960
ds_read_b128 v[124:127], v23 offset:45056
s_waitcnt lgkmcnt(5)
v_mfma_f32_32x32x16_bf16 v[64:79], v[188:191], v[104:107], v[64:79]
s_waitcnt lgkmcnt(4)
v_mfma_f32_32x32x16_bf16 v[80:95], v[188:191], v[108:111], v[80:95]
s_add_u32 s63, s65, 20480
s_and_b32 s63, s63, 0xffff
buffer_load_dwordx4 v[228:231], v2, s[40:43], s63 offen offset:0 sc1
buffer_load_dwordx4 v[232:235], v2, s[40:43], s63 offen offset:1024 sc1
s_waitcnt vmcnt(14) lgkmcnt(3)
v_mfma_f32_32x32x16_bf16 v[32:47], v[192:195], v[112:115], v[32:47]
ds_read_b128 v[96:99], v20 offset:49152
ds_read_b128 v[100:103], v20 offset:53248
s_waitcnt lgkmcnt(4)
v_mfma_f32_32x32x16_bf16 v[48:63], v[192:195], v[116:119], v[48:63]
ds_read_b128 v[104:107], v20 offset:57344
ds_read_b128 v[108:111], v20 offset:61440
s_waitcnt lgkmcnt(5)
v_mfma_f32_32x32x16_bf16 v[64:79], v[192:195], v[120:123], v[64:79]
s_waitcnt lgkmcnt(4)
v_mfma_f32_32x32x16_bf16 v[80:95], v[192:195], v[124:127], v[80:95]
buffer_load_dwordx4 v[236:239], v2, s[40:43], s63 offen offset:2048 sc1
buffer_load_dwordx4 v[240:243], v2, s[40:43], s63 offen offset:3072 sc1
s_waitcnt vmcnt(11) lgkmcnt(3)
v_mov_b32 v14, 6
s_mov_b64 exec, 1
ds_write_b32 v13, v14
s_mov_b64 exec, -1
v_mfma_f32_32x32x16_bf16 v[32:47], v[196:199], v[96:99], v[32:47]
ds_read_b128 v[112:115], v21 offset:49152
ds_read_b128 v[116:119], v21 offset:53248
s_waitcnt lgkmcnt(5)
v_mfma_f32_32x32x16_bf16 v[48:63], v[196:199], v[100:103], v[48:63]
ds_read_b128 v[120:123], v21 offset:57344
ds_read_b128 v[124:127], v21 offset:61440
s_waitcnt lgkmcnt(6)
v_mfma_f32_32x32x16_bf16 v[64:79], v[196:199], v[104:107], v[64:79]
s_add_u32 m0, s67, 0
s_nop 0
buffer_load_dwordx4 v244, s[52:55], s62 offen offset:0 lds
s_waitcnt lgkmcnt(5)
v_mfma_f32_32x32x16_bf16 v[80:95], v[196:199], v[108:111], v[80:95]
s_add_u32 s63, s65, 24576
s_and_b32 s63, s63, 0xffff
buffer_load_dwordx4 v[148:151], v2, s[40:43], s63 offen offset:0 sc1
buffer_load_dwordx4 v[152:155], v2, s[40:43], s63 offen offset:1024 sc1
s_waitcnt vmcnt(13) lgkmcnt(3)
v_mfma_f32_32x32x16_bf16 v[32:47], v[200:203], v[112:115], v[32:47]
ds_read_b128 v[96:99], v22 offset:49152
ds_read_b128 v[100:103], v22 offset:53248
s_waitcnt lgkmcnt(4)
v_mfma_f32_32x32x16_bf16 v[48:63], v[200:203], v[116:119], v[48:63]
ds_read_b128 v[104:107], v22 offset:57344
ds_read_b128 v[108:111], v22 offset:61440
s_waitcnt lgkmcnt(5)
v_mfma_f32_32x32x16_bf16 v[64:79], v[200:203], v[120:123], v[64:79]
buffer_load_dwordx4 v245, s[52:55], s62 offen offset:1024 lds
s_waitcnt lgkmcnt(4)
v_mfma_f32_32x32x16_bf16 v[80:95], v[200:203], v[124:127], v[80:95]
buffer_load_dwordx4 v[156:159], v2, s[40:43], s63 offen offset:2048 sc1
buffer_load_dwordx4 v[160:163], v2, s[40:43], s63 offen offset:3072 sc1
s_waitcnt vmcnt(15) lgkmcnt(3)
v_mfma_f32_32x32x16_bf16 v[32:47], v[204:207], v[96:99], v[32:47]
ds_read_b128 v[112:115], v23 offset:49152
ds_read_b128 v[116:119], v23 offset:53248
s_waitcnt lgkmcnt(4)
v_mfma_f32_32x32x16_bf16 v[48:63], v[204:207], v[100:103], v[48:63]
ds_read_b128 v[120:123], v23 offset:57344
ds_read_b128 v[124:127], v23 offset:61440
s_waitcnt lgkmcnt(5)
v_mfma_f32_32x32x16_bf16 v[64:79], v[204:207], v[104:107], v[64:79]
buffer_load_dwordx4 v246, s[52:55], s62 offen offset:2048 lds
s_waitcnt lgkmcnt(4)
v_mfma_f32_32x32x16_bf16 v[80:95], v[204:207], v[108:111], v[80:95]
s_add_u32 s63, s65, 28672
s_and_b32 s63, s63, 0xffff
buffer_load_dwordx4 v[164:167], v2, s[40:43], s63 offen offset:0 sc1
buffer_load_dwordx4 v[168:171], v2, s[40:43], s63 offen offset:1024 sc1
ds_read_b128 v[8:11], v12
s_waitcnt vmcnt(17) lgkmcnt(0)
L_ck63:
v_min3_u32 v15, v8, v9, v10
v_min_u32 v15, v15, v11
s_nop 0
v_readfirstlane_b32 s60, v15
s_nop 0
s_cmp_ge_u32 s60, 6
s_cbranch_scc1 L_ckd64
ds_read_b128 v[8:11], v12 offset:0
s_waitcnt lgkmcnt(0)
s_branch L_ck63
L_ckd64:
v_mfma_f32_32x32x16_bf16 v[32:47], v[208:211], v[112:115], v[32:47]
ds_read_b128 v[96:99], v24 offset:0
ds_read_b128 v[100:103], v24 offset:4096
v_mfma_f32_32x32x16_bf16 v[48:63], v[208:211], v[116:119], v[48:63]
ds_read_b128 v[104:107], v24 offset:8192
ds_read_b128 v[108:111], v24 offset:12288
v_mfma_f32_32x32x16_bf16 v[64:79], v[208:211], v[120:123], v[64:79]
buffer_load_dwordx4 v247, s[52:55], s62 offen offset:3072 lds
v_mfma_f32_32x32x16_bf16 v[80:95], v[208:211], v[124:127], v[80:95]
buffer_load_dwordx4 v[172:175], v2, s[40:43], s63 offen offset:2048 sc1
buffer_load_dwordx4 v[176:179], v2, s[40:43], s63 offen offset:3072 sc1
s_waitcnt vmcnt(19) lgkmcnt(3)
v_mfma_f32_32x32x16_bf16 v[32:47], v[212:215], v[96:99], v[32:47]
ds_read_b128 v[112:115], v25 offset:0
ds_read_b128 v[116:119], v25 offset:4096
s_waitcnt lgkmcnt(4)
v_mfma_f32_32x32x16_bf16 v[48:63], v[212:215], v[100:103], v[48:63]
ds_read_b128 v[120:123], v25 offset:8192
ds_read_b128 v[124:127], v25 offset:12288
s_waitcnt lgkmcnt(5)
v_mfma_f32_32x32x16_bf16 v[64:79], v[212:215], v[104:107], v[64:79]
s_add_u32 m0, s67, 16384
s_add_u32 s62, s64, 512
s_and_b32 s62, s62, 0x3ff
buffer_load_dwordx4 v244, s[48:51], s62 offen offset:0 lds
s_waitcnt lgkmcnt(4)
v_mfma_f32_32x32x16_bf16 v[80:95], v[212:215], v[108:111], v[80:95]
s_add_u32 s63, s65, 32768
s_and_b32 s63, s63, 0xffff
buffer_load_dwordx4 v[180:183], v2, s[40:43], s63 offen offset:0 sc1
buffer_load_dwordx4 v[184:187], v2, s[40:43], s63 offen offset:1024 sc1
s_waitcnt vmcnt(21) lgkmcnt(3)
v_mfma_f32_32x32x16_bf16 v[32:47], v[216:219], v[112:115], v[32:47]
ds_read_b128 v[96:99], v26 offset:0
ds_read_b128 v[100:103], v26 offset:4096
s_waitcnt lgkmcnt(4)
v_mfma_f32_32x32x16_bf16 v[48:63], v[216:219], v[116:119], v[48:63]
ds_read_b128 v[104:107], v26 offset:8192
ds_read_b128 v[108:111], v26 offset:12288
s_waitcnt lgkmcnt(5)
v_mfma_f32_32x32x16_bf16 v[64:79], v[216:219], v[120:123], v[64:79]
buffer_load_dwordx4 v245, s[48:51], s62 offen offset:1024 lds
s_waitcnt lgkmcnt(4)
v_mfma_f32_32x32x16_bf16 v[80:95], v[216:219], v[124:127], v[80:95]
buffer_load_dwordx4 v[188:191], v2, s[40:43], s63 offen offset:2048 sc1
buffer_load_dwordx4 v[192:195], v2, s[40:43], s63 offen offset:3072 sc1
s_waitcnt vmcnt(23) lgkmcnt(3)
v_mfma_f32_32x32x16_bf16 v[32:47], v[220:223], v[96:99], v[32:47]
ds_read_b128 v[112:115], v27 offset:0
ds_read_b128 v[116:119], v27 offset:4096
s_waitcnt lgkmcnt(4)
v_mfma_f32_32x32x16_bf16 v[48:63], v[220:223], v[100:103], v[48:63]
ds_read_b128 v[120:123], v27 offset:8192
ds_read_b128 v[124:127], v27 offset:12288
s_waitcnt lgkmcnt(5)
v_mfma_f32_32x32x16_bf16 v[64:79], v[220:223], v[104:107], v[64:79]
buffer_load_dwordx4 v246, s[48:51], s62 offen offset:2048 lds
s_waitcnt lgkmcnt(4)
v_mfma_f32_32x32x16_bf16 v[80:95], v[220:223], v[108:111], v[80:95]
s_add_u32 s63, s65, 36864
s_and_b32 s63, s63, 0xffff
buffer_load_dwordx4 v[196:199], v2, s[40:43], s63 offen offset:0 sc1
buffer_load_dwordx4 v[200:203], v2, s[40:43], s63 offen offset:1024 sc1
s_waitcnt vmcnt(25) lgkmcnt(3)
v_mfma_f32_32x32x16_bf16 v[32:47], v[224:227], v[112:115], v[32:47]
ds_read_b128 v[96:99], v24 offset:16384
ds_read_b128 v[100:103], v24 offset:20480
s_waitcnt lgkmcnt(4)
v_mfma_f32_32x32x16_bf16 v[48:63], v[224:227], v[116:119], v[48:63]
ds_read_b128 v[104:107], v24 offset:24576
ds_read_b128 v[108:111], v24 offset:28672
s_waitcnt lgkmcnt(5)
v_mfma_f32_32x32x16_bf16 v[64:79], v[224:227], v[120:123], v[64:79]
buffer_load_dwordx4 v247, s[48:51], s62 offen offset:3072 lds
s_waitcnt lgkmcnt(4)
v_mfma_f32_32x32x16_bf16 v[80:95], v[224:227], v[124:127], v[80:95]
buffer_load_dwordx4 v[204:207], v2, s[40:43], s63 offen offset:2048 sc1
buffer_load_dwordx4 v[208:211], v2, s[40:43], s63 offen offset:3072 sc1
s_waitcnt vmcnt(14) lgkmcnt(3)
v_mov_b32 v14, 7
s_mov_b64 exec, 1
ds_write_b32 v13, v14
s_mov_b64 exec, -1
v_mfma_f32_32x32x16_bf16 v[32:47], v[228:231], v[96:99], v[32:47]
ds_read_b128 v[112:115], v25 offset:16384
ds_read_b128 v[116:119], v25 offset:20480
s_waitcnt lgkmcnt(5)
v_mfma_f32_32x32x16_bf16 v[48:63], v[228:231], v[100:103], v[48:63]
ds_read_b128 v[120:123], v25 offset:24576
ds_read_b128 v[124:127], v25 offset:28672
s_waitcnt lgkmcnt(6)
v_mfma_f32_32x32x16_bf16 v[64:79], v[228:231], v[104:107], v[64:79]
s_add_u32 m0, s67, 32768
s_nop 0
buffer_load_dwordx4 v244, s[52:55], s62 offen offset:0 lds
s_waitcnt lgkmcnt(5)
v_mfma_f32_32x32x16_bf16 v[80:95], v[228:231], v[108:111], v[80:95]
s_add_u32 s63, s65, 40960
s_and_b32 s63, s63, 0xffff
buffer_load_dwordx4 v[212:215], v2, s[40:43], s63 offen offset:0 sc1
buffer_load_dwordx4 v[216:219], v2, s[40:43], s63 offen offset:1024 sc1
s_waitcnt vmcnt(29) lgkmcnt(3)
v_mfma_f32_32x32x16_bf16 v[32:47], v[232:235], v[112:115], v[32:47]
ds_read_b128 v[96:99], v26 offset:16384
ds_read_b128 v[100:103], v26 offset:20480
s_waitcnt lgkmcnt(4)
v_mfma_f32_32x32x16_bf16 v[48:63], v[232:235], v[116:119], v[48:63]
ds_read_b128 v[104:107], v26 offset:24576
ds_read_b128 v[108:111], v26 offset:28672
s_waitcnt lgkmcnt(5)
v_mfma_f32_32x32x16_bf16 v[64:79], v[232:235], v[120:123], v[64:79]
buffer_load_dwordx4 v245, s[52:55], s62 offen offset:1024 lds
s_waitcnt lgkmcnt(4)
v_mfma_f32_32x32x16_bf16 v[80:95], v[232:235], v[124:127], v[80:95]
buffer_load_dwordx4 v[220:223], v2, s[40:43], s63 offen offset:2048 sc1
buffer_load_dwordx4 v[224:227], v2, s[40:43], s63 offen offset:3072 sc1
s_waitcnt vmcnt(31) lgkmcnt(3)
v_mfma_f32_32x32x16_bf16 v[32:47], v[236:239], v[96:99], v[32:47]
ds_read_b128 v[112:115], v27 offset:16384
ds_read_b128 v[116:119], v27 offset:20480
s_waitcnt lgkmcnt(4)
v_mfma_f32_32x32x16_bf16 v[48:63], v[236:239], v[100:103], v[48:63]
ds_read_b128 v[120:123], v27 offset:24576
ds_read_b128 v[124:127], v27 offset:28672
s_waitcnt lgkmcnt(5)
v_mfma_f32_32x32x16_bf16 v[64:79], v[236:239], v[104:107], v[64:79]
buffer_load_dwordx4 v246, s[52:55], s62 offen offset:2048 lds
s_waitcnt lgkmcnt(4)
v_mfma_f32_32x32x16_bf16 v[80:95], v[236:239], v[108:111], v[80:95]
s_add_u32 s63, s65, 45056
s_and_b32 s63, s63, 0xffff
buffer_load_dwordx4 v[228:231], v2, s[40:43], s63 offen offset:0 sc1
buffer_load_dwordx4 v[232:235], v2, s[40:43], s63 offen offset:1024 sc1
ds_read_b128 v[8:11], v12
s_waitcnt vmcnt(33) lgkmcnt(0)
L_ck65:
v_min3_u32 v15, v8, v9, v10
v_min_u32 v15, v15, v11
s_nop 0
v_readfirstlane_b32 s60, v15
s_nop 0
s_cmp_ge_u32 s60, 7
s_cbranch_scc1 L_ckd66
ds_read_b128 v[8:11], v12 offset:0
s_waitcnt lgkmcnt(0)
s_branch L_ck65
L_ckd66:
v_mfma_f32_32x32x16_bf16 v[32:47], v[240:243], v[112:115], v[32:47]
ds_read_b128 v[96:99], v24 offset:32768
ds_read_b128 v[100:103], v24 offset:36864
v_mfma_f32_32x32x16_bf16 v[48:63], v[240:243], v[116:119], v[48:63]
ds_read_b128 v[104:107], v24 offset:40960
ds_read_b128 v[108:111], v24 offset:45056
v_mfma_f32_32x32x16_bf16 v[64:79], v[240:243], v[120:123], v[64:79]
buffer_load_dwordx4 v247, s[52:55], s62 offen offset:3072 lds
v_mfma_f32_32x32x16_bf16 v[80:95], v[240:243], v[124:127], v[80:95]
buffer_load_dwordx4 v[236:239], v2, s[40:43], s63 offen offset:2048 sc1
buffer_load_dwordx4 v[240:243], v2, s[40:43], s63 offen offset:3072 sc1
s_waitcnt vmcnt(34) lgkmcnt(3)
v_mfma_f32_32x32x16_bf16 v[32:47], v[148:151], v[96:99], v[32:47]
ds_read_b128 v[112:115], v25 offset:32768
ds_read_b128 v[116:119], v25 offset:36864
s_waitcnt lgkmcnt(4)
v_mfma_f32_32x32x16_bf16 v[48:63], v[148:151], v[100:103], v[48:63]
ds_read_b128 v[120:123], v25 offset:40960
ds_read_b128 v[124:127], v25 offset:45056
s_waitcnt lgkmcnt(5)
v_mfma_f32_32x32x16_bf16 v[64:79], v[148:151], v[104:107], v[64:79]
s_add_u32 m0, s67, 49152
s_add_u32 s62, s64, 640
s_and_b32 s62, s62, 0x3ff
buffer_load_dwordx4 v244, s[48:51], s62 offen offset:0 lds
s_waitcnt lgkmcnt(4)
v_mfma_f32_32x32x16_bf16 v[80:95], v[148:151], v[108:111], v[80:95]
s_add_u32 s63, s65, 49152
s_and_b32 s63, s63, 0xffff
buffer_load_dwordx4 v[148:151], v2, s[40:43], s63 offen offset:0 sc1
s_waitcnt vmcnt(35) lgkmcnt(3)
v_mfma_f32_32x32x16_bf16 v[32:47], v[152:155], v[112:115], v[32:47]
ds_read_b128 v[96:99], v26 offset:32768
ds_read_b128 v[100:103], v26 offset:36864
s_waitcnt lgkmcnt(4)
v_mfma_f32_32x32x16_bf16 v[48:63], v[152:155], v[116:119], v[48:63]
ds_read_b128 v[104:107], v26 offset:40960
ds_read_b128 v[108:111], v26 offset:45056
s_waitcnt lgkmcnt(5)
v_mfma_f32_32x32x16_bf16 v[64:79], v[152:155], v[120:123], v[64:79]
buffer_load_dwordx4 v245, s[48:51], s62 offen offset:1024 lds
s_waitcnt lgkmcnt(4)
v_mfma_f32_32x32x16_bf16 v[80:95], v[152:155], v[124:127], v[80:95]
buffer_load_dwordx4 v[152:155], v2, s[40:43], s63 offen offset:1024 sc1
s_waitcnt vmcnt(35) lgkmcnt(3)
v_mfma_f32_32x32x16_bf16 v[32:47], v[156:159], v[96:99], v[32:47]
ds_read_b128 v[112:115], v27 offset:32768
ds_read_b128 v[116:119], v27 offset:36864
s_waitcnt lgkmcnt(4)
v_mfma_f32_32x32x16_bf16 v[48:63], v[156:159], v[100:103], v[48:63]
ds_read_b128 v[120:123], v27 offset:40960
ds_read_b128 v[124:127], v27 offset:45056
s_waitcnt lgkmcnt(5)
v_mfma_f32_32x32x16_bf16 v[64:79], v[156:159], v[104:107], v[64:79]
buffer_load_dwordx4 v246, s[48:51], s62 offen offset:2048 lds
s_waitcnt lgkmcnt(4)
v_mfma_f32_32x32x16_bf16 v[80:95], v[156:159], v[108:111], v[80:95]
buffer_load_dwordx4 v[156:159], v2, s[40:43], s63 offen offset:2048 sc1
s_waitcnt vmcnt(36) lgkmcnt(3)
v_mfma_f32_32x32x16_bf16 v[32:47], v[160:163], v[112:115], v[32:47]
ds_read_b128 v[96:99], v20 offset:0
ds_read_b128 v[100:103], v20 offset:4096
s_waitcnt lgkmcnt(4)
v_mfma_f32_32x32x16_bf16 v[48:63], v[160:163], v[116:119], v[48:63]
ds_read_b128 v[104:107], v20 offset:8192
ds_read_b128 v[108:111], v20 offset:12288
s_waitcnt lgkmcnt(5)
v_mfma_f32_32x32x16_bf16 v[64:79], v[160:163], v[120:123], v[64:79]
buffer_load_dwordx4 v247, s[48:51], s62 offen offset:3072 lds
s_waitcnt lgkmcnt(4)
v_mfma_f32_32x32x16_bf16 v[80:95], v[160:163], v[124:127], v[80:95]
buffer_load_dwordx4 v[160:163], v2, s[40:43], s63 offen offset:3072 sc1
s_waitcnt vmcnt(10) lgkmcnt(3)
v_mov_b32 v14, 8
s_mov_b64 exec, 1
ds_write_b32 v13, v14
s_mov_b64 exec, -1
v_mfma_f32_32x32x16_bf16 v[32:47], v[164:167], v[96:99], v[32:47]
ds_read_b128 v[112:115], v21 offset:0
ds_read_b128 v[116:119], v21 offset:4096
s_waitcnt lgkmcnt(5)
v_mfma_f32_32x32x16_bf16 v[48:63], v[164:167], v[100:103], v[48:63]
ds_read_b128 v[120:123], v21 offset:8192
ds_read_b128 v[124:127], v21 offset:12288
s_waitcnt lgkmcnt(6)
v_mfma_f32_32x32x16_bf16 v[64:79], v[164:167], v[104:107], v[64:79]
s_add_u32 m0, s67, 65536
s_nop 0
buffer_load_dwordx4 v244, s[52:55], s62 offen offset:0 lds
s_waitcnt lgkmcnt(5)
v_mfma_f32_32x32x16_bf16 v[80:95], v[164:167], v[108:111], v[80:95]
s_add_u32 s63, s65, 53248
s_and_b32 s63, s63, 0xffff
buffer_load_dwordx4 v[164:167], v2, s[40:43], s63 offen offset:0 sc1
s_waitcnt vmcnt(37) lgkmcnt(3)
v_mfma_f32_32x32x16_bf16 v[32:47], v[168:171], v[112:115], v[32:47]
ds_read_b128 v[96:99], v22 offset:0
ds_read_b128 v[100:103], v22 offset:4096
s_waitcnt lgkmcnt(4)
v_mfma_f32_32x32x16_bf16 v[48:63], v[168:171], v[116:119], v[48:63]
ds_read_b128 v[104:107], v22 offset:8192
ds_read_b128 v[108:111], v22 offset:12288
s_waitcnt lgkmcnt(5)
v_mfma_f32_32x32x16_bf16 v[64:79], v[168:171], v[120:123], v[64:79]
buffer_load_dwordx4 v245, s[52:55], s62 offen offset:1024 lds
s_waitcnt lgkmcnt(4)
v_mfma_f32_32x32x16_bf16 v[80:95], v[168:171], v[124:127], v[80:95]
buffer_load_dwordx4 v[168:171], v2, s[40:43], s63 offen offset:1024 sc1
s_waitcnt vmcnt(37) lgkmcnt(3)
v_mfma_f32_32x32x16_bf16 v[32:47], v[172:175], v[96:99], v[32:47]
ds_read_b128 v[112:115], v23 offset:0
ds_read_b128 v[116:119], v23 offset:4096
s_waitcnt lgkmcnt(4)
v_mfma_f32_32x32x16_bf16 v[48:63], v[172:175], v[100:103], v[48:63]
ds_read_b128 v[120:123], v23 offset:8192
ds_read_b128 v[124:127], v23 offset:12288
s_waitcnt lgkmcnt(5)
v_mfma_f32_32x32x16_bf16 v[64:79], v[172:175], v[104:107], v[64:79]
buffer_load_dwordx4 v246, s[52:55], s62 offen offset:2048 lds
s_waitcnt lgkmcnt(4)
v_mfma_f32_32x32x16_bf16 v[80:95], v[172:175], v[108:111], v[80:95]
buffer_load_dwordx4 v[172:175], v2, s[40:43], s63 offen offset:2048 sc1
ds_read_b128 v[8:11], v12
s_waitcnt vmcnt(38) lgkmcnt(0)
L_ck67:
v_min3_u32 v15, v8, v9, v10
v_min_u32 v15, v15, v11
s_nop 0
v_readfirstlane_b32 s60, v15
s_nop 0
s_cmp_ge_u32 s60, 8
s_cbranch_scc1 L_ckd68
ds_read_b128 v[8:11], v12 offset:0
s_waitcnt lgkmcnt(0)
s_branch L_ck67
L_ckd68:
v_mfma_f32_32x32x16_bf16 v[32:47], v[176:179], v[112:115], v[32:47]
ds_read_b128 v[96:99], v20 offset:16384
ds_read_b128 v[100:103], v20 offset:20480
v_mfma_f32_32x32x16_bf16 v[48:63], v[176:179], v[116:119], v[48:63]
ds_read_b128 v[104:107], v20 offset:24576
ds_read_b128 v[108:111], v20 offset:28672
v_mfma_f32_32x32x16_bf16 v[64:79], v[176:179], v[120:123], v[64:79]
buffer_load_dwordx4 v247, s[52:55], s62 offen offset:3072 lds
v_mfma_f32_32x32x16_bf16 v[80:95], v[176:179], v[124:127], v[80:95]
buffer_load_dwordx4 v[176:179], v2, s[40:43], s63 offen offset:3072 sc1
s_waitcnt vmcnt(38) lgkmcnt(3)
v_mfma_f32_32x32x16_bf16 v[32:47], v[180:183], v[96:99], v[32:47]
ds_read_b128 v[112:115], v21 offset:16384
ds_read_b128 v[116:119], v21 offset:20480
s_waitcnt lgkmcnt(4)
v_mfma_f32_32x32x16_bf16 v[48:63], v[180:183], v[100:103], v[48:63]
ds_read_b128 v[120:123], v21 offset:24576
ds_read_b128 v[124:127], v21 offset:28672
s_waitcnt lgkmcnt(5)
v_mfma_f32_32x32x16_bf16 v[64:79], v[180:183], v[104:107], v[64:79]
s_add_u32 m0, s67, 81920
s_add_u32 s62, s64, 768
s_and_b32 s62, s62, 0x3ff
buffer_load_dwordx4 v244, s[48:51], s62 offen offset:0 lds
s_waitcnt lgkmcnt(4)
v_mfma_f32_32x32x16_bf16 v[80:95], v[180:183], v[108:111], v[80:95]
s_add_u32 s63, s65, 57344
s_and_b32 s63, s63, 0xffff
buffer_load_dwordx4 v[180:183], v2, s[40:43], s63 offen offset:0 sc1
s_waitcnt vmcnt(39) lgkmcnt(3)
v_mfma_f32_32x32x16_bf16 v[32:47], v[184:187], v[112:115], v[32:47]
ds_read_b128 v[96:99], v22 offset:16384
ds_read_b128 v[100:103], v22 offset:20480
s_waitcnt lgkmcnt(4)
v_mfma_f32_32x32x16_bf16 v[48:63], v[184:187], v[116:119], v[48:63]
ds_read_b128 v[104:107], v22 offset:24576
ds_read_b128 v[108:111], v22 offset:28672
s_waitcnt lgkmcnt(5)
v_mfma_f32_32x32x16_bf16 v[64:79], v[184:187], v[120:123], v[64:79]
buffer_load_dwordx4 v245, s[48:51], s62 offen offset:1024 lds
s_waitcnt lgkmcnt(4)
v_mfma_f32_32x32x16_bf16 v[80:95], v[184:187], v[124:127], v[80:95]
buffer_load_dwordx4 v[184:187], v2, s[40:43], s63 offen offset:1024 sc1
s_waitcnt vmcnt(39) lgkmcnt(3)
v_mfma_f32_32x32x16_bf16 v[32:47], v[188:191], v[96:99], v[32:47]
ds_read_b128 v[112:115], v23 offset:16384
ds_read_b128 v[116:119], v23 offset:20480
s_waitcnt lgkmcnt(4)
v_mfma_f32_32x32x16_bf16 v[48:63], v[188:191], v[100:103], v[48:63]
ds_read_b128 v[120:123], v23 offset:24576
ds_read_b128 v[124:127], v23 offset:28672
s_waitcnt lgkmcnt(5)
v_mfma_f32_32x32x16_bf16 v[64:79], v[188:191], v[104:107], v[64:79]
buffer_load_dwordx4 v246, s[48:51], s62 offen offset:2048 lds
s_waitcnt lgkmcnt(4)
v_mfma_f32_32x32x16_bf16 v[80:95], v[188:191], v[108:111], v[80:95]
buffer_load_dwordx4 v[188:191], v2, s[40:43], s63 offen offset:2048 sc1
s_waitcnt vmcnt(40) lgkmcnt(3)
v_mfma_f32_32x32x16_bf16 v[32:47], v[192:195], v[112:115], v[32:47]
ds_read_b128 v[96:99], v20 offset:32768
ds_read_b128 v[100:103], v20 offset:36864
s_waitcnt lgkmcnt(4)
v_mfma_f32_32x32x16_bf16 v[48:63], v[192:195], v[116:119], v[48:63]
ds_read_b128 v[104:107], v20 offset:40960
ds_read_b128 v[108:111], v20 offset:45056
s_waitcnt lgkmcnt(5)
v_mfma_f32_32x32x16_bf16 v[64:79], v[192:195], v[120:123], v[64:79]
buffer_load_dwordx4 v247, s[48:51], s62 offen offset:3072 lds
s_waitcnt lgkmcnt(4)
v_mfma_f32_32x32x16_bf16 v[80:95], v[192:195], v[124:127], v[80:95]
buffer_load_dwordx4 v[192:195], v2, s[40:43], s63 offen offset:3072 sc1
s_waitcnt vmcnt(9) lgkmcnt(3)
v_mov_b32 v14, 9
s_mov_b64 exec, 1
ds_write_b32 v13, v14
s_mov_b64 exec, -1
v_mfma_f32_32x32x16_bf16 v[32:47], v[196:199], v[96:99], v[32:47]
ds_read_b128 v[112:115], v21 offset:32768
ds_read_b128 v[116:119], v21 offset:36864
s_waitcnt lgkmcnt(5)
v_mfma_f32_32x32x16_bf16 v[48:63], v[196:199], v[100:103], v[48:63]
ds_read_b128 v[120:123], v21 offset:40960
ds_read_b128 v[124:127], v21 offset:45056
s_waitcnt lgkmcnt(6)
v_mfma_f32_32x32x16_bf16 v[64:79], v[196:199], v[104:107], v[64:79]
s_add_u32 m0, s67, 98304
s_nop 0
buffer_load_dwordx4 v244, s[52:55], s62 offen offset:0 lds
s_waitcnt lgkmcnt(5)
v_mfma_f32_32x32x16_bf16 v[80:95], v[196:199], v[108:111], v[80:95]
s_add_u32 s63, s65, 61440
s_and_b32 s63, s63, 0xffff
buffer_load_dwordx4 v[196:199], v2, s[40:43], s63 offen offset:0 sc1
s_waitcnt vmcnt(41) lgkmcnt(3)
v_mfma_f32_32x32x16_bf16 v[32:47], v[200:203], v[112:115], v[32:47]
ds_read_b128 v[96:99], v22 offset:32768
ds_read_b128 v[100:103], v22 offset:36864
s_waitcnt lgkmcnt(4)
v_mfma_f32_32x32x16_bf16 v[48:63], v[200:203], v[116:119], v[48:63]
ds_read_b128 v[104:107], v22 offset:40960
ds_read_b128 v[108:111], v22 offset:45056
s_waitcnt lgkmcnt(5)
v_mfma_f32_32x32x16_bf16 v[64:79], v[200:203], v[120:123], v[64:79]
buffer_load_dwordx4 v245, s[52:55], s62 offen offset:1024 lds
s_waitcnt lgkmcnt(4)
v_mfma_f32_32x32x16_bf16 v[80:95], v[200:203], v[124:127], v[80:95]
buffer_load_dwordx4 v[200:203], v2, s[40:43], s63 offen offset:1024 sc1
s_waitcnt vmcnt(41) lgkmcnt(3)
v_mfma_f32_32x32x16_bf16 v[32:47], v[204:207], v[96:99], v[32:47]
ds_read_b128 v[112:115], v23 offset:32768
ds_read_b128 v[116:119], v23 offset:36864
s_waitcnt lgkmcnt(4)
v_mfma_f32_32x32x16_bf16 v[48:63], v[204:207], v[100:103], v[48:63]
ds_read_b128 v[120:123], v23 offset:40960
ds_read_b128 v[124:127], v23 offset:45056
s_waitcnt lgkmcnt(5)
v_mfma_f32_32x32x16_bf16 v[64:79], v[204:207], v[104:107], v[64:79]
buffer_load_dwordx4 v246, s[52:55], s62 offen offset:2048 lds
s_waitcnt lgkmcnt(4)
v_mfma_f32_32x32x16_bf16 v[80:95], v[204:207], v[108:111], v[80:95]
buffer_load_dwordx4 v[204:207], v2, s[40:43], s63 offen offset:2048 sc1
ds_read_b128 v[8:11], v12
s_waitcnt vmcnt(42) lgkmcnt(0)
L_ck69:
v_min3_u32 v15, v8, v9, v10
v_min_u32 v15, v15, v11
s_nop 0
v_readfirstlane_b32 s60, v15
s_nop 0
s_cmp_ge_u32 s60, 9
s_cbranch_scc1 L_ckd70
ds_read_b128 v[8:11], v12 offset:0
s_waitcnt lgkmcnt(0)
s_branch L_ck69
L_ckd70:
v_mfma_f32_32x32x16_bf16 v[32:47], v[208:211], v[112:115], v[32:47]
ds_read_b128 v[96:99], v20 offset:49152
ds_read_b128 v[100:103], v20 offset:53248
v_mfma_f32_32x32x16_bf16 v[48:63], v[208:211], v[116:119], v[48:63]
ds_read_b128 v[104:107], v20 offset:57344
ds_read_b128 v[108:111], v20 offset:61440
v_mfma_f32_32x32x16_bf16 v[64:79], v[208:211], v[120:123], v[64:79]
buffer_load_dwordx4 v247, s[52:55], s62 offen offset:3072 lds
v_mfma_f32_32x32x16_bf16 v[80:95], v[208:211], v[124:127], v[80:95]
buffer_load_dwordx4 v[208:211], v2, s[40:43], s63 offen offset:3072 sc1
s_waitcnt vmcnt(42) lgkmcnt(3)
v_mfma_f32_32x32x16_bf16 v[32:47], v[212:215], v[96:99], v[32:47]
ds_read_b128 v[112:115], v21 offset:49152
ds_read_b128 v[116:119], v21 offset:53248
s_waitcnt lgkmcnt(4)
v_mfma_f32_32x32x16_bf16 v[48:63], v[212:215], v[100:103], v[48:63]
ds_read_b128 v[120:123], v21 offset:57344
ds_read_b128 v[124:127], v21 offset:61440
s_waitcnt lgkmcnt(5)
v_mfma_f32_32x32x16_bf16 v[64:79], v[212:215], v[104:107], v[64:79]
s_add_u32 m0, s67, 0
s_add_u32 s62, s64, 896
s_and_b32 s62, s62, 0x3ff
buffer_load_dwordx4 v244, s[48:51], s62 offen offset:0 lds
s_waitcnt lgkmcnt(4)
v_mfma_f32_32x32x16_bf16 v[80:95], v[212:215], v[108:111], v[80:95]
s_waitcnt vmcnt(42) lgkmcnt(3)
v_mfma_f32_32x32x16_bf16 v[32:47], v[216:219], v[112:115], v[32:47]
ds_read_b128 v[96:99], v22 offset:49152
ds_read_b128 v[100:103], v22 offset:53248
s_waitcnt lgkmcnt(4)
v_mfma_f32_32x32x16_bf16 v[48:63], v[216:219], v[116:119], v[48:63]
ds_read_b128 v[104:107], v22 offset:57344
ds_read_b128 v[108:111], v22 offset:61440
s_waitcnt lgkmcnt(5)
v_mfma_f32_32x32x16_bf16 v[64:79], v[216:219], v[120:123], v[64:79]
buffer_load_dwordx4 v245, s[48:51], s62 offen offset:1024 lds
s_waitcnt lgkmcnt(4)
v_mfma_f32_32x32x16_bf16 v[80:95], v[216:219], v[124:127], v[80:95]
s_waitcnt vmcnt(41) lgkmcnt(3)
v_mfma_f32_32x32x16_bf16 v[32:47], v[220:223], v[96:99], v[32:47]
ds_read_b128 v[112:115], v23 offset:49152
ds_read_b128 v[116:119], v23 offset:53248
s_waitcnt lgkmcnt(4)
v_mfma_f32_32x32x16_bf16 v[48:63], v[220:223], v[100:103], v[48:63]
ds_read_b128 v[120:123], v23 offset:57344
ds_read_b128 v[124:127], v23 offset:61440
s_waitcnt lgkmcnt(5)
v_mfma_f32_32x32x16_bf16 v[64:79], v[220:223], v[104:107], v[64:79]
buffer_load_dwordx4 v246, s[48:51], s62 offen offset:2048 lds
s_waitcnt lgkmcnt(4)
v_mfma_f32_32x32x16_bf16 v[80:95], v[220:223], v[108:111], v[80:95]
s_waitcnt vmcnt(41) lgkmcnt(3)
v_mfma_f32_32x32x16_bf16 v[32:47], v[224:227], v[112:115], v[32:47]
ds_read_b128 v[96:99], v24 offset:0
ds_read_b128 v[100:103], v24 offset:4096
s_waitcnt lgkmcnt(4)
v_mfma_f32_32x32x16_bf16 v[48:63], v[224:227], v[116:119], v[48:63]
ds_read_b128 v[104:107], v24 offset:8192
ds_read_b128 v[108:111], v24 offset:12288
s_waitcnt lgkmcnt(5)
v_mfma_f32_32x32x16_bf16 v[64:79], v[224:227], v[120:123], v[64:79]
buffer_load_dwordx4 v247, s[48:51], s62 offen offset:3072 lds
s_waitcnt lgkmcnt(4)
v_mfma_f32_32x32x16_bf16 v[80:95], v[224:227], v[124:127], v[80:95]
s_waitcnt vmcnt(5) lgkmcnt(3)
v_mov_b32 v14, 10
s_mov_b64 exec, 1
ds_write_b32 v13, v14
s_mov_b64 exec, -1
v_mfma_f32_32x32x16_bf16 v[32:47], v[228:231], v[96:99], v[32:47]
ds_read_b128 v[112:115], v25 offset:0
ds_read_b128 v[116:119], v25 offset:4096
s_waitcnt lgkmcnt(5)
v_mfma_f32_32x32x16_bf16 v[48:63], v[228:231], v[100:103], v[48:63]
ds_read_b128 v[120:123], v25 offset:8192
ds_read_b128 v[124:127], v25 offset:12288
s_waitcnt lgkmcnt(6)
v_mfma_f32_32x32x16_bf16 v[64:79], v[228:231], v[104:107], v[64:79]
s_add_u32 m0, s67, 16384
s_nop 0
buffer_load_dwordx4 v244, s[52:55], s62 offen offset:0 lds
s_waitcnt lgkmcnt(5)
v_mfma_f32_32x32x16_bf16 v[80:95], v[228:231], v[108:111], v[80:95]
s_waitcnt vmcnt(40) lgkmcnt(3)
v_mfma_f32_32x32x16_bf16 v[32:47], v[232:235], v[112:115], v[32:47]
ds_read_b128 v[96:99], v26 offset:0
ds_read_b128 v[100:103], v26 offset:4096
s_waitcnt lgkmcnt(4)
v_mfma_f32_32x32x16_bf16 v[48:63], v[232:235], v[116:119], v[48:63]
ds_read_b128 v[104:107], v26 offset:8192
ds_read_b128 v[108:111], v26 offset:12288
s_waitcnt lgkmcnt(5)
v_mfma_f32_32x32x16_bf16 v[64:79], v[232:235], v[120:123], v[64:79]
buffer_load_dwordx4 v245, s[52:55], s62 offen offset:1024 lds
s_waitcnt lgkmcnt(4)
v_mfma_f32_32x32x16_bf16 v[80:95], v[232:235], v[124:127], v[80:95]
s_waitcnt vmcnt(39) lgkmcnt(3)
v_mfma_f32_32x32x16_bf16 v[32:47], v[236:239], v[96:99], v[32:47]
ds_read_b128 v[112:115], v27 offset:0
ds_read_b128 v[116:119], v27 offset:4096
s_waitcnt lgkmcnt(4)
v_mfma_f32_32x32x16_bf16 v[48:63], v[236:239], v[100:103], v[48:63]
ds_read_b128 v[120:123], v27 offset:8192
ds_read_b128 v[124:127], v27 offset:12288
s_waitcnt lgkmcnt(5)
v_mfma_f32_32x32x16_bf16 v[64:79], v[236:239], v[104:107], v[64:79]
buffer_load_dwordx4 v246, s[52:55], s62 offen offset:2048 lds
s_waitcnt lgkmcnt(4)
v_mfma_f32_32x32x16_bf16 v[80:95], v[236:239], v[108:111], v[80:95]
ds_read_b128 v[8:11], v12
global_load_dword v31, v30, s[26:27]
s_waitcnt vmcnt(40) lgkmcnt(0)
L_ck71:
v_min3_u32 v15, v8, v9, v10
v_min_u32 v15, v15, v11
s_nop 0
v_readfirstlane_b32 s60, v15
s_nop 0
s_cmp_ge_u32 s60, 10
s_cbranch_scc1 L_ckd72
ds_read_b128 v[8:11], v12 offset:0
s_waitcnt lgkmcnt(0)
s_branch L_ck71
L_ckd72:
v_mfma_f32_32x32x16_bf16 v[32:47], v[240:243], v[112:115], v[32:47]
ds_read_b128 v[96:99], v24 offset:16384
ds_read_b128 v[100:103], v24 offset:20480
v_mfma_f32_32x32x16_bf16 v[48:63], v[240:243], v[116:119], v[48:63]
ds_read_b128 v[104:107], v24 offset:24576
ds_read_b128 v[108:111], v24 offset:28672
v_mfma_f32_32x32x16_bf16 v[64:79], v[240:243], v[120:123], v[64:79]
buffer_load_dwordx4 v247, s[52:55], s62 offen offset:3072 lds
v_mfma_f32_32x32x16_bf16 v[80:95], v[240:243], v[124:127], v[80:95]
s_mov_b32 s60, 0
buffer_load_dword v128, v28, s[56:59], s60 offen offset:0
s_waitcnt vmcnt(40) lgkmcnt(3)
v_mfma_f32_32x32x16_bf16 v[32:47], v[148:151], v[96:99], v[32:47]
ds_read_b128 v[112:115], v25 offset:16384
ds_read_b128 v[116:119], v25 offset:20480
s_waitcnt lgkmcnt(4)
v_mfma_f32_32x32x16_bf16 v[48:63], v[148:151], v[100:103], v[48:63]
ds_read_b128 v[120:123], v25 offset:24576
ds_read_b128 v[124:127], v25 offset:28672
s_waitcnt lgkmcnt(5)
v_mfma_f32_32x32x16_bf16 v[64:79], v[148:151], v[104:107], v[64:79]
s_waitcnt lgkmcnt(4)
v_mfma_f32_32x32x16_bf16 v[80:95], v[148:151], v[108:111], v[80:95]
s_mov_b32 s60, 0
buffer_load_dword v129, v28, s[56:59], s60 offen offset:2048
s_waitcnt vmcnt(39) lgkmcnt(3)
v_mfma_f32_32x32x16_bf16 v[32:47], v[152:155], v[112:115], v[32:47]
ds_read_b128 v[96:99], v26 offset:16384
ds_read_b128 v[100:103], v26 offset:20480
s_waitcnt lgkmcnt(4)
v_mfma_f32_32x32x16_bf16 v[48:63], v[152:155], v[116:119], v[48:63]
ds_read_b128 v[104:107], v26 offset:24576
ds_read_b128 v[108:111], v26 offset:28672
s_waitcnt lgkmcnt(5)
v_mfma_f32_32x32x16_bf16 v[64:79], v[152:155], v[120:123], v[64:79]
s_waitcnt lgkmcnt(4)
v_mfma_f32_32x32x16_bf16 v[80:95], v[152:155], v[124:127], v[80:95]
s_mov_b32 s60, 4096
buffer_load_dword v130, v28, s[56:59], s60 offen offset:0
s_waitcnt vmcnt(38) lgkmcnt(3)
v_mfma_f32_32x32x16_bf16 v[32:47], v[156:159], v[96:99], v[32:47]
ds_read_b128 v[112:115], v27 offset:16384
ds_read_b128 v[116:119], v27 offset:20480
s_waitcnt lgkmcnt(4)
v_mfma_f32_32x32x16_bf16 v[48:63], v[156:159], v[100:103], v[48:63]
ds_read_b128 v[120:123], v27 offset:24576
ds_read_b128 v[124:127], v27 offset:28672
s_waitcnt lgkmcnt(5)
v_mfma_f32_32x32x16_bf16 v[64:79], v[156:159], v[104:107], v[64:79]
s_waitcnt lgkmcnt(4)
v_mfma_f32_32x32x16_bf16 v[80:95], v[156:159], v[108:111], v[80:95]
s_mov_b32 s60, 4096
buffer_load_dword v131, v28, s[56:59], s60 offen offset:2048
s_waitcnt vmcnt(37) lgkmcnt(3)
v_mfma_f32_32x32x16_bf16 v[32:47], v[160:163], v[112:115], v[32:47]
ds_read_b128 v[96:99], v24 offset:32768
ds_read_b128 v[100:103], v24 offset:36864
s_waitcnt lgkmcnt(4)
v_mfma_f32_32x32x16_bf16 v[48:63], v[160:163], v[116:119], v[48:63]
s_waitcnt lgkmcnt(3)
v_mfma_f32_32x32x16_bf16 v[64:79], v[160:163], v[120:123], v[64:79]
s_waitcnt lgkmcnt(2)
v_mfma_f32_32x32x16_bf16 v[80:95], v[160:163], v[124:127], v[80:95]
s_mov_b32 s60, 65536
buffer_load_dword v132, v28, s[56:59], s60 offen offset:0
s_waitcnt vmcnt(5) lgkmcnt(1)
v_mov_b32 v14, 11
s_mov_b64 exec, 1
ds_write_b32 v13, v14
s_mov_b64 exec, -1
v_mfma_f32_32x32x16_bf16 v[32:47], v[164:167], v[96:99], v[32:47]
ds_read_b128 v[112:115], v25 offset:32768
ds_read_b128 v[116:119], v25 offset:36864
s_waitcnt lgkmcnt(3)
v_mfma_f32_32x32x16_bf16 v[48:63], v[164:167], v[100:103], v[48:63]
s_mov_b32 s60, 65536
buffer_load_dword v133, v28, s[56:59], s60 offen offset:2048
s_waitcnt vmcnt(35) lgkmcnt(1)
v_mfma_f32_32x32x16_bf16 v[32:47], v[168:171], v[112:115], v[32:47]
ds_read_b128 v[96:99], v26 offset:32768
ds_read_b128 v[100:103], v26 offset:36864
s_waitcnt lgkmcnt(2)
v_mfma_f32_32x32x16_bf16 v[48:63], v[168:171], v[116:119], v[48:63]
s_mov_b32 s60, 69632
buffer_load_dword v134, v28, s[56:59], s60 offen offset:0
s_waitcnt vmcnt(34) lgkmcnt(1)
v_mfma_f32_32x32x16_bf16 v[32:47], v[172:175], v[96:99], v[32:47]
ds_read_b128 v[112:115], v27 offset:32768
ds_read_b128 v[116:119], v27 offset:36864
s_waitcnt lgkmcnt(2)
v_mfma_f32_32x32x16_bf16 v[48:63], v[172:175], v[100:103], v[48:63]
ds_read_b128 v[8:11], v12
s_mov_b32 s60, 69632
buffer_load_dword v135, v28, s[56:59], s60 offen offset:2048
s_waitcnt vmcnt(33) lgkmcnt(0)
L_ck73:
v_min3_u32 v15, v8, v9, v10
v_min_u32 v15, v15, v11
s_nop 0
v_readfirstlane_b32 s60, v15
s_nop 0
s_cmp_ge_u32 s60, 11
s_cbranch_scc1 L_ckd74
ds_read_b128 v[8:11], v12 offset:0
s_waitcnt lgkmcnt(0)
s_branch L_ck73
L_ckd74:
v_mfma_f32_32x32x16_bf16 v[32:47], v[176:179], v[112:115], v[32:47]
ds_read_b128 v[96:99], v20 offset:0
ds_read_b128 v[100:103], v20 offset:4096
v_mfma_f32_32x32x16_bf16 v[48:63], v[176:179], v[116:119], v[48:63]
s_mov_b32 s60, 8192
buffer_load_dword v136, v28, s[56:59], s60 offen offset:0
s_waitcnt vmcnt(32) lgkmcnt(1)
v_mfma_f32_32x32x16_bf16 v[32:47], v[180:183], v[96:99], v[32:47]
ds_read_b128 v[112:115], v21 offset:0
ds_read_b128 v[116:119], v21 offset:4096
s_waitcnt lgkmcnt(2)
v_mfma_f32_32x32x16_bf16 v[48:63], v[180:183], v[100:103], v[48:63]
s_mov_b32 s60, 8192
buffer_load_dword v137, v28, s[56:59], s60 offen offset:2048
s_waitcnt vmcnt(31) lgkmcnt(1)
v_mfma_f32_32x32x16_bf16 v[32:47], v[184:187], v[112:115], v[32:47]
ds_read_b128 v[96:99], v22 offset:0
ds_read_b128 v[100:103], v22 offset:4096
s_waitcnt lgkmcnt(2)
v_mfma_f32_32x32x16_bf16 v[48:63], v[184:187], v[116:119], v[48:63]
s_mov_b32 s60, 12288
buffer_load_dword v138, v28, s[56:59], s60 offen offset:0
s_waitcnt vmcnt(30) lgkmcnt(1)
v_mfma_f32_32x32x16_bf16 v[32:47], v[188:191], v[96:99], v[32:47]
ds_read_b128 v[112:115], v23 offset:0
ds_read_b128 v[116:119], v23 offset:4096
s_waitcnt lgkmcnt(2)
v_mfma_f32_32x32x16_bf16 v[48:63], v[188:191], v[100:103], v[48:63]
s_mov_b32 s60, 12288
buffer_load_dword v139, v28, s[56:59], s60 offen offset:2048
s_waitcnt vmcnt(29) lgkmcnt(1)
v_mfma_f32_32x32x16_bf16 v[32:47], v[192:195], v[112:115], v[32:47]
ds_read_b128 v[96:99], v20 offset:16384
ds_read_b128 v[100:103], v20 offset:20480
s_waitcnt lgkmcnt(2)
v_mfma_f32_32x32x16_bf16 v[48:63], v[192:195], v[116:119], v[48:63]
s_mov_b32 s60, 73728
buffer_load_dword v140, v28, s[56:59], s60 offen offset:0
s_waitcnt vmcnt(28) lgkmcnt(1)
v_mfma_f32_32x32x16_bf16 v[32:47], v[196:199], v[96:99], v[32:47]
ds_read_b128 v[112:115], v21 offset:16384
ds_read_b128 v[116:119], v21 offset:20480
s_waitcnt lgkmcnt(2)
v_mfma_f32_32x32x16_bf16 v[48:63], v[196:199], v[100:103], v[48:63]
s_mov_b32 s60, 73728
buffer_load_dword v141, v28, s[56:59], s60 offen offset:2048
s_waitcnt vmcnt(27) lgkmcnt(1)
v_mfma_f32_32x32x16_bf16 v[32:47], v[200:203], v[112:115], v[32:47]
ds_read_b128 v[96:99], v22 offset:16384
ds_read_b128 v[100:103], v22 offset:20480
s_waitcnt lgkmcnt(2)
v_mfma_f32_32x32x16_bf16 v[48:63], v[200:203], v[116:119], v[48:63]
s_mov_b32 s60, 77824
buffer_load_dword v142, v28, s[56:59], s60 offen offset:0
s_waitcnt vmcnt(26) lgkmcnt(1)
v_mfma_f32_32x32x16_bf16 v[32:47], v[204:207], v[96:99], v[32:47]
ds_read_b128 v[112:115], v23 offset:16384
ds_read_b128 v[116:119], v23 offset:20480
s_waitcnt lgkmcnt(2)
v_mfma_f32_32x32x16_bf16 v[48:63], v[204:207], v[100:103], v[48:63]
s_mov_b32 s60, 77824
buffer_load_dword v143, v28, s[56:59], s60 offen offset:2048
s_waitcnt vmcnt(25) lgkmcnt(0)
v_mfma_f32_32x32x16_bf16 v[32:47], v[208:211], v[112:115], v[32:47]
v_mfma_f32_32x32x16_bf16 v[48:63], v[208:211], v[116:119], v[48:63]
s_mul_i32 s60, s37, 0x9e3779b1
s_and_b32 s60, s60, 0xbfff0000
s_or_b32 s60, s60, 0x20000000
s_sub_u32 s61, s37, 1
s_xor_b32 s61, s61, s60
s_cmp_lt_u32 s61, 0x10000
s_cselect_b32 s61, 0x10000, 0
s_xor_b32 s60, s60, s61
s_lshl_b32 s64, s35, 4
s_add_u32 s64, s64, s36
s_lshl_b32 s64, s64, 2
s_add_u32 s64, s64, s34
s_lshl_b32 s64, s64, 13
s_add_u32 s50, s64, 33554432
s_add_u32 s48, s32, s50
s_addc_u32 s49, s33, 0
s_mov_b32 s50, 8192
s_mov_b32 s51, 0x20000
s_xor_b32 s64, s64, 262144
s_add_u32 s54, s64, 33554432
s_add_u32 s52, s32, s54
s_addc_u32 s53, s33, 0
s_mov_b32 s54, 8192
s_mov_b32 s55, 0x20000
s_movk_i32 s64, 0x1000
v_cvt_pk_bf16_f32 v96, v32, v48
v_cvt_pk_bf16_f32 v97, v33, v49
v_cvt_pk_bf16_f32 v98, v34, v50
v_cvt_pk_bf16_f32 v99, v35, s60
buffer_store_dwordx4 v[96:99], v2, s[48:51], 0 offen offset:0 sc1
v_cvt_pk_bf16_f32 v100, v51, v36
v_cvt_pk_bf16_f32 v101, v52, v37
v_cvt_pk_bf16_f32 v102, v53, v38
v_cvt_pk_bf16_f32 v103, v54, s60
buffer_store_dwordx4 v[100:103], v2, s[48:51], 0 offen offset:1024 sc1
v_cvt_pk_bf16_f32 v244, v39, v55
v_cvt_pk_bf16_f32 v245, v40, v56
v_cvt_pk_bf16_f32 v246, v41, v57
v_cvt_pk_bf16_f32 v247, v42, s60
buffer_store_dwordx4 v[244:247], v2, s[48:51], 0 offen offset:2048 sc1
v_cvt_pk_bf16_f32 v248, v58, v43
v_cvt_pk_bf16_f32 v249, v59, v44
v_cvt_pk_bf16_f32 v250, v60, v45
v_cvt_pk_bf16_f32 v251, v61, s60
buffer_store_dwordx4 v[248:251], v2, s[48:51], 0 offen offset:3072 sc1
v_cvt_pk_bf16_f32 v252, v46, v62
v_cvt_pk_bf16_f32 v253, v47, v63
v_cvt_pk_bf16_f32 v254, v63, v63
v_cvt_pk_bf16_f32 v255, v63, s60
buffer_store_dwordx4 v[252:255], v2, s[48:51], s64 offen offset:0 sc1
ds_read_b128 v[104:107], v24 offset:40960
ds_read_b128 v[108:111], v24 offset:45056
ds_read_b128 v[120:123], v25 offset:40960
ds_read_b128 v[124:127], v25 offset:45056
s_waitcnt lgkmcnt(2)
v_mfma_f32_32x32x16_bf16 v[64:79], v[164:167], v[104:107], v[64:79]
v_mfma_f32_32x32x16_bf16 v[80:95], v[164:167], v[108:111], v[80:95]
ds_read_b128 v[104:107], v26 offset:40960
ds_read_b128 v[108:111], v26 offset:45056
s_waitcnt lgkmcnt(2)
v_mfma_f32_32x32x16_bf16 v[64:79], v[168:171], v[120:123], v[64:79]
v_mfma_f32_32x32x16_bf16 v[80:95], v[168:171], v[124:127], v[80:95]
ds_read_b128 v[120:123], v27 offset:40960
ds_read_b128 v[124:127], v27 offset:45056
s_waitcnt lgkmcnt(2)
v_mfma_f32_32x32x16_bf16 v[64:79], v[172:175], v[104:107], v[64:79]
v_mfma_f32_32x32x16_bf16 v[80:95], v[172:175], v[108:111], v[80:95]
ds_read_b128 v[104:107], v20 offset:8192
ds_read_b128 v[108:111], v20 offset:12288
s_waitcnt lgkmcnt(2)
v_mfma_f32_32x32x16_bf16 v[64:79], v[176:179], v[120:123], v[64:79]
v_mfma_f32_32x32x16_bf16 v[80:95], v[176:179], v[124:127], v[80:95]
ds_read_b128 v[120:123], v21 offset:8192
ds_read_b128 v[124:127], v21 offset:12288
s_waitcnt lgkmcnt(2)
v_mfma_f32_32x32x16_bf16 v[64:79], v[180:183], v[104:107], v[64:79]
v_mfma_f32_32x32x16_bf16 v[80:95], v[180:183], v[108:111], v[80:95]
ds_read_b128 v[104:107], v22 offset:8192
ds_read_b128 v[108:111], v22 offset:12288
s_waitcnt lgkmcnt(2)
v_mfma_f32_32x32x16_bf16 v[64:79], v[184:187], v[120:123], v[64:79]
v_mfma_f32_32x32x16_bf16 v[80:95], v[184:187], v[124:127], v[80:95]
ds_read_b128 v[120:123], v23 offset:8192
ds_read_b128 v[124:127], v23 offset:12288
s_waitcnt lgkmcnt(2)
v_mfma_f32_32x32x16_bf16 v[64:79], v[188:191], v[104:107], v[64:79]
v_mfma_f32_32x32x16_bf16 v[80:95], v[188:191], v[108:111], v[80:95]
ds_read_b128 v[104:107], v20 offset:24576
ds_read_b128 v[108:111], v20 offset:28672
s_waitcnt lgkmcnt(2)
v_mfma_f32_32x32x16_bf16 v[64:79], v[192:195], v[120:123], v[64:79]
v_mfma_f32_32x32x16_bf16 v[80:95], v[192:195], v[124:127], v[80:95]
ds_read_b128 v[120:123], v21 offset:24576
ds_read_b128 v[124:127], v21 offset:28672
s_waitcnt lgkmcnt(2)
v_mfma_f32_32x32x16_bf16 v[64:79], v[196:199], v[104:107], v[64:79]
v_mfma_f32_32x32x16_bf16 v[80:95], v[196:199], v[108:111], v[80:95]
ds_read_b128 v[104:107], v22 offset:24576
ds_read_b128 v[108:111], v22 offset:28672
s_waitcnt lgkmcnt(2)
v_mfma_f32_32x32x16_bf16 v[64:79], v[200:203], v[120:123], v[64:79]
v_mfma_f32_32x32x16_bf16 v[80:95], v[200:203], v[124:127], v[80:95]
ds_read_b128 v[120:123], v23 offset:24576
ds_read_b128 v[124:127], v23 offset:28672
s_waitcnt lgkmcnt(2)
v_mfma_f32_32x32x16_bf16 v[64:79], v[204:207], v[104:107], v[64:79]
v_mfma_f32_32x32x16_bf16 v[80:95], v[204:207], v[108:111], v[80:95]
s_waitcnt lgkmcnt(0)
v_mfma_f32_32x32x16_bf16 v[64:79], v[208:211], v[120:123], v[64:79]
v_mfma_f32_32x32x16_bf16 v[80:95], v[208:211], v[124:127], v[80:95]
s_waitcnt vmcnt(5)
v_lshlrev_b32 v8, 16, v31
v_and_b32 v9, 0xffff0000, v31
v_lshlrev_b32 v148, 16, v128
v_and_b32 v149, 0xffff0000, v128
v_pk_mul_f32 v[148:149], v[148:149], v[8:9]
v_cvt_pk_bf16_f32 v10, v148, v149
v_lshlrev_b32 v148, 16, v10
v_and_b32 v149, 0xffff0000, v10
s_nop 1
v_add_f32 v148, v148, v64
v_add_f32 v149, v149, v80
v_lshlrev_b32 v150, 16, v129
v_and_b32 v151, 0xffff0000, v129
v_pk_mul_f32 v[150:151], v[150:151], v[8:9]
v_cvt_pk_bf16_f32 v10, v150, v151
v_lshlrev_b32 v150, 16, v10
v_and_b32 v151, 0xffff0000, v10
v_add_f32 v150, v150, v65
v_add_f32 v151, v151, v81
v_lshlrev_b32 v152, 16, v130
v_and_b32 v153, 0xffff0000, v130
v_pk_mul_f32 v[152:153], v[152:153], v[8:9]
v_cvt_pk_bf16_f32 v10, v152, v153
v_lshlrev_b32 v152, 16, v10
v_and_b32 v153, 0xffff0000, v10
v_add_f32 v152, v152, v66
v_add_f32 v153, v153, v82
v_lshlrev_b32 v154, 16, v131
v_and_b32 v155, 0xffff0000, v131
v_pk_mul_f32 v[154:155], v[154:155], v[8:9]
v_cvt_pk_bf16_f32 v10, v154, v155
v_lshlrev_b32 v154, 16, v10
v_and_b32 v155, 0xffff0000, v10
v_add_f32 v154, v154, v67
v_add_f32 v155, v155, v83
v_lshlrev_b32 v156, 16, v132
v_and_b32 v157, 0xffff0000, v132
v_pk_mul_f32 v[156:157], v[156:157], v[8:9]
v_cvt_pk_bf16_f32 v10, v156, v157
v_lshlrev_b32 v156, 16, v10
v_and_b32 v157, 0xffff0000, v10
v_add_f32 v156, v156, v68
v_add_f32 v157, v157, v84
v_lshlrev_b32 v158, 16, v133
v_and_b32 v159, 0xffff0000, v133
v_pk_mul_f32 v[158:159], v[158:159], v[8:9]
v_cvt_pk_bf16_f32 v10, v158, v159
v_lshlrev_b32 v158, 16, v10
v_and_b32 v159, 0xffff0000, v10
v_add_f32 v158, v158, v69
v_add_f32 v159, v159, v85
v_lshlrev_b32 v160, 16, v134
v_and_b32 v161, 0xffff0000, v134
v_pk_mul_f32 v[160:161], v[160:161], v[8:9]
v_cvt_pk_bf16_f32 v10, v160, v161
v_lshlrev_b32 v160, 16, v10
v_and_b32 v161, 0xffff0000, v10
v_add_f32 v160, v160, v70
v_add_f32 v161, v161, v86
v_lshlrev_b32 v162, 16, v135
v_and_b32 v163, 0xffff0000, v135
v_pk_mul_f32 v[162:163], v[162:163], v[8:9]
v_cvt_pk_bf16_f32 v10, v162, v163
v_lshlrev_b32 v162, 16, v10
v_and_b32 v163, 0xffff0000, v10
v_add_f32 v162, v162, v71
v_add_f32 v163, v163, v87
v_lshlrev_b32 v164, 16, v136
v_and_b32 v165, 0xffff0000, v136
v_pk_mul_f32 v[164:165], v[164:165], v[8:9]
v_cvt_pk_bf16_f32 v10, v164, v165
v_lshlrev_b32 v164, 16, v10
v_and_b32 v165, 0xffff0000, v10
v_add_f32 v164, v164, v72
v_add_f32 v165, v165, v88
v_lshlrev_b32 v166, 16, v137
v_and_b32 v167, 0xffff0000, v137
v_pk_mul_f32 v[166:167], v[166:167], v[8:9]
v_cvt_pk_bf16_f32 v10, v166, v167
v_lshlrev_b32 v166, 16, v10
v_and_b32 v167, 0xffff0000, v10
v_add_f32 v166, v166, v73
v_add_f32 v167, v167, v89
v_lshlrev_b32 v168, 16, v138
v_and_b32 v169, 0xffff0000, v138
v_pk_mul_f32 v[168:169], v[168:169], v[8:9]
v_cvt_pk_bf16_f32 v10, v168, v169
v_lshlrev_b32 v168, 16, v10
v_and_b32 v169, 0xffff0000, v10
v_add_f32 v168, v168, v74
v_add_f32 v169, v169, v90
v_lshlrev_b32 v170, 16, v139
v_and_b32 v171, 0xffff0000, v139
v_pk_mul_f32 v[170:171], v[170:171], v[8:9]
v_cvt_pk_bf16_f32 v10, v170, v171
v_lshlrev_b32 v170, 16, v10
v_and_b32 v171, 0xffff0000, v10
v_add_f32 v170, v170, v75
v_add_f32 v171, v171, v91
v_lshlrev_b32 v172, 16, v140
v_and_b32 v173, 0xffff0000, v140
v_pk_mul_f32 v[172:173], v[172:173], v[8:9]
v_cvt_pk_bf16_f32 v10, v172, v173
v_lshlrev_b32 v172, 16, v10
v_and_b32 v173, 0xffff0000, v10
v_add_f32 v172, v172, v76
v_add_f32 v173, v173, v92
v_lshlrev_b32 v174, 16, v141
v_and_b32 v175, 0xffff0000, v141
v_pk_mul_f32 v[174:175], v[174:175], v[8:9]
v_cvt_pk_bf16_f32 v10, v174, v175
v_lshlrev_b32 v174, 16, v10
v_and_b32 v175, 0xffff0000, v10
v_add_f32 v174, v174, v77
v_add_f32 v175, v175, v93
v_lshlrev_b32 v176, 16, v142
v_and_b32 v177, 0xffff0000, v142
v_pk_mul_f32 v[176:177], v[176:177], v[8:9]
v_cvt_pk_bf16_f32 v10, v176, v177
v_lshlrev_b32 v176, 16, v10
v_and_b32 v177, 0xffff0000, v10
v_add_f32 v176, v176, v78
v_add_f32 v177, v177, v94
v_lshlrev_b32 v178, 16, v143
v_and_b32 v179, 0xffff0000, v143
v_pk_mul_f32 v[178:179], v[178:179], v[8:9]
v_cvt_pk_bf16_f32 v10, v178, v179
v_lshlrev_b32 v178, 16, v10
v_and_b32 v179, 0xffff0000, v10
v_add_f32 v178, v178, v79
v_add_f32 v179, v179, v95
s_mov_b32 s44, s28
s_mov_b32 s45, s29
s_mov_b32 s46, s24
s_mov_b32 s47, 0x20000
s_mov_b32 s92, 0
L_xw77:
s_load_dword s61, s[52:53], 5116 glc
s_add_u32 s92, s92, 1
s_waitcnt lgkmcnt(0)
s_xor_b32 s61, s61, s60
s_cmp_lt_u32 s61, 0x10000
s_cbranch_scc1 L_xwd78
s_cmp_lt_u32 s92, 200000
s_cbranch_scc1 L_xw77
L_xwd78:
s_mov_b32 s92, 0
buffer_load_dwordx4 v[180:183], v2, s[52:55], 0 offen offset:0 sc1
buffer_load_dwordx4 v[184:187], v2, s[52:55], 0 offen offset:1024 sc1
buffer_load_dwordx4 v[188:191], v2, s[52:55], 0 offen offset:2048 sc1
buffer_load_dwordx4 v[192:195], v2, s[52:55], 0 offen offset:3072 sc1
buffer_load_dwordx4 v[196:199], v2, s[52:55], s64 offen offset:0 sc1
L_xl75:
v_mov_b32 v10, 0
s_waitcnt vmcnt(4)
v_bitop3_b32 v10, v10, v183, s60 bitop3:0xf6
s_waitcnt vmcnt(3)
v_bitop3_b32 v10, v10, v187, s60 bitop3:0xf6
s_waitcnt vmcnt(2)
v_bitop3_b32 v10, v10, v191, s60 bitop3:0xf6
s_waitcnt vmcnt(1)
v_bitop3_b32 v10, v10, v195, s60 bitop3:0xf6
s_waitcnt vmcnt(0)
v_bitop3_b32 v10, v10, v199, s60 bitop3:0xf6
v_cmp_lt_u32 vcc, 0xffff, v10
s_nop 0
s_cbranch_vccz L_xd76
s_add_u32 s92, s92, 1
s_cmp_ge_u32 s92, 200000
s_cbranch_scc1 L_xd76
buffer_load_dwordx4 v[180:183], v2, s[52:55], 0 offen offset:0 sc1
buffer_load_dwordx4 v[184:187], v2, s[52:55], 0 offen offset:1024 sc1
buffer_load_dwordx4 v[188:191], v2, s[52:55], 0 offen offset:2048 sc1
buffer_load_dwordx4 v[192:195], v2, s[52:55], 0 offen offset:3072 sc1
buffer_load_dwordx4 v[196:199], v2, s[52:55], s64 offen offset:0 sc1
s_branch L_xl75
L_xd76:
v_lshlrev_b32 v10, 16, v180
v_and_b32 v11, 0xffff0000, v180
v_pk_add_f32 v[148:149], v[148:149], v[10:11]
s_mov_b32 s64, 0
buffer_store_dwordx2 v[148:149], v29, s[44:47], s64 offen nt
v_lshlrev_b32 v10, 16, v181
v_and_b32 v11, 0xffff0000, v181
v_pk_add_f32 v[150:151], v[150:151], v[10:11]
s_mov_b32 s64, 8192
buffer_store_dwordx2 v[150:151], v29, s[44:47], s64 offen nt
v_lshlrev_b32 v10, 16, v182
v_and_b32 v11, 0xffff0000, v182
v_pk_add_f32 v[152:153], v[152:153], v[10:11]
s_mov_b32 s64, 16384
buffer_store_dwordx2 v[152:153], v29, s[44:47], s64 offen nt
v_lshlrev_b32 v10, 16, v183
v_lshlrev_b32 v11, 16, v184
v_pk_add_f32 v[154:155], v[154:155], v[10:11]
s_mov_b32 s64, 24576
buffer_store_dwordx2 v[154:155], v29, s[44:47], s64 offen nt
v_and_b32 v10, 0xffff0000, v184
v_lshlrev_b32 v11, 16, v185
v_pk_add_f32 v[156:157], v[156:157], v[10:11]
s_mov_b32 s64, 262144
buffer_store_dwordx2 v[156:157], v29, s[44:47], s64 offen nt
v_and_b32 v10, 0xffff0000, v185
v_lshlrev_b32 v11, 16, v186
v_pk_add_f32 v[158:159], v[158:159], v[10:11]
s_mov_b32 s64, 270336
buffer_store_dwordx2 v[158:159], v29, s[44:47], s64 offen nt
v_and_b32 v10, 0xffff0000, v186
v_lshlrev_b32 v11, 16, v187
v_pk_add_f32 v[160:161], v[160:161], v[10:11]
s_mov_b32 s64, 278528
buffer_store_dwordx2 v[160:161], v29, s[44:47], s64 offen nt
v_lshlrev_b32 v10, 16, v188
v_and_b32 v11, 0xffff0000, v188
v_pk_add_f32 v[162:163], v[162:163], v[10:11]
s_mov_b32 s64, 286720
buffer_store_dwordx2 v[162:163], v29, s[44:47], s64 offen nt
v_lshlrev_b32 v10, 16, v189
v_and_b32 v11, 0xffff0000, v189
v_pk_add_f32 v[164:165], v[164:165], v[10:11]
s_mov_b32 s64, 32768
buffer_store_dwordx2 v[164:165], v29, s[44:47], s64 offen nt
v_lshlrev_b32 v10, 16, v190
v_and_b32 v11, 0xffff0000, v190
v_pk_add_f32 v[166:167], v[166:167], v[10:11]
s_mov_b32 s64, 40960
buffer_store_dwordx2 v[166:167], v29, s[44:47], s64 offen nt
v_lshlrev_b32 v10, 16, v191
v_lshlrev_b32 v11, 16, v192
v_pk_add_f32 v[168:169], v[168:169], v[10:11]
s_mov_b32 s64, 49152
buffer_store_dwordx2 v[168:169], v29, s[44:47], s64 offen nt
v_and_b32 v10, 0xffff0000, v192
v_lshlrev_b32 v11, 16, v193
v_pk_add_f32 v[170:171], v[170:171], v[10:11]
s_mov_b32 s64, 57344
buffer_store_dwordx2 v[170:171], v29, s[44:47], s64 offen nt
v_and_b32 v10, 0xffff0000, v193
v_lshlrev_b32 v11, 16, v194
v_pk_add_f32 v[172:173], v[172:173], v[10:11]
s_mov_b32 s64, 294912
buffer_store_dwordx2 v[172:173], v29, s[44:47], s64 offen nt
v_and_b32 v10, 0xffff0000, v194
v_lshlrev_b32 v11, 16, v195
v_pk_add_f32 v[174:175], v[174:175], v[10:11]
s_mov_b32 s64, 303104
buffer_store_dwordx2 v[174:175], v29, s[44:47], s64 offen nt
v_lshlrev_b32 v10, 16, v196
v_and_b32 v11, 0xffff0000, v196
v_pk_add_f32 v[176:177], v[176:177], v[10:11]
s_mov_b32 s64, 311296
buffer_store_dwordx2 v[176:177], v29, s[44:47], s64 offen nt
v_lshlrev_b32 v10, 16, v197
v_and_b32 v11, 0xffff0000, v197
v_pk_add_f32 v[178:179], v[178:179], v[10:11]
s_mov_b32 s64, 319488
buffer_store_dwordx2 v[178:179], v29, s[44:47], s64 offen nt
L_concat_heads__spectral_gfnet__ssm_conv_s5__prompt_kernel_end:
s_endpgm

.section .rodata,"a"
.p2align 6
.amdhsa_kernel concat_heads__spectral_gfnet__ssm_conv_s5__prompt_kernel
  .amdhsa_next_free_vgpr 256
  .amdhsa_next_free_sgpr 102
  .amdhsa_accum_offset 256
  .amdhsa_group_segment_fixed_size 0
  .amdhsa_kernarg_size 120
  .amdhsa_user_sgpr_count 2
  .amdhsa_user_sgpr_kernarg_segment_ptr 1
  .amdhsa_system_sgpr_workgroup_id_x 1
.end_amdhsa_kernel
.text
```
